```python
import torch

def _softmax(x, axis=-1):
    return torch.softmax(x, dim=axis)
def _gelu(x):
    return torch.nn.functional.gelu(x, approximate="tanh")
def _silu(x):
    return torch.nn.functional.silu(x)
def _sigmoid(x):
    return torch.sigmoid(x)
def _layernorm(x, axis=-1, eps=1e-5):
    m = x.mean(dim=axis, keepdim=True)
    v = x.var(dim=axis, keepdim=True, unbiased=False)
    return (x - m) / torch.sqrt(v + eps)
def _scatter_add(tgt, idx, src, axis=0):
    return tgt.clone().index_add_(axis, idx, src)
def _segment_sum(src, seg, n):
    out = torch.zeros((n,) + src.shape[1:], dtype=src.dtype)
    return out.index_add_(0, seg, src)
def _pad(x, pw):
    flat = tuple(v for pair in reversed(pw) for v in pair)
    return torch.nn.functional.pad(x, flat)

kernel_name = 'interleave_layers__spectral_gfnet__dense_activation_silu__prompt'

def setup_inputs():

    _w = (lambda a: (lambda t: t.to(torch.bfloat16) if t.is_floating_point() else t)(torch.as_tensor(a)))
    def _A_setup():
        B, S, D = 1, 2048, 1024
        Df = D // 2 + 1
        return {
            "x": _w((lambda *s: torch.randn(*s, dtype=torch.bfloat16) * 0.05)(B, S, D)),
            "w_r": _w((lambda *s: torch.randn(*s, dtype=torch.bfloat16) * 0.4)(S, Df) * 0.02),
            "w_i": _w((lambda *s: torch.randn(*s, dtype=torch.bfloat16) * 0.4)(S, Df) * 0.02),
        }
    _A_in = _A_setup()

    def _B_setup():
        B, S, D, F = 1, 2048, 1024, 3584
        return {
            "x": _w((lambda *s: torch.randn(*s, dtype=torch.bfloat16) * 0.05)(B, S, D)),
            "w1": _w((lambda *s: torch.randn(*s, dtype=torch.bfloat16) * 0.4)(D, F) * (D ** -0.5)),
            "w2": _w((lambda *s: torch.randn(*s, dtype=torch.bfloat16) * 0.1)(F, D) * (F ** -0.5)),
        }
    _B_in = _B_setup()

    return {
        "A_x": _A_in["x"],
        "A_w_r": _A_in["w_r"],
        "A_w_i": _A_in["w_i"],
        "B_x": _B_in["x"],
        "B_w1": _B_in["w1"],
        "B_w2": _B_in["w2"],
    }

def reference(A_x, A_w_r, A_w_i, B_x, B_w1, B_w2):
    def _A_ref(x, w_r, w_i):
        B, S, D = x.shape
        X = (lambda x, axes=(-2,-1): torch.fft.rfft2(x.float(), dim=axes))(x, axes=(-2, -1))
        W = w_r + 1j * w_i
        X = X * W
        y = (lambda x, s, axes=(-2,-1): torch.fft.irfft2(x, s=s, dim=axes).to(torch.bfloat16))(X, (S, D), axes=(-2, -1))
        return y

    def _B_ref(x, w1, w2):
        h = torch.einsum("bsd,df->bsf", x, w1)
        h = _silu(h)
        out = torch.einsum("bsf,fd->bsd", h, w2)
        return out

    x = A_x
    x = x + _A_ref(_layernorm(x, axis=-1), A_w_r, A_w_i)
    x = x + _B_ref(_layernorm(x, axis=-1), B_w1, B_w2)
    x = x + _A_ref(_layernorm(x, axis=-1), A_w_r, A_w_i)
    x = x + _B_ref(_layernorm(x, axis=-1), B_w1, B_w2)
    return x
```

```asm
; @launch kernel=main_kernel grid=(256,1,1) block=(256,1,1) lds=163840
.amdgcn_target "amdgcn-amd-amdhsa--gfx950"
.text
.globl main_kernel
.p2align 12
.type main_kernel,@function
main_kernel:
    s_cmp_ge_u32 s2, 256
    s_cbranch_scc1 main_kernel_end
    s_load_dwordx8 s[60:67], s[0:1], 0
    s_load_dwordx4 s[56:59], s[0:1], 32
    s_load_dwordx2 s[4:5], s[0:1], 64
    s_cmp_lg_u32 s2, 240
    s_cbranch_scc1 main_kernel_nz
    v_mov_b32 v240, 0
    v_mov_b32 v241, 0
    v_mov_b32 v242, 0
    v_mov_b32 v243, 0
    v_lshlrev_b32 v254, 4, v0
    s_mov_b32 s18, 268435456
    s_mov_b32 s19, 0x20000
    s_mov_b32 s9, 27459584
    s_waitcnt lgkmcnt(0)
    s_mov_b32 s16, s4
    s_mov_b32 s17, s5
    buffer_store_dwordx4 v[240:243], v254, s[16:19], s9 offen sc1
    s_add_u32 s9, s9, 4096
    buffer_store_dwordx4 v[240:243], v254, s[16:19], s9 offen sc1
    s_add_u32 s9, s9, 4096
    buffer_store_dwordx4 v[240:243], v254, s[16:19], s9 offen sc1
    s_add_u32 s9, s9, 4096
    buffer_store_dwordx4 v[240:243], v254, s[16:19], s9 offen sc1
    s_branch main_kernel_nt
main_kernel_nz:
    s_cmp_lt_u32 s2, 224
    s_cbranch_scc1 main_kernel_nt
    s_getpc_b64 s[8:9]
    s_add_u32 s8, s8, main_kernel@rel32@lo+4
    s_addc_u32 s9, s9, main_kernel@rel32@hi+12
    s_mov_b32 s10, code_end-main_kernel
    s_mov_b32 s11, 0x20000
    s_getpc_b64 s[12:13]
    s_add_u32 s12, s12, tab_k2@rel32@lo+4
    s_addc_u32 s13, s13, tab_k2@rel32@hi+12
    s_mov_b32 s14, 147456
    s_mov_b32 s15, 0x20000
    s_bfe_u32 s6, s2, 0x20003
    s_lshl_b32 s6, s6, 15
    s_sub_u32 s7, s6, 98304
    v_lshlrev_b32 v3, 7, v0
    buffer_load_dword v250, v3, s[8:11], s6 offen
    buffer_load_dword v251, v3, s[12:15], s7 offen
    s_add_u32 s7, s6, 32768
    buffer_load_dword v249, v3, s[12:15], s7 offen
main_kernel_nt:
    s_mov_b32 s69, 0
    s_and_b32 s55, s2, 7
    s_lshl_b32 s55, s55, 5
    s_lshr_b32 s6, s2, 3
    s_add_u32 s55, s55, s6
    s_lshl_b32 s68, s55, 6
    s_lshl_b32 s55, s55, 4
    s_add_u32 s55, s55, 27492352
    s_add_u32 s68, s68, 27459584
    v_mov_b32 v15, 0x80000000
    v_cmp_ne_u32 vcc, 0, v0
    s_nop 1
    v_cndmask_b32 v15, 0, v15, vcc
    s_cmp_ge_u32 s2, 112
    s_cbranch_scc1 main_kernel_rB
    s_mov_b32 s3, s2
    s_and_b32 s8, s3, 7
    s_mul_i32 s8, s8, 14
    s_lshr_b32 s3, s3, 3
    s_lshl_b32 s36, s8, 6
    s_mul_i32 s37, s3, 512
    s_add_u32 s3, s3, s8
    s_getpc_b64 s[12:13]
    s_add_u32 s12, s12, tab_t@rel32@lo+4
    s_addc_u32 s13, s13, tab_t@rel32@hi+12
    s_mov_b32 s14, 18432
    s_mov_b32 s15, 0x20000
    v_lshrrev_b32 v7, 6, v0
    v_and_b32 v1, 63, v0
    v_and_b32 v2, 15, v0
    v_bfe_u32 v3, v0, 4, 2
    v_readfirstlane_b32 s10, v7
    v_lshlrev_b32 v4, 4, v1
    s_mov_b32 s22, 8192
    s_mov_b32 s23, 12288
    s_mov_b32 s28, 16384
    buffer_load_dwordx4 v[16:19], v4, s[12:15], s22 offen offset:0
    buffer_load_dwordx4 v[20:23], v4, s[12:15], s22 offen offset:1024
    buffer_load_dwordx4 v[24:27], v4, s[12:15], s22 offen offset:2048
    buffer_load_dwordx4 v[28:31], v4, s[12:15], s22 offen offset:3072
    buffer_load_dwordx4 v[32:35], v4, s[12:15], s23 offen offset:0
    buffer_load_dwordx4 v[36:39], v4, s[12:15], s23 offen offset:1024
    buffer_load_dwordx4 v[40:43], v4, s[12:15], s23 offen offset:2048
    buffer_load_dwordx4 v[44:47], v4, s[12:15], s23 offen offset:3072
    buffer_load_dwordx4 v[248:251], v4, s[12:15], s28 offen offset:0
    buffer_load_dwordx4 v[252:255], v4, s[12:15], s28 offen offset:1024
    s_mul_i32 s11, s10, 16384
    v_bfe_u32 v5, v1, 2, 2
    s_mov_b32 s9, 114688
    v_mul_lo_u32 v5, v5, s9
    v_mul_u32_u24 v6, 7168, v3
    v_add_u32 v5, v5, v6
    v_and_b32 v6, 3, v1
    v_lshl_add_u32 v5, v6, 4, v5
    s_mul_i32 s20, s10, 28672
    s_lshl_b32 s9, s3, 6
    s_add_u32 s20, s20, s9
    s_add_u32 s11, s11, 0
    s_mov_b32 s26, 7340032
    s_mov_b32 s27, 0x20000
    s_waitcnt lgkmcnt(0)
    s_mov_b32 s24, s56
    s_mov_b32 s25, s57
    s_mov_b32 s16, s4
    s_mov_b32 s17, s5
    s_mov_b32 s18, 268435456
    s_mov_b32 s19, 0x20000
    s_and_b32 s52, s2, 3
    s_lshr_b32 s53, s2, 2
    s_lshr_b32 s8, s53, 4
    s_lshl_b32 s8, s8, 4
    s_and_b32 s9, s53, 15
    s_lshl_b32 s9, s9, 7
    s_add_u32 s8, s8, s9
    s_lshl_b32 s9, s52, 2
    s_add_u32 s8, s8, s9
    s_mul_i32 s40, s8, 1026
    s_and_b32 s54, s40, 15
    s_mul_i32 s9, s10, 32832
    s_add_u32 s40, s40, s9
    s_and_b32 s40, s40, -16
    s_add_u32 s41, s40, 4096
    s_mul_i32 s42, s10, 5120
    s_add_u32 s42, s42, 66560
    s_mov_b32 s34, 2101248
    s_mov_b32 s35, 0x20000
    s_mov_b32 s46, 2101248
    s_mov_b32 s47, 0x20000
    s_mov_b32 s32, s62
    s_mov_b32 s33, s63
    s_mov_b32 s44, s64
    s_mov_b32 s45, s65
    s_add_u32 m0, s42, 0
    s_nop 0
    buffer_load_dwordx4 v4, s[32:35], s40 offen offset:0 lds
    buffer_load_dwordx4 v4, s[32:35], s40 offen offset:1024 lds
    buffer_load_dwordx4 v4, s[32:35], s40 offen offset:2048 lds
    buffer_load_dwordx4 v4, s[32:35], s40 offen offset:3072 lds
    s_add_u32 m0, s42, 20480
    s_nop 0
    buffer_load_dwordx4 v4, s[44:47], s40 offen offset:0 lds
    buffer_load_dwordx4 v4, s[44:47], s40 offen offset:1024 lds
    buffer_load_dwordx4 v4, s[44:47], s40 offen offset:2048 lds
    buffer_load_dwordx4 v4, s[44:47], s40 offen offset:3072 lds
    s_mov_b64 exec, 3
    s_add_u32 m0, s42, 4096
    s_nop 0
    buffer_load_dwordx4 v4, s[32:35], s41 offen lds
    s_add_u32 m0, s42, 24576
    s_nop 0
    buffer_load_dwordx4 v4, s[44:47], s41 offen lds
    s_mov_b64 exec, -1
    v_mov_b32 v6, 0
    buffer_store_dword v6, v15, s[16:19], s55 offen sc1
    v_add_u32 v240, s37, v0
    v_mul_u32_u24 v242, 9363, v240
    v_lshrrev_b32 v242, 16, v242
    v_lshlrev_b32 v240, 7, v240
    v_mul_u32_u24 v242, 6272, v242
    v_add_u32 v240, v240, v242
    buffer_load_dword v240, v240, s[24:27], s36 offen
    v_add_u32 v241, s37, v0
    v_add_u32 v241, 256, v241
    v_mul_u32_u24 v242, 9363, v241
    v_lshrrev_b32 v242, 16, v242
    v_lshlrev_b32 v241, 7, v241
    v_mul_u32_u24 v242, 6272, v242
    v_add_u32 v241, v241, v242
    buffer_load_dword v241, v241, s[24:27], s36 offen
    v_lshlrev_b32 v8, 10, v3
    v_lshl_add_u32 v8, v2, 4, v8
    v_add_u32 v8, s11, v8
    s_mov_b32 s9, 4128
    v_mul_lo_u32 v9, v3, s9
    v_lshl_add_u32 v9, v2, 4, v9
    s_lshl_b32 s9, s10, 8
    s_add_u32 s9, s9, 0
    v_add_u32 v9, s9, v9
    s_mul_i32 s9, s10, 16512
    s_add_u32 s9, s9, 0
    v_add_u32 v10, s9, v4
    v_mov_b32 v11, -1
    v_mov_b32 v12, 0xffff0000
    v_cmp_gt_u32 vcc, 16, v0
    s_nop 1
    v_cndmask_b32 v11, v11, v12, vcc
    v_mov_b32 v12, 1.0
    v_cndmask_b32 v12, v12, 0, vcc
    v_lshlrev_b32 v188, 2, v3
    v_cvt_f32_u32 v188, v188
    v_mul_f32 v176, 0x3a800000, v188
    v_add_f32 v177, 0x3a800000, v176
    v_add_f32 v178, 0x3a800000, v177
    v_add_f32 v179, 0x3a800000, v178
    v_and_b32 v188, 12, v2
    v_bfe_u32 v189, v2, 1, 1
    v_add_u32 v188, v188, v189
    v_lshlrev_b32 v188, 6, v188
    v_lshl_add_u32 v188, s10, 3, v188
    v_cvt_f32_u32 v188, v188
    v_add_f32 v189, 0x43000000, v188
    v_lshrrev_b32 v190, 3, v2
    v_lshl_add_u32 v190, v190, 1, 1
    v_and_b32 v191, 1, v2
    v_mul_u32_u24 v190, v190, v191
    v_cvt_f32_u32 v190, v190
    v_mul_f32 v190, 0x3e800000, v190
    v_fma_f32 v180, v176, v188, v190
    v_fma_f32 v181, v177, v188, v190
    v_fma_f32 v182, v178, v188, v190
    v_fma_f32 v183, v179, v188, v190
    v_fma_f32 v184, v176, v189, v190
    v_fma_f32 v185, v177, v189, v190
    v_fma_f32 v186, v178, v189, v190
    v_fma_f32 v187, v179, v189, v190
    v_cos_f32 v192, v176
    v_sin_f32 v196, v176
    v_cos_f32 v193, v177
    v_sin_f32 v197, v177
    v_cos_f32 v194, v178
    v_sin_f32 v198, v178
    v_cos_f32 v195, v179
    v_sin_f32 v199, v179
    v_cos_f32 v200, v180
    v_sin_f32 v204, v180
    v_cos_f32 v201, v181
    v_sin_f32 v205, v181
    v_cos_f32 v202, v182
    v_sin_f32 v206, v182
    v_cos_f32 v203, v183
    v_sin_f32 v207, v183
    v_cvt_pk_bf16_f32 v48, v200, v201
    v_cvt_pk_bf16_f32 v49, v202, v203
    v_cvt_pk_bf16_f32 v50, v204, v205
    v_cvt_pk_bf16_f32 v51, v206, v207
    v_cos_f32 v216, v184
    v_sin_f32 v220, v184
    v_cos_f32 v217, v185
    v_sin_f32 v221, v185
    v_cos_f32 v218, v186
    v_sin_f32 v222, v186
    v_cos_f32 v219, v187
    v_sin_f32 v223, v187
    v_cvt_pk_bf16_f32 v52, v216, v217
    v_cvt_pk_bf16_f32 v53, v218, v219
    v_cvt_pk_bf16_f32 v54, v220, v221
    v_cvt_pk_bf16_f32 v55, v222, v223
    v_pk_mul_f32 v[208:209], v[200:201], v[192:193]
    v_pk_mul_f32 v[212:213], v[204:205], v[192:193]
    v_pk_mul_f32 v[210:211], v[202:203], v[194:195]
    v_pk_mul_f32 v[214:215], v[206:207], v[194:195]
    v_pk_fma_f32 v[208:209], v[204:205], v[196:197], v[208:209] neg_lo:[1,0,0] neg_hi:[1,0,0]
    v_pk_fma_f32 v[212:213], v[200:201], v[196:197], v[212:213]
    v_pk_fma_f32 v[210:211], v[206:207], v[198:199], v[210:211] neg_lo:[1,0,0] neg_hi:[1,0,0]
    v_pk_fma_f32 v[214:215], v[202:203], v[198:199], v[214:215]
    v_cvt_pk_bf16_f32 v56, v208, v209
    v_cvt_pk_bf16_f32 v57, v210, v211
    v_cvt_pk_bf16_f32 v58, v212, v213
    v_cvt_pk_bf16_f32 v59, v214, v215
    v_pk_mul_f32 v[224:225], v[216:217], v[192:193]
    v_pk_mul_f32 v[228:229], v[220:221], v[192:193]
    v_pk_mul_f32 v[226:227], v[218:219], v[194:195]
    v_pk_mul_f32 v[230:231], v[222:223], v[194:195]
    v_pk_fma_f32 v[224:225], v[220:221], v[196:197], v[224:225] neg_lo:[1,0,0] neg_hi:[1,0,0]
    v_pk_fma_f32 v[228:229], v[216:217], v[196:197], v[228:229]
    v_pk_fma_f32 v[226:227], v[222:223], v[198:199], v[226:227] neg_lo:[1,0,0] neg_hi:[1,0,0]
    v_pk_fma_f32 v[230:231], v[218:219], v[198:199], v[230:231]
    v_cvt_pk_bf16_f32 v60, v224, v225
    v_cvt_pk_bf16_f32 v61, v226, v227
    v_cvt_pk_bf16_f32 v62, v228, v229
    v_cvt_pk_bf16_f32 v63, v230, v231
    v_pk_mul_f32 v[200:201], v[208:209], v[192:193]
    v_pk_mul_f32 v[204:205], v[212:213], v[192:193]
    v_pk_mul_f32 v[202:203], v[210:211], v[194:195]
    v_pk_mul_f32 v[206:207], v[214:215], v[194:195]
    v_pk_fma_f32 v[200:201], v[212:213], v[196:197], v[200:201] neg_lo:[1,0,0] neg_hi:[1,0,0]
    v_pk_fma_f32 v[204:205], v[208:209], v[196:197], v[204:205]
    v_pk_fma_f32 v[202:203], v[214:215], v[198:199], v[202:203] neg_lo:[1,0,0] neg_hi:[1,0,0]
    v_pk_fma_f32 v[206:207], v[210:211], v[198:199], v[206:207]
    v_cvt_pk_bf16_f32 v64, v200, v201
    v_cvt_pk_bf16_f32 v65, v202, v203
    v_cvt_pk_bf16_f32 v66, v204, v205
    v_cvt_pk_bf16_f32 v67, v206, v207
    v_pk_mul_f32 v[216:217], v[224:225], v[192:193]
    v_pk_mul_f32 v[220:221], v[228:229], v[192:193]
    v_pk_mul_f32 v[218:219], v[226:227], v[194:195]
    v_pk_mul_f32 v[222:223], v[230:231], v[194:195]
    v_pk_fma_f32 v[216:217], v[228:229], v[196:197], v[216:217] neg_lo:[1,0,0] neg_hi:[1,0,0]
    v_pk_fma_f32 v[220:221], v[224:225], v[196:197], v[220:221]
    v_pk_fma_f32 v[218:219], v[230:231], v[198:199], v[218:219] neg_lo:[1,0,0] neg_hi:[1,0,0]
    v_pk_fma_f32 v[222:223], v[226:227], v[198:199], v[222:223]
    v_cvt_pk_bf16_f32 v68, v216, v217
    v_cvt_pk_bf16_f32 v69, v218, v219
    v_cvt_pk_bf16_f32 v70, v220, v221
    v_cvt_pk_bf16_f32 v71, v222, v223
    v_pk_mul_f32 v[208:209], v[200:201], v[192:193]
    v_pk_mul_f32 v[212:213], v[204:205], v[192:193]
    v_pk_mul_f32 v[210:211], v[202:203], v[194:195]
    v_pk_mul_f32 v[214:215], v[206:207], v[194:195]
    v_pk_fma_f32 v[208:209], v[204:205], v[196:197], v[208:209] neg_lo:[1,0,0] neg_hi:[1,0,0]
    v_pk_fma_f32 v[212:213], v[200:201], v[196:197], v[212:213]
    v_pk_fma_f32 v[210:211], v[206:207], v[198:199], v[210:211] neg_lo:[1,0,0] neg_hi:[1,0,0]
    v_pk_fma_f32 v[214:215], v[202:203], v[198:199], v[214:215]
    v_cvt_pk_bf16_f32 v72, v208, v209
    v_cvt_pk_bf16_f32 v73, v210, v211
    v_cvt_pk_bf16_f32 v74, v212, v213
    v_cvt_pk_bf16_f32 v75, v214, v215
    v_pk_mul_f32 v[224:225], v[216:217], v[192:193]
    v_pk_mul_f32 v[228:229], v[220:221], v[192:193]
    v_pk_mul_f32 v[226:227], v[218:219], v[194:195]
    v_pk_mul_f32 v[230:231], v[222:223], v[194:195]
    v_pk_fma_f32 v[224:225], v[220:221], v[196:197], v[224:225] neg_lo:[1,0,0] neg_hi:[1,0,0]
    v_pk_fma_f32 v[228:229], v[216:217], v[196:197], v[228:229]
    v_pk_fma_f32 v[226:227], v[222:223], v[198:199], v[226:227] neg_lo:[1,0,0] neg_hi:[1,0,0]
    v_pk_fma_f32 v[230:231], v[218:219], v[198:199], v[230:231]
    v_cvt_pk_bf16_f32 v76, v224, v225
    v_cvt_pk_bf16_f32 v77, v226, v227
    v_cvt_pk_bf16_f32 v78, v228, v229
    v_cvt_pk_bf16_f32 v79, v230, v231
    v_pk_mul_f32 v[200:201], v[208:209], v[192:193]
    v_pk_mul_f32 v[204:205], v[212:213], v[192:193]
    v_pk_mul_f32 v[202:203], v[210:211], v[194:195]
    v_pk_mul_f32 v[206:207], v[214:215], v[194:195]
    v_pk_fma_f32 v[200:201], v[212:213], v[196:197], v[200:201] neg_lo:[1,0,0] neg_hi:[1,0,0]
    v_pk_fma_f32 v[204:205], v[208:209], v[196:197], v[204:205]
    v_pk_fma_f32 v[202:203], v[214:215], v[198:199], v[202:203] neg_lo:[1,0,0] neg_hi:[1,0,0]
    v_pk_fma_f32 v[206:207], v[210:211], v[198:199], v[206:207]
    v_cvt_pk_bf16_f32 v80, v200, v201
    v_cvt_pk_bf16_f32 v81, v202, v203
    v_cvt_pk_bf16_f32 v82, v204, v205
    v_cvt_pk_bf16_f32 v83, v206, v207
    v_pk_mul_f32 v[216:217], v[224:225], v[192:193]
    v_pk_mul_f32 v[220:221], v[228:229], v[192:193]
    v_pk_mul_f32 v[218:219], v[226:227], v[194:195]
    v_pk_mul_f32 v[222:223], v[230:231], v[194:195]
    v_pk_fma_f32 v[216:217], v[228:229], v[196:197], v[216:217] neg_lo:[1,0,0] neg_hi:[1,0,0]
    v_pk_fma_f32 v[220:221], v[224:225], v[196:197], v[220:221]
    v_pk_fma_f32 v[218:219], v[230:231], v[198:199], v[218:219] neg_lo:[1,0,0] neg_hi:[1,0,0]
    v_pk_fma_f32 v[222:223], v[226:227], v[198:199], v[222:223]
    v_cvt_pk_bf16_f32 v84, v216, v217
    v_cvt_pk_bf16_f32 v85, v218, v219
    v_cvt_pk_bf16_f32 v86, v220, v221
    v_cvt_pk_bf16_f32 v87, v222, v223
    v_pk_mul_f32 v[208:209], v[200:201], v[192:193]
    v_pk_mul_f32 v[212:213], v[204:205], v[192:193]
    v_pk_mul_f32 v[210:211], v[202:203], v[194:195]
    v_pk_mul_f32 v[214:215], v[206:207], v[194:195]
    v_pk_fma_f32 v[208:209], v[204:205], v[196:197], v[208:209] neg_lo:[1,0,0] neg_hi:[1,0,0]
    v_pk_fma_f32 v[212:213], v[200:201], v[196:197], v[212:213]
    v_pk_fma_f32 v[210:211], v[206:207], v[198:199], v[210:211] neg_lo:[1,0,0] neg_hi:[1,0,0]
    v_pk_fma_f32 v[214:215], v[202:203], v[198:199], v[214:215]
    v_cvt_pk_bf16_f32 v88, v208, v209
    v_cvt_pk_bf16_f32 v89, v210, v211
    v_cvt_pk_bf16_f32 v90, v212, v213
    v_cvt_pk_bf16_f32 v91, v214, v215
    v_pk_mul_f32 v[224:225], v[216:217], v[192:193]
    v_pk_mul_f32 v[228:229], v[220:221], v[192:193]
    v_pk_mul_f32 v[226:227], v[218:219], v[194:195]
    v_pk_mul_f32 v[230:231], v[222:223], v[194:195]
    v_pk_fma_f32 v[224:225], v[220:221], v[196:197], v[224:225] neg_lo:[1,0,0] neg_hi:[1,0,0]
    v_pk_fma_f32 v[228:229], v[216:217], v[196:197], v[228:229]
    v_pk_fma_f32 v[226:227], v[222:223], v[198:199], v[226:227] neg_lo:[1,0,0] neg_hi:[1,0,0]
    v_pk_fma_f32 v[230:231], v[218:219], v[198:199], v[230:231]
    v_cvt_pk_bf16_f32 v92, v224, v225
    v_cvt_pk_bf16_f32 v93, v226, v227
    v_cvt_pk_bf16_f32 v94, v228, v229
    v_cvt_pk_bf16_f32 v95, v230, v231
    v_pk_mul_f32 v[200:201], v[208:209], v[192:193]
    v_pk_mul_f32 v[204:205], v[212:213], v[192:193]
    v_pk_mul_f32 v[202:203], v[210:211], v[194:195]
    v_pk_mul_f32 v[206:207], v[214:215], v[194:195]
    v_pk_fma_f32 v[200:201], v[212:213], v[196:197], v[200:201] neg_lo:[1,0,0] neg_hi:[1,0,0]
    v_pk_fma_f32 v[204:205], v[208:209], v[196:197], v[204:205]
    v_pk_fma_f32 v[202:203], v[214:215], v[198:199], v[202:203] neg_lo:[1,0,0] neg_hi:[1,0,0]
    v_pk_fma_f32 v[206:207], v[210:211], v[198:199], v[206:207]
    v_cvt_pk_bf16_f32 v96, v200, v201
    v_cvt_pk_bf16_f32 v97, v202, v203
    v_cvt_pk_bf16_f32 v98, v204, v205
    v_cvt_pk_bf16_f32 v99, v206, v207
    v_pk_mul_f32 v[216:217], v[224:225], v[192:193]
    v_pk_mul_f32 v[220:221], v[228:229], v[192:193]
    v_pk_mul_f32 v[218:219], v[226:227], v[194:195]
    v_pk_mul_f32 v[222:223], v[230:231], v[194:195]
    v_pk_fma_f32 v[216:217], v[228:229], v[196:197], v[216:217] neg_lo:[1,0,0] neg_hi:[1,0,0]
    v_pk_fma_f32 v[220:221], v[224:225], v[196:197], v[220:221]
    v_pk_fma_f32 v[218:219], v[230:231], v[198:199], v[218:219] neg_lo:[1,0,0] neg_hi:[1,0,0]
    v_pk_fma_f32 v[222:223], v[226:227], v[198:199], v[222:223]
    v_cvt_pk_bf16_f32 v100, v216, v217
    v_cvt_pk_bf16_f32 v101, v218, v219
    v_cvt_pk_bf16_f32 v102, v220, v221
    v_cvt_pk_bf16_f32 v103, v222, v223
    v_pk_mul_f32 v[208:209], v[200:201], v[192:193]
    v_pk_mul_f32 v[212:213], v[204:205], v[192:193]
    v_pk_mul_f32 v[210:211], v[202:203], v[194:195]
    v_pk_mul_f32 v[214:215], v[206:207], v[194:195]
    v_pk_fma_f32 v[208:209], v[204:205], v[196:197], v[208:209] neg_lo:[1,0,0] neg_hi:[1,0,0]
    v_pk_fma_f32 v[212:213], v[200:201], v[196:197], v[212:213]
    v_pk_fma_f32 v[210:211], v[206:207], v[198:199], v[210:211] neg_lo:[1,0,0] neg_hi:[1,0,0]
    v_pk_fma_f32 v[214:215], v[202:203], v[198:199], v[214:215]
    v_cvt_pk_bf16_f32 v104, v208, v209
    v_cvt_pk_bf16_f32 v105, v210, v211
    v_cvt_pk_bf16_f32 v106, v212, v213
    v_cvt_pk_bf16_f32 v107, v214, v215
    v_pk_mul_f32 v[224:225], v[216:217], v[192:193]
    v_pk_mul_f32 v[228:229], v[220:221], v[192:193]
    v_pk_mul_f32 v[226:227], v[218:219], v[194:195]
    v_pk_mul_f32 v[230:231], v[222:223], v[194:195]
    v_pk_fma_f32 v[224:225], v[220:221], v[196:197], v[224:225] neg_lo:[1,0,0] neg_hi:[1,0,0]
    v_pk_fma_f32 v[228:229], v[216:217], v[196:197], v[228:229]
    v_pk_fma_f32 v[226:227], v[222:223], v[198:199], v[226:227] neg_lo:[1,0,0] neg_hi:[1,0,0]
    v_pk_fma_f32 v[230:231], v[218:219], v[198:199], v[230:231]
    v_cvt_pk_bf16_f32 v108, v224, v225
    v_cvt_pk_bf16_f32 v109, v226, v227
    v_cvt_pk_bf16_f32 v110, v228, v229
    v_cvt_pk_bf16_f32 v111, v230, v231
    v_and_b32 v112, 3, v1
    v_lshrrev_b32 v113, 2, v1
    v_mul_u32_u24 v116, 1026, v112
    v_lshl_add_u32 v116, v113, 4, v116
    s_lshl_b32 s9, s10, 8
    s_add_u32 s9, s9, s54
    s_add_u32 s9, s9, 66562
    v_add_u32 v116, s9, v116
    v_and_b32 v114, 2, v116
    v_lshlrev_b32 v114, 3, v114
    v_and_b32 v116, -4, v116
    s_lshl_b32 s30, s53, 17
    s_lshl_b32 s9, s10, 13
    s_add_u32 s30, s30, s9
    s_lshl_b32 s9, s52, 15
    s_add_u32 s30, s30, s9
    s_add_u32 s30, s30, 23068672
    s_add_u32 s31, s30, 4096
    v_lshrrev_b32 v115, 2, v113
    v_lshlrev_b32 v115, 13, v115
    v_and_b32 v113, 3, v113
    v_lshl_add_u32 v115, v113, 8, v115
    v_lshl_add_u32 v115, v112, 4, v115
    s_mov_b32 s40, 0x05040100
    s_mov_b32 s41, 0x07060302
    s_waitcnt vmcnt(3)
    s_barrier
    ds_read_b32 v128, v116 offset:0
    ds_read_b32 v129, v116 offset:4
    ds_read_b32 v130, v116 offset:8
    ds_read_b32 v131, v116 offset:12
    ds_read_b32 v132, v116 offset:16
    ds_read_b32 v152, v116 offset:20480
    ds_read_b32 v153, v116 offset:20484
    ds_read_b32 v154, v116 offset:20488
    ds_read_b32 v155, v116 offset:20492
    ds_read_b32 v156, v116 offset:20496
    ds_read_b32 v134, v116 offset:5120
    ds_read_b32 v135, v116 offset:5124
    ds_read_b32 v136, v116 offset:5128
    ds_read_b32 v137, v116 offset:5132
    ds_read_b32 v138, v116 offset:5136
    s_waitcnt lgkmcnt(10)
    ds_read_b32 v158, v116 offset:25600
    ds_read_b32 v159, v116 offset:25604
    ds_read_b32 v160, v116 offset:25608
    ds_read_b32 v161, v116 offset:25612
    ds_read_b32 v162, v116 offset:25616
    v_alignbit_b32 v128, v129, v128, v114
    v_alignbit_b32 v129, v130, v129, v114
    v_alignbit_b32 v130, v131, v130, v114
    v_alignbit_b32 v131, v132, v131, v114
    s_waitcnt lgkmcnt(10)
    ds_read_b32 v140, v116 offset:10240
    ds_read_b32 v141, v116 offset:10244
    ds_read_b32 v142, v116 offset:10248
    ds_read_b32 v143, v116 offset:10252
    ds_read_b32 v144, v116 offset:10256
    v_alignbit_b32 v152, v153, v152, v114
    v_alignbit_b32 v153, v154, v153, v114
    v_alignbit_b32 v154, v155, v154, v114
    v_alignbit_b32 v155, v156, v155, v114
    s_waitcnt lgkmcnt(10)
    ds_read_b32 v164, v116 offset:30720
    ds_read_b32 v165, v116 offset:30724
    ds_read_b32 v166, v116 offset:30728
    ds_read_b32 v167, v116 offset:30732
    ds_read_b32 v168, v116 offset:30736
    v_alignbit_b32 v134, v135, v134, v114
    v_alignbit_b32 v135, v136, v135, v114
    v_alignbit_b32 v136, v137, v136, v114
    v_alignbit_b32 v137, v138, v137, v114
    s_waitcnt lgkmcnt(10)
    ds_read_b32 v146, v116 offset:15360
    ds_read_b32 v147, v116 offset:15364
    ds_read_b32 v148, v116 offset:15368
    ds_read_b32 v149, v116 offset:15372
    ds_read_b32 v150, v116 offset:15376
    v_alignbit_b32 v158, v159, v158, v114
    v_alignbit_b32 v159, v160, v159, v114
    v_alignbit_b32 v160, v161, v160, v114
    v_alignbit_b32 v161, v162, v161, v114
    s_waitcnt lgkmcnt(10)
    ds_read_b32 v170, v116 offset:35840
    ds_read_b32 v171, v116 offset:35844
    ds_read_b32 v172, v116 offset:35848
    ds_read_b32 v173, v116 offset:35852
    ds_read_b32 v174, v116 offset:35856
    v_alignbit_b32 v140, v141, v140, v114
    v_alignbit_b32 v141, v142, v141, v114
    v_alignbit_b32 v142, v143, v142, v114
    v_alignbit_b32 v143, v144, v143, v114
    s_waitcnt lgkmcnt(10)
    v_alignbit_b32 v164, v165, v164, v114
    v_alignbit_b32 v165, v166, v165, v114
    v_alignbit_b32 v166, v167, v166, v114
    v_alignbit_b32 v167, v168, v167, v114
    s_waitcnt lgkmcnt(5)
    v_alignbit_b32 v146, v147, v146, v114
    v_alignbit_b32 v147, v148, v147, v114
    v_alignbit_b32 v148, v149, v148, v114
    v_alignbit_b32 v149, v150, v149, v114
    s_waitcnt lgkmcnt(0)
    v_alignbit_b32 v170, v171, v170, v114
    v_alignbit_b32 v171, v172, v171, v114
    v_alignbit_b32 v172, v173, v172, v114
    v_alignbit_b32 v173, v174, v173, v114
    v_perm_b32 v176, v152, v128, s40
    v_perm_b32 v177, v158, v134, s40
    v_perm_b32 v178, v164, v140, s40
    v_perm_b32 v179, v170, v146, s40
    buffer_store_dwordx4 v[176:179], v4, s[16:19], s30 offen offset:0 sc1
    v_perm_b32 v180, v152, v128, s41
    v_perm_b32 v181, v158, v134, s41
    v_perm_b32 v182, v164, v140, s41
    v_perm_b32 v183, v170, v146, s41
    buffer_store_dwordx4 v[180:183], v4, s[16:19], s30 offen offset:1024 sc1
    v_perm_b32 v184, v153, v129, s40
    v_perm_b32 v185, v159, v135, s40
    v_perm_b32 v186, v165, v141, s40
    v_perm_b32 v187, v171, v147, s40
    buffer_store_dwordx4 v[184:187], v4, s[16:19], s30 offen offset:2048 sc1
    v_perm_b32 v188, v153, v129, s41
    v_perm_b32 v189, v159, v135, s41
    v_perm_b32 v190, v165, v141, s41
    v_perm_b32 v191, v171, v147, s41
    buffer_store_dwordx4 v[188:191], v4, s[16:19], s30 offen offset:3072 sc1
    v_perm_b32 v192, v154, v130, s40
    v_perm_b32 v193, v160, v136, s40
    v_perm_b32 v194, v166, v142, s40
    v_perm_b32 v195, v172, v148, s40
    buffer_store_dwordx4 v[192:195], v4, s[16:19], s31 offen offset:0 sc1
    v_perm_b32 v196, v154, v130, s41
    v_perm_b32 v197, v160, v136, s41
    v_perm_b32 v198, v166, v142, s41
    v_perm_b32 v199, v172, v148, s41
    buffer_store_dwordx4 v[196:199], v4, s[16:19], s31 offen offset:1024 sc1
    v_perm_b32 v200, v155, v131, s40
    v_perm_b32 v201, v161, v137, s40
    v_perm_b32 v202, v167, v143, s40
    v_perm_b32 v203, v173, v149, s40
    buffer_store_dwordx4 v[200:203], v4, s[16:19], s31 offen offset:2048 sc1
    v_perm_b32 v204, v155, v131, s41
    v_perm_b32 v205, v161, v137, s41
    v_perm_b32 v206, v167, v143, s41
    v_perm_b32 v207, v173, v149, s41
    buffer_store_dwordx4 v[204:207], v4, s[16:19], s31 offen offset:3072 sc1
    s_waitcnt vmcnt(10)
    buffer_load_dword v6, off, s[16:19], s55 sc1
    s_add_u32 m0, s11, 0
    s_add_u32 s21, s20, 0
    buffer_load_dwordx4 v5, s[24:27], s21 offen lds
    s_add_u32 m0, s11, 1024
    s_add_u32 s21, s20, 458752
    buffer_load_dwordx4 v5, s[24:27], s21 offen lds
    s_add_u32 m0, s11, 2048
    s_add_u32 s21, s20, 917504
    buffer_load_dwordx4 v5, s[24:27], s21 offen lds
    s_add_u32 m0, s11, 3072
    s_add_u32 s21, s20, 1376256
    buffer_load_dwordx4 v5, s[24:27], s21 offen lds
    s_add_u32 m0, s11, 4096
    s_add_u32 s21, s20, 1835008
    buffer_load_dwordx4 v5, s[24:27], s21 offen lds
    s_add_u32 m0, s11, 5120
    s_add_u32 s21, s20, 2293760
    buffer_load_dwordx4 v5, s[24:27], s21 offen lds
    s_add_u32 m0, s11, 6144
    s_add_u32 s21, s20, 2752512
    buffer_load_dwordx4 v5, s[24:27], s21 offen lds
    s_add_u32 m0, s11, 7168
    s_add_u32 s21, s20, 3211264
    buffer_load_dwordx4 v5, s[24:27], s21 offen lds
    s_add_u32 m0, s11, 8192
    s_add_u32 s21, s20, 3670016
    buffer_load_dwordx4 v5, s[24:27], s21 offen lds
    s_add_u32 m0, s11, 9216
    s_add_u32 s21, s20, 4128768
    buffer_load_dwordx4 v5, s[24:27], s21 offen lds
    s_add_u32 m0, s11, 10240
    s_add_u32 s21, s20, 4587520
    buffer_load_dwordx4 v5, s[24:27], s21 offen lds
    s_add_u32 m0, s11, 11264
    s_add_u32 s21, s20, 5046272
    buffer_load_dwordx4 v5, s[24:27], s21 offen lds
    s_add_u32 m0, s11, 12288
    s_add_u32 s21, s20, 5505024
    buffer_load_dwordx4 v5, s[24:27], s21 offen lds
    s_add_u32 m0, s11, 13312
    s_add_u32 s21, s20, 5963776
    buffer_load_dwordx4 v5, s[24:27], s21 offen lds
    s_add_u32 m0, s11, 14336
    s_add_u32 s21, s20, 6422528
    buffer_load_dwordx4 v5, s[24:27], s21 offen lds
    s_add_u32 m0, s11, 15360
    s_add_u32 s21, s20, 6881280
    buffer_load_dwordx4 v5, s[24:27], s21 offen lds
    s_call_b64 s[90:91], main_kernel_visit0
    s_waitcnt vmcnt(16)
    s_barrier
    v_readfirstlane_b32 s9, v6
    v_mov_b32 v7, 1
    s_cmp_eq_u32 s9, 0
    s_cbranch_scc1 main_kernel_msA
main_kernel_mbA:
    buffer_store_dword v7, v15, s[16:19], s68 offen sc1
    s_getpc_b64 s[32:33]
    s_add_u32 s32, s32, tab_k2@rel32@lo+4
    s_addc_u32 s33, s33, tab_k2@rel32@hi+12
    s_mov_b32 s34, 147456
    s_mov_b32 s35, 0x20000
    s_mul_i32 s31, s10, 10240
    s_add_u32 m0, s31, 122880
    s_add_u32 s30, s31, 0
    buffer_load_dwordx4 v4, s[32:35], s30 offen offset:0 lds
    buffer_load_dwordx4 v4, s[32:35], s30 offen offset:1024 lds
    buffer_load_dwordx4 v4, s[32:35], s30 offen offset:2048 lds
    buffer_load_dwordx4 v4, s[32:35], s30 offen offset:3072 lds
    s_add_u32 m0, s31, 126976
    s_add_u32 s30, s31, 4096
    buffer_load_dwordx4 v4, s[32:35], s30 offen offset:0 lds
    buffer_load_dwordx4 v4, s[32:35], s30 offen offset:1024 lds
    buffer_load_dwordx4 v4, s[32:35], s30 offen offset:2048 lds
    buffer_load_dwordx4 v4, s[32:35], s30 offen offset:3072 lds
    s_add_u32 m0, s31, 131072
    s_add_u32 s30, s31, 8192
    buffer_load_dwordx4 v4, s[32:35], s30 offen offset:0 lds
    buffer_load_dwordx4 v4, s[32:35], s30 offen offset:1024 lds
    s_cmp_lg_u32 s10, 0
    s_cbranch_scc1 main_kernel_w1_c0
    v_mov_b32 v48, v248
    v_mov_b32 v49, v249
    v_mov_b32 v50, v250
    v_mov_b32 v51, v251
    v_mov_b32 v52, v252
    v_mov_b32 v53, v253
    v_mov_b32 v54, v254
    v_mov_b32 v55, v255
main_kernel_w1_c0:
    s_waitcnt vmcnt(19)
    ds_read_b64_tr_b16 v[112:113], v8 offset:0
    ds_read_b64_tr_b16 v[114:115], v8 offset:4096
    ds_read_b64_tr_b16 v[128:129], v8 offset:256
    ds_read_b64_tr_b16 v[130:131], v8 offset:4352
    ds_read_b64_tr_b16 v[144:145], v8 offset:512
    ds_read_b64_tr_b16 v[146:147], v8 offset:4608
    ds_read_b64_tr_b16 v[160:161], v8 offset:768
    ds_read_b64_tr_b16 v[162:163], v8 offset:4864
    ds_read_b64_tr_b16 v[120:121], v8 offset:8
    ds_read_b64_tr_b16 v[122:123], v8 offset:4104
    ds_read_b64_tr_b16 v[136:137], v8 offset:264
    ds_read_b64_tr_b16 v[138:139], v8 offset:4360
    ds_read_b64_tr_b16 v[152:153], v8 offset:520
    ds_read_b64_tr_b16 v[154:155], v8 offset:4616
    ds_read_b64_tr_b16 v[168:169], v8 offset:776
    ds_read_b64_tr_b16 v[170:171], v8 offset:4872
    s_waitcnt lgkmcnt(14)
    v_mfma_f32_16x16x32_bf16 v[176:179], v[16:19], v[112:115], 0
    v_mfma_f32_16x16x32_bf16 v[192:195], v[24:27], v[112:115], 0
    v_mfma_f32_16x16x32_bf16 v[208:211], v[32:35], v[112:115], 0
    v_mfma_f32_16x16x32_bf16 v[224:227], v[40:43], v[112:115], 0
    s_waitcnt lgkmcnt(12)
    v_mfma_f32_16x16x32_bf16 v[180:183], v[16:19], v[128:131], 0
    v_mfma_f32_16x16x32_bf16 v[196:199], v[24:27], v[128:131], 0
    v_mfma_f32_16x16x32_bf16 v[212:215], v[32:35], v[128:131], 0
    v_mfma_f32_16x16x32_bf16 v[228:231], v[40:43], v[128:131], 0
    s_waitcnt lgkmcnt(10)
    v_mfma_f32_16x16x32_bf16 v[184:187], v[16:19], v[144:147], 0
    v_mfma_f32_16x16x32_bf16 v[200:203], v[24:27], v[144:147], 0
    v_mfma_f32_16x16x32_bf16 v[216:219], v[32:35], v[144:147], 0
    v_mfma_f32_16x16x32_bf16 v[232:235], v[40:43], v[144:147], 0
    s_waitcnt lgkmcnt(8)
    v_mfma_f32_16x16x32_bf16 v[188:191], v[16:19], v[160:163], 0
    v_mfma_f32_16x16x32_bf16 v[204:207], v[24:27], v[160:163], 0
    v_mfma_f32_16x16x32_bf16 v[220:223], v[32:35], v[160:163], 0
    v_mfma_f32_16x16x32_bf16 v[236:239], v[40:43], v[160:163], 0
    s_waitcnt vmcnt(11)
    ds_read_b64_tr_b16 v[116:117], v8 offset:8192
    ds_read_b64_tr_b16 v[118:119], v8 offset:12288
    ds_read_b64_tr_b16 v[132:133], v8 offset:8448
    ds_read_b64_tr_b16 v[134:135], v8 offset:12544
    ds_read_b64_tr_b16 v[148:149], v8 offset:8704
    ds_read_b64_tr_b16 v[150:151], v8 offset:12800
    ds_read_b64_tr_b16 v[164:165], v8 offset:8960
    ds_read_b64_tr_b16 v[166:167], v8 offset:13056
    ds_read_b64_tr_b16 v[124:125], v8 offset:8200
    ds_read_b64_tr_b16 v[126:127], v8 offset:12296
    ds_read_b64_tr_b16 v[140:141], v8 offset:8456
    ds_read_b64_tr_b16 v[142:143], v8 offset:12552
    ds_read_b64_tr_b16 v[156:157], v8 offset:8712
    ds_read_b64_tr_b16 v[158:159], v8 offset:12808
    ds_read_b64_tr_b16 v[172:173], v8 offset:8968
    ds_read_b64_tr_b16 v[174:175], v8 offset:13064
    s_waitcnt lgkmcnt(14)
    v_mfma_f32_16x16x32_bf16 v[176:179], v[20:23], v[116:119], v[176:179]
    v_mfma_f32_16x16x32_bf16 v[192:195], v[28:31], v[116:119], v[192:195]
    v_mfma_f32_16x16x32_bf16 v[208:211], v[36:39], v[116:119], v[208:211]
    v_mfma_f32_16x16x32_bf16 v[224:227], v[44:47], v[116:119], v[224:227]
    s_waitcnt lgkmcnt(12)
    v_mfma_f32_16x16x32_bf16 v[180:183], v[20:23], v[132:135], v[180:183]
    v_mfma_f32_16x16x32_bf16 v[196:199], v[28:31], v[132:135], v[196:199]
    v_mfma_f32_16x16x32_bf16 v[212:215], v[36:39], v[132:135], v[212:215]
    v_mfma_f32_16x16x32_bf16 v[228:231], v[44:47], v[132:135], v[228:231]
    s_waitcnt lgkmcnt(0)
    s_barrier
    v_mfma_f32_16x16x32_bf16 v[184:187], v[20:23], v[148:151], v[184:187]
    v_mfma_f32_16x16x32_bf16 v[200:203], v[28:31], v[148:151], v[200:203]
    v_mfma_f32_16x16x32_bf16 v[216:219], v[36:39], v[148:151], v[216:219]
    v_mfma_f32_16x16x32_bf16 v[232:235], v[44:47], v[148:151], v[232:235]
    v_mfma_f32_16x16x32_bf16 v[188:191], v[20:23], v[164:167], v[188:191]
    v_mfma_f32_16x16x32_bf16 v[204:207], v[28:31], v[164:167], v[204:207]
    v_mfma_f32_16x16x32_bf16 v[220:223], v[36:39], v[164:167], v[220:223]
    v_mfma_f32_16x16x32_bf16 v[236:239], v[44:47], v[164:167], v[236:239]
    v_cvt_pk_bf16_f32 v240, v176, v180
    s_nop 3
    v_cvt_pk_bf16_f32 v241, v184, v188
    v_cvt_pk_bf16_f32 v242, v177, v181
    v_cvt_pk_bf16_f32 v243, v185, v189
    ds_write_b128 v9, v[240:243] offset:0
    v_cvt_pk_bf16_f32 v244, v178, v182
    v_cvt_pk_bf16_f32 v245, v186, v190
    v_cvt_pk_bf16_f32 v246, v179, v183
    v_cvt_pk_bf16_f32 v247, v187, v191
    ds_write_b128 v9, v[244:247] offset:2064
    v_mfma_f32_16x16x32_bf16 v[176:179], v[16:19], v[120:123], 0
    v_cvt_pk_bf16_f32 v248, v192, v196
    v_cvt_pk_bf16_f32 v249, v200, v204
    v_cvt_pk_bf16_f32 v250, v193, v197
    v_mfma_f32_16x16x32_bf16 v[180:183], v[16:19], v[136:139], 0
    v_cvt_pk_bf16_f32 v251, v201, v205
    ds_write_b128 v9, v[248:251] offset:16512
    v_cvt_pk_bf16_f32 v252, v194, v198
    v_mfma_f32_16x16x32_bf16 v[184:187], v[16:19], v[152:155], 0
    v_cvt_pk_bf16_f32 v253, v202, v206
    v_cvt_pk_bf16_f32 v254, v195, v199
    v_cvt_pk_bf16_f32 v255, v203, v207
    v_mfma_f32_16x16x32_bf16 v[188:191], v[16:19], v[168:171], 0
    ds_write_b128 v9, v[252:255] offset:18576
    v_mfma_f32_16x16x32_bf16 v[176:179], v[20:23], v[124:127], v[176:179]
    v_mfma_f32_16x16x32_bf16 v[180:183], v[20:23], v[140:143], v[180:183]
    v_mfma_f32_16x16x32_bf16 v[184:187], v[20:23], v[156:159], v[184:187]
    v_mfma_f32_16x16x32_bf16 v[188:191], v[20:23], v[172:175], v[188:191]
    v_mfma_f32_16x16x32_bf16 v[192:195], v[24:27], v[120:123], 0
    v_cvt_pk_bf16_f32 v240, v208, v212
    v_cvt_pk_bf16_f32 v241, v216, v220
    v_cvt_pk_bf16_f32 v242, v209, v213
    v_mfma_f32_16x16x32_bf16 v[196:199], v[24:27], v[136:139], 0
    v_cvt_pk_bf16_f32 v243, v217, v221
    ds_write_b128 v9, v[240:243] offset:33024
    v_cvt_pk_bf16_f32 v244, v210, v214
    v_mfma_f32_16x16x32_bf16 v[200:203], v[24:27], v[152:155], 0
    v_cvt_pk_bf16_f32 v245, v218, v222
    v_cvt_pk_bf16_f32 v246, v211, v215
    v_cvt_pk_bf16_f32 v247, v219, v223
    v_mfma_f32_16x16x32_bf16 v[204:207], v[24:27], v[168:171], 0
    ds_write_b128 v9, v[244:247] offset:35088
    v_cvt_pk_bf16_f32 v240, v176, v180
    v_cvt_pk_bf16_f32 v241, v184, v188
    v_mfma_f32_16x16x32_bf16 v[192:195], v[28:31], v[124:127], v[192:195]
    v_cvt_pk_bf16_f32 v242, v177, v181
    v_cvt_pk_bf16_f32 v243, v185, v189
    ds_write_b128 v9, v[240:243] offset:1024
    v_mfma_f32_16x16x32_bf16 v[196:199], v[28:31], v[140:143], v[196:199]
    v_cvt_pk_bf16_f32 v244, v178, v182
    v_cvt_pk_bf16_f32 v245, v186, v190
    v_cvt_pk_bf16_f32 v246, v179, v183
    v_mfma_f32_16x16x32_bf16 v[200:203], v[28:31], v[156:159], v[200:203]
    v_cvt_pk_bf16_f32 v247, v187, v191
    ds_write_b128 v9, v[244:247] offset:3088
    v_mfma_f32_16x16x32_bf16 v[204:207], v[28:31], v[172:175], v[204:207]
    v_mfma_f32_16x16x32_bf16 v[208:211], v[32:35], v[120:123], 0
    v_cvt_pk_bf16_f32 v248, v224, v228
    v_cvt_pk_bf16_f32 v249, v232, v236
    v_cvt_pk_bf16_f32 v250, v225, v229
    v_mfma_f32_16x16x32_bf16 v[212:215], v[32:35], v[136:139], 0
    v_cvt_pk_bf16_f32 v251, v233, v237
    ds_write_b128 v9, v[248:251] offset:49536
    v_cvt_pk_bf16_f32 v252, v226, v230
    v_mfma_f32_16x16x32_bf16 v[216:219], v[32:35], v[152:155], 0
    v_cvt_pk_bf16_f32 v253, v234, v238
    v_cvt_pk_bf16_f32 v254, v227, v231
    v_cvt_pk_bf16_f32 v255, v235, v239
    v_mfma_f32_16x16x32_bf16 v[220:223], v[32:35], v[168:171], 0
    ds_write_b128 v9, v[252:255] offset:51600
    v_cvt_pk_bf16_f32 v248, v192, v196
    v_cvt_pk_bf16_f32 v249, v200, v204
    v_mfma_f32_16x16x32_bf16 v[208:211], v[36:39], v[124:127], v[208:211]
    v_cvt_pk_bf16_f32 v250, v193, v197
    v_cvt_pk_bf16_f32 v251, v201, v205
    ds_write_b128 v9, v[248:251] offset:17536
    v_mfma_f32_16x16x32_bf16 v[212:215], v[36:39], v[140:143], v[212:215]
    v_cvt_pk_bf16_f32 v252, v194, v198
    v_cvt_pk_bf16_f32 v253, v202, v206
    v_cvt_pk_bf16_f32 v254, v195, v199
    v_mfma_f32_16x16x32_bf16 v[216:219], v[36:39], v[156:159], v[216:219]
    v_cvt_pk_bf16_f32 v255, v203, v207
    ds_write_b128 v9, v[252:255] offset:19600
    v_mfma_f32_16x16x32_bf16 v[220:223], v[36:39], v[172:175], v[220:223]
    v_mfma_f32_16x16x32_bf16 v[224:227], v[40:43], v[120:123], 0
    v_cvt_pk_bf16_f32 v240, v208, v212
    s_nop 5
    v_cvt_pk_bf16_f32 v241, v216, v220
    v_cvt_pk_bf16_f32 v242, v209, v213
    v_mfma_f32_16x16x32_bf16 v[228:231], v[40:43], v[136:139], 0
    v_cvt_pk_bf16_f32 v243, v217, v221
    ds_write_b128 v9, v[240:243] offset:34048
    v_cvt_pk_bf16_f32 v244, v210, v214
    v_mfma_f32_16x16x32_bf16 v[232:235], v[40:43], v[152:155], 0
    v_cvt_pk_bf16_f32 v245, v218, v222
    v_cvt_pk_bf16_f32 v246, v211, v215
    v_cvt_pk_bf16_f32 v247, v219, v223
    v_mfma_f32_16x16x32_bf16 v[236:239], v[40:43], v[168:171], 0
    ds_write_b128 v9, v[244:247] offset:36112
    v_mfma_f32_16x16x32_bf16 v[224:227], v[44:47], v[124:127], v[224:227]
    v_mfma_f32_16x16x32_bf16 v[228:231], v[44:47], v[140:143], v[228:231]
    v_mfma_f32_16x16x32_bf16 v[232:235], v[44:47], v[156:159], v[232:235]
    v_mfma_f32_16x16x32_bf16 v[236:239], v[44:47], v[172:175], v[236:239]
    s_nop 5
    v_cvt_pk_bf16_f32 v248, v224, v228
    s_nop 0
    v_cvt_pk_bf16_f32 v249, v232, v236
    v_cvt_pk_bf16_f32 v250, v225, v229
    v_cvt_pk_bf16_f32 v251, v233, v237
    ds_write_b128 v9, v[248:251] offset:50560
    v_cvt_pk_bf16_f32 v252, v226, v230
    v_cvt_pk_bf16_f32 v253, v234, v238
    v_cvt_pk_bf16_f32 v254, v227, v231
    v_cvt_pk_bf16_f32 v255, v235, v239
    ds_write_b128 v9, v[252:255] offset:52624
    s_mul_i32 s8, s3, 9363
    s_lshr_b32 s8, s8, 16
    s_mul_i32 s9, s8, 7
    s_sub_u32 s9, s3, s9
    s_mov_b32 s32, 6
    s_mov_b32 s33, 0
    s_cmp_ge_u32 s9, 3
    s_cselect_b32 s32, 4, s32
    s_cselect_b32 s33, 186, s33
    s_cmp_ge_u32 s9, 5
    s_cselect_b32 s32, 4, s32
    s_cselect_b32 s33, 310, s33
    s_mul_i32 s30, s10, s32
    s_lshl_b32 s30, s30, 3
    s_add_u32 s30, s30, s33
    s_lshl_b32 s9, s9, 1
    s_add_u32 s30, s30, s9
    s_mul_i32 s8, s8, 896
    s_add_u32 s30, s30, s8
    s_lshl_b32 s30, s30, 10
    s_add_u32 s30, s30, 8388608
    s_lshl_b32 s32, s32, 10
    s_waitcnt vmcnt(0)
    s_waitcnt lgkmcnt(0)
    s_barrier
    s_mov_b32 s9, 27459584
    v_lshlrev_b32 v253, 6, v0
    buffer_load_dword v252, v253, s[16:19], s9 offen sc1
    ds_read_b128 v[112:115], v10 offset:0
    ds_read_b128 v[116:119], v10 offset:1024
    ds_read_b128 v[120:123], v10 offset:2064
    ds_read_b128 v[124:127], v10 offset:3088
    ds_read_b128 v[128:131], v10 offset:4128
    ds_read_b128 v[132:135], v10 offset:5152
    ds_read_b128 v[136:139], v10 offset:6192
    ds_read_b128 v[140:143], v10 offset:7216
    ds_read_b128 v[144:147], v10 offset:8256
    ds_read_b128 v[148:151], v10 offset:9280
    ds_read_b128 v[152:155], v10 offset:10320
    ds_read_b128 v[156:159], v10 offset:11344
    ds_read_b128 v[160:163], v10 offset:12384
    ds_read_b128 v[164:167], v10 offset:13408
    ds_read_b128 v[168:171], v10 offset:14448
    ds_read_b128 v[172:175], v10 offset:15472
    s_waitcnt lgkmcnt(14)
    v_mfma_f32_16x16x32_bf16 v[176:179], v[48:51], v[112:115], 0
    v_mfma_f32_16x16x32_bf16 v[180:183], v[52:55], v[112:115], 0
    v_mfma_f32_16x16x32_bf16 v[184:187], v[48:51], v[116:119], 0
    v_mfma_f32_16x16x32_bf16 v[188:191], v[52:55], v[116:119], 0
    v_add_u32 v14, 122880, v4
    ds_read_b128 a[96:99], v14 offset:0
    ds_read_b128 a[100:103], v14 offset:1024
    ds_read_b128 a[104:107], v14 offset:2048
    ds_read_b128 a[108:111], v14 offset:3072
    s_waitcnt lgkmcnt(15)
    v_mfma_f32_16x16x32_bf16 v[192:195], v[56:59], v[120:123], 0
    v_mfma_f32_16x16x32_bf16 v[196:199], v[60:63], v[120:123], 0
    v_mfma_f32_16x16x32_bf16 v[200:203], v[56:59], v[124:127], 0
    v_mfma_f32_16x16x32_bf16 v[204:207], v[60:63], v[124:127], 0
    ds_read_b128 a[112:115], v14 offset:4096
    ds_read_b128 a[116:119], v14 offset:5120
    ds_read_b128 a[120:123], v14 offset:6144
    ds_read_b128 a[124:127], v14 offset:7168
    ds_read_b128 a[128:131], v14 offset:8192
    s_waitcnt lgkmcnt(15)
    v_mfma_f32_16x16x32_bf16 v[208:211], v[64:67], v[128:131], 0
    v_cvt_pk_bf16_f32 v16, v176, v177
    v_cvt_pk_bf16_f32 v17, v178, v179
    v_cvt_pk_bf16_f32 v18, v180, v181
    v_mfma_f32_16x16x32_bf16 v[212:215], v[68:71], v[128:131], 0
    v_cvt_pk_bf16_f32 v19, v182, v183
    v_and_b32 v16, v16, v11
    buffer_store_dwordx4 v[16:19], v4, s[16:19], s30 offen offset:0 sc1
    v_mfma_f32_16x16x32_bf16 v[216:219], v[64:67], v[132:135], 0
    v_cvt_pk_bf16_f32 v20, v184, v185
    v_cvt_pk_bf16_f32 v21, v186, v187
    v_cvt_pk_bf16_f32 v22, v188, v189
    v_mfma_f32_16x16x32_bf16 v[220:223], v[68:71], v[132:135], 0
    v_cvt_pk_bf16_f32 v23, v190, v191
    v_and_b32 v20, v20, v11
    buffer_store_dwordx4 v[20:23], v4, s[16:19], s30 offen offset:1024 sc1
    s_add_u32 s30, s30, s32
    ds_read_b128 a[132:135], v14 offset:9216
    ds_read_b128 a[136:139], v14 offset:10240
    ds_read_b128 a[140:143], v14 offset:11264
    ds_read_b128 a[144:147], v14 offset:12288
    ds_read_b128 a[148:151], v14 offset:13312
    v_mfma_f32_16x16x32_bf16 v[224:227], v[72:75], v[136:139], 0
    v_cvt_pk_bf16_f32 v24, v192, v193
    v_cvt_pk_bf16_f32 v25, v194, v195
    v_cvt_pk_bf16_f32 v26, v196, v197
    v_mfma_f32_16x16x32_bf16 v[228:231], v[76:79], v[136:139], 0
    v_cvt_pk_bf16_f32 v27, v198, v199
    buffer_store_dwordx4 v[24:27], v4, s[16:19], s30 offen offset:0 sc1
    v_cvt_pk_bf16_f32 v28, v200, v201
    v_mfma_f32_16x16x32_bf16 v[232:235], v[72:75], v[140:143], 0
    v_cvt_pk_bf16_f32 v29, v202, v203
    v_cvt_pk_bf16_f32 v30, v204, v205
    v_cvt_pk_bf16_f32 v31, v206, v207
    v_mfma_f32_16x16x32_bf16 v[236:239], v[76:79], v[140:143], 0
    buffer_store_dwordx4 v[28:31], v4, s[16:19], s30 offen offset:1024 sc1
    s_add_u32 s30, s30, s32
    ds_read_b128 a[152:155], v14 offset:14336
    ds_read_b128 a[156:159], v14 offset:15360
    ds_read_b128 a[160:163], v14 offset:16384
    ds_read_b128 a[164:167], v14 offset:17408
    ds_read_b128 a[168:171], v14 offset:18432
    v_mfma_f32_16x16x32_bf16 v[176:179], v[80:83], v[144:147], 0
    v_cvt_pk_bf16_f32 v32, v208, v209
    v_cvt_pk_bf16_f32 v33, v210, v211
    v_cvt_pk_bf16_f32 v34, v212, v213
    v_mfma_f32_16x16x32_bf16 v[180:183], v[84:87], v[144:147], 0
    v_cvt_pk_bf16_f32 v35, v214, v215
    buffer_store_dwordx4 v[32:35], v4, s[16:19], s30 offen offset:0 sc1
    v_cvt_pk_bf16_f32 v36, v216, v217
    v_mfma_f32_16x16x32_bf16 v[184:187], v[80:83], v[148:151], 0
    v_cvt_pk_bf16_f32 v37, v218, v219
    v_cvt_pk_bf16_f32 v38, v220, v221
    v_cvt_pk_bf16_f32 v39, v222, v223
    v_mfma_f32_16x16x32_bf16 v[188:191], v[84:87], v[148:151], 0
    buffer_store_dwordx4 v[36:39], v4, s[16:19], s30 offen offset:1024 sc1
    s_add_u32 s30, s30, s32
    ds_read_b128 a[172:175], v14 offset:19456
    ds_read_b128 a[176:179], v14 offset:20480
    ds_read_b128 a[180:183], v14 offset:21504
    ds_read_b128 a[184:187], v14 offset:22528
    ds_read_b128 a[188:191], v14 offset:23552
    s_waitcnt lgkmcnt(15)
    v_mfma_f32_16x16x32_bf16 v[192:195], v[88:91], v[152:155], 0
    v_cvt_pk_bf16_f32 v40, v224, v225
    v_cvt_pk_bf16_f32 v41, v226, v227
    v_cvt_pk_bf16_f32 v42, v228, v229
    v_mfma_f32_16x16x32_bf16 v[196:199], v[92:95], v[152:155], 0
    v_cvt_pk_bf16_f32 v43, v230, v231
    buffer_store_dwordx4 v[40:43], v4, s[16:19], s30 offen offset:0 sc1
    v_cvt_pk_bf16_f32 v44, v232, v233
    v_mfma_f32_16x16x32_bf16 v[200:203], v[88:91], v[156:159], 0
    v_cvt_pk_bf16_f32 v45, v234, v235
    v_cvt_pk_bf16_f32 v46, v236, v237
    v_cvt_pk_bf16_f32 v47, v238, v239
    v_mfma_f32_16x16x32_bf16 v[204:207], v[92:95], v[156:159], 0
    buffer_store_dwordx4 v[44:47], v4, s[16:19], s30 offen offset:1024 sc1
    s_add_u32 s30, s30, s32
    ds_read_b128 a[192:195], v14 offset:24576
    ds_read_b128 a[196:199], v14 offset:25600
    ds_read_b128 a[200:203], v14 offset:26624
    ds_read_b128 a[204:207], v14 offset:27648
    ds_read_b128 a[208:211], v14 offset:28672
    v_mfma_f32_16x16x32_bf16 v[208:211], v[96:99], v[160:163], 0
    v_cvt_pk_bf16_f32 v16, v176, v177
    v_cvt_pk_bf16_f32 v17, v178, v179
    v_cvt_pk_bf16_f32 v18, v180, v181
    v_mfma_f32_16x16x32_bf16 v[212:215], v[100:103], v[160:163], 0
    v_cvt_pk_bf16_f32 v19, v182, v183
    buffer_store_dwordx4 v[16:19], v4, s[16:19], s30 offen offset:0 sc1
    v_cvt_pk_bf16_f32 v20, v184, v185
    v_mfma_f32_16x16x32_bf16 v[216:219], v[96:99], v[164:167], 0
    v_cvt_pk_bf16_f32 v21, v186, v187
    v_cvt_pk_bf16_f32 v22, v188, v189
    v_cvt_pk_bf16_f32 v23, v190, v191
    v_mfma_f32_16x16x32_bf16 v[220:223], v[100:103], v[164:167], 0
    buffer_store_dwordx4 v[20:23], v4, s[16:19], s30 offen offset:1024 sc1
    s_add_u32 s30, s30, s32
    ds_read_b128 a[212:215], v14 offset:29696
    ds_read_b128 a[216:219], v14 offset:30720
    ds_read_b128 a[220:223], v14 offset:31744
    ds_read_b128 a[224:227], v14 offset:32768
    ds_read_b128 a[228:231], v14 offset:33792
    v_mfma_f32_16x16x32_bf16 v[224:227], v[104:107], v[168:171], 0
    v_cvt_pk_bf16_f32 v24, v192, v193
    v_cvt_pk_bf16_f32 v25, v194, v195
    v_cvt_pk_bf16_f32 v26, v196, v197
    v_mfma_f32_16x16x32_bf16 v[228:231], v[108:111], v[168:171], 0
    v_cvt_pk_bf16_f32 v27, v198, v199
    buffer_store_dwordx4 v[24:27], v4, s[16:19], s30 offen offset:0 sc1
    v_cvt_pk_bf16_f32 v28, v200, v201
    v_mfma_f32_16x16x32_bf16 v[232:235], v[104:107], v[172:175], 0
    v_cvt_pk_bf16_f32 v29, v202, v203
    v_cvt_pk_bf16_f32 v30, v204, v205
    v_cvt_pk_bf16_f32 v31, v206, v207
    v_mfma_f32_16x16x32_bf16 v[236:239], v[108:111], v[172:175], 0
    buffer_store_dwordx4 v[28:31], v4, s[16:19], s30 offen offset:1024 sc1
    s_add_u32 s30, s30, s32
    ds_read_b128 a[232:235], v14 offset:34816
    ds_read_b128 a[236:239], v14 offset:35840
    ds_read_b128 a[240:243], v14 offset:36864
    ds_read_b128 a[244:247], v14 offset:37888
    ds_read_b128 a[248:251], v14 offset:38912
    ds_read_b128 a[252:255], v14 offset:39936
    v_cvt_pk_bf16_f32 v32, v208, v209
    v_cvt_pk_bf16_f32 v33, v210, v211
    v_cvt_pk_bf16_f32 v34, v212, v213
    v_cvt_pk_bf16_f32 v35, v214, v215
    buffer_store_dwordx4 v[32:35], v4, s[16:19], s30 offen offset:0 sc1
    v_cvt_pk_bf16_f32 v36, v216, v217
    v_cvt_pk_bf16_f32 v37, v218, v219
    v_cvt_pk_bf16_f32 v38, v220, v221
    v_cvt_pk_bf16_f32 v39, v222, v223
    buffer_store_dwordx4 v[36:39], v4, s[16:19], s30 offen offset:1024 sc1
    s_add_u32 s30, s30, s32
    v_cvt_pk_bf16_f32 v40, v224, v225
    v_cvt_pk_bf16_f32 v41, v226, v227
    v_cvt_pk_bf16_f32 v42, v228, v229
    v_cvt_pk_bf16_f32 v43, v230, v231
    buffer_store_dwordx4 v[40:43], v4, s[16:19], s30 offen offset:0 sc1
    v_cvt_pk_bf16_f32 v44, v232, v233
    v_cvt_pk_bf16_f32 v45, v234, v235
    v_cvt_pk_bf16_f32 v46, v236, v237
    v_cvt_pk_bf16_f32 v47, v238, v239
    buffer_store_dwordx4 v[44:47], v4, s[16:19], s30 offen offset:1024 sc1
    s_add_u32 s30, s30, s32
    s_mov_b32 s67, 0x80000000
    s_mov_b32 s66, 0
    s_call_b64 s[90:91], main_kernel_visit1
    s_waitcnt vmcnt(16)
    s_branch main_kernel_schk
main_kernel_rB:
    s_cmp_ge_u32 s2, 224
    s_cbranch_scc1 main_kernel_rC
    s_sub_u32 s3, s2, 112
    s_getpc_b64 s[12:13]
    s_add_u32 s12, s12, tab_t@rel32@lo+4
    s_addc_u32 s13, s13, tab_t@rel32@hi+12
    s_mov_b32 s14, 18432
    s_mov_b32 s15, 0x20000
    v_lshrrev_b32 v7, 6, v0
    v_and_b32 v1, 63, v0
    v_and_b32 v2, 15, v0
    v_bfe_u32 v3, v0, 4, 2
    v_readfirstlane_b32 s10, v7
    v_lshlrev_b32 v4, 4, v1
    s_mov_b32 s22, 0
    s_mov_b32 s23, 4096
    s_mov_b32 s28, 16384
    buffer_load_dwordx4 v[16:19], v4, s[12:15], s22 offen offset:0
    buffer_load_dwordx4 v[20:23], v4, s[12:15], s22 offen offset:1024
    buffer_load_dwordx4 v[24:27], v4, s[12:15], s22 offen offset:2048
    buffer_load_dwordx4 v[28:31], v4, s[12:15], s22 offen offset:3072
    buffer_load_dwordx4 v[32:35], v4, s[12:15], s23 offen offset:0
    buffer_load_dwordx4 v[36:39], v4, s[12:15], s23 offen offset:1024
    buffer_load_dwordx4 v[40:43], v4, s[12:15], s23 offen offset:2048
    buffer_load_dwordx4 v[44:47], v4, s[12:15], s23 offen offset:3072
    buffer_load_dwordx4 v[248:251], v4, s[12:15], s28 offen offset:0
    buffer_load_dwordx4 v[252:255], v4, s[12:15], s28 offen offset:1024
    s_mul_i32 s11, s10, 8192
    s_lshr_b32 s20, s3, 3
    s_lshl_b32 s20, s20, 18
    s_and_b32 s9, s3, 7
    s_lshl_b32 s9, s9, 14
    s_add_u32 s20, s20, s9
    s_lshr_b32 s9, s10, 1
    s_lshl_b32 s9, s9, 17
    s_add_u32 s20, s20, s9
    s_and_b32 s9, s10, 1
    s_lshl_b32 s9, s9, 13
    s_add_u32 s20, s20, s9
    s_add_u32 s11, s11, 67072
    s_mov_b32 s26, 4194304
    s_mov_b32 s27, 0x20000
    s_waitcnt lgkmcnt(0)
    s_mov_b32 s24, s60
    s_mov_b32 s25, s61
    s_mov_b32 s16, s4
    s_mov_b32 s17, s5
    s_mov_b32 s18, 268435456
    s_mov_b32 s19, 0x20000
    s_add_u32 m0, s11, 0
    s_add_u32 s21, s20, 0
    buffer_load_dwordx4 v4, s[24:27], s21 offen offset:0 lds
    buffer_load_dwordx4 v4, s[24:27], s21 offen offset:1024 lds
    buffer_load_dwordx4 v4, s[24:27], s21 offen offset:2048 lds
    buffer_load_dwordx4 v4, s[24:27], s21 offen offset:3072 lds
    s_add_u32 m0, s11, 4096
    s_add_u32 s21, s20, 4096
    buffer_load_dwordx4 v4, s[24:27], s21 offen offset:0 lds
    buffer_load_dwordx4 v4, s[24:27], s21 offen offset:1024 lds
    buffer_load_dwordx4 v4, s[24:27], s21 offen offset:2048 lds
    buffer_load_dwordx4 v4, s[24:27], s21 offen offset:3072 lds
    v_mov_b32 v6, 0
    buffer_store_dword v6, v15, s[16:19], s55 offen sc1
    v_lshl_add_u32 v8, v1, 3, s11
    s_mov_b32 s9, 1040
    v_mul_lo_u32 v9, v2, s9
    v_lshl_add_u32 v9, v3, 8, v9
    s_lshl_b32 s9, s10, 6
    s_add_u32 s9, s9, 67072
    v_add_u32 v9, s9, v9
    s_mul_i32 s9, s10, 8320
    s_add_u32 s9, s9, 67072
    v_add_u32 v10, s9, v4
    v_mov_b32 v11, -1
    v_mov_b32 v12, 0xffff0000
    v_cmp_gt_u32 vcc, 16, v0
    s_nop 1
    v_cndmask_b32 v11, v11, v12, vcc
    v_mov_b32 v12, 1.0
    v_cndmask_b32 v12, v12, 0, vcc
    v_lshlrev_b32 v188, 2, v3
    v_cvt_f32_u32 v188, v188
    v_mul_f32 v176, 0x3a800000, v188
    v_add_f32 v177, 0x3a800000, v176
    v_add_f32 v178, 0x3a800000, v177
    v_add_f32 v179, 0x3a800000, v178
    v_and_b32 v188, 12, v2
    v_bfe_u32 v189, v2, 1, 1
    v_add_u32 v188, v188, v189
    v_lshlrev_b32 v188, 6, v188
    v_lshl_add_u32 v188, s10, 3, v188
    v_cvt_f32_u32 v188, v188
    v_add_f32 v189, 0x43000000, v188
    v_lshrrev_b32 v190, 3, v2
    v_lshl_add_u32 v190, v190, 1, 1
    v_and_b32 v191, 1, v2
    v_mul_u32_u24 v190, v190, v191
    v_cvt_f32_u32 v190, v190
    v_mul_f32 v190, 0x3e800000, v190
    v_fma_f32 v180, v176, v188, v190
    v_fma_f32 v181, v177, v188, v190
    v_fma_f32 v182, v178, v188, v190
    v_fma_f32 v183, v179, v188, v190
    v_fma_f32 v184, v176, v189, v190
    v_fma_f32 v185, v177, v189, v190
    v_fma_f32 v186, v178, v189, v190
    v_fma_f32 v187, v179, v189, v190
    v_cos_f32 v192, v176
    v_sin_f32 v196, v176
    v_cos_f32 v193, v177
    v_sin_f32 v197, v177
    v_cos_f32 v194, v178
    v_sin_f32 v198, v178
    v_cos_f32 v195, v179
    v_sin_f32 v199, v179
    v_cos_f32 v200, v180
    v_sin_f32 v204, v180
    v_cos_f32 v201, v181
    v_sin_f32 v205, v181
    v_cos_f32 v202, v182
    v_sin_f32 v206, v182
    v_cos_f32 v203, v183
    v_sin_f32 v207, v183
    v_cvt_pk_bf16_f32 v48, v200, v201
    v_cvt_pk_bf16_f32 v49, v202, v203
    v_cvt_pk_bf16_f32 v50, v204, v205
    v_cvt_pk_bf16_f32 v51, v206, v207
    v_cos_f32 v216, v184
    v_sin_f32 v220, v184
    v_cos_f32 v217, v185
    v_sin_f32 v221, v185
    v_cos_f32 v218, v186
    v_sin_f32 v222, v186
    v_cos_f32 v219, v187
    v_sin_f32 v223, v187
    v_cvt_pk_bf16_f32 v52, v216, v217
    v_cvt_pk_bf16_f32 v53, v218, v219
    v_cvt_pk_bf16_f32 v54, v220, v221
    v_cvt_pk_bf16_f32 v55, v222, v223
    v_pk_mul_f32 v[208:209], v[200:201], v[192:193]
    v_pk_mul_f32 v[212:213], v[204:205], v[192:193]
    v_pk_mul_f32 v[210:211], v[202:203], v[194:195]
    v_pk_mul_f32 v[214:215], v[206:207], v[194:195]
    v_pk_fma_f32 v[208:209], v[204:205], v[196:197], v[208:209] neg_lo:[1,0,0] neg_hi:[1,0,0]
    v_pk_fma_f32 v[212:213], v[200:201], v[196:197], v[212:213]
    v_pk_fma_f32 v[210:211], v[206:207], v[198:199], v[210:211] neg_lo:[1,0,0] neg_hi:[1,0,0]
    v_pk_fma_f32 v[214:215], v[202:203], v[198:199], v[214:215]
    v_cvt_pk_bf16_f32 v56, v208, v209
    v_cvt_pk_bf16_f32 v57, v210, v211
    v_cvt_pk_bf16_f32 v58, v212, v213
    v_cvt_pk_bf16_f32 v59, v214, v215
    v_pk_mul_f32 v[224:225], v[216:217], v[192:193]
    v_pk_mul_f32 v[228:229], v[220:221], v[192:193]
    v_pk_mul_f32 v[226:227], v[218:219], v[194:195]
    v_pk_mul_f32 v[230:231], v[222:223], v[194:195]
    v_pk_fma_f32 v[224:225], v[220:221], v[196:197], v[224:225] neg_lo:[1,0,0] neg_hi:[1,0,0]
    v_pk_fma_f32 v[228:229], v[216:217], v[196:197], v[228:229]
    v_pk_fma_f32 v[226:227], v[222:223], v[198:199], v[226:227] neg_lo:[1,0,0] neg_hi:[1,0,0]
    v_pk_fma_f32 v[230:231], v[218:219], v[198:199], v[230:231]
    v_cvt_pk_bf16_f32 v60, v224, v225
    v_cvt_pk_bf16_f32 v61, v226, v227
    v_cvt_pk_bf16_f32 v62, v228, v229
    v_cvt_pk_bf16_f32 v63, v230, v231
    v_pk_mul_f32 v[200:201], v[208:209], v[192:193]
    v_pk_mul_f32 v[204:205], v[212:213], v[192:193]
    v_pk_mul_f32 v[202:203], v[210:211], v[194:195]
    v_pk_mul_f32 v[206:207], v[214:215], v[194:195]
    v_pk_fma_f32 v[200:201], v[212:213], v[196:197], v[200:201] neg_lo:[1,0,0] neg_hi:[1,0,0]
    v_pk_fma_f32 v[204:205], v[208:209], v[196:197], v[204:205]
    v_pk_fma_f32 v[202:203], v[214:215], v[198:199], v[202:203] neg_lo:[1,0,0] neg_hi:[1,0,0]
    v_pk_fma_f32 v[206:207], v[210:211], v[198:199], v[206:207]
    v_cvt_pk_bf16_f32 v64, v200, v201
    v_cvt_pk_bf16_f32 v65, v202, v203
    v_cvt_pk_bf16_f32 v66, v204, v205
    v_cvt_pk_bf16_f32 v67, v206, v207
    v_pk_mul_f32 v[216:217], v[224:225], v[192:193]
    v_pk_mul_f32 v[220:221], v[228:229], v[192:193]
    v_pk_mul_f32 v[218:219], v[226:227], v[194:195]
    v_pk_mul_f32 v[222:223], v[230:231], v[194:195]
    v_pk_fma_f32 v[216:217], v[228:229], v[196:197], v[216:217] neg_lo:[1,0,0] neg_hi:[1,0,0]
    v_pk_fma_f32 v[220:221], v[224:225], v[196:197], v[220:221]
    v_pk_fma_f32 v[218:219], v[230:231], v[198:199], v[218:219] neg_lo:[1,0,0] neg_hi:[1,0,0]
    v_pk_fma_f32 v[222:223], v[226:227], v[198:199], v[222:223]
    v_cvt_pk_bf16_f32 v68, v216, v217
    v_cvt_pk_bf16_f32 v69, v218, v219
    v_cvt_pk_bf16_f32 v70, v220, v221
    v_cvt_pk_bf16_f32 v71, v222, v223
    v_pk_mul_f32 v[208:209], v[200:201], v[192:193]
    v_pk_mul_f32 v[212:213], v[204:205], v[192:193]
    v_pk_mul_f32 v[210:211], v[202:203], v[194:195]
    v_pk_mul_f32 v[214:215], v[206:207], v[194:195]
    v_pk_fma_f32 v[208:209], v[204:205], v[196:197], v[208:209] neg_lo:[1,0,0] neg_hi:[1,0,0]
    v_pk_fma_f32 v[212:213], v[200:201], v[196:197], v[212:213]
    v_pk_fma_f32 v[210:211], v[206:207], v[198:199], v[210:211] neg_lo:[1,0,0] neg_hi:[1,0,0]
    v_pk_fma_f32 v[214:215], v[202:203], v[198:199], v[214:215]
    v_cvt_pk_bf16_f32 v72, v208, v209
    v_cvt_pk_bf16_f32 v73, v210, v211
    v_cvt_pk_bf16_f32 v74, v212, v213
    v_cvt_pk_bf16_f32 v75, v214, v215
    v_pk_mul_f32 v[224:225], v[216:217], v[192:193]
    v_pk_mul_f32 v[228:229], v[220:221], v[192:193]
    v_pk_mul_f32 v[226:227], v[218:219], v[194:195]
    v_pk_mul_f32 v[230:231], v[222:223], v[194:195]
    v_pk_fma_f32 v[224:225], v[220:221], v[196:197], v[224:225] neg_lo:[1,0,0] neg_hi:[1,0,0]
    v_pk_fma_f32 v[228:229], v[216:217], v[196:197], v[228:229]
    v_pk_fma_f32 v[226:227], v[222:223], v[198:199], v[226:227] neg_lo:[1,0,0] neg_hi:[1,0,0]
    v_pk_fma_f32 v[230:231], v[218:219], v[198:199], v[230:231]
    v_cvt_pk_bf16_f32 v76, v224, v225
    v_cvt_pk_bf16_f32 v77, v226, v227
    v_cvt_pk_bf16_f32 v78, v228, v229
    v_cvt_pk_bf16_f32 v79, v230, v231
    v_pk_mul_f32 v[200:201], v[208:209], v[192:193]
    v_pk_mul_f32 v[204:205], v[212:213], v[192:193]
    v_pk_mul_f32 v[202:203], v[210:211], v[194:195]
    v_pk_mul_f32 v[206:207], v[214:215], v[194:195]
    v_pk_fma_f32 v[200:201], v[212:213], v[196:197], v[200:201] neg_lo:[1,0,0] neg_hi:[1,0,0]
    v_pk_fma_f32 v[204:205], v[208:209], v[196:197], v[204:205]
    v_pk_fma_f32 v[202:203], v[214:215], v[198:199], v[202:203] neg_lo:[1,0,0] neg_hi:[1,0,0]
    v_pk_fma_f32 v[206:207], v[210:211], v[198:199], v[206:207]
    v_cvt_pk_bf16_f32 v80, v200, v201
    v_cvt_pk_bf16_f32 v81, v202, v203
    v_cvt_pk_bf16_f32 v82, v204, v205
    v_cvt_pk_bf16_f32 v83, v206, v207
    v_pk_mul_f32 v[216:217], v[224:225], v[192:193]
    v_pk_mul_f32 v[220:221], v[228:229], v[192:193]
    v_pk_mul_f32 v[218:219], v[226:227], v[194:195]
    v_pk_mul_f32 v[222:223], v[230:231], v[194:195]
    v_pk_fma_f32 v[216:217], v[228:229], v[196:197], v[216:217] neg_lo:[1,0,0] neg_hi:[1,0,0]
    v_pk_fma_f32 v[220:221], v[224:225], v[196:197], v[220:221]
    v_pk_fma_f32 v[218:219], v[230:231], v[198:199], v[218:219] neg_lo:[1,0,0] neg_hi:[1,0,0]
    v_pk_fma_f32 v[222:223], v[226:227], v[198:199], v[222:223]
    v_cvt_pk_bf16_f32 v84, v216, v217
    v_cvt_pk_bf16_f32 v85, v218, v219
    v_cvt_pk_bf16_f32 v86, v220, v221
    v_cvt_pk_bf16_f32 v87, v222, v223
    v_pk_mul_f32 v[208:209], v[200:201], v[192:193]
    v_pk_mul_f32 v[212:213], v[204:205], v[192:193]
    v_pk_mul_f32 v[210:211], v[202:203], v[194:195]
    v_pk_mul_f32 v[214:215], v[206:207], v[194:195]
    v_pk_fma_f32 v[208:209], v[204:205], v[196:197], v[208:209] neg_lo:[1,0,0] neg_hi:[1,0,0]
    v_pk_fma_f32 v[212:213], v[200:201], v[196:197], v[212:213]
    v_pk_fma_f32 v[210:211], v[206:207], v[198:199], v[210:211] neg_lo:[1,0,0] neg_hi:[1,0,0]
    v_pk_fma_f32 v[214:215], v[202:203], v[198:199], v[214:215]
    v_cvt_pk_bf16_f32 v88, v208, v209
    v_cvt_pk_bf16_f32 v89, v210, v211
    v_cvt_pk_bf16_f32 v90, v212, v213
    v_cvt_pk_bf16_f32 v91, v214, v215
    v_pk_mul_f32 v[224:225], v[216:217], v[192:193]
    v_pk_mul_f32 v[228:229], v[220:221], v[192:193]
    v_pk_mul_f32 v[226:227], v[218:219], v[194:195]
    v_pk_mul_f32 v[230:231], v[222:223], v[194:195]
    v_pk_fma_f32 v[224:225], v[220:221], v[196:197], v[224:225] neg_lo:[1,0,0] neg_hi:[1,0,0]
    v_pk_fma_f32 v[228:229], v[216:217], v[196:197], v[228:229]
    v_pk_fma_f32 v[226:227], v[222:223], v[198:199], v[226:227] neg_lo:[1,0,0] neg_hi:[1,0,0]
    v_pk_fma_f32 v[230:231], v[218:219], v[198:199], v[230:231]
    v_cvt_pk_bf16_f32 v92, v224, v225
    v_cvt_pk_bf16_f32 v93, v226, v227
    v_cvt_pk_bf16_f32 v94, v228, v229
    v_cvt_pk_bf16_f32 v95, v230, v231
    v_pk_mul_f32 v[200:201], v[208:209], v[192:193]
    v_pk_mul_f32 v[204:205], v[212:213], v[192:193]
    v_pk_mul_f32 v[202:203], v[210:211], v[194:195]
    v_pk_mul_f32 v[206:207], v[214:215], v[194:195]
    v_pk_fma_f32 v[200:201], v[212:213], v[196:197], v[200:201] neg_lo:[1,0,0] neg_hi:[1,0,0]
    v_pk_fma_f32 v[204:205], v[208:209], v[196:197], v[204:205]
    v_pk_fma_f32 v[202:203], v[214:215], v[198:199], v[202:203] neg_lo:[1,0,0] neg_hi:[1,0,0]
    v_pk_fma_f32 v[206:207], v[210:211], v[198:199], v[206:207]
    v_cvt_pk_bf16_f32 v96, v200, v201
    v_cvt_pk_bf16_f32 v97, v202, v203
    v_cvt_pk_bf16_f32 v98, v204, v205
    v_cvt_pk_bf16_f32 v99, v206, v207
    v_pk_mul_f32 v[216:217], v[224:225], v[192:193]
    v_pk_mul_f32 v[220:221], v[228:229], v[192:193]
    v_pk_mul_f32 v[218:219], v[226:227], v[194:195]
    v_pk_mul_f32 v[222:223], v[230:231], v[194:195]
    v_pk_fma_f32 v[216:217], v[228:229], v[196:197], v[216:217] neg_lo:[1,0,0] neg_hi:[1,0,0]
    v_pk_fma_f32 v[220:221], v[224:225], v[196:197], v[220:221]
    v_pk_fma_f32 v[218:219], v[230:231], v[198:199], v[218:219] neg_lo:[1,0,0] neg_hi:[1,0,0]
    v_pk_fma_f32 v[222:223], v[226:227], v[198:199], v[222:223]
    v_cvt_pk_bf16_f32 v100, v216, v217
    v_cvt_pk_bf16_f32 v101, v218, v219
    v_cvt_pk_bf16_f32 v102, v220, v221
    v_cvt_pk_bf16_f32 v103, v222, v223
    v_pk_mul_f32 v[208:209], v[200:201], v[192:193]
    v_pk_mul_f32 v[212:213], v[204:205], v[192:193]
    v_pk_mul_f32 v[210:211], v[202:203], v[194:195]
    v_pk_mul_f32 v[214:215], v[206:207], v[194:195]
    v_pk_fma_f32 v[208:209], v[204:205], v[196:197], v[208:209] neg_lo:[1,0,0] neg_hi:[1,0,0]
    v_pk_fma_f32 v[212:213], v[200:201], v[196:197], v[212:213]
    v_pk_fma_f32 v[210:211], v[206:207], v[198:199], v[210:211] neg_lo:[1,0,0] neg_hi:[1,0,0]
    v_pk_fma_f32 v[214:215], v[202:203], v[198:199], v[214:215]
    v_cvt_pk_bf16_f32 v104, v208, v209
    v_cvt_pk_bf16_f32 v105, v210, v211
    v_cvt_pk_bf16_f32 v106, v212, v213
    v_cvt_pk_bf16_f32 v107, v214, v215
    v_pk_mul_f32 v[224:225], v[216:217], v[192:193]
    v_pk_mul_f32 v[228:229], v[220:221], v[192:193]
    v_pk_mul_f32 v[226:227], v[218:219], v[194:195]
    v_pk_mul_f32 v[230:231], v[222:223], v[194:195]
    v_pk_fma_f32 v[224:225], v[220:221], v[196:197], v[224:225] neg_lo:[1,0,0] neg_hi:[1,0,0]
    v_pk_fma_f32 v[228:229], v[216:217], v[196:197], v[228:229]
    v_pk_fma_f32 v[226:227], v[222:223], v[198:199], v[226:227] neg_lo:[1,0,0] neg_hi:[1,0,0]
    v_pk_fma_f32 v[230:231], v[218:219], v[198:199], v[230:231]
    v_cvt_pk_bf16_f32 v108, v224, v225
    v_cvt_pk_bf16_f32 v109, v226, v227
    v_cvt_pk_bf16_f32 v110, v228, v229
    v_cvt_pk_bf16_f32 v111, v230, v231
    s_waitcnt vmcnt(9)
    s_cmp_lg_u32 s10, 0
    s_cbranch_scc1 main_kernel_xb_c0
    v_mov_b32 v48, v248
    v_mov_b32 v49, v249
    v_mov_b32 v50, v250
    v_mov_b32 v51, v251
    v_mov_b32 v52, v252
    v_mov_b32 v53, v253
    v_mov_b32 v54, v254
    v_mov_b32 v55, v255
main_kernel_xb_c0:
    s_waitcnt vmcnt(5)
    ds_read_b64_tr_b16 v[112:113], v8 offset:0
    ds_read_b64_tr_b16 v[114:115], v8 offset:512
    ds_read_b64_tr_b16 v[116:117], v8 offset:1024
    ds_read_b64_tr_b16 v[118:119], v8 offset:1536
    ds_read_b64_tr_b16 v[120:121], v8 offset:2048
    ds_read_b64_tr_b16 v[122:123], v8 offset:2560
    ds_read_b64_tr_b16 v[124:125], v8 offset:3072
    ds_read_b64_tr_b16 v[126:127], v8 offset:3584
    s_waitcnt lgkmcnt(4)
    v_mfma_f32_16x16x32_bf16 v[176:179], v[112:115], v[16:19], 0
    v_mfma_f32_16x16x32_bf16 v[180:183], v[112:115], v[24:27], 0
    v_mfma_f32_16x16x32_bf16 v[184:187], v[112:115], v[32:35], 0
    v_mfma_f32_16x16x32_bf16 v[188:191], v[112:115], v[40:43], 0
    v_mfma_f32_16x16x32_bf16 v[176:179], v[116:119], v[20:23], v[176:179]
    v_mfma_f32_16x16x32_bf16 v[180:183], v[116:119], v[28:31], v[180:183]
    v_mfma_f32_16x16x32_bf16 v[184:187], v[116:119], v[36:39], v[184:187]
    v_mfma_f32_16x16x32_bf16 v[188:191], v[116:119], v[44:47], v[188:191]
    s_waitcnt lgkmcnt(0)
    v_mfma_f32_16x16x32_bf16 v[192:195], v[120:123], v[16:19], 0
    v_mfma_f32_16x16x32_bf16 v[196:199], v[120:123], v[24:27], 0
    v_mfma_f32_16x16x32_bf16 v[200:203], v[120:123], v[32:35], 0
    s_nop 0
    v_cvt_pk_bf16_f32 v112, v176, v177
    v_cvt_pk_bf16_f32 v113, v178, v179
    v_mfma_f32_16x16x32_bf16 v[204:207], v[120:123], v[40:43], 0
    v_cvt_pk_bf16_f32 v114, v180, v181
    v_cvt_pk_bf16_f32 v115, v182, v183
    v_mfma_f32_16x16x32_bf16 v[192:195], v[124:127], v[20:23], v[192:195]
    v_cvt_pk_bf16_f32 v116, v184, v185
    v_cvt_pk_bf16_f32 v117, v186, v187
    v_mfma_f32_16x16x32_bf16 v[196:199], v[124:127], v[28:31], v[196:199]
    v_cvt_pk_bf16_f32 v118, v188, v189
    v_cvt_pk_bf16_f32 v119, v190, v191
    v_mfma_f32_16x16x32_bf16 v[200:203], v[124:127], v[36:39], v[200:203]
    v_mfma_f32_16x16x32_bf16 v[204:207], v[124:127], v[44:47], v[204:207]
    s_nop 0
    v_cvt_pk_bf16_f32 v120, v192, v193
    v_cvt_pk_bf16_f32 v121, v194, v195
    s_nop 0
    v_cvt_pk_bf16_f32 v122, v196, v197
    v_cvt_pk_bf16_f32 v123, v198, v199
    s_nop 0
    v_cvt_pk_bf16_f32 v124, v200, v201
    v_cvt_pk_bf16_f32 v125, v202, v203
    v_cvt_pk_bf16_f32 v126, v204, v205
    v_cvt_pk_bf16_f32 v127, v206, v207
    s_waitcnt vmcnt(1)
    ds_read_b64_tr_b16 v[128:129], v8 offset:4096
    ds_read_b64_tr_b16 v[130:131], v8 offset:4608
    ds_read_b64_tr_b16 v[132:133], v8 offset:5120
    ds_read_b64_tr_b16 v[134:135], v8 offset:5632
    ds_read_b64_tr_b16 v[136:137], v8 offset:6144
    ds_read_b64_tr_b16 v[138:139], v8 offset:6656
    ds_read_b64_tr_b16 v[140:141], v8 offset:7168
    ds_read_b64_tr_b16 v[142:143], v8 offset:7680
    s_waitcnt lgkmcnt(0)
    s_barrier
    v_mfma_f32_16x16x32_bf16 v[208:211], v[128:131], v[16:19], 0
    ds_write_b128 v9, v[112:115] offset:0
    v_mfma_f32_16x16x32_bf16 v[212:215], v[128:131], v[24:27], 0
    ds_write_b128 v9, v[116:119] offset:16640
    v_mfma_f32_16x16x32_bf16 v[216:219], v[128:131], v[32:35], 0
    ds_write_b128 v9, v[120:123] offset:16
    v_mfma_f32_16x16x32_bf16 v[220:223], v[128:131], v[40:43], 0
    ds_write_b128 v9, v[124:127] offset:16656
    v_mfma_f32_16x16x32_bf16 v[208:211], v[132:135], v[20:23], v[208:211]
    v_mfma_f32_16x16x32_bf16 v[212:215], v[132:135], v[28:31], v[212:215]
    v_mfma_f32_16x16x32_bf16 v[216:219], v[132:135], v[36:39], v[216:219]
    v_mfma_f32_16x16x32_bf16 v[220:223], v[132:135], v[44:47], v[220:223]
    v_mfma_f32_16x16x32_bf16 v[224:227], v[136:139], v[16:19], 0
    v_mfma_f32_16x16x32_bf16 v[228:231], v[136:139], v[24:27], 0
    v_mfma_f32_16x16x32_bf16 v[232:235], v[136:139], v[32:35], 0
    s_nop 1
    v_cvt_pk_bf16_f32 v160, v208, v209
    v_cvt_pk_bf16_f32 v161, v210, v211
    v_mfma_f32_16x16x32_bf16 v[236:239], v[136:139], v[40:43], 0
    v_cvt_pk_bf16_f32 v162, v212, v213
    v_cvt_pk_bf16_f32 v163, v214, v215
    v_mfma_f32_16x16x32_bf16 v[224:227], v[140:143], v[20:23], v[224:227]
    ds_write_b128 v9, v[160:163] offset:32
    v_cvt_pk_bf16_f32 v164, v216, v217
    v_mfma_f32_16x16x32_bf16 v[228:231], v[140:143], v[28:31], v[228:231]
    v_cvt_pk_bf16_f32 v165, v218, v219
    v_cvt_pk_bf16_f32 v166, v220, v221
    v_mfma_f32_16x16x32_bf16 v[232:235], v[140:143], v[36:39], v[232:235]
    v_cvt_pk_bf16_f32 v167, v222, v223
    ds_write_b128 v9, v[164:167] offset:16672
    v_mfma_f32_16x16x32_bf16 v[236:239], v[140:143], v[44:47], v[236:239]
    v_cvt_pk_bf16_f32 v168, v224, v225
    v_cvt_pk_bf16_f32 v169, v226, v227
    v_cvt_pk_bf16_f32 v170, v228, v229
    v_cvt_pk_bf16_f32 v171, v230, v231
    ds_write_b128 v9, v[168:171] offset:48
    v_cvt_pk_bf16_f32 v172, v232, v233
    v_cvt_pk_bf16_f32 v173, v234, v235
    s_nop 0
    v_cvt_pk_bf16_f32 v174, v236, v237
    v_cvt_pk_bf16_f32 v175, v238, v239
    ds_write_b128 v9, v[172:175] offset:16688
    s_lshl_b32 s30, s10, 20
    s_lshr_b32 s9, s3, 1
    s_lshl_b32 s9, s9, 11
    s_add_u32 s30, s30, s9
    s_and_b32 s9, s3, 1
    s_lshl_b32 s9, s9, 7
    s_add_u32 s30, s30, s9
    s_add_u32 s30, s30, 0
    v_and_b32 v5, 0x370, v4
    v_and_b32 v8, 8, v2
    v_lshl_add_u32 v5, v8, 7, v5
    v_mov_b32 v13, 0
    v_mov_b32 v14, 0
    s_waitcnt lgkmcnt(0)
    s_barrier
    ds_read_b128 v[112:115], v10 offset:0
    ds_read_b128 v[116:119], v10 offset:1040
    ds_read_b128 v[120:123], v10 offset:2080
    ds_read_b128 v[124:127], v10 offset:3120
    ds_read_b128 v[128:131], v10 offset:4160
    ds_read_b128 v[132:135], v10 offset:5200
    ds_read_b128 v[136:139], v10 offset:6240
    ds_read_b128 v[140:143], v10 offset:7280
    s_waitcnt lgkmcnt(7)
    v_mfma_f32_16x16x32_bf16 v[176:179], v[48:51], v[112:115], 0
    v_mfma_f32_16x16x32_bf16 v[180:183], v[52:55], v[112:115], 0
    s_waitcnt lgkmcnt(6)
    v_mfma_f32_16x16x32_bf16 v[192:195], v[56:59], v[116:119], 0
    v_mfma_f32_16x16x32_bf16 v[196:199], v[60:63], v[116:119], 0
    s_waitcnt lgkmcnt(5)
    v_mfma_f32_16x16x32_bf16 v[208:211], v[64:67], v[120:123], 0
    s_nop 1
    v_cvt_pk_bf16_f32 v144, v176, v177
    v_cvt_pk_bf16_f32 v145, v178, v179
    v_cvt_pk_bf16_f32 v146, v180, v181
    v_mfma_f32_16x16x32_bf16 v[212:215], v[68:71], v[120:123], 0
    v_cvt_pk_bf16_f32 v147, v182, v183
    v_mul_f32 v176, v176, v12
    v_fmac_f32 v13, v176, v176
    v_mov_b32_dpp v148, v146 row_ror:8 row_mask:0xf bank_mask:0xf
    v_mov_b32_dpp v149, v147 row_ror:8 row_mask:0xf bank_mask:0xf
    v_mov_b32_dpp v146, v144 row_ror:8 row_mask:0xf bank_mask:0x3
    v_mov_b32_dpp v147, v145 row_ror:8 row_mask:0xf bank_mask:0x3
    v_fmac_f32 v14, v177, v177
    v_mov_b32_dpp v144, v148 quad_perm:[0,1,2,3] row_mask:0xf bank_mask:0xc
    v_mov_b32_dpp v145, v149 quad_perm:[0,1,2,3] row_mask:0xf bank_mask:0xc
    v_and_b32 v144, -2, v144
    buffer_store_dwordx4 v[144:147], v5, s[16:19], s30 offen sc1
    v_fmac_f32 v13, v178, v178
    v_fmac_f32 v14, v179, v179
    v_fmac_f32 v13, v180, v180
    v_fmac_f32 v14, v181, v181
    v_fmac_f32 v13, v182, v182
    v_fmac_f32 v14, v183, v183
    s_add_u32 s30, s30, 131072
    s_waitcnt lgkmcnt(4)
    v_mfma_f32_16x16x32_bf16 v[224:227], v[72:75], v[124:127], 0
    v_cvt_pk_bf16_f32 v152, v192, v193
    v_cvt_pk_bf16_f32 v153, v194, v195
    v_cvt_pk_bf16_f32 v154, v196, v197
    v_mfma_f32_16x16x32_bf16 v[228:231], v[76:79], v[124:127], 0
    v_cvt_pk_bf16_f32 v155, v198, v199
    v_fmac_f32 v13, v192, v192
    v_fmac_f32 v14, v193, v193
    v_mov_b32_dpp v156, v154 row_ror:8 row_mask:0xf bank_mask:0xf
    v_mov_b32_dpp v157, v155 row_ror:8 row_mask:0xf bank_mask:0xf
    v_mov_b32_dpp v154, v152 row_ror:8 row_mask:0xf bank_mask:0x3
    v_mov_b32_dpp v155, v153 row_ror:8 row_mask:0xf bank_mask:0x3
    v_fmac_f32 v13, v194, v194
    v_mov_b32_dpp v152, v156 quad_perm:[0,1,2,3] row_mask:0xf bank_mask:0xc
    v_mov_b32_dpp v153, v157 quad_perm:[0,1,2,3] row_mask:0xf bank_mask:0xc
    v_and_b32 v152, -2, v152
    buffer_store_dwordx4 v[152:155], v5, s[16:19], s30 offen sc1
    v_fmac_f32 v14, v195, v195
    v_fmac_f32 v13, v196, v196
    v_fmac_f32 v14, v197, v197
    v_fmac_f32 v13, v198, v198
    v_fmac_f32 v14, v199, v199
    s_add_u32 s30, s30, 131072
    s_waitcnt lgkmcnt(3)
    v_mfma_f32_16x16x32_bf16 v[176:179], v[80:83], v[128:131], 0
    v_cvt_pk_bf16_f32 v160, v208, v209
    v_cvt_pk_bf16_f32 v161, v210, v211
    v_cvt_pk_bf16_f32 v162, v212, v213
    v_mfma_f32_16x16x32_bf16 v[180:183], v[84:87], v[128:131], 0
    v_cvt_pk_bf16_f32 v163, v214, v215
    v_fmac_f32 v13, v208, v208
    v_fmac_f32 v14, v209, v209
    v_mov_b32_dpp v164, v162 row_ror:8 row_mask:0xf bank_mask:0xf
    v_mov_b32_dpp v165, v163 row_ror:8 row_mask:0xf bank_mask:0xf
    v_mov_b32_dpp v162, v160 row_ror:8 row_mask:0xf bank_mask:0x3
    v_mov_b32_dpp v163, v161 row_ror:8 row_mask:0xf bank_mask:0x3
    v_fmac_f32 v13, v210, v210
    v_mov_b32_dpp v160, v164 quad_perm:[0,1,2,3] row_mask:0xf bank_mask:0xc
    v_mov_b32_dpp v161, v165 quad_perm:[0,1,2,3] row_mask:0xf bank_mask:0xc
    v_and_b32 v160, -2, v160
    buffer_store_dwordx4 v[160:163], v5, s[16:19], s30 offen sc1
    v_fmac_f32 v14, v211, v211
    v_fmac_f32 v13, v212, v212
    v_fmac_f32 v14, v213, v213
    v_fmac_f32 v13, v214, v214
    v_fmac_f32 v14, v215, v215
    s_add_u32 s30, s30, 131072
    s_waitcnt lgkmcnt(2)
    v_mfma_f32_16x16x32_bf16 v[192:195], v[88:91], v[132:135], 0
    v_cvt_pk_bf16_f32 v168, v224, v225
    v_cvt_pk_bf16_f32 v169, v226, v227
    v_cvt_pk_bf16_f32 v170, v228, v229
    v_mfma_f32_16x16x32_bf16 v[196:199], v[92:95], v[132:135], 0
    v_cvt_pk_bf16_f32 v171, v230, v231
    v_fmac_f32 v13, v224, v224
    v_fmac_f32 v14, v225, v225
    v_mov_b32_dpp v172, v170 row_ror:8 row_mask:0xf bank_mask:0xf
    v_mov_b32_dpp v173, v171 row_ror:8 row_mask:0xf bank_mask:0xf
    v_mov_b32_dpp v170, v168 row_ror:8 row_mask:0xf bank_mask:0x3
    v_mov_b32_dpp v171, v169 row_ror:8 row_mask:0xf bank_mask:0x3
    v_fmac_f32 v13, v226, v226
    v_mov_b32_dpp v168, v172 quad_perm:[0,1,2,3] row_mask:0xf bank_mask:0xc
    v_mov_b32_dpp v169, v173 quad_perm:[0,1,2,3] row_mask:0xf bank_mask:0xc
    v_and_b32 v168, -2, v168
    buffer_store_dwordx4 v[168:171], v5, s[16:19], s30 offen sc1
    v_fmac_f32 v14, v227, v227
    v_fmac_f32 v13, v228, v228
    v_fmac_f32 v14, v229, v229
    v_fmac_f32 v13, v230, v230
    v_fmac_f32 v14, v231, v231
    s_add_u32 s30, s30, 131072
    s_waitcnt lgkmcnt(1)
    v_mfma_f32_16x16x32_bf16 v[208:211], v[96:99], v[136:139], 0
    v_cvt_pk_bf16_f32 v144, v176, v177
    v_cvt_pk_bf16_f32 v145, v178, v179
    v_cvt_pk_bf16_f32 v146, v180, v181
    v_mfma_f32_16x16x32_bf16 v[212:215], v[100:103], v[136:139], 0
    v_cvt_pk_bf16_f32 v147, v182, v183
    v_fmac_f32 v13, v176, v176
    v_fmac_f32 v14, v177, v177
    v_mov_b32_dpp v148, v146 row_ror:8 row_mask:0xf bank_mask:0xf
    v_mov_b32_dpp v149, v147 row_ror:8 row_mask:0xf bank_mask:0xf
    v_mov_b32_dpp v146, v144 row_ror:8 row_mask:0xf bank_mask:0x3
    v_mov_b32_dpp v147, v145 row_ror:8 row_mask:0xf bank_mask:0x3
    v_fmac_f32 v13, v178, v178
    v_mov_b32_dpp v144, v148 quad_perm:[0,1,2,3] row_mask:0xf bank_mask:0xc
    v_mov_b32_dpp v145, v149 quad_perm:[0,1,2,3] row_mask:0xf bank_mask:0xc
    v_and_b32 v144, -2, v144
    buffer_store_dwordx4 v[144:147], v5, s[16:19], s30 offen sc1
    v_fmac_f32 v14, v179, v179
    v_fmac_f32 v13, v180, v180
    v_fmac_f32 v14, v181, v181
    v_fmac_f32 v13, v182, v182
    v_fmac_f32 v14, v183, v183
    s_add_u32 s30, s30, 131072
    s_waitcnt lgkmcnt(0)
    v_mfma_f32_16x16x32_bf16 v[224:227], v[104:107], v[140:143], 0
    v_cvt_pk_bf16_f32 v152, v192, v193
    v_cvt_pk_bf16_f32 v153, v194, v195
    v_cvt_pk_bf16_f32 v154, v196, v197
    v_mfma_f32_16x16x32_bf16 v[228:231], v[108:111], v[140:143], 0
    v_cvt_pk_bf16_f32 v155, v198, v199
    v_fmac_f32 v13, v192, v192
    v_fmac_f32 v14, v193, v193
    v_mov_b32_dpp v156, v154 row_ror:8 row_mask:0xf bank_mask:0xf
    v_mov_b32_dpp v157, v155 row_ror:8 row_mask:0xf bank_mask:0xf
    v_mov_b32_dpp v154, v152 row_ror:8 row_mask:0xf bank_mask:0x3
    v_mov_b32_dpp v155, v153 row_ror:8 row_mask:0xf bank_mask:0x3
    v_fmac_f32 v13, v194, v194
    v_mov_b32_dpp v152, v156 quad_perm:[0,1,2,3] row_mask:0xf bank_mask:0xc
    v_mov_b32_dpp v153, v157 quad_perm:[0,1,2,3] row_mask:0xf bank_mask:0xc
    v_and_b32 v152, -2, v152
    buffer_store_dwordx4 v[152:155], v5, s[16:19], s30 offen sc1
    v_fmac_f32 v14, v195, v195
    v_fmac_f32 v13, v196, v196
    v_fmac_f32 v14, v197, v197
    v_fmac_f32 v13, v198, v198
    v_fmac_f32 v14, v199, v199
    s_add_u32 s30, s30, 131072
    v_cvt_pk_bf16_f32 v160, v208, v209
    v_cvt_pk_bf16_f32 v161, v210, v211
    v_cvt_pk_bf16_f32 v162, v212, v213
    v_cvt_pk_bf16_f32 v163, v214, v215
    v_fmac_f32 v13, v208, v208
    v_fmac_f32 v14, v209, v209
    v_mov_b32_dpp v164, v162 row_ror:8 row_mask:0xf bank_mask:0xf
    v_mov_b32_dpp v165, v163 row_ror:8 row_mask:0xf bank_mask:0xf
    v_mov_b32_dpp v162, v160 row_ror:8 row_mask:0xf bank_mask:0x3
    v_mov_b32_dpp v163, v161 row_ror:8 row_mask:0xf bank_mask:0x3
    v_fmac_f32 v13, v210, v210
    v_mov_b32_dpp v160, v164 quad_perm:[0,1,2,3] row_mask:0xf bank_mask:0xc
    v_mov_b32_dpp v161, v165 quad_perm:[0,1,2,3] row_mask:0xf bank_mask:0xc
    v_and_b32 v160, -2, v160
    buffer_store_dwordx4 v[160:163], v5, s[16:19], s30 offen sc1
    v_fmac_f32 v14, v211, v211
    v_fmac_f32 v13, v212, v212
    v_fmac_f32 v14, v213, v213
    v_fmac_f32 v13, v214, v214
    v_fmac_f32 v14, v215, v215
    s_add_u32 s30, s30, 131072
    v_cvt_pk_bf16_f32 v168, v224, v225
    v_cvt_pk_bf16_f32 v169, v226, v227
    v_cvt_pk_bf16_f32 v170, v228, v229
    v_cvt_pk_bf16_f32 v171, v230, v231
    v_fmac_f32 v13, v224, v224
    v_fmac_f32 v14, v225, v225
    v_mov_b32_dpp v172, v170 row_ror:8 row_mask:0xf bank_mask:0xf
    v_mov_b32_dpp v173, v171 row_ror:8 row_mask:0xf bank_mask:0xf
    v_mov_b32_dpp v170, v168 row_ror:8 row_mask:0xf bank_mask:0x3
    v_mov_b32_dpp v171, v169 row_ror:8 row_mask:0xf bank_mask:0x3
    v_fmac_f32 v13, v226, v226
    v_mov_b32_dpp v168, v172 quad_perm:[0,1,2,3] row_mask:0xf bank_mask:0xc
    v_mov_b32_dpp v169, v173 quad_perm:[0,1,2,3] row_mask:0xf bank_mask:0xc
    v_and_b32 v168, -2, v168
    buffer_store_dwordx4 v[168:171], v5, s[16:19], s30 offen sc1
    v_fmac_f32 v14, v227, v227
    v_fmac_f32 v13, v228, v228
    v_fmac_f32 v14, v229, v229
    v_fmac_f32 v13, v230, v230
    v_fmac_f32 v14, v231, v231
    s_add_u32 s30, s30, 131072
    v_add_f32 v13, v13, v14
    v_mov_b32 v14, v13
    s_nop 1
    v_permlane32_swap_b32 v13, v14
    v_add_f32 v13, v13, v14
    v_mov_b32 v14, v13
    s_nop 1
    v_permlane16_swap_b32 v13, v14
    v_add_f32 v13, v13, v14
    v_lshlrev_b32 v14, 2, v2
    s_lshl_b32 s9, s10, 7
    s_add_u32 s9, s9, 66560
    v_add_u32 v10, s9, v14
    ds_write_b32 v10, v13
    s_waitcnt lgkmcnt(0)
    s_barrier
    s_cmp_lg_u32 s10, 0
    s_cbranch_scc1 main_kernel_xb_done
    ds_read_b32 v121, v10 offset:128
    ds_read_b32 v122, v10 offset:256
    ds_read_b32 v123, v10 offset:384
    s_lshl_b32 s9, s3, 7
    s_add_u32 s9, s9, 27262976
    v_and_b32 v14, 7, v2
    v_lshlrev_b32 v14, 4, v14
    v_add_u32 v14, v14, v8
    s_mov_b64 exec, 0xffff
    s_mov_b32 s20, 0xa7c6
    s_mov_b32 s21, 0x42900000
    s_waitcnt lgkmcnt(0)
    v_add_f32 v13, v13, v121
    v_add_f32 v122, v122, v123
    v_add_f32 v13, v13, v122
    v_mul_f32 v13, 0x45800000, v13
    v_cvt_f64_f32 v[124:125], v13
    v_add_f64 v[124:125], v[124:125], s[20:21]
    buffer_store_dwordx2 v[124:125], v14, s[16:19], s9 offen sc1
    s_mov_b64 exec, -1
main_kernel_xb_done:
    s_waitcnt vmcnt(8)
    buffer_load_dword v6, off, s[16:19], s55 sc1
    s_getpc_b64 s[12:13]
    s_add_u32 s12, s12, tab_t@rel32@lo+4
    s_addc_u32 s13, s13, tab_t@rel32@hi+12
    s_mov_b32 s14, 18432
    s_mov_b32 s15, 0x20000
    v_lshrrev_b32 v7, 6, v0
    v_and_b32 v1, 63, v0
    v_and_b32 v2, 15, v0
    v_bfe_u32 v3, v0, 4, 2
    v_readfirstlane_b32 s10, v7
    v_lshlrev_b32 v4, 4, v1
    s_mov_b32 s22, 0
    s_mov_b32 s23, 4096
    s_mov_b32 s28, 16384
    s_mul_i32 s11, s10, 16384
    s_mul_i32 s20, s3, 65536
    s_add_u32 s20, s20, s11
    s_add_u32 s11, s11, 0
    s_mov_b32 s26, 7340032
    s_mov_b32 s27, 0x20000
    s_mov_b32 s24, s58
    s_mov_b32 s25, s59
    s_mov_b32 s16, s4
    s_mov_b32 s17, s5
    s_mov_b32 s18, 268435456
    s_mov_b32 s19, 0x20000
    s_add_u32 m0, s11, 0
    s_add_u32 s21, s20, 0
    buffer_load_dwordx4 v4, s[24:27], s21 offen offset:0 lds
    buffer_load_dwordx4 v4, s[24:27], s21 offen offset:1024 lds
    buffer_load_dwordx4 v4, s[24:27], s21 offen offset:2048 lds
    buffer_load_dwordx4 v4, s[24:27], s21 offen offset:3072 lds
    s_add_u32 m0, s11, 4096
    s_add_u32 s21, s20, 4096
    buffer_load_dwordx4 v4, s[24:27], s21 offen offset:0 lds
    buffer_load_dwordx4 v4, s[24:27], s21 offen offset:1024 lds
    buffer_load_dwordx4 v4, s[24:27], s21 offen offset:2048 lds
    buffer_load_dwordx4 v4, s[24:27], s21 offen offset:3072 lds
    s_add_u32 m0, s11, 8192
    s_add_u32 s21, s20, 8192
    buffer_load_dwordx4 v4, s[24:27], s21 offen offset:0 lds
    buffer_load_dwordx4 v4, s[24:27], s21 offen offset:1024 lds
    buffer_load_dwordx4 v4, s[24:27], s21 offen offset:2048 lds
    buffer_load_dwordx4 v4, s[24:27], s21 offen offset:3072 lds
    s_add_u32 m0, s11, 12288
    s_add_u32 s21, s20, 12288
    buffer_load_dwordx4 v4, s[24:27], s21 offen offset:0 lds
    buffer_load_dwordx4 v4, s[24:27], s21 offen offset:1024 lds
    buffer_load_dwordx4 v4, s[24:27], s21 offen offset:2048 lds
    buffer_load_dwordx4 v4, s[24:27], s21 offen offset:3072 lds
    v_lshl_add_u32 v8, v1, 3, s11
    s_mov_b32 s9, 2064
    v_mul_lo_u32 v9, v2, s9
    v_lshl_add_u32 v9, v3, 8, v9
    s_lshl_b32 s9, s10, 6
    s_add_u32 s9, s9, 0
    v_add_u32 v9, s9, v9
    s_mul_i32 s9, s10, 16512
    s_add_u32 s9, s9, 0
    v_add_u32 v10, s9, v4
    v_mov_b32 v11, -1
    v_mov_b32 v12, 0xffff0000
    v_cmp_gt_u32 vcc, 16, v0
    s_nop 1
    v_cndmask_b32 v11, v11, v12, vcc
    v_mov_b32 v12, 1.0
    v_cndmask_b32 v12, v12, 0, vcc
    s_call_b64 s[90:91], main_kernel_visit0
    s_waitcnt vmcnt(16)
    s_barrier
    v_readfirstlane_b32 s9, v6
    v_mov_b32 v7, 1
    s_cmp_eq_u32 s9, 0
    s_cbranch_scc1 main_kernel_msB
main_kernel_mbB:
    buffer_store_dword v7, v15, s[16:19], s68 offen sc1
    s_getpc_b64 s[32:33]
    s_add_u32 s32, s32, tab_k2@rel32@lo+4
    s_addc_u32 s33, s33, tab_k2@rel32@hi+12
    s_mov_b32 s34, 147456
    s_mov_b32 s35, 0x20000
    s_mul_i32 s31, s10, 10240
    s_add_u32 m0, s31, 122880
    s_add_u32 s30, s31, 0
    buffer_load_dwordx4 v4, s[32:35], s30 offen offset:0 lds
    buffer_load_dwordx4 v4, s[32:35], s30 offen offset:1024 lds
    buffer_load_dwordx4 v4, s[32:35], s30 offen offset:2048 lds
    buffer_load_dwordx4 v4, s[32:35], s30 offen offset:3072 lds
    s_add_u32 m0, s31, 126976
    s_add_u32 s30, s31, 4096
    buffer_load_dwordx4 v4, s[32:35], s30 offen offset:0 lds
    buffer_load_dwordx4 v4, s[32:35], s30 offen offset:1024 lds
    buffer_load_dwordx4 v4, s[32:35], s30 offen offset:2048 lds
    buffer_load_dwordx4 v4, s[32:35], s30 offen offset:3072 lds
    s_add_u32 m0, s31, 131072
    s_add_u32 s30, s31, 8192
    buffer_load_dwordx4 v4, s[32:35], s30 offen offset:0 lds
    buffer_load_dwordx4 v4, s[32:35], s30 offen offset:1024 lds
    s_waitcnt vmcnt(23)
    ds_read_b64_tr_b16 v[112:113], v8 offset:0
    ds_read_b64_tr_b16 v[114:115], v8 offset:512
    ds_read_b64_tr_b16 v[116:117], v8 offset:1024
    ds_read_b64_tr_b16 v[118:119], v8 offset:1536
    ds_read_b64_tr_b16 v[120:121], v8 offset:2048
    ds_read_b64_tr_b16 v[122:123], v8 offset:2560
    ds_read_b64_tr_b16 v[124:125], v8 offset:3072
    ds_read_b64_tr_b16 v[126:127], v8 offset:3584
    s_waitcnt lgkmcnt(4)
    v_mfma_f32_16x16x32_bf16 v[176:179], v[112:115], v[16:19], 0
    v_mfma_f32_16x16x32_bf16 v[180:183], v[112:115], v[24:27], 0
    v_mfma_f32_16x16x32_bf16 v[184:187], v[112:115], v[32:35], 0
    v_mfma_f32_16x16x32_bf16 v[188:191], v[112:115], v[40:43], 0
    v_mfma_f32_16x16x32_bf16 v[176:179], v[116:119], v[20:23], v[176:179]
    v_mfma_f32_16x16x32_bf16 v[180:183], v[116:119], v[28:31], v[180:183]
    v_mfma_f32_16x16x32_bf16 v[184:187], v[116:119], v[36:39], v[184:187]
    v_mfma_f32_16x16x32_bf16 v[188:191], v[116:119], v[44:47], v[188:191]
    s_waitcnt lgkmcnt(0)
    v_mfma_f32_16x16x32_bf16 v[192:195], v[120:123], v[16:19], 0
    v_mfma_f32_16x16x32_bf16 v[196:199], v[120:123], v[24:27], 0
    v_mfma_f32_16x16x32_bf16 v[200:203], v[120:123], v[32:35], 0
    s_nop 0
    v_cvt_pk_bf16_f32 v112, v176, v177
    v_cvt_pk_bf16_f32 v113, v178, v179
    v_mfma_f32_16x16x32_bf16 v[204:207], v[120:123], v[40:43], 0
    v_cvt_pk_bf16_f32 v114, v180, v181
    v_cvt_pk_bf16_f32 v115, v182, v183
    v_mfma_f32_16x16x32_bf16 v[192:195], v[124:127], v[20:23], v[192:195]
    v_cvt_pk_bf16_f32 v116, v184, v185
    v_cvt_pk_bf16_f32 v117, v186, v187
    v_mfma_f32_16x16x32_bf16 v[196:199], v[124:127], v[28:31], v[196:199]
    v_cvt_pk_bf16_f32 v118, v188, v189
    v_cvt_pk_bf16_f32 v119, v190, v191
    v_mfma_f32_16x16x32_bf16 v[200:203], v[124:127], v[36:39], v[200:203]
    v_mfma_f32_16x16x32_bf16 v[204:207], v[124:127], v[44:47], v[204:207]
    s_nop 0
    v_cvt_pk_bf16_f32 v120, v192, v193
    v_cvt_pk_bf16_f32 v121, v194, v195
    s_nop 0
    v_cvt_pk_bf16_f32 v122, v196, v197
    v_cvt_pk_bf16_f32 v123, v198, v199
    s_nop 0
    v_cvt_pk_bf16_f32 v124, v200, v201
    v_cvt_pk_bf16_f32 v125, v202, v203
    v_cvt_pk_bf16_f32 v126, v204, v205
    v_cvt_pk_bf16_f32 v127, v206, v207
    s_waitcnt vmcnt(19)
    ds_read_b64_tr_b16 v[128:129], v8 offset:4096
    ds_read_b64_tr_b16 v[130:131], v8 offset:4608
    ds_read_b64_tr_b16 v[132:133], v8 offset:5120
    ds_read_b64_tr_b16 v[134:135], v8 offset:5632
    ds_read_b64_tr_b16 v[136:137], v8 offset:6144
    ds_read_b64_tr_b16 v[138:139], v8 offset:6656
    ds_read_b64_tr_b16 v[140:141], v8 offset:7168
    ds_read_b64_tr_b16 v[142:143], v8 offset:7680
    s_waitcnt lgkmcnt(4)
    v_mfma_f32_16x16x32_bf16 v[208:211], v[128:131], v[16:19], 0
    v_mfma_f32_16x16x32_bf16 v[212:215], v[128:131], v[24:27], 0
    v_mfma_f32_16x16x32_bf16 v[216:219], v[128:131], v[32:35], 0
    v_mfma_f32_16x16x32_bf16 v[220:223], v[128:131], v[40:43], 0
    v_mfma_f32_16x16x32_bf16 v[208:211], v[132:135], v[20:23], v[208:211]
    v_mfma_f32_16x16x32_bf16 v[212:215], v[132:135], v[28:31], v[212:215]
    v_mfma_f32_16x16x32_bf16 v[216:219], v[132:135], v[36:39], v[216:219]
    v_mfma_f32_16x16x32_bf16 v[220:223], v[132:135], v[44:47], v[220:223]
    s_waitcnt lgkmcnt(0)
    v_mfma_f32_16x16x32_bf16 v[224:227], v[136:139], v[16:19], 0
    v_mfma_f32_16x16x32_bf16 v[228:231], v[136:139], v[24:27], 0
    v_mfma_f32_16x16x32_bf16 v[232:235], v[136:139], v[32:35], 0
    s_nop 0
    v_cvt_pk_bf16_f32 v128, v208, v209
    v_cvt_pk_bf16_f32 v129, v210, v211
    v_mfma_f32_16x16x32_bf16 v[236:239], v[136:139], v[40:43], 0
    v_cvt_pk_bf16_f32 v130, v212, v213
    v_cvt_pk_bf16_f32 v131, v214, v215
    v_mfma_f32_16x16x32_bf16 v[224:227], v[140:143], v[20:23], v[224:227]
    v_cvt_pk_bf16_f32 v132, v216, v217
    v_cvt_pk_bf16_f32 v133, v218, v219
    v_mfma_f32_16x16x32_bf16 v[228:231], v[140:143], v[28:31], v[228:231]
    v_cvt_pk_bf16_f32 v134, v220, v221
    v_cvt_pk_bf16_f32 v135, v222, v223
    v_mfma_f32_16x16x32_bf16 v[232:235], v[140:143], v[36:39], v[232:235]
    v_mfma_f32_16x16x32_bf16 v[236:239], v[140:143], v[44:47], v[236:239]
    s_nop 0
    v_cvt_pk_bf16_f32 v136, v224, v225
    v_cvt_pk_bf16_f32 v137, v226, v227
    s_nop 0
    v_cvt_pk_bf16_f32 v138, v228, v229
    v_cvt_pk_bf16_f32 v139, v230, v231
    s_nop 0
    v_cvt_pk_bf16_f32 v140, v232, v233
    v_cvt_pk_bf16_f32 v141, v234, v235
    v_cvt_pk_bf16_f32 v142, v236, v237
    v_cvt_pk_bf16_f32 v143, v238, v239
    s_waitcnt vmcnt(15)
    ds_read_b64_tr_b16 v[144:145], v8 offset:8192
    ds_read_b64_tr_b16 v[146:147], v8 offset:8704
    ds_read_b64_tr_b16 v[148:149], v8 offset:9216
    ds_read_b64_tr_b16 v[150:151], v8 offset:9728
    ds_read_b64_tr_b16 v[152:153], v8 offset:10240
    ds_read_b64_tr_b16 v[154:155], v8 offset:10752
    ds_read_b64_tr_b16 v[156:157], v8 offset:11264
    ds_read_b64_tr_b16 v[158:159], v8 offset:11776
    s_waitcnt lgkmcnt(4)
    v_mfma_f32_16x16x32_bf16 v[176:179], v[144:147], v[16:19], 0
    v_mfma_f32_16x16x32_bf16 v[180:183], v[144:147], v[24:27], 0
    v_mfma_f32_16x16x32_bf16 v[184:187], v[144:147], v[32:35], 0
    v_mfma_f32_16x16x32_bf16 v[188:191], v[144:147], v[40:43], 0
    v_mfma_f32_16x16x32_bf16 v[176:179], v[148:151], v[20:23], v[176:179]
    v_mfma_f32_16x16x32_bf16 v[180:183], v[148:151], v[28:31], v[180:183]
    v_mfma_f32_16x16x32_bf16 v[184:187], v[148:151], v[36:39], v[184:187]
    v_mfma_f32_16x16x32_bf16 v[188:191], v[148:151], v[44:47], v[188:191]
    s_waitcnt lgkmcnt(0)
    v_mfma_f32_16x16x32_bf16 v[192:195], v[152:155], v[16:19], 0
    v_mfma_f32_16x16x32_bf16 v[196:199], v[152:155], v[24:27], 0
    v_mfma_f32_16x16x32_bf16 v[200:203], v[152:155], v[32:35], 0
    s_nop 0
    v_cvt_pk_bf16_f32 v144, v176, v177
    v_cvt_pk_bf16_f32 v145, v178, v179
    v_mfma_f32_16x16x32_bf16 v[204:207], v[152:155], v[40:43], 0
    v_cvt_pk_bf16_f32 v146, v180, v181
    v_cvt_pk_bf16_f32 v147, v182, v183
    v_mfma_f32_16x16x32_bf16 v[192:195], v[156:159], v[20:23], v[192:195]
    v_cvt_pk_bf16_f32 v148, v184, v185
    v_cvt_pk_bf16_f32 v149, v186, v187
    v_mfma_f32_16x16x32_bf16 v[196:199], v[156:159], v[28:31], v[196:199]
    v_cvt_pk_bf16_f32 v150, v188, v189
    v_cvt_pk_bf16_f32 v151, v190, v191
    v_mfma_f32_16x16x32_bf16 v[200:203], v[156:159], v[36:39], v[200:203]
    v_mfma_f32_16x16x32_bf16 v[204:207], v[156:159], v[44:47], v[204:207]
    s_nop 0
    v_cvt_pk_bf16_f32 v152, v192, v193
    v_cvt_pk_bf16_f32 v153, v194, v195
    s_nop 0
    v_cvt_pk_bf16_f32 v154, v196, v197
    v_cvt_pk_bf16_f32 v155, v198, v199
    s_nop 0
    v_cvt_pk_bf16_f32 v156, v200, v201
    v_cvt_pk_bf16_f32 v157, v202, v203
    v_cvt_pk_bf16_f32 v158, v204, v205
    v_cvt_pk_bf16_f32 v159, v206, v207
    s_waitcnt vmcnt(11)
    ds_read_b64_tr_b16 v[160:161], v8 offset:12288
    ds_read_b64_tr_b16 v[162:163], v8 offset:12800
    ds_read_b64_tr_b16 v[164:165], v8 offset:13312
    ds_read_b64_tr_b16 v[166:167], v8 offset:13824
    ds_read_b64_tr_b16 v[168:169], v8 offset:14336
    ds_read_b64_tr_b16 v[170:171], v8 offset:14848
    ds_read_b64_tr_b16 v[172:173], v8 offset:15360
    ds_read_b64_tr_b16 v[174:175], v8 offset:15872
    s_waitcnt lgkmcnt(0)
    s_barrier
    v_mfma_f32_16x16x32_bf16 v[208:211], v[160:163], v[16:19], 0
    ds_write_b128 v9, v[112:115] offset:0
    v_mfma_f32_16x16x32_bf16 v[212:215], v[160:163], v[24:27], 0
    ds_write_b128 v9, v[116:119] offset:33024
    v_mfma_f32_16x16x32_bf16 v[216:219], v[160:163], v[32:35], 0
    ds_write_b128 v9, v[120:123] offset:16
    v_mfma_f32_16x16x32_bf16 v[220:223], v[160:163], v[40:43], 0
    ds_write_b128 v9, v[124:127] offset:33040
    v_mfma_f32_16x16x32_bf16 v[208:211], v[164:167], v[20:23], v[208:211]
    ds_write_b128 v9, v[128:131] offset:32
    v_mfma_f32_16x16x32_bf16 v[212:215], v[164:167], v[28:31], v[212:215]
    ds_write_b128 v9, v[132:135] offset:33056
    v_mfma_f32_16x16x32_bf16 v[216:219], v[164:167], v[36:39], v[216:219]
    ds_write_b128 v9, v[136:139] offset:48
    v_mfma_f32_16x16x32_bf16 v[220:223], v[164:167], v[44:47], v[220:223]
    ds_write_b128 v9, v[140:143] offset:33072
    v_mfma_f32_16x16x32_bf16 v[224:227], v[168:171], v[16:19], 0
    ds_write_b128 v9, v[144:147] offset:1024
    ds_write_b128 v9, v[148:151] offset:34048
    v_mfma_f32_16x16x32_bf16 v[228:231], v[168:171], v[24:27], 0
    ds_write_b128 v9, v[152:155] offset:1040
    ds_write_b128 v9, v[156:159] offset:34064
    v_mfma_f32_16x16x32_bf16 v[232:235], v[168:171], v[32:35], 0
    v_cvt_pk_bf16_f32 v240, v208, v209
    v_cvt_pk_bf16_f32 v241, v210, v211
    v_mfma_f32_16x16x32_bf16 v[236:239], v[168:171], v[40:43], 0
    v_cvt_pk_bf16_f32 v242, v212, v213
    v_cvt_pk_bf16_f32 v243, v214, v215
    v_mfma_f32_16x16x32_bf16 v[224:227], v[172:175], v[20:23], v[224:227]
    ds_write_b128 v9, v[240:243] offset:1056
    v_cvt_pk_bf16_f32 v244, v216, v217
    v_mfma_f32_16x16x32_bf16 v[228:231], v[172:175], v[28:31], v[228:231]
    v_cvt_pk_bf16_f32 v245, v218, v219
    v_cvt_pk_bf16_f32 v246, v220, v221
    v_mfma_f32_16x16x32_bf16 v[232:235], v[172:175], v[36:39], v[232:235]
    v_cvt_pk_bf16_f32 v247, v222, v223
    ds_write_b128 v9, v[244:247] offset:34080
    v_mfma_f32_16x16x32_bf16 v[236:239], v[172:175], v[44:47], v[236:239]
    v_cvt_pk_bf16_f32 v248, v224, v225
    v_cvt_pk_bf16_f32 v249, v226, v227
    v_cvt_pk_bf16_f32 v250, v228, v229
    v_cvt_pk_bf16_f32 v251, v230, v231
    ds_write_b128 v9, v[248:251] offset:1072
    v_cvt_pk_bf16_f32 v252, v232, v233
    v_cvt_pk_bf16_f32 v253, v234, v235
    s_nop 0
    v_cvt_pk_bf16_f32 v254, v236, v237
    v_cvt_pk_bf16_f32 v255, v238, v239
    ds_write_b128 v9, v[252:255] offset:34096
    s_mul_i32 s8, s3, 9363
    s_lshr_b32 s8, s8, 16
    s_mul_i32 s9, s8, 7
    s_sub_u32 s9, s3, s9
    s_and_b32 s38, s8, 8
    s_mov_b32 s40, 0
    s_cmp_eq_u32 s9, 4
    s_cselect_b32 s40, 0, s40
    s_cmp_eq_u32 s9, 5
    s_cselect_b32 s40, 16, s40
    s_cmp_eq_u32 s9, 6
    s_cselect_b32 s40, 64, s40
    s_mov_b32 s41, 2
    s_cmp_eq_u32 s9, 4
    s_cselect_b32 s41, 32, s41
    s_cmp_eq_u32 s9, 5
    s_cselect_b32 s41, 48, s41
    s_cmp_eq_u32 s9, 6
    s_cselect_b32 s41, 80, s41
    s_mov_b32 s42, 4
    s_cmp_eq_u32 s9, 4
    s_cselect_b32 s42, 96, s42
    s_cmp_eq_u32 s9, 5
    s_cselect_b32 s42, 112, s42
    s_cmp_eq_u32 s9, 6
    s_cselect_b32 s42, 128, s42
    s_mov_b32 s43, 6
    s_cmp_eq_u32 s9, 4
    s_cselect_b32 s43, 144, s43
    s_cmp_eq_u32 s9, 5
    s_cselect_b32 s43, 160, s43
    s_cmp_eq_u32 s9, 6
    s_cselect_b32 s43, 176, s43
    s_cmp_eq_u32 s38, 0
    s_cselect_b32 s44, s42, s40
    s_cselect_b32 s45, s43, s41
    s_cselect_b32 s46, s40, s42
    s_cselect_b32 s47, s41, s43
    s_lshl_b32 s30, s10, 1
    s_sub_u32 s31, s8, s30
    s_and_b32 s31, s31, 7
    s_mul_i32 s32, s9, 7
    s_add_u32 s32, s32, s31
    s_add_u32 s32, s32, 3
    s_cmp_eq_u32 s31, 0
    s_cselect_b32 s32, s9, s32
    s_lshl_b32 s32, s32, 3
    s_add_u32 s32, s32, 448
    s_lshl_b32 s31, s31, 1
    s_add_u32 s31, s31, 704
    s_cmp_lt_u32 s9, 4
    s_cselect_b32 s32, s32, s31
    s_add_u32 s30, s30, s38
    s_mul_i32 s30, s30, 896
    s_add_u32 s32, s32, s30
    s_add_u32 s48, s32, s44
    s_lshl_b32 s48, s48, 10
    s_add_u32 s48, s48, 8388608
    s_add_u32 s49, s32, s45
    s_lshl_b32 s49, s49, 10
    s_add_u32 s49, s49, 8388608
    s_add_u32 s50, s32, s46
    s_lshl_b32 s50, s50, 10
    s_add_u32 s50, s50, 8388608
    s_add_u32 s51, s32, s47
    s_lshl_b32 s51, s51, 10
    s_add_u32 s51, s51, 8388608
    s_lshl_b32 s30, s10, 1
    s_add_u32 s30, s30, 1
    s_sub_u32 s31, s8, s30
    s_and_b32 s31, s31, 7
    s_mul_i32 s32, s9, 7
    s_add_u32 s32, s32, s31
    s_add_u32 s32, s32, 3
    s_cmp_eq_u32 s31, 0
    s_cselect_b32 s32, s9, s32
    s_lshl_b32 s32, s32, 3
    s_add_u32 s32, s32, 448
    s_lshl_b32 s31, s31, 1
    s_add_u32 s31, s31, 704
    s_cmp_lt_u32 s9, 4
    s_cselect_b32 s32, s32, s31
    s_add_u32 s30, s30, s38
    s_mul_i32 s30, s30, 896
    s_add_u32 s32, s32, s30
    s_add_u32 s52, s32, s44
    s_lshl_b32 s52, s52, 10
    s_add_u32 s52, s52, 8388608
    s_add_u32 s53, s32, s45
    s_lshl_b32 s53, s53, 10
    s_add_u32 s53, s53, 8388608
    s_add_u32 s54, s32, s46
    s_lshl_b32 s54, s54, 10
    s_add_u32 s54, s54, 8388608
    s_add_u32 s55, s32, s47
    s_lshl_b32 s55, s55, 10
    s_add_u32 s55, s55, 8388608
    s_waitcnt vmcnt(0)
    s_waitcnt lgkmcnt(0)
    s_barrier
    s_mov_b32 s9, 27459584
    v_lshlrev_b32 v253, 6, v0
    buffer_load_dword v252, v253, s[16:19], s9 offen sc1
    ds_read_b128 v[112:115], v10 offset:0
    ds_read_b128 v[116:119], v10 offset:1024
    ds_read_b128 v[120:123], v10 offset:2064
    ds_read_b128 v[124:127], v10 offset:3088
    ds_read_b128 v[128:131], v10 offset:4128
    ds_read_b128 v[132:135], v10 offset:5152
    ds_read_b128 v[136:139], v10 offset:6192
    ds_read_b128 v[140:143], v10 offset:7216
    ds_read_b128 v[144:147], v10 offset:8256
    ds_read_b128 v[148:151], v10 offset:9280
    ds_read_b128 v[152:155], v10 offset:10320
    ds_read_b128 v[156:159], v10 offset:11344
    ds_read_b128 v[160:163], v10 offset:12384
    ds_read_b128 v[164:167], v10 offset:13408
    ds_read_b128 v[168:171], v10 offset:14448
    ds_read_b128 v[172:175], v10 offset:15472
    s_waitcnt lgkmcnt(14)
    v_mfma_f32_16x16x32_bf16 v[176:179], v[112:115], v[48:51], 0
    v_mfma_f32_16x16x32_bf16 v[184:187], v[112:115], v[52:55], 0
    v_mfma_f32_16x16x32_bf16 v[180:183], v[116:119], v[48:51], 0
    v_mfma_f32_16x16x32_bf16 v[188:191], v[116:119], v[52:55], 0
    v_add_u32 v14, 122880, v4
    ds_read_b128 a[96:99], v14 offset:0
    ds_read_b128 a[100:103], v14 offset:1024
    ds_read_b128 a[104:107], v14 offset:2048
    ds_read_b128 a[108:111], v14 offset:3072
    s_waitcnt lgkmcnt(15)
    v_mfma_f32_16x16x32_bf16 v[192:195], v[120:123], v[56:59], 0
    v_mfma_f32_16x16x32_bf16 v[200:203], v[120:123], v[60:63], 0
    v_mfma_f32_16x16x32_bf16 v[196:199], v[124:127], v[56:59], 0
    v_mfma_f32_16x16x32_bf16 v[204:207], v[124:127], v[60:63], 0
    ds_read_b128 a[112:115], v14 offset:4096
    ds_read_b128 a[116:119], v14 offset:5120
    ds_read_b128 a[120:123], v14 offset:6144
    ds_read_b128 a[124:127], v14 offset:7168
    ds_read_b128 a[128:131], v14 offset:8192
    s_waitcnt lgkmcnt(15)
    v_mfma_f32_16x16x32_bf16 v[208:211], v[128:131], v[64:67], 0
    v_cvt_pk_bf16_f32 v16, v176, v177
    v_cvt_pk_bf16_f32 v17, v178, v179
    v_cvt_pk_bf16_f32 v18, v180, v181
    v_mfma_f32_16x16x32_bf16 v[216:219], v[128:131], v[68:71], 0
    v_cvt_pk_bf16_f32 v19, v182, v183
    buffer_store_dwordx4 v[16:19], v4, s[16:19], s48 offen offset:0 sc1
    v_cvt_pk_bf16_f32 v20, v184, v185
    v_mfma_f32_16x16x32_bf16 v[212:215], v[132:135], v[64:67], 0
    v_cvt_pk_bf16_f32 v21, v186, v187
    v_cvt_pk_bf16_f32 v22, v188, v189
    v_cvt_pk_bf16_f32 v23, v190, v191
    v_mfma_f32_16x16x32_bf16 v[220:223], v[132:135], v[68:71], 0
    buffer_store_dwordx4 v[20:23], v4, s[16:19], s48 offen offset:1024 sc1
    ds_read_b128 a[132:135], v14 offset:9216
    ds_read_b128 a[136:139], v14 offset:10240
    ds_read_b128 a[140:143], v14 offset:11264
    ds_read_b128 a[144:147], v14 offset:12288
    ds_read_b128 a[148:151], v14 offset:13312
    v_mfma_f32_16x16x32_bf16 v[224:227], v[136:139], v[72:75], 0
    v_cvt_pk_bf16_f32 v24, v192, v193
    v_cvt_pk_bf16_f32 v25, v194, v195
    v_cvt_pk_bf16_f32 v26, v196, v197
    v_mfma_f32_16x16x32_bf16 v[232:235], v[136:139], v[76:79], 0
    v_cvt_pk_bf16_f32 v27, v198, v199
    buffer_store_dwordx4 v[24:27], v4, s[16:19], s49 offen offset:0 sc1
    v_cvt_pk_bf16_f32 v28, v200, v201
    v_mfma_f32_16x16x32_bf16 v[228:231], v[140:143], v[72:75], 0
    v_cvt_pk_bf16_f32 v29, v202, v203
    v_cvt_pk_bf16_f32 v30, v204, v205
    v_cvt_pk_bf16_f32 v31, v206, v207
    v_mfma_f32_16x16x32_bf16 v[236:239], v[140:143], v[76:79], 0
    buffer_store_dwordx4 v[28:31], v4, s[16:19], s49 offen offset:1024 sc1
    ds_read_b128 a[152:155], v14 offset:14336
    ds_read_b128 a[156:159], v14 offset:15360
    ds_read_b128 a[160:163], v14 offset:16384
    ds_read_b128 a[164:167], v14 offset:17408
    ds_read_b128 a[168:171], v14 offset:18432
    v_mfma_f32_16x16x32_bf16 v[176:179], v[144:147], v[80:83], 0
    v_cvt_pk_bf16_f32 v32, v208, v209
    v_cvt_pk_bf16_f32 v33, v210, v211
    v_cvt_pk_bf16_f32 v34, v212, v213
    v_mfma_f32_16x16x32_bf16 v[184:187], v[144:147], v[84:87], 0
    v_cvt_pk_bf16_f32 v35, v214, v215
    buffer_store_dwordx4 v[32:35], v4, s[16:19], s50 offen offset:0 sc1
    v_cvt_pk_bf16_f32 v36, v216, v217
    v_mfma_f32_16x16x32_bf16 v[180:183], v[148:151], v[80:83], 0
    v_cvt_pk_bf16_f32 v37, v218, v219
    v_cvt_pk_bf16_f32 v38, v220, v221
    v_cvt_pk_bf16_f32 v39, v222, v223
    v_mfma_f32_16x16x32_bf16 v[188:191], v[148:151], v[84:87], 0
    buffer_store_dwordx4 v[36:39], v4, s[16:19], s50 offen offset:1024 sc1
    ds_read_b128 a[172:175], v14 offset:19456
    ds_read_b128 a[176:179], v14 offset:20480
    ds_read_b128 a[180:183], v14 offset:21504
    ds_read_b128 a[184:187], v14 offset:22528
    ds_read_b128 a[188:191], v14 offset:23552
    s_waitcnt lgkmcnt(15)
    v_mfma_f32_16x16x32_bf16 v[192:195], v[152:155], v[88:91], 0
    v_cvt_pk_bf16_f32 v40, v224, v225
    v_cvt_pk_bf16_f32 v41, v226, v227
    v_cvt_pk_bf16_f32 v42, v228, v229
    v_mfma_f32_16x16x32_bf16 v[200:203], v[152:155], v[92:95], 0
    v_cvt_pk_bf16_f32 v43, v230, v231
    buffer_store_dwordx4 v[40:43], v4, s[16:19], s51 offen offset:0 sc1
    v_cvt_pk_bf16_f32 v44, v232, v233
    v_mfma_f32_16x16x32_bf16 v[196:199], v[156:159], v[88:91], 0
    v_cvt_pk_bf16_f32 v45, v234, v235
    v_cvt_pk_bf16_f32 v46, v236, v237
    v_cvt_pk_bf16_f32 v47, v238, v239
    v_mfma_f32_16x16x32_bf16 v[204:207], v[156:159], v[92:95], 0
    buffer_store_dwordx4 v[44:47], v4, s[16:19], s51 offen offset:1024 sc1
    ds_read_b128 a[192:195], v14 offset:24576
    ds_read_b128 a[196:199], v14 offset:25600
    ds_read_b128 a[200:203], v14 offset:26624
    ds_read_b128 a[204:207], v14 offset:27648
    ds_read_b128 a[208:211], v14 offset:28672
    v_mfma_f32_16x16x32_bf16 v[208:211], v[160:163], v[96:99], 0
    v_cvt_pk_bf16_f32 v16, v176, v177
    v_cvt_pk_bf16_f32 v17, v178, v179
    v_cvt_pk_bf16_f32 v18, v180, v181
    v_mfma_f32_16x16x32_bf16 v[216:219], v[160:163], v[100:103], 0
    v_cvt_pk_bf16_f32 v19, v182, v183
    buffer_store_dwordx4 v[16:19], v4, s[16:19], s52 offen offset:0 sc1
    v_cvt_pk_bf16_f32 v20, v184, v185
    v_mfma_f32_16x16x32_bf16 v[212:215], v[164:167], v[96:99], 0
    v_cvt_pk_bf16_f32 v21, v186, v187
    v_cvt_pk_bf16_f32 v22, v188, v189
    v_cvt_pk_bf16_f32 v23, v190, v191
    v_mfma_f32_16x16x32_bf16 v[220:223], v[164:167], v[100:103], 0
    buffer_store_dwordx4 v[20:23], v4, s[16:19], s52 offen offset:1024 sc1
    ds_read_b128 a[212:215], v14 offset:29696
    ds_read_b128 a[216:219], v14 offset:30720
    ds_read_b128 a[220:223], v14 offset:31744
    ds_read_b128 a[224:227], v14 offset:32768
    ds_read_b128 a[228:231], v14 offset:33792
    v_mfma_f32_16x16x32_bf16 v[224:227], v[168:171], v[104:107], 0
    v_cvt_pk_bf16_f32 v24, v192, v193
    v_cvt_pk_bf16_f32 v25, v194, v195
    v_cvt_pk_bf16_f32 v26, v196, v197
    v_mfma_f32_16x16x32_bf16 v[232:235], v[168:171], v[108:111], 0
    v_cvt_pk_bf16_f32 v27, v198, v199
    buffer_store_dwordx4 v[24:27], v4, s[16:19], s53 offen offset:0 sc1
    v_cvt_pk_bf16_f32 v28, v200, v201
    v_mfma_f32_16x16x32_bf16 v[228:231], v[172:175], v[104:107], 0
    v_cvt_pk_bf16_f32 v29, v202, v203
    v_cvt_pk_bf16_f32 v30, v204, v205
    v_cvt_pk_bf16_f32 v31, v206, v207
    v_mfma_f32_16x16x32_bf16 v[236:239], v[172:175], v[108:111], 0
    buffer_store_dwordx4 v[28:31], v4, s[16:19], s53 offen offset:1024 sc1
    ds_read_b128 a[232:235], v14 offset:34816
    ds_read_b128 a[236:239], v14 offset:35840
    ds_read_b128 a[240:243], v14 offset:36864
    ds_read_b128 a[244:247], v14 offset:37888
    ds_read_b128 a[248:251], v14 offset:38912
    ds_read_b128 a[252:255], v14 offset:39936
    v_cvt_pk_bf16_f32 v32, v208, v209
    v_cvt_pk_bf16_f32 v33, v210, v211
    v_cvt_pk_bf16_f32 v34, v212, v213
    v_cvt_pk_bf16_f32 v35, v214, v215
    buffer_store_dwordx4 v[32:35], v4, s[16:19], s54 offen offset:0 sc1
    v_cvt_pk_bf16_f32 v36, v216, v217
    v_cvt_pk_bf16_f32 v37, v218, v219
    v_cvt_pk_bf16_f32 v38, v220, v221
    v_cvt_pk_bf16_f32 v39, v222, v223
    buffer_store_dwordx4 v[36:39], v4, s[16:19], s54 offen offset:1024 sc1
    v_cvt_pk_bf16_f32 v40, v224, v225
    v_cvt_pk_bf16_f32 v41, v226, v227
    v_cvt_pk_bf16_f32 v42, v228, v229
    v_cvt_pk_bf16_f32 v43, v230, v231
    buffer_store_dwordx4 v[40:43], v4, s[16:19], s55 offen offset:0 sc1
    v_cvt_pk_bf16_f32 v44, v232, v233
    v_cvt_pk_bf16_f32 v45, v234, v235
    v_cvt_pk_bf16_f32 v46, v236, v237
    v_cvt_pk_bf16_f32 v47, v238, v239
    buffer_store_dwordx4 v[44:47], v4, s[16:19], s55 offen offset:1024 sc1
    s_mov_b32 s67, 0x80000000
    s_mov_b32 s66, 0
    s_call_b64 s[90:91], main_kernel_visit1
    s_waitcnt vmcnt(16)
    s_branch main_kernel_schk
main_kernel_rC:
    s_cmp_ge_u32 s2, 240
    s_cbranch_scc1 main_kernel_rD
    s_sub_u32 s3, s2, 112
    s_sub_u32 s29, s2, 224
    s_getpc_b64 s[12:13]
    s_add_u32 s12, s12, tab_t@rel32@lo+4
    s_addc_u32 s13, s13, tab_t@rel32@hi+12
    s_mov_b32 s14, 18432
    s_mov_b32 s15, 0x20000
    v_lshrrev_b32 v7, 6, v0
    v_and_b32 v1, 63, v0
    v_and_b32 v2, 15, v0
    v_bfe_u32 v3, v0, 4, 2
    v_readfirstlane_b32 s10, v7
    v_lshlrev_b32 v4, 4, v1
    s_mov_b32 s22, 0
    s_mov_b32 s23, 4096
    s_mov_b32 s28, 16384
    buffer_load_dwordx4 v[16:19], v4, s[12:15], s22 offen offset:0
    buffer_load_dwordx4 v[20:23], v4, s[12:15], s22 offen offset:1024
    buffer_load_dwordx4 v[24:27], v4, s[12:15], s22 offen offset:2048
    buffer_load_dwordx4 v[28:31], v4, s[12:15], s22 offen offset:3072
    buffer_load_dwordx4 v[32:35], v4, s[12:15], s23 offen offset:0
    buffer_load_dwordx4 v[36:39], v4, s[12:15], s23 offen offset:1024
    buffer_load_dwordx4 v[40:43], v4, s[12:15], s23 offen offset:2048
    buffer_load_dwordx4 v[44:47], v4, s[12:15], s23 offen offset:3072
    buffer_load_dwordx4 v[248:251], v4, s[12:15], s28 offen offset:0
    buffer_load_dwordx4 v[252:255], v4, s[12:15], s28 offen offset:1024
    s_mul_i32 s11, s10, 8192
    s_lshr_b32 s20, s3, 3
    s_lshl_b32 s20, s20, 18
    s_and_b32 s9, s3, 7
    s_lshl_b32 s9, s9, 14
    s_add_u32 s20, s20, s9
    s_lshr_b32 s9, s10, 1
    s_lshl_b32 s9, s9, 17
    s_add_u32 s20, s20, s9
    s_and_b32 s9, s10, 1
    s_lshl_b32 s9, s9, 13
    s_add_u32 s20, s20, s9
    s_add_u32 s11, s11, 108032
    s_mov_b32 s26, 4194304
    s_mov_b32 s27, 0x20000
    s_waitcnt lgkmcnt(0)
    s_mov_b32 s24, s60
    s_mov_b32 s25, s61
    s_mov_b32 s16, s4
    s_mov_b32 s17, s5
    s_mov_b32 s18, 268435456
    s_mov_b32 s19, 0x20000
    s_add_u32 m0, s11, 0
    s_add_u32 s21, s20, 0
    buffer_load_dwordx4 v4, s[24:27], s21 offen offset:0 lds
    buffer_load_dwordx4 v4, s[24:27], s21 offen offset:1024 lds
    buffer_load_dwordx4 v4, s[24:27], s21 offen offset:2048 lds
    buffer_load_dwordx4 v4, s[24:27], s21 offen offset:3072 lds
    s_add_u32 m0, s11, 4096
    s_add_u32 s21, s20, 4096
    buffer_load_dwordx4 v4, s[24:27], s21 offen offset:0 lds
    buffer_load_dwordx4 v4, s[24:27], s21 offen offset:1024 lds
    buffer_load_dwordx4 v4, s[24:27], s21 offen offset:2048 lds
    buffer_load_dwordx4 v4, s[24:27], s21 offen offset:3072 lds
    v_lshl_add_u32 v8, v1, 3, s11
    s_mov_b32 s9, 1040
    v_mul_lo_u32 v9, v2, s9
    v_lshl_add_u32 v9, v3, 8, v9
    s_lshl_b32 s9, s10, 6
    s_add_u32 s9, s9, 108032
    v_add_u32 v9, s9, v9
    s_mul_i32 s9, s10, 8320
    s_add_u32 s9, s9, 108032
    v_add_u32 v10, s9, v4
    v_mov_b32 v11, -1
    v_mov_b32 v12, 0xffff0000
    v_cmp_gt_u32 vcc, 16, v0
    s_nop 1
    v_cndmask_b32 v11, v11, v12, vcc
    v_mov_b32 v12, 1.0
    v_cndmask_b32 v12, v12, 0, vcc
    v_lshlrev_b32 v188, 2, v3
    v_cvt_f32_u32 v188, v188
    v_mul_f32 v176, 0x3a800000, v188
    v_add_f32 v177, 0x3a800000, v176
    v_add_f32 v178, 0x3a800000, v177
    v_add_f32 v179, 0x3a800000, v178
    v_and_b32 v188, 12, v2
    v_bfe_u32 v189, v2, 1, 1
    v_add_u32 v188, v188, v189
    v_lshlrev_b32 v188, 6, v188
    v_lshl_add_u32 v188, s10, 3, v188
    v_cvt_f32_u32 v188, v188
    v_add_f32 v189, 0x43000000, v188
    v_lshrrev_b32 v190, 3, v2
    v_lshl_add_u32 v190, v190, 1, 1
    v_and_b32 v191, 1, v2
    v_mul_u32_u24 v190, v190, v191
    v_cvt_f32_u32 v190, v190
    v_mul_f32 v190, 0x3e800000, v190
    v_fma_f32 v180, v176, v188, v190
    v_fma_f32 v181, v177, v188, v190
    v_fma_f32 v182, v178, v188, v190
    v_fma_f32 v183, v179, v188, v190
    v_fma_f32 v184, v176, v189, v190
    v_fma_f32 v185, v177, v189, v190
    v_fma_f32 v186, v178, v189, v190
    v_fma_f32 v187, v179, v189, v190
    v_cos_f32 v192, v176
    v_sin_f32 v196, v176
    v_cos_f32 v193, v177
    v_sin_f32 v197, v177
    v_cos_f32 v194, v178
    v_sin_f32 v198, v178
    v_cos_f32 v195, v179
    v_sin_f32 v199, v179
    v_cos_f32 v200, v180
    v_sin_f32 v204, v180
    v_cos_f32 v201, v181
    v_sin_f32 v205, v181
    v_cos_f32 v202, v182
    v_sin_f32 v206, v182
    v_cos_f32 v203, v183
    v_sin_f32 v207, v183
    v_cvt_pk_bf16_f32 v48, v200, v201
    v_cvt_pk_bf16_f32 v49, v202, v203
    v_cvt_pk_bf16_f32 v50, v204, v205
    v_cvt_pk_bf16_f32 v51, v206, v207
    v_cos_f32 v216, v184
    v_sin_f32 v220, v184
    v_cos_f32 v217, v185
    v_sin_f32 v221, v185
    v_cos_f32 v218, v186
    v_sin_f32 v222, v186
    v_cos_f32 v219, v187
    v_sin_f32 v223, v187
    v_cvt_pk_bf16_f32 v52, v216, v217
    v_cvt_pk_bf16_f32 v53, v218, v219
    v_cvt_pk_bf16_f32 v54, v220, v221
    v_cvt_pk_bf16_f32 v55, v222, v223
    v_pk_mul_f32 v[208:209], v[200:201], v[192:193]
    v_pk_mul_f32 v[212:213], v[204:205], v[192:193]
    v_pk_mul_f32 v[210:211], v[202:203], v[194:195]
    v_pk_mul_f32 v[214:215], v[206:207], v[194:195]
    v_pk_fma_f32 v[208:209], v[204:205], v[196:197], v[208:209] neg_lo:[1,0,0] neg_hi:[1,0,0]
    v_pk_fma_f32 v[212:213], v[200:201], v[196:197], v[212:213]
    v_pk_fma_f32 v[210:211], v[206:207], v[198:199], v[210:211] neg_lo:[1,0,0] neg_hi:[1,0,0]
    v_pk_fma_f32 v[214:215], v[202:203], v[198:199], v[214:215]
    v_cvt_pk_bf16_f32 v56, v208, v209
    v_cvt_pk_bf16_f32 v57, v210, v211
    v_cvt_pk_bf16_f32 v58, v212, v213
    v_cvt_pk_bf16_f32 v59, v214, v215
    v_pk_mul_f32 v[224:225], v[216:217], v[192:193]
    v_pk_mul_f32 v[228:229], v[220:221], v[192:193]
    v_pk_mul_f32 v[226:227], v[218:219], v[194:195]
    v_pk_mul_f32 v[230:231], v[222:223], v[194:195]
    v_pk_fma_f32 v[224:225], v[220:221], v[196:197], v[224:225] neg_lo:[1,0,0] neg_hi:[1,0,0]
    v_pk_fma_f32 v[228:229], v[216:217], v[196:197], v[228:229]
    v_pk_fma_f32 v[226:227], v[222:223], v[198:199], v[226:227] neg_lo:[1,0,0] neg_hi:[1,0,0]
    v_pk_fma_f32 v[230:231], v[218:219], v[198:199], v[230:231]
    v_cvt_pk_bf16_f32 v60, v224, v225
    v_cvt_pk_bf16_f32 v61, v226, v227
    v_cvt_pk_bf16_f32 v62, v228, v229
    v_cvt_pk_bf16_f32 v63, v230, v231
    v_pk_mul_f32 v[200:201], v[208:209], v[192:193]
    v_pk_mul_f32 v[204:205], v[212:213], v[192:193]
    v_pk_mul_f32 v[202:203], v[210:211], v[194:195]
    v_pk_mul_f32 v[206:207], v[214:215], v[194:195]
    v_pk_fma_f32 v[200:201], v[212:213], v[196:197], v[200:201] neg_lo:[1,0,0] neg_hi:[1,0,0]
    v_pk_fma_f32 v[204:205], v[208:209], v[196:197], v[204:205]
    v_pk_fma_f32 v[202:203], v[214:215], v[198:199], v[202:203] neg_lo:[1,0,0] neg_hi:[1,0,0]
    v_pk_fma_f32 v[206:207], v[210:211], v[198:199], v[206:207]
    v_cvt_pk_bf16_f32 v64, v200, v201
    v_cvt_pk_bf16_f32 v65, v202, v203
    v_cvt_pk_bf16_f32 v66, v204, v205
    v_cvt_pk_bf16_f32 v67, v206, v207
    v_pk_mul_f32 v[216:217], v[224:225], v[192:193]
    v_pk_mul_f32 v[220:221], v[228:229], v[192:193]
    v_pk_mul_f32 v[218:219], v[226:227], v[194:195]
    v_pk_mul_f32 v[222:223], v[230:231], v[194:195]
    v_pk_fma_f32 v[216:217], v[228:229], v[196:197], v[216:217] neg_lo:[1,0,0] neg_hi:[1,0,0]
    v_pk_fma_f32 v[220:221], v[224:225], v[196:197], v[220:221]
    v_pk_fma_f32 v[218:219], v[230:231], v[198:199], v[218:219] neg_lo:[1,0,0] neg_hi:[1,0,0]
    v_pk_fma_f32 v[222:223], v[226:227], v[198:199], v[222:223]
    v_cvt_pk_bf16_f32 v68, v216, v217
    v_cvt_pk_bf16_f32 v69, v218, v219
    v_cvt_pk_bf16_f32 v70, v220, v221
    v_cvt_pk_bf16_f32 v71, v222, v223
    v_pk_mul_f32 v[208:209], v[200:201], v[192:193]
    v_pk_mul_f32 v[212:213], v[204:205], v[192:193]
    v_pk_mul_f32 v[210:211], v[202:203], v[194:195]
    v_pk_mul_f32 v[214:215], v[206:207], v[194:195]
    v_pk_fma_f32 v[208:209], v[204:205], v[196:197], v[208:209] neg_lo:[1,0,0] neg_hi:[1,0,0]
    v_pk_fma_f32 v[212:213], v[200:201], v[196:197], v[212:213]
    v_pk_fma_f32 v[210:211], v[206:207], v[198:199], v[210:211] neg_lo:[1,0,0] neg_hi:[1,0,0]
    v_pk_fma_f32 v[214:215], v[202:203], v[198:199], v[214:215]
    v_cvt_pk_bf16_f32 v72, v208, v209
    v_cvt_pk_bf16_f32 v73, v210, v211
    v_cvt_pk_bf16_f32 v74, v212, v213
    v_cvt_pk_bf16_f32 v75, v214, v215
    v_pk_mul_f32 v[224:225], v[216:217], v[192:193]
    v_pk_mul_f32 v[228:229], v[220:221], v[192:193]
    v_pk_mul_f32 v[226:227], v[218:219], v[194:195]
    v_pk_mul_f32 v[230:231], v[222:223], v[194:195]
    v_pk_fma_f32 v[224:225], v[220:221], v[196:197], v[224:225] neg_lo:[1,0,0] neg_hi:[1,0,0]
    v_pk_fma_f32 v[228:229], v[216:217], v[196:197], v[228:229]
    v_pk_fma_f32 v[226:227], v[222:223], v[198:199], v[226:227] neg_lo:[1,0,0] neg_hi:[1,0,0]
    v_pk_fma_f32 v[230:231], v[218:219], v[198:199], v[230:231]
    v_cvt_pk_bf16_f32 v76, v224, v225
    v_cvt_pk_bf16_f32 v77, v226, v227
    v_cvt_pk_bf16_f32 v78, v228, v229
    v_cvt_pk_bf16_f32 v79, v230, v231
    v_pk_mul_f32 v[200:201], v[208:209], v[192:193]
    v_pk_mul_f32 v[204:205], v[212:213], v[192:193]
    v_pk_mul_f32 v[202:203], v[210:211], v[194:195]
    v_pk_mul_f32 v[206:207], v[214:215], v[194:195]
    v_pk_fma_f32 v[200:201], v[212:213], v[196:197], v[200:201] neg_lo:[1,0,0] neg_hi:[1,0,0]
    v_pk_fma_f32 v[204:205], v[208:209], v[196:197], v[204:205]
    v_pk_fma_f32 v[202:203], v[214:215], v[198:199], v[202:203] neg_lo:[1,0,0] neg_hi:[1,0,0]
    v_pk_fma_f32 v[206:207], v[210:211], v[198:199], v[206:207]
    v_cvt_pk_bf16_f32 v80, v200, v201
    v_cvt_pk_bf16_f32 v81, v202, v203
    v_cvt_pk_bf16_f32 v82, v204, v205
    v_cvt_pk_bf16_f32 v83, v206, v207
    v_pk_mul_f32 v[216:217], v[224:225], v[192:193]
    v_pk_mul_f32 v[220:221], v[228:229], v[192:193]
    v_pk_mul_f32 v[218:219], v[226:227], v[194:195]
    v_pk_mul_f32 v[222:223], v[230:231], v[194:195]
    v_pk_fma_f32 v[216:217], v[228:229], v[196:197], v[216:217] neg_lo:[1,0,0] neg_hi:[1,0,0]
    v_pk_fma_f32 v[220:221], v[224:225], v[196:197], v[220:221]
    v_pk_fma_f32 v[218:219], v[230:231], v[198:199], v[218:219] neg_lo:[1,0,0] neg_hi:[1,0,0]
    v_pk_fma_f32 v[222:223], v[226:227], v[198:199], v[222:223]
    v_cvt_pk_bf16_f32 v84, v216, v217
    v_cvt_pk_bf16_f32 v85, v218, v219
    v_cvt_pk_bf16_f32 v86, v220, v221
    v_cvt_pk_bf16_f32 v87, v222, v223
    v_pk_mul_f32 v[208:209], v[200:201], v[192:193]
    v_pk_mul_f32 v[212:213], v[204:205], v[192:193]
    v_pk_mul_f32 v[210:211], v[202:203], v[194:195]
    v_pk_mul_f32 v[214:215], v[206:207], v[194:195]
    v_pk_fma_f32 v[208:209], v[204:205], v[196:197], v[208:209] neg_lo:[1,0,0] neg_hi:[1,0,0]
    v_pk_fma_f32 v[212:213], v[200:201], v[196:197], v[212:213]
    v_pk_fma_f32 v[210:211], v[206:207], v[198:199], v[210:211] neg_lo:[1,0,0] neg_hi:[1,0,0]
    v_pk_fma_f32 v[214:215], v[202:203], v[198:199], v[214:215]
    v_cvt_pk_bf16_f32 v88, v208, v209
    v_cvt_pk_bf16_f32 v89, v210, v211
    v_cvt_pk_bf16_f32 v90, v212, v213
    v_cvt_pk_bf16_f32 v91, v214, v215
    v_pk_mul_f32 v[224:225], v[216:217], v[192:193]
    v_pk_mul_f32 v[228:229], v[220:221], v[192:193]
    v_pk_mul_f32 v[226:227], v[218:219], v[194:195]
    v_pk_mul_f32 v[230:231], v[222:223], v[194:195]
    v_pk_fma_f32 v[224:225], v[220:221], v[196:197], v[224:225] neg_lo:[1,0,0] neg_hi:[1,0,0]
    v_pk_fma_f32 v[228:229], v[216:217], v[196:197], v[228:229]
    v_pk_fma_f32 v[226:227], v[222:223], v[198:199], v[226:227] neg_lo:[1,0,0] neg_hi:[1,0,0]
    v_pk_fma_f32 v[230:231], v[218:219], v[198:199], v[230:231]
    v_cvt_pk_bf16_f32 v92, v224, v225
    v_cvt_pk_bf16_f32 v93, v226, v227
    v_cvt_pk_bf16_f32 v94, v228, v229
    v_cvt_pk_bf16_f32 v95, v230, v231
    v_pk_mul_f32 v[200:201], v[208:209], v[192:193]
    v_pk_mul_f32 v[204:205], v[212:213], v[192:193]
    v_pk_mul_f32 v[202:203], v[210:211], v[194:195]
    v_pk_mul_f32 v[206:207], v[214:215], v[194:195]
    v_pk_fma_f32 v[200:201], v[212:213], v[196:197], v[200:201] neg_lo:[1,0,0] neg_hi:[1,0,0]
    v_pk_fma_f32 v[204:205], v[208:209], v[196:197], v[204:205]
    v_pk_fma_f32 v[202:203], v[214:215], v[198:199], v[202:203] neg_lo:[1,0,0] neg_hi:[1,0,0]
    v_pk_fma_f32 v[206:207], v[210:211], v[198:199], v[206:207]
    v_cvt_pk_bf16_f32 v96, v200, v201
    v_cvt_pk_bf16_f32 v97, v202, v203
    v_cvt_pk_bf16_f32 v98, v204, v205
    v_cvt_pk_bf16_f32 v99, v206, v207
    v_pk_mul_f32 v[216:217], v[224:225], v[192:193]
    v_pk_mul_f32 v[220:221], v[228:229], v[192:193]
    v_pk_mul_f32 v[218:219], v[226:227], v[194:195]
    v_pk_mul_f32 v[222:223], v[230:231], v[194:195]
    v_pk_fma_f32 v[216:217], v[228:229], v[196:197], v[216:217] neg_lo:[1,0,0] neg_hi:[1,0,0]
    v_pk_fma_f32 v[220:221], v[224:225], v[196:197], v[220:221]
    v_pk_fma_f32 v[218:219], v[230:231], v[198:199], v[218:219] neg_lo:[1,0,0] neg_hi:[1,0,0]
    v_pk_fma_f32 v[222:223], v[226:227], v[198:199], v[222:223]
    v_cvt_pk_bf16_f32 v100, v216, v217
    v_cvt_pk_bf16_f32 v101, v218, v219
    v_cvt_pk_bf16_f32 v102, v220, v221
    v_cvt_pk_bf16_f32 v103, v222, v223
    v_pk_mul_f32 v[208:209], v[200:201], v[192:193]
    v_pk_mul_f32 v[212:213], v[204:205], v[192:193]
    v_pk_mul_f32 v[210:211], v[202:203], v[194:195]
    v_pk_mul_f32 v[214:215], v[206:207], v[194:195]
    v_pk_fma_f32 v[208:209], v[204:205], v[196:197], v[208:209] neg_lo:[1,0,0] neg_hi:[1,0,0]
    v_pk_fma_f32 v[212:213], v[200:201], v[196:197], v[212:213]
    v_pk_fma_f32 v[210:211], v[206:207], v[198:199], v[210:211] neg_lo:[1,0,0] neg_hi:[1,0,0]
    v_pk_fma_f32 v[214:215], v[202:203], v[198:199], v[214:215]
    v_cvt_pk_bf16_f32 v104, v208, v209
    v_cvt_pk_bf16_f32 v105, v210, v211
    v_cvt_pk_bf16_f32 v106, v212, v213
    v_cvt_pk_bf16_f32 v107, v214, v215
    v_pk_mul_f32 v[224:225], v[216:217], v[192:193]
    v_pk_mul_f32 v[228:229], v[220:221], v[192:193]
    v_pk_mul_f32 v[226:227], v[218:219], v[194:195]
    v_pk_mul_f32 v[230:231], v[222:223], v[194:195]
    v_pk_fma_f32 v[224:225], v[220:221], v[196:197], v[224:225] neg_lo:[1,0,0] neg_hi:[1,0,0]
    v_pk_fma_f32 v[228:229], v[216:217], v[196:197], v[228:229]
    v_pk_fma_f32 v[226:227], v[222:223], v[198:199], v[226:227] neg_lo:[1,0,0] neg_hi:[1,0,0]
    v_pk_fma_f32 v[230:231], v[218:219], v[198:199], v[230:231]
    v_cvt_pk_bf16_f32 v108, v224, v225
    v_cvt_pk_bf16_f32 v109, v226, v227
    v_cvt_pk_bf16_f32 v110, v228, v229
    v_cvt_pk_bf16_f32 v111, v230, v231
    v_mov_b32 v6, 0
    buffer_store_dword v6, v15, s[16:19], s55 offen sc1
    v_mov_b32 v232, 0
    v_mov_b32 v236, 0x88e368f1
    v_mov_b32 v233, 0
    v_mov_b32 v237, 0x4044f8b5
    v_mov_b32 v234, 0
    v_mov_b32 v238, 0x88e368f1
    v_mov_b32 v235, 0
    v_mov_b32 v239, 0x4044f8b5
    v_lshlrev_b32 v231, 4, v0
    s_lshl_b32 s51, s29, 12
    s_add_u32 s48, s51, 27328512
    s_add_u32 s50, s51, 45154304
    s_add_u32 s49, s51, 45088768
    s_add_u32 s51, s51, 27246592
    s_cmp_lt_u32 s29, 8
    s_cselect_b32 s49, s49, s51
    s_cmp_lt_u32 s29, 12
    s_cselect_b32 s49, s49, 0x80000000
    buffer_store_dwordx4 v[232:235], v231, s[16:19], s48 offen sc1
    buffer_store_dwordx4 v[232:235], v231, s[16:19], s50 offen sc1
    buffer_store_dwordx4 v[236:239], v231, s[16:19], s49 offen sc1
    s_waitcnt vmcnt(12)
    s_cmp_lg_u32 s10, 0
    s_cbranch_scc1 main_kernel_xc_c0
    v_mov_b32 v48, v248
    v_mov_b32 v49, v249
    v_mov_b32 v50, v250
    v_mov_b32 v51, v251
    v_mov_b32 v52, v252
    v_mov_b32 v53, v253
    v_mov_b32 v54, v254
    v_mov_b32 v55, v255
main_kernel_xc_c0:
    s_waitcnt vmcnt(8)
    ds_read_b64_tr_b16 v[112:113], v8 offset:0
    ds_read_b64_tr_b16 v[114:115], v8 offset:512
    ds_read_b64_tr_b16 v[116:117], v8 offset:1024
    ds_read_b64_tr_b16 v[118:119], v8 offset:1536
    ds_read_b64_tr_b16 v[120:121], v8 offset:2048
    ds_read_b64_tr_b16 v[122:123], v8 offset:2560
    ds_read_b64_tr_b16 v[124:125], v8 offset:3072
    ds_read_b64_tr_b16 v[126:127], v8 offset:3584
    s_waitcnt lgkmcnt(4)
    v_mfma_f32_16x16x32_bf16 v[176:179], v[112:115], v[16:19], 0
    v_mfma_f32_16x16x32_bf16 v[180:183], v[112:115], v[24:27], 0
    v_mfma_f32_16x16x32_bf16 v[184:187], v[112:115], v[32:35], 0
    v_mfma_f32_16x16x32_bf16 v[188:191], v[112:115], v[40:43], 0
    v_mfma_f32_16x16x32_bf16 v[176:179], v[116:119], v[20:23], v[176:179]
    v_mfma_f32_16x16x32_bf16 v[180:183], v[116:119], v[28:31], v[180:183]
    v_mfma_f32_16x16x32_bf16 v[184:187], v[116:119], v[36:39], v[184:187]
    v_mfma_f32_16x16x32_bf16 v[188:191], v[116:119], v[44:47], v[188:191]
    s_waitcnt lgkmcnt(0)
    v_mfma_f32_16x16x32_bf16 v[192:195], v[120:123], v[16:19], 0
    v_mfma_f32_16x16x32_bf16 v[196:199], v[120:123], v[24:27], 0
    v_mfma_f32_16x16x32_bf16 v[200:203], v[120:123], v[32:35], 0
    s_nop 0
    v_cvt_pk_bf16_f32 v112, v176, v177
    v_cvt_pk_bf16_f32 v113, v178, v179
    v_mfma_f32_16x16x32_bf16 v[204:207], v[120:123], v[40:43], 0
    v_cvt_pk_bf16_f32 v114, v180, v181
    v_cvt_pk_bf16_f32 v115, v182, v183
    v_mfma_f32_16x16x32_bf16 v[192:195], v[124:127], v[20:23], v[192:195]
    v_cvt_pk_bf16_f32 v116, v184, v185
    v_cvt_pk_bf16_f32 v117, v186, v187
    v_mfma_f32_16x16x32_bf16 v[196:199], v[124:127], v[28:31], v[196:199]
    v_cvt_pk_bf16_f32 v118, v188, v189
    v_cvt_pk_bf16_f32 v119, v190, v191
    v_mfma_f32_16x16x32_bf16 v[200:203], v[124:127], v[36:39], v[200:203]
    v_mfma_f32_16x16x32_bf16 v[204:207], v[124:127], v[44:47], v[204:207]
    s_nop 0
    v_cvt_pk_bf16_f32 v120, v192, v193
    v_cvt_pk_bf16_f32 v121, v194, v195
    s_nop 0
    v_cvt_pk_bf16_f32 v122, v196, v197
    v_cvt_pk_bf16_f32 v123, v198, v199
    s_nop 0
    v_cvt_pk_bf16_f32 v124, v200, v201
    v_cvt_pk_bf16_f32 v125, v202, v203
    v_cvt_pk_bf16_f32 v126, v204, v205
    v_cvt_pk_bf16_f32 v127, v206, v207
    s_waitcnt vmcnt(4)
    ds_read_b64_tr_b16 v[128:129], v8 offset:4096
    ds_read_b64_tr_b16 v[130:131], v8 offset:4608
    ds_read_b64_tr_b16 v[132:133], v8 offset:5120
    ds_read_b64_tr_b16 v[134:135], v8 offset:5632
    ds_read_b64_tr_b16 v[136:137], v8 offset:6144
    ds_read_b64_tr_b16 v[138:139], v8 offset:6656
    ds_read_b64_tr_b16 v[140:141], v8 offset:7168
    ds_read_b64_tr_b16 v[142:143], v8 offset:7680
    s_waitcnt lgkmcnt(0)
    s_barrier
    v_mfma_f32_16x16x32_bf16 v[208:211], v[128:131], v[16:19], 0
    ds_write_b128 v9, v[112:115] offset:0
    v_mfma_f32_16x16x32_bf16 v[212:215], v[128:131], v[24:27], 0
    ds_write_b128 v9, v[116:119] offset:16640
    v_mfma_f32_16x16x32_bf16 v[216:219], v[128:131], v[32:35], 0
    ds_write_b128 v9, v[120:123] offset:16
    v_mfma_f32_16x16x32_bf16 v[220:223], v[128:131], v[40:43], 0
    ds_write_b128 v9, v[124:127] offset:16656
    v_mfma_f32_16x16x32_bf16 v[208:211], v[132:135], v[20:23], v[208:211]
    v_mfma_f32_16x16x32_bf16 v[212:215], v[132:135], v[28:31], v[212:215]
    v_mfma_f32_16x16x32_bf16 v[216:219], v[132:135], v[36:39], v[216:219]
    v_mfma_f32_16x16x32_bf16 v[220:223], v[132:135], v[44:47], v[220:223]
    v_mfma_f32_16x16x32_bf16 v[224:227], v[136:139], v[16:19], 0
    v_mfma_f32_16x16x32_bf16 v[228:231], v[136:139], v[24:27], 0
    v_mfma_f32_16x16x32_bf16 v[232:235], v[136:139], v[32:35], 0
    s_nop 1
    v_cvt_pk_bf16_f32 v240, v208, v209
    v_cvt_pk_bf16_f32 v241, v210, v211
    v_mfma_f32_16x16x32_bf16 v[236:239], v[136:139], v[40:43], 0
    v_cvt_pk_bf16_f32 v242, v212, v213
    v_cvt_pk_bf16_f32 v243, v214, v215
    v_mfma_f32_16x16x32_bf16 v[224:227], v[140:143], v[20:23], v[224:227]
    ds_write_b128 v9, v[240:243] offset:32
    v_cvt_pk_bf16_f32 v244, v216, v217
    v_mfma_f32_16x16x32_bf16 v[228:231], v[140:143], v[28:31], v[228:231]
    v_cvt_pk_bf16_f32 v245, v218, v219
    v_cvt_pk_bf16_f32 v246, v220, v221
    v_mfma_f32_16x16x32_bf16 v[232:235], v[140:143], v[36:39], v[232:235]
    v_cvt_pk_bf16_f32 v247, v222, v223
    ds_write_b128 v9, v[244:247] offset:16672
    v_mfma_f32_16x16x32_bf16 v[236:239], v[140:143], v[44:47], v[236:239]
    v_cvt_pk_bf16_f32 v248, v224, v225
    v_cvt_pk_bf16_f32 v249, v226, v227
    v_cvt_pk_bf16_f32 v250, v228, v229
    v_cvt_pk_bf16_f32 v251, v230, v231
    ds_write_b128 v9, v[248:251] offset:48
    v_cvt_pk_bf16_f32 v252, v232, v233
    v_cvt_pk_bf16_f32 v253, v234, v235
    s_nop 0
    v_cvt_pk_bf16_f32 v254, v236, v237
    v_cvt_pk_bf16_f32 v255, v238, v239
    ds_write_b128 v9, v[252:255] offset:16688
    s_lshl_b32 s30, s10, 20
    s_lshr_b32 s9, s3, 1
    s_lshl_b32 s9, s9, 11
    s_add_u32 s30, s30, s9
    s_and_b32 s9, s3, 1
    s_lshl_b32 s9, s9, 7
    s_add_u32 s30, s30, s9
    s_add_u32 s30, s30, 0
    v_and_b32 v5, 0x370, v4
    v_and_b32 v8, 8, v2
    v_lshl_add_u32 v5, v8, 7, v5
    v_mov_b32 v13, 0
    v_mov_b32 v14, 0
    s_waitcnt lgkmcnt(0)
    s_barrier
    ds_read_b128 v[112:115], v10 offset:0
    ds_read_b128 v[116:119], v10 offset:1040
    ds_read_b128 v[120:123], v10 offset:2080
    ds_read_b128 v[124:127], v10 offset:3120
    ds_read_b128 v[128:131], v10 offset:4160
    ds_read_b128 v[132:135], v10 offset:5200
    ds_read_b128 v[136:139], v10 offset:6240
    ds_read_b128 v[140:143], v10 offset:7280
    s_waitcnt lgkmcnt(7)
    v_mfma_f32_16x16x32_bf16 v[176:179], v[48:51], v[112:115], 0
    v_mfma_f32_16x16x32_bf16 v[180:183], v[52:55], v[112:115], 0
    s_waitcnt lgkmcnt(6)
    v_mfma_f32_16x16x32_bf16 v[192:195], v[56:59], v[116:119], 0
    v_mfma_f32_16x16x32_bf16 v[196:199], v[60:63], v[116:119], 0
    s_waitcnt lgkmcnt(5)
    v_mfma_f32_16x16x32_bf16 v[208:211], v[64:67], v[120:123], 0
    s_nop 1
    v_cvt_pk_bf16_f32 v144, v176, v177
    v_cvt_pk_bf16_f32 v145, v178, v179
    v_cvt_pk_bf16_f32 v146, v180, v181
    v_mfma_f32_16x16x32_bf16 v[212:215], v[68:71], v[120:123], 0
    v_cvt_pk_bf16_f32 v147, v182, v183
    v_mul_f32 v176, v176, v12
    v_fmac_f32 v13, v176, v176
    v_mov_b32_dpp v148, v146 row_ror:8 row_mask:0xf bank_mask:0xf
    v_mov_b32_dpp v149, v147 row_ror:8 row_mask:0xf bank_mask:0xf
    v_mov_b32_dpp v146, v144 row_ror:8 row_mask:0xf bank_mask:0x3
    v_mov_b32_dpp v147, v145 row_ror:8 row_mask:0xf bank_mask:0x3
    v_fmac_f32 v14, v177, v177
    v_mov_b32_dpp v144, v148 quad_perm:[0,1,2,3] row_mask:0xf bank_mask:0xc
    v_mov_b32_dpp v145, v149 quad_perm:[0,1,2,3] row_mask:0xf bank_mask:0xc
    v_and_b32 v144, -2, v144
    buffer_store_dwordx4 v[144:147], v5, s[16:19], s30 offen sc1
    v_fmac_f32 v13, v178, v178
    v_fmac_f32 v14, v179, v179
    v_fmac_f32 v13, v180, v180
    v_fmac_f32 v14, v181, v181
    v_fmac_f32 v13, v182, v182
    v_fmac_f32 v14, v183, v183
    s_add_u32 s30, s30, 131072
    s_waitcnt lgkmcnt(4)
    v_mfma_f32_16x16x32_bf16 v[224:227], v[72:75], v[124:127], 0
    v_cvt_pk_bf16_f32 v152, v192, v193
    v_cvt_pk_bf16_f32 v153, v194, v195
    v_cvt_pk_bf16_f32 v154, v196, v197
    v_mfma_f32_16x16x32_bf16 v[228:231], v[76:79], v[124:127], 0
    v_cvt_pk_bf16_f32 v155, v198, v199
    v_fmac_f32 v13, v192, v192
    v_fmac_f32 v14, v193, v193
    v_mov_b32_dpp v156, v154 row_ror:8 row_mask:0xf bank_mask:0xf
    v_mov_b32_dpp v157, v155 row_ror:8 row_mask:0xf bank_mask:0xf
    v_mov_b32_dpp v154, v152 row_ror:8 row_mask:0xf bank_mask:0x3
    v_mov_b32_dpp v155, v153 row_ror:8 row_mask:0xf bank_mask:0x3
    v_fmac_f32 v13, v194, v194
    v_mov_b32_dpp v152, v156 quad_perm:[0,1,2,3] row_mask:0xf bank_mask:0xc
    v_mov_b32_dpp v153, v157 quad_perm:[0,1,2,3] row_mask:0xf bank_mask:0xc
    v_and_b32 v152, -2, v152
    buffer_store_dwordx4 v[152:155], v5, s[16:19], s30 offen sc1
    v_fmac_f32 v14, v195, v195
    v_fmac_f32 v13, v196, v196
    v_fmac_f32 v14, v197, v197
    v_fmac_f32 v13, v198, v198
    v_fmac_f32 v14, v199, v199
    s_add_u32 s30, s30, 131072
    s_waitcnt lgkmcnt(3)
    v_mfma_f32_16x16x32_bf16 v[176:179], v[80:83], v[128:131], 0
    v_cvt_pk_bf16_f32 v160, v208, v209
    v_cvt_pk_bf16_f32 v161, v210, v211
    v_cvt_pk_bf16_f32 v162, v212, v213
    v_mfma_f32_16x16x32_bf16 v[180:183], v[84:87], v[128:131], 0
    v_cvt_pk_bf16_f32 v163, v214, v215
    v_fmac_f32 v13, v208, v208
    v_fmac_f32 v14, v209, v209
    v_mov_b32_dpp v164, v162 row_ror:8 row_mask:0xf bank_mask:0xf
    v_mov_b32_dpp v165, v163 row_ror:8 row_mask:0xf bank_mask:0xf
    v_mov_b32_dpp v162, v160 row_ror:8 row_mask:0xf bank_mask:0x3
    v_mov_b32_dpp v163, v161 row_ror:8 row_mask:0xf bank_mask:0x3
    v_fmac_f32 v13, v210, v210
    v_mov_b32_dpp v160, v164 quad_perm:[0,1,2,3] row_mask:0xf bank_mask:0xc
    v_mov_b32_dpp v161, v165 quad_perm:[0,1,2,3] row_mask:0xf bank_mask:0xc
    v_and_b32 v160, -2, v160
    buffer_store_dwordx4 v[160:163], v5, s[16:19], s30 offen sc1
    v_fmac_f32 v14, v211, v211
    v_fmac_f32 v13, v212, v212
    v_fmac_f32 v14, v213, v213
    v_fmac_f32 v13, v214, v214
    v_fmac_f32 v14, v215, v215
    s_add_u32 s30, s30, 131072
    s_waitcnt lgkmcnt(2)
    v_mfma_f32_16x16x32_bf16 v[192:195], v[88:91], v[132:135], 0
    v_cvt_pk_bf16_f32 v168, v224, v225
    v_cvt_pk_bf16_f32 v169, v226, v227
    v_cvt_pk_bf16_f32 v170, v228, v229
    v_mfma_f32_16x16x32_bf16 v[196:199], v[92:95], v[132:135], 0
    v_cvt_pk_bf16_f32 v171, v230, v231
    v_fmac_f32 v13, v224, v224
    v_fmac_f32 v14, v225, v225
    v_mov_b32_dpp v172, v170 row_ror:8 row_mask:0xf bank_mask:0xf
    v_mov_b32_dpp v173, v171 row_ror:8 row_mask:0xf bank_mask:0xf
    v_mov_b32_dpp v170, v168 row_ror:8 row_mask:0xf bank_mask:0x3
    v_mov_b32_dpp v171, v169 row_ror:8 row_mask:0xf bank_mask:0x3
    v_fmac_f32 v13, v226, v226
    v_mov_b32_dpp v168, v172 quad_perm:[0,1,2,3] row_mask:0xf bank_mask:0xc
    v_mov_b32_dpp v169, v173 quad_perm:[0,1,2,3] row_mask:0xf bank_mask:0xc
    v_and_b32 v168, -2, v168
    buffer_store_dwordx4 v[168:171], v5, s[16:19], s30 offen sc1
    v_fmac_f32 v14, v227, v227
    v_fmac_f32 v13, v228, v228
    v_fmac_f32 v14, v229, v229
    v_fmac_f32 v13, v230, v230
    v_fmac_f32 v14, v231, v231
    s_add_u32 s30, s30, 131072
    s_waitcnt lgkmcnt(1)
    v_mfma_f32_16x16x32_bf16 v[208:211], v[96:99], v[136:139], 0
    v_cvt_pk_bf16_f32 v144, v176, v177
    v_cvt_pk_bf16_f32 v145, v178, v179
    v_cvt_pk_bf16_f32 v146, v180, v181
    v_mfma_f32_16x16x32_bf16 v[212:215], v[100:103], v[136:139], 0
    v_cvt_pk_bf16_f32 v147, v182, v183
    v_fmac_f32 v13, v176, v176
    v_fmac_f32 v14, v177, v177
    v_mov_b32_dpp v148, v146 row_ror:8 row_mask:0xf bank_mask:0xf
    v_mov_b32_dpp v149, v147 row_ror:8 row_mask:0xf bank_mask:0xf
    v_mov_b32_dpp v146, v144 row_ror:8 row_mask:0xf bank_mask:0x3
    v_mov_b32_dpp v147, v145 row_ror:8 row_mask:0xf bank_mask:0x3
    v_fmac_f32 v13, v178, v178
    v_mov_b32_dpp v144, v148 quad_perm:[0,1,2,3] row_mask:0xf bank_mask:0xc
    v_mov_b32_dpp v145, v149 quad_perm:[0,1,2,3] row_mask:0xf bank_mask:0xc
    v_and_b32 v144, -2, v144
    buffer_store_dwordx4 v[144:147], v5, s[16:19], s30 offen sc1
    v_fmac_f32 v14, v179, v179
    v_fmac_f32 v13, v180, v180
    v_fmac_f32 v14, v181, v181
    v_fmac_f32 v13, v182, v182
    v_fmac_f32 v14, v183, v183
    s_add_u32 s30, s30, 131072
    s_waitcnt lgkmcnt(0)
    v_mfma_f32_16x16x32_bf16 v[224:227], v[104:107], v[140:143], 0
    v_cvt_pk_bf16_f32 v152, v192, v193
    v_cvt_pk_bf16_f32 v153, v194, v195
    v_cvt_pk_bf16_f32 v154, v196, v197
    v_mfma_f32_16x16x32_bf16 v[228:231], v[108:111], v[140:143], 0
    v_cvt_pk_bf16_f32 v155, v198, v199
    v_fmac_f32 v13, v192, v192
    v_fmac_f32 v14, v193, v193
    v_mov_b32_dpp v156, v154 row_ror:8 row_mask:0xf bank_mask:0xf
    v_mov_b32_dpp v157, v155 row_ror:8 row_mask:0xf bank_mask:0xf
    v_mov_b32_dpp v154, v152 row_ror:8 row_mask:0xf bank_mask:0x3
    v_mov_b32_dpp v155, v153 row_ror:8 row_mask:0xf bank_mask:0x3
    v_fmac_f32 v13, v194, v194
    v_mov_b32_dpp v152, v156 quad_perm:[0,1,2,3] row_mask:0xf bank_mask:0xc
    v_mov_b32_dpp v153, v157 quad_perm:[0,1,2,3] row_mask:0xf bank_mask:0xc
    v_and_b32 v152, -2, v152
    buffer_store_dwordx4 v[152:155], v5, s[16:19], s30 offen sc1
    v_fmac_f32 v14, v195, v195
    v_fmac_f32 v13, v196, v196
    v_fmac_f32 v14, v197, v197
    v_fmac_f32 v13, v198, v198
    v_fmac_f32 v14, v199, v199
    s_add_u32 s30, s30, 131072
    v_cvt_pk_bf16_f32 v160, v208, v209
    v_cvt_pk_bf16_f32 v161, v210, v211
    v_cvt_pk_bf16_f32 v162, v212, v213
    v_cvt_pk_bf16_f32 v163, v214, v215
    v_fmac_f32 v13, v208, v208
    v_fmac_f32 v14, v209, v209
    v_mov_b32_dpp v164, v162 row_ror:8 row_mask:0xf bank_mask:0xf
    v_mov_b32_dpp v165, v163 row_ror:8 row_mask:0xf bank_mask:0xf
    v_mov_b32_dpp v162, v160 row_ror:8 row_mask:0xf bank_mask:0x3
    v_mov_b32_dpp v163, v161 row_ror:8 row_mask:0xf bank_mask:0x3
    v_fmac_f32 v13, v210, v210
    v_mov_b32_dpp v160, v164 quad_perm:[0,1,2,3] row_mask:0xf bank_mask:0xc
    v_mov_b32_dpp v161, v165 quad_perm:[0,1,2,3] row_mask:0xf bank_mask:0xc
    v_and_b32 v160, -2, v160
    buffer_store_dwordx4 v[160:163], v5, s[16:19], s30 offen sc1
    v_fmac_f32 v14, v211, v211
    v_fmac_f32 v13, v212, v212
    v_fmac_f32 v14, v213, v213
    v_fmac_f32 v13, v214, v214
    v_fmac_f32 v14, v215, v215
    s_add_u32 s30, s30, 131072
    v_cvt_pk_bf16_f32 v168, v224, v225
    v_cvt_pk_bf16_f32 v169, v226, v227
    v_cvt_pk_bf16_f32 v170, v228, v229
    v_cvt_pk_bf16_f32 v171, v230, v231
    v_fmac_f32 v13, v224, v224
    v_fmac_f32 v14, v225, v225
    v_mov_b32_dpp v172, v170 row_ror:8 row_mask:0xf bank_mask:0xf
    v_mov_b32_dpp v173, v171 row_ror:8 row_mask:0xf bank_mask:0xf
    v_mov_b32_dpp v170, v168 row_ror:8 row_mask:0xf bank_mask:0x3
    v_mov_b32_dpp v171, v169 row_ror:8 row_mask:0xf bank_mask:0x3
    v_fmac_f32 v13, v226, v226
    v_mov_b32_dpp v168, v172 quad_perm:[0,1,2,3] row_mask:0xf bank_mask:0xc
    v_mov_b32_dpp v169, v173 quad_perm:[0,1,2,3] row_mask:0xf bank_mask:0xc
    v_and_b32 v168, -2, v168
    buffer_store_dwordx4 v[168:171], v5, s[16:19], s30 offen sc1
    v_fmac_f32 v14, v227, v227
    v_fmac_f32 v13, v228, v228
    v_fmac_f32 v14, v229, v229
    v_fmac_f32 v13, v230, v230
    v_fmac_f32 v14, v231, v231
    s_add_u32 s30, s30, 131072
    v_add_f32 v13, v13, v14
    v_mov_b32 v14, v13
    s_nop 1
    v_permlane32_swap_b32 v13, v14
    v_add_f32 v13, v13, v14
    v_mov_b32 v14, v13
    s_nop 1
    v_permlane16_swap_b32 v13, v14
    v_add_f32 v13, v13, v14
    v_lshlrev_b32 v14, 2, v2
    s_lshl_b32 s9, s10, 7
    s_add_u32 s9, s9, 107520
    v_add_u32 v10, s9, v14
    ds_write_b32 v10, v13
    s_waitcnt lgkmcnt(0)
    s_barrier
    s_cmp_lg_u32 s10, 0
    s_cbranch_scc1 main_kernel_xc_done
    ds_read_b32 v121, v10 offset:128
    ds_read_b32 v122, v10 offset:256
    ds_read_b32 v123, v10 offset:384
    s_lshl_b32 s9, s3, 7
    s_add_u32 s9, s9, 27262976
    v_and_b32 v14, 7, v2
    v_lshlrev_b32 v14, 4, v14
    v_add_u32 v14, v14, v8
    s_mov_b64 exec, 0xffff
    s_mov_b32 s20, 0xa7c6
    s_mov_b32 s21, 0x42900000
    s_waitcnt lgkmcnt(0)
    v_add_f32 v13, v13, v121
    v_add_f32 v122, v122, v123
    v_add_f32 v13, v13, v122
    v_mul_f32 v13, 0x45800000, v13
    v_cvt_f64_f32 v[124:125], v13
    v_add_f64 v[124:125], v[124:125], s[20:21]
    buffer_store_dwordx2 v[124:125], v14, s[16:19], s9 offen sc1
    s_mov_b64 exec, -1
main_kernel_xc_done:
    s_waitcnt vmcnt(11)
    buffer_load_dword v6, off, s[16:19], s55 sc1
    s_getpc_b64 s[32:33]
    s_add_u32 s32, s32, tab_k2@rel32@lo+4
    s_addc_u32 s33, s33, tab_k2@rel32@hi+12
    s_mov_b32 s34, 147456
    s_mov_b32 s35, 0x20000
    s_mul_i32 s31, s10, 10240
    s_add_u32 m0, s31, 122880
    s_add_u32 s30, s31, 0
    buffer_load_dwordx4 v4, s[32:35], s30 offen offset:0 lds
    buffer_load_dwordx4 v4, s[32:35], s30 offen offset:1024 lds
    buffer_load_dwordx4 v4, s[32:35], s30 offen offset:2048 lds
    buffer_load_dwordx4 v4, s[32:35], s30 offen offset:3072 lds
    s_add_u32 m0, s31, 126976
    s_add_u32 s30, s31, 4096
    buffer_load_dwordx4 v4, s[32:35], s30 offen offset:0 lds
    buffer_load_dwordx4 v4, s[32:35], s30 offen offset:1024 lds
    buffer_load_dwordx4 v4, s[32:35], s30 offen offset:2048 lds
    buffer_load_dwordx4 v4, s[32:35], s30 offen offset:3072 lds
    s_add_u32 m0, s31, 131072
    s_add_u32 s30, s31, 8192
    buffer_load_dwordx4 v4, s[32:35], s30 offen offset:0 lds
    buffer_load_dwordx4 v4, s[32:35], s30 offen offset:1024 lds
    s_waitcnt vmcnt(10)
    s_barrier
    v_readfirstlane_b32 s9, v6
    v_mov_b32 v7, 1
    s_cmp_eq_u32 s9, 0
    s_cbranch_scc1 main_kernel_msC
main_kernel_mbC:
    buffer_store_dword v7, v15, s[16:19], s68 offen sc1
    s_call_b64 s[90:91], main_kernel_visit0
    s_waitcnt vmcnt(1)
    s_barrier
    v_add_u32 v14, 122880, v4
    ds_read_b128 a[96:99], v14 offset:0
    ds_read_b128 a[100:103], v14 offset:1024
    ds_read_b128 a[104:107], v14 offset:2048
    ds_read_b128 a[108:111], v14 offset:3072
    ds_read_b128 a[112:115], v14 offset:4096
    ds_read_b128 a[116:119], v14 offset:5120
    ds_read_b128 a[120:123], v14 offset:6144
    ds_read_b128 a[124:127], v14 offset:7168
    ds_read_b128 a[128:131], v14 offset:8192
    ds_read_b128 a[132:135], v14 offset:9216
    ds_read_b128 a[136:139], v14 offset:10240
    ds_read_b128 a[140:143], v14 offset:11264
    ds_read_b128 a[144:147], v14 offset:12288
    ds_read_b128 a[148:151], v14 offset:13312
    ds_read_b128 a[152:155], v14 offset:14336
    ds_read_b128 a[156:159], v14 offset:15360
    ds_read_b128 a[160:163], v14 offset:16384
    ds_read_b128 a[164:167], v14 offset:17408
    ds_read_b128 a[168:171], v14 offset:18432
    ds_read_b128 a[172:175], v14 offset:19456
    ds_read_b128 a[176:179], v14 offset:20480
    ds_read_b128 a[180:183], v14 offset:21504
    ds_read_b128 a[184:187], v14 offset:22528
    ds_read_b128 a[188:191], v14 offset:23552
    ds_read_b128 a[192:195], v14 offset:24576
    ds_read_b128 a[196:199], v14 offset:25600
    ds_read_b128 a[200:203], v14 offset:26624
    ds_read_b128 a[204:207], v14 offset:27648
    ds_read_b128 a[208:211], v14 offset:28672
    ds_read_b128 a[212:215], v14 offset:29696
    ds_read_b128 a[216:219], v14 offset:30720
    ds_read_b128 a[220:223], v14 offset:31744
    ds_read_b128 a[224:227], v14 offset:32768
    ds_read_b128 a[228:231], v14 offset:33792
    ds_read_b128 a[232:235], v14 offset:34816
    ds_read_b128 a[236:239], v14 offset:35840
    ds_read_b128 a[240:243], v14 offset:36864
    ds_read_b128 a[244:247], v14 offset:37888
    ds_read_b128 a[248:251], v14 offset:38912
    ds_read_b128 a[252:255], v14 offset:39936
    s_call_b64 s[90:91], main_kernel_visit1
    s_sleep 50
    s_mov_b32 s9, 27459584
    v_lshlrev_b32 v253, 6, v0
    buffer_load_dword v252, v253, s[16:19], s9 offen sc1
    s_mov_b32 s67, 0x80000000
    s_mov_b32 s66, 0
    s_waitcnt vmcnt(0)
    s_branch main_kernel_schk
main_kernel_msA:
    buffer_load_dword v6, off, s[16:19], s55 sc1
    s_add_u32 s69, s69, 1
    s_waitcnt vmcnt(0)
    v_readfirstlane_b32 s9, v6
    s_nop 0
    s_cmp_lg_u32 s9, 0
    s_cbranch_scc1 main_kernel_mbA
    s_cmp_lt_u32 s69, 32768
    s_cbranch_scc1 main_kernel_msA
    s_branch main_kernel_mbA
main_kernel_msB:
    buffer_load_dword v6, off, s[16:19], s55 sc1
    s_add_u32 s69, s69, 1
    s_waitcnt vmcnt(0)
    v_readfirstlane_b32 s9, v6
    s_nop 0
    s_cmp_lg_u32 s9, 0
    s_cbranch_scc1 main_kernel_mbB
    s_cmp_lt_u32 s69, 32768
    s_cbranch_scc1 main_kernel_msB
    s_branch main_kernel_mbB
main_kernel_msC:
    buffer_load_dword v6, off, s[16:19], s55 sc1
    s_add_u32 s69, s69, 1
    s_waitcnt vmcnt(0)
    v_readfirstlane_b32 s9, v6
    s_nop 0
    s_cmp_lg_u32 s9, 0
    s_cbranch_scc1 main_kernel_mbC
    s_cmp_lt_u32 s69, 32768
    s_cbranch_scc1 main_kernel_msC
    s_branch main_kernel_mbC
main_kernel_msD:
    buffer_load_dword v6, off, s[16:19], s55 sc1
    s_add_u32 s69, s69, 1
    s_waitcnt vmcnt(0)
    v_readfirstlane_b32 s9, v6
    s_nop 0
    s_cmp_lg_u32 s9, 0
    s_cbranch_scc1 main_kernel_mbD
    s_cmp_lt_u32 s69, 32768
    s_cbranch_scc1 main_kernel_msD
    s_branch main_kernel_mbD
main_kernel_sslow:
    s_mov_b64 exec, vcc
    v_mov_b32 v244, 1
    v_lshlrev_b32 v245, 4, v0
    s_and_b32 s9, s69, 1
    s_cselect_b32 s8, 0x80000000, s67
    buffer_store_dword v244, v245, s[16:19], s8 offen sc1
    s_cmp_eq_u32 s66, 0
    s_mov_b32 s66, 1
    s_cbranch_scc1 main_kernel_nsl
    s_sleep 12
main_kernel_nsl:
    s_mov_b32 s9, 27459584
    buffer_load_dword v252, v253, s[16:19], s9 offen sc1
    s_add_u32 s69, s69, 1
    s_waitcnt vmcnt(0)
    s_cmp_lt_u32 s69, 32768
    s_cbranch_scc1 main_kernel_schk
    s_branch main_kernel_join
main_kernel_rD:
    s_sub_u32 s3, s2, 128
    s_sub_u32 s29, s2, 224
    v_lshrrev_b32 v7, 6, v0
    v_and_b32 v1, 63, v0
    v_readfirstlane_b32 s10, v7
    v_lshlrev_b32 v4, 4, v1
    v_mov_b32 v244, 1
    v_mov_b32 v245, 1
    v_mov_b32 v246, 1
    v_mov_b32 v247, 1
    v_lshlrev_b32 v254, 4, v0
    s_waitcnt lgkmcnt(0)
    s_mov_b32 s16, s4
    s_mov_b32 s17, s5
    s_mov_b32 s18, 268435456
    s_mov_b32 s19, 0x20000
    s_cmp_eq_u32 s2, 240
    s_mov_b32 s67, 0x80000000
    s_mov_b32 s66, 0
    s_cselect_b32 s67, 27492352, s67
    v_mov_b32 v6, 0
    buffer_store_dword v6, v15, s[16:19], s55 offen sc1
    s_and_b32 s52, s3, 3
    s_lshr_b32 s53, s3, 2
    s_lshr_b32 s8, s53, 4
    s_lshl_b32 s8, s8, 4
    s_and_b32 s9, s53, 15
    s_lshl_b32 s9, s9, 7
    s_add_u32 s8, s8, s9
    s_lshl_b32 s9, s52, 2
    s_add_u32 s8, s8, s9
    s_mul_i32 s40, s8, 1026
    s_and_b32 s54, s40, 15
    s_mul_i32 s9, s10, 32832
    s_add_u32 s40, s40, s9
    s_and_b32 s40, s40, -16
    s_add_u32 s41, s40, 4096
    s_mul_i32 s42, s10, 5120
    s_add_u32 s42, s42, 66560
    s_mov_b32 s34, 2101248
    s_mov_b32 s35, 0x20000
    s_mov_b32 s46, 2101248
    s_mov_b32 s47, 0x20000
    s_mov_b32 s32, s62
    s_mov_b32 s33, s63
    s_mov_b32 s44, s64
    s_mov_b32 s45, s65
    s_add_u32 m0, s42, 0
    s_nop 0
    buffer_load_dwordx4 v4, s[32:35], s40 offen offset:0 lds
    buffer_load_dwordx4 v4, s[32:35], s40 offen offset:1024 lds
    buffer_load_dwordx4 v4, s[32:35], s40 offen offset:2048 lds
    buffer_load_dwordx4 v4, s[32:35], s40 offen offset:3072 lds
    s_add_u32 m0, s42, 20480
    s_nop 0
    buffer_load_dwordx4 v4, s[44:47], s40 offen offset:0 lds
    buffer_load_dwordx4 v4, s[44:47], s40 offen offset:1024 lds
    buffer_load_dwordx4 v4, s[44:47], s40 offen offset:2048 lds
    buffer_load_dwordx4 v4, s[44:47], s40 offen offset:3072 lds
    s_mov_b64 exec, 3
    s_add_u32 m0, s42, 4096
    s_nop 0
    buffer_load_dwordx4 v4, s[32:35], s41 offen lds
    s_add_u32 m0, s42, 24576
    s_nop 0
    buffer_load_dwordx4 v4, s[44:47], s41 offen lds
    s_mov_b64 exec, -1
    v_mov_b32 v232, 0
    v_mov_b32 v236, 0x88e368f1
    v_mov_b32 v233, 0
    v_mov_b32 v237, 0x4044f8b5
    v_mov_b32 v234, 0
    v_mov_b32 v238, 0x88e368f1
    v_mov_b32 v235, 0
    v_mov_b32 v239, 0x4044f8b5
    v_lshlrev_b32 v231, 4, v0
    s_lshl_b32 s51, s29, 12
    s_add_u32 s48, s51, 27328512
    s_add_u32 s50, s51, 45154304
    s_add_u32 s49, s51, 45088768
    s_add_u32 s51, s51, 27246592
    s_cmp_lt_u32 s29, 8
    s_cselect_b32 s49, s49, s51
    s_cmp_lt_u32 s29, 12
    s_cselect_b32 s49, s49, 0x80000000
    buffer_store_dwordx4 v[232:235], v231, s[16:19], s48 offen sc1
    buffer_store_dwordx4 v[232:235], v231, s[16:19], s50 offen sc1
    buffer_store_dwordx4 v[236:239], v231, s[16:19], s49 offen sc1
    v_and_b32 v112, 3, v1
    v_lshrrev_b32 v113, 2, v1
    v_mul_u32_u24 v116, 1026, v112
    v_lshl_add_u32 v116, v113, 4, v116
    s_lshl_b32 s9, s10, 8
    s_add_u32 s9, s9, s54
    s_add_u32 s9, s9, 66562
    v_add_u32 v116, s9, v116
    v_and_b32 v114, 2, v116
    v_lshlrev_b32 v114, 3, v114
    v_and_b32 v116, -4, v116
    s_lshl_b32 s30, s53, 17
    s_lshl_b32 s9, s10, 13
    s_add_u32 s30, s30, s9
    s_lshl_b32 s9, s52, 15
    s_add_u32 s30, s30, s9
    s_add_u32 s30, s30, 23068672
    s_add_u32 s31, s30, 4096
    v_lshrrev_b32 v115, 2, v113
    v_lshlrev_b32 v115, 13, v115
    v_and_b32 v113, 3, v113
    v_lshl_add_u32 v115, v113, 8, v115
    v_lshl_add_u32 v115, v112, 4, v115
    s_mov_b32 s40, 0x05040100
    s_mov_b32 s41, 0x07060302
    s_waitcnt vmcnt(13)
    s_barrier
    buffer_store_dwordx4 v[244:247], v254, s[16:19], s67 offen sc1
    s_waitcnt vmcnt(4)
    s_barrier
    ds_read_b32 v128, v116 offset:0
    ds_read_b32 v129, v116 offset:4
    ds_read_b32 v130, v116 offset:8
    ds_read_b32 v131, v116 offset:12
    ds_read_b32 v132, v116 offset:16
    ds_read_b32 v152, v116 offset:20480
    ds_read_b32 v153, v116 offset:20484
    ds_read_b32 v154, v116 offset:20488
    ds_read_b32 v155, v116 offset:20492
    ds_read_b32 v156, v116 offset:20496
    ds_read_b32 v134, v116 offset:5120
    ds_read_b32 v135, v116 offset:5124
    ds_read_b32 v136, v116 offset:5128
    ds_read_b32 v137, v116 offset:5132
    ds_read_b32 v138, v116 offset:5136
    s_waitcnt lgkmcnt(10)
    ds_read_b32 v158, v116 offset:25600
    ds_read_b32 v159, v116 offset:25604
    ds_read_b32 v160, v116 offset:25608
    ds_read_b32 v161, v116 offset:25612
    ds_read_b32 v162, v116 offset:25616
    v_alignbit_b32 v128, v129, v128, v114
    v_alignbit_b32 v129, v130, v129, v114
    v_alignbit_b32 v130, v131, v130, v114
    v_alignbit_b32 v131, v132, v131, v114
    s_waitcnt lgkmcnt(10)
    ds_read_b32 v140, v116 offset:10240
    ds_read_b32 v141, v116 offset:10244
    ds_read_b32 v142, v116 offset:10248
    ds_read_b32 v143, v116 offset:10252
    ds_read_b32 v144, v116 offset:10256
    v_alignbit_b32 v152, v153, v152, v114
    v_alignbit_b32 v153, v154, v153, v114
    v_alignbit_b32 v154, v155, v154, v114
    v_alignbit_b32 v155, v156, v155, v114
    s_waitcnt lgkmcnt(10)
    ds_read_b32 v164, v116 offset:30720
    ds_read_b32 v165, v116 offset:30724
    ds_read_b32 v166, v116 offset:30728
    ds_read_b32 v167, v116 offset:30732
    ds_read_b32 v168, v116 offset:30736
    v_alignbit_b32 v134, v135, v134, v114
    v_alignbit_b32 v135, v136, v135, v114
    v_alignbit_b32 v136, v137, v136, v114
    v_alignbit_b32 v137, v138, v137, v114
    s_waitcnt lgkmcnt(10)
    ds_read_b32 v146, v116 offset:15360
    ds_read_b32 v147, v116 offset:15364
    ds_read_b32 v148, v116 offset:15368
    ds_read_b32 v149, v116 offset:15372
    ds_read_b32 v150, v116 offset:15376
    v_alignbit_b32 v158, v159, v158, v114
    v_alignbit_b32 v159, v160, v159, v114
    v_alignbit_b32 v160, v161, v160, v114
    v_alignbit_b32 v161, v162, v161, v114
    s_waitcnt lgkmcnt(10)
    ds_read_b32 v170, v116 offset:35840
    ds_read_b32 v171, v116 offset:35844
    ds_read_b32 v172, v116 offset:35848
    ds_read_b32 v173, v116 offset:35852
    ds_read_b32 v174, v116 offset:35856
    v_alignbit_b32 v140, v141, v140, v114
    v_alignbit_b32 v141, v142, v141, v114
    v_alignbit_b32 v142, v143, v142, v114
    v_alignbit_b32 v143, v144, v143, v114
    s_waitcnt lgkmcnt(10)
    v_alignbit_b32 v164, v165, v164, v114
    v_alignbit_b32 v165, v166, v165, v114
    v_alignbit_b32 v166, v167, v166, v114
    v_alignbit_b32 v167, v168, v167, v114
    s_waitcnt lgkmcnt(5)
    v_alignbit_b32 v146, v147, v146, v114
    v_alignbit_b32 v147, v148, v147, v114
    v_alignbit_b32 v148, v149, v148, v114
    v_alignbit_b32 v149, v150, v149, v114
    s_waitcnt lgkmcnt(0)
    v_alignbit_b32 v170, v171, v170, v114
    v_alignbit_b32 v171, v172, v171, v114
    v_alignbit_b32 v172, v173, v172, v114
    v_alignbit_b32 v173, v174, v173, v114
    v_perm_b32 v176, v152, v128, s40
    v_perm_b32 v177, v158, v134, s40
    v_perm_b32 v178, v164, v140, s40
    v_perm_b32 v179, v170, v146, s40
    buffer_store_dwordx4 v[176:179], v4, s[16:19], s30 offen offset:0 sc1
    v_perm_b32 v180, v152, v128, s41
    v_perm_b32 v181, v158, v134, s41
    v_perm_b32 v182, v164, v140, s41
    v_perm_b32 v183, v170, v146, s41
    buffer_store_dwordx4 v[180:183], v4, s[16:19], s30 offen offset:1024 sc1
    v_perm_b32 v184, v153, v129, s40
    v_perm_b32 v185, v159, v135, s40
    v_perm_b32 v186, v165, v141, s40
    v_perm_b32 v187, v171, v147, s40
    buffer_store_dwordx4 v[184:187], v4, s[16:19], s30 offen offset:2048 sc1
    v_perm_b32 v188, v153, v129, s41
    v_perm_b32 v189, v159, v135, s41
    v_perm_b32 v190, v165, v141, s41
    v_perm_b32 v191, v171, v147, s41
    buffer_store_dwordx4 v[188:191], v4, s[16:19], s30 offen offset:3072 sc1
    v_perm_b32 v192, v154, v130, s40
    v_perm_b32 v193, v160, v136, s40
    v_perm_b32 v194, v166, v142, s40
    v_perm_b32 v195, v172, v148, s40
    buffer_store_dwordx4 v[192:195], v4, s[16:19], s31 offen offset:0 sc1
    v_perm_b32 v196, v154, v130, s41
    v_perm_b32 v197, v160, v136, s41
    v_perm_b32 v198, v166, v142, s41
    v_perm_b32 v199, v172, v148, s41
    buffer_store_dwordx4 v[196:199], v4, s[16:19], s31 offen offset:1024 sc1
    v_perm_b32 v200, v155, v131, s40
    v_perm_b32 v201, v161, v137, s40
    v_perm_b32 v202, v167, v143, s40
    v_perm_b32 v203, v173, v149, s40
    buffer_store_dwordx4 v[200:203], v4, s[16:19], s31 offen offset:2048 sc1
    v_perm_b32 v204, v155, v131, s41
    v_perm_b32 v205, v161, v137, s41
    v_perm_b32 v206, v167, v143, s41
    v_perm_b32 v207, v173, v149, s41
    buffer_store_dwordx4 v[204:207], v4, s[16:19], s31 offen offset:3072 sc1
    buffer_store_dwordx4 v[244:247], v254, s[16:19], s67 offen sc1
    buffer_load_dword v6, off, s[16:19], s55 sc1
    s_getpc_b64 s[32:33]
    s_add_u32 s32, s32, tab_k2@rel32@lo+4
    s_addc_u32 s33, s33, tab_k2@rel32@hi+12
    s_mov_b32 s34, 147456
    s_mov_b32 s35, 0x20000
    s_mul_i32 s31, s10, 10240
    s_add_u32 m0, s31, 122880
    s_add_u32 s30, s31, 0
    buffer_load_dwordx4 v4, s[32:35], s30 offen offset:0 lds
    buffer_load_dwordx4 v4, s[32:35], s30 offen offset:1024 lds
    buffer_load_dwordx4 v4, s[32:35], s30 offen offset:2048 lds
    buffer_load_dwordx4 v4, s[32:35], s30 offen offset:3072 lds
    s_add_u32 m0, s31, 126976
    s_add_u32 s30, s31, 4096
    buffer_load_dwordx4 v4, s[32:35], s30 offen offset:0 lds
    buffer_load_dwordx4 v4, s[32:35], s30 offen offset:1024 lds
    buffer_load_dwordx4 v4, s[32:35], s30 offen offset:2048 lds
    buffer_load_dwordx4 v4, s[32:35], s30 offen offset:3072 lds
    s_add_u32 m0, s31, 131072
    s_add_u32 s30, s31, 8192
    buffer_load_dwordx4 v4, s[32:35], s30 offen offset:0 lds
    buffer_load_dwordx4 v4, s[32:35], s30 offen offset:1024 lds
    s_waitcnt vmcnt(10)
    s_barrier
    v_readfirstlane_b32 s9, v6
    v_mov_b32 v7, 1
    s_cmp_eq_u32 s9, 0
    s_cbranch_scc1 main_kernel_msD
main_kernel_mbD:
    buffer_store_dword v7, v15, s[16:19], s68 offen sc1
    buffer_store_dwordx4 v[244:247], v254, s[16:19], s67 offen sc1
    s_call_b64 s[90:91], main_kernel_visit0
    s_waitcnt vmcnt(2)
    s_barrier
    v_add_u32 v14, 122880, v4
    ds_read_b128 a[96:99], v14 offset:0
    ds_read_b128 a[100:103], v14 offset:1024
    ds_read_b128 a[104:107], v14 offset:2048
    ds_read_b128 a[108:111], v14 offset:3072
    ds_read_b128 a[112:115], v14 offset:4096
    ds_read_b128 a[116:119], v14 offset:5120
    ds_read_b128 a[120:123], v14 offset:6144
    ds_read_b128 a[124:127], v14 offset:7168
    ds_read_b128 a[128:131], v14 offset:8192
    ds_read_b128 a[132:135], v14 offset:9216
    ds_read_b128 a[136:139], v14 offset:10240
    ds_read_b128 a[140:143], v14 offset:11264
    ds_read_b128 a[144:147], v14 offset:12288
    ds_read_b128 a[148:151], v14 offset:13312
    ds_read_b128 a[152:155], v14 offset:14336
    ds_read_b128 a[156:159], v14 offset:15360
    ds_read_b128 a[160:163], v14 offset:16384
    ds_read_b128 a[164:167], v14 offset:17408
    ds_read_b128 a[168:171], v14 offset:18432
    ds_read_b128 a[172:175], v14 offset:19456
    ds_read_b128 a[176:179], v14 offset:20480
    ds_read_b128 a[180:183], v14 offset:21504
    ds_read_b128 a[184:187], v14 offset:22528
    ds_read_b128 a[188:191], v14 offset:23552
    ds_read_b128 a[192:195], v14 offset:24576
    ds_read_b128 a[196:199], v14 offset:25600
    ds_read_b128 a[200:203], v14 offset:26624
    ds_read_b128 a[204:207], v14 offset:27648
    ds_read_b128 a[208:211], v14 offset:28672
    ds_read_b128 a[212:215], v14 offset:29696
    ds_read_b128 a[216:219], v14 offset:30720
    ds_read_b128 a[220:223], v14 offset:31744
    ds_read_b128 a[224:227], v14 offset:32768
    ds_read_b128 a[228:231], v14 offset:33792
    ds_read_b128 a[232:235], v14 offset:34816
    ds_read_b128 a[236:239], v14 offset:35840
    ds_read_b128 a[240:243], v14 offset:36864
    ds_read_b128 a[244:247], v14 offset:37888
    ds_read_b128 a[248:251], v14 offset:38912
    ds_read_b128 a[252:255], v14 offset:39936
    buffer_store_dwordx4 v[244:247], v254, s[16:19], s67 offen sc1
    s_call_b64 s[90:91], main_kernel_visit1
    s_sleep 60
    s_mov_b32 s9, 27459584
    v_lshlrev_b32 v253, 6, v0
    buffer_load_dword v252, v253, s[16:19], s9 offen sc1
    s_waitcnt vmcnt(0)
main_kernel_schk:
    v_cmp_eq_u32 vcc, 0, v252
    s_nop 0
    s_cbranch_vccnz main_kernel_sslow
main_kernel_join:
    s_mov_b64 exec, -1
    s_barrier
    s_load_dwordx2 s[64:65], s[0:1], 48
    s_getpc_b64 s[60:61]
    s_add_u32 s60, s60, tab_k2@rel32@lo+4
    s_addc_u32 s61, s61, tab_k2@rel32@hi+12
    s_mov_b32 s62, 147456
    s_mov_b32 s63, 0x20000
    v_lshrrev_b32 v1, 6, v0
    v_and_b32 v2, 63, v0
    v_lshlrev_b32 v3, 4, v2
    v_readfirstlane_b32 s10, v1
    s_mov_b32 s12, 0
    s_mov_b32 s3, 0
    s_mov_b32 s48, 0
    s_mov_b64 s[66:67], -1
    s_mul_i32 s31, s10, 10240
    s_and_b32 s6, s2, 7
    s_lshl_b32 s26, s10, 11
    s_bfe_u32 s15, s2, 0x10003
    s_lshr_b32 s16, s2, 4
    s_lshl_b32 s16, s16, 3
    s_add_u32 s16, s16, s6
    s_lshr_b32 s17, s16, 2
    s_and_b32 s18, s16, 3
    s_lshl_b32 s17, s17, 17
    s_lshl_b32 s18, s18, 8
    s_add_u32 s17, s17, s18
    s_lshl_b32 s18, s15, 10
    s_add_u32 s18, s17, s18
    s_add_u32 s18, s18, s26
    s_add_u32 s40, s18, 0
    s_add_u32 s41, s18, 8192
    s_add_u32 s42, s18, 65536
    s_add_u32 s43, s18, 73728
    s_lshl_b32 s44, s10, 8
    s_add_u32 s44, s44, 27262976
    s_add_u32 s45, s44, 8192
    s_cmp_eq_u32 s2, 0
    s_cselect_b32 s46, 0, 1.0
    s_mov_b32 s47, s46
    v_bfe_u32 v186, v2, 4, 2
    v_and_b32 v187, 15, v2
    v_lshlrev_b32 v176, 14, v186
    v_lshl_add_u32 v176, v187, 4, v176
    v_lshlrev_b32 v177, 11, v186
    v_lshl_add_u32 v177, v187, 4, v177
    s_mov_b32 s20, s4
    s_mov_b32 s21, s5
    s_mov_b32 s22, 268435456
    s_mov_b32 s23, 0x20000
    buffer_load_dwordx4 v[16:19], v176, s[20:23], s40 offen sc1
    buffer_load_dwordx4 v[20:23], v176, s[20:23], s41 offen sc1
    buffer_load_dwordx4 v[24:27], v176, s[20:23], s42 offen sc1
    buffer_load_dwordx4 v[28:31], v176, s[20:23], s43 offen sc1
    buffer_load_dwordx4 v[32:35], v177, s[20:23], s44 offen offset:0 sc1
    buffer_load_dwordx4 v[36:39], v177, s[20:23], s44 offen offset:1024 sc1
    buffer_load_dwordx4 v[40:43], v177, s[20:23], s45 offen offset:0 sc1
    buffer_load_dwordx4 v[44:47], v177, s[20:23], s45 offen offset:1024 sc1
    s_lshl_b32 s17, s16, 2
    s_lshl_b32 s18, s15, 1
    s_add_u32 s17, s17, s18
    s_lshr_b32 s18, s10, 1
    s_add_u32 s17, s17, s18
    s_and_b32 s17, s17, 15
    s_lshr_b32 s16, s16, 2
    s_lshl_b32 s18, s17, 6
    s_add_u32 s19, s18, s16
    s_sub_u32 s15, 1024, s19
    s_sub_u32 s18, s18, 480
    s_cmp_eq_u32 s16, 0
    s_cselect_b32 s15, s18, s15
    s_cmp_lt_u32 s17, 8
    s_cselect_b32 s17, s19, s15
    s_cmp_eq_u32 s17, 0
    s_cselect_b32 s17, 512, s17
    s_sub_u32 s17, s17, 1
    s_and_b32 s18, s17, 7
    s_lshl_b32 s18, s18, 4
    s_bfe_u32 s19, s17, 0x40003
    s_and_b32 s17, s17, 0x180
    s_add_u32 s17, s17, s18
    s_add_u32 s17, s17, s19
    s_lshl_b32 s17, s17, 6
    s_and_b32 s18, s10, 1
    s_lshl_b32 s18, s18, 21
    s_add_u32 s17, s17, s18
    s_add_u32 s59, s17, 23068672
    v_lshrrev_b32 v190, 2, v2
    v_lshlrev_b32 v190, 15, v190
    v_and_b32 v191, 48, v3
    v_add_u32 v190, v190, v191
    s_add_u32 s28, s59, 0
    buffer_load_dwordx4 v[112:115], v190, s[20:23], s28 offen sc1
    s_add_u32 s29, s59, 524288
    buffer_load_dwordx4 v[116:119], v190, s[20:23], s29 offen sc1
    s_add_u32 s30, s59, 1048576
    buffer_load_dwordx4 v[120:123], v190, s[20:23], s30 offen sc1
    s_add_u32 s27, s59, 1572864
    buffer_load_dwordx4 v[124:127], v190, s[20:23], s27 offen sc1
    v_add_u32 v4, 0x10000, v3
    v_add_u32 v5, 0x20000, v3
    s_lshr_b32 s7, s2, 3
    s_lshr_b32 s8, s6, 1
    s_lshl_b32 s8, s8, 2
    s_lshr_b32 s9, s7, 3
    s_add_u32 s8, s8, s9
    s_and_b32 s9, s7, 7
    s_and_b32 s11, s6, 1
    s_lshl_b32 s13, s8, 13
    s_add_u32 s13, s13, s26
    s_lshl_b32 s14, s11, 3
    s_add_u32 s14, s14, s9
    s_mul_i32 s25, s14, 917504
    s_add_u32 s25, s25, 8388608
    s_lshl_b32 s57, s10, 12
    v_add_u32 v1, 0x30000, v3
    s_mov_b32 s38, 0
    s_mov_b32 s39, 0xc2900000
main_kernel_stub6:
    s_cbranch_execz main_kernel_ret
    v_mov_b32 v0, 0x80000000
    v_lshl_add_u32 v178, s10, 10, v3
    v_add_u32 v178, 147456, v178
    v_lshl_add_u32 v179, s10, 12, v3
    v_add_u32 v179, 147456, v179
    v_cvt_f32_u32 v180, v187
    v_mul_f32 v180, 0x3a000000, v180
    v_add_f32 v181, 0x3c000000, v180
    v_add_f32 v182, 0x3c000000, v181
    v_add_f32 v183, 0x3c000000, v182
    v_lshlrev_b32 v190, 2, v186
    v_lshl_add_u32 v191, s10, 4, v190
    v_and_b32 v190, 31, v191
    v_cvt_f32_u32 v191, v191
    v_cvt_f32_u32 v190, v190
    v_mul_f32 v72, v191, v180
    v_cos_f32 v64, v72
    v_sin_f32 v72, v72
    v_mul_f32 v76, v191, v181
    v_cos_f32 v68, v76
    v_sin_f32 v76, v76
    v_mul_f32 v96, v190, v180
    v_cos_f32 v80, v96
    v_sin_f32 v96, v96
    v_mul_f32 v100, v190, v181
    v_cos_f32 v84, v100
    v_sin_f32 v100, v100
    v_mul_f32 v104, v190, v182
    v_cos_f32 v88, v104
    v_sin_f32 v104, v104
    v_mul_f32 v108, v190, v183
    v_cos_f32 v92, v108
    v_sin_f32 v108, v108
    v_add_f32 v191, 1.0, v191
    v_add_f32 v190, 1.0, v190
    v_mul_f32 v73, v191, v180
    v_cos_f32 v65, v73
    v_sin_f32 v73, v73
    v_mul_f32 v77, v191, v181
    v_cos_f32 v69, v77
    v_sin_f32 v77, v77
    v_mul_f32 v97, v190, v180
    v_cos_f32 v81, v97
    v_sin_f32 v97, v97
    v_mul_f32 v101, v190, v181
    v_cos_f32 v85, v101
    v_sin_f32 v101, v101
    v_mul_f32 v105, v190, v182
    v_cos_f32 v89, v105
    v_sin_f32 v105, v105
    v_mul_f32 v109, v190, v183
    v_cos_f32 v93, v109
    v_sin_f32 v109, v109
    v_add_f32 v191, 1.0, v191
    v_add_f32 v190, 1.0, v190
    v_mul_f32 v74, v191, v180
    v_cos_f32 v66, v74
    v_sin_f32 v74, v74
    v_mul_f32 v78, v191, v181
    v_cos_f32 v70, v78
    v_sin_f32 v78, v78
    v_mul_f32 v98, v190, v180
    v_cos_f32 v82, v98
    v_sin_f32 v98, v98
    v_mul_f32 v102, v190, v181
    v_cos_f32 v86, v102
    v_sin_f32 v102, v102
    v_mul_f32 v106, v190, v182
    v_cos_f32 v90, v106
    v_sin_f32 v106, v106
    v_mul_f32 v110, v190, v183
    v_cos_f32 v94, v110
    v_sin_f32 v110, v110
    v_add_f32 v191, 1.0, v191
    v_add_f32 v190, 1.0, v190
    v_mul_f32 v75, v191, v180
    v_cos_f32 v67, v75
    v_sin_f32 v75, v75
    v_mul_f32 v79, v191, v181
    v_cos_f32 v71, v79
    v_sin_f32 v79, v79
    v_mul_f32 v99, v190, v180
    v_cos_f32 v83, v99
    v_sin_f32 v99, v99
    v_mul_f32 v103, v190, v181
    v_cos_f32 v87, v103
    v_sin_f32 v103, v103
    v_mul_f32 v107, v190, v182
    v_cos_f32 v91, v107
    v_sin_f32 v107, v107
    v_mul_f32 v111, v190, v183
    v_cos_f32 v95, v111
    v_sin_f32 v111, v111
    s_waitcnt vmcnt(8)
    s_waitcnt lgkmcnt(0)
    s_barrier
    v_mov_b32 v7, 1
    buffer_store_dword v7, v15, s[20:23], s68 offen offset:4 sc1
    v_lshlrev_b32 v160, 16, v16
    v_and_b32 v136, 0xffff0000, v16
    v_lshlrev_b32 v144, 16, v17
    v_and_b32 v152, 0xffff0000, v17
    v_lshlrev_b32 v161, 16, v18
    v_and_b32 v137, 0xffff0000, v18
    v_lshlrev_b32 v145, 16, v19
    v_and_b32 v153, 0xffff0000, v19
    v_lshlrev_b32 v162, 16, v20
    v_and_b32 v138, 0xffff0000, v20
    v_lshlrev_b32 v146, 16, v21
    v_and_b32 v154, 0xffff0000, v21
    v_lshlrev_b32 v163, 16, v22
    v_and_b32 v139, 0xffff0000, v22
    v_lshlrev_b32 v147, 16, v23
    v_and_b32 v155, 0xffff0000, v23
    v_lshlrev_b32 v164, 16, v24
    v_and_b32 v140, 0xffff0000, v24
    v_lshlrev_b32 v148, 16, v25
    v_and_b32 v156, 0xffff0000, v25
    v_lshlrev_b32 v165, 16, v26
    v_and_b32 v141, 0xffff0000, v26
    v_lshlrev_b32 v149, 16, v27
    v_and_b32 v157, 0xffff0000, v27
    v_lshlrev_b32 v166, 16, v28
    v_and_b32 v142, 0xffff0000, v28
    v_lshlrev_b32 v150, 16, v29
    v_and_b32 v158, 0xffff0000, v29
    v_lshlrev_b32 v167, 16, v30
    v_and_b32 v143, 0xffff0000, v30
    v_lshlrev_b32 v151, 16, v31
    v_and_b32 v159, 0xffff0000, v31
    s_waitcnt vmcnt(5)
main_kernel_k2body:
    v_add_f64 v[32:33], v[32:33], s[38:39]
    v_add_f64 v[34:35], v[34:35], s[38:39]
    v_add_f64 v[36:37], v[36:37], s[38:39]
    v_add_f64 v[38:39], v[38:39], s[38:39]
    v_add_f64 v[40:41], v[40:41], s[38:39]
    v_add_f64 v[42:43], v[42:43], s[38:39]
    v_add_f64 v[44:45], v[44:45], s[38:39]
    v_add_f64 v[46:47], v[46:47], s[38:39]
    v_cvt_f32_f64 v168, v[32:33]
    v_cvt_f32_f64 v169, v[34:35]
    v_cvt_f32_f64 v170, v[36:37]
    v_cvt_f32_f64 v171, v[38:39]
    v_cvt_f32_f64 v172, v[40:41]
    v_cvt_f32_f64 v173, v[42:43]
    v_cvt_f32_f64 v174, v[44:45]
    v_cvt_f32_f64 v175, v[46:47]
    v_rsq_f32 v168, v168
    v_rsq_f32 v169, v169
    v_rsq_f32 v170, v170
    v_rsq_f32 v171, v171
    v_rsq_f32 v172, v172
    v_rsq_f32 v173, v173
    v_rsq_f32 v174, v174
    v_rsq_f32 v175, v175
    v_pk_mul_f32 v[224:225], v[160:161], s[46:47]
    v_pk_mul_f32 v[226:227], v[162:163], s[46:47]
    v_pk_mul_f32 v[228:229], v[164:165], s[46:47]
    v_pk_mul_f32 v[230:231], v[166:167], s[46:47]
    v_pk_mul_f32 v[232:233], v[136:137], v[168:169]
    v_pk_mul_f32 v[224:225], v[224:225], v[168:169]
    v_pk_mul_f32 v[234:235], v[138:139], v[170:171]
    v_pk_mul_f32 v[226:227], v[226:227], v[170:171]
    v_pk_mul_f32 v[236:237], v[140:141], v[172:173]
    v_pk_mul_f32 v[228:229], v[228:229], v[172:173]
    v_pk_mul_f32 v[238:239], v[142:143], v[174:175]
    v_pk_mul_f32 v[230:231], v[230:231], v[174:175]
    v_pk_mul_f32 v[248:249], v[152:153], v[168:169]
    v_pk_mul_f32 v[240:241], v[144:145], v[168:169]
    v_pk_mul_f32 v[250:251], v[154:155], v[170:171]
    v_pk_mul_f32 v[242:243], v[146:147], v[170:171]
    v_pk_mul_f32 v[252:253], v[156:157], v[172:173]
    v_pk_mul_f32 v[244:245], v[148:149], v[172:173]
    v_pk_mul_f32 v[254:255], v[158:159], v[174:175]
    v_pk_mul_f32 v[246:247], v[150:151], v[174:175]
    v_cvt_pk_bf16_f32 v48, v224, v232
    v_cvt_pk_bf16_f32 v49, v225, v233
    v_cvt_pk_bf16_f32 v50, v226, v234
    v_cvt_pk_bf16_f32 v51, v227, v235
    v_cvt_pk_bf16_f32 v52, v228, v236
    v_cvt_pk_bf16_f32 v53, v229, v237
    v_cvt_pk_bf16_f32 v54, v230, v238
    v_cvt_pk_bf16_f32 v55, v231, v239
    s_waitcnt lgkmcnt(0)
    v_mfma_f32_16x16x32_bf16 v[192:195], v[48:51], a[96:99], 0
    v_cvt_pk_bf16_f32 v56, v240, v248
    v_cvt_pk_bf16_f32 v57, v241, v249
    v_mfma_f32_16x16x32_bf16 v[200:203], v[48:51], a[112:115], 0
    v_cvt_pk_bf16_f32 v58, v242, v250
    v_cvt_pk_bf16_f32 v59, v243, v251
    v_mfma_f32_16x16x32_bf16 v[192:195], v[52:55], a[100:103], v[192:195]
    v_cvt_pk_bf16_f32 v60, v244, v252
    v_cvt_pk_bf16_f32 v61, v245, v253
    v_mfma_f32_16x16x32_bf16 v[200:203], v[52:55], a[116:119], v[200:203]
    v_cvt_pk_bf16_f32 v62, v246, v254
    v_cvt_pk_bf16_f32 v63, v247, v255
    v_mfma_f32_16x16x32_bf16 v[196:199], v[48:51], a[104:107], 0
    s_add_u32 m0, s57, 0
    s_nop 0
    buffer_load_dwordx4 v0, s[20:23], m0 offen offset:0 sc1 lds
    v_mfma_f32_16x16x32_bf16 v[204:207], v[48:51], a[120:123], 0
    v_mfma_f32_16x16x32_bf16 v[196:199], v[52:55], a[108:111], v[196:199]
    v_mfma_f32_16x16x32_bf16 v[204:207], v[52:55], a[124:127], v[204:207]
    v_mfma_f32_16x16x32_bf16 v[208:211], v[56:59], a[96:99], 0
    v_mul_f32 v8, v192, v64
    v_mul_f32 v10, v200, v64
    v_mfma_f32_16x16x32_bf16 v[216:219], v[56:59], a[112:115], 0
    buffer_load_dwordx4 v0, s[20:23], m0 offen offset:1024 sc1 lds
    v_fma_f32 v8, v200, v72, v8
    v_fma_f32 v10, -v192, v72, v10
    v_cvt_pk_bf16_f32 v192, v8, v10
    v_mfma_f32_16x16x32_bf16 v[208:211], v[60:63], a[100:103], v[208:211]
    v_mul_f32 v12, v193, v65
    v_mul_f32 v14, v201, v65
    v_mfma_f32_16x16x32_bf16 v[216:219], v[60:63], a[116:119], v[216:219]
    v_fma_f32 v12, v201, v73, v12
    v_fma_f32 v14, -v193, v73, v14
    v_cvt_pk_bf16_f32 v193, v12, v14
    v_mfma_f32_16x16x32_bf16 v[212:215], v[56:59], a[104:107], 0
    v_mul_f32 v4, v194, v66
    v_mul_f32 v6, v202, v66
    v_mfma_f32_16x16x32_bf16 v[220:223], v[56:59], a[120:123], 0
    v_fma_f32 v4, v202, v74, v4
    v_fma_f32 v6, -v194, v74, v6
    v_cvt_pk_bf16_f32 v194, v4, v6
    v_mfma_f32_16x16x32_bf16 v[212:215], v[60:63], a[108:111], v[212:215]
    buffer_load_dwordx4 v0, s[20:23], m0 offen offset:2048 sc1 lds
    v_mul_f32 v8, v195, v67
    v_mul_f32 v10, v203, v67
    v_mfma_f32_16x16x32_bf16 v[220:223], v[60:63], a[124:127], v[220:223]
    v_fma_f32 v8, v203, v75, v8
    v_fma_f32 v10, -v195, v75, v10
    v_cvt_pk_bf16_f32 v195, v8, v10
    ds_write_b128 v178, v[192:195] offset:0
    v_pk_mul_f32 v[12:13], v[196:197], v[68:69]
    v_pk_mul_f32 v[14:15], v[204:205], v[68:69]
    v_pk_fma_f32 v[12:13], v[204:205], v[76:77], v[12:13]
    v_pk_fma_f32 v[14:15], v[196:197], v[76:77], v[14:15] neg_lo:[1,0,0] neg_hi:[1,0,0]
    v_cvt_pk_bf16_f32 v196, v12, v14
    v_cvt_pk_bf16_f32 v197, v13, v15
    v_pk_mul_f32 v[4:5], v[198:199], v[70:71]
    v_pk_mul_f32 v[6:7], v[206:207], v[70:71]
    v_pk_fma_f32 v[4:5], v[206:207], v[78:79], v[4:5]
    v_pk_fma_f32 v[6:7], v[198:199], v[78:79], v[6:7] neg_lo:[1,0,0] neg_hi:[1,0,0]
    v_cvt_pk_bf16_f32 v198, v4, v6
    v_cvt_pk_bf16_f32 v199, v5, v7
    ds_write_b128 v178, v[196:199] offset:4096
    v_pk_mul_f32 v[8:9], v[208:209], v[64:65]
    v_pk_mul_f32 v[10:11], v[216:217], v[64:65]
    v_pk_fma_f32 v[8:9], v[216:217], v[72:73], v[8:9]
    v_pk_fma_f32 v[10:11], v[208:209], v[72:73], v[10:11] neg_lo:[1,0,0] neg_hi:[1,0,0]
    v_cvt_pk_bf16_f32 v208, v8, v10
    v_cvt_pk_bf16_f32 v209, v9, v11
    v_pk_mul_f32 v[12:13], v[210:211], v[66:67]
    v_pk_mul_f32 v[14:15], v[218:219], v[66:67]
    v_pk_fma_f32 v[12:13], v[218:219], v[74:75], v[12:13]
    v_pk_fma_f32 v[14:15], v[210:211], v[74:75], v[14:15] neg_lo:[1,0,0] neg_hi:[1,0,0]
    v_cvt_pk_bf16_f32 v210, v12, v14
    v_cvt_pk_bf16_f32 v211, v13, v15
    ds_write_b128 v178, v[208:211] offset:8192
    v_pk_mul_f32 v[4:5], v[212:213], v[68:69]
    v_pk_mul_f32 v[6:7], v[220:221], v[68:69]
    v_pk_fma_f32 v[4:5], v[220:221], v[76:77], v[4:5]
    v_pk_fma_f32 v[6:7], v[212:213], v[76:77], v[6:7] neg_lo:[1,0,0] neg_hi:[1,0,0]
    v_cvt_pk_bf16_f32 v212, v4, v6
    v_cvt_pk_bf16_f32 v213, v5, v7
    v_pk_mul_f32 v[8:9], v[214:215], v[70:71]
    v_pk_mul_f32 v[10:11], v[222:223], v[70:71]
    v_pk_fma_f32 v[8:9], v[222:223], v[78:79], v[8:9]
    v_pk_fma_f32 v[10:11], v[214:215], v[78:79], v[10:11] neg_lo:[1,0,0] neg_hi:[1,0,0]
    v_cvt_pk_bf16_f32 v214, v8, v10
    v_cvt_pk_bf16_f32 v215, v9, v11
    ds_write_b128 v178, v[212:215] offset:12288
    s_waitcnt lgkmcnt(0)
    s_barrier
    ds_read_b128 v[16:19], v179 offset:0
    ds_read_b128 v[20:23], v179 offset:1024
    ds_read_b128 v[24:27], v179 offset:2048
    ds_read_b128 v[28:31], v179 offset:3072
    s_waitcnt vmcnt(4)
    v_lshlrev_b32 v32, 16, v112
    v_and_b32 v48, 0xffff0000, v112
    v_lshlrev_b32 v33, 16, v113
    v_and_b32 v49, 0xffff0000, v113
    v_lshlrev_b32 v34, 16, v114
    v_and_b32 v50, 0xffff0000, v114
    v_lshlrev_b32 v35, 16, v115
    v_and_b32 v51, 0xffff0000, v115
    v_lshlrev_b32 v36, 16, v116
    v_and_b32 v52, 0xffff0000, v116
    s_waitcnt lgkmcnt(3)
    v_mfma_f32_16x16x32_bf16 v[224:227], a[128:131], v[16:19], 0
    v_lshlrev_b32 v37, 16, v117
    v_and_b32 v53, 0xffff0000, v117
    v_mfma_f32_16x16x32_bf16 v[240:243], a[192:195], v[16:19], 0
    v_lshlrev_b32 v38, 16, v118
    v_and_b32 v54, 0xffff0000, v118
    s_waitcnt lgkmcnt(2)
    v_mfma_f32_16x16x32_bf16 v[224:227], a[132:135], v[20:23], v[224:227]
    v_lshlrev_b32 v39, 16, v119
    v_and_b32 v55, 0xffff0000, v119
    v_mfma_f32_16x16x32_bf16 v[240:243], a[196:199], v[20:23], v[240:243]
    buffer_load_dwordx4 v0, s[20:23], m0 offen offset:3072 sc1 lds
    v_lshlrev_b32 v40, 16, v120
    v_and_b32 v56, 0xffff0000, v120
    s_waitcnt lgkmcnt(1)
    v_mfma_f32_16x16x32_bf16 v[224:227], a[136:139], v[24:27], v[224:227]
    v_lshlrev_b32 v41, 16, v121
    v_and_b32 v57, 0xffff0000, v121
    v_mfma_f32_16x16x32_bf16 v[240:243], a[200:203], v[24:27], v[240:243]
    v_lshlrev_b32 v42, 16, v122
    v_and_b32 v58, 0xffff0000, v122
    s_waitcnt lgkmcnt(0)
    v_mfma_f32_16x16x32_bf16 v[224:227], a[140:143], v[28:31], v[224:227]
    v_lshlrev_b32 v43, 16, v123
    v_and_b32 v59, 0xffff0000, v123
    v_mfma_f32_16x16x32_bf16 v[240:243], a[204:207], v[28:31], v[240:243]
    v_lshlrev_b32 v44, 16, v124
    v_and_b32 v60, 0xffff0000, v124
    v_mfma_f32_16x16x32_bf16 v[228:231], a[144:147], v[16:19], 0
    s_add_u32 m0, s57, 16384
    s_nop 0
    buffer_load_dwordx4 v0, s[20:23], m0 offen offset:0 sc1 lds
    v_lshlrev_b32 v45, 16, v125
    v_and_b32 v61, 0xffff0000, v125
    v_mfma_f32_16x16x32_bf16 v[244:247], a[208:211], v[16:19], 0
    v_lshlrev_b32 v46, 16, v126
    v_and_b32 v62, 0xffff0000, v126
    v_mfma_f32_16x16x32_bf16 v[228:231], a[148:151], v[20:23], v[228:231]
    v_lshlrev_b32 v47, 16, v127
    v_and_b32 v63, 0xffff0000, v127
    v_mfma_f32_16x16x32_bf16 v[244:247], a[212:215], v[20:23], v[244:247]
    v_mul_f32 v12, v224, v32
    v_mul_f32 v14, v240, v32
    v_mfma_f32_16x16x32_bf16 v[228:231], a[152:155], v[24:27], v[228:231]
    v_fma_f32 v12, -v240, v48, v12
    v_fma_f32 v14, v224, v48, v14
    v_mfma_f32_16x16x32_bf16 v[244:247], a[216:219], v[24:27], v[244:247]
    buffer_load_dwordx4 v0, s[20:23], m0 offen offset:1024 sc1 lds
    v_cvt_pk_bf16_f32 v224, v12, -v14
    v_mul_f32 v4, v225, v33
    v_mfma_f32_16x16x32_bf16 v[228:231], a[156:159], v[28:31], v[228:231]
    v_mul_f32 v6, v241, v33
    v_fma_f32 v4, -v241, v49, v4
    v_mfma_f32_16x16x32_bf16 v[244:247], a[220:223], v[28:31], v[244:247]
    v_fma_f32 v6, v225, v49, v6
    v_cvt_pk_bf16_f32 v225, v4, -v6
    v_mul_f32 v8, v226, v34
    v_mfma_f32_16x16x32_bf16 v[232:235], a[160:163], v[16:19], 0
    v_mul_f32 v10, v242, v34
    v_fma_f32 v8, -v242, v50, v8
    v_mfma_f32_16x16x32_bf16 v[248:251], a[224:227], v[16:19], 0
    v_fma_f32 v10, v226, v50, v10
    v_cvt_pk_bf16_f32 v226, v8, -v10
    v_mfma_f32_16x16x32_bf16 v[232:235], a[164:167], v[20:23], v[232:235]
    buffer_load_dwordx4 v0, s[20:23], m0 offen offset:2048 sc1 lds
    v_mul_f32 v12, v227, v35
    v_mul_f32 v14, v243, v35
    v_mfma_f32_16x16x32_bf16 v[248:251], a[228:231], v[20:23], v[248:251]
    v_fma_f32 v12, -v243, v51, v12
    v_fma_f32 v14, v227, v51, v14
    v_mfma_f32_16x16x32_bf16 v[232:235], a[168:171], v[24:27], v[232:235]
    v_cvt_pk_bf16_f32 v227, v12, -v14
    v_mul_f32 v4, v228, v36
    v_mul_f32 v6, v244, v36
    v_mfma_f32_16x16x32_bf16 v[248:251], a[232:235], v[24:27], v[248:251]
    v_fma_f32 v4, -v244, v52, v4
    v_fma_f32 v6, v228, v52, v6
    v_mfma_f32_16x16x32_bf16 v[232:235], a[172:175], v[28:31], v[232:235]
    v_cvt_pk_bf16_f32 v228, v4, -v6
    v_mul_f32 v8, v229, v37
    v_mfma_f32_16x16x32_bf16 v[248:251], a[236:239], v[28:31], v[248:251]
    buffer_load_dwordx4 v0, s[20:23], m0 offen offset:3072 sc1 lds
    v_mul_f32 v10, v245, v37
    v_fma_f32 v8, -v245, v53, v8
    v_mfma_f32_16x16x32_bf16 v[236:239], a[176:179], v[16:19], 0
    v_fma_f32 v10, v229, v53, v10
    v_cvt_pk_bf16_f32 v229, v8, -v10
    v_mfma_f32_16x16x32_bf16 v[252:255], a[240:243], v[16:19], 0
    v_mul_f32 v12, v230, v38
    v_mul_f32 v14, v246, v38
    v_fma_f32 v12, -v246, v54, v12
    v_mfma_f32_16x16x32_bf16 v[236:239], a[180:183], v[20:23], v[236:239]
    v_fma_f32 v14, v230, v54, v14
    v_cvt_pk_bf16_f32 v230, v12, -v14
    v_mfma_f32_16x16x32_bf16 v[252:255], a[244:247], v[20:23], v[252:255]
    v_mul_f32 v4, v231, v39
    v_mul_f32 v6, v247, v39
    v_mfma_f32_16x16x32_bf16 v[236:239], a[184:187], v[24:27], v[236:239]
    s_add_u32 m0, s57, 32768
    s_nop 0
    buffer_load_dwordx4 v0, s[20:23], m0 offen offset:0 sc1 lds
    v_fma_f32 v4, -v247, v55, v4
    v_fma_f32 v6, v231, v55, v6
    v_mfma_f32_16x16x32_bf16 v[252:255], a[248:251], v[24:27], v[252:255]
    v_cvt_pk_bf16_f32 v231, v4, -v6
    v_mul_f32 v8, v232, v40
    v_mfma_f32_16x16x32_bf16 v[236:239], a[188:191], v[28:31], v[236:239]
    v_mul_f32 v10, v248, v40
    v_fma_f32 v8, -v248, v56, v8
    v_fma_f32 v10, v232, v56, v10
    v_mfma_f32_16x16x32_bf16 v[252:255], a[252:255], v[28:31], v[252:255]
    v_cvt_pk_bf16_f32 v232, v8, -v10
    v_mul_f32 v12, v233, v41
    v_mfma_f32_16x16x32_bf16 v[192:195], v[224:227], a[128:131], 0
    v_mul_f32 v14, v249, v41
    v_fma_f32 v12, -v249, v57, v12
    v_mfma_f32_16x16x32_bf16 v[208:211], v[224:227], a[192:195], 0
    buffer_load_dwordx4 v0, s[20:23], m0 offen offset:1024 sc1 lds
    v_fma_f32 v14, v233, v57, v14
    v_cvt_pk_bf16_f32 v233, v12, -v14
    v_mfma_f32_16x16x32_bf16 v[192:195], v[228:231], a[132:135], v[192:195]
    v_mul_f32 v4, v234, v42
    v_mul_f32 v6, v250, v42
    v_mfma_f32_16x16x32_bf16 v[208:211], v[228:231], a[196:199], v[208:211]
    v_fma_f32 v4, -v250, v58, v4
    v_fma_f32 v6, v234, v58, v6
    v_mfma_f32_16x16x32_bf16 v[196:199], v[224:227], a[144:147], 0
    v_cvt_pk_bf16_f32 v234, v4, -v6
    v_mul_f32 v8, v235, v43
    v_mul_f32 v10, v251, v43
    v_mfma_f32_16x16x32_bf16 v[212:215], v[224:227], a[208:211], 0
    v_fma_f32 v8, -v251, v59, v8
    v_fma_f32 v10, v235, v59, v10
    v_mfma_f32_16x16x32_bf16 v[196:199], v[228:231], a[148:151], v[196:199]
    buffer_load_dwordx4 v0, s[20:23], m0 offen offset:2048 sc1 lds
    v_cvt_pk_bf16_f32 v235, v8, -v10
    v_mul_f32 v12, v236, v44
    v_mfma_f32_16x16x32_bf16 v[212:215], v[228:231], a[212:215], v[212:215]
    v_mul_f32 v14, v252, v44
    v_fma_f32 v12, -v252, v60, v12
    v_mfma_f32_16x16x32_bf16 v[200:203], v[224:227], a[160:163], 0
    v_fma_f32 v14, v236, v60, v14
    v_cvt_pk_bf16_f32 v236, v12, -v14
    v_mfma_f32_16x16x32_bf16 v[216:219], v[224:227], a[224:227], 0
    v_mul_f32 v4, v237, v45
    v_mul_f32 v6, v253, v45
    v_fma_f32 v4, -v253, v61, v4
    v_mfma_f32_16x16x32_bf16 v[200:203], v[228:231], a[164:167], v[200:203]
    v_fma_f32 v6, v237, v61, v6
    v_cvt_pk_bf16_f32 v237, v4, -v6
    v_mfma_f32_16x16x32_bf16 v[216:219], v[228:231], a[228:231], v[216:219]
    buffer_load_dwordx4 v0, s[20:23], m0 offen offset:3072 sc1 lds
    v_mul_f32 v8, v238, v46
    v_mul_f32 v10, v254, v46
    v_mfma_f32_16x16x32_bf16 v[204:207], v[224:227], a[176:179], 0
    v_fma_f32 v8, -v254, v62, v8
    v_fma_f32 v10, v238, v62, v10
    v_mfma_f32_16x16x32_bf16 v[220:223], v[224:227], a[240:243], 0
    v_cvt_pk_bf16_f32 v238, v8, -v10
    v_mul_f32 v12, v239, v47
    v_mfma_f32_16x16x32_bf16 v[204:207], v[228:231], a[180:183], v[204:207]
    v_mul_f32 v14, v255, v47
    v_fma_f32 v12, -v255, v63, v12
    v_fma_f32 v14, v239, v63, v14
    v_mfma_f32_16x16x32_bf16 v[220:223], v[228:231], a[244:247], v[220:223]
    v_cvt_pk_bf16_f32 v239, v12, -v14
    v_mfma_f32_16x16x32_bf16 v[192:195], v[232:235], a[136:139], v[192:195]
    s_add_u32 m0, s57, 49152
    s_nop 0
    buffer_load_dwordx4 v0, s[20:23], m0 offen offset:0 sc1 lds
    v_mfma_f32_16x16x32_bf16 v[208:211], v[232:235], a[200:203], v[208:211]
    v_mfma_f32_16x16x32_bf16 v[196:199], v[232:235], a[152:155], v[196:199]
    v_mfma_f32_16x16x32_bf16 v[212:215], v[232:235], a[216:219], v[212:215]
    v_mfma_f32_16x16x32_bf16 v[192:195], v[236:239], a[140:143], v[192:195]
    v_mfma_f32_16x16x32_bf16 v[208:211], v[236:239], a[204:207], v[208:211]
    buffer_load_dwordx4 v0, s[20:23], m0 offen offset:1024 sc1 lds
    v_mfma_f32_16x16x32_bf16 v[196:199], v[236:239], a[156:159], v[196:199]
    v_mfma_f32_16x16x32_bf16 v[212:215], v[236:239], a[220:223], v[212:215]
    v_mfma_f32_16x16x32_bf16 v[200:203], v[232:235], a[168:171], v[200:203]
    v_mfma_f32_16x16x32_bf16 v[216:219], v[232:235], a[232:235], v[216:219]
    s_nop 1
    v_mul_f32 v4, v192, v80
    v_mul_f32 v6, -v208, v80
    v_fma_f32 v4, v208, v96, v4
    v_mfma_f32_16x16x32_bf16 v[200:203], v[236:239], a[172:175], v[200:203]
    buffer_load_dwordx4 v0, s[20:23], m0 offen offset:2048 sc1 lds
    v_fma_f32 v6, v192, v96, v6
    v_cvt_pk_bf16_f32 v192, v6, v4
    v_mul_f32 v8, v193, v81
    v_mfma_f32_16x16x32_bf16 v[216:219], v[236:239], a[236:239], v[216:219]
    v_mul_f32 v10, -v209, v81
    v_fma_f32 v8, v209, v97, v8
    v_fma_f32 v10, v193, v97, v10
    v_mfma_f32_16x16x32_bf16 v[204:207], v[232:235], a[184:187], v[204:207]
    v_cvt_pk_bf16_f32 v193, v10, v8
    v_mul_f32 v12, v194, v82
    v_mul_f32 v14, -v210, v82
    v_mfma_f32_16x16x32_bf16 v[220:223], v[232:235], a[248:251], v[220:223]
    v_fma_f32 v12, v210, v98, v12
    v_fma_f32 v14, v194, v98, v14
    v_cvt_pk_bf16_f32 v194, v14, v12
    v_mfma_f32_16x16x32_bf16 v[204:207], v[236:239], a[188:191], v[204:207]
    v_mul_f32 v4, v195, v83
    v_mul_f32 v6, -v211, v83
    v_fma_f32 v4, v211, v99, v4
    v_mfma_f32_16x16x32_bf16 v[220:223], v[236:239], a[252:255], v[220:223]
    buffer_load_dwordx4 v0, s[20:23], m0 offen offset:3072 sc1 lds
    v_fma_f32 v6, v195, v99, v6
    v_cvt_pk_bf16_f32 v195, v6, v4
    ds_write_b128 v179, v[192:195] offset:0
    v_pk_mul_f32 v[8:9], v[196:197], v[84:85]
    v_pk_mul_f32 v[10:11], v[212:213], v[84:85] neg_lo:[1,0] neg_hi:[1,0]
    v_pk_fma_f32 v[8:9], v[212:213], v[100:101], v[8:9]
    v_pk_fma_f32 v[10:11], v[196:197], v[100:101], v[10:11]
    v_cvt_pk_bf16_f32 v196, v10, v8
    v_cvt_pk_bf16_f32 v197, v11, v9
    v_pk_mul_f32 v[12:13], v[198:199], v[86:87]
    v_pk_mul_f32 v[14:15], v[214:215], v[86:87] neg_lo:[1,0] neg_hi:[1,0]
    v_pk_fma_f32 v[12:13], v[214:215], v[102:103], v[12:13]
    v_pk_fma_f32 v[14:15], v[198:199], v[102:103], v[14:15]
    v_cvt_pk_bf16_f32 v198, v14, v12
    v_cvt_pk_bf16_f32 v199, v15, v13
    ds_write_b128 v179, v[196:199] offset:1024
    v_pk_mul_f32 v[4:5], v[200:201], v[88:89]
    v_pk_mul_f32 v[6:7], v[216:217], v[88:89] neg_lo:[1,0] neg_hi:[1,0]
    v_pk_fma_f32 v[4:5], v[216:217], v[104:105], v[4:5]
    v_pk_fma_f32 v[6:7], v[200:201], v[104:105], v[6:7]
    v_cvt_pk_bf16_f32 v200, v6, v4
    v_cvt_pk_bf16_f32 v201, v7, v5
    v_pk_mul_f32 v[8:9], v[202:203], v[90:91]
    v_pk_mul_f32 v[10:11], v[218:219], v[90:91] neg_lo:[1,0] neg_hi:[1,0]
    v_pk_fma_f32 v[8:9], v[218:219], v[106:107], v[8:9]
    v_pk_fma_f32 v[10:11], v[202:203], v[106:107], v[10:11]
    v_cvt_pk_bf16_f32 v202, v10, v8
    v_cvt_pk_bf16_f32 v203, v11, v9
    ds_write_b128 v179, v[200:203] offset:2048
    v_pk_mul_f32 v[12:13], v[204:205], v[92:93]
    v_pk_mul_f32 v[14:15], v[220:221], v[92:93] neg_lo:[1,0] neg_hi:[1,0]
    v_pk_fma_f32 v[12:13], v[220:221], v[108:109], v[12:13]
    v_pk_fma_f32 v[14:15], v[204:205], v[108:109], v[14:15]
    v_cvt_pk_bf16_f32 v204, v14, v12
    v_cvt_pk_bf16_f32 v205, v15, v13
    v_pk_mul_f32 v[4:5], v[206:207], v[94:95]
    v_pk_mul_f32 v[6:7], v[222:223], v[94:95] neg_lo:[1,0] neg_hi:[1,0]
    v_pk_fma_f32 v[4:5], v[222:223], v[110:111], v[4:5]
    v_pk_fma_f32 v[6:7], v[206:207], v[110:111], v[6:7]
    v_cvt_pk_bf16_f32 v206, v6, v4
    v_cvt_pk_bf16_f32 v207, v7, v5
    ds_write_b128 v179, v[204:207] offset:3072
    s_waitcnt lgkmcnt(0)
    s_barrier
    ds_read_b128 v[224:227], v178 offset:0
    ds_read_b128 v[228:231], v178 offset:4096
    ds_read_b128 v[232:235], v178 offset:8192
    ds_read_b128 v[236:239], v178 offset:12288
    s_add_u32 s24, s13, 0
    s_and_b32 s30, s14, 1
    s_mul_i32 s30, s30, 7
    s_lshr_b32 s31, s14, 1
    s_lshl_b32 s31, s31, 5
    s_add_u32 s30, s30, s31
    s_lshl_b32 s30, s30, 6
    s_add_u32 s30, s30, 27459588
    v_min_u32 v9, 6, v2
    v_lshlrev_b32 v9, 6, v9
    buffer_load_dword v9, v9, s[20:23], s30 offen sc1
    s_waitcnt lgkmcnt(3)
    v_mfma_f32_16x16x32_bf16 v[128:131], a[112:115], v[224:227], 0
    v_mfma_f32_16x16x32_bf16 v[136:139], a[96:99], v[224:227], v[136:139]
    s_waitcnt lgkmcnt(2)
    v_mfma_f32_16x16x32_bf16 v[128:131], a[116:119], v[228:231], v[128:131]
    v_mfma_f32_16x16x32_bf16 v[136:139], a[100:103], v[228:231], v[136:139]
    s_waitcnt lgkmcnt(1)
    v_mfma_f32_16x16x32_bf16 v[144:147], a[112:115], v[232:235], v[144:147]
    v_mfma_f32_16x16x32_bf16 v[152:155], a[96:99], v[232:235], v[152:155]
    s_waitcnt lgkmcnt(0)
    v_mfma_f32_16x16x32_bf16 v[144:147], a[116:119], v[236:239], v[144:147]
    v_mfma_f32_16x16x32_bf16 v[152:155], a[100:103], v[236:239], v[152:155]
    v_mfma_f32_16x16x32_bf16 v[132:135], a[120:123], v[224:227], 0
    v_fma_f32 v128, v128, s46, v160
    v_cvt_pk_bf16_f32 v16, v128, v136
    v_mfma_f32_16x16x32_bf16 v[140:143], a[104:107], v[224:227], v[140:143]
    v_fma_f32 v129, v129, s46, v161
    v_cvt_pk_bf16_f32 v18, v129, v137
    v_mfma_f32_16x16x32_bf16 v[132:135], a[124:127], v[228:231], v[132:135]
    v_fma_f32 v130, v130, s46, v162
    v_cvt_pk_bf16_f32 v20, v130, v138
    v_mfma_f32_16x16x32_bf16 v[140:143], a[108:111], v[228:231], v[140:143]
    v_fma_f32 v131, v131, s46, v163
    v_cvt_pk_bf16_f32 v22, v131, v139
    v_mfma_f32_16x16x32_bf16 v[148:151], a[120:123], v[232:235], v[148:151]
    v_cvt_pk_bf16_f32 v17, v144, v152
    v_cvt_pk_bf16_f32 v19, v145, v153
    v_mfma_f32_16x16x32_bf16 v[156:159], a[104:107], v[232:235], v[156:159]
    v_or_b32 v16, 1, v16
    buffer_store_dwordx4 v[16:19], v176, s[20:23], s40 offen sc1
    v_mfma_f32_16x16x32_bf16 v[148:151], a[124:127], v[236:239], v[148:151]
    v_cvt_pk_bf16_f32 v21, v146, v154
    v_cvt_pk_bf16_f32 v23, v147, v155
    v_mfma_f32_16x16x32_bf16 v[156:159], a[108:111], v[236:239], v[156:159]
    v_or_b32 v20, 1, v20
    buffer_store_dwordx4 v[20:23], v176, s[20:23], s41 offen sc1
    v_fma_f32 v132, v132, s46, v164
    v_cvt_pk_bf16_f32 v24, v132, v140
    v_fma_f32 v133, v133, s46, v165
    v_cvt_pk_bf16_f32 v26, v133, v141
    v_fma_f32 v134, v134, s46, v166
    v_cvt_pk_bf16_f32 v28, v134, v142
    v_fma_f32 v135, v135, s46, v167
    v_cvt_pk_bf16_f32 v30, v135, v143
    v_cvt_pk_bf16_f32 v25, v148, v156
    v_cvt_pk_bf16_f32 v27, v149, v157
    v_or_b32 v24, 1, v24
    buffer_store_dwordx4 v[24:27], v176, s[20:23], s42 offen sc1
    v_cvt_pk_bf16_f32 v29, v150, v158
    v_cvt_pk_bf16_f32 v31, v151, v159
    v_or_b32 v28, 1, v28
    buffer_store_dwordx4 v[28:31], v176, s[20:23], s43 offen sc1
    s_cmp_lg_u32 s12, 0
    s_cbranch_scc1 main_kernel_norep
    s_waitcnt vmcnt(4)
    v_cmp_eq_u32 vcc, 0, v9
    s_nop 0
    s_cbranch_vccnz main_kernel_sloww1
main_kernel_backw1:
    v_add_u32 v0, s25, v3
    s_add_u32 m0, s57, 0
    s_nop 0
    buffer_load_dwordx4 v0, s[20:23], m0 offen offset:0 sc1 lds
    buffer_load_dwordx4 v0, s[20:23], m0 offen offset:1024 sc1 lds
    buffer_load_dwordx4 v0, s[20:23], m0 offen offset:2048 sc1 lds
    buffer_load_dwordx4 v0, s[20:23], m0 offen offset:3072 sc1 lds
main_kernel_stub7:
    s_cbranch_execz main_kernel_ret
    s_add_u32 m0, s57, 16384
    s_nop 0
    buffer_load_dwordx4 v0, s[20:23], m0 offen offset:0 sc1 lds
    buffer_load_dwordx4 v0, s[20:23], m0 offen offset:1024 sc1 lds
    buffer_load_dwordx4 v0, s[20:23], m0 offen offset:2048 sc1 lds
    buffer_load_dwordx4 v0, s[20:23], m0 offen offset:3072 sc1 lds
    s_add_u32 m0, s57, 32768
    s_nop 0
    buffer_load_dwordx4 v0, s[20:23], m0 offen offset:0 sc1 lds
    buffer_load_dwordx4 v0, s[20:23], m0 offen offset:1024 sc1 lds
    buffer_load_dwordx4 v0, s[20:23], m0 offen offset:2048 sc1 lds
    buffer_load_dwordx4 v0, s[20:23], m0 offen offset:3072 sc1 lds
    s_add_u32 m0, s57, 49152
    s_nop 0
    buffer_load_dwordx4 v0, s[20:23], m0 offen offset:0 sc1 lds
    buffer_load_dwordx4 v0, s[20:23], m0 offen offset:1024 sc1 lds
    buffer_load_dwordx4 v0, s[20:23], m0 offen offset:2048 sc1 lds
    buffer_load_dwordx4 v0, s[20:23], m0 offen offset:3072 sc1 lds
    s_mov_b32 s31, 0x80000000
    buffer_load_dword v9, off, s[20:23], s31
    buffer_load_dword v9, off, s[20:23], s31
    buffer_load_dword v9, off, s[20:23], s31
    buffer_load_dword v9, off, s[20:23], s31
    buffer_load_dword v9, off, s[20:23], s31
main_kernel_norep:
    s_mul_i32 s7, s11, 448
    s_add_u32 s7, s7, 27460484
    s_add_u32 m0, s57, 65536
    s_nop 0
    buffer_load_dwordx4 v0, s[20:23], m0 offen offset:0 sc1 lds
    buffer_load_dwordx4 v0, s[20:23], m0 offen offset:1024 sc1 lds
    buffer_load_dwordx4 v0, s[20:23], m0 offen offset:2048 sc1 lds
    buffer_load_dwordx4 v0, s[20:23], m0 offen offset:3072 sc1 lds
    v_add_u32 v4, 0x10000, v3
    v_add_u32 v5, 0x20000, v3
    v_mov_b32 v7, 1
    v_mov_b32 v8, 0
    v_mov_b32 v6, 0x80000000
    v_cmp_eq_u32 vcc, 0, v2
    s_nop 1
    v_cndmask_b32 v6, v6, v8, vcc
    s_lshl_b32 s17, s11, 4
    s_add_u32 s17, s17, s8
    s_mul_i32 s17, s17, 458752
    s_add_u32 s17, s17, s26
    s_add_u32 s17, s17, 28311552
    s_add_u32 s17, s17, s3
    s_mov_b32 s69, 0x80000000
    s_add_u32 s18, s9, 0
    s_and_b32 s18, s18, 7
    s_lshl_b32 s18, s18, 13
    s_add_u32 s32, s18, s17
    s_add_u32 s40, s32, 0x40000
    s_add_u32 s18, s9, 1
    s_and_b32 s18, s18, 7
    s_lshl_b32 s18, s18, 13
    s_add_u32 s33, s18, s17
    s_add_u32 s41, s33, 0x40000
    s_add_u32 s18, s9, 2
    s_and_b32 s18, s18, 7
    s_lshl_b32 s18, s18, 13
    s_add_u32 s34, s18, s17
    s_add_u32 s42, s34, 0x40000
    s_add_u32 s18, s9, 3
    s_and_b32 s18, s18, 7
    s_lshl_b32 s18, s18, 13
    s_add_u32 s35, s18, s17
    s_add_u32 s43, s35, 0x40000
    s_add_u32 s18, s9, 4
    s_and_b32 s18, s18, 7
    s_lshl_b32 s18, s18, 13
    s_add_u32 s36, s18, s17
    s_add_u32 s44, s36, 0x40000
    s_add_u32 s18, s9, 5
    s_and_b32 s18, s18, 7
    s_lshl_b32 s18, s18, 13
    s_add_u32 s37, s18, s17
    s_add_u32 s45, s37, 0x40000
    s_add_u32 s18, s9, 6
    s_and_b32 s18, s18, 7
    s_lshl_b32 s18, s18, 13
    s_add_u32 s38, s18, s17
    s_add_u32 s46, s38, 0x40000
    s_add_u32 s18, s9, 7
    s_and_b32 s18, s18, 7
    s_lshl_b32 s18, s18, 13
    s_add_u32 s39, s18, s17
    s_add_u32 s47, s39, 0x40000
    s_lshl_b32 s49, s8, 1
    s_add_u32 s49, s49, s11
    s_lshl_b32 s49, s49, 11
    s_lshl_b32 s18, s10, 6
    s_add_u32 s49, s49, s18
    s_add_u32 s49, s49, 27328512
    s_add_u32 s49, s49, s3
    s_mov_b32 s50, 0x3fb8aa3b
    s_lshl_b32 s18, s9, 2
    s_lshl_b32 s19, s11, 1
    s_add_u32 s18, s18, s19
    s_lshl_b32 s52, s18, 17
    s_add_u32 s52, s52, s13
    s_xor_b32 s55, s49, 2048
    s_lshl_b32 s51, s2, 14
    s_lshl_b32 s19, s10, 12
    s_add_u32 s51, s51, s19
    s_add_u32 s51, s51, 4194304
    s_xor_b32 s68, s51, 16384
    s_lshl_b32 s17, s12, 31
    s_add_u32 s18, s59, s17
    s_xor_b32 s19, s17, 0x80000000
    s_add_u32 s15, s26, s19
    s_add_u32 s15, s15, 59392
    s_lshl_b32 s16, s10, 14
    s_add_u32 s16, s16, s19
    s_add_u32 s16, s16, 67584
    s_mov_b32 s19, 4096
    s_lshl_b32 s56, s8, 10
    s_lshl_b32 s58, s10, 8
    s_add_u32 s56, s56, s58
    s_add_u32 s56, s56, s3
    s_add_u32 s56, s56, 27279360
    s_mov_b32 s100, 0
    s_mov_b32 s101, 0x42500000
    s_mov_b32 s94, 0
    s_mov_b32 s95, 0xc2900000
    s_mov_b32 s58, 0x42900000
    s_sleep 6
    s_cmp_eq_u32 s12, 0
    s_cbranch_scc1 main_kernel_noxd
    s_sleep 9
main_kernel_noxd:
    s_add_u32 s31, s24, 0
    buffer_load_dwordx4 v[112:115], v3, s[20:23], s31 offen offset:0 sc1
    buffer_load_dwordx4 v[116:119], v3, s[20:23], s31 offen offset:1024 sc1
    s_add_u32 s31, s24, 131072
    buffer_load_dwordx4 v[120:123], v3, s[20:23], s31 offen offset:0 sc1
    buffer_load_dwordx4 v[124:127], v3, s[20:23], s31 offen offset:1024 sc1
    s_add_u32 s31, s24, 262144
    buffer_load_dwordx4 v[128:131], v3, s[20:23], s31 offen offset:0 sc1
    buffer_load_dwordx4 v[132:135], v3, s[20:23], s31 offen offset:1024 sc1
    s_add_u32 s31, s24, 393216
    buffer_load_dwordx4 v[136:139], v3, s[20:23], s31 offen offset:0 sc1
    buffer_load_dwordx4 v[140:143], v3, s[20:23], s31 offen offset:1024 sc1
    s_add_u32 m0, s57, 81920
    s_nop 0
    buffer_load_dwordx4 v0, s[20:23], m0 offen offset:0 sc1 lds
    buffer_load_dwordx4 v0, s[20:23], m0 offen offset:1024 sc1 lds
    buffer_load_dwordx4 v0, s[20:23], m0 offen offset:2048 sc1 lds
    buffer_load_dwordx4 v0, s[20:23], m0 offen offset:3072 sc1 lds
    s_waitcnt vmcnt(29)
    s_barrier
    ds_read_b128 v[16:19], v3 offset:0
    ds_read_b128 v[20:23], v3 offset:1024
    ds_read_b128 v[24:27], v3 offset:2048
    ds_read_b128 v[28:31], v3 offset:3072
    ds_read_b128 v[32:35], v3 offset:4096
    ds_read_b128 v[36:39], v3 offset:5120
    ds_read_b128 v[40:43], v3 offset:6144
    ds_read_b128 v[44:47], v3 offset:7168
    v_bfe_u32 v12, v2, 4, 2
    v_and_b32 v13, 15, v2
    v_lshlrev_b32 v202, 4, v13
    v_lshrrev_b32 v14, 5, v2
    v_lshl_add_u32 v200, v14, 3, v202
    v_lshlrev_b32 v14, 31, v12
    v_or_b32 v200, v200, v14
    v_add_u32 v201, s14, v12
    v_min_u32 v201, 1, v201
    v_cvt_f32_u32 v201, v201
    v_mov_b32 v12, -1
    v_mov_b32 v13, -1
    v_mov_b32 v14, -1
    v_mov_b32 v15, -1
    s_waitcnt vmcnt(10)
    v_bitop3_b32 v9, v112, v116, 1 bitop3:0x80
    s_waitcnt vmcnt(8)
    v_bitop3_b32 v9, v120, v124, v9 bitop3:0x80
    v_cmp_eq_u32 vcc, 0, v9
    s_nop 0
    s_cbranch_vccnz main_kernel_xin
main_kernel_xok:
    s_mov_b64 exec, -1
    v_accvgpr_write_b32 a0, v112
    v_accvgpr_write_b32 a1, v113
    v_accvgpr_write_b32 a2, v116
    v_accvgpr_write_b32 a3, v117
    v_accvgpr_write_b32 a4, v114
    v_accvgpr_write_b32 a5, v115
    v_accvgpr_write_b32 a6, v118
    v_accvgpr_write_b32 a7, v119
    s_waitcnt lgkmcnt(4)
    v_mfma_f32_16x16x32_bf16 v[64:67], v[16:19], a[0:3], 0
    ds_read_b128 v[48:51], v3 offset:8192
    s_add_u32 m0, s57, 98304
    v_mfma_f32_16x16x32_bf16 v[72:75], v[16:19], a[4:7], 0
    buffer_load_dwordx4 v0, s[20:23], m0 offen offset:0 sc1 lds
    v_mfma_f32_16x16x32_bf16 v[68:71], v[20:23], a[0:3], 0
    ds_read_b128 v[52:55], v3 offset:9216
    v_accvgpr_write_b32 a8, v120
    v_mfma_f32_16x16x32_bf16 v[76:79], v[20:23], a[4:7], 0
    buffer_load_dwordx4 v0, s[20:23], m0 offen offset:1024 sc1 lds
    v_mfma_f32_16x16x32_bf16 v[80:83], v[24:27], a[0:3], 0
    ds_read_b128 v[56:59], v3 offset:10240
    s_add_u32 s28, s24, 524288
    v_mfma_f32_16x16x32_bf16 v[88:91], v[24:27], a[4:7], 0
    buffer_load_dwordx4 v[144:147], v3, s[20:23], s28 offen offset:0 sc1
    v_mfma_f32_16x16x32_bf16 v[84:87], v[28:31], a[0:3], 0
    ds_read_b128 v[60:63], v3 offset:11264
    v_accvgpr_write_b32 a9, v121
    v_mfma_f32_16x16x32_bf16 v[92:95], v[28:31], a[4:7], 0
    s_waitcnt lgkmcnt(4) vmcnt(9)
    v_accvgpr_write_b32 a10, v124
    v_accvgpr_write_b32 a11, v125
    v_mfma_f32_16x16x32_bf16 v[96:99], v[32:35], a[0:3], 0
    ds_read_b128 v[16:19], v3 offset:12288
    v_accvgpr_write_b32 a12, v122
    v_accvgpr_write_b32 a13, v123
    v_mfma_f32_16x16x32_bf16 v[104:107], v[32:35], a[4:7], 0
    buffer_load_dwordx4 v[148:151], v3, s[20:23], s28 offen offset:1024 sc1
    v_accvgpr_write_b32 a14, v126
    v_mfma_f32_16x16x32_bf16 v[100:103], v[36:39], a[0:3], 0
    ds_read_b128 v[20:23], v3 offset:13312
    s_add_u32 s29, s24, 655360
    v_accvgpr_write_b32 a15, v127
    v_mfma_f32_16x16x32_bf16 v[108:111], v[36:39], a[4:7], 0
    buffer_load_dwordx4 v[152:155], v3, s[20:23], s29 offen offset:0 sc1
    v_bitop3_b32 v9, v128, v132, 1 bitop3:0x80
    v_mfma_f32_16x16x32_bf16 v[64:67], v[40:43], a[8:11], v[64:67]
    ds_read_b128 v[24:27], v3 offset:14336
    v_cmp_eq_u32 vcc, 0, v9
    v_mfma_f32_16x16x32_bf16 v[72:75], v[40:43], a[12:15], v[72:75]
    buffer_load_dwordx4 v[156:159], v3, s[20:23], s29 offen offset:1024 sc1
    s_cbranch_vccnz main_kernel_slowx2
main_kernel_backx2:
    v_accvgpr_write_b32 a16, v128
    v_mfma_f32_16x16x32_bf16 v[68:71], v[44:47], a[8:11], v[68:71]
    ds_read_b128 v[28:31], v3 offset:15360
    s_add_u32 s53, s52, 0
    v_mfma_f32_16x16x32_bf16 v[76:79], v[44:47], a[12:15], v[76:79]
    s_waitcnt lgkmcnt(4)
    v_accvgpr_write_b32 a17, v129
    v_accvgpr_write_b32 a18, v132
    v_mfma_f32_16x16x32_bf16 v[80:83], v[48:51], a[8:11], v[80:83]
    ds_read_b128 v[32:35], v3 offset:16384
    v_accvgpr_write_b32 a19, v133
    v_mfma_f32_16x16x32_bf16 v[88:91], v[48:51], a[12:15], v[88:91]
    buffer_load_dwordx4 v[208:211], v3, s[20:23], s53 offen sc1
    v_mfma_f32_16x16x32_bf16 v[84:87], v[52:55], a[8:11], v[84:87]
    ds_read_b128 v[36:39], v3 offset:17408
    v_accvgpr_write_b32 a20, v130
    v_mfma_f32_16x16x32_bf16 v[92:95], v[52:55], a[12:15], v[92:95]
    buffer_load_dwordx4 v[212:215], v3, s[20:23], s53 offen offset:1024 sc1
    v_mfma_f32_16x16x32_bf16 v[96:99], v[56:59], a[8:11], v[96:99]
    ds_read_b128 v[40:43], v3 offset:18432
    s_add_u32 s30, s24, 786432
    v_mfma_f32_16x16x32_bf16 v[104:107], v[56:59], a[12:15], v[104:107]
    buffer_load_dwordx4 v[160:163], v3, s[20:23], s30 offen offset:0 sc1
    v_mfma_f32_16x16x32_bf16 v[100:103], v[60:63], a[8:11], v[100:103]
    ds_read_b128 v[44:47], v3 offset:19456
    v_accvgpr_write_b32 a21, v131
    v_mfma_f32_16x16x32_bf16 v[108:111], v[60:63], a[12:15], v[108:111]
    s_waitcnt lgkmcnt(4) vmcnt(13)
    v_accvgpr_write_b32 a22, v134
    v_accvgpr_write_b32 a23, v135
    v_mfma_f32_16x16x32_bf16 v[64:67], v[16:19], a[16:19], v[64:67]
    ds_read_b128 v[48:51], v3 offset:20480
    v_bitop3_b32 v9, v136, v140, 1 bitop3:0x80
    v_cmp_eq_u32 vcc, 0, v9
    v_mfma_f32_16x16x32_bf16 v[72:75], v[16:19], a[20:23], v[72:75]
    buffer_load_dwordx4 v[164:167], v3, s[20:23], s30 offen offset:1024 sc1
    s_cbranch_vccnz main_kernel_slowx3
main_kernel_backx3:
    v_accvgpr_write_b32 a24, v136
    v_mfma_f32_16x16x32_bf16 v[68:71], v[20:23], a[16:19], v[68:71]
    ds_read_b128 v[52:55], v3 offset:21504
    v_accvgpr_write_b32 a25, v137
    v_mfma_f32_16x16x32_bf16 v[76:79], v[20:23], a[20:23], v[76:79]
    buffer_load_dwordx4 v0, s[20:23], m0 offen offset:2048 sc1 lds
    v_mfma_f32_16x16x32_bf16 v[80:83], v[24:27], a[16:19], v[80:83]
    ds_read_b128 v[56:59], v3 offset:22528
    v_accvgpr_write_b32 a26, v140
    v_mfma_f32_16x16x32_bf16 v[88:91], v[24:27], a[20:23], v[88:91]
    buffer_load_dwordx4 v0, s[20:23], m0 offen offset:3072 sc1 lds
    v_mfma_f32_16x16x32_bf16 v[84:87], v[28:31], a[16:19], v[84:87]
    ds_read_b128 v[60:63], v3 offset:23552
    s_add_u32 s27, s24, 917504
    v_mfma_f32_16x16x32_bf16 v[92:95], v[28:31], a[20:23], v[92:95]
    s_waitcnt lgkmcnt(4) vmcnt(8)
    v_accvgpr_write_b32 a27, v141
    v_accvgpr_write_b32 a28, v138
    v_mfma_f32_16x16x32_bf16 v[96:99], v[32:35], a[16:19], v[96:99]
    ds_read_b128 v[16:19], v3 offset:24576
    v_accvgpr_write_b32 a29, v139
    v_accvgpr_write_b32 a30, v142
    v_mfma_f32_16x16x32_bf16 v[104:107], v[32:35], a[20:23], v[104:107]
    buffer_load_dwordx4 v[168:171], v3, s[20:23], s27 offen offset:0 sc1
    v_accvgpr_write_b32 a31, v143
    v_mfma_f32_16x16x32_bf16 v[100:103], v[36:39], a[16:19], v[100:103]
    ds_read_b128 v[20:23], v3 offset:25600
    v_bitop3_b32 v9, v144, v148, 1 bitop3:0x80
    v_cmp_eq_u32 vcc, 0, v9
    v_mfma_f32_16x16x32_bf16 v[108:111], v[36:39], a[20:23], v[108:111]
    buffer_load_dwordx4 v[172:175], v3, s[20:23], s27 offen offset:1024 sc1
    s_cbranch_vccnz main_kernel_slowx4
main_kernel_backx4:
    v_accvgpr_write_b32 a32, v144
    v_mfma_f32_16x16x32_bf16 v[64:67], v[40:43], a[24:27], v[64:67]
    ds_read_b128 v[24:27], v3 offset:26624
    s_add_u32 s54, s52, 131072
    v_mfma_f32_16x16x32_bf16 v[72:75], v[40:43], a[28:31], v[72:75]
    buffer_load_dwordx4 v[216:219], v3, s[20:23], s54 offen sc1
    v_mfma_f32_16x16x32_bf16 v[68:71], v[44:47], a[24:27], v[68:71]
    ds_read_b128 v[28:31], v3 offset:27648
    v_accvgpr_write_b32 a33, v145
    v_mfma_f32_16x16x32_bf16 v[76:79], v[44:47], a[28:31], v[76:79]
    s_waitcnt lgkmcnt(4)
    v_accvgpr_write_b32 a34, v148
    v_accvgpr_write_b32 a35, v149
    v_mfma_f32_16x16x32_bf16 v[80:83], v[48:51], a[24:27], v[80:83]
    ds_read_b128 v[32:35], v3 offset:28672
    v_accvgpr_write_b32 a36, v146
    v_mfma_f32_16x16x32_bf16 v[88:91], v[48:51], a[28:31], v[88:91]
    buffer_load_dwordx4 v[220:223], v3, s[20:23], s54 offen offset:1024 sc1
    v_mfma_f32_16x16x32_bf16 v[84:87], v[52:55], a[24:27], v[84:87]
    ds_read_b128 v[36:39], v3 offset:29696
    s_add_u32 s28, s24, 1048576
    v_mfma_f32_16x16x32_bf16 v[92:95], v[52:55], a[28:31], v[92:95]
    buffer_load_dwordx4 v[176:179], v3, s[20:23], s28 offen offset:0 sc1
    v_mfma_f32_16x16x32_bf16 v[96:99], v[56:59], a[24:27], v[96:99]
    ds_read_b128 v[40:43], v3 offset:30720
    v_accvgpr_write_b32 a37, v147
    v_mfma_f32_16x16x32_bf16 v[104:107], v[56:59], a[28:31], v[104:107]
    buffer_load_dwordx4 v[180:183], v3, s[20:23], s28 offen offset:1024 sc1
    v_mfma_f32_16x16x32_bf16 v[100:103], v[60:63], a[24:27], v[100:103]
    ds_read_b128 v[44:47], v3 offset:31744
    s_add_u32 s29, s24, 1179648
    v_mfma_f32_16x16x32_bf16 v[108:111], v[60:63], a[28:31], v[108:111]
    s_waitcnt lgkmcnt(4) vmcnt(12)
    s_barrier
    v_mfma_f32_16x16x32_bf16 v[64:67], v[16:19], a[32:35], v[64:67]
    ds_read_b128 v[48:51], v3 offset:32768
    v_accvgpr_write_b32 a38, v150
    v_accvgpr_write_b32 a39, v151
    s_nop 1
    v_mfma_f32_16x16x32_bf16 v[72:75], v[16:19], a[36:39], v[72:75]
    buffer_load_dwordx4 v[184:187], v3, s[20:23], s29 offen offset:0 sc1
    v_bitop3_b32 v9, v152, v156, 1 bitop3:0x80
    v_mfma_f32_16x16x32_bf16 v[68:71], v[20:23], a[32:35], v[68:71]
    ds_read_b128 v[52:55], v3 offset:33792
    v_cmp_eq_u32 vcc, 0, v9
    v_mfma_f32_16x16x32_bf16 v[76:79], v[20:23], a[36:39], v[76:79]
    buffer_load_dwordx4 v[188:191], v3, s[20:23], s29 offen offset:1024 sc1
    s_cbranch_vccnz main_kernel_slowx5
main_kernel_backx5:
    v_accvgpr_write_b32 a40, v152
    v_mfma_f32_16x16x32_bf16 v[80:83], v[24:27], a[32:35], v[80:83]
    ds_read_b128 v[56:59], v3 offset:34816
    s_add_u32 s30, s24, 1310720
    v_mfma_f32_16x16x32_bf16 v[88:91], v[24:27], a[36:39], v[88:91]
    buffer_load_dwordx4 v[112:115], v3, s[20:23], s30 offen offset:0 sc1
    v_mfma_f32_16x16x32_bf16 v[84:87], v[28:31], a[32:35], v[84:87]
    ds_read_b128 v[60:63], v3 offset:35840
    v_accvgpr_write_b32 a41, v153
    v_mfma_f32_16x16x32_bf16 v[92:95], v[28:31], a[36:39], v[92:95]
    s_waitcnt lgkmcnt(4) vmcnt(11)
    v_accvgpr_write_b32 a42, v156
    v_accvgpr_write_b32 a43, v157
    v_mfma_f32_16x16x32_bf16 v[96:99], v[32:35], a[32:35], v[96:99]
    ds_read_b128 v[16:19], v3 offset:36864
    v_accvgpr_write_b32 a44, v154
    v_accvgpr_write_b32 a45, v155
    v_mfma_f32_16x16x32_bf16 v[104:107], v[32:35], a[36:39], v[104:107]
    buffer_load_dwordx4 v[116:119], v3, s[20:23], s30 offen offset:1024 sc1
    v_accvgpr_write_b32 a46, v158
    v_mfma_f32_16x16x32_bf16 v[100:103], v[36:39], a[32:35], v[100:103]
    ds_read_b128 v[20:23], v3 offset:37888
    s_add_u32 s27, s24, 1441792
    v_accvgpr_write_b32 a47, v159
    v_mfma_f32_16x16x32_bf16 v[108:111], v[36:39], a[36:39], v[108:111]
    buffer_load_dwordx4 v[120:123], v3, s[20:23], s27 offen offset:0 sc1
    v_bitop3_b32 v9, v160, v164, 1 bitop3:0x80
    v_mfma_f32_16x16x32_bf16 v[64:67], v[40:43], a[40:43], v[64:67]
    ds_read_b128 v[24:27], v3 offset:38912
    v_cmp_eq_u32 vcc, 0, v9
    v_mfma_f32_16x16x32_bf16 v[72:75], v[40:43], a[44:47], v[72:75]
    buffer_load_dwordx4 v[124:127], v3, s[20:23], s27 offen offset:1024 sc1
    s_cbranch_vccnz main_kernel_slowx6
main_kernel_backx6:
    v_accvgpr_write_b32 a48, v160
    v_mfma_f32_16x16x32_bf16 v[68:71], v[44:47], a[40:43], v[68:71]
    ds_read_b128 v[28:31], v3 offset:39936
    s_add_u32 s28, s24, 1572864
    v_mfma_f32_16x16x32_bf16 v[76:79], v[44:47], a[44:47], v[76:79]
    s_waitcnt lgkmcnt(4)
    v_accvgpr_write_b32 a49, v161
    v_accvgpr_write_b32 a50, v164
    v_mfma_f32_16x16x32_bf16 v[80:83], v[48:51], a[40:43], v[80:83]
    ds_read_b128 v[32:35], v3 offset:40960
    v_accvgpr_write_b32 a51, v165
    v_mfma_f32_16x16x32_bf16 v[88:91], v[48:51], a[44:47], v[88:91]
    buffer_load_dwordx4 v[128:131], v3, s[20:23], s28 offen offset:0 sc1
    v_mfma_f32_16x16x32_bf16 v[84:87], v[52:55], a[40:43], v[84:87]
    ds_read_b128 v[36:39], v3 offset:41984
    v_accvgpr_write_b32 a52, v162
    v_mfma_f32_16x16x32_bf16 v[92:95], v[52:55], a[44:47], v[92:95]
    buffer_load_dwordx4 v[132:135], v3, s[20:23], s28 offen offset:1024 sc1
    v_mfma_f32_16x16x32_bf16 v[96:99], v[56:59], a[40:43], v[96:99]
    ds_read_b128 v[40:43], v3 offset:43008
    s_add_u32 s29, s24, 1703936
    v_mfma_f32_16x16x32_bf16 v[104:107], v[56:59], a[44:47], v[104:107]
    buffer_load_dwordx4 v[136:139], v3, s[20:23], s29 offen offset:0 sc1
    v_mfma_f32_16x16x32_bf16 v[100:103], v[60:63], a[40:43], v[100:103]
    ds_read_b128 v[44:47], v3 offset:44032
    v_accvgpr_write_b32 a53, v163
    v_mfma_f32_16x16x32_bf16 v[108:111], v[60:63], a[44:47], v[108:111]
    s_waitcnt lgkmcnt(4) vmcnt(11)
    v_accvgpr_write_b32 a54, v166
    v_accvgpr_write_b32 a55, v167
    v_mfma_f32_16x16x32_bf16 v[64:67], v[16:19], a[48:51], v[64:67]
    ds_read_b128 v[48:51], v3 offset:45056
    v_bitop3_b32 v9, v168, v172, 1 bitop3:0x80
    v_cmp_eq_u32 vcc, 0, v9
    v_mfma_f32_16x16x32_bf16 v[72:75], v[16:19], a[52:55], v[72:75]
    buffer_load_dwordx4 v[140:143], v3, s[20:23], s29 offen offset:1024 sc1
    s_cbranch_vccnz main_kernel_slowx7
main_kernel_backx7:
    v_accvgpr_write_b32 a56, v168
    v_mfma_f32_16x16x32_bf16 v[68:71], v[20:23], a[48:51], v[68:71]
    ds_read_b128 v[52:55], v3 offset:46080
    s_add_u32 s30, s24, 1835008
    v_accvgpr_write_b32 a57, v169
    v_mfma_f32_16x16x32_bf16 v[76:79], v[20:23], a[52:55], v[76:79]
    buffer_load_dwordx4 v[144:147], v3, s[20:23], s30 offen offset:0 sc1
    v_accvgpr_write_b32 a58, v172
    v_mfma_f32_16x16x32_bf16 v[80:83], v[24:27], a[48:51], v[80:83]
    ds_read_b128 v[56:59], v3 offset:47104
    v_accvgpr_write_b32 a59, v173
    v_accvgpr_write_b32 a60, v170
    v_mfma_f32_16x16x32_bf16 v[88:91], v[24:27], a[52:55], v[88:91]
    buffer_load_dwordx4 v[148:151], v3, s[20:23], s30 offen offset:1024 sc1
    v_accvgpr_write_b32 a61, v171
    v_mfma_f32_16x16x32_bf16 v[84:87], v[28:31], a[48:51], v[84:87]
    ds_read_b128 v[60:63], v3 offset:48128
    s_add_u32 m0, s57, 114688
    v_accvgpr_write_b32 a62, v174
    v_mfma_f32_16x16x32_bf16 v[92:95], v[28:31], a[52:55], v[92:95]
    s_waitcnt lgkmcnt(4) vmcnt(12)
    v_accvgpr_write_b32 a63, v175
    v_bitop3_b32 v9, v176, v180, 1 bitop3:0x80
    v_cmp_eq_u32 vcc, 0, v9
    v_mfma_f32_16x16x32_bf16 v[96:99], v[32:35], a[48:51], v[96:99]
    ds_read_b128 v[16:19], v3 offset:49152
    s_cbranch_vccnz main_kernel_slowx8
main_kernel_backx8:
    v_accvgpr_write_b32 a64, v176
    v_accvgpr_write_b32 a65, v177
    v_mfma_f32_16x16x32_bf16 v[104:107], v[32:35], a[52:55], v[104:107]
    buffer_load_dwordx4 v0, s[20:23], m0 offen offset:0 sc1 lds
    v_accvgpr_write_b32 a66, v180
    v_mfma_f32_16x16x32_bf16 v[100:103], v[36:39], a[48:51], v[100:103]
    ds_read_b128 v[20:23], v3 offset:50176
    v_accvgpr_write_b32 a67, v181
    v_accvgpr_write_b32 a68, v178
    v_mfma_f32_16x16x32_bf16 v[108:111], v[36:39], a[52:55], v[108:111]
    buffer_load_dwordx4 v0, s[20:23], m0 offen offset:1024 sc1 lds
    v_accvgpr_write_b32 a69, v179
    v_mfma_f32_16x16x32_bf16 v[64:67], v[40:43], a[56:59], v[64:67]
    ds_read_b128 v[24:27], v3 offset:51200
    s_add_u32 s27, s24, 1966080
    v_accvgpr_write_b32 a70, v182
    v_mfma_f32_16x16x32_bf16 v[72:75], v[40:43], a[60:63], v[72:75]
    buffer_load_dwordx4 v[152:155], v3, s[20:23], s27 offen offset:0 sc1
    v_accvgpr_write_b32 a71, v183
    v_mfma_f32_16x16x32_bf16 v[68:71], v[44:47], a[56:59], v[68:71]
    ds_read_b128 v[28:31], v3 offset:52224
    v_bitop3_b32 v206, v208, v212, 1 bitop3:0x80
    v_bitop3_b32 v206, v216, v220, v206 bitop3:0x80
    v_mfma_f32_16x16x32_bf16 v[76:79], v[44:47], a[60:63], v[76:79]
    s_waitcnt lgkmcnt(4)
    v_cmp_eq_u32 vcc, 0, v206
    v_mfma_f32_16x16x32_bf16 v[80:83], v[48:51], a[56:59], v[80:83]
    ds_read_b128 v[32:35], v3 offset:53248
    s_cbranch_vccnz main_kernel_slowxr
main_kernel_backxr:
    v_lshlrev_b32 v224, 16, v208
    v_and_b32 v225, 0xffff0000, v208
    v_mfma_f32_16x16x32_bf16 v[88:91], v[48:51], a[60:63], v[88:91]
    buffer_load_dwordx4 v[156:159], v3, s[20:23], s27 offen offset:1024 sc1
    v_lshlrev_b32 v226, 16, v209
    v_mfma_f32_16x16x32_bf16 v[84:87], v[52:55], a[56:59], v[84:87]
    ds_read_b128 v[36:39], v3 offset:54272
    v_and_b32 v227, 0xffff0000, v209
    v_lshlrev_b32 v232, 16, v210
    v_mfma_f32_16x16x32_bf16 v[92:95], v[52:55], a[60:63], v[92:95]
    buffer_load_dwordx4 v0, s[20:23], m0 offen offset:2048 sc1 lds
    v_and_b32 v233, 0xffff0000, v210
    v_mfma_f32_16x16x32_bf16 v[96:99], v[56:59], a[56:59], v[96:99]
    ds_read_b128 v[40:43], v3 offset:55296
    v_lshlrev_b32 v234, 16, v211
    v_and_b32 v235, 0xffff0000, v211
    v_mfma_f32_16x16x32_bf16 v[104:107], v[56:59], a[60:63], v[104:107]
    buffer_load_dwordx4 v0, s[20:23], m0 offen offset:3072 sc1 lds
    v_lshlrev_b32 v228, 16, v212
    v_mfma_f32_16x16x32_bf16 v[100:103], v[60:63], a[56:59], v[100:103]
    ds_read_b128 v[44:47], v3 offset:56320
    s_add_u32 s28, s24, 2097152
    v_and_b32 v229, 0xffff0000, v212
    v_mfma_f32_16x16x32_bf16 v[108:111], v[60:63], a[60:63], v[108:111]
    s_waitcnt lgkmcnt(4) vmcnt(16)
    v_bitop3_b32 v9, v184, v188, 1 bitop3:0x80
    v_cmp_eq_u32 vcc, 0, v9
    v_lshlrev_b32 v230, 16, v213
    v_mfma_f32_16x16x32_bf16 v[64:67], v[16:19], a[64:67], v[64:67]
    ds_read_b128 v[48:51], v3 offset:57344
    s_cbranch_vccnz main_kernel_slowx9
main_kernel_backx9:
    v_accvgpr_write_b32 a72, v184
    v_accvgpr_write_b32 a73, v185
    v_mfma_f32_16x16x32_bf16 v[72:75], v[16:19], a[68:71], v[72:75]
    buffer_load_dwordx4 v[160:163], v3, s[20:23], s28 offen offset:0 sc1
    v_accvgpr_write_b32 a74, v188
    v_mfma_f32_16x16x32_bf16 v[68:71], v[20:23], a[64:67], v[68:71]
    ds_read_b128 v[52:55], v3 offset:58368
    v_accvgpr_write_b32 a75, v189
    v_accvgpr_write_b32 a76, v186
    v_mfma_f32_16x16x32_bf16 v[76:79], v[20:23], a[68:71], v[76:79]
    buffer_load_dwordx4 v[164:167], v3, s[20:23], s28 offen offset:1024 sc1
    v_accvgpr_write_b32 a77, v187
    v_mfma_f32_16x16x32_bf16 v[80:83], v[24:27], a[64:67], v[80:83]
    ds_read_b128 v[56:59], v3 offset:59392
    s_add_u32 s29, s24, 2228224
    v_accvgpr_write_b32 a78, v190
    v_mfma_f32_16x16x32_bf16 v[88:91], v[24:27], a[68:71], v[88:91]
    buffer_load_dwordx4 v[168:171], v3, s[20:23], s29 offen offset:0 sc1
    v_accvgpr_write_b32 a79, v191
    v_mfma_f32_16x16x32_bf16 v[84:87], v[28:31], a[64:67], v[84:87]
    ds_read_b128 v[60:63], v3 offset:60416
    v_and_b32 v231, 0xffff0000, v213
    v_lshlrev_b32 v236, 16, v214
    v_mfma_f32_16x16x32_bf16 v[92:95], v[28:31], a[68:71], v[92:95]
    s_waitcnt lgkmcnt(4) vmcnt(17)
    v_bitop3_b32 v9, v112, v116, 1 bitop3:0x80
    v_cmp_eq_u32 vcc, 0, v9
    v_and_b32 v237, 0xffff0000, v214
    v_mfma_f32_16x16x32_bf16 v[96:99], v[32:35], a[64:67], v[96:99]
    ds_read_b128 v[16:19], v3 offset:61440
    s_cbranch_vccnz main_kernel_slowx10
main_kernel_backx10:
    v_accvgpr_write_b32 a80, v112
    v_accvgpr_write_b32 a81, v113
    v_mfma_f32_16x16x32_bf16 v[104:107], v[32:35], a[68:71], v[104:107]
    buffer_load_dwordx4 v[172:175], v3, s[20:23], s29 offen offset:1024 sc1
    v_accvgpr_write_b32 a82, v116
    v_mfma_f32_16x16x32_bf16 v[100:103], v[36:39], a[64:67], v[100:103]
    ds_read_b128 v[20:23], v3 offset:62464
    s_add_u32 s30, s24, 2359296
    v_accvgpr_write_b32 a83, v117
    v_mfma_f32_16x16x32_bf16 v[108:111], v[36:39], a[68:71], v[108:111]
    v_accvgpr_write_b32 a84, v114
    v_accvgpr_write_b32 a85, v115
    v_accvgpr_write_b32 a86, v118
    v_mfma_f32_16x16x32_bf16 v[64:67], v[40:43], a[72:75], v[64:67]
    ds_read_b128 v[24:27], v3 offset:63488
    v_accvgpr_write_b32 a87, v119
    v_lshlrev_b32 v238, 16, v215
    v_mfma_f32_16x16x32_bf16 v[72:75], v[40:43], a[76:79], v[72:75]
    buffer_load_dwordx4 v[176:179], v3, s[20:23], s30 offen offset:0 sc1
    v_and_b32 v239, 0xffff0000, v215
    v_mfma_f32_16x16x32_bf16 v[68:71], v[44:47], a[72:75], v[68:71]
    ds_read_b128 v[28:31], v3 offset:64512
    v_lshlrev_b32 v240, 16, v216
    v_and_b32 v241, 0xffff0000, v216
    v_mfma_f32_16x16x32_bf16 v[76:79], v[44:47], a[76:79], v[76:79]
    s_waitcnt lgkmcnt(4)
    s_barrier
    v_mfma_f32_16x16x32_bf16 v[80:83], v[48:51], a[72:75], v[80:83]
    ds_read_b128 v[32:35], v4 offset:0
    v_lshlrev_b32 v242, 16, v217
    v_and_b32 v243, 0xffff0000, v217
    v_mfma_f32_16x16x32_bf16 v[88:91], v[48:51], a[76:79], v[88:91]
    buffer_load_dwordx4 v[180:183], v3, s[20:23], s30 offen offset:1024 sc1
    v_lshlrev_b32 v248, 16, v218
    v_mfma_f32_16x16x32_bf16 v[84:87], v[52:55], a[72:75], v[84:87]
    ds_read_b128 v[36:39], v4 offset:1024
    v_and_b32 v249, 0xffff0000, v218
    v_lshlrev_b32 v250, 16, v219
    v_mfma_f32_16x16x32_bf16 v[92:95], v[52:55], a[76:79], v[92:95]
    v_and_b32 v251, 0xffff0000, v219
    v_lshlrev_b32 v244, 16, v220
    v_and_b32 v245, 0xffff0000, v220
    v_mfma_f32_16x16x32_bf16 v[96:99], v[56:59], a[72:75], v[96:99]
    ds_read_b128 v[40:43], v4 offset:2048
    v_lshlrev_b32 v246, 16, v221
    v_and_b32 v247, 0xffff0000, v221
    v_mfma_f32_16x16x32_bf16 v[104:107], v[56:59], a[76:79], v[104:107]
main_kernel_stub8:
    s_cbranch_execz main_kernel_ret
    v_lshlrev_b32 v252, 16, v222
    v_and_b32 v253, 0xffff0000, v222
    v_lshlrev_b32 v254, 16, v223
    v_mfma_f32_16x16x32_bf16 v[100:103], v[60:63], a[72:75], v[100:103]
    ds_read_b128 v[44:47], v4 offset:3072
    v_and_b32 v255, 0xffff0000, v223
    v_mul_f32 v204, v224, v201
    v_mfma_f32_16x16x32_bf16 v[108:111], v[60:63], a[76:79], v[108:111]
    s_waitcnt lgkmcnt(4) vmcnt(18)
    v_bitop3_b32 v9, v120, v124, 1 bitop3:0x80
    v_cmp_eq_u32 vcc, 0, v9
    v_mul_f32 v204, v204, v224
    v_mfma_f32_16x16x32_bf16 v[64:67], v[16:19], a[80:83], v[64:67]
    ds_read_b128 v[48:51], v4 offset:4096
    s_add_u32 m0, s57, 131072
    s_cbranch_vccnz main_kernel_slowx11
main_kernel_backx11:
    v_accvgpr_write_b32 a88, v120
    v_mfma_f32_16x16x32_bf16 v[72:75], v[16:19], a[84:87], v[72:75]
    buffer_load_dwordx4 v0, s[20:23], m0 offen offset:0 sc1 lds
    v_accvgpr_write_b32 a89, v121
    v_mfma_f32_16x16x32_bf16 v[68:71], v[20:23], a[80:83], v[68:71]
    ds_read_b128 v[52:55], v4 offset:5120
    v_accvgpr_write_b32 a90, v124
    v_accvgpr_write_b32 a91, v125
    v_mfma_f32_16x16x32_bf16 v[76:79], v[20:23], a[84:87], v[76:79]
    buffer_load_dwordx4 v0, s[20:23], m0 offen offset:1024 sc1 lds
    v_accvgpr_write_b32 a92, v122
    v_mfma_f32_16x16x32_bf16 v[80:83], v[24:27], a[80:83], v[80:83]
    ds_read_b128 v[56:59], v4 offset:6144
    s_add_u32 s27, s24, 2490368
    v_accvgpr_write_b32 a93, v123
    v_mfma_f32_16x16x32_bf16 v[88:91], v[24:27], a[84:87], v[88:91]
    buffer_load_dwordx4 v[184:187], v3, s[20:23], s27 offen offset:0 sc1
    v_accvgpr_write_b32 a94, v126
    v_mfma_f32_16x16x32_bf16 v[84:87], v[28:31], a[80:83], v[84:87]
    ds_read_b128 v[60:63], v4 offset:7168
    v_accvgpr_write_b32 a95, v127
    v_mul_f32 v205, v232, v201
    v_mfma_f32_16x16x32_bf16 v[92:95], v[28:31], a[84:87], v[92:95]
    s_waitcnt lgkmcnt(4) vmcnt(19)
    v_bitop3_b32 v9, v128, v132, 1 bitop3:0x80
    v_cmp_eq_u32 vcc, 0, v9
    v_mul_f32 v205, v205, v232
    v_mfma_f32_16x16x32_bf16 v[96:99], v[32:35], a[80:83], v[96:99]
    ds_read_b128 v[16:19], v4 offset:8192
    s_cbranch_vccnz main_kernel_slowx12
main_kernel_backx12:
    v_accvgpr_write_b32 a96, v128
    v_accvgpr_write_b32 a97, v129
    v_mfma_f32_16x16x32_bf16 v[104:107], v[32:35], a[84:87], v[104:107]
    buffer_load_dwordx4 v[188:191], v3, s[20:23], s27 offen offset:1024 sc1
    v_accvgpr_write_b32 a98, v132
    v_mfma_f32_16x16x32_bf16 v[100:103], v[36:39], a[80:83], v[100:103]
    ds_read_b128 v[20:23], v4 offset:9216
    s_add_u32 s28, s24, 2621440
    v_accvgpr_write_b32 a99, v133
    v_mfma_f32_16x16x32_bf16 v[108:111], v[36:39], a[84:87], v[108:111]
    v_accvgpr_write_b32 a100, v130
    v_accvgpr_write_b32 a101, v131
    v_accvgpr_write_b32 a102, v134
    v_mfma_f32_16x16x32_bf16 v[64:67], v[40:43], a[88:91], v[64:67]
    ds_read_b128 v[24:27], v4 offset:10240
    v_accvgpr_write_b32 a103, v135
    v_fmac_f32 v204, v225, v225
    v_mfma_f32_16x16x32_bf16 v[72:75], v[40:43], a[92:95], v[72:75]
    buffer_load_dwordx4 v[112:115], v3, s[20:23], s28 offen offset:0 sc1
    v_fmac_f32 v205, v233, v233
    v_mfma_f32_16x16x32_bf16 v[68:71], v[44:47], a[88:91], v[68:71]
    ds_read_b128 v[28:31], v4 offset:11264
    v_fmac_f32 v204, v226, v226
    v_fmac_f32 v205, v234, v234
    v_mfma_f32_16x16x32_bf16 v[76:79], v[44:47], a[92:95], v[76:79]
    s_waitcnt lgkmcnt(4)
    v_fmac_f32 v204, v227, v227
    v_fmac_f32 v205, v235, v235
    v_fmac_f32 v204, v228, v228
    v_mfma_f32_16x16x32_bf16 v[80:83], v[48:51], a[88:91], v[80:83]
    ds_read_b128 v[32:35], v4 offset:12288
    v_fmac_f32 v205, v236, v236
    v_fmac_f32 v204, v229, v229
    v_mfma_f32_16x16x32_bf16 v[88:91], v[48:51], a[92:95], v[88:91]
    buffer_load_dwordx4 v[116:119], v3, s[20:23], s28 offen offset:1024 sc1
    v_fmac_f32 v205, v237, v237
    v_mfma_f32_16x16x32_bf16 v[84:87], v[52:55], a[88:91], v[84:87]
    ds_read_b128 v[36:39], v4 offset:13312
    v_fmac_f32 v204, v230, v230
    v_fmac_f32 v205, v238, v238
    v_mfma_f32_16x16x32_bf16 v[92:95], v[52:55], a[92:95], v[92:95]
    v_fmac_f32 v204, v231, v231
    v_fmac_f32 v205, v239, v239
    v_fmac_f32 v204, v240, v240
    v_mfma_f32_16x16x32_bf16 v[96:99], v[56:59], a[88:91], v[96:99]
    ds_read_b128 v[40:43], v4 offset:14336
    v_fmac_f32 v205, v248, v248
    v_fmac_f32 v204, v241, v241
    v_mfma_f32_16x16x32_bf16 v[104:107], v[56:59], a[92:95], v[104:107]
    buffer_load_dwordx4 v0, s[20:23], m0 offen offset:2048 sc1 lds
    v_fmac_f32 v205, v249, v249
    v_mfma_f32_16x16x32_bf16 v[100:103], v[60:63], a[88:91], v[100:103]
    ds_read_b128 v[44:47], v4 offset:15360
    v_fmac_f32 v204, v242, v242
    v_fmac_f32 v205, v250, v250
    v_mfma_f32_16x16x32_bf16 v[108:111], v[60:63], a[92:95], v[108:111]
    s_waitcnt lgkmcnt(4) vmcnt(21)
    v_bitop3_b32 v9, v136, v140, 1 bitop3:0x80
    v_cmp_eq_u32 vcc, 0, v9
    v_fmac_f32 v204, v243, v243
    v_mfma_f32_16x16x32_bf16 v[64:67], v[16:19], a[96:99], v[64:67]
    ds_read_b128 v[48:51], v4 offset:16384
    s_cbranch_vccnz main_kernel_slowx13
main_kernel_backx13:
    v_accvgpr_write_b32 a104, v136
    v_accvgpr_write_b32 a105, v137
    v_mfma_f32_16x16x32_bf16 v[72:75], v[16:19], a[100:103], v[72:75]
    buffer_load_dwordx4 v0, s[20:23], m0 offen offset:3072 sc1 lds
    v_accvgpr_write_b32 a106, v140
    v_mfma_f32_16x16x32_bf16 v[68:71], v[20:23], a[96:99], v[68:71]
    ds_read_b128 v[52:55], v4 offset:17408
    s_add_u32 s29, s24, 2752512
    v_accvgpr_write_b32 a107, v141
    v_mfma_f32_16x16x32_bf16 v[76:79], v[20:23], a[100:103], v[76:79]
    buffer_load_dwordx4 v[120:123], v3, s[20:23], s29 offen offset:0 sc1
    v_accvgpr_write_b32 a108, v138
    v_mfma_f32_16x16x32_bf16 v[80:83], v[24:27], a[96:99], v[80:83]
    ds_read_b128 v[56:59], v4 offset:18432
    v_accvgpr_write_b32 a109, v139
    v_accvgpr_write_b32 a110, v142
    v_mfma_f32_16x16x32_bf16 v[88:91], v[24:27], a[100:103], v[88:91]
    buffer_load_dwordx4 v[124:127], v3, s[20:23], s29 offen offset:1024 sc1
    v_accvgpr_write_b32 a111, v143
    v_mfma_f32_16x16x32_bf16 v[84:87], v[28:31], a[96:99], v[84:87]
    ds_read_b128 v[60:63], v4 offset:19456
    s_add_u32 m0, s57, 147456
    v_fmac_f32 v205, v251, v251
    v_mfma_f32_16x16x32_bf16 v[92:95], v[28:31], a[100:103], v[92:95]
    s_waitcnt lgkmcnt(4) vmcnt(22)
    v_bitop3_b32 v9, v144, v148, 1 bitop3:0x80
    v_cmp_eq_u32 vcc, 0, v9
    v_fmac_f32 v204, v244, v244
    v_mfma_f32_16x16x32_bf16 v[96:99], v[32:35], a[96:99], v[96:99]
    ds_read_b128 v[16:19], v4 offset:20480
    s_cbranch_vccnz main_kernel_slowx14
main_kernel_backx14:
    v_accvgpr_write_b32 a112, v144
    v_accvgpr_write_b32 a113, v145
    v_mfma_f32_16x16x32_bf16 v[104:107], v[32:35], a[100:103], v[104:107]
    buffer_load_dwordx4 v0, s[20:23], m0 offen offset:0 sc1 lds
    v_accvgpr_write_b32 a114, v148
    v_mfma_f32_16x16x32_bf16 v[100:103], v[36:39], a[96:99], v[100:103]
    ds_read_b128 v[20:23], v4 offset:21504
    v_accvgpr_write_b32 a115, v149
    v_accvgpr_write_b32 a116, v146
    v_mfma_f32_16x16x32_bf16 v[108:111], v[36:39], a[100:103], v[108:111]
    buffer_load_dwordx4 v0, s[20:23], m0 offen offset:1024 sc1 lds
    v_accvgpr_write_b32 a117, v147
    v_mfma_f32_16x16x32_bf16 v[64:67], v[40:43], a[104:107], v[64:67]
    ds_read_b128 v[24:27], v4 offset:22528
    v_accvgpr_write_b32 a118, v150
    v_accvgpr_write_b32 a119, v151
    v_mfma_f32_16x16x32_bf16 v[72:75], v[40:43], a[108:111], v[72:75]
    buffer_load_dwordx4 v0, s[20:23], m0 offen offset:2048 sc1 lds
    v_fmac_f32 v205, v252, v252
    v_mfma_f32_16x16x32_bf16 v[68:71], v[44:47], a[104:107], v[68:71]
    ds_read_b128 v[28:31], v4 offset:23552
    v_fmac_f32 v204, v245, v245
    v_fmac_f32 v205, v253, v253
    v_mfma_f32_16x16x32_bf16 v[76:79], v[44:47], a[108:111], v[76:79]
    s_waitcnt lgkmcnt(4)
    v_fmac_f32 v204, v246, v246
    v_fmac_f32 v205, v254, v254
    v_fmac_f32 v204, v247, v247
    v_mfma_f32_16x16x32_bf16 v[80:83], v[48:51], a[104:107], v[80:83]
    ds_read_b128 v[32:35], v4 offset:24576
    v_fmac_f32 v205, v255, v255
    s_nop 1
    v_permlane32_swap_b32 v204, v205
    v_mfma_f32_16x16x32_bf16 v[88:91], v[48:51], a[108:111], v[88:91]
    buffer_load_dwordx4 v0, s[20:23], m0 offen offset:3072 sc1 lds
    v_add_u32 v0, 163840, v0
    v_mfma_f32_16x16x32_bf16 v[84:87], v[52:55], a[104:107], v[84:87]
    ds_read_b128 v[36:39], v4 offset:25600
    s_add_u32 s30, s24, 2883584
    v_mfma_f32_16x16x32_bf16 v[92:95], v[52:55], a[108:111], v[92:95]
    v_add_f32 v204, v204, v205
    v_mfma_f32_16x16x32_bf16 v[96:99], v[56:59], a[104:107], v[96:99]
    ds_read_b128 v[40:43], v4 offset:26624
    v_mov_b32 v205, v204
    v_mfma_f32_16x16x32_bf16 v[104:107], v[56:59], a[108:111], v[104:107]
    buffer_load_dwordx4 v[128:131], v3, s[20:23], s30 offen offset:0 sc1
    v_mfma_f32_16x16x32_bf16 v[100:103], v[60:63], a[104:107], v[100:103]
    ds_read_b128 v[44:47], v4 offset:27648
    v_permlane16_swap_b32 v204, v205
    v_mfma_f32_16x16x32_bf16 v[108:111], v[60:63], a[108:111], v[108:111]
    s_waitcnt lgkmcnt(4) vmcnt(23)
    v_bitop3_b32 v9, v152, v156, 1 bitop3:0x80
    v_cmp_eq_u32 vcc, 0, v9
    v_mfma_f32_16x16x32_bf16 v[64:67], v[16:19], a[112:115], v[64:67]
    ds_read_b128 v[48:51], v4 offset:28672
    s_cbranch_vccnz main_kernel_slowx15
main_kernel_backx15:
    v_accvgpr_write_b32 a120, v152
    v_accvgpr_write_b32 a121, v153
    v_mfma_f32_16x16x32_bf16 v[72:75], v[16:19], a[116:119], v[72:75]
    buffer_load_dwordx4 v[132:135], v3, s[20:23], s30 offen offset:1024 sc1
    v_accvgpr_write_b32 a122, v156
    v_mfma_f32_16x16x32_bf16 v[68:71], v[20:23], a[112:115], v[68:71]
    ds_read_b128 v[52:55], v4 offset:29696
    s_add_u32 s27, s24, 3014656
    v_accvgpr_write_b32 a123, v157
    v_mfma_f32_16x16x32_bf16 v[76:79], v[20:23], a[116:119], v[76:79]
    v_accvgpr_write_b32 a124, v154
    v_accvgpr_write_b32 a125, v155
    v_accvgpr_write_b32 a126, v158
    v_mfma_f32_16x16x32_bf16 v[80:83], v[24:27], a[112:115], v[80:83]
    ds_read_b128 v[56:59], v4 offset:30720
    v_accvgpr_write_b32 a127, v159
    v_mfma_f32_16x16x32_bf16 v[88:91], v[24:27], a[116:119], v[88:91]
    buffer_load_dwordx4 v[136:139], v3, s[20:23], s27 offen offset:0 sc1
    v_mfma_f32_16x16x32_bf16 v[84:87], v[28:31], a[112:115], v[84:87]
    ds_read_b128 v[60:63], v4 offset:31744
    v_add_f32 v204, v204, v205
    v_mfma_f32_16x16x32_bf16 v[92:95], v[28:31], a[116:119], v[92:95]
    s_waitcnt lgkmcnt(4) vmcnt(21)
    s_barrier
    v_mfma_f32_16x16x32_bf16 v[96:99], v[32:35], a[112:115], v[96:99]
    ds_read_b128 v[16:19], v4 offset:32768
    v_bitop3_b32 v9, v160, v164, 1 bitop3:0x80
    v_cmp_eq_u32 vcc, 0, v9
    v_mfma_f32_16x16x32_bf16 v[104:107], v[32:35], a[116:119], v[104:107]
    buffer_load_dwordx4 v[140:143], v3, s[20:23], s27 offen offset:1024 sc1
    s_cbranch_vccnz main_kernel_slowx16
main_kernel_backx16:
    v_accvgpr_write_b32 a128, v160
    v_mfma_f32_16x16x32_bf16 v[100:103], v[36:39], a[112:115], v[100:103]
    ds_read_b128 v[20:23], v4 offset:33792
    s_add_u32 s28, s24, 3145728
    v_accvgpr_write_b32 a129, v161
    v_mfma_f32_16x16x32_bf16 v[108:111], v[36:39], a[116:119], v[108:111]
    v_accvgpr_write_b32 a130, v164
    v_accvgpr_write_b32 a131, v165
    v_accvgpr_write_b32 a132, v162
    v_mfma_f32_16x16x32_bf16 v[64:67], v[40:43], a[120:123], v[64:67]
    ds_read_b128 v[24:27], v4 offset:34816
    v_accvgpr_write_b32 a133, v163
    v_mfma_f32_16x16x32_bf16 v[72:75], v[40:43], a[124:127], v[72:75]
    buffer_load_dwordx4 v[144:147], v3, s[20:23], s28 offen offset:0 sc1
    v_mfma_f32_16x16x32_bf16 v[68:71], v[44:47], a[120:123], v[68:71]
    ds_read_b128 v[28:31], v4 offset:35840
    v_accvgpr_write_b32 a134, v166
    v_mfma_f32_16x16x32_bf16 v[76:79], v[44:47], a[124:127], v[76:79]
    s_waitcnt lgkmcnt(4)
    v_accvgpr_write_b32 a135, v167
    v_mul_f32 v204, 0x45800000, v204
    v_mfma_f32_16x16x32_bf16 v[80:83], v[48:51], a[120:123], v[80:83]
    ds_read_b128 v[32:35], v4 offset:36864
    v_cvt_f64_f32 v[204:205], v204
    v_mfma_f32_16x16x32_bf16 v[88:91], v[48:51], a[124:127], v[88:91]
    buffer_load_dwordx4 v[148:151], v3, s[20:23], s28 offen offset:1024 sc1
    v_mfma_f32_16x16x32_bf16 v[84:87], v[52:55], a[120:123], v[84:87]
    ds_read_b128 v[36:39], v4 offset:37888
    s_add_u32 m0, s57, 0
    v_mfma_f32_16x16x32_bf16 v[92:95], v[52:55], a[124:127], v[92:95]
    v_add_f64 v[204:205], v[204:205], s[100:101]
    v_mfma_f32_16x16x32_bf16 v[96:99], v[56:59], a[120:123], v[96:99]
    ds_read_b128 v[40:43], v4 offset:38912
    v_mfma_f32_16x16x32_bf16 v[104:107], v[56:59], a[124:127], v[104:107]
    buffer_load_dwordx4 v0, s[20:23], m0 offen offset:0 sc1 lds
    v_mfma_f32_16x16x32_bf16 v[100:103], v[60:63], a[120:123], v[100:103]
    ds_read_b128 v[44:47], v4 offset:39936
    v_mfma_f32_16x16x32_bf16 v[108:111], v[60:63], a[124:127], v[108:111]
    s_waitcnt lgkmcnt(4) vmcnt(23)
    v_bitop3_b32 v9, v168, v172, 1 bitop3:0x80
    v_cmp_eq_u32 vcc, 0, v9
    v_mfma_f32_16x16x32_bf16 v[64:67], v[16:19], a[128:131], v[64:67]
    ds_read_b128 v[48:51], v4 offset:40960
    s_cbranch_vccnz main_kernel_slowx17
main_kernel_backx17:
    v_accvgpr_write_b32 a136, v168
    v_accvgpr_write_b32 a137, v169
    v_mfma_f32_16x16x32_bf16 v[72:75], v[16:19], a[132:135], v[72:75]
    buffer_load_dwordx4 v0, s[20:23], m0 offen offset:1024 sc1 lds
    v_mfma_f32_16x16x32_bf16 v[68:71], v[20:23], a[128:131], v[68:71]
    ds_read_b128 v[52:55], v4 offset:41984
    v_accvgpr_write_b32 a138, v172
    v_mfma_f32_16x16x32_bf16 v[76:79], v[20:23], a[132:135], v[76:79]
    buffer_atomic_add_f64 v[204:205], v200, s[20:23], s56 offen
    v_mfma_f32_16x16x32_bf16 v[80:83], v[24:27], a[128:131], v[80:83]
    ds_read_b128 v[56:59], v4 offset:43008
    s_add_u32 s29, s24, 3276800
    v_mfma_f32_16x16x32_bf16 v[88:91], v[24:27], a[132:135], v[88:91]
    buffer_load_dwordx4 v[152:155], v3, s[20:23], s29 offen offset:0 sc1
    v_mfma_f32_16x16x32_bf16 v[84:87], v[28:31], a[128:131], v[84:87]
    ds_read_b128 v[60:63], v4 offset:44032
    v_accvgpr_write_b32 a139, v173
    v_mfma_f32_16x16x32_bf16 v[92:95], v[28:31], a[132:135], v[92:95]
    s_waitcnt lgkmcnt(4) vmcnt(24)
    v_accvgpr_write_b32 a140, v170
    v_accvgpr_write_b32 a141, v171
    v_mfma_f32_16x16x32_bf16 v[96:99], v[32:35], a[128:131], v[96:99]
    ds_read_b128 v[16:19], v4 offset:45056
    v_accvgpr_write_b32 a142, v174
    v_accvgpr_write_b32 a143, v175
    v_mfma_f32_16x16x32_bf16 v[104:107], v[32:35], a[132:135], v[104:107]
    buffer_load_dwordx4 v[156:159], v3, s[20:23], s29 offen offset:1024 sc1
    v_bitop3_b32 v9, v176, v180, 1 bitop3:0x80
    v_mfma_f32_16x16x32_bf16 v[100:103], v[36:39], a[128:131], v[100:103]
    ds_read_b128 v[20:23], v4 offset:46080
    v_cmp_eq_u32 vcc, 0, v9
    v_mfma_f32_16x16x32_bf16 v[108:111], v[36:39], a[132:135], v[108:111]
    buffer_load_dwordx4 v0, s[20:23], m0 offen offset:2048 sc1 lds
    s_cbranch_vccnz main_kernel_slowx18
main_kernel_backx18:
    v_accvgpr_write_b32 a144, v176
    v_mfma_f32_16x16x32_bf16 v[64:67], v[40:43], a[136:139], v[64:67]
    ds_read_b128 v[24:27], v4 offset:47104
    v_accvgpr_write_b32 a145, v177
    v_mfma_f32_16x16x32_bf16 v[72:75], v[40:43], a[140:143], v[72:75]
    buffer_load_dwordx4 v0, s[20:23], m0 offen offset:3072 sc1 lds
    v_mfma_f32_16x16x32_bf16 v[68:71], v[44:47], a[136:139], v[68:71]
    ds_read_b128 v[28:31], v4 offset:48128
    s_add_u32 s30, s24, 3407872
    v_mfma_f32_16x16x32_bf16 v[76:79], v[44:47], a[140:143], v[76:79]
    s_waitcnt lgkmcnt(4)
    v_accvgpr_write_b32 a146, v180
    v_accvgpr_write_b32 a147, v181
    v_mfma_f32_16x16x32_bf16 v[80:83], v[48:51], a[136:139], v[80:83]
    ds_read_b128 v[32:35], v4 offset:49152
    v_accvgpr_write_b32 a148, v178
    v_mfma_f32_16x16x32_bf16 v[88:91], v[48:51], a[140:143], v[88:91]
    buffer_load_dwordx4 v[160:163], v3, s[20:23], s30 offen offset:0 sc1
    v_mfma_f32_16x16x32_bf16 v[84:87], v[52:55], a[136:139], v[84:87]
    ds_read_b128 v[36:39], v4 offset:50176
    v_accvgpr_write_b32 a149, v179
    v_mfma_f32_16x16x32_bf16 v[92:95], v[52:55], a[140:143], v[92:95]
    buffer_load_dwordx4 v[164:167], v3, s[20:23], s30 offen offset:1024 sc1
    v_mfma_f32_16x16x32_bf16 v[96:99], v[56:59], a[136:139], v[96:99]
    ds_read_b128 v[40:43], v4 offset:51200
    s_add_u32 m0, s57, 16384
    v_mfma_f32_16x16x32_bf16 v[104:107], v[56:59], a[140:143], v[104:107]
    buffer_load_dwordx4 v0, s[20:23], m0 offen offset:0 sc1 lds
    v_mfma_f32_16x16x32_bf16 v[100:103], v[60:63], a[136:139], v[100:103]
    ds_read_b128 v[44:47], v4 offset:52224
    v_accvgpr_write_b32 a150, v182
    v_mfma_f32_16x16x32_bf16 v[108:111], v[60:63], a[140:143], v[108:111]
    s_waitcnt lgkmcnt(4) vmcnt(26)
    v_accvgpr_write_b32 a151, v183
    v_bitop3_b32 v9, v184, v188, 1 bitop3:0x80
    v_mfma_f32_16x16x32_bf16 v[64:67], v[16:19], a[144:147], v[64:67]
    ds_read_b128 v[48:51], v4 offset:53248
    v_cmp_eq_u32 vcc, 0, v9
    v_mfma_f32_16x16x32_bf16 v[72:75], v[16:19], a[148:151], v[72:75]
    buffer_load_dwordx4 v0, s[20:23], m0 offen offset:1024 sc1 lds
    s_cbranch_vccnz main_kernel_slowx19
main_kernel_backx19:
    v_accvgpr_write_b32 a152, v184
    v_mfma_f32_16x16x32_bf16 v[68:71], v[20:23], a[144:147], v[68:71]
    ds_read_b128 v[52:55], v4 offset:54272
    s_add_u32 s27, s24, 3538944
    v_mfma_f32_16x16x32_bf16 v[76:79], v[20:23], a[148:151], v[76:79]
    buffer_load_dwordx4 v[168:171], v3, s[20:23], s27 offen offset:0 sc1
    v_mfma_f32_16x16x32_bf16 v[80:83], v[24:27], a[144:147], v[80:83]
    ds_read_b128 v[56:59], v4 offset:55296
    v_accvgpr_write_b32 a153, v185
    v_mfma_f32_16x16x32_bf16 v[88:91], v[24:27], a[148:151], v[88:91]
    buffer_load_dwordx4 v[172:175], v3, s[20:23], s27 offen offset:1024 sc1
    v_mfma_f32_16x16x32_bf16 v[84:87], v[28:31], a[144:147], v[84:87]
    ds_read_b128 v[60:63], v4 offset:56320
    v_accvgpr_write_b32 a154, v188
    v_mfma_f32_16x16x32_bf16 v[92:95], v[28:31], a[148:151], v[92:95]
    s_waitcnt lgkmcnt(4) vmcnt(27)
    v_accvgpr_write_b32 a155, v189
    v_accvgpr_write_b32 a156, v186
    v_mfma_f32_16x16x32_bf16 v[96:99], v[32:35], a[144:147], v[96:99]
    ds_read_b128 v[16:19], v4 offset:57344
    v_accvgpr_write_b32 a157, v187
    v_accvgpr_write_b32 a158, v190
    v_mfma_f32_16x16x32_bf16 v[104:107], v[32:35], a[148:151], v[104:107]
    buffer_load_dwordx4 v0, s[20:23], m0 offen offset:2048 sc1 lds
    v_accvgpr_write_b32 a159, v191
    v_mfma_f32_16x16x32_bf16 v[100:103], v[36:39], a[144:147], v[100:103]
    ds_read_b128 v[20:23], v4 offset:58368
    v_bitop3_b32 v9, v112, v116, 1 bitop3:0x80
    v_cmp_eq_u32 vcc, 0, v9
    v_mfma_f32_16x16x32_bf16 v[108:111], v[36:39], a[148:151], v[108:111]
    buffer_load_dwordx4 v0, s[20:23], m0 offen offset:3072 sc1 lds
    s_cbranch_vccnz main_kernel_slowx20
main_kernel_backx20:
    v_accvgpr_write_b32 a160, v112
    v_mfma_f32_16x16x32_bf16 v[64:67], v[40:43], a[152:155], v[64:67]
    ds_read_b128 v[24:27], v4 offset:59392
    s_add_u32 s28, s24, 3670016
    v_mfma_f32_16x16x32_bf16 v[72:75], v[40:43], a[156:159], v[72:75]
    buffer_load_dwordx4 v[176:179], v3, s[20:23], s28 offen offset:0 sc1
    v_mfma_f32_16x16x32_bf16 v[68:71], v[44:47], a[152:155], v[68:71]
    ds_read_b128 v[28:31], v4 offset:60416
    v_accvgpr_write_b32 a161, v113
    v_mfma_f32_16x16x32_bf16 v[76:79], v[44:47], a[156:159], v[76:79]
    s_waitcnt lgkmcnt(4)
    v_accvgpr_write_b32 a162, v116
    v_accvgpr_write_b32 a163, v117
    v_mfma_f32_16x16x32_bf16 v[80:83], v[48:51], a[152:155], v[80:83]
    ds_read_b128 v[32:35], v4 offset:61440
    v_accvgpr_write_b32 a164, v114
    v_mfma_f32_16x16x32_bf16 v[88:91], v[48:51], a[156:159], v[88:91]
    buffer_load_dwordx4 v[180:183], v3, s[20:23], s28 offen offset:1024 sc1
    v_mfma_f32_16x16x32_bf16 v[84:87], v[52:55], a[152:155], v[84:87]
    ds_read_b128 v[36:39], v4 offset:62464
    v_accvgpr_write_b32 a165, v115
    v_mfma_f32_16x16x32_bf16 v[92:95], v[52:55], a[156:159], v[92:95]
    v_accvgpr_write_b32 a166, v118
    v_accvgpr_write_b32 a167, v119
    v_mfma_f32_16x16x32_bf16 v[96:99], v[56:59], a[152:155], v[96:99]
    ds_read_b128 v[40:43], v4 offset:63488
    v_mfma_f32_16x16x32_bf16 v[104:107], v[56:59], a[156:159], v[104:107]
    v_mfma_f32_16x16x32_bf16 v[100:103], v[60:63], a[152:155], v[100:103]
    ds_read_b128 v[44:47], v4 offset:64512
    v_mfma_f32_16x16x32_bf16 v[108:111], v[60:63], a[156:159], v[108:111]
    s_waitcnt lgkmcnt(4) vmcnt(23)
    s_barrier
    v_mfma_f32_16x16x32_bf16 v[64:67], v[16:19], a[160:163], v[64:67]
    ds_read_b128 v[48:51], v5 offset:0
    s_add_u32 s29, s24, 3801088
    v_bitop3_b32 v9, v120, v124, 1 bitop3:0x80
    v_mfma_f32_16x16x32_bf16 v[72:75], v[16:19], a[164:167], v[72:75]
    buffer_load_dwordx4 v[184:187], v3, s[20:23], s29 offen offset:0 sc1
    v_cmp_eq_u32 vcc, 0, v9
    v_mfma_f32_16x16x32_bf16 v[68:71], v[20:23], a[160:163], v[68:71]
    ds_read_b128 v[52:55], v5 offset:1024
    s_cbranch_vccnz main_kernel_slowx21
main_kernel_backx21:
    v_accvgpr_write_b32 a168, v120
    v_accvgpr_write_b32 a169, v121
    v_mfma_f32_16x16x32_bf16 v[76:79], v[20:23], a[164:167], v[76:79]
    v_accvgpr_write_b32 a170, v124
    v_accvgpr_write_b32 a171, v125
    v_mfma_f32_16x16x32_bf16 v[80:83], v[24:27], a[160:163], v[80:83]
    ds_read_b128 v[56:59], v5 offset:2048
    v_accvgpr_write_b32 a172, v122
    v_mfma_f32_16x16x32_bf16 v[88:91], v[24:27], a[164:167], v[88:91]
    buffer_load_dwordx4 v[188:191], v3, s[20:23], s29 offen offset:1024 sc1
    v_mfma_f32_16x16x32_bf16 v[84:87], v[28:31], a[160:163], v[84:87]
    ds_read_b128 v[60:63], v5 offset:3072
    v_accvgpr_write_b32 a173, v123
    v_mfma_f32_16x16x32_bf16 v[92:95], v[28:31], a[164:167], v[92:95]
    s_waitcnt lgkmcnt(4) vmcnt(23)
    v_accvgpr_write_b32 a174, v126
    v_accvgpr_write_b32 a175, v127
    v_mfma_f32_16x16x32_bf16 v[96:99], v[32:35], a[160:163], v[96:99]
    ds_read_b128 v[16:19], v5 offset:4096
    s_add_u32 m0, s57, 32768
    v_bitop3_b32 v9, v128, v132, 1 bitop3:0x80
    v_mfma_f32_16x16x32_bf16 v[104:107], v[32:35], a[164:167], v[104:107]
    buffer_load_dwordx4 v0, s[20:23], m0 offen offset:0 sc1 lds
    v_cmp_eq_u32 vcc, 0, v9
    v_mfma_f32_16x16x32_bf16 v[100:103], v[36:39], a[160:163], v[100:103]
    ds_read_b128 v[20:23], v5 offset:5120
    s_cbranch_vccnz main_kernel_slowx22
main_kernel_backx22:
    v_accvgpr_write_b32 a176, v128
    v_accvgpr_write_b32 a177, v129
    v_mfma_f32_16x16x32_bf16 v[108:111], v[36:39], a[164:167], v[108:111]
    buffer_load_dwordx4 v0, s[20:23], m0 offen offset:1024 sc1 lds
    v_mfma_f32_16x16x32_bf16 v[64:67], v[40:43], a[168:171], v[64:67]
    ds_read_b128 v[24:27], v5 offset:6144
    s_add_u32 s30, s24, 3932160
    v_mfma_f32_16x16x32_bf16 v[72:75], v[40:43], a[172:175], v[72:75]
    buffer_load_dwordx4 v[112:115], v3, s[20:23], s30 offen offset:0 sc1
    v_mfma_f32_16x16x32_bf16 v[68:71], v[44:47], a[168:171], v[68:71]
    ds_read_b128 v[28:31], v5 offset:7168
    v_accvgpr_write_b32 a178, v132
    v_mfma_f32_16x16x32_bf16 v[76:79], v[44:47], a[172:175], v[76:79]
    s_waitcnt lgkmcnt(4)
    v_accvgpr_write_b32 a179, v133
    v_accvgpr_write_b32 a180, v130
    v_mfma_f32_16x16x32_bf16 v[80:83], v[48:51], a[168:171], v[80:83]
    ds_read_b128 v[32:35], v5 offset:8192
    v_accvgpr_write_b32 a181, v131
    v_mfma_f32_16x16x32_bf16 v[88:91], v[48:51], a[172:175], v[88:91]
    buffer_load_dwordx4 v[116:119], v3, s[20:23], s30 offen offset:1024 sc1
    v_mfma_f32_16x16x32_bf16 v[84:87], v[52:55], a[168:171], v[84:87]
    ds_read_b128 v[36:39], v5 offset:9216
    v_accvgpr_write_b32 a182, v134
    v_mfma_f32_16x16x32_bf16 v[92:95], v[52:55], a[172:175], v[92:95]
    v_accvgpr_write_b32 a183, v135
    v_mfma_f32_16x16x32_bf16 v[96:99], v[56:59], a[168:171], v[96:99]
    ds_read_b128 v[40:43], v5 offset:10240
    v_mfma_f32_16x16x32_bf16 v[104:107], v[56:59], a[172:175], v[104:107]
    v_mfma_f32_16x16x32_bf16 v[100:103], v[60:63], a[168:171], v[100:103]
    ds_read_b128 v[44:47], v5 offset:11264
    v_mfma_f32_16x16x32_bf16 v[108:111], v[60:63], a[172:175], v[108:111]
    s_waitcnt lgkmcnt(4) vmcnt(25)
    v_bitop3_b32 v9, v136, v140, 1 bitop3:0x80
    v_cmp_eq_u32 vcc, 0, v9
    v_mfma_f32_16x16x32_bf16 v[64:67], v[16:19], a[176:179], v[64:67]
    ds_read_b128 v[48:51], v5 offset:12288
    s_cbranch_vccnz main_kernel_slowx23
main_kernel_backx23:
    v_accvgpr_write_b32 a184, v136
    v_accvgpr_write_b32 a185, v137
    v_mfma_f32_16x16x32_bf16 v[72:75], v[16:19], a[180:183], v[72:75]
    buffer_load_dwordx4 v0, s[20:23], m0 offen offset:2048 sc1 lds
    v_mfma_f32_16x16x32_bf16 v[68:71], v[20:23], a[176:179], v[68:71]
    ds_read_b128 v[52:55], v5 offset:13312
    v_accvgpr_write_b32 a186, v140
    v_mfma_f32_16x16x32_bf16 v[76:79], v[20:23], a[180:183], v[76:79]
    buffer_load_dwordx4 v0, s[20:23], m0 offen offset:3072 sc1 lds
    v_mfma_f32_16x16x32_bf16 v[80:83], v[24:27], a[176:179], v[80:83]
    ds_read_b128 v[56:59], v5 offset:14336
    s_add_u32 s27, s24, 4063232
    v_mfma_f32_16x16x32_bf16 v[88:91], v[24:27], a[180:183], v[88:91]
    buffer_load_dwordx4 v[120:123], v3, s[20:23], s27 offen offset:0 sc1
    v_mfma_f32_16x16x32_bf16 v[84:87], v[28:31], a[176:179], v[84:87]
    ds_read_b128 v[60:63], v5 offset:15360
    v_accvgpr_write_b32 a187, v141
    v_mfma_f32_16x16x32_bf16 v[92:95], v[28:31], a[180:183], v[92:95]
    s_waitcnt lgkmcnt(4) vmcnt(26)
    v_accvgpr_write_b32 a188, v138
    v_accvgpr_write_b32 a189, v139
    v_mfma_f32_16x16x32_bf16 v[96:99], v[32:35], a[176:179], v[96:99]
    ds_read_b128 v[16:19], v5 offset:16384
    v_accvgpr_write_b32 a190, v142
    v_accvgpr_write_b32 a191, v143
    v_mfma_f32_16x16x32_bf16 v[104:107], v[32:35], a[180:183], v[104:107]
    buffer_load_dwordx4 v[124:127], v3, s[20:23], s27 offen offset:1024 sc1
    v_bitop3_b32 v9, v144, v148, 1 bitop3:0x80
    v_mfma_f32_16x16x32_bf16 v[100:103], v[36:39], a[176:179], v[100:103]
    ds_read_b128 v[20:23], v5 offset:17408
    s_add_u32 m0, s57, 49152
    v_cmp_eq_u32 vcc, 0, v9
    v_mfma_f32_16x16x32_bf16 v[108:111], v[36:39], a[180:183], v[108:111]
    s_cbranch_vccnz main_kernel_slowx24
main_kernel_backx24:
    v_accvgpr_write_b32 a192, v144
    v_accvgpr_write_b32 a193, v145
    v_accvgpr_write_b32 a194, v148
    v_mfma_f32_16x16x32_bf16 v[64:67], v[40:43], a[184:187], v[64:67]
    ds_read_b128 v[24:27], v5 offset:18432
    v_accvgpr_write_b32 a195, v149
    v_mfma_f32_16x16x32_bf16 v[72:75], v[40:43], a[188:191], v[72:75]
    buffer_load_dwordx4 v0, s[20:23], m0 offen offset:0 sc1 lds
    v_mfma_f32_16x16x32_bf16 v[68:71], v[44:47], a[184:187], v[68:71]
    ds_read_b128 v[28:31], v5 offset:19456
    v_accvgpr_write_b32 a196, v146
    v_mfma_f32_16x16x32_bf16 v[76:79], v[44:47], a[188:191], v[76:79]
    s_waitcnt lgkmcnt(4)
    v_accvgpr_write_b32 a197, v147
    v_accvgpr_write_b32 a198, v150
    v_mfma_f32_16x16x32_bf16 v[80:83], v[48:51], a[184:187], v[80:83]
    ds_read_b128 v[32:35], v5 offset:20480
    v_accvgpr_write_b32 a199, v151
    v_mfma_f32_16x16x32_bf16 v[88:91], v[48:51], a[188:191], v[88:91]
    buffer_load_dwordx4 v0, s[20:23], m0 offen offset:1024 sc1 lds
    v_mfma_f32_16x16x32_bf16 v[84:87], v[52:55], a[184:187], v[84:87]
    ds_read_b128 v[36:39], v5 offset:21504
    v_mfma_f32_16x16x32_bf16 v[92:95], v[52:55], a[188:191], v[92:95]
    buffer_load_dwordx4 v0, s[20:23], m0 offen offset:2048 sc1 lds
    v_mfma_f32_16x16x32_bf16 v[96:99], v[56:59], a[184:187], v[96:99]
    ds_read_b128 v[40:43], v5 offset:22528
    v_mfma_f32_16x16x32_bf16 v[104:107], v[56:59], a[188:191], v[104:107]
    buffer_load_dwordx4 v0, s[20:23], m0 offen offset:3072 sc1 lds
    v_mfma_f32_16x16x32_bf16 v[100:103], v[60:63], a[184:187], v[100:103]
    ds_read_b128 v[44:47], v5 offset:23552
    v_mfma_f32_16x16x32_bf16 v[108:111], v[60:63], a[188:191], v[108:111]
    s_waitcnt lgkmcnt(4) vmcnt(26)
    v_bitop3_b32 v9, v152, v156, 1 bitop3:0x80
    v_cmp_eq_u32 vcc, 0, v9
    v_mfma_f32_16x16x32_bf16 v[64:67], v[16:19], a[192:195], v[64:67]
    ds_read_b128 v[48:51], v5 offset:24576
    s_cbranch_vccnz main_kernel_slowx25
main_kernel_backx25:
    v_accvgpr_write_b32 a200, v152
    v_accvgpr_write_b32 a201, v153
    v_mfma_f32_16x16x32_bf16 v[72:75], v[16:19], a[196:199], v[72:75]
    v_accvgpr_write_b32 a202, v156
    v_accvgpr_write_b32 a203, v157
    v_mfma_f32_16x16x32_bf16 v[68:71], v[20:23], a[192:195], v[68:71]
main_kernel_stub9:
    s_cbranch_execz main_kernel_ret
    ds_read_b128 v[52:55], v5 offset:25600
    v_accvgpr_write_b32 a204, v154
    v_mfma_f32_16x16x32_bf16 v[76:79], v[20:23], a[196:199], v[76:79]
    v_accvgpr_write_b32 a205, v155
    v_accvgpr_write_b32 a206, v158
    v_mfma_f32_16x16x32_bf16 v[80:83], v[24:27], a[192:195], v[80:83]
    ds_read_b128 v[56:59], v5 offset:26624
    v_accvgpr_write_b32 a207, v159
    v_mfma_f32_16x16x32_bf16 v[88:91], v[24:27], a[196:199], v[88:91]
    v_mfma_f32_16x16x32_bf16 v[84:87], v[28:31], a[192:195], v[84:87]
    ds_read_b128 v[60:63], v5 offset:27648
    v_mfma_f32_16x16x32_bf16 v[92:95], v[28:31], a[196:199], v[92:95]
    s_waitcnt lgkmcnt(4) vmcnt(22)
    v_bitop3_b32 v9, v160, v164, 1 bitop3:0x80
    v_cmp_eq_u32 vcc, 0, v9
    v_mfma_f32_16x16x32_bf16 v[96:99], v[32:35], a[192:195], v[96:99]
    ds_read_b128 v[16:19], v5 offset:28672
    s_cbranch_vccnz main_kernel_slowx26
main_kernel_backx26:
    v_accvgpr_write_b32 a208, v160
    v_accvgpr_write_b32 a209, v161
    v_mfma_f32_16x16x32_bf16 v[104:107], v[32:35], a[196:199], v[104:107]
    v_accvgpr_write_b32 a210, v164
    v_accvgpr_write_b32 a211, v165
    v_mfma_f32_16x16x32_bf16 v[100:103], v[36:39], a[192:195], v[100:103]
    ds_read_b128 v[20:23], v5 offset:29696
    v_accvgpr_write_b32 a212, v162
    v_mfma_f32_16x16x32_bf16 v[108:111], v[36:39], a[196:199], v[108:111]
    v_accvgpr_write_b32 a213, v163
    v_accvgpr_write_b32 a214, v166
    v_mfma_f32_16x16x32_bf16 v[64:67], v[40:43], a[200:203], v[64:67]
    ds_read_b128 v[24:27], v5 offset:30720
    v_accvgpr_write_b32 a215, v167
    v_mfma_f32_16x16x32_bf16 v[72:75], v[40:43], a[204:207], v[72:75]
    v_mfma_f32_16x16x32_bf16 v[68:71], v[44:47], a[200:203], v[68:71]
    ds_read_b128 v[28:31], v5 offset:31744
    v_mfma_f32_16x16x32_bf16 v[76:79], v[44:47], a[204:207], v[76:79]
    s_waitcnt lgkmcnt(4) vmcnt(16)
    s_barrier
    v_mfma_f32_16x16x32_bf16 v[80:83], v[48:51], a[200:203], v[80:83]
    ds_read_b128 v[32:35], v3 offset:0
    s_add_u32 m0, s57, 65536
    v_mfma_f32_16x16x32_bf16 v[88:91], v[48:51], a[204:207], v[88:91]
    buffer_load_dwordx4 v0, s[20:23], m0 offen offset:0 sc1 lds
    v_mfma_f32_16x16x32_bf16 v[84:87], v[52:55], a[200:203], v[84:87]
    ds_read_b128 v[36:39], v3 offset:1024
    v_mfma_f32_16x16x32_bf16 v[92:95], v[52:55], a[204:207], v[92:95]
    buffer_load_dwordx4 v0, s[20:23], m0 offen offset:1024 sc1 lds
    v_mfma_f32_16x16x32_bf16 v[96:99], v[56:59], a[200:203], v[96:99]
    ds_read_b128 v[40:43], v3 offset:2048
    v_mfma_f32_16x16x32_bf16 v[104:107], v[56:59], a[204:207], v[104:107]
    v_mfma_f32_16x16x32_bf16 v[100:103], v[60:63], a[200:203], v[100:103]
    ds_read_b128 v[44:47], v3 offset:3072
    v_mfma_f32_16x16x32_bf16 v[108:111], v[60:63], a[204:207], v[108:111]
    s_waitcnt lgkmcnt(4)
    v_bitop3_b32 v9, v168, v172, 1 bitop3:0x80
    v_cmp_eq_u32 vcc, 0, v9
    v_mfma_f32_16x16x32_bf16 v[64:67], v[16:19], a[208:211], v[64:67]
    ds_read_b128 v[48:51], v3 offset:4096
    s_cbranch_vccnz main_kernel_slowx27
main_kernel_backx27:
    v_accvgpr_write_b32 a216, v168
    v_accvgpr_write_b32 a217, v169
    v_mfma_f32_16x16x32_bf16 v[72:75], v[16:19], a[212:215], v[72:75]
    buffer_load_dwordx4 v[192:195], v202, s[20:23], s56 offen sc1
    v_mfma_f32_16x16x32_bf16 v[68:71], v[20:23], a[208:211], v[68:71]
    ds_read_b128 v[52:55], v3 offset:5120
    v_accvgpr_write_b32 a218, v172
    v_mfma_f32_16x16x32_bf16 v[76:79], v[20:23], a[212:215], v[76:79]
    v_accvgpr_write_b32 a219, v173
    v_accvgpr_write_b32 a220, v170
    v_mfma_f32_16x16x32_bf16 v[80:83], v[24:27], a[208:211], v[80:83]
    ds_read_b128 v[56:59], v3 offset:6144
    v_accvgpr_write_b32 a221, v171
    v_mfma_f32_16x16x32_bf16 v[88:91], v[24:27], a[212:215], v[88:91]
    v_accvgpr_write_b32 a222, v174
    v_accvgpr_write_b32 a223, v175
    v_mfma_f32_16x16x32_bf16 v[84:87], v[28:31], a[208:211], v[84:87]
    ds_read_b128 v[60:63], v3 offset:7168
    v_mfma_f32_16x16x32_bf16 v[92:95], v[28:31], a[212:215], v[92:95]
    s_waitcnt lgkmcnt(4) vmcnt(17)
    v_bitop3_b32 v9, v176, v180, 1 bitop3:0x80
    v_cmp_eq_u32 vcc, 0, v9
    v_mfma_f32_16x16x32_bf16 v[96:99], v[32:35], a[208:211], v[96:99]
    ds_read_b128 v[16:19], v3 offset:8192
    s_cbranch_vccnz main_kernel_slowx28
main_kernel_backx28:
    v_accvgpr_write_b32 a224, v176
    v_accvgpr_write_b32 a225, v177
    v_mfma_f32_16x16x32_bf16 v[104:107], v[32:35], a[212:215], v[104:107]
    buffer_load_dwordx4 v0, s[20:23], m0 offen offset:2048 sc1 lds
    v_mfma_f32_16x16x32_bf16 v[100:103], v[36:39], a[208:211], v[100:103]
    ds_read_b128 v[20:23], v3 offset:9216
    v_accvgpr_write_b32 a226, v180
    v_mfma_f32_16x16x32_bf16 v[108:111], v[36:39], a[212:215], v[108:111]
    v_accvgpr_write_b32 a227, v181
    v_accvgpr_write_b32 a228, v178
    v_mfma_f32_16x16x32_bf16 v[64:67], v[40:43], a[216:219], v[64:67]
    ds_read_b128 v[24:27], v3 offset:10240
    v_accvgpr_write_b32 a229, v179
    v_mfma_f32_16x16x32_bf16 v[72:75], v[40:43], a[220:223], v[72:75]
    buffer_load_dwordx4 v0, s[20:23], m0 offen offset:3072 sc1 lds
    v_mfma_f32_16x16x32_bf16 v[68:71], v[44:47], a[216:219], v[68:71]
    ds_read_b128 v[28:31], v3 offset:11264
    v_accvgpr_write_b32 a230, v182
    v_mfma_f32_16x16x32_bf16 v[76:79], v[44:47], a[220:223], v[76:79]
    s_waitcnt lgkmcnt(4)
    v_accvgpr_write_b32 a231, v183
    v_mfma_f32_16x16x32_bf16 v[80:83], v[48:51], a[216:219], v[80:83]
    ds_read_b128 v[32:35], v3 offset:12288
    s_add_u32 m0, s57, 81920
    v_mfma_f32_16x16x32_bf16 v[88:91], v[48:51], a[220:223], v[88:91]
    buffer_load_dwordx4 v0, s[20:23], m0 offen offset:0 sc1 lds
    v_mfma_f32_16x16x32_bf16 v[84:87], v[52:55], a[216:219], v[84:87]
    ds_read_b128 v[36:39], v3 offset:13312
    v_mfma_f32_16x16x32_bf16 v[92:95], v[52:55], a[220:223], v[92:95]
    buffer_load_dwordx4 v0, s[20:23], m0 offen offset:1024 sc1 lds
    v_mfma_f32_16x16x32_bf16 v[96:99], v[56:59], a[216:219], v[96:99]
    ds_read_b128 v[40:43], v3 offset:14336
    v_mfma_f32_16x16x32_bf16 v[104:107], v[56:59], a[220:223], v[104:107]
    v_mfma_f32_16x16x32_bf16 v[100:103], v[60:63], a[216:219], v[100:103]
    ds_read_b128 v[44:47], v3 offset:15360
    v_mfma_f32_16x16x32_bf16 v[108:111], v[60:63], a[220:223], v[108:111]
    s_waitcnt lgkmcnt(4) vmcnt(19)
    v_bitop3_b32 v9, v184, v188, 1 bitop3:0x80
    v_cmp_eq_u32 vcc, 0, v9
    v_mfma_f32_16x16x32_bf16 v[64:67], v[16:19], a[224:227], v[64:67]
    ds_read_b128 v[48:51], v3 offset:16384
    s_cbranch_vccnz main_kernel_slowx29
main_kernel_backx29:
    v_accvgpr_write_b32 a232, v184
    v_accvgpr_write_b32 a233, v185
    v_mfma_f32_16x16x32_bf16 v[72:75], v[16:19], a[228:231], v[72:75]
    v_accvgpr_write_b32 a234, v188
    v_accvgpr_write_b32 a235, v189
    v_mfma_f32_16x16x32_bf16 v[68:71], v[20:23], a[224:227], v[68:71]
    ds_read_b128 v[52:55], v3 offset:17408
    v_accvgpr_write_b32 a236, v186
    v_mfma_f32_16x16x32_bf16 v[76:79], v[20:23], a[228:231], v[76:79]
    v_accvgpr_write_b32 a237, v187
    v_accvgpr_write_b32 a238, v190
    v_mfma_f32_16x16x32_bf16 v[80:83], v[24:27], a[224:227], v[80:83]
    ds_read_b128 v[56:59], v3 offset:18432
    v_accvgpr_write_b32 a239, v191
    v_mfma_f32_16x16x32_bf16 v[88:91], v[24:27], a[228:231], v[88:91]
    v_mfma_f32_16x16x32_bf16 v[84:87], v[28:31], a[224:227], v[84:87]
    ds_read_b128 v[60:63], v3 offset:19456
    v_mfma_f32_16x16x32_bf16 v[92:95], v[28:31], a[228:231], v[92:95]
    s_waitcnt lgkmcnt(4) vmcnt(15)
    v_bitop3_b32 v9, v112, v116, 1 bitop3:0x80
    v_cmp_eq_u32 vcc, 0, v9
    v_mfma_f32_16x16x32_bf16 v[96:99], v[32:35], a[224:227], v[96:99]
    ds_read_b128 v[16:19], v3 offset:20480
    s_cbranch_vccnz main_kernel_slowx30
main_kernel_backx30:
    v_accvgpr_write_b32 a240, v112
    v_accvgpr_write_b32 a241, v113
    v_mfma_f32_16x16x32_bf16 v[104:107], v[32:35], a[228:231], v[104:107]
    buffer_load_dwordx4 v0, s[20:23], m0 offen offset:2048 sc1 lds
    v_mfma_f32_16x16x32_bf16 v[100:103], v[36:39], a[224:227], v[100:103]
    ds_read_b128 v[20:23], v3 offset:21504
    v_accvgpr_write_b32 a242, v116
    v_mfma_f32_16x16x32_bf16 v[108:111], v[36:39], a[228:231], v[108:111]
    v_accvgpr_write_b32 a243, v117
    v_accvgpr_write_b32 a244, v114
    v_mfma_f32_16x16x32_bf16 v[64:67], v[40:43], a[232:235], v[64:67]
    ds_read_b128 v[24:27], v3 offset:22528
    v_accvgpr_write_b32 a245, v115
    v_mfma_f32_16x16x32_bf16 v[72:75], v[40:43], a[236:239], v[72:75]
    buffer_load_dwordx4 v0, s[20:23], m0 offen offset:3072 sc1 lds
    v_mfma_f32_16x16x32_bf16 v[68:71], v[44:47], a[232:235], v[68:71]
    ds_read_b128 v[28:31], v3 offset:23552
    v_accvgpr_write_b32 a246, v118
    v_mfma_f32_16x16x32_bf16 v[76:79], v[44:47], a[236:239], v[76:79]
    s_waitcnt lgkmcnt(4)
    v_accvgpr_write_b32 a247, v119
    v_mfma_f32_16x16x32_bf16 v[80:83], v[48:51], a[232:235], v[80:83]
    ds_read_b128 v[32:35], v3 offset:24576
    v_mfma_f32_16x16x32_bf16 v[88:91], v[48:51], a[236:239], v[88:91]
    v_mfma_f32_16x16x32_bf16 v[84:87], v[52:55], a[232:235], v[84:87]
    ds_read_b128 v[36:39], v3 offset:25600
    v_mfma_f32_16x16x32_bf16 v[92:95], v[52:55], a[236:239], v[92:95]
    v_mfma_f32_16x16x32_bf16 v[96:99], v[56:59], a[232:235], v[96:99]
    ds_read_b128 v[40:43], v3 offset:26624
    v_mfma_f32_16x16x32_bf16 v[104:107], v[56:59], a[236:239], v[104:107]
    v_mfma_f32_16x16x32_bf16 v[100:103], v[60:63], a[232:235], v[100:103]
    ds_read_b128 v[44:47], v3 offset:27648
    v_mfma_f32_16x16x32_bf16 v[108:111], v[60:63], a[236:239], v[108:111]
    s_waitcnt lgkmcnt(4) vmcnt(13)
    v_bitop3_b32 v9, v120, v124, 1 bitop3:0x80
    v_cmp_eq_u32 vcc, 0, v9
    v_mfma_f32_16x16x32_bf16 v[64:67], v[16:19], a[240:243], v[64:67]
    ds_read_b128 v[48:51], v3 offset:28672
    s_cbranch_vccnz main_kernel_slowx31
main_kernel_backx31:
    v_accvgpr_write_b32 a248, v120
    v_accvgpr_write_b32 a249, v121
    v_mfma_f32_16x16x32_bf16 v[72:75], v[16:19], a[244:247], v[72:75]
    v_accvgpr_write_b32 a250, v124
    v_accvgpr_write_b32 a251, v125
    v_mfma_f32_16x16x32_bf16 v[68:71], v[20:23], a[240:243], v[68:71]
    ds_read_b128 v[52:55], v3 offset:29696
    v_accvgpr_write_b32 a252, v122
    v_mfma_f32_16x16x32_bf16 v[76:79], v[20:23], a[244:247], v[76:79]
    v_accvgpr_write_b32 a253, v123
    v_accvgpr_write_b32 a254, v126
    v_mfma_f32_16x16x32_bf16 v[80:83], v[24:27], a[240:243], v[80:83]
    ds_read_b128 v[56:59], v3 offset:30720
    v_accvgpr_write_b32 a255, v127
    v_mfma_f32_16x16x32_bf16 v[88:91], v[24:27], a[244:247], v[88:91]
    v_mfma_f32_16x16x32_bf16 v[84:87], v[28:31], a[240:243], v[84:87]
    ds_read_b128 v[60:63], v3 offset:31744
    v_mfma_f32_16x16x32_bf16 v[92:95], v[28:31], a[244:247], v[92:95]
    s_waitcnt lgkmcnt(4) vmcnt(9)
    s_barrier
    v_mfma_f32_16x16x32_bf16 v[96:99], v[32:35], a[240:243], v[96:99]
    ds_read_b128 v[16:19], v3 offset:32768
    s_add_u32 m0, s57, 98304
    v_mfma_f32_16x16x32_bf16 v[104:107], v[32:35], a[244:247], v[104:107]
    buffer_load_dwordx4 v0, s[20:23], m0 offen offset:0 sc1 lds
    v_mfma_f32_16x16x32_bf16 v[100:103], v[36:39], a[240:243], v[100:103]
    ds_read_b128 v[20:23], v3 offset:33792
    v_mfma_f32_16x16x32_bf16 v[108:111], v[36:39], a[244:247], v[108:111]
    buffer_load_dwordx4 v0, s[20:23], m0 offen offset:1024 sc1 lds
    v_mfma_f32_16x16x32_bf16 v[64:67], v[40:43], a[248:251], v[64:67]
    ds_read_b128 v[24:27], v3 offset:34816
    v_mfma_f32_16x16x32_bf16 v[72:75], v[40:43], a[252:255], v[72:75]
    v_mfma_f32_16x16x32_bf16 v[68:71], v[44:47], a[248:251], v[68:71]
    ds_read_b128 v[28:31], v3 offset:35840
    v_mfma_f32_16x16x32_bf16 v[76:79], v[44:47], a[252:255], v[76:79]
    s_waitcnt lgkmcnt(4)
    v_mfma_f32_16x16x32_bf16 v[80:83], v[48:51], a[248:251], v[80:83]
    ds_read_b128 v[32:35], v3 offset:36864
    v_mfma_f32_16x16x32_bf16 v[88:91], v[48:51], a[252:255], v[88:91]
    v_mfma_f32_16x16x32_bf16 v[84:87], v[52:55], a[248:251], v[84:87]
    ds_read_b128 v[36:39], v3 offset:37888
    v_mfma_f32_16x16x32_bf16 v[92:95], v[52:55], a[252:255], v[92:95]
    v_mfma_f32_16x16x32_bf16 v[96:99], v[56:59], a[248:251], v[96:99]
    ds_read_b128 v[40:43], v3 offset:38912
    v_mfma_f32_16x16x32_bf16 v[104:107], v[56:59], a[252:255], v[104:107]
    v_mfma_f32_16x16x32_bf16 v[100:103], v[60:63], a[248:251], v[100:103]
    ds_read_b128 v[44:47], v3 offset:39936
    v_mfma_f32_16x16x32_bf16 v[108:111], v[60:63], a[252:255], v[108:111]
    s_waitcnt lgkmcnt(4) vmcnt(8)
    v_mfma_f32_16x16x32_bf16 v[112:115], v[16:19], a[0:3], 0
    ds_read_b128 v[48:51], v3 offset:40960
    v_mfma_f32_16x16x32_bf16 v[120:123], v[16:19], a[4:7], 0
    buffer_load_dwordx4 v0, s[20:23], m0 offen offset:2048 sc1 lds
    v_mfma_f32_16x16x32_bf16 v[116:119], v[20:23], a[0:3], 0
    ds_read_b128 v[52:55], v3 offset:41984
    v_mfma_f32_16x16x32_bf16 v[124:127], v[20:23], a[4:7], 0
    buffer_load_dwordx4 v0, s[20:23], m0 offen offset:3072 sc1 lds
    v_mfma_f32_16x16x32_bf16 v[128:131], v[24:27], a[0:3], 0
    ds_read_b128 v[56:59], v3 offset:43008
    v_mfma_f32_16x16x32_bf16 v[136:139], v[24:27], a[4:7], 0
    v_mfma_f32_16x16x32_bf16 v[132:135], v[28:31], a[0:3], 0
    ds_read_b128 v[60:63], v3 offset:44032
    v_mfma_f32_16x16x32_bf16 v[140:143], v[28:31], a[4:7], 0
    s_waitcnt lgkmcnt(4)
    v_mfma_f32_16x16x32_bf16 v[112:115], v[32:35], a[8:11], v[112:115]
    ds_read_b128 v[16:19], v3 offset:45056
    v_min_u32 v203, v193, v195
    v_mfma_f32_16x16x32_bf16 v[120:123], v[32:35], a[12:15], v[120:123]
    buffer_store_dwordx4 v[12:15], v3, s[20:23], s51 offen offset:0 sc1
    v_mfma_f32_16x16x32_bf16 v[116:119], v[36:39], a[8:11], v[116:119]
    ds_read_b128 v[20:23], v3 offset:46080
    s_add_u32 m0, s57, 114688
    v_cmp_gt_u32 vcc, s58, v203
    v_mfma_f32_16x16x32_bf16 v[124:127], v[36:39], a[12:15], v[124:127]
    s_cbranch_vccnz main_kernel_slowst
main_kernel_backst:
    v_add_f64 v[192:193], v[192:193], s[94:95]
    v_add_f64 v[194:195], v[194:195], s[94:95]
    v_mfma_f32_16x16x32_bf16 v[128:131], v[40:43], a[8:11], v[128:131]
    ds_read_b128 v[24:27], v3 offset:47104
    v_cvt_f32_f64 v10, v[192:193]
    v_mfma_f32_16x16x32_bf16 v[136:139], v[40:43], a[12:15], v[136:139]
    buffer_load_dwordx4 v0, s[20:23], m0 offen offset:0 sc1 lds
    v_mfma_f32_16x16x32_bf16 v[132:135], v[44:47], a[8:11], v[132:135]
    ds_read_b128 v[28:31], v3 offset:48128
    v_cvt_f32_f64 v11, v[194:195]
    v_mfma_f32_16x16x32_bf16 v[140:143], v[44:47], a[12:15], v[140:143]
    s_waitcnt lgkmcnt(4)
    v_rsq_f32 v10, v10
    v_mfma_f32_16x16x32_bf16 v[112:115], v[48:51], a[16:19], v[112:115]
    ds_read_b128 v[32:35], v3 offset:49152
    v_mul_f32 v10, 0x4538aa3b, v10
    v_mfma_f32_16x16x32_bf16 v[120:123], v[48:51], a[20:23], v[120:123]
    buffer_load_dwordx4 v0, s[20:23], m0 offen offset:1024 sc1 lds
    v_mfma_f32_16x16x32_bf16 v[116:119], v[52:55], a[16:19], v[116:119]
    ds_read_b128 v[36:39], v3 offset:50176
    v_mul_f32 v64, v64, v10
    v_mfma_f32_16x16x32_bf16 v[124:127], v[52:55], a[20:23], v[124:127]
    v_rsq_f32 v11, v11
    v_mfma_f32_16x16x32_bf16 v[128:131], v[56:59], a[16:19], v[128:131]
    ds_read_b128 v[40:43], v3 offset:51200
    v_exp_f32 v176, -v64
    v_mfma_f32_16x16x32_bf16 v[136:139], v[56:59], a[20:23], v[136:139]
    buffer_load_dwordx4 v0, s[20:23], m0 offen offset:2048 sc1 lds
    v_mfma_f32_16x16x32_bf16 v[132:135], v[60:63], a[16:19], v[132:135]
    ds_read_b128 v[44:47], v3 offset:52224
    v_mul_f32 v11, 0x4538aa3b, v11
    v_mfma_f32_16x16x32_bf16 v[140:143], v[60:63], a[20:23], v[140:143]
    s_waitcnt lgkmcnt(4)
    v_mul_f32 v65, v65, v10
    v_mul_f32 v66, v66, v10
    v_mfma_f32_16x16x32_bf16 v[112:115], v[16:19], a[24:27], v[112:115]
    ds_read_b128 v[48:51], v3 offset:53248
    v_mul_f32 v67, v67, v10
    v_mfma_f32_16x16x32_bf16 v[120:123], v[16:19], a[28:31], v[120:123]
    buffer_load_dwordx4 v0, s[20:23], m0 offen offset:3072 sc1 lds
    v_fma_f32 v176, v176, s50, s50
    v_mfma_f32_16x16x32_bf16 v[116:119], v[20:23], a[24:27], v[116:119]
    ds_read_b128 v[52:55], v3 offset:54272
    v_mul_f32 v68, v68, v10
    v_mfma_f32_16x16x32_bf16 v[124:127], v[20:23], a[28:31], v[124:127]
    v_exp_f32 v177, -v65
    v_mfma_f32_16x16x32_bf16 v[128:131], v[24:27], a[24:27], v[128:131]
    ds_read_b128 v[56:59], v3 offset:55296
    v_fma_f32 v177, v177, s50, s50
    v_mfma_f32_16x16x32_bf16 v[136:139], v[24:27], a[28:31], v[136:139]
    v_exp_f32 v178, -v66
    v_mfma_f32_16x16x32_bf16 v[132:135], v[28:31], a[24:27], v[132:135]
    ds_read_b128 v[60:63], v3 offset:56320
    v_exp_f32 v179, -v67
    v_mfma_f32_16x16x32_bf16 v[140:143], v[28:31], a[28:31], v[140:143]
    s_waitcnt lgkmcnt(4)
    v_rcp_f32 v176, v176
    v_mfma_f32_16x16x32_bf16 v[112:115], v[32:35], a[32:35], v[112:115]
    ds_read_b128 v[16:19], v3 offset:57344
    s_add_u32 m0, s57, 131072
    v_mfma_f32_16x16x32_bf16 v[120:123], v[32:35], a[36:39], v[120:123]
    buffer_load_dwordx4 v0, s[20:23], m0 offen offset:0 sc1 lds
    v_mfma_f32_16x16x32_bf16 v[116:119], v[36:39], a[32:35], v[116:119]
    ds_read_b128 v[20:23], v3 offset:58368
    v_fma_f32 v178, v178, s50, s50
    v_mfma_f32_16x16x32_bf16 v[124:127], v[36:39], a[36:39], v[124:127]
    v_rcp_f32 v177, v177
    v_fma_f32 v179, v179, s50, s50
    v_mfma_f32_16x16x32_bf16 v[128:131], v[40:43], a[32:35], v[128:131]
    ds_read_b128 v[24:27], v3 offset:59392
    v_mul_f32 v176, v64, v176
    v_mfma_f32_16x16x32_bf16 v[136:139], v[40:43], a[36:39], v[136:139]
    buffer_load_dwordx4 v0, s[20:23], m0 offen offset:1024 sc1 lds
    v_mfma_f32_16x16x32_bf16 v[132:135], v[44:47], a[32:35], v[132:135]
    ds_read_b128 v[28:31], v3 offset:60416
    v_mul_f32 v177, v65, v177
    v_mfma_f32_16x16x32_bf16 v[140:143], v[44:47], a[36:39], v[140:143]
    s_waitcnt lgkmcnt(4)
    v_rcp_f32 v178, v178
    v_mfma_f32_16x16x32_bf16 v[112:115], v[48:51], a[40:43], v[112:115]
    ds_read_b128 v[32:35], v3 offset:61440
    v_rcp_f32 v179, v179
    v_mfma_f32_16x16x32_bf16 v[120:123], v[48:51], a[44:47], v[120:123]
    v_exp_f32 v180, -v68
    v_mfma_f32_16x16x32_bf16 v[116:119], v[52:55], a[40:43], v[116:119]
    ds_read_b128 v[36:39], v3 offset:62464
    v_mul_f32 v178, v66, v178
    v_mfma_f32_16x16x32_bf16 v[124:127], v[52:55], a[44:47], v[124:127]
    v_mul_f32 v179, v67, v179
    v_mul_f32 v69, v69, v10
    v_mfma_f32_16x16x32_bf16 v[128:131], v[56:59], a[40:43], v[128:131]
    ds_read_b128 v[40:43], v3 offset:63488
    v_mul_f32 v70, v70, v10
    v_mfma_f32_16x16x32_bf16 v[136:139], v[56:59], a[44:47], v[136:139]
    v_exp_f32 v181, -v69
    v_mul_f32 v71, v71, v10
    v_mfma_f32_16x16x32_bf16 v[132:135], v[60:63], a[40:43], v[132:135]
    ds_read_b128 v[44:47], v3 offset:64512
    v_fma_f32 v180, v180, s50, s50
    v_mfma_f32_16x16x32_bf16 v[140:143], v[60:63], a[44:47], v[140:143]
    s_waitcnt lgkmcnt(4) vmcnt(11)
    s_barrier
    v_mfma_f32_16x16x32_bf16 v[112:115], v[16:19], a[48:51], v[112:115]
    ds_read_b128 v[48:51], v4 offset:0
    v_fma_f32 v181, v181, s50, s50
    v_mfma_f32_16x16x32_bf16 v[120:123], v[16:19], a[52:55], v[120:123]
    buffer_load_dwordx4 v0, s[20:23], m0 offen offset:2048 sc1 lds
    v_mfma_f32_16x16x32_bf16 v[116:119], v[20:23], a[48:51], v[116:119]
    ds_read_b128 v[52:55], v4 offset:1024
    v_exp_f32 v182, -v70
    v_mfma_f32_16x16x32_bf16 v[124:127], v[20:23], a[52:55], v[124:127]
    v_exp_f32 v183, -v71
    v_mfma_f32_16x16x32_bf16 v[128:131], v[24:27], a[48:51], v[128:131]
    ds_read_b128 v[56:59], v4 offset:2048
    v_fma_f32 v182, v182, s50, s50
    v_mfma_f32_16x16x32_bf16 v[136:139], v[24:27], a[52:55], v[136:139]
    buffer_load_dwordx4 v0, s[20:23], m0 offen offset:3072 sc1 lds
    v_mfma_f32_16x16x32_bf16 v[132:135], v[28:31], a[48:51], v[132:135]
    ds_read_b128 v[60:63], v4 offset:3072
    v_fma_f32 v183, v183, s50, s50
    v_mfma_f32_16x16x32_bf16 v[140:143], v[28:31], a[52:55], v[140:143]
    s_waitcnt lgkmcnt(4)
    v_rcp_f32 v180, v180
    v_cvt_pk_bf16_f32 v64, v176, v177
    v_mfma_f32_16x16x32_bf16 v[112:115], v[32:35], a[56:59], v[112:115]
    ds_read_b128 v[16:19], v4 offset:4096
    s_add_u32 m0, s57, 147456
    v_mfma_f32_16x16x32_bf16 v[120:123], v[32:35], a[60:63], v[120:123]
    buffer_load_dwordx4 v0, s[20:23], m0 offen offset:0 sc1 lds
    v_mfma_f32_16x16x32_bf16 v[116:119], v[36:39], a[56:59], v[116:119]
    ds_read_b128 v[20:23], v4 offset:5120
    v_mul_f32 v180, v68, v180
    v_mfma_f32_16x16x32_bf16 v[124:127], v[36:39], a[60:63], v[124:127]
    v_rcp_f32 v181, v181
    v_mfma_f32_16x16x32_bf16 v[128:131], v[40:43], a[56:59], v[128:131]
    ds_read_b128 v[24:27], v4 offset:6144
    v_rcp_f32 v182, v182
    v_mfma_f32_16x16x32_bf16 v[136:139], v[40:43], a[60:63], v[136:139]
    buffer_load_dwordx4 v0, s[20:23], m0 offen offset:1024 sc1 lds
    v_mfma_f32_16x16x32_bf16 v[132:135], v[44:47], a[56:59], v[132:135]
    ds_read_b128 v[28:31], v4 offset:7168
    v_mul_f32 v181, v69, v181
    v_mfma_f32_16x16x32_bf16 v[140:143], v[44:47], a[60:63], v[140:143]
    s_waitcnt lgkmcnt(4)
    v_rcp_f32 v183, v183
    v_mfma_f32_16x16x32_bf16 v[112:115], v[48:51], a[64:67], v[112:115]
    ds_read_b128 v[32:35], v4 offset:8192
    v_mul_f32 v182, v70, v182
    v_mfma_f32_16x16x32_bf16 v[120:123], v[48:51], a[68:71], v[120:123]
    buffer_store_dwordx4 v[12:15], v3, s[20:23], s51 offen offset:1024 sc1
    v_mul_f32 v183, v71, v183
    v_mfma_f32_16x16x32_bf16 v[116:119], v[52:55], a[64:67], v[116:119]
    ds_read_b128 v[36:39], v4 offset:9216
    v_cvt_pk_bf16_f32 v65, v178, v179
    v_mfma_f32_16x16x32_bf16 v[124:127], v[52:55], a[68:71], v[124:127]
    v_cvt_pk_bf16_f32 v66, v180, v181
    v_cvt_pk_bf16_f32 v67, v182, v183
    v_mfma_f32_16x16x32_bf16 v[128:131], v[56:59], a[64:67], v[128:131]
    ds_read_b128 v[40:43], v4 offset:10240
    v_mul_f32 v72, v72, v11
    v_mfma_f32_16x16x32_bf16 v[136:139], v[56:59], a[68:71], v[136:139]
    buffer_store_dwordx4 v[64:67], v3, s[20:23], s32 offen offset:0 sc1
    v_mfma_f32_16x16x32_bf16 v[132:135], v[60:63], a[64:67], v[132:135]
    ds_read_b128 v[44:47], v4 offset:11264
    v_exp_f32 v184, -v72
    v_mfma_f32_16x16x32_bf16 v[140:143], v[60:63], a[68:71], v[140:143]
    s_waitcnt lgkmcnt(4)
    v_mul_f32 v73, v73, v11
    v_mul_f32 v74, v74, v11
    v_mfma_f32_16x16x32_bf16 v[112:115], v[16:19], a[72:75], v[112:115]
    ds_read_b128 v[48:51], v4 offset:12288
    v_mul_f32 v75, v75, v11
    v_mfma_f32_16x16x32_bf16 v[120:123], v[16:19], a[76:79], v[120:123]
    buffer_load_dwordx4 v0, s[20:23], m0 offen offset:2048 sc1 lds
    v_mfma_f32_16x16x32_bf16 v[116:119], v[20:23], a[72:75], v[116:119]
    ds_read_b128 v[52:55], v4 offset:13312
    v_fma_f32 v184, v184, s50, s50
    v_mfma_f32_16x16x32_bf16 v[124:127], v[20:23], a[76:79], v[124:127]
    v_exp_f32 v185, -v73
    v_mul_f32 v76, v76, v11
    v_mfma_f32_16x16x32_bf16 v[128:131], v[24:27], a[72:75], v[128:131]
    ds_read_b128 v[56:59], v4 offset:14336
    v_fma_f32 v185, v185, s50, s50
    v_mfma_f32_16x16x32_bf16 v[136:139], v[24:27], a[76:79], v[136:139]
    buffer_load_dwordx4 v0, s[20:23], m0 offen offset:3072 sc1 lds
    v_add_u32 v0, 163840, v0
    v_mfma_f32_16x16x32_bf16 v[132:135], v[28:31], a[72:75], v[132:135]
    ds_read_b128 v[60:63], v4 offset:15360
    v_mul_f32 v77, v77, v11
    v_mfma_f32_16x16x32_bf16 v[140:143], v[28:31], a[76:79], v[140:143]
    s_waitcnt lgkmcnt(4)
    v_exp_f32 v186, -v74
    v_mfma_f32_16x16x32_bf16 v[112:115], v[32:35], a[80:83], v[112:115]
    ds_read_b128 v[16:19], v4 offset:16384
    s_add_u32 m0, s57, 0
    v_fma_f32 v186, v186, s50, s50
    v_mfma_f32_16x16x32_bf16 v[120:123], v[32:35], a[84:87], v[120:123]
    buffer_load_dwordx4 v0, s[20:23], m0 offen offset:0 sc1 lds
    v_mfma_f32_16x16x32_bf16 v[116:119], v[36:39], a[80:83], v[116:119]
    ds_read_b128 v[20:23], v4 offset:17408
    v_mul_f32 v78, v78, v11
    v_mfma_f32_16x16x32_bf16 v[124:127], v[36:39], a[84:87], v[124:127]
    v_exp_f32 v187, -v75
    v_mfma_f32_16x16x32_bf16 v[128:131], v[40:43], a[80:83], v[128:131]
    ds_read_b128 v[24:27], v4 offset:18432
    v_fma_f32 v187, v187, s50, s50
    v_mfma_f32_16x16x32_bf16 v[136:139], v[40:43], a[84:87], v[136:139]
    buffer_load_dwordx4 v0, s[20:23], m0 offen offset:1024 sc1 lds
    v_mul_f32 v79, v79, v11
    v_mfma_f32_16x16x32_bf16 v[132:135], v[44:47], a[80:83], v[132:135]
    ds_read_b128 v[28:31], v4 offset:19456
    v_mul_f32 v80, v80, v10
    v_mfma_f32_16x16x32_bf16 v[140:143], v[44:47], a[84:87], v[140:143]
    s_waitcnt lgkmcnt(4)
    v_rcp_f32 v184, v184
    v_mfma_f32_16x16x32_bf16 v[112:115], v[48:51], a[88:91], v[112:115]
    ds_read_b128 v[32:35], v4 offset:20480
    v_mul_f32 v184, v72, v184
    v_mfma_f32_16x16x32_bf16 v[120:123], v[48:51], a[92:95], v[120:123]
    buffer_load_dwordx4 v0, s[20:23], m0 offen offset:2048 sc1 lds
    v_mfma_f32_16x16x32_bf16 v[116:119], v[52:55], a[88:91], v[116:119]
    ds_read_b128 v[36:39], v4 offset:21504
    v_rcp_f32 v185, v185
    v_mfma_f32_16x16x32_bf16 v[124:127], v[52:55], a[92:95], v[124:127]
    v_rcp_f32 v186, v186
    v_mfma_f32_16x16x32_bf16 v[128:131], v[56:59], a[88:91], v[128:131]
    ds_read_b128 v[40:43], v4 offset:22528
    v_mul_f32 v185, v73, v185
    v_mfma_f32_16x16x32_bf16 v[136:139], v[56:59], a[92:95], v[136:139]
    buffer_load_dwordx4 v0, s[20:23], m0 offen offset:3072 sc1 lds
    v_mfma_f32_16x16x32_bf16 v[132:135], v[60:63], a[88:91], v[132:135]
    ds_read_b128 v[44:47], v4 offset:23552
    v_mul_f32 v186, v74, v186
    v_mfma_f32_16x16x32_bf16 v[140:143], v[60:63], a[92:95], v[140:143]
    s_waitcnt lgkmcnt(4)
    v_rcp_f32 v187, v187
    v_cvt_pk_bf16_f32 v72, v184, v185
    v_mfma_f32_16x16x32_bf16 v[112:115], v[16:19], a[96:99], v[112:115]
    ds_read_b128 v[48:51], v4 offset:24576
    v_mul_f32 v187, v75, v187
    v_mfma_f32_16x16x32_bf16 v[120:123], v[16:19], a[100:103], v[120:123]
    v_exp_f32 v188, -v76
    v_mfma_f32_16x16x32_bf16 v[116:119], v[20:23], a[96:99], v[116:119]
    ds_read_b128 v[52:55], v4 offset:25600
    v_fma_f32 v188, v188, s50, s50
    v_mfma_f32_16x16x32_bf16 v[124:127], v[20:23], a[100:103], v[124:127]
    v_exp_f32 v189, -v77
    v_mfma_f32_16x16x32_bf16 v[128:131], v[24:27], a[96:99], v[128:131]
    ds_read_b128 v[56:59], v4 offset:26624
    v_exp_f32 v190, -v78
    v_mfma_f32_16x16x32_bf16 v[136:139], v[24:27], a[100:103], v[136:139]
    v_exp_f32 v191, -v79
    v_mfma_f32_16x16x32_bf16 v[132:135], v[28:31], a[96:99], v[132:135]
    ds_read_b128 v[60:63], v4 offset:27648
    v_fma_f32 v189, v189, s50, s50
    v_mfma_f32_16x16x32_bf16 v[140:143], v[28:31], a[100:103], v[140:143]
    s_waitcnt lgkmcnt(4)
    v_rcp_f32 v188, v188
    v_mfma_f32_16x16x32_bf16 v[112:115], v[32:35], a[104:107], v[112:115]
    ds_read_b128 v[16:19], v4 offset:28672
    s_add_u32 m0, s57, 16384
    v_mfma_f32_16x16x32_bf16 v[120:123], v[32:35], a[108:111], v[120:123]
    buffer_load_dwordx4 v0, s[20:23], m0 offen offset:0 sc1 lds
    v_fma_f32 v190, v190, s50, s50
    v_mfma_f32_16x16x32_bf16 v[116:119], v[36:39], a[104:107], v[116:119]
    ds_read_b128 v[20:23], v4 offset:29696
    v_fma_f32 v191, v191, s50, s50
    v_mfma_f32_16x16x32_bf16 v[124:127], v[36:39], a[108:111], v[124:127]
    v_rcp_f32 v189, v189
    v_mfma_f32_16x16x32_bf16 v[128:131], v[40:43], a[104:107], v[128:131]
    ds_read_b128 v[24:27], v4 offset:30720
    v_mul_f32 v188, v76, v188
    v_mfma_f32_16x16x32_bf16 v[136:139], v[40:43], a[108:111], v[136:139]
    buffer_load_dwordx4 v0, s[20:23], m0 offen offset:1024 sc1 lds
    v_mfma_f32_16x16x32_bf16 v[132:135], v[44:47], a[104:107], v[132:135]
    ds_read_b128 v[28:31], v4 offset:31744
    v_rcp_f32 v190, v190
    v_mfma_f32_16x16x32_bf16 v[140:143], v[44:47], a[108:111], v[140:143]
    s_waitcnt lgkmcnt(4) vmcnt(16)
    s_barrier
    v_mfma_f32_16x16x32_bf16 v[112:115], v[48:51], a[112:115], v[112:115]
    ds_read_b128 v[32:35], v4 offset:32768
    v_mul_f32 v189, v77, v189
    v_mfma_f32_16x16x32_bf16 v[120:123], v[48:51], a[116:119], v[120:123]
    buffer_load_dwordx4 v0, s[20:23], m0 offen offset:2048 sc1 lds
    v_mfma_f32_16x16x32_bf16 v[116:119], v[52:55], a[112:115], v[116:119]
    ds_read_b128 v[36:39], v4 offset:33792
    v_mul_f32 v190, v78, v190
    v_mfma_f32_16x16x32_bf16 v[124:127], v[52:55], a[116:119], v[124:127]
    v_rcp_f32 v191, v191
    v_cvt_pk_bf16_f32 v73, v186, v187
    v_mfma_f32_16x16x32_bf16 v[128:131], v[56:59], a[112:115], v[128:131]
    ds_read_b128 v[40:43], v4 offset:34816
    v_mul_f32 v191, v79, v191
    v_mfma_f32_16x16x32_bf16 v[136:139], v[56:59], a[116:119], v[136:139]
main_kernel_stub10:
    s_cbranch_execz main_kernel_ret
    buffer_load_dwordx4 v0, s[20:23], m0 offen offset:3072 sc1 lds
    v_mfma_f32_16x16x32_bf16 v[132:135], v[60:63], a[112:115], v[132:135]
    ds_read_b128 v[44:47], v4 offset:35840
    v_cvt_pk_bf16_f32 v74, v188, v189
    v_mfma_f32_16x16x32_bf16 v[140:143], v[60:63], a[116:119], v[140:143]
    s_waitcnt lgkmcnt(4)
    v_exp_f32 v176, -v80
    v_mfma_f32_16x16x32_bf16 v[112:115], v[16:19], a[120:123], v[112:115]
    ds_read_b128 v[48:51], v4 offset:36864
    v_cvt_pk_bf16_f32 v75, v190, v191
    v_mul_f32 v81, v81, v10
    v_mfma_f32_16x16x32_bf16 v[120:123], v[16:19], a[124:127], v[120:123]
    v_exp_f32 v177, -v81
    v_mfma_f32_16x16x32_bf16 v[116:119], v[20:23], a[120:123], v[116:119]
    ds_read_b128 v[52:55], v4 offset:37888
    v_mul_f32 v82, v82, v10
    v_mfma_f32_16x16x32_bf16 v[124:127], v[20:23], a[124:127], v[124:127]
    v_exp_f32 v178, -v82
    v_mfma_f32_16x16x32_bf16 v[128:131], v[24:27], a[120:123], v[128:131]
    ds_read_b128 v[56:59], v4 offset:38912
    v_mul_f32 v83, v83, v10
    v_mfma_f32_16x16x32_bf16 v[136:139], v[24:27], a[124:127], v[136:139]
    buffer_store_dwordx4 v[72:75], v3, s[20:23], s32 offen offset:1024 sc1
    v_fma_f32 v176, v176, s50, s50
    v_mfma_f32_16x16x32_bf16 v[132:135], v[28:31], a[120:123], v[132:135]
    ds_read_b128 v[60:63], v4 offset:39936
    v_fma_f32 v177, v177, s50, s50
    v_mfma_f32_16x16x32_bf16 v[140:143], v[28:31], a[124:127], v[140:143]
    s_waitcnt lgkmcnt(4)
    v_exp_f32 v179, -v83
    v_mfma_f32_16x16x32_bf16 v[112:115], v[32:35], a[128:131], v[112:115]
    ds_read_b128 v[16:19], v4 offset:40960
    s_add_u32 m0, s57, 32768
    v_mfma_f32_16x16x32_bf16 v[120:123], v[32:35], a[132:135], v[120:123]
    buffer_load_dwordx4 v0, s[20:23], m0 offen offset:0 sc1 lds
    v_mfma_f32_16x16x32_bf16 v[116:119], v[36:39], a[128:131], v[116:119]
    ds_read_b128 v[20:23], v4 offset:41984
    v_rcp_f32 v176, v176
    v_mfma_f32_16x16x32_bf16 v[124:127], v[36:39], a[132:135], v[124:127]
    v_rcp_f32 v177, v177
    v_mfma_f32_16x16x32_bf16 v[128:131], v[40:43], a[128:131], v[128:131]
    ds_read_b128 v[24:27], v4 offset:43008
    v_fma_f32 v178, v178, s50, s50
    v_mfma_f32_16x16x32_bf16 v[136:139], v[40:43], a[132:135], v[136:139]
    buffer_load_dwordx4 v0, s[20:23], m0 offen offset:1024 sc1 lds
    v_mfma_f32_16x16x32_bf16 v[132:135], v[44:47], a[128:131], v[132:135]
    ds_read_b128 v[28:31], v4 offset:44032
    v_fma_f32 v179, v179, s50, s50
    v_mfma_f32_16x16x32_bf16 v[140:143], v[44:47], a[132:135], v[140:143]
    s_waitcnt lgkmcnt(4)
    v_rcp_f32 v178, v178
    v_mul_f32 v176, v80, v176
    v_mfma_f32_16x16x32_bf16 v[112:115], v[48:51], a[136:139], v[112:115]
    ds_read_b128 v[32:35], v4 offset:45056
    v_mul_f32 v177, v81, v177
    v_mfma_f32_16x16x32_bf16 v[120:123], v[48:51], a[140:143], v[120:123]
    buffer_store_dwordx4 v[12:15], v3, s[20:23], s51 offen offset:2048 sc1
    v_mfma_f32_16x16x32_bf16 v[116:119], v[52:55], a[136:139], v[116:119]
    ds_read_b128 v[36:39], v4 offset:46080
    v_mul_f32 v178, v82, v178
    v_mfma_f32_16x16x32_bf16 v[124:127], v[52:55], a[140:143], v[124:127]
    v_and_b32 v9, 7, v2
    v_mul_i32_i24 v9, -3, v9
    v_lshl_add_u32 v9, v2, 2, v9
    v_lshlrev_b32 v9, 6, v9
    buffer_load_dword v9, v9, s[20:23], s7 offen sc1
    v_mfma_f32_16x16x32_bf16 v[128:131], v[56:59], a[136:139], v[128:131]
    ds_read_b128 v[40:43], v4 offset:47104
    v_rcp_f32 v179, v179
    v_mfma_f32_16x16x32_bf16 v[136:139], v[56:59], a[140:143], v[136:139]
    buffer_load_dwordx4 v0, s[20:23], m0 offen offset:2048 sc1 lds
    v_mfma_f32_16x16x32_bf16 v[132:135], v[60:63], a[136:139], v[132:135]
    ds_read_b128 v[44:47], v4 offset:48128
    v_mul_f32 v179, v83, v179
    v_mfma_f32_16x16x32_bf16 v[140:143], v[60:63], a[140:143], v[140:143]
    s_waitcnt lgkmcnt(4)
    v_mul_f32 v84, v84, v10
    v_mul_f32 v85, v85, v10
    v_mfma_f32_16x16x32_bf16 v[112:115], v[16:19], a[144:147], v[112:115]
    ds_read_b128 v[48:51], v4 offset:49152
    v_mul_f32 v86, v86, v10
    v_mfma_f32_16x16x32_bf16 v[120:123], v[16:19], a[148:151], v[120:123]
    buffer_load_dwordx4 v0, s[20:23], m0 offen offset:3072 sc1 lds
    v_mul_f32 v87, v87, v10
    v_mfma_f32_16x16x32_bf16 v[116:119], v[20:23], a[144:147], v[116:119]
    ds_read_b128 v[52:55], v4 offset:50176
    s_add_u32 m0, s57, 49152
    v_mfma_f32_16x16x32_bf16 v[124:127], v[20:23], a[148:151], v[124:127]
    v_exp_f32 v180, -v84
    v_mfma_f32_16x16x32_bf16 v[128:131], v[24:27], a[144:147], v[128:131]
    ds_read_b128 v[56:59], v4 offset:51200
    v_fma_f32 v180, v180, s50, s50
    v_mfma_f32_16x16x32_bf16 v[136:139], v[24:27], a[148:151], v[136:139]
    buffer_load_dwordx4 v0, s[20:23], m0 offen offset:0 sc1 lds
    v_mfma_f32_16x16x32_bf16 v[132:135], v[28:31], a[144:147], v[132:135]
    ds_read_b128 v[60:63], v4 offset:52224
    v_exp_f32 v181, -v85
    v_mfma_f32_16x16x32_bf16 v[140:143], v[28:31], a[148:151], v[140:143]
    s_waitcnt lgkmcnt(4)
    v_exp_f32 v182, -v86
    v_mfma_f32_16x16x32_bf16 v[112:115], v[32:35], a[152:155], v[112:115]
    ds_read_b128 v[16:19], v4 offset:53248
    v_fma_f32 v181, v181, s50, s50
    v_mfma_f32_16x16x32_bf16 v[120:123], v[32:35], a[156:159], v[120:123]
    buffer_load_dwordx4 v0, s[20:23], m0 offen offset:1024 sc1 lds
    v_mfma_f32_16x16x32_bf16 v[116:119], v[36:39], a[152:155], v[116:119]
    ds_read_b128 v[20:23], v4 offset:54272
    v_fma_f32 v182, v182, s50, s50
    v_mfma_f32_16x16x32_bf16 v[124:127], v[36:39], a[156:159], v[124:127]
    v_exp_f32 v183, -v87
    v_cvt_pk_bf16_f32 v80, v176, v177
    v_mfma_f32_16x16x32_bf16 v[128:131], v[40:43], a[152:155], v[128:131]
    ds_read_b128 v[24:27], v4 offset:55296
    v_fma_f32 v183, v183, s50, s50
    v_mfma_f32_16x16x32_bf16 v[136:139], v[40:43], a[156:159], v[136:139]
    v_rcp_f32 v180, v180
    v_mfma_f32_16x16x32_bf16 v[132:135], v[44:47], a[152:155], v[132:135]
    ds_read_b128 v[28:31], v4 offset:56320
    v_mul_f32 v180, v84, v180
    v_mfma_f32_16x16x32_bf16 v[140:143], v[44:47], a[156:159], v[140:143]
    s_waitcnt lgkmcnt(4)
    v_rcp_f32 v181, v181
    v_mfma_f32_16x16x32_bf16 v[112:115], v[48:51], a[160:163], v[112:115]
    ds_read_b128 v[32:35], v4 offset:57344
    v_rcp_f32 v182, v182
    v_mfma_f32_16x16x32_bf16 v[120:123], v[48:51], a[164:167], v[120:123]
    buffer_load_dwordx4 v0, s[20:23], m0 offen offset:2048 sc1 lds
    v_mfma_f32_16x16x32_bf16 v[116:119], v[52:55], a[160:163], v[116:119]
    ds_read_b128 v[36:39], v4 offset:58368
    v_mul_f32 v181, v85, v181
    v_mfma_f32_16x16x32_bf16 v[124:127], v[52:55], a[164:167], v[124:127]
    v_rcp_f32 v183, v183
    v_mfma_f32_16x16x32_bf16 v[128:131], v[56:59], a[160:163], v[128:131]
    ds_read_b128 v[40:43], v4 offset:59392
    v_mul_f32 v182, v86, v182
    v_mfma_f32_16x16x32_bf16 v[136:139], v[56:59], a[164:167], v[136:139]
    buffer_load_dwordx4 v0, s[20:23], m0 offen offset:3072 sc1 lds
    v_mul_f32 v183, v87, v183
    v_mfma_f32_16x16x32_bf16 v[132:135], v[60:63], a[160:163], v[132:135]
    ds_read_b128 v[44:47], v4 offset:60416
    v_cvt_pk_bf16_f32 v81, v178, v179
    v_mfma_f32_16x16x32_bf16 v[140:143], v[60:63], a[164:167], v[140:143]
    s_waitcnt lgkmcnt(4)
    v_cvt_pk_bf16_f32 v82, v180, v181
    v_cvt_pk_bf16_f32 v83, v182, v183
    v_mfma_f32_16x16x32_bf16 v[112:115], v[16:19], a[168:171], v[112:115]
    ds_read_b128 v[48:51], v4 offset:61440
    s_add_u32 m0, s57, 65536
    v_mfma_f32_16x16x32_bf16 v[120:123], v[16:19], a[172:175], v[120:123]
    buffer_load_dwordx4 v0, s[20:23], m0 offen offset:0 sc1 lds
    v_mfma_f32_16x16x32_bf16 v[116:119], v[20:23], a[168:171], v[116:119]
    ds_read_b128 v[52:55], v4 offset:62464
    v_mul_f32 v88, v88, v11
    v_mul_f32 v89, v89, v11
    v_mfma_f32_16x16x32_bf16 v[124:127], v[20:23], a[172:175], v[124:127]
    v_exp_f32 v184, -v88
    v_mfma_f32_16x16x32_bf16 v[128:131], v[24:27], a[168:171], v[128:131]
    ds_read_b128 v[56:59], v4 offset:63488
    v_mul_f32 v90, v90, v11
    v_mfma_f32_16x16x32_bf16 v[136:139], v[24:27], a[172:175], v[136:139]
    buffer_load_dwordx4 v0, s[20:23], m0 offen offset:1024 sc1 lds
    v_mfma_f32_16x16x32_bf16 v[132:135], v[28:31], a[168:171], v[132:135]
    ds_read_b128 v[60:63], v4 offset:64512
    v_mul_f32 v91, v91, v11
    v_mfma_f32_16x16x32_bf16 v[140:143], v[28:31], a[172:175], v[140:143]
    s_waitcnt lgkmcnt(4) vmcnt(21)
    s_barrier
    v_mfma_f32_16x16x32_bf16 v[112:115], v[32:35], a[176:179], v[112:115]
    ds_read_b128 v[16:19], v5 offset:0
    v_fma_f32 v184, v184, s50, s50
    v_mfma_f32_16x16x32_bf16 v[120:123], v[32:35], a[180:183], v[120:123]
    buffer_store_dwordx4 v[80:83], v4, s[20:23], s32 offen offset:0 sc1
    v_mfma_f32_16x16x32_bf16 v[116:119], v[36:39], a[176:179], v[116:119]
    ds_read_b128 v[20:23], v5 offset:1024
    v_mul_f32 v92, v92, v11
    v_mfma_f32_16x16x32_bf16 v[124:127], v[36:39], a[180:183], v[124:127]
    v_exp_f32 v185, -v89
    v_mfma_f32_16x16x32_bf16 v[128:131], v[40:43], a[176:179], v[128:131]
    ds_read_b128 v[24:27], v5 offset:2048
    v_exp_f32 v186, -v90
    v_mfma_f32_16x16x32_bf16 v[136:139], v[40:43], a[180:183], v[136:139]
    v_exp_f32 v187, -v91
    v_mfma_f32_16x16x32_bf16 v[132:135], v[44:47], a[176:179], v[132:135]
    ds_read_b128 v[28:31], v5 offset:3072
    v_fma_f32 v185, v185, s50, s50
    v_mfma_f32_16x16x32_bf16 v[140:143], v[44:47], a[180:183], v[140:143]
    s_waitcnt lgkmcnt(4)
    v_rcp_f32 v184, v184
    v_mfma_f32_16x16x32_bf16 v[112:115], v[48:51], a[184:187], v[112:115]
    ds_read_b128 v[32:35], v5 offset:4096
    v_fma_f32 v186, v186, s50, s50
    v_mfma_f32_16x16x32_bf16 v[120:123], v[48:51], a[188:191], v[120:123]
    buffer_load_dwordx4 v0, s[20:23], m0 offen offset:2048 sc1 lds
    v_fma_f32 v187, v187, s50, s50
    v_mfma_f32_16x16x32_bf16 v[116:119], v[52:55], a[184:187], v[116:119]
    ds_read_b128 v[36:39], v5 offset:5120
    v_mul_f32 v184, v88, v184
    v_mfma_f32_16x16x32_bf16 v[124:127], v[52:55], a[188:191], v[124:127]
    v_rcp_f32 v185, v185
    v_mfma_f32_16x16x32_bf16 v[128:131], v[56:59], a[184:187], v[128:131]
    ds_read_b128 v[40:43], v5 offset:6144
    v_mul_f32 v185, v89, v185
    v_mfma_f32_16x16x32_bf16 v[136:139], v[56:59], a[188:191], v[136:139]
    buffer_load_dwordx4 v0, s[20:23], m0 offen offset:3072 sc1 lds
    v_mfma_f32_16x16x32_bf16 v[132:135], v[60:63], a[184:187], v[132:135]
    ds_read_b128 v[44:47], v5 offset:7168
    v_rcp_f32 v186, v186
    v_mfma_f32_16x16x32_bf16 v[140:143], v[60:63], a[188:191], v[140:143]
    s_waitcnt lgkmcnt(4)
    v_rcp_f32 v187, v187
    v_mfma_f32_16x16x32_bf16 v[112:115], v[16:19], a[192:195], v[112:115]
    ds_read_b128 v[48:51], v5 offset:8192
    v_mul_f32 v186, v90, v186
    v_mfma_f32_16x16x32_bf16 v[120:123], v[16:19], a[196:199], v[120:123]
    buffer_store_dwordx4 v[12:15], v3, s[20:23], s51 offen offset:3072 sc1
    v_mfma_f32_16x16x32_bf16 v[116:119], v[20:23], a[192:195], v[116:119]
    ds_read_b128 v[52:55], v5 offset:9216
    s_add_u32 m0, s57, 81920
    v_mfma_f32_16x16x32_bf16 v[124:127], v[20:23], a[196:199], v[124:127]
    buffer_load_dwordx4 v0, s[20:23], m0 offen offset:0 sc1 lds
    v_mul_f32 v187, v91, v187
    v_mfma_f32_16x16x32_bf16 v[128:131], v[24:27], a[192:195], v[128:131]
    ds_read_b128 v[56:59], v5 offset:10240
    v_mul_f32 v93, v93, v11
    v_mfma_f32_16x16x32_bf16 v[136:139], v[24:27], a[196:199], v[136:139]
    buffer_load_dwordx4 v0, s[20:23], m0 offen offset:1024 sc1 lds
    v_mfma_f32_16x16x32_bf16 v[132:135], v[28:31], a[192:195], v[132:135]
    ds_read_b128 v[60:63], v5 offset:11264
    v_mul_f32 v94, v94, v11
    v_mfma_f32_16x16x32_bf16 v[140:143], v[28:31], a[196:199], v[140:143]
    s_waitcnt lgkmcnt(4)
    v_exp_f32 v188, -v92
    v_mfma_f32_16x16x32_bf16 v[112:115], v[32:35], a[200:203], v[112:115]
    ds_read_b128 v[16:19], v5 offset:12288
    v_exp_f32 v189, -v93
    v_mfma_f32_16x16x32_bf16 v[120:123], v[32:35], a[204:207], v[120:123]
    s_waitcnt vmcnt(14)
    v_cmp_eq_u32 vcc, 0, v9
    s_nop 0
    s_cbranch_vccnz main_kernel_sloww2
main_kernel_backw2:
    v_mfma_f32_16x16x32_bf16 v[116:119], v[36:39], a[200:203], v[116:119]
    ds_read_b128 v[20:23], v5 offset:13312
    v_mul_f32 v95, v95, v11
    v_mfma_f32_16x16x32_bf16 v[124:127], v[36:39], a[204:207], v[124:127]
    v_exp_f32 v190, -v94
    v_mfma_f32_16x16x32_bf16 v[128:131], v[40:43], a[200:203], v[128:131]
    ds_read_b128 v[24:27], v5 offset:14336
    v_fma_f32 v188, v188, s50, s50
    v_mfma_f32_16x16x32_bf16 v[136:139], v[40:43], a[204:207], v[136:139]
    buffer_load_dwordx4 v0, s[20:23], m0 offen offset:2048 sc1 lds
    v_fma_f32 v189, v189, s50, s50
    v_mfma_f32_16x16x32_bf16 v[132:135], v[44:47], a[200:203], v[132:135]
    ds_read_b128 v[28:31], v5 offset:15360
    v_fma_f32 v190, v190, s50, s50
    v_mfma_f32_16x16x32_bf16 v[140:143], v[44:47], a[204:207], v[140:143]
    s_waitcnt lgkmcnt(4)
    v_exp_f32 v191, -v95
    v_mfma_f32_16x16x32_bf16 v[112:115], v[48:51], a[208:211], v[112:115]
    ds_read_b128 v[32:35], v5 offset:16384
    v_fma_f32 v191, v191, s50, s50
    v_mfma_f32_16x16x32_bf16 v[120:123], v[48:51], a[212:215], v[120:123]
    buffer_load_dwordx4 v0, s[20:23], m0 offen offset:3072 sc1 lds
    v_mfma_f32_16x16x32_bf16 v[116:119], v[52:55], a[208:211], v[116:119]
    ds_read_b128 v[36:39], v5 offset:17408
    v_rcp_f32 v188, v188
    v_mfma_f32_16x16x32_bf16 v[124:127], v[52:55], a[212:215], v[124:127]
    v_rcp_f32 v189, v189
    v_mfma_f32_16x16x32_bf16 v[128:131], v[56:59], a[208:211], v[128:131]
    ds_read_b128 v[40:43], v5 offset:18432
    v_mul_f32 v188, v92, v188
    v_mfma_f32_16x16x32_bf16 v[136:139], v[56:59], a[212:215], v[136:139]
    v_rcp_f32 v190, v190
    v_mfma_f32_16x16x32_bf16 v[132:135], v[60:63], a[208:211], v[132:135]
    ds_read_b128 v[44:47], v5 offset:19456
    v_mul_f32 v189, v93, v189
    v_mfma_f32_16x16x32_bf16 v[140:143], v[60:63], a[212:215], v[140:143]
    s_waitcnt lgkmcnt(4)
    v_rcp_f32 v191, v191
    v_mul_f32 v190, v94, v190
    v_mfma_f32_16x16x32_bf16 v[112:115], v[16:19], a[216:219], v[112:115]
    ds_read_b128 v[48:51], v5 offset:20480
    s_add_u32 m0, s57, 98304
    v_mfma_f32_16x16x32_bf16 v[120:123], v[16:19], a[220:223], v[120:123]
    buffer_load_dwordx4 v0, s[20:23], m0 offen offset:0 sc1 lds
    v_mfma_f32_16x16x32_bf16 v[116:119], v[20:23], a[216:219], v[116:119]
    ds_read_b128 v[52:55], v5 offset:21504
    v_mul_f32 v191, v95, v191
    v_mfma_f32_16x16x32_bf16 v[124:127], v[20:23], a[220:223], v[124:127]
    v_cvt_pk_bf16_f32 v88, v184, v185
    v_cvt_pk_bf16_f32 v89, v186, v187
    v_mfma_f32_16x16x32_bf16 v[128:131], v[24:27], a[216:219], v[128:131]
    ds_read_b128 v[56:59], v5 offset:22528
    v_cvt_pk_bf16_f32 v90, v188, v189
    v_cvt_pk_bf16_f32 v91, v190, v191
    v_mfma_f32_16x16x32_bf16 v[136:139], v[24:27], a[220:223], v[136:139]
    buffer_load_dwordx4 v0, s[20:23], m0 offen offset:1024 sc1 lds
    v_mfma_f32_16x16x32_bf16 v[132:135], v[28:31], a[216:219], v[132:135]
    ds_read_b128 v[60:63], v5 offset:23552
    v_mul_f32 v96, v96, v10
    v_mfma_f32_16x16x32_bf16 v[140:143], v[28:31], a[220:223], v[140:143]
    s_waitcnt lgkmcnt(4)
    v_exp_f32 v176, -v96
    v_mfma_f32_16x16x32_bf16 v[112:115], v[32:35], a[224:227], v[112:115]
    ds_read_b128 v[16:19], v5 offset:24576
    v_mul_f32 v97, v97, v10
    v_mfma_f32_16x16x32_bf16 v[120:123], v[32:35], a[228:231], v[120:123]
    buffer_store_dwordx4 v[88:91], v4, s[20:23], s32 offen offset:1024 sc1
    v_mul_f32 v98, v98, v10
    v_mfma_f32_16x16x32_bf16 v[116:119], v[36:39], a[224:227], v[116:119]
    ds_read_b128 v[20:23], v5 offset:25600
    v_mul_f32 v99, v99, v10
    v_mfma_f32_16x16x32_bf16 v[124:127], v[36:39], a[228:231], v[124:127]
    v_exp_f32 v177, -v97
    v_mfma_f32_16x16x32_bf16 v[128:131], v[40:43], a[224:227], v[128:131]
    ds_read_b128 v[24:27], v5 offset:26624
    v_fma_f32 v176, v176, s50, s50
    v_mfma_f32_16x16x32_bf16 v[136:139], v[40:43], a[228:231], v[136:139]
    buffer_load_dwordx4 v0, s[20:23], m0 offen offset:2048 sc1 lds
    v_mfma_f32_16x16x32_bf16 v[132:135], v[44:47], a[224:227], v[132:135]
    ds_read_b128 v[28:31], v5 offset:27648
    v_exp_f32 v178, -v98
    v_mfma_f32_16x16x32_bf16 v[140:143], v[44:47], a[228:231], v[140:143]
    s_waitcnt lgkmcnt(4)
    v_exp_f32 v179, -v99
    v_mfma_f32_16x16x32_bf16 v[112:115], v[48:51], a[232:235], v[112:115]
    ds_read_b128 v[32:35], v5 offset:28672
    v_fma_f32 v177, v177, s50, s50
    v_mfma_f32_16x16x32_bf16 v[120:123], v[48:51], a[236:239], v[120:123]
    buffer_load_dwordx4 v0, s[20:23], m0 offen offset:3072 sc1 lds
    v_mfma_f32_16x16x32_bf16 v[116:119], v[52:55], a[232:235], v[116:119]
    ds_read_b128 v[36:39], v5 offset:29696
    v_fma_f32 v178, v178, s50, s50
    v_mfma_f32_16x16x32_bf16 v[124:127], v[52:55], a[236:239], v[124:127]
    v_rcp_f32 v176, v176
    v_fma_f32 v179, v179, s50, s50
    v_mfma_f32_16x16x32_bf16 v[128:131], v[56:59], a[232:235], v[128:131]
    ds_read_b128 v[40:43], v5 offset:30720
    v_mul_f32 v176, v96, v176
    v_mfma_f32_16x16x32_bf16 v[136:139], v[56:59], a[236:239], v[136:139]
    buffer_atomic_add v7, v6, s[20:23], s49 offen offset:0 sc1
    v_mfma_f32_16x16x32_bf16 v[132:135], v[60:63], a[232:235], v[132:135]
    ds_read_b128 v[44:47], v5 offset:31744
    v_mul_f32 v100, v100, v10
    v_mfma_f32_16x16x32_bf16 v[140:143], v[60:63], a[236:239], v[140:143]
    s_waitcnt lgkmcnt(4)
    s_barrier
    v_mfma_f32_16x16x32_bf16 v[112:115], v[16:19], a[240:243], v[112:115]
    ds_read_b128 v[48:51], v3 offset:0
    s_add_u32 m0, s57, 114688
    v_mul_f32 v101, v101, v10
    v_mfma_f32_16x16x32_bf16 v[120:123], v[16:19], a[244:247], v[120:123]
    buffer_load_dwordx4 v0, s[20:23], m0 offen offset:0 sc1 lds
    v_mfma_f32_16x16x32_bf16 v[116:119], v[20:23], a[240:243], v[116:119]
    ds_read_b128 v[52:55], v3 offset:1024
    v_mul_f32 v102, v102, v10
    v_mfma_f32_16x16x32_bf16 v[124:127], v[20:23], a[244:247], v[124:127]
    v_rcp_f32 v177, v177
    v_mfma_f32_16x16x32_bf16 v[128:131], v[24:27], a[240:243], v[128:131]
    ds_read_b128 v[56:59], v3 offset:2048
    v_mul_f32 v177, v97, v177
    v_mfma_f32_16x16x32_bf16 v[136:139], v[24:27], a[244:247], v[136:139]
    buffer_load_dwordx4 v0, s[20:23], m0 offen offset:1024 sc1 lds
    v_mul_f32 v103, v103, v10
    v_mfma_f32_16x16x32_bf16 v[132:135], v[28:31], a[240:243], v[132:135]
    ds_read_b128 v[60:63], v3 offset:3072
    v_cvt_pk_bf16_f32 v96, v176, v177
    v_mfma_f32_16x16x32_bf16 v[140:143], v[28:31], a[244:247], v[140:143]
    s_waitcnt lgkmcnt(4)
    v_rcp_f32 v178, v178
    v_mfma_f32_16x16x32_bf16 v[112:115], v[32:35], a[248:251], v[112:115]
    ds_read_b128 v[16:19], v3 offset:4096
    v_mul_f32 v178, v98, v178
    v_mfma_f32_16x16x32_bf16 v[120:123], v[32:35], a[252:255], v[120:123]
    v_rcp_f32 v179, v179
    v_mfma_f32_16x16x32_bf16 v[116:119], v[36:39], a[248:251], v[116:119]
    ds_read_b128 v[20:23], v3 offset:5120
    v_exp_f32 v180, -v100
    v_mfma_f32_16x16x32_bf16 v[124:127], v[36:39], a[252:255], v[124:127]
    v_exp_f32 v181, -v101
    v_mfma_f32_16x16x32_bf16 v[128:131], v[40:43], a[248:251], v[128:131]
    ds_read_b128 v[24:27], v3 offset:6144
    v_mul_f32 v179, v99, v179
    v_mfma_f32_16x16x32_bf16 v[136:139], v[40:43], a[252:255], v[136:139]
    v_exp_f32 v182, -v102
    v_mfma_f32_16x16x32_bf16 v[132:135], v[44:47], a[248:251], v[132:135]
    ds_read_b128 v[28:31], v3 offset:7168
    v_fma_f32 v180, v180, s50, s50
    v_mfma_f32_16x16x32_bf16 v[140:143], v[44:47], a[252:255], v[140:143]
    s_waitcnt lgkmcnt(4)
    v_exp_f32 v183, -v103
    v_fma_f32 v181, v181, s50, s50
    v_mfma_f32_16x16x32_bf16 v[144:147], v[48:51], a[0:3], 0
    ds_read_b128 v[32:35], v3 offset:8192
    v_fma_f32 v182, v182, s50, s50
    v_mfma_f32_16x16x32_bf16 v[152:155], v[48:51], a[4:7], 0
    buffer_load_dwordx4 v0, s[20:23], m0 offen offset:2048 sc1 lds
    v_mfma_f32_16x16x32_bf16 v[148:151], v[52:55], a[0:3], 0
    ds_read_b128 v[36:39], v3 offset:9216
    v_fma_f32 v183, v183, s50, s50
    v_mfma_f32_16x16x32_bf16 v[156:159], v[52:55], a[4:7], 0
    v_rcp_f32 v180, v180
    v_mfma_f32_16x16x32_bf16 v[160:163], v[56:59], a[0:3], 0
    ds_read_b128 v[40:43], v3 offset:10240
    v_rcp_f32 v181, v181
    v_mfma_f32_16x16x32_bf16 v[168:171], v[56:59], a[4:7], 0
    buffer_load_dwordx4 v0, s[20:23], m0 offen offset:3072 sc1 lds
    v_mfma_f32_16x16x32_bf16 v[164:167], v[60:63], a[0:3], 0
    ds_read_b128 v[44:47], v3 offset:11264
    v_mul_f32 v180, v100, v180
    v_mfma_f32_16x16x32_bf16 v[172:175], v[60:63], a[4:7], 0
    s_waitcnt lgkmcnt(4)
    v_rcp_f32 v182, v182
    v_mfma_f32_16x16x32_bf16 v[144:147], v[16:19], a[8:11], v[144:147]
    ds_read_b128 v[48:51], v3 offset:12288
    s_add_u32 m0, s57, 131072
    v_mfma_f32_16x16x32_bf16 v[152:155], v[16:19], a[12:15], v[152:155]
    buffer_load_dwordx4 v0, s[20:23], m0 offen offset:0 sc1 lds
    v_mul_f32 v181, v101, v181
    v_mfma_f32_16x16x32_bf16 v[148:151], v[20:23], a[8:11], v[148:151]
    ds_read_b128 v[52:55], v3 offset:13312
    v_mul_f32 v182, v102, v182
    v_mfma_f32_16x16x32_bf16 v[156:159], v[20:23], a[12:15], v[156:159]
    v_rcp_f32 v183, v183
    v_mfma_f32_16x16x32_bf16 v[160:163], v[24:27], a[8:11], v[160:163]
    ds_read_b128 v[56:59], v3 offset:14336
    v_mul_f32 v183, v103, v183
    v_mfma_f32_16x16x32_bf16 v[168:171], v[24:27], a[12:15], v[168:171]
    buffer_load_dwordx4 v0, s[20:23], m0 offen offset:1024 sc1 lds
    v_mfma_f32_16x16x32_bf16 v[164:167], v[28:31], a[8:11], v[164:167]
    ds_read_b128 v[60:63], v3 offset:15360
    v_cvt_pk_bf16_f32 v97, v178, v179
    v_cvt_pk_bf16_f32 v98, v180, v181
    v_mfma_f32_16x16x32_bf16 v[172:175], v[28:31], a[12:15], v[172:175]
    s_waitcnt lgkmcnt(4)
    v_cvt_pk_bf16_f32 v99, v182, v183
    v_mul_f32 v104, v104, v11
    v_mfma_f32_16x16x32_bf16 v[144:147], v[32:35], a[16:19], v[144:147]
    ds_read_b128 v[16:19], v3 offset:16384
    v_mul_f32 v105, v105, v11
    v_mfma_f32_16x16x32_bf16 v[152:155], v[32:35], a[20:23], v[152:155]
    buffer_load_dwordx4 v0, s[20:23], m0 offen offset:2048 sc1 lds
    v_mfma_f32_16x16x32_bf16 v[148:151], v[36:39], a[16:19], v[148:151]
    ds_read_b128 v[20:23], v3 offset:17408
    v_mul_f32 v106, v106, v11
    v_mfma_f32_16x16x32_bf16 v[156:159], v[36:39], a[20:23], v[156:159]
    v_exp_f32 v184, -v104
    v_mul_f32 v107, v107, v11
    v_mfma_f32_16x16x32_bf16 v[160:163], v[40:43], a[16:19], v[160:163]
    ds_read_b128 v[24:27], v3 offset:18432
    v_fma_f32 v184, v184, s50, s50
    v_mfma_f32_16x16x32_bf16 v[168:171], v[40:43], a[20:23], v[168:171]
    buffer_load_dwordx4 v0, s[20:23], m0 offen offset:3072 sc1 lds
    v_mfma_f32_16x16x32_bf16 v[164:167], v[44:47], a[16:19], v[164:167]
    ds_read_b128 v[28:31], v3 offset:19456
    v_mul_f32 v108, v108, v11
    v_mfma_f32_16x16x32_bf16 v[172:175], v[44:47], a[20:23], v[172:175]
    s_waitcnt lgkmcnt(4)
    v_exp_f32 v185, -v105
    v_mfma_f32_16x16x32_bf16 v[144:147], v[48:51], a[24:27], v[144:147]
    ds_read_b128 v[32:35], v3 offset:20480
    v_exp_f32 v186, -v106
    v_mfma_f32_16x16x32_bf16 v[152:155], v[48:51], a[28:31], v[152:155]
    buffer_store_dwordx4 v[96:99], v5, s[20:23], s32 offen offset:0 sc1
    v_mfma_f32_16x16x32_bf16 v[148:151], v[52:55], a[24:27], v[148:151]
    ds_read_b128 v[36:39], v3 offset:21504
    v_fma_f32 v185, v185, s50, s50
    v_mfma_f32_16x16x32_bf16 v[156:159], v[52:55], a[28:31], v[156:159]
    v_exp_f32 v187, -v107
    v_mfma_f32_16x16x32_bf16 v[160:163], v[56:59], a[24:27], v[160:163]
    ds_read_b128 v[40:43], v3 offset:22528
    v_fma_f32 v186, v186, s50, s50
    v_mfma_f32_16x16x32_bf16 v[168:171], v[56:59], a[28:31], v[168:171]
    v_rcp_f32 v184, v184
    v_fma_f32 v187, v187, s50, s50
    v_mfma_f32_16x16x32_bf16 v[164:167], v[60:63], a[24:27], v[164:167]
    ds_read_b128 v[44:47], v3 offset:23552
    v_mul_f32 v184, v104, v184
    v_mfma_f32_16x16x32_bf16 v[172:175], v[60:63], a[28:31], v[172:175]
    s_waitcnt lgkmcnt(4)
    v_rcp_f32 v185, v185
    v_mfma_f32_16x16x32_bf16 v[144:147], v[16:19], a[32:35], v[144:147]
    ds_read_b128 v[48:51], v3 offset:24576
    v_mul_f32 v185, v105, v185
    v_mfma_f32_16x16x32_bf16 v[152:155], v[16:19], a[36:39], v[152:155]
    v_rcp_f32 v186, v186
    v_mfma_f32_16x16x32_bf16 v[148:151], v[20:23], a[32:35], v[148:151]
    ds_read_b128 v[52:55], v3 offset:25600
    v_rcp_f32 v187, v187
    v_mfma_f32_16x16x32_bf16 v[156:159], v[20:23], a[36:39], v[156:159]
    v_exp_f32 v188, -v108
    v_mfma_f32_16x16x32_bf16 v[160:163], v[24:27], a[32:35], v[160:163]
    ds_read_b128 v[56:59], v3 offset:26624
    v_mul_f32 v186, v106, v186
    v_mfma_f32_16x16x32_bf16 v[168:171], v[24:27], a[36:39], v[168:171]
    v_mul_f32 v187, v107, v187
    v_mul_f32 v109, v109, v11
    v_mfma_f32_16x16x32_bf16 v[164:167], v[28:31], a[32:35], v[164:167]
    ds_read_b128 v[60:63], v3 offset:27648
    v_mul_f32 v110, v110, v11
    v_mfma_f32_16x16x32_bf16 v[172:175], v[28:31], a[36:39], v[172:175]
    s_waitcnt lgkmcnt(4)
    v_exp_f32 v189, -v109
    v_mul_f32 v111, v111, v11
    v_mfma_f32_16x16x32_bf16 v[144:147], v[32:35], a[40:43], v[144:147]
    ds_read_b128 v[16:19], v3 offset:28672
    v_fma_f32 v188, v188, s50, s50
    v_mfma_f32_16x16x32_bf16 v[152:155], v[32:35], a[44:47], v[152:155]
    v_exp_f32 v190, -v110
    v_mfma_f32_16x16x32_bf16 v[148:151], v[36:39], a[40:43], v[148:151]
    ds_read_b128 v[20:23], v3 offset:29696
    v_fma_f32 v189, v189, s50, s50
    v_mfma_f32_16x16x32_bf16 v[156:159], v[36:39], a[44:47], v[156:159]
    v_exp_f32 v191, -v111
    v_mfma_f32_16x16x32_bf16 v[160:163], v[40:43], a[40:43], v[160:163]
    ds_read_b128 v[24:27], v3 offset:30720
    v_rcp_f32 v188, v188
    v_mfma_f32_16x16x32_bf16 v[168:171], v[40:43], a[44:47], v[168:171]
    v_rcp_f32 v189, v189
    v_mfma_f32_16x16x32_bf16 v[164:167], v[44:47], a[40:43], v[164:167]
    ds_read_b128 v[28:31], v3 offset:31744
    v_fma_f32 v190, v190, s50, s50
    v_mfma_f32_16x16x32_bf16 v[172:175], v[44:47], a[44:47], v[172:175]
    s_waitcnt lgkmcnt(4) vmcnt(25)
    s_barrier
    v_mfma_f32_16x16x32_bf16 v[144:147], v[48:51], a[48:51], v[144:147]
    ds_read_b128 v[32:35], v3 offset:32768
    s_add_u32 m0, s57, 147456
    v_mfma_f32_16x16x32_bf16 v[152:155], v[48:51], a[52:55], v[152:155]
    buffer_load_dwordx4 v0, s[20:23], m0 offen offset:0 sc1 lds
    v_fma_f32 v191, v191, s50, s50
    v_mfma_f32_16x16x32_bf16 v[148:151], v[52:55], a[48:51], v[148:151]
    ds_read_b128 v[36:39], v3 offset:33792
    v_mul_f32 v188, v108, v188
    v_mfma_f32_16x16x32_bf16 v[156:159], v[52:55], a[52:55], v[156:159]
    v_rcp_f32 v190, v190
    v_mfma_f32_16x16x32_bf16 v[160:163], v[56:59], a[48:51], v[160:163]
    ds_read_b128 v[40:43], v3 offset:34816
    v_mul_f32 v189, v109, v189
    v_mfma_f32_16x16x32_bf16 v[168:171], v[56:59], a[52:55], v[168:171]
    buffer_load_dwordx4 v0, s[20:23], m0 offen offset:1024 sc1 lds
    v_mfma_f32_16x16x32_bf16 v[164:167], v[60:63], a[48:51], v[164:167]
    ds_read_b128 v[44:47], v3 offset:35840
    v_rcp_f32 v191, v191
    v_mfma_f32_16x16x32_bf16 v[172:175], v[60:63], a[52:55], v[172:175]
    s_waitcnt lgkmcnt(4)
    v_mul_f32 v190, v110, v190
    v_mul_f32 v191, v111, v191
    v_mfma_f32_16x16x32_bf16 v[144:147], v[16:19], a[56:59], v[144:147]
    ds_read_b128 v[48:51], v3 offset:36864
    v_cvt_pk_bf16_f32 v104, v184, v185
    v_mfma_f32_16x16x32_bf16 v[152:155], v[16:19], a[60:63], v[152:155]
    buffer_load_dword v12, v8, s[20:23], s49 offen offset:0 sc1
    v_mfma_f32_16x16x32_bf16 v[148:151], v[20:23], a[56:59], v[148:151]
    ds_read_b128 v[52:55], v3 offset:37888
    v_cvt_pk_bf16_f32 v105, v186, v187
    v_mfma_f32_16x16x32_bf16 v[156:159], v[20:23], a[60:63], v[156:159]
    v_cvt_pk_bf16_f32 v106, v188, v189
    v_cvt_pk_bf16_f32 v107, v190, v191
    v_mul_f32 v112, v112, v10
    v_mfma_f32_16x16x32_bf16 v[160:163], v[24:27], a[56:59], v[160:163]
    ds_read_b128 v[56:59], v3 offset:38912
    v_mul_f32 v113, v113, v10
    v_mfma_f32_16x16x32_bf16 v[168:171], v[24:27], a[60:63], v[168:171]
    buffer_store_dwordx4 v[104:107], v5, s[20:23], s32 offen offset:1024 sc1
    v_mfma_f32_16x16x32_bf16 v[164:167], v[28:31], a[56:59], v[164:167]
    ds_read_b128 v[60:63], v3 offset:39936
    v_mul_f32 v114, v114, v10
    v_mfma_f32_16x16x32_bf16 v[172:175], v[28:31], a[60:63], v[172:175]
    s_waitcnt lgkmcnt(4)
    v_exp_f32 v176, -v112
    v_mfma_f32_16x16x32_bf16 v[144:147], v[32:35], a[64:67], v[144:147]
    ds_read_b128 v[16:19], v3 offset:40960
    v_exp_f32 v177, -v113
    v_mfma_f32_16x16x32_bf16 v[152:155], v[32:35], a[68:71], v[152:155]
    buffer_load_dwordx4 v0, s[20:23], m0 offen offset:2048 sc1 lds
    v_mfma_f32_16x16x32_bf16 v[148:151], v[36:39], a[64:67], v[148:151]
    ds_read_b128 v[20:23], v3 offset:41984
    v_mul_f32 v115, v115, v10
    v_mfma_f32_16x16x32_bf16 v[156:159], v[36:39], a[68:71], v[156:159]
main_kernel_stub11:
    s_cbranch_execz main_kernel_ret
    v_exp_f32 v178, -v114
    v_mfma_f32_16x16x32_bf16 v[160:163], v[40:43], a[64:67], v[160:163]
    ds_read_b128 v[24:27], v3 offset:43008
    v_fma_f32 v176, v176, s50, s50
    v_mfma_f32_16x16x32_bf16 v[168:171], v[40:43], a[68:71], v[168:171]
    buffer_load_dwordx4 v0, s[20:23], m0 offen offset:3072 sc1 lds
    v_add_u32 v0, 163840, v0
    v_fma_f32 v177, v177, s50, s50
    v_mfma_f32_16x16x32_bf16 v[164:167], v[44:47], a[64:67], v[164:167]
    ds_read_b128 v[28:31], v3 offset:44032
    v_fma_f32 v178, v178, s50, s50
    v_mfma_f32_16x16x32_bf16 v[172:175], v[44:47], a[68:71], v[172:175]
    s_waitcnt lgkmcnt(4)
    v_exp_f32 v179, -v115
    v_mfma_f32_16x16x32_bf16 v[144:147], v[48:51], a[72:75], v[144:147]
    ds_read_b128 v[32:35], v3 offset:45056
    s_add_u32 m0, s57, 0
    v_mfma_f32_16x16x32_bf16 v[152:155], v[48:51], a[76:79], v[152:155]
    buffer_load_dwordx4 v0, s[20:23], m0 offen offset:0 sc1 lds
    v_mfma_f32_16x16x32_bf16 v[148:151], v[52:55], a[72:75], v[148:151]
    ds_read_b128 v[36:39], v3 offset:46080
    v_rcp_f32 v176, v176
    v_mfma_f32_16x16x32_bf16 v[156:159], v[52:55], a[76:79], v[156:159]
    v_rcp_f32 v177, v177
    v_mfma_f32_16x16x32_bf16 v[160:163], v[56:59], a[72:75], v[160:163]
    ds_read_b128 v[40:43], v3 offset:47104
    v_fma_f32 v179, v179, s50, s50
    v_mfma_f32_16x16x32_bf16 v[168:171], v[56:59], a[76:79], v[168:171]
    buffer_load_dwordx4 v0, s[20:23], m0 offen offset:1024 sc1 lds
    v_mfma_f32_16x16x32_bf16 v[164:167], v[60:63], a[72:75], v[164:167]
    ds_read_b128 v[44:47], v3 offset:48128
    v_mul_f32 v176, v112, v176
    v_mfma_f32_16x16x32_bf16 v[172:175], v[60:63], a[76:79], v[172:175]
    s_waitcnt lgkmcnt(4)
    v_rcp_f32 v178, v178
    v_mul_f32 v177, v113, v177
    v_mfma_f32_16x16x32_bf16 v[144:147], v[16:19], a[80:83], v[144:147]
    ds_read_b128 v[48:51], v3 offset:49152
    v_mul_f32 v178, v114, v178
    v_mfma_f32_16x16x32_bf16 v[152:155], v[16:19], a[84:87], v[152:155]
    s_waitcnt vmcnt(20)
    buffer_atomic_add v7, v6, s[20:23], s49 offen offset:256 sc1
    v_mfma_f32_16x16x32_bf16 v[148:151], v[20:23], a[80:83], v[148:151]
    ds_read_b128 v[52:55], v3 offset:50176
    v_mul_f32 v116, v116, v10
    v_mfma_f32_16x16x32_bf16 v[156:159], v[20:23], a[84:87], v[156:159]
    v_rcp_f32 v179, v179
    v_mfma_f32_16x16x32_bf16 v[160:163], v[24:27], a[80:83], v[160:163]
    ds_read_b128 v[56:59], v3 offset:51200
    v_exp_f32 v180, -v116
    v_mfma_f32_16x16x32_bf16 v[168:171], v[24:27], a[84:87], v[168:171]
    v_mul_f32 v179, v115, v179
    v_mul_f32 v117, v117, v10
    v_mfma_f32_16x16x32_bf16 v[164:167], v[28:31], a[80:83], v[164:167]
    ds_read_b128 v[60:63], v3 offset:52224
    v_mul_f32 v118, v118, v10
    v_mfma_f32_16x16x32_bf16 v[172:175], v[28:31], a[84:87], v[172:175]
    s_waitcnt lgkmcnt(4)
    v_exp_f32 v181, -v117
    v_mfma_f32_16x16x32_bf16 v[144:147], v[32:35], a[88:91], v[144:147]
    ds_read_b128 v[16:19], v3 offset:53248
    v_mul_f32 v119, v119, v10
    v_mfma_f32_16x16x32_bf16 v[152:155], v[32:35], a[92:95], v[152:155]
    buffer_load_dwordx4 v0, s[20:23], m0 offen offset:2048 sc1 lds
    v_fma_f32 v180, v180, s50, s50
    v_mfma_f32_16x16x32_bf16 v[148:151], v[36:39], a[88:91], v[148:151]
    ds_read_b128 v[20:23], v3 offset:54272
    v_fma_f32 v181, v181, s50, s50
    v_mfma_f32_16x16x32_bf16 v[156:159], v[36:39], a[92:95], v[156:159]
    v_exp_f32 v182, -v118
    v_mfma_f32_16x16x32_bf16 v[160:163], v[40:43], a[88:91], v[160:163]
    ds_read_b128 v[24:27], v3 offset:55296
    v_fma_f32 v182, v182, s50, s50
    v_mfma_f32_16x16x32_bf16 v[168:171], v[40:43], a[92:95], v[168:171]
    buffer_load_dwordx4 v0, s[20:23], m0 offen offset:3072 sc1 lds
    v_mfma_f32_16x16x32_bf16 v[164:167], v[44:47], a[88:91], v[164:167]
    ds_read_b128 v[28:31], v3 offset:56320
    v_exp_f32 v183, -v119
    v_mfma_f32_16x16x32_bf16 v[172:175], v[44:47], a[92:95], v[172:175]
    s_waitcnt lgkmcnt(4)
    v_rcp_f32 v180, v180
    v_mfma_f32_16x16x32_bf16 v[144:147], v[48:51], a[96:99], v[144:147]
    ds_read_b128 v[32:35], v3 offset:57344
    v_fma_f32 v183, v183, s50, s50
    v_mfma_f32_16x16x32_bf16 v[152:155], v[48:51], a[100:103], v[152:155]
    v_rcp_f32 v181, v181
    v_mfma_f32_16x16x32_bf16 v[148:151], v[52:55], a[96:99], v[148:151]
    ds_read_b128 v[36:39], v3 offset:58368
    v_mul_f32 v180, v116, v180
    v_mfma_f32_16x16x32_bf16 v[156:159], v[52:55], a[100:103], v[156:159]
    v_rcp_f32 v182, v182
    v_mul_f32 v181, v117, v181
    v_mfma_f32_16x16x32_bf16 v[160:163], v[56:59], a[96:99], v[160:163]
    ds_read_b128 v[40:43], v3 offset:59392
    v_mul_f32 v182, v118, v182
    v_mfma_f32_16x16x32_bf16 v[168:171], v[56:59], a[100:103], v[168:171]
    v_rcp_f32 v183, v183
    v_mfma_f32_16x16x32_bf16 v[164:167], v[60:63], a[96:99], v[164:167]
    ds_read_b128 v[44:47], v3 offset:60416
    v_mul_f32 v183, v119, v183
    v_mfma_f32_16x16x32_bf16 v[172:175], v[60:63], a[100:103], v[172:175]
    s_waitcnt lgkmcnt(4)
    v_cvt_pk_bf16_f32 v112, v176, v177
    v_cvt_pk_bf16_f32 v113, v178, v179
    v_mfma_f32_16x16x32_bf16 v[144:147], v[16:19], a[104:107], v[144:147]
    ds_read_b128 v[48:51], v3 offset:61440
    v_cvt_pk_bf16_f32 v114, v180, v181
    v_cvt_pk_bf16_f32 v115, v182, v183
    v_mfma_f32_16x16x32_bf16 v[152:155], v[16:19], a[108:111], v[152:155]
    v_mul_f32 v120, v120, v11
    v_mul_f32 v121, v121, v11
    v_mfma_f32_16x16x32_bf16 v[148:151], v[20:23], a[104:107], v[148:151]
    ds_read_b128 v[52:55], v3 offset:62464
    v_mul_f32 v122, v122, v11
    v_mfma_f32_16x16x32_bf16 v[156:159], v[20:23], a[108:111], v[156:159]
    v_exp_f32 v184, -v120
    v_mfma_f32_16x16x32_bf16 v[160:163], v[24:27], a[104:107], v[160:163]
    ds_read_b128 v[56:59], v3 offset:63488
    v_mul_f32 v123, v123, v11
    v_mfma_f32_16x16x32_bf16 v[168:171], v[24:27], a[108:111], v[168:171]
    buffer_store_dwordx4 v[112:115], v1, s[20:23], s32 offen offset:0 sc1
    v_fma_f32 v184, v184, s50, s50
    v_mfma_f32_16x16x32_bf16 v[164:167], v[28:31], a[104:107], v[164:167]
    ds_read_b128 v[60:63], v3 offset:64512
    v_mul_f32 v124, v124, v11
    v_mfma_f32_16x16x32_bf16 v[172:175], v[28:31], a[108:111], v[172:175]
    s_waitcnt lgkmcnt(4)
    s_barrier
    v_mfma_f32_16x16x32_bf16 v[144:147], v[32:35], a[112:115], v[144:147]
    ds_read_b128 v[16:19], v4 offset:0
    s_add_u32 m0, s57, 16384
    v_mfma_f32_16x16x32_bf16 v[152:155], v[32:35], a[116:119], v[152:155]
    buffer_load_dwordx4 v0, s[20:23], m0 offen offset:0 sc1 lds
    v_mfma_f32_16x16x32_bf16 v[148:151], v[36:39], a[112:115], v[148:151]
    ds_read_b128 v[20:23], v4 offset:1024
    v_exp_f32 v185, -v121
    v_mfma_f32_16x16x32_bf16 v[156:159], v[36:39], a[116:119], v[156:159]
    v_exp_f32 v186, -v122
    v_mfma_f32_16x16x32_bf16 v[160:163], v[40:43], a[112:115], v[160:163]
    ds_read_b128 v[24:27], v4 offset:2048
    v_fma_f32 v185, v185, s50, s50
    v_mfma_f32_16x16x32_bf16 v[168:171], v[40:43], a[116:119], v[168:171]
    buffer_load_dwordx4 v0, s[20:23], m0 offen offset:1024 sc1 lds
    v_mfma_f32_16x16x32_bf16 v[164:167], v[44:47], a[112:115], v[164:167]
    ds_read_b128 v[28:31], v4 offset:3072
    v_fma_f32 v186, v186, s50, s50
    v_mfma_f32_16x16x32_bf16 v[172:175], v[44:47], a[116:119], v[172:175]
    s_waitcnt lgkmcnt(4)
    v_exp_f32 v187, -v123
    v_mul_f32 v125, v125, v11
    v_mfma_f32_16x16x32_bf16 v[144:147], v[48:51], a[120:123], v[144:147]
    ds_read_b128 v[32:35], v4 offset:4096
    v_fma_f32 v187, v187, s50, s50
    v_mfma_f32_16x16x32_bf16 v[152:155], v[48:51], a[124:127], v[152:155]
    s_waitcnt vmcnt(11)
    v_readfirstlane_b32 s31, v12
    s_nop 0
    s_cmp_lt_u32 s31, 8
    s_cbranch_scc1 main_kernel_slow0
main_kernel_back0:
    v_mfma_f32_16x16x32_bf16 v[148:151], v[52:55], a[120:123], v[148:151]
    ds_read_b128 v[36:39], v4 offset:5120
    v_mul_f32 v126, v126, v11
    v_mfma_f32_16x16x32_bf16 v[156:159], v[52:55], a[124:127], v[156:159]
    v_rcp_f32 v184, v184
    v_mfma_f32_16x16x32_bf16 v[160:163], v[56:59], a[120:123], v[160:163]
    ds_read_b128 v[40:43], v4 offset:6144
    v_rcp_f32 v185, v185
    v_mfma_f32_16x16x32_bf16 v[168:171], v[56:59], a[124:127], v[168:171]
    buffer_load_dwordx4 a[0:3], v3, s[20:23], s33 offen offset:0 sc1
    v_mfma_f32_16x16x32_bf16 v[164:167], v[60:63], a[120:123], v[164:167]
    ds_read_b128 v[44:47], v4 offset:7168
    v_mul_f32 v184, v120, v184
    v_mfma_f32_16x16x32_bf16 v[172:175], v[60:63], a[124:127], v[172:175]
    s_waitcnt lgkmcnt(4)
    v_rcp_f32 v186, v186
    v_mfma_f32_16x16x32_bf16 v[144:147], v[16:19], a[128:131], v[144:147]
    ds_read_b128 v[48:51], v4 offset:8192
    v_mul_f32 v185, v121, v185
    v_mfma_f32_16x16x32_bf16 v[152:155], v[16:19], a[132:135], v[152:155]
    buffer_load_dwordx4 a[4:7], v3, s[20:23], s33 offen offset:1024 sc1
    v_mul_f32 v186, v122, v186
    v_mfma_f32_16x16x32_bf16 v[148:151], v[20:23], a[128:131], v[148:151]
    ds_read_b128 v[52:55], v4 offset:9216
    v_mul_f32 v127, v127, v11
    v_mfma_f32_16x16x32_bf16 v[156:159], v[20:23], a[132:135], v[156:159]
    buffer_load_dwordx4 v0, s[20:23], m0 offen offset:2048 sc1 lds
    v_mfma_f32_16x16x32_bf16 v[160:163], v[24:27], a[128:131], v[160:163]
    ds_read_b128 v[56:59], v4 offset:10240
    v_cvt_pk_bf16_f32 v120, v184, v185
    v_mfma_f32_16x16x32_bf16 v[168:171], v[24:27], a[132:135], v[168:171]
    buffer_load_dwordx4 v0, s[20:23], m0 offen offset:3072 sc1 lds
    v_mfma_f32_16x16x32_bf16 v[164:167], v[28:31], a[128:131], v[164:167]
    ds_read_b128 v[60:63], v4 offset:11264
    v_rcp_f32 v187, v187
    v_mfma_f32_16x16x32_bf16 v[172:175], v[28:31], a[132:135], v[172:175]
    s_waitcnt lgkmcnt(4)
    v_exp_f32 v188, -v124
    v_mfma_f32_16x16x32_bf16 v[144:147], v[32:35], a[136:139], v[144:147]
    ds_read_b128 v[16:19], v4 offset:12288
    v_mul_f32 v187, v123, v187
    v_mfma_f32_16x16x32_bf16 v[152:155], v[32:35], a[140:143], v[152:155]
    buffer_load_dwordx4 a[8:11], v3, s[20:23], s34 offen offset:0 sc1
    v_mfma_f32_16x16x32_bf16 v[148:151], v[36:39], a[136:139], v[148:151]
    ds_read_b128 v[20:23], v4 offset:13312
    v_fma_f32 v188, v188, s50, s50
    v_mfma_f32_16x16x32_bf16 v[156:159], v[36:39], a[140:143], v[156:159]
    v_exp_f32 v189, -v125
    v_cvt_pk_bf16_f32 v121, v186, v187
    v_mfma_f32_16x16x32_bf16 v[160:163], v[40:43], a[136:139], v[160:163]
    ds_read_b128 v[24:27], v4 offset:14336
    v_fma_f32 v189, v189, s50, s50
    v_mfma_f32_16x16x32_bf16 v[168:171], v[40:43], a[140:143], v[168:171]
    buffer_load_dwordx4 a[12:15], v3, s[20:23], s34 offen offset:1024 sc1
    v_mfma_f32_16x16x32_bf16 v[164:167], v[44:47], a[136:139], v[164:167]
    ds_read_b128 v[28:31], v4 offset:15360
    v_mul_f32 v128, v128, v10
    v_mfma_f32_16x16x32_bf16 v[172:175], v[44:47], a[140:143], v[172:175]
    s_waitcnt lgkmcnt(4)
    v_exp_f32 v190, -v126
    v_mfma_f32_16x16x32_bf16 v[144:147], v[48:51], a[144:147], v[144:147]
    ds_read_b128 v[32:35], v4 offset:16384
    v_exp_f32 v191, -v127
    v_mfma_f32_16x16x32_bf16 v[152:155], v[48:51], a[148:151], v[152:155]
    buffer_load_dwordx4 a[16:19], v3, s[20:23], s35 offen offset:0 sc1
    v_mfma_f32_16x16x32_bf16 v[148:151], v[52:55], a[144:147], v[148:151]
    ds_read_b128 v[36:39], v4 offset:17408
    v_fma_f32 v190, v190, s50, s50
    v_mfma_f32_16x16x32_bf16 v[156:159], v[52:55], a[148:151], v[156:159]
    v_rcp_f32 v188, v188
    v_mfma_f32_16x16x32_bf16 v[160:163], v[56:59], a[144:147], v[160:163]
    ds_read_b128 v[40:43], v4 offset:18432
    v_fma_f32 v191, v191, s50, s50
    v_mfma_f32_16x16x32_bf16 v[168:171], v[56:59], a[148:151], v[168:171]
    buffer_load_dwordx4 a[20:23], v3, s[20:23], s35 offen offset:1024 sc1
    v_mul_f32 v188, v124, v188
    v_mfma_f32_16x16x32_bf16 v[164:167], v[60:63], a[144:147], v[164:167]
    ds_read_b128 v[44:47], v4 offset:19456
    v_mul_f32 v129, v129, v10
    v_mfma_f32_16x16x32_bf16 v[172:175], v[60:63], a[148:151], v[172:175]
    s_waitcnt lgkmcnt(4)
    v_rcp_f32 v189, v189
    v_mfma_f32_16x16x32_bf16 v[144:147], v[16:19], a[152:155], v[144:147]
    ds_read_b128 v[48:51], v4 offset:20480
    s_add_u32 m0, s57, 32768
    v_mfma_f32_16x16x32_bf16 v[152:155], v[16:19], a[156:159], v[152:155]
    buffer_load_dwordx4 v0, s[20:23], m0 offen offset:0 sc1 lds
    v_mfma_f32_16x16x32_bf16 v[148:151], v[20:23], a[152:155], v[148:151]
    ds_read_b128 v[52:55], v4 offset:21504
    v_rcp_f32 v190, v190
    v_mfma_f32_16x16x32_bf16 v[156:159], v[20:23], a[156:159], v[156:159]
    v_rcp_f32 v191, v191
    v_mfma_f32_16x16x32_bf16 v[160:163], v[24:27], a[152:155], v[160:163]
    ds_read_b128 v[56:59], v4 offset:22528
    v_mul_f32 v189, v125, v189
    v_mfma_f32_16x16x32_bf16 v[168:171], v[24:27], a[156:159], v[168:171]
    buffer_load_dwordx4 v0, s[20:23], m0 offen offset:1024 sc1 lds
    v_mfma_f32_16x16x32_bf16 v[164:167], v[28:31], a[152:155], v[164:167]
    ds_read_b128 v[60:63], v4 offset:23552
    v_mul_f32 v190, v126, v190
    v_mfma_f32_16x16x32_bf16 v[172:175], v[28:31], a[156:159], v[172:175]
    s_waitcnt lgkmcnt(4)
    v_exp_f32 v176, -v128
    v_mul_f32 v191, v127, v191
    v_mfma_f32_16x16x32_bf16 v[144:147], v[32:35], a[160:163], v[144:147]
    ds_read_b128 v[16:19], v4 offset:24576
    v_cvt_pk_bf16_f32 v122, v188, v189
    v_mfma_f32_16x16x32_bf16 v[152:155], v[32:35], a[164:167], v[152:155]
    buffer_load_dword v13, v8, s[20:23], s49 offen offset:256 sc1
    v_mfma_f32_16x16x32_bf16 v[148:151], v[36:39], a[160:163], v[148:151]
    ds_read_b128 v[20:23], v4 offset:25600
    v_cvt_pk_bf16_f32 v123, v190, v191
    v_mfma_f32_16x16x32_bf16 v[156:159], v[36:39], a[164:167], v[156:159]
    v_exp_f32 v177, -v129
    v_mfma_f32_16x16x32_bf16 v[160:163], v[40:43], a[160:163], v[160:163]
    ds_read_b128 v[24:27], v4 offset:26624
    v_mul_f32 v130, v130, v10
    v_mul_f32 v131, v131, v10
    v_mfma_f32_16x16x32_bf16 v[168:171], v[40:43], a[164:167], v[168:171]
    buffer_load_dwordx4 a[24:27], v3, s[20:23], s36 offen offset:0 sc1
    v_mfma_f32_16x16x32_bf16 v[164:167], v[44:47], a[160:163], v[164:167]
    ds_read_b128 v[28:31], v4 offset:27648
    v_fma_f32 v176, v176, s50, s50
    v_mfma_f32_16x16x32_bf16 v[172:175], v[44:47], a[164:167], v[172:175]
    s_waitcnt lgkmcnt(4)
    v_exp_f32 v178, -v130
    v_mfma_f32_16x16x32_bf16 v[144:147], v[48:51], a[168:171], v[144:147]
    ds_read_b128 v[32:35], v4 offset:28672
    v_fma_f32 v177, v177, s50, s50
    v_mfma_f32_16x16x32_bf16 v[152:155], v[48:51], a[172:175], v[152:155]
    buffer_load_dwordx4 a[28:31], v3, s[20:23], s36 offen offset:1024 sc1
    v_fma_f32 v178, v178, s50, s50
    v_mfma_f32_16x16x32_bf16 v[148:151], v[52:55], a[168:171], v[148:151]
    ds_read_b128 v[36:39], v4 offset:29696
    v_mul_f32 v132, v132, v10
    v_mfma_f32_16x16x32_bf16 v[156:159], v[52:55], a[172:175], v[156:159]
    buffer_store_dwordx4 v[120:123], v1, s[20:23], s32 offen offset:1024 sc1
    v_mfma_f32_16x16x32_bf16 v[160:163], v[56:59], a[168:171], v[160:163]
    ds_read_b128 v[40:43], v4 offset:30720
    v_mul_f32 v133, v133, v10
    v_mfma_f32_16x16x32_bf16 v[168:171], v[56:59], a[172:175], v[168:171]
    buffer_load_dwordx4 v0, s[20:23], m0 offen offset:2048 sc1 lds
    v_mfma_f32_16x16x32_bf16 v[164:167], v[60:63], a[168:171], v[164:167]
    ds_read_b128 v[44:47], v4 offset:31744
    v_exp_f32 v179, -v131
    v_mfma_f32_16x16x32_bf16 v[172:175], v[60:63], a[172:175], v[172:175]
    s_waitcnt lgkmcnt(4)
    s_barrier
    v_mfma_f32_16x16x32_bf16 v[144:147], v[16:19], a[176:179], v[144:147]
    ds_read_b128 v[48:51], v4 offset:32768
    v_fma_f32 v179, v179, s50, s50
    v_mfma_f32_16x16x32_bf16 v[152:155], v[16:19], a[180:183], v[152:155]
    buffer_load_dwordx4 v0, s[20:23], m0 offen offset:3072 sc1 lds
    v_mfma_f32_16x16x32_bf16 v[148:151], v[20:23], a[176:179], v[148:151]
    ds_read_b128 v[52:55], v4 offset:33792
    v_mul_f32 v134, v134, v10
    v_mfma_f32_16x16x32_bf16 v[156:159], v[20:23], a[180:183], v[156:159]
    s_waitcnt vmcnt(26)
    buffer_atomic_add v7, v6, s[20:23], s49 offen offset:512 sc1
    v_mul_f32 v135, v135, v10
    v_mfma_f32_16x16x32_bf16 v[160:163], v[24:27], a[176:179], v[160:163]
    ds_read_b128 v[56:59], v4 offset:34816
    v_mul_f32 v136, v136, v11
    v_mfma_f32_16x16x32_bf16 v[168:171], v[24:27], a[180:183], v[168:171]
    buffer_load_dwordx4 a[32:35], v3, s[20:23], s37 offen offset:0 sc1
    v_mfma_f32_16x16x32_bf16 v[164:167], v[28:31], a[176:179], v[164:167]
    ds_read_b128 v[60:63], v4 offset:35840
    v_mul_f32 v137, v137, v11
    v_mfma_f32_16x16x32_bf16 v[172:175], v[28:31], a[180:183], v[172:175]
    s_waitcnt lgkmcnt(4)
    v_rcp_f32 v176, v176
    v_mfma_f32_16x16x32_bf16 v[144:147], v[32:35], a[184:187], v[144:147]
    ds_read_b128 v[16:19], v4 offset:36864
    v_rcp_f32 v177, v177
    v_mfma_f32_16x16x32_bf16 v[152:155], v[32:35], a[188:191], v[152:155]
    buffer_load_dwordx4 a[36:39], v3, s[20:23], s37 offen offset:1024 sc1
    v_mfma_f32_16x16x32_bf16 v[148:151], v[36:39], a[184:187], v[148:151]
    ds_read_b128 v[20:23], v4 offset:37888
    v_mul_f32 v176, v128, v176
    v_mfma_f32_16x16x32_bf16 v[156:159], v[36:39], a[188:191], v[156:159]
    v_rcp_f32 v178, v178
    v_mfma_f32_16x16x32_bf16 v[160:163], v[40:43], a[184:187], v[160:163]
    ds_read_b128 v[24:27], v4 offset:38912
    v_mul_f32 v177, v129, v177
    v_mfma_f32_16x16x32_bf16 v[168:171], v[40:43], a[188:191], v[168:171]
    v_rcp_f32 v179, v179
    v_mul_f32 v178, v130, v178
    v_mfma_f32_16x16x32_bf16 v[164:167], v[44:47], a[184:187], v[164:167]
    ds_read_b128 v[28:31], v4 offset:39936
    v_mul_f32 v179, v131, v179
    v_mfma_f32_16x16x32_bf16 v[172:175], v[44:47], a[188:191], v[172:175]
    s_waitcnt lgkmcnt(4)
    v_exp_f32 v180, -v132
    v_mfma_f32_16x16x32_bf16 v[144:147], v[48:51], a[192:195], v[144:147]
    ds_read_b128 v[32:35], v4 offset:40960
    s_add_u32 m0, s57, 49152
    v_mfma_f32_16x16x32_bf16 v[152:155], v[48:51], a[196:199], v[152:155]
    buffer_load_dwordx4 v0, s[20:23], m0 offen offset:0 sc1 lds
    v_mfma_f32_16x16x32_bf16 v[148:151], v[52:55], a[192:195], v[148:151]
    ds_read_b128 v[36:39], v4 offset:41984
    v_exp_f32 v181, -v133
    v_mfma_f32_16x16x32_bf16 v[156:159], v[52:55], a[196:199], v[156:159]
    buffer_load_dwordx4 v0, s[20:23], m0 offen offset:1024 sc1 lds
    v_mfma_f32_16x16x32_bf16 v[160:163], v[56:59], a[192:195], v[160:163]
    ds_read_b128 v[40:43], v4 offset:43008
    v_fma_f32 v180, v180, s50, s50
    v_mfma_f32_16x16x32_bf16 v[168:171], v[56:59], a[196:199], v[168:171]
    buffer_load_dwordx4 a[40:43], v3, s[20:23], s38 offen offset:0 sc1
    v_mfma_f32_16x16x32_bf16 v[164:167], v[60:63], a[192:195], v[164:167]
    ds_read_b128 v[44:47], v4 offset:44032
    v_fma_f32 v181, v181, s50, s50
    v_mfma_f32_16x16x32_bf16 v[172:175], v[60:63], a[196:199], v[172:175]
    s_waitcnt lgkmcnt(4)
    v_exp_f32 v182, -v134
    v_cvt_pk_bf16_f32 v128, v176, v177
    v_mfma_f32_16x16x32_bf16 v[144:147], v[16:19], a[200:203], v[144:147]
    ds_read_b128 v[48:51], v4 offset:45056
    v_fma_f32 v182, v182, s50, s50
    v_mfma_f32_16x16x32_bf16 v[152:155], v[16:19], a[204:207], v[152:155]
    buffer_load_dwordx4 a[44:47], v3, s[20:23], s38 offen offset:1024 sc1
    v_mfma_f32_16x16x32_bf16 v[148:151], v[20:23], a[200:203], v[148:151]
    ds_read_b128 v[52:55], v4 offset:46080
    v_cvt_pk_bf16_f32 v129, v178, v179
    v_mfma_f32_16x16x32_bf16 v[156:159], v[20:23], a[204:207], v[156:159]
    v_exp_f32 v183, -v135
    v_mfma_f32_16x16x32_bf16 v[160:163], v[24:27], a[200:203], v[160:163]
    ds_read_b128 v[56:59], v4 offset:47104
    v_rcp_f32 v180, v180
    v_mfma_f32_16x16x32_bf16 v[168:171], v[24:27], a[204:207], v[168:171]
    v_rcp_f32 v181, v181
    v_mfma_f32_16x16x32_bf16 v[164:167], v[28:31], a[200:203], v[164:167]
    ds_read_b128 v[60:63], v4 offset:48128
    v_fma_f32 v183, v183, s50, s50
    v_mfma_f32_16x16x32_bf16 v[172:175], v[28:31], a[204:207], v[172:175]
    s_waitcnt lgkmcnt(4)
    v_rcp_f32 v182, v182
    v_mfma_f32_16x16x32_bf16 v[144:147], v[32:35], a[208:211], v[144:147]
    ds_read_b128 v[16:19], v4 offset:49152
    v_mul_f32 v180, v132, v180
    v_mfma_f32_16x16x32_bf16 v[152:155], v[32:35], a[212:215], v[152:155]
    buffer_load_dwordx4 v0, s[20:23], m0 offen offset:2048 sc1 lds
    v_mul_f32 v181, v133, v181
    v_mfma_f32_16x16x32_bf16 v[148:151], v[36:39], a[208:211], v[148:151]
    ds_read_b128 v[20:23], v4 offset:50176
    v_mul_f32 v182, v134, v182
    v_mfma_f32_16x16x32_bf16 v[156:159], v[36:39], a[212:215], v[156:159]
    buffer_load_dwordx4 v0, s[20:23], m0 offen offset:3072 sc1 lds
    v_mfma_f32_16x16x32_bf16 v[160:163], v[40:43], a[208:211], v[160:163]
    ds_read_b128 v[24:27], v4 offset:51200
    v_cvt_pk_bf16_f32 v130, v180, v181
    v_mfma_f32_16x16x32_bf16 v[168:171], v[40:43], a[212:215], v[168:171]
    buffer_load_dwordx4 a[48:51], v3, s[20:23], s39 offen offset:0 sc1
    v_mfma_f32_16x16x32_bf16 v[164:167], v[44:47], a[208:211], v[164:167]
    ds_read_b128 v[28:31], v4 offset:52224
    v_rcp_f32 v183, v183
    v_mfma_f32_16x16x32_bf16 v[172:175], v[44:47], a[212:215], v[172:175]
    s_waitcnt lgkmcnt(4)
    v_exp_f32 v184, -v136
    v_mfma_f32_16x16x32_bf16 v[144:147], v[48:51], a[216:219], v[144:147]
    ds_read_b128 v[32:35], v4 offset:53248
    v_mul_f32 v183, v135, v183
    v_mfma_f32_16x16x32_bf16 v[152:155], v[48:51], a[220:223], v[152:155]
    buffer_load_dwordx4 a[52:55], v3, s[20:23], s39 offen offset:1024 sc1
    v_mfma_f32_16x16x32_bf16 v[148:151], v[52:55], a[216:219], v[148:151]
    ds_read_b128 v[36:39], v4 offset:54272
    v_cvt_pk_bf16_f32 v131, v182, v183
    v_mfma_f32_16x16x32_bf16 v[156:159], v[52:55], a[220:223], v[156:159]
    s_waitcnt vmcnt(16)
    v_readfirstlane_b32 s31, v13
    s_nop 0
    s_cmp_lt_u32 s31, 8
    s_cbranch_scc1 main_kernel_slow1
main_kernel_back1:
    v_mul_f32 v138, v138, v11
    v_mfma_f32_16x16x32_bf16 v[160:163], v[56:59], a[216:219], v[160:163]
    ds_read_b128 v[40:43], v4 offset:55296
    v_mul_f32 v139, v139, v11
    v_mfma_f32_16x16x32_bf16 v[168:171], v[56:59], a[220:223], v[168:171]
    buffer_load_dwordx4 a[56:59], v4, s[20:23], s33 offen offset:0 sc1
    v_mfma_f32_16x16x32_bf16 v[164:167], v[60:63], a[216:219], v[164:167]
    ds_read_b128 v[44:47], v4 offset:56320
    v_fma_f32 v184, v184, s50, s50
    v_mfma_f32_16x16x32_bf16 v[172:175], v[60:63], a[220:223], v[172:175]
    s_waitcnt lgkmcnt(4)
    v_exp_f32 v185, -v137
    v_mfma_f32_16x16x32_bf16 v[144:147], v[16:19], a[224:227], v[144:147]
    ds_read_b128 v[48:51], v4 offset:57344
    v_exp_f32 v186, -v138
    v_mfma_f32_16x16x32_bf16 v[152:155], v[16:19], a[228:231], v[152:155]
    buffer_load_dwordx4 a[60:63], v4, s[20:23], s33 offen offset:1024 sc1
    v_mfma_f32_16x16x32_bf16 v[148:151], v[20:23], a[224:227], v[148:151]
    ds_read_b128 v[52:55], v4 offset:58368
    v_fma_f32 v185, v185, s50, s50
    v_mfma_f32_16x16x32_bf16 v[156:159], v[20:23], a[228:231], v[156:159]
    v_exp_f32 v187, -v139
    v_mfma_f32_16x16x32_bf16 v[160:163], v[24:27], a[224:227], v[160:163]
    ds_read_b128 v[56:59], v4 offset:59392
    v_fma_f32 v186, v186, s50, s50
    v_mfma_f32_16x16x32_bf16 v[168:171], v[24:27], a[228:231], v[168:171]
    buffer_store_dwordx4 v[128:131], v3, s[20:23], s40 offen offset:0 sc1
    v_fma_f32 v187, v187, s50, s50
    v_mfma_f32_16x16x32_bf16 v[164:167], v[28:31], a[224:227], v[164:167]
    ds_read_b128 v[60:63], v4 offset:60416
    v_mul_f32 v140, v140, v11
    v_mfma_f32_16x16x32_bf16 v[172:175], v[28:31], a[228:231], v[172:175]
    s_waitcnt lgkmcnt(4)
    v_rcp_f32 v184, v184
    v_mfma_f32_16x16x32_bf16 v[144:147], v[32:35], a[232:235], v[144:147]
    ds_read_b128 v[16:19], v4 offset:61440
    s_add_u32 m0, s57, 65536
    v_mfma_f32_16x16x32_bf16 v[152:155], v[32:35], a[236:239], v[152:155]
    buffer_load_dwordx4 v0, s[20:23], m0 offen offset:0 sc1 lds
    v_mfma_f32_16x16x32_bf16 v[148:151], v[36:39], a[232:235], v[148:151]
    ds_read_b128 v[20:23], v4 offset:62464
    v_rcp_f32 v185, v185
    v_mfma_f32_16x16x32_bf16 v[156:159], v[36:39], a[236:239], v[156:159]
    buffer_load_dwordx4 v0, s[20:23], m0 offen offset:1024 sc1 lds
    v_mfma_f32_16x16x32_bf16 v[160:163], v[40:43], a[232:235], v[160:163]
    ds_read_b128 v[24:27], v4 offset:63488
    v_mul_f32 v184, v136, v184
    v_mfma_f32_16x16x32_bf16 v[168:171], v[40:43], a[236:239], v[168:171]
    buffer_load_dwordx4 a[64:67], v4, s[20:23], s34 offen offset:0 sc1
    v_mfma_f32_16x16x32_bf16 v[164:167], v[44:47], a[232:235], v[164:167]
    ds_read_b128 v[28:31], v4 offset:64512
    v_mul_f32 v185, v137, v185
    v_mfma_f32_16x16x32_bf16 v[172:175], v[44:47], a[236:239], v[172:175]
    s_waitcnt lgkmcnt(4)
    s_barrier
    v_mfma_f32_16x16x32_bf16 v[144:147], v[48:51], a[240:243], v[144:147]
    ds_read_b128 v[32:35], v5 offset:0
    v_mul_f32 v141, v141, v11
    v_mfma_f32_16x16x32_bf16 v[152:155], v[48:51], a[244:247], v[152:155]
    buffer_load_dwordx4 a[68:71], v4, s[20:23], s34 offen offset:1024 sc1
    v_mfma_f32_16x16x32_bf16 v[148:151], v[52:55], a[240:243], v[148:151]
    ds_read_b128 v[36:39], v5 offset:1024
    v_mul_f32 v142, v142, v11
    v_mfma_f32_16x16x32_bf16 v[156:159], v[52:55], a[244:247], v[156:159]
    v_rcp_f32 v186, v186
    v_mfma_f32_16x16x32_bf16 v[160:163], v[56:59], a[240:243], v[160:163]
    ds_read_b128 v[40:43], v5 offset:2048
    v_rcp_f32 v187, v187
    v_mfma_f32_16x16x32_bf16 v[168:171], v[56:59], a[244:247], v[168:171]
    v_exp_f32 v188, -v140
    v_mfma_f32_16x16x32_bf16 v[164:167], v[60:63], a[240:243], v[164:167]
    ds_read_b128 v[44:47], v5 offset:3072
    v_mul_f32 v186, v138, v186
    v_mfma_f32_16x16x32_bf16 v[172:175], v[60:63], a[244:247], v[172:175]
    s_waitcnt lgkmcnt(4)
    v_exp_f32 v189, -v141
    v_mfma_f32_16x16x32_bf16 v[144:147], v[16:19], a[248:251], v[144:147]
    ds_read_b128 v[48:51], v5 offset:4096
    v_mul_f32 v187, v139, v187
    v_mfma_f32_16x16x32_bf16 v[152:155], v[16:19], a[252:255], v[152:155]
    buffer_load_dwordx4 v0, s[20:23], m0 offen offset:2048 sc1 lds
    v_mul_f32 v143, v143, v11
    v_mfma_f32_16x16x32_bf16 v[148:151], v[20:23], a[248:251], v[148:151]
    ds_read_b128 v[52:55], v5 offset:5120
    v_fma_f32 v188, v188, s50, s50
    v_mfma_f32_16x16x32_bf16 v[156:159], v[20:23], a[252:255], v[156:159]
    buffer_load_dwordx4 v0, s[20:23], m0 offen offset:3072 sc1 lds
    v_mfma_f32_16x16x32_bf16 v[160:163], v[24:27], a[248:251], v[160:163]
    ds_read_b128 v[56:59], v5 offset:6144
    v_fma_f32 v189, v189, s50, s50
    v_mfma_f32_16x16x32_bf16 v[168:171], v[24:27], a[252:255], v[168:171]
    buffer_load_dwordx4 a[72:75], v4, s[20:23], s35 offen offset:0 sc1
    v_mfma_f32_16x16x32_bf16 v[164:167], v[28:31], a[248:251], v[164:167]
    ds_read_b128 v[60:63], v5 offset:7168
    v_exp_f32 v190, -v142
    v_mfma_f32_16x16x32_bf16 v[172:175], v[28:31], a[252:255], v[172:175]
    s_waitcnt lgkmcnt(4)
    v_exp_f32 v191, -v143
    v_mfma_f32_16x16x32_bf16 v[192:195], v[32:35], v[64:67], 0
    ds_read_b128 v[16:19], v5 offset:8192
    v_fma_f32 v190, v190, s50, s50
    v_mfma_f32_16x16x32_bf16 v[200:203], v[32:35], v[72:75], 0
    buffer_load_dwordx4 a[76:79], v4, s[20:23], s35 offen offset:1024 sc1
    v_mfma_f32_16x16x32_bf16 v[196:199], v[36:39], v[64:67], 0
    ds_read_b128 v[20:23], v5 offset:9216
    v_fma_f32 v191, v191, s50, s50
    v_mfma_f32_16x16x32_bf16 v[204:207], v[36:39], v[72:75], 0
    v_rcp_f32 v188, v188
    v_cvt_pk_bf16_f32 v136, v184, v185
    v_mfma_f32_16x16x32_bf16 v[208:211], v[40:43], v[64:67], 0
    ds_read_b128 v[24:27], v5 offset:10240
    v_mul_f32 v188, v140, v188
    v_mfma_f32_16x16x32_bf16 v[216:219], v[40:43], v[72:75], 0
    buffer_load_dword v14, v8, s[20:23], s49 offen offset:512 sc1
    v_mfma_f32_16x16x32_bf16 v[212:215], v[44:47], v[64:67], 0
    ds_read_b128 v[28:31], v5 offset:11264
    v_cvt_pk_bf16_f32 v137, v186, v187
    v_mfma_f32_16x16x32_bf16 v[220:223], v[44:47], v[72:75], 0
    s_waitcnt lgkmcnt(4)
    v_rcp_f32 v189, v189
    v_mfma_f32_16x16x32_bf16 v[224:227], v[48:51], v[64:67], v[224:227]
    ds_read_b128 v[32:35], v5 offset:12288
    v_rcp_f32 v190, v190
    v_mfma_f32_16x16x32_bf16 v[232:235], v[48:51], v[72:75], v[232:235]
    buffer_load_dwordx4 a[80:83], v4, s[20:23], s36 offen offset:0 sc1
    v_mfma_f32_16x16x32_bf16 v[228:231], v[52:55], v[64:67], v[228:231]
    ds_read_b128 v[36:39], v5 offset:13312
    v_mul_f32 v189, v141, v189
    v_mfma_f32_16x16x32_bf16 v[236:239], v[52:55], v[72:75], v[236:239]
    v_rcp_f32 v191, v191
    v_mfma_f32_16x16x32_bf16 v[240:243], v[56:59], v[64:67], v[240:243]
    ds_read_b128 v[40:43], v5 offset:14336
    v_mul_f32 v190, v142, v190
    v_mfma_f32_16x16x32_bf16 v[248:251], v[56:59], v[72:75], v[248:251]
    buffer_load_dwordx4 a[84:87], v4, s[20:23], s36 offen offset:1024 sc1
    v_mul_f32 v191, v143, v191
    v_mfma_f32_16x16x32_bf16 v[244:247], v[60:63], v[64:67], v[244:247]
    ds_read_b128 v[44:47], v5 offset:15360
    v_cvt_pk_bf16_f32 v138, v188, v189
    v_mfma_f32_16x16x32_bf16 v[252:255], v[60:63], v[72:75], v[252:255]
    s_waitcnt lgkmcnt(4)
    v_cvt_pk_bf16_f32 v139, v190, v191
    v_mul_f32 v144, v144, v10
    v_mfma_f32_16x16x32_bf16 v[192:195], v[16:19], v[80:83], v[192:195]
    ds_read_b128 v[48:51], v5 offset:16384
    s_add_u32 m0, s57, 81920
    v_mfma_f32_16x16x32_bf16 v[200:203], v[16:19], v[88:91], v[200:203]
    buffer_load_dwordx4 v0, s[20:23], m0 offen offset:0 sc1 lds
    v_mfma_f32_16x16x32_bf16 v[196:199], v[20:23], v[80:83], v[196:199]
main_kernel_stub12:
    s_cbranch_execz main_kernel_ret
    ds_read_b128 v[52:55], v5 offset:17408
    v_exp_f32 v176, -v144
    v_mfma_f32_16x16x32_bf16 v[204:207], v[20:23], v[88:91], v[204:207]
    v_mul_f32 v145, v145, v10
    v_mul_f32 v146, v146, v10
    v_mfma_f32_16x16x32_bf16 v[208:211], v[24:27], v[80:83], v[208:211]
    ds_read_b128 v[56:59], v5 offset:18432
    v_mul_f32 v147, v147, v10
    v_mfma_f32_16x16x32_bf16 v[216:219], v[24:27], v[88:91], v[216:219]
    buffer_load_dwordx4 v0, s[20:23], m0 offen offset:1024 sc1 lds
    v_mfma_f32_16x16x32_bf16 v[212:215], v[28:31], v[80:83], v[212:215]
    ds_read_b128 v[60:63], v5 offset:19456
    v_fma_f32 v176, v176, s50, s50
    v_mfma_f32_16x16x32_bf16 v[220:223], v[28:31], v[88:91], v[220:223]
    s_waitcnt lgkmcnt(4)
    v_exp_f32 v177, -v145
    v_mul_f32 v148, v148, v10
    v_mfma_f32_16x16x32_bf16 v[224:227], v[32:35], v[80:83], v[224:227]
    ds_read_b128 v[16:19], v5 offset:20480
    v_fma_f32 v177, v177, s50, s50
    v_mfma_f32_16x16x32_bf16 v[232:235], v[32:35], v[88:91], v[232:235]
    buffer_store_dwordx4 v[136:139], v3, s[20:23], s40 offen offset:1024 sc1
    v_mfma_f32_16x16x32_bf16 v[228:231], v[36:39], v[80:83], v[228:231]
    ds_read_b128 v[20:23], v5 offset:21504
    v_mul_f32 v149, v149, v10
    v_mfma_f32_16x16x32_bf16 v[236:239], v[36:39], v[88:91], v[236:239]
    buffer_load_dwordx4 a[88:91], v4, s[20:23], s37 offen offset:0 sc1
    v_mfma_f32_16x16x32_bf16 v[240:243], v[40:43], v[80:83], v[240:243]
    ds_read_b128 v[24:27], v5 offset:22528
    v_exp_f32 v178, -v146
    v_mfma_f32_16x16x32_bf16 v[248:251], v[40:43], v[88:91], v[248:251]
    buffer_load_dwordx4 a[92:95], v4, s[20:23], s37 offen offset:1024 sc1
    v_mfma_f32_16x16x32_bf16 v[244:247], v[44:47], v[80:83], v[244:247]
    ds_read_b128 v[28:31], v5 offset:23552
    v_fma_f32 v178, v178, s50, s50
    v_mfma_f32_16x16x32_bf16 v[252:255], v[44:47], v[88:91], v[252:255]
    s_waitcnt lgkmcnt(4)
    v_exp_f32 v179, -v147
    v_mfma_f32_16x16x32_bf16 v[192:195], v[48:51], v[96:99], v[192:195]
    ds_read_b128 v[32:35], v5 offset:24576
    v_fma_f32 v179, v179, s50, s50
    v_mfma_f32_16x16x32_bf16 v[200:203], v[48:51], v[104:107], v[200:203]
    s_waitcnt vmcnt(32)
    buffer_atomic_add v7, v6, s[20:23], s49 offen offset:768 sc1
    v_mul_f32 v150, v150, v10
    v_mfma_f32_16x16x32_bf16 v[196:199], v[52:55], v[96:99], v[196:199]
    ds_read_b128 v[36:39], v5 offset:25600
    v_mul_f32 v151, v151, v10
    v_mfma_f32_16x16x32_bf16 v[204:207], v[52:55], v[104:107], v[204:207]
    v_rcp_f32 v176, v176
    v_mfma_f32_16x16x32_bf16 v[208:211], v[56:59], v[96:99], v[208:211]
    ds_read_b128 v[40:43], v5 offset:26624
    v_mul_f32 v176, v144, v176
    v_mfma_f32_16x16x32_bf16 v[216:219], v[56:59], v[104:107], v[216:219]
    buffer_load_dwordx4 v0, s[20:23], m0 offen offset:2048 sc1 lds
    v_mfma_f32_16x16x32_bf16 v[212:215], v[60:63], v[96:99], v[212:215]
    ds_read_b128 v[44:47], v5 offset:27648
    v_rcp_f32 v177, v177
    v_mfma_f32_16x16x32_bf16 v[220:223], v[60:63], v[104:107], v[220:223]
    s_waitcnt lgkmcnt(4)
    v_rcp_f32 v178, v178
    v_mfma_f32_16x16x32_bf16 v[224:227], v[16:19], v[96:99], v[224:227]
    ds_read_b128 v[48:51], v5 offset:28672
    v_mul_f32 v177, v145, v177
    v_mfma_f32_16x16x32_bf16 v[232:235], v[16:19], v[104:107], v[232:235]
    buffer_load_dwordx4 v0, s[20:23], m0 offen offset:3072 sc1 lds
    v_mfma_f32_16x16x32_bf16 v[228:231], v[20:23], v[96:99], v[228:231]
    ds_read_b128 v[52:55], v5 offset:29696
    v_mul_f32 v178, v146, v178
    v_mfma_f32_16x16x32_bf16 v[236:239], v[20:23], v[104:107], v[236:239]
    v_rcp_f32 v179, v179
    v_cvt_pk_bf16_f32 v144, v176, v177
    v_mfma_f32_16x16x32_bf16 v[240:243], v[24:27], v[96:99], v[240:243]
    ds_read_b128 v[56:59], v5 offset:30720
    v_mul_f32 v179, v147, v179
    v_mfma_f32_16x16x32_bf16 v[248:251], v[24:27], v[104:107], v[248:251]
    buffer_load_dwordx4 a[96:99], v4, s[20:23], s38 offen offset:0 sc1
    v_mfma_f32_16x16x32_bf16 v[244:247], v[28:31], v[96:99], v[244:247]
    ds_read_b128 v[60:63], v5 offset:31744
    v_cvt_pk_bf16_f32 v145, v178, v179
    v_mfma_f32_16x16x32_bf16 v[252:255], v[28:31], v[104:107], v[252:255]
    s_waitcnt lgkmcnt(4)
    s_barrier
    v_mfma_f32_16x16x32_bf16 v[192:195], v[32:35], v[112:115], v[192:195]
    ds_read_b128 v[16:19], v3 offset:0
    v_exp_f32 v180, -v148
    v_mfma_f32_16x16x32_bf16 v[200:203], v[32:35], v[120:123], v[200:203]
    buffer_load_dwordx4 a[100:103], v4, s[20:23], s38 offen offset:1024 sc1
    v_mfma_f32_16x16x32_bf16 v[196:199], v[36:39], v[112:115], v[196:199]
    ds_read_b128 v[20:23], v3 offset:1024
    s_add_u32 m0, s57, 98304
    v_mfma_f32_16x16x32_bf16 v[204:207], v[36:39], v[120:123], v[204:207]
    v_exp_f32 v181, -v149
    v_mfma_f32_16x16x32_bf16 v[208:211], v[40:43], v[112:115], v[208:211]
    ds_read_b128 v[24:27], v3 offset:2048
    v_fma_f32 v180, v180, s50, s50
    v_mfma_f32_16x16x32_bf16 v[216:219], v[40:43], v[120:123], v[216:219]
    buffer_load_dwordx4 v0, s[20:23], m0 offen offset:0 sc1 lds
    v_fma_f32 v181, v181, s50, s50
    v_mfma_f32_16x16x32_bf16 v[212:215], v[44:47], v[112:115], v[212:215]
    ds_read_b128 v[28:31], v3 offset:3072
    v_mul_f32 v152, v152, v11
    v_mfma_f32_16x16x32_bf16 v[220:223], v[44:47], v[120:123], v[220:223]
    s_waitcnt lgkmcnt(4)
    v_exp_f32 v182, -v150
    v_mfma_f32_16x16x32_bf16 v[224:227], v[48:51], v[112:115], v[224:227]
    ds_read_b128 v[32:35], v3 offset:4096
    v_fma_f32 v182, v182, s50, s50
    v_mfma_f32_16x16x32_bf16 v[232:235], v[48:51], v[120:123], v[232:235]
    buffer_load_dwordx4 v0, s[20:23], m0 offen offset:1024 sc1 lds
    v_mfma_f32_16x16x32_bf16 v[228:231], v[52:55], v[112:115], v[228:231]
    ds_read_b128 v[36:39], v3 offset:5120
    v_exp_f32 v183, -v151
    v_mfma_f32_16x16x32_bf16 v[236:239], v[52:55], v[120:123], v[236:239]
    v_rcp_f32 v180, v180
    v_mfma_f32_16x16x32_bf16 v[240:243], v[56:59], v[112:115], v[240:243]
    ds_read_b128 v[40:43], v3 offset:6144
    v_fma_f32 v183, v183, s50, s50
    v_mfma_f32_16x16x32_bf16 v[248:251], v[56:59], v[120:123], v[248:251]
    buffer_load_dwordx4 a[104:107], v4, s[20:23], s39 offen offset:0 sc1
    v_mfma_f32_16x16x32_bf16 v[244:247], v[60:63], v[112:115], v[244:247]
    ds_read_b128 v[44:47], v3 offset:7168
    v_mul_f32 v180, v148, v180
    v_mfma_f32_16x16x32_bf16 v[252:255], v[60:63], v[120:123], v[252:255]
    s_waitcnt lgkmcnt(4)
    v_rcp_f32 v181, v181
    v_mul_f32 v153, v153, v11
    v_mfma_f32_16x16x32_bf16 v[192:195], v[16:19], a[0:3], v[192:195]
    ds_read_b128 v[48:51], v3 offset:8192
    v_mul_f32 v181, v149, v181
    v_mfma_f32_16x16x32_bf16 v[200:203], v[16:19], a[4:7], v[200:203]
    buffer_load_dwordx4 a[108:111], v4, s[20:23], s39 offen offset:1024 sc1
    v_mfma_f32_16x16x32_bf16 v[196:199], v[20:23], a[0:3], v[196:199]
    ds_read_b128 v[52:55], v3 offset:9216
    v_cvt_pk_bf16_f32 v146, v180, v181
    v_mfma_f32_16x16x32_bf16 v[204:207], v[20:23], a[4:7], v[204:207]
    buffer_load_dwordx4 v0, s[20:23], m0 offen offset:2048 sc1 lds
    v_mfma_f32_16x16x32_bf16 v[208:211], v[24:27], a[0:3], v[208:211]
    ds_read_b128 v[56:59], v3 offset:10240
    v_rcp_f32 v182, v182
    v_mfma_f32_16x16x32_bf16 v[216:219], v[24:27], a[4:7], v[216:219]
    buffer_load_dwordx4 v0, s[20:23], m0 offen offset:3072 sc1 lds
    v_mfma_f32_16x16x32_bf16 v[212:215], v[28:31], a[0:3], v[212:215]
    ds_read_b128 v[60:63], v3 offset:11264
    v_mul_f32 v182, v150, v182
    v_mfma_f32_16x16x32_bf16 v[220:223], v[28:31], a[4:7], v[220:223]
    s_waitcnt lgkmcnt(4)
    v_rcp_f32 v183, v183
    v_mfma_f32_16x16x32_bf16 v[224:227], v[32:35], a[0:3], v[224:227]
    ds_read_b128 v[16:19], v3 offset:12288
    v_mul_f32 v183, v151, v183
    v_mfma_f32_16x16x32_bf16 v[232:235], v[32:35], a[4:7], v[232:235]
    s_waitcnt vmcnt(18)
    v_readfirstlane_b32 s31, v14
    s_nop 0
    s_cmp_lt_u32 s31, 8
    s_cbranch_scc1 main_kernel_slow2
main_kernel_back2:
    v_cvt_pk_bf16_f32 v147, v182, v183
    v_mfma_f32_16x16x32_bf16 v[228:231], v[36:39], a[0:3], v[228:231]
    ds_read_b128 v[20:23], v3 offset:13312
    v_mul_f32 v154, v154, v11
    v_mfma_f32_16x16x32_bf16 v[236:239], v[36:39], a[4:7], v[236:239]
    buffer_load_dwordx4 a[112:115], v5, s[20:23], s33 offen offset:0 sc1
    v_mfma_f32_16x16x32_bf16 v[240:243], v[40:43], a[0:3], v[240:243]
    ds_read_b128 v[24:27], v3 offset:14336
    v_mul_f32 v155, v155, v11
    v_mfma_f32_16x16x32_bf16 v[248:251], v[40:43], a[4:7], v[248:251]
    buffer_load_dwordx4 a[116:119], v5, s[20:23], s33 offen offset:1024 sc1
    v_mfma_f32_16x16x32_bf16 v[244:247], v[44:47], a[0:3], v[244:247]
    ds_read_b128 v[28:31], v3 offset:15360
    v_exp_f32 v184, -v152
    v_mfma_f32_16x16x32_bf16 v[252:255], v[44:47], a[4:7], v[252:255]
    s_waitcnt lgkmcnt(4)
    v_exp_f32 v185, -v153
    v_mfma_f32_16x16x32_bf16 v[192:195], v[48:51], a[8:11], v[192:195]
    ds_read_b128 v[32:35], v3 offset:16384
    v_fma_f32 v184, v184, s50, s50
    v_mfma_f32_16x16x32_bf16 v[200:203], v[48:51], a[12:15], v[200:203]
    buffer_store_dwordx4 v[144:147], v4, s[20:23], s40 offen offset:0 sc1
    v_mfma_f32_16x16x32_bf16 v[196:199], v[52:55], a[8:11], v[196:199]
    ds_read_b128 v[36:39], v3 offset:17408
    v_fma_f32 v185, v185, s50, s50
    v_mfma_f32_16x16x32_bf16 v[204:207], v[52:55], a[12:15], v[204:207]
    v_exp_f32 v186, -v154
    v_mul_f32 v156, v156, v11
    v_mfma_f32_16x16x32_bf16 v[208:211], v[56:59], a[8:11], v[208:211]
    ds_read_b128 v[40:43], v3 offset:18432
    v_fma_f32 v186, v186, s50, s50
    v_mfma_f32_16x16x32_bf16 v[216:219], v[56:59], a[12:15], v[216:219]
    buffer_load_dwordx4 a[120:123], v5, s[20:23], s34 offen offset:0 sc1
    v_mfma_f32_16x16x32_bf16 v[212:215], v[60:63], a[8:11], v[212:215]
    ds_read_b128 v[44:47], v3 offset:19456
    v_mul_f32 v157, v157, v11
    v_mfma_f32_16x16x32_bf16 v[220:223], v[60:63], a[12:15], v[220:223]
    s_waitcnt lgkmcnt(4)
    v_exp_f32 v187, -v155
    v_mfma_f32_16x16x32_bf16 v[224:227], v[16:19], a[8:11], v[224:227]
    ds_read_b128 v[48:51], v3 offset:20480
    v_rcp_f32 v184, v184
    v_mfma_f32_16x16x32_bf16 v[232:235], v[16:19], a[12:15], v[232:235]
    buffer_load_dwordx4 a[124:127], v5, s[20:23], s34 offen offset:1024 sc1
    v_mfma_f32_16x16x32_bf16 v[228:231], v[20:23], a[8:11], v[228:231]
    ds_read_b128 v[52:55], v3 offset:21504
    s_add_u32 m0, s57, 114688
    v_mfma_f32_16x16x32_bf16 v[236:239], v[20:23], a[12:15], v[236:239]
    v_rcp_f32 v185, v185
    v_mfma_f32_16x16x32_bf16 v[240:243], v[24:27], a[8:11], v[240:243]
    ds_read_b128 v[56:59], v3 offset:22528
    v_fma_f32 v187, v187, s50, s50
    v_mfma_f32_16x16x32_bf16 v[248:251], v[24:27], a[12:15], v[248:251]
    buffer_load_dwordx4 v0, s[20:23], m0 offen offset:0 sc1 lds
    v_mul_f32 v184, v152, v184
    v_mfma_f32_16x16x32_bf16 v[244:247], v[28:31], a[8:11], v[244:247]
    ds_read_b128 v[60:63], v3 offset:23552
    v_mul_f32 v185, v153, v185
    v_mfma_f32_16x16x32_bf16 v[252:255], v[28:31], a[12:15], v[252:255]
    s_waitcnt lgkmcnt(4)
    v_rcp_f32 v186, v186
    v_mfma_f32_16x16x32_bf16 v[192:195], v[32:35], a[16:19], v[192:195]
    ds_read_b128 v[16:19], v3 offset:24576
    v_mul_f32 v186, v154, v186
    v_mfma_f32_16x16x32_bf16 v[200:203], v[32:35], a[20:23], v[200:203]
    buffer_load_dwordx4 v0, s[20:23], m0 offen offset:1024 sc1 lds
    v_mfma_f32_16x16x32_bf16 v[196:199], v[36:39], a[16:19], v[196:199]
    ds_read_b128 v[20:23], v3 offset:25600
    v_rcp_f32 v187, v187
    v_mfma_f32_16x16x32_bf16 v[204:207], v[36:39], a[20:23], v[204:207]
    v_exp_f32 v188, -v156
    v_mfma_f32_16x16x32_bf16 v[208:211], v[40:43], a[16:19], v[208:211]
    ds_read_b128 v[24:27], v3 offset:26624
    v_mul_f32 v187, v155, v187
    v_mfma_f32_16x16x32_bf16 v[216:219], v[40:43], a[20:23], v[216:219]
    buffer_load_dwordx4 a[128:131], v5, s[20:23], s35 offen offset:0 sc1
    v_mfma_f32_16x16x32_bf16 v[212:215], v[44:47], a[16:19], v[212:215]
    ds_read_b128 v[28:31], v3 offset:27648
    v_mul_f32 v158, v158, v11
    v_mfma_f32_16x16x32_bf16 v[220:223], v[44:47], a[20:23], v[220:223]
    s_waitcnt lgkmcnt(4)
    v_exp_f32 v189, -v157
    v_mul_f32 v159, v159, v11
    v_mfma_f32_16x16x32_bf16 v[224:227], v[48:51], a[16:19], v[224:227]
    ds_read_b128 v[32:35], v3 offset:28672
    v_fma_f32 v188, v188, s50, s50
    v_mfma_f32_16x16x32_bf16 v[232:235], v[48:51], a[20:23], v[232:235]
    buffer_load_dwordx4 a[132:135], v5, s[20:23], s35 offen offset:1024 sc1
    v_mfma_f32_16x16x32_bf16 v[228:231], v[52:55], a[16:19], v[228:231]
    ds_read_b128 v[36:39], v3 offset:29696
    v_fma_f32 v189, v189, s50, s50
    v_mfma_f32_16x16x32_bf16 v[236:239], v[52:55], a[20:23], v[236:239]
    buffer_load_dwordx4 v0, s[20:23], m0 offen offset:2048 sc1 lds
    v_mfma_f32_16x16x32_bf16 v[240:243], v[56:59], a[16:19], v[240:243]
    ds_read_b128 v[40:43], v3 offset:30720
    v_exp_f32 v190, -v158
    v_mfma_f32_16x16x32_bf16 v[248:251], v[56:59], a[20:23], v[248:251]
    buffer_load_dwordx4 v0, s[20:23], m0 offen offset:3072 sc1 lds
    v_mfma_f32_16x16x32_bf16 v[244:247], v[60:63], a[16:19], v[244:247]
    ds_read_b128 v[44:47], v3 offset:31744
    v_fma_f32 v190, v190, s50, s50
    v_mfma_f32_16x16x32_bf16 v[252:255], v[60:63], a[20:23], v[252:255]
    s_waitcnt lgkmcnt(4)
    s_barrier
    v_mfma_f32_16x16x32_bf16 v[192:195], v[16:19], a[24:27], v[192:195]
    ds_read_b128 v[48:51], v3 offset:32768
    v_cvt_pk_bf16_f32 v152, v184, v185
    v_mfma_f32_16x16x32_bf16 v[200:203], v[16:19], a[28:31], v[200:203]
    buffer_load_dword v12, v8, s[20:23], s49 offen offset:768 sc1
    v_cvt_pk_bf16_f32 v153, v186, v187
    v_mfma_f32_16x16x32_bf16 v[196:199], v[20:23], a[24:27], v[196:199]
    ds_read_b128 v[52:55], v3 offset:33792
    v_mul_f32 v160, v160, v10
    v_mfma_f32_16x16x32_bf16 v[204:207], v[20:23], a[28:31], v[204:207]
    v_exp_f32 v191, -v159
    v_mfma_f32_16x16x32_bf16 v[208:211], v[24:27], a[24:27], v[208:211]
    ds_read_b128 v[56:59], v3 offset:34816
    v_fma_f32 v191, v191, s50, s50
    v_mfma_f32_16x16x32_bf16 v[216:219], v[24:27], a[28:31], v[216:219]
    buffer_load_dwordx4 a[136:139], v5, s[20:23], s36 offen offset:0 sc1
    v_mfma_f32_16x16x32_bf16 v[212:215], v[28:31], a[24:27], v[212:215]
    ds_read_b128 v[60:63], v3 offset:35840
    v_rcp_f32 v188, v188
    v_mfma_f32_16x16x32_bf16 v[220:223], v[28:31], a[28:31], v[220:223]
    s_waitcnt lgkmcnt(4)
    v_rcp_f32 v189, v189
    v_mfma_f32_16x16x32_bf16 v[224:227], v[32:35], a[24:27], v[224:227]
    ds_read_b128 v[16:19], v3 offset:36864
    v_mul_f32 v188, v156, v188
    v_mfma_f32_16x16x32_bf16 v[232:235], v[32:35], a[28:31], v[232:235]
    buffer_load_dwordx4 a[140:143], v5, s[20:23], s36 offen offset:1024 sc1
    v_mfma_f32_16x16x32_bf16 v[228:231], v[36:39], a[24:27], v[228:231]
    ds_read_b128 v[20:23], v3 offset:37888
    v_mul_f32 v189, v157, v189
    v_mfma_f32_16x16x32_bf16 v[236:239], v[36:39], a[28:31], v[236:239]
    v_rcp_f32 v190, v190
    v_cvt_pk_bf16_f32 v154, v188, v189
    v_mfma_f32_16x16x32_bf16 v[240:243], v[40:43], a[24:27], v[240:243]
    ds_read_b128 v[24:27], v3 offset:38912
    v_mul_f32 v190, v158, v190
    v_mfma_f32_16x16x32_bf16 v[248:251], v[40:43], a[28:31], v[248:251]
    v_rcp_f32 v191, v191
    v_mfma_f32_16x16x32_bf16 v[244:247], v[44:47], a[24:27], v[244:247]
    ds_read_b128 v[28:31], v3 offset:39936
    v_mul_f32 v191, v159, v191
    v_mfma_f32_16x16x32_bf16 v[252:255], v[44:47], a[28:31], v[252:255]
    s_waitcnt lgkmcnt(4)
    v_exp_f32 v176, -v160
    v_mfma_f32_16x16x32_bf16 v[192:195], v[48:51], a[32:35], v[192:195]
    ds_read_b128 v[32:35], v3 offset:40960
    s_add_u32 m0, s57, 131072
    v_cvt_pk_bf16_f32 v155, v190, v191
    v_mfma_f32_16x16x32_bf16 v[200:203], v[48:51], a[36:39], v[200:203]
    buffer_load_dwordx4 v0, s[20:23], m0 offen offset:0 sc1 lds
    v_mfma_f32_16x16x32_bf16 v[196:199], v[52:55], a[32:35], v[196:199]
    ds_read_b128 v[36:39], v3 offset:41984
    v_mul_f32 v161, v161, v10
    v_mfma_f32_16x16x32_bf16 v[204:207], v[52:55], a[36:39], v[204:207]
    buffer_load_dwordx4 v0, s[20:23], m0 offen offset:1024 sc1 lds
    v_mfma_f32_16x16x32_bf16 v[208:211], v[56:59], a[32:35], v[208:211]
    ds_read_b128 v[40:43], v3 offset:43008
    v_mul_f32 v162, v162, v10
    v_mfma_f32_16x16x32_bf16 v[216:219], v[56:59], a[36:39], v[216:219]
    buffer_load_dwordx4 a[144:147], v5, s[20:23], s37 offen offset:0 sc1
    v_mul_f32 v163, v163, v10
    v_mfma_f32_16x16x32_bf16 v[212:215], v[60:63], a[32:35], v[212:215]
    ds_read_b128 v[44:47], v3 offset:44032
    v_fma_f32 v176, v176, s50, s50
    v_mfma_f32_16x16x32_bf16 v[220:223], v[60:63], a[36:39], v[220:223]
    s_waitcnt lgkmcnt(4)
    v_exp_f32 v177, -v161
    v_mfma_f32_16x16x32_bf16 v[224:227], v[16:19], a[32:35], v[224:227]
    ds_read_b128 v[48:51], v3 offset:45056
    v_fma_f32 v177, v177, s50, s50
    v_mfma_f32_16x16x32_bf16 v[232:235], v[16:19], a[36:39], v[232:235]
    buffer_load_dwordx4 a[148:151], v5, s[20:23], s37 offen offset:1024 sc1
    v_mfma_f32_16x16x32_bf16 v[228:231], v[20:23], a[32:35], v[228:231]
    ds_read_b128 v[52:55], v3 offset:46080
    v_exp_f32 v178, -v162
    v_mfma_f32_16x16x32_bf16 v[236:239], v[20:23], a[36:39], v[236:239]
    v_exp_f32 v179, -v163
    v_mfma_f32_16x16x32_bf16 v[240:243], v[24:27], a[32:35], v[240:243]
    ds_read_b128 v[56:59], v3 offset:47104
    v_fma_f32 v178, v178, s50, s50
    v_mfma_f32_16x16x32_bf16 v[248:251], v[24:27], a[36:39], v[248:251]
    buffer_store_dwordx4 v[152:155], v4, s[20:23], s40 offen offset:1024 sc1
    v_mfma_f32_16x16x32_bf16 v[244:247], v[28:31], a[32:35], v[244:247]
    ds_read_b128 v[60:63], v3 offset:48128
    v_fma_f32 v179, v179, s50, s50
    v_mfma_f32_16x16x32_bf16 v[252:255], v[28:31], a[36:39], v[252:255]
    s_waitcnt lgkmcnt(4)
    v_rcp_f32 v176, v176
    v_mul_f32 v164, v164, v10
    v_mfma_f32_16x16x32_bf16 v[192:195], v[32:35], a[40:43], v[192:195]
    ds_read_b128 v[16:19], v3 offset:49152
    v_mul_f32 v176, v160, v176
    v_mfma_f32_16x16x32_bf16 v[200:203], v[32:35], a[44:47], v[200:203]
    s_waitcnt vmcnt(32)
    buffer_atomic_add v7, v6, s[20:23], s49 offen offset:1024 sc1
    v_mfma_f32_16x16x32_bf16 v[196:199], v[36:39], a[40:43], v[196:199]
    ds_read_b128 v[20:23], v3 offset:50176
    v_mul_f32 v165, v165, v10
    v_mfma_f32_16x16x32_bf16 v[204:207], v[36:39], a[44:47], v[204:207]
    buffer_load_dwordx4 v0, s[20:23], m0 offen offset:2048 sc1 lds
    v_mfma_f32_16x16x32_bf16 v[208:211], v[40:43], a[40:43], v[208:211]
    ds_read_b128 v[24:27], v3 offset:51200
    v_rcp_f32 v177, v177
    v_mfma_f32_16x16x32_bf16 v[216:219], v[40:43], a[44:47], v[216:219]
    buffer_load_dwordx4 v0, s[20:23], m0 offen offset:3072 sc1 lds
    v_mfma_f32_16x16x32_bf16 v[212:215], v[44:47], a[40:43], v[212:215]
    ds_read_b128 v[28:31], v3 offset:52224
    v_mul_f32 v177, v161, v177
    v_mfma_f32_16x16x32_bf16 v[220:223], v[44:47], a[44:47], v[220:223]
    s_waitcnt lgkmcnt(4)
    v_rcp_f32 v178, v178
    v_mfma_f32_16x16x32_bf16 v[224:227], v[48:51], a[40:43], v[224:227]
    ds_read_b128 v[32:35], v3 offset:53248
    v_mul_f32 v178, v162, v178
    v_mfma_f32_16x16x32_bf16 v[232:235], v[48:51], a[44:47], v[232:235]
    buffer_load_dwordx4 a[152:155], v5, s[20:23], s38 offen offset:0 sc1
    v_mul_f32 v166, v166, v10
    v_mfma_f32_16x16x32_bf16 v[228:231], v[52:55], a[40:43], v[228:231]
    ds_read_b128 v[36:39], v3 offset:54272
    v_mul_f32 v167, v167, v10
    v_mfma_f32_16x16x32_bf16 v[236:239], v[52:55], a[44:47], v[236:239]
    buffer_load_dwordx4 a[156:159], v5, s[20:23], s38 offen offset:1024 sc1
    v_mfma_f32_16x16x32_bf16 v[240:243], v[56:59], a[40:43], v[240:243]
    ds_read_b128 v[40:43], v3 offset:55296
    v_cvt_pk_bf16_f32 v160, v176, v177
    v_mfma_f32_16x16x32_bf16 v[248:251], v[56:59], a[44:47], v[248:251]
    buffer_load_dwordx4 a[160:163], v5, s[20:23], s39 offen offset:0 sc1
    v_mfma_f32_16x16x32_bf16 v[244:247], v[60:63], a[40:43], v[244:247]
    ds_read_b128 v[44:47], v3 offset:56320
    v_rcp_f32 v179, v179
    v_mfma_f32_16x16x32_bf16 v[252:255], v[60:63], a[44:47], v[252:255]
    s_waitcnt lgkmcnt(4)
    v_exp_f32 v180, -v164
    v_mfma_f32_16x16x32_bf16 v[192:195], v[16:19], a[48:51], v[192:195]
    ds_read_b128 v[48:51], v3 offset:57344
    v_mul_f32 v179, v163, v179
    v_mfma_f32_16x16x32_bf16 v[200:203], v[16:19], a[52:55], v[200:203]
    buffer_load_dwordx4 a[164:167], v5, s[20:23], s39 offen offset:1024 sc1
    v_mfma_f32_16x16x32_bf16 v[196:199], v[20:23], a[48:51], v[196:199]
    ds_read_b128 v[52:55], v3 offset:58368
    v_fma_f32 v180, v180, s50, s50
    v_mfma_f32_16x16x32_bf16 v[204:207], v[20:23], a[52:55], v[204:207]
    v_exp_f32 v181, -v165
    v_cvt_pk_bf16_f32 v161, v178, v179
    v_mfma_f32_16x16x32_bf16 v[208:211], v[24:27], a[48:51], v[208:211]
    ds_read_b128 v[56:59], v3 offset:59392
    v_fma_f32 v181, v181, s50, s50
    v_mfma_f32_16x16x32_bf16 v[216:219], v[24:27], a[52:55], v[216:219]
    v_exp_f32 v182, -v166
    v_mfma_f32_16x16x32_bf16 v[212:215], v[28:31], a[48:51], v[212:215]
    ds_read_b128 v[60:63], v3 offset:60416
    v_fma_f32 v182, v182, s50, s50
    v_mfma_f32_16x16x32_bf16 v[220:223], v[28:31], a[52:55], v[220:223]
    s_waitcnt lgkmcnt(4)
    v_exp_f32 v183, -v167
    v_mfma_f32_16x16x32_bf16 v[224:227], v[32:35], a[48:51], v[224:227]
    ds_read_b128 v[16:19], v3 offset:61440
    s_add_u32 m0, s57, 147456
    v_fma_f32 v183, v183, s50, s50
    v_mfma_f32_16x16x32_bf16 v[232:235], v[32:35], a[52:55], v[232:235]
    buffer_load_dwordx4 v0, s[20:23], m0 offen offset:0 sc1 lds
    v_mfma_f32_16x16x32_bf16 v[228:231], v[36:39], a[48:51], v[228:231]
    ds_read_b128 v[20:23], v3 offset:62464
    v_mul_f32 v168, v168, v11
    v_mfma_f32_16x16x32_bf16 v[236:239], v[36:39], a[52:55], v[236:239]
    buffer_load_dwordx4 v0, s[20:23], m0 offen offset:1024 sc1 lds
    v_mfma_f32_16x16x32_bf16 v[240:243], v[40:43], a[48:51], v[240:243]
    ds_read_b128 v[24:27], v3 offset:63488
    v_mul_f32 v169, v169, v11
    v_mfma_f32_16x16x32_bf16 v[248:251], v[40:43], a[52:55], v[248:251]
    s_waitcnt vmcnt(16)
    v_readfirstlane_b32 s31, v12
    s_nop 0
    s_cmp_lt_u32 s31, 8
    s_cbranch_scc1 main_kernel_slow3
main_kernel_back3:
    v_mul_f32 v170, v170, v11
    v_mfma_f32_16x16x32_bf16 v[244:247], v[44:47], a[48:51], v[244:247]
    ds_read_b128 v[28:31], v3 offset:64512
    v_mul_f32 v171, v171, v11
    v_mfma_f32_16x16x32_bf16 v[252:255], v[44:47], a[52:55], v[252:255]
    s_waitcnt lgkmcnt(4)
    s_barrier
    v_mfma_f32_16x16x32_bf16 v[192:195], v[48:51], a[56:59], v[192:195]
    ds_read_b128 v[32:35], v4 offset:0
    v_mul_f32 v172, v172, v11
    v_mfma_f32_16x16x32_bf16 v[200:203], v[48:51], a[60:63], v[200:203]
    buffer_load_dword v15, v8, s[20:23], s55 offen offset:768 sc1
    v_mfma_f32_16x16x32_bf16 v[196:199], v[52:55], a[56:59], v[196:199]
    ds_read_b128 v[36:39], v4 offset:1024
    v_rcp_f32 v180, v180
    v_mfma_f32_16x16x32_bf16 v[204:207], v[52:55], a[60:63], v[204:207]
    v_rcp_f32 v181, v181
    v_mfma_f32_16x16x32_bf16 v[208:211], v[56:59], a[56:59], v[208:211]
    ds_read_b128 v[40:43], v4 offset:2048
    v_mul_f32 v180, v164, v180
    v_mfma_f32_16x16x32_bf16 v[216:219], v[56:59], a[60:63], v[216:219]
    buffer_load_dwordx4 a[168:171], v1, s[20:23], s33 offen offset:0 sc1
    v_mfma_f32_16x16x32_bf16 v[212:215], v[60:63], a[56:59], v[212:215]
    ds_read_b128 v[44:47], v4 offset:3072
    v_mul_f32 v181, v165, v181
    v_mfma_f32_16x16x32_bf16 v[220:223], v[60:63], a[60:63], v[220:223]
    s_waitcnt lgkmcnt(4)
    v_rcp_f32 v182, v182
    v_cvt_pk_bf16_f32 v162, v180, v181
    v_mfma_f32_16x16x32_bf16 v[224:227], v[16:19], a[56:59], v[224:227]
    ds_read_b128 v[48:51], v4 offset:4096
    v_mul_f32 v182, v166, v182
    v_mfma_f32_16x16x32_bf16 v[232:235], v[16:19], a[60:63], v[232:235]
    buffer_load_dwordx4 a[172:175], v1, s[20:23], s33 offen offset:1024 sc1
    v_mfma_f32_16x16x32_bf16 v[228:231], v[20:23], a[56:59], v[228:231]
    ds_read_b128 v[52:55], v4 offset:5120
    v_mul_f32 v173, v173, v11
    v_mfma_f32_16x16x32_bf16 v[236:239], v[20:23], a[60:63], v[236:239]
    buffer_load_dwordx4 v0, s[20:23], m0 offen offset:2048 sc1 lds
    v_mfma_f32_16x16x32_bf16 v[240:243], v[24:27], a[56:59], v[240:243]
    ds_read_b128 v[56:59], v4 offset:6144
    v_rcp_f32 v183, v183
    v_mfma_f32_16x16x32_bf16 v[248:251], v[24:27], a[60:63], v[248:251]
    buffer_load_dwordx4 v0, s[20:23], m0 offen offset:3072 sc1 lds
    v_add_u32 v0, 163840, v0
    v_mfma_f32_16x16x32_bf16 v[244:247], v[28:31], a[56:59], v[244:247]
    ds_read_b128 v[60:63], v4 offset:7168
    v_mul_f32 v183, v167, v183
    v_mfma_f32_16x16x32_bf16 v[252:255], v[28:31], a[60:63], v[252:255]
    s_waitcnt lgkmcnt(4)
    v_exp_f32 v184, -v168
    v_mfma_f32_16x16x32_bf16 v[192:195], v[32:35], a[64:67], v[192:195]
    ds_read_b128 v[16:19], v4 offset:8192
    v_cvt_pk_bf16_f32 v163, v182, v183
    v_mfma_f32_16x16x32_bf16 v[200:203], v[32:35], a[68:71], v[200:203]
    buffer_load_dwordx4 a[176:179], v1, s[20:23], s34 offen offset:0 sc1
    v_fma_f32 v184, v184, s50, s50
    v_mfma_f32_16x16x32_bf16 v[196:199], v[36:39], a[64:67], v[196:199]
    ds_read_b128 v[20:23], v4 offset:9216
    v_mul_f32 v174, v174, v11
    v_mfma_f32_16x16x32_bf16 v[204:207], v[36:39], a[68:71], v[204:207]
    v_exp_f32 v185, -v169
    v_mfma_f32_16x16x32_bf16 v[208:211], v[40:43], a[64:67], v[208:211]
    ds_read_b128 v[24:27], v4 offset:10240
    v_fma_f32 v185, v185, s50, s50
    v_mfma_f32_16x16x32_bf16 v[216:219], v[40:43], a[68:71], v[216:219]
    buffer_load_dwordx4 a[180:183], v1, s[20:23], s34 offen offset:1024 sc1
    v_mfma_f32_16x16x32_bf16 v[212:215], v[44:47], a[64:67], v[212:215]
    ds_read_b128 v[28:31], v4 offset:11264
    v_exp_f32 v186, -v170
    v_mfma_f32_16x16x32_bf16 v[220:223], v[44:47], a[68:71], v[220:223]
    s_waitcnt lgkmcnt(4)
    v_exp_f32 v187, -v171
    v_mfma_f32_16x16x32_bf16 v[224:227], v[48:51], a[64:67], v[224:227]
    ds_read_b128 v[32:35], v4 offset:12288
    v_fma_f32 v186, v186, s50, s50
    v_mfma_f32_16x16x32_bf16 v[232:235], v[48:51], a[68:71], v[232:235]
    buffer_store_dwordx4 v[160:163], v5, s[20:23], s40 offen offset:0 sc1
    v_mfma_f32_16x16x32_bf16 v[228:231], v[52:55], a[64:67], v[228:231]
    ds_read_b128 v[36:39], v4 offset:13312
    v_fma_f32 v187, v187, s50, s50
    v_mfma_f32_16x16x32_bf16 v[236:239], v[52:55], a[68:71], v[236:239]
    v_rcp_f32 v184, v184
    v_mul_f32 v175, v175, v11
    v_mfma_f32_16x16x32_bf16 v[240:243], v[56:59], a[64:67], v[240:243]
    ds_read_b128 v[40:43], v4 offset:14336
    v_mul_f32 v184, v168, v184
    v_mfma_f32_16x16x32_bf16 v[248:251], v[56:59], a[68:71], v[248:251]
    buffer_load_dwordx4 a[184:187], v1, s[20:23], s35 offen offset:0 sc1
    v_mfma_f32_16x16x32_bf16 v[244:247], v[60:63], a[64:67], v[244:247]
    ds_read_b128 v[44:47], v4 offset:15360
    v_mfma_f32_16x16x32_bf16 v[252:255], v[60:63], a[68:71], v[252:255]
    s_waitcnt lgkmcnt(4)
    v_rcp_f32 v185, v185
    v_mfma_f32_16x16x32_bf16 v[192:195], v[16:19], a[72:75], v[192:195]
    ds_read_b128 v[48:51], v4 offset:16384
    v_rcp_f32 v186, v186
    v_mfma_f32_16x16x32_bf16 v[200:203], v[16:19], a[76:79], v[200:203]
    buffer_load_dwordx4 a[188:191], v1, s[20:23], s35 offen offset:1024 sc1
    v_mfma_f32_16x16x32_bf16 v[196:199], v[20:23], a[72:75], v[196:199]
    ds_read_b128 v[52:55], v4 offset:17408
    s_add_u32 m0, s57, 0
    v_mfma_f32_16x16x32_bf16 v[204:207], v[20:23], a[76:79], v[204:207]
    v_rcp_f32 v187, v187
    v_mfma_f32_16x16x32_bf16 v[208:211], v[24:27], a[72:75], v[208:211]
    ds_read_b128 v[56:59], v4 offset:18432
    v_mul_f32 v185, v169, v185
    v_mfma_f32_16x16x32_bf16 v[216:219], v[24:27], a[76:79], v[216:219]
    buffer_load_dwordx4 v0, s[20:23], m0 offen offset:0 sc1 lds
    v_mul_f32 v186, v170, v186
    v_mfma_f32_16x16x32_bf16 v[212:215], v[28:31], a[72:75], v[212:215]
    ds_read_b128 v[60:63], v4 offset:19456
    v_mul_f32 v187, v171, v187
    v_mfma_f32_16x16x32_bf16 v[220:223], v[28:31], a[76:79], v[220:223]
    s_waitcnt lgkmcnt(4)
    v_exp_f32 v188, -v172
    v_mfma_f32_16x16x32_bf16 v[224:227], v[32:35], a[72:75], v[224:227]
    ds_read_b128 v[16:19], v4 offset:20480
    v_fma_f32 v188, v188, s50, s50
    v_mfma_f32_16x16x32_bf16 v[232:235], v[32:35], a[76:79], v[232:235]
    buffer_load_dwordx4 v0, s[20:23], m0 offen offset:1024 sc1 lds
    v_mfma_f32_16x16x32_bf16 v[228:231], v[36:39], a[72:75], v[228:231]
    ds_read_b128 v[20:23], v4 offset:21504
    v_exp_f32 v189, -v173
    v_mfma_f32_16x16x32_bf16 v[236:239], v[36:39], a[76:79], v[236:239]
    buffer_load_dword v13, v8, s[20:23], s49 offen offset:1024 sc1
    v_mfma_f32_16x16x32_bf16 v[240:243], v[40:43], a[72:75], v[240:243]
    ds_read_b128 v[24:27], v4 offset:22528
    v_fma_f32 v189, v189, s50, s50
    v_mfma_f32_16x16x32_bf16 v[248:251], v[40:43], a[76:79], v[248:251]
    buffer_load_dwordx4 a[192:195], v1, s[20:23], s36 offen offset:0 sc1
    v_mfma_f32_16x16x32_bf16 v[244:247], v[44:47], a[72:75], v[244:247]
    ds_read_b128 v[28:31], v4 offset:23552
    v_cvt_pk_bf16_f32 v168, v184, v185
    v_mfma_f32_16x16x32_bf16 v[252:255], v[44:47], a[76:79], v[252:255]
    s_waitcnt lgkmcnt(4)
    v_exp_f32 v190, -v174
    v_cvt_pk_bf16_f32 v169, v186, v187
    v_mfma_f32_16x16x32_bf16 v[192:195], v[48:51], a[80:83], v[192:195]
main_kernel_stub13:
    s_cbranch_execz main_kernel_ret
    ds_read_b128 v[32:35], v4 offset:24576
    v_fma_f32 v190, v190, s50, s50
    v_mfma_f32_16x16x32_bf16 v[200:203], v[48:51], a[84:87], v[200:203]
    buffer_load_dwordx4 a[196:199], v1, s[20:23], s36 offen offset:1024 sc1
    v_mfma_f32_16x16x32_bf16 v[196:199], v[52:55], a[80:83], v[196:199]
    ds_read_b128 v[36:39], v4 offset:25600
    v_mfma_f32_16x16x32_bf16 v[204:207], v[52:55], a[84:87], v[204:207]
    v_exp_f32 v191, -v175
    v_mfma_f32_16x16x32_bf16 v[208:211], v[56:59], a[80:83], v[208:211]
    ds_read_b128 v[40:43], v4 offset:26624
    v_rcp_f32 v188, v188
    v_mfma_f32_16x16x32_bf16 v[216:219], v[56:59], a[84:87], v[216:219]
    buffer_load_dwordx4 v0, s[20:23], m0 offen offset:2048 sc1 lds
    v_mfma_f32_16x16x32_bf16 v[212:215], v[60:63], a[80:83], v[212:215]
    ds_read_b128 v[44:47], v4 offset:27648
    v_fma_f32 v191, v191, s50, s50
    v_mfma_f32_16x16x32_bf16 v[220:223], v[60:63], a[84:87], v[220:223]
    s_waitcnt lgkmcnt(4)
    v_rcp_f32 v189, v189
    v_mfma_f32_16x16x32_bf16 v[224:227], v[16:19], a[80:83], v[224:227]
    ds_read_b128 v[48:51], v4 offset:28672
    v_mul_f32 v188, v172, v188
    v_mfma_f32_16x16x32_bf16 v[232:235], v[16:19], a[84:87], v[232:235]
    buffer_load_dwordx4 v0, s[20:23], m0 offen offset:3072 sc1 lds
    v_mul_f32 v189, v173, v189
    v_mfma_f32_16x16x32_bf16 v[228:231], v[20:23], a[80:83], v[228:231]
    ds_read_b128 v[52:55], v4 offset:29696
    v_cvt_pk_bf16_f32 v170, v188, v189
    v_mfma_f32_16x16x32_bf16 v[236:239], v[20:23], a[84:87], v[236:239]
    s_waitcnt vmcnt(16)
    v_readfirstlane_b32 s31, v15
    s_nop 0
    s_cmp_lt_u32 s31, 8
    s_cbranch_scc1 main_kernel_slow7
main_kernel_back7:
    v_mfma_f32_16x16x32_bf16 v[240:243], v[24:27], a[80:83], v[240:243]
    ds_read_b128 v[56:59], v4 offset:30720
    v_mfma_f32_16x16x32_bf16 v[248:251], v[24:27], a[84:87], v[248:251]
    buffer_load_dwordx4 a[200:203], v1, s[20:23], s37 offen offset:0 sc1
    v_mfma_f32_16x16x32_bf16 v[244:247], v[28:31], a[80:83], v[244:247]
    ds_read_b128 v[60:63], v4 offset:31744
    v_rcp_f32 v190, v190
    v_mfma_f32_16x16x32_bf16 v[252:255], v[28:31], a[84:87], v[252:255]
    s_waitcnt lgkmcnt(4)
    s_barrier
    v_mfma_f32_16x16x32_bf16 v[192:195], v[32:35], a[88:91], v[192:195]
    ds_read_b128 v[16:19], v4 offset:32768
    v_mul_f32 v190, v174, v190
    v_mfma_f32_16x16x32_bf16 v[200:203], v[32:35], a[92:95], v[200:203]
    buffer_load_dwordx4 a[204:207], v1, s[20:23], s37 offen offset:1024 sc1
    v_mfma_f32_16x16x32_bf16 v[196:199], v[36:39], a[88:91], v[196:199]
    ds_read_b128 v[20:23], v4 offset:33792
    v_mfma_f32_16x16x32_bf16 v[204:207], v[36:39], a[92:95], v[204:207]
    v_rcp_f32 v191, v191
    v_mfma_f32_16x16x32_bf16 v[208:211], v[40:43], a[88:91], v[208:211]
    ds_read_b128 v[24:27], v4 offset:34816
    v_mul_f32 v191, v175, v191
    v_mfma_f32_16x16x32_bf16 v[216:219], v[40:43], a[92:95], v[216:219]
    v_cvt_pk_bf16_f32 v171, v190, v191
    v_mfma_f32_16x16x32_bf16 v[212:215], v[44:47], a[88:91], v[212:215]
    ds_read_b128 v[28:31], v4 offset:35840
    v_mfma_f32_16x16x32_bf16 v[220:223], v[44:47], a[92:95], v[220:223]
    s_waitcnt lgkmcnt(4)
    v_mfma_f32_16x16x32_bf16 v[224:227], v[48:51], a[88:91], v[224:227]
    ds_read_b128 v[32:35], v4 offset:36864
    v_bfe_u32 v186, v2, 4, 2
    v_and_b32 v187, 15, v2
    v_mfma_f32_16x16x32_bf16 v[232:235], v[48:51], a[92:95], v[232:235]
    buffer_store_dwordx4 v[168:171], v5, s[20:23], s40 offen offset:1024 sc1
    v_mfma_f32_16x16x32_bf16 v[228:231], v[52:55], a[88:91], v[228:231]
    ds_read_b128 v[36:39], v4 offset:37888
    s_add_u32 m0, s57, 16384
    v_mfma_f32_16x16x32_bf16 v[236:239], v[52:55], a[92:95], v[236:239]
    buffer_load_dwordx4 v0, s[20:23], m0 offen offset:0 sc1 lds
    v_mfma_f32_16x16x32_bf16 v[240:243], v[56:59], a[88:91], v[240:243]
    ds_read_b128 v[40:43], v4 offset:38912
    v_lshlrev_b32 v176, 14, v186
    v_mfma_f32_16x16x32_bf16 v[248:251], v[56:59], a[92:95], v[248:251]
    buffer_load_dwordx4 v0, s[20:23], m0 offen offset:1024 sc1 lds
    v_lshl_add_u32 v176, v187, 4, v176
    v_mfma_f32_16x16x32_bf16 v[244:247], v[60:63], a[88:91], v[244:247]
    ds_read_b128 v[44:47], v4 offset:39936
    v_lshlrev_b32 v177, 11, v186
    v_mfma_f32_16x16x32_bf16 v[252:255], v[60:63], a[92:95], v[252:255]
    s_waitcnt lgkmcnt(4)
    v_lshl_add_u32 v177, v187, 4, v177
    v_lshl_add_u32 v178, s10, 10, v3
    v_mfma_f32_16x16x32_bf16 v[192:195], v[16:19], a[96:99], v[192:195]
    ds_read_b128 v[48:51], v4 offset:40960
    v_add_u32 v178, 147456, v178
    v_mfma_f32_16x16x32_bf16 v[200:203], v[16:19], a[100:103], v[200:203]
    buffer_load_dwordx4 a[208:211], v1, s[20:23], s38 offen offset:0 sc1
    v_mfma_f32_16x16x32_bf16 v[196:199], v[20:23], a[96:99], v[196:199]
    ds_read_b128 v[52:55], v4 offset:41984
    v_lshl_add_u32 v179, s10, 12, v3
    v_cvt_f32_u32 v180, v187
    v_mfma_f32_16x16x32_bf16 v[204:207], v[20:23], a[100:103], v[204:207]
    buffer_load_dwordx4 a[212:215], v1, s[20:23], s38 offen offset:1024 sc1
    v_mfma_f32_16x16x32_bf16 v[208:211], v[24:27], a[96:99], v[208:211]
    ds_read_b128 v[56:59], v4 offset:43008
    v_add_u32 v179, 147456, v179
    v_mfma_f32_16x16x32_bf16 v[216:219], v[24:27], a[100:103], v[216:219]
    buffer_atomic_add v7, v6, s[20:23], s49 offen offset:1280 sc1
    v_mfma_f32_16x16x32_bf16 v[212:215], v[28:31], a[96:99], v[212:215]
    ds_read_b128 v[60:63], v4 offset:44032
    v_mul_f32 v180, 0x3a000000, v180
    v_mfma_f32_16x16x32_bf16 v[220:223], v[28:31], a[100:103], v[220:223]
    s_waitcnt lgkmcnt(4)
    v_add_f32 v181, 0x3c000000, v180
    v_lshlrev_b32 v190, 2, v186
    v_mfma_f32_16x16x32_bf16 v[224:227], v[32:35], a[96:99], v[224:227]
    ds_read_b128 v[16:19], v4 offset:45056
    v_add_f32 v182, 0x3c000000, v181
    v_mfma_f32_16x16x32_bf16 v[232:235], v[32:35], a[100:103], v[232:235]
    buffer_load_dwordx4 a[216:219], v1, s[20:23], s39 offen offset:0 sc1
    v_mfma_f32_16x16x32_bf16 v[228:231], v[36:39], a[96:99], v[228:231]
    ds_read_b128 v[20:23], v4 offset:46080
    v_add_f32 v183, 0x3c000000, v182
    v_mfma_f32_16x16x32_bf16 v[236:239], v[36:39], a[100:103], v[236:239]
    buffer_load_dwordx4 a[220:223], v1, s[20:23], s39 offen offset:1024 sc1
    v_mfma_f32_16x16x32_bf16 v[240:243], v[40:43], a[96:99], v[240:243]
    ds_read_b128 v[24:27], v4 offset:47104
    v_lshl_add_u32 v191, s10, 4, v190
    v_mfma_f32_16x16x32_bf16 v[248:251], v[40:43], a[100:103], v[248:251]
    buffer_load_dwordx4 v0, s[20:23], m0 offen offset:2048 sc1 lds
    v_mfma_f32_16x16x32_bf16 v[244:247], v[44:47], a[96:99], v[244:247]
    ds_read_b128 v[28:31], v4 offset:48128
    v_and_b32 v190, 31, v191
    v_mfma_f32_16x16x32_bf16 v[252:255], v[44:47], a[100:103], v[252:255]
    s_waitcnt lgkmcnt(4)
    v_cvt_f32_u32 v191, v191
    v_cvt_f32_u32 v190, v190
    v_mfma_f32_16x16x32_bf16 v[192:195], v[48:51], a[104:107], v[192:195]
    ds_read_b128 v[32:35], v4 offset:49152
    v_mul_f32 v72, v191, v180
    v_mfma_f32_16x16x32_bf16 v[200:203], v[48:51], a[108:111], v[200:203]
    buffer_load_dwordx4 v0, s[20:23], m0 offen offset:3072 sc1 lds
    v_mul_f32 v76, v191, v181
    v_mfma_f32_16x16x32_bf16 v[196:199], v[52:55], a[104:107], v[196:199]
    ds_read_b128 v[36:39], v4 offset:50176
    v_mul_f32 v96, v190, v180
    v_mfma_f32_16x16x32_bf16 v[204:207], v[52:55], a[108:111], v[204:207]
    v_cos_f32 v64, v72
    v_mfma_f32_16x16x32_bf16 v[208:211], v[56:59], a[104:107], v[208:211]
    ds_read_b128 v[40:43], v4 offset:51200
    v_mul_f32 v100, v190, v181
    v_mfma_f32_16x16x32_bf16 v[216:219], v[56:59], a[108:111], v[216:219]
    v_sin_f32 v72, v72
    v_mfma_f32_16x16x32_bf16 v[212:215], v[60:63], a[104:107], v[212:215]
    ds_read_b128 v[44:47], v4 offset:52224
    v_cos_f32 v68, v76
    v_mfma_f32_16x16x32_bf16 v[220:223], v[60:63], a[108:111], v[220:223]
    s_waitcnt lgkmcnt(4)
    v_sin_f32 v76, v76
    v_mfma_f32_16x16x32_bf16 v[224:227], v[16:19], a[104:107], v[224:227]
    ds_read_b128 v[48:51], v4 offset:53248
    v_mul_f32 v104, v190, v182
    v_mfma_f32_16x16x32_bf16 v[232:235], v[16:19], a[108:111], v[232:235]
    s_waitcnt vmcnt(16)
    v_readfirstlane_b32 s31, v13
    s_nop 0
    s_cmp_lt_u32 s31, 8
    s_cbranch_scc1 main_kernel_slow4
main_kernel_back4:
    v_mfma_f32_16x16x32_bf16 v[228:231], v[20:23], a[104:107], v[228:231]
    ds_read_b128 v[52:55], v4 offset:54272
    v_mul_f32 v108, v190, v183
    v_mfma_f32_16x16x32_bf16 v[236:239], v[20:23], a[108:111], v[236:239]
    v_cos_f32 v80, v96
    v_add_f32 v191, 1.0, v191
    v_mfma_f32_16x16x32_bf16 v[240:243], v[24:27], a[104:107], v[240:243]
    ds_read_b128 v[56:59], v4 offset:55296
    v_add_f32 v190, 1.0, v190
    v_mfma_f32_16x16x32_bf16 v[248:251], v[24:27], a[108:111], v[248:251]
    buffer_load_dwordx4 a[224:227], v3, s[20:23], s41 offen offset:0 sc1
    v_mfma_f32_16x16x32_bf16 v[244:247], v[28:31], a[104:107], v[244:247]
    ds_read_b128 v[60:63], v4 offset:56320
    v_mul_f32 v73, v191, v180
    v_mfma_f32_16x16x32_bf16 v[252:255], v[28:31], a[108:111], v[252:255]
    s_waitcnt lgkmcnt(4)
    v_sin_f32 v96, v96
    v_mfma_f32_16x16x32_bf16 v[192:195], v[32:35], a[112:115], v[192:195]
    ds_read_b128 v[16:19], v4 offset:57344
    v_cos_f32 v84, v100
    v_mfma_f32_16x16x32_bf16 v[200:203], v[32:35], a[116:119], v[200:203]
    buffer_load_dwordx4 a[228:231], v3, s[20:23], s41 offen offset:1024 sc1
    v_mfma_f32_16x16x32_bf16 v[196:199], v[36:39], a[112:115], v[196:199]
    ds_read_b128 v[20:23], v4 offset:58368
    s_add_u32 m0, s57, 32768
    v_mfma_f32_16x16x32_bf16 v[204:207], v[36:39], a[116:119], v[204:207]
    buffer_load_dwordx4 v0, s[20:23], m0 offen offset:0 sc1 lds
    v_mfma_f32_16x16x32_bf16 v[208:211], v[40:43], a[112:115], v[208:211]
    ds_read_b128 v[24:27], v4 offset:59392
    v_mul_f32 v77, v191, v181
    v_mfma_f32_16x16x32_bf16 v[216:219], v[40:43], a[116:119], v[216:219]
    buffer_load_dwordx4 v0, s[20:23], m0 offen offset:1024 sc1 lds
    v_mul_f32 v97, v190, v180
    v_mfma_f32_16x16x32_bf16 v[212:215], v[44:47], a[112:115], v[212:215]
    ds_read_b128 v[28:31], v4 offset:60416
    v_mul_f32 v101, v190, v181
    v_mfma_f32_16x16x32_bf16 v[220:223], v[44:47], a[116:119], v[220:223]
    s_waitcnt lgkmcnt(4)
    v_sin_f32 v100, v100
    v_mfma_f32_16x16x32_bf16 v[224:227], v[48:51], a[112:115], v[224:227]
    ds_read_b128 v[32:35], v4 offset:61440
    v_mul_f32 v105, v190, v182
    v_mfma_f32_16x16x32_bf16 v[232:235], v[48:51], a[116:119], v[232:235]
    buffer_load_dwordx4 a[232:235], v3, s[20:23], s42 offen offset:0 sc1
    v_mfma_f32_16x16x32_bf16 v[228:231], v[52:55], a[112:115], v[228:231]
    ds_read_b128 v[36:39], v4 offset:62464
    v_cos_f32 v88, v104
    v_mfma_f32_16x16x32_bf16 v[236:239], v[52:55], a[116:119], v[236:239]
    v_sin_f32 v104, v104
    v_mfma_f32_16x16x32_bf16 v[240:243], v[56:59], a[112:115], v[240:243]
    ds_read_b128 v[40:43], v4 offset:63488
    v_mul_f32 v109, v190, v183
    v_mfma_f32_16x16x32_bf16 v[248:251], v[56:59], a[116:119], v[248:251]
    buffer_load_dwordx4 a[236:239], v3, s[20:23], s42 offen offset:1024 sc1
    v_mfma_f32_16x16x32_bf16 v[244:247], v[60:63], a[112:115], v[244:247]
    ds_read_b128 v[44:47], v4 offset:64512
    v_add_f32 v191, 1.0, v191
    v_mfma_f32_16x16x32_bf16 v[252:255], v[60:63], a[116:119], v[252:255]
    s_waitcnt lgkmcnt(4)
    s_barrier
    v_mfma_f32_16x16x32_bf16 v[192:195], v[16:19], a[120:123], v[192:195]
    ds_read_b128 v[48:51], v5 offset:0
    v_add_f32 v190, 1.0, v190
    v_mfma_f32_16x16x32_bf16 v[200:203], v[16:19], a[124:127], v[200:203]
    buffer_load_dwordx4 v0, s[20:23], m0 offen offset:2048 sc1 lds
    v_mfma_f32_16x16x32_bf16 v[196:199], v[20:23], a[120:123], v[196:199]
    ds_read_b128 v[52:55], v5 offset:1024
    v_mul_f32 v74, v191, v180
    v_mfma_f32_16x16x32_bf16 v[204:207], v[20:23], a[124:127], v[204:207]
    buffer_load_dwordx4 v0, s[20:23], m0 offen offset:3072 sc1 lds
    v_mfma_f32_16x16x32_bf16 v[208:211], v[24:27], a[120:123], v[208:211]
    ds_read_b128 v[56:59], v5 offset:2048
    v_cos_f32 v92, v108
    v_mfma_f32_16x16x32_bf16 v[216:219], v[24:27], a[124:127], v[216:219]
    buffer_load_dwordx4 a[240:243], v3, s[20:23], s43 offen offset:0 sc1
    v_mfma_f32_16x16x32_bf16 v[212:215], v[28:31], a[120:123], v[212:215]
    ds_read_b128 v[60:63], v5 offset:3072
    v_mul_f32 v78, v191, v181
    v_mfma_f32_16x16x32_bf16 v[220:223], v[28:31], a[124:127], v[220:223]
    s_waitcnt lgkmcnt(4)
    v_sin_f32 v108, v108
    v_mfma_f32_16x16x32_bf16 v[224:227], v[32:35], a[120:123], v[224:227]
    ds_read_b128 v[16:19], v5 offset:4096
    v_mul_f32 v98, v190, v180
    v_mfma_f32_16x16x32_bf16 v[232:235], v[32:35], a[124:127], v[232:235]
    buffer_load_dwordx4 a[244:247], v3, s[20:23], s43 offen offset:1024 sc1
    v_mul_f32 v102, v190, v181
    v_mfma_f32_16x16x32_bf16 v[228:231], v[36:39], a[120:123], v[228:231]
    ds_read_b128 v[20:23], v5 offset:5120
    v_mul_f32 v106, v190, v182
    v_mfma_f32_16x16x32_bf16 v[236:239], v[36:39], a[124:127], v[236:239]
    v_cos_f32 v65, v73
    v_mfma_f32_16x16x32_bf16 v[240:243], v[40:43], a[120:123], v[240:243]
    ds_read_b128 v[24:27], v5 offset:6144
    v_mul_f32 v110, v190, v183
    v_mfma_f32_16x16x32_bf16 v[248:251], v[40:43], a[124:127], v[248:251]
    v_sin_f32 v73, v73
    v_mfma_f32_16x16x32_bf16 v[244:247], v[44:47], a[120:123], v[244:247]
    ds_read_b128 v[28:31], v5 offset:7168
    v_cos_f32 v69, v77
    v_mfma_f32_16x16x32_bf16 v[252:255], v[44:47], a[124:127], v[252:255]
    s_waitcnt lgkmcnt(4)
    v_sin_f32 v77, v77
    v_mfma_f32_16x16x32_bf16 v[192:195], v[48:51], a[128:131], v[192:195]
    ds_read_b128 v[32:35], v5 offset:8192
    s_add_u32 m0, s57, 49152
    v_mfma_f32_16x16x32_bf16 v[200:203], v[48:51], a[132:135], v[200:203]
    buffer_load_dwordx4 v0, s[20:23], m0 offen offset:0 sc1 lds
    v_mfma_f32_16x16x32_bf16 v[196:199], v[52:55], a[128:131], v[196:199]
    ds_read_b128 v[36:39], v5 offset:9216
    v_add_f32 v191, 1.0, v191
    v_mfma_f32_16x16x32_bf16 v[204:207], v[52:55], a[132:135], v[204:207]
    buffer_load_dwordx4 v0, s[20:23], m0 offen offset:1024 sc1 lds
    v_add_f32 v190, 1.0, v190
    v_mfma_f32_16x16x32_bf16 v[208:211], v[56:59], a[128:131], v[208:211]
    ds_read_b128 v[40:43], v5 offset:10240
    v_mul_f32 v75, v191, v180
    v_mfma_f32_16x16x32_bf16 v[216:219], v[56:59], a[132:135], v[216:219]
    buffer_load_dwordx4 a[248:251], v3, s[20:23], s44 offen offset:0 sc1
    v_mfma_f32_16x16x32_bf16 v[212:215], v[60:63], a[128:131], v[212:215]
    ds_read_b128 v[44:47], v5 offset:11264
    v_mul_f32 v79, v191, v181
    v_mfma_f32_16x16x32_bf16 v[220:223], v[60:63], a[132:135], v[220:223]
    s_waitcnt lgkmcnt(4)
    v_cos_f32 v81, v97
    v_mfma_f32_16x16x32_bf16 v[224:227], v[16:19], a[128:131], v[224:227]
    ds_read_b128 v[48:51], v5 offset:12288
    v_sin_f32 v97, v97
    v_mfma_f32_16x16x32_bf16 v[232:235], v[16:19], a[132:135], v[232:235]
    buffer_load_dwordx4 a[252:255], v3, s[20:23], s44 offen offset:1024 sc1
    v_mfma_f32_16x16x32_bf16 v[228:231], v[20:23], a[128:131], v[228:231]
    ds_read_b128 v[52:55], v5 offset:13312
    v_mul_f32 v99, v190, v180
    v_mfma_f32_16x16x32_bf16 v[236:239], v[20:23], a[132:135], v[236:239]
    v_cos_f32 v85, v101
    v_mfma_f32_16x16x32_bf16 v[240:243], v[24:27], a[128:131], v[240:243]
    ds_read_b128 v[56:59], v5 offset:14336
    v_mul_f32 v103, v190, v181
    v_mfma_f32_16x16x32_bf16 v[248:251], v[24:27], a[132:135], v[248:251]
    v_sin_f32 v101, v101
    v_mul_f32 v107, v190, v182
    v_mfma_f32_16x16x32_bf16 v[244:247], v[28:31], a[128:131], v[244:247]
    ds_read_b128 v[60:63], v5 offset:15360
    v_mul_f32 v111, v190, v183
    v_mfma_f32_16x16x32_bf16 v[252:255], v[28:31], a[132:135], v[252:255]
    s_waitcnt lgkmcnt(4)
    v_cos_f32 v89, v105
    v_mfma_f32_16x16x32_bf16 v[192:195], v[32:35], a[136:139], v[192:195]
    ds_read_b128 v[16:19], v5 offset:16384
    v_bfe_u32 v186, v2, 4, 2
    v_mfma_f32_16x16x32_bf16 v[200:203], v[32:35], a[140:143], v[200:203]
    buffer_load_dwordx4 v0, s[20:23], m0 offen offset:2048 sc1 lds
    v_mfma_f32_16x16x32_bf16 v[196:199], v[36:39], a[136:139], v[196:199]
    ds_read_b128 v[20:23], v5 offset:17408
    v_sin_f32 v105, v105
    v_mfma_f32_16x16x32_bf16 v[204:207], v[36:39], a[140:143], v[204:207]
    buffer_load_dwordx4 v0, s[20:23], m0 offen offset:3072 sc1 lds
    v_mfma_f32_16x16x32_bf16 v[208:211], v[40:43], a[136:139], v[208:211]
    ds_read_b128 v[24:27], v5 offset:18432
    v_and_b32 v187, 15, v2
    v_mfma_f32_16x16x32_bf16 v[216:219], v[40:43], a[140:143], v[216:219]
    buffer_load_dword v14, v8, s[20:23], s49 offen offset:1280 sc1
    v_mfma_f32_16x16x32_bf16 v[212:215], v[44:47], a[136:139], v[212:215]
    ds_read_b128 v[28:31], v5 offset:19456
    v_lshlrev_b32 v180, 4, v187
    v_mfma_f32_16x16x32_bf16 v[220:223], v[44:47], a[140:143], v[220:223]
    s_waitcnt lgkmcnt(4)
    v_cos_f32 v93, v109
    v_lshrrev_b32 v190, 5, v2
    v_mfma_f32_16x16x32_bf16 v[224:227], v[48:51], a[136:139], v[224:227]
    ds_read_b128 v[32:35], v5 offset:20480
    v_lshl_add_u32 v180, v190, 3, v180
    v_mfma_f32_16x16x32_bf16 v[232:235], v[48:51], a[140:143], v[232:235]
    buffer_load_dwordx4 a[0:3], v3, s[20:23], s45 offen offset:0 sc1
    v_mfma_f32_16x16x32_bf16 v[228:231], v[52:55], a[136:139], v[228:231]
    ds_read_b128 v[36:39], v5 offset:21504
    v_lshlrev_b32 v190, 31, v186
    v_mfma_f32_16x16x32_bf16 v[236:239], v[52:55], a[140:143], v[236:239]
    v_sin_f32 v109, v109
    v_mfma_f32_16x16x32_bf16 v[240:243], v[56:59], a[136:139], v[240:243]
    ds_read_b128 v[40:43], v5 offset:22528
    v_cos_f32 v66, v74
    v_mfma_f32_16x16x32_bf16 v[248:251], v[56:59], a[140:143], v[248:251]
    buffer_load_dwordx4 a[4:7], v3, s[20:23], s45 offen offset:1024 sc1
    v_mfma_f32_16x16x32_bf16 v[244:247], v[60:63], a[136:139], v[244:247]
    ds_read_b128 v[44:47], v5 offset:23552
    v_or_b32 v180, v180, v190
    v_mfma_f32_16x16x32_bf16 v[252:255], v[60:63], a[140:143], v[252:255]
    s_waitcnt lgkmcnt(4)
    v_sin_f32 v74, v74
    v_mfma_f32_16x16x32_bf16 v[192:195], v[16:19], a[144:147], v[192:195]
    ds_read_b128 v[48:51], v5 offset:24576
    v_add_u32 v181, s14, v186
    v_mfma_f32_16x16x32_bf16 v[200:203], v[16:19], a[148:151], v[200:203]
    buffer_load_dwordx4 a[8:11], v3, s[20:23], s46 offen offset:0 sc1
    v_min_u32 v181, 1, v181
    v_mfma_f32_16x16x32_bf16 v[196:199], v[20:23], a[144:147], v[196:199]
    ds_read_b128 v[52:55], v5 offset:25600
    v_cvt_f32_u32 v181, v181
    v_mfma_f32_16x16x32_bf16 v[204:207], v[20:23], a[148:151], v[204:207]
    v_cos_f32 v70, v78
    v_mfma_f32_16x16x32_bf16 v[208:211], v[24:27], a[144:147], v[208:211]
    ds_read_b128 v[56:59], v5 offset:26624
    v_lshlrev_b32 v190, 2, v186
    v_mfma_f32_16x16x32_bf16 v[216:219], v[24:27], a[148:151], v[216:219]
    buffer_load_dwordx4 a[12:15], v3, s[20:23], s46 offen offset:1024 sc1
    v_mfma_f32_16x16x32_bf16 v[212:215], v[28:31], a[144:147], v[212:215]
    ds_read_b128 v[60:63], v5 offset:27648
    v_sin_f32 v78, v78
    v_mfma_f32_16x16x32_bf16 v[220:223], v[28:31], a[148:151], v[220:223]
    s_waitcnt lgkmcnt(4)
    v_cos_f32 v82, v98
    v_mfma_f32_16x16x32_bf16 v[224:227], v[32:35], a[144:147], v[224:227]
    ds_read_b128 v[16:19], v5 offset:28672
    v_sub_u32 v190, v187, v190
    v_mfma_f32_16x16x32_bf16 v[232:235], v[32:35], a[148:151], v[232:235]
    s_waitcnt vmcnt(30)
    buffer_atomic_add v7, v6, s[20:23], s49 offen offset:1536 sc1
    v_mfma_f32_16x16x32_bf16 v[228:231], v[36:39], a[144:147], v[228:231]
    ds_read_b128 v[20:23], v5 offset:29696
    s_add_u32 m0, s57, 65536
    v_mfma_f32_16x16x32_bf16 v[236:239], v[36:39], a[148:151], v[236:239]
    buffer_load_dwordx4 v0, s[20:23], m0 offen offset:0 sc1 lds
    v_min_u32 v190, 4, v190
    v_mfma_f32_16x16x32_bf16 v[240:243], v[40:43], a[144:147], v[240:243]
    ds_read_b128 v[24:27], v5 offset:30720
    v_lshlrev_b32 v190, 4, v190
    v_mfma_f32_16x16x32_bf16 v[248:251], v[40:43], a[148:151], v[248:251]
    buffer_load_dwordx4 v0, s[20:23], m0 offen offset:1024 sc1 lds
    v_mfma_f32_16x16x32_bf16 v[244:247], v[44:47], a[144:147], v[244:247]
    ds_read_b128 v[28:31], v5 offset:31744
    v_lshrrev_b32 v191, 6, v190
    v_mfma_f32_16x16x32_bf16 v[252:255], v[44:47], a[148:151], v[252:255]
    s_waitcnt lgkmcnt(4) vmcnt(24)
    s_barrier
    v_mfma_f32_16x16x32_bf16 v[192:195], v[48:51], a[152:155], v[192:195]
    ds_read_b128 v[32:35], v3 offset:0
    v_sin_f32 v98, v98
    v_mfma_f32_16x16x32_bf16 v[200:203], v[48:51], a[156:159], v[200:203]
    buffer_load_dwordx4 a[16:19], v3, s[20:23], s47 offen offset:0 sc1
    v_mfma_f32_16x16x32_bf16 v[196:199], v[52:55], a[152:155], v[196:199]
    ds_read_b128 v[36:39], v3 offset:1024
    v_sub_u32 v191, 1, v191
    v_mfma_f32_16x16x32_bf16 v[204:207], v[52:55], a[156:159], v[204:207]
    v_cos_f32 v86, v102
    v_mfma_f32_16x16x32_bf16 v[208:211], v[56:59], a[152:155], v[208:211]
    ds_read_b128 v[40:43], v3 offset:2048
    v_mul_u32_u24 v188, 0x3f80, v191
    v_mfma_f32_16x16x32_bf16 v[216:219], v[56:59], a[156:159], v[216:219]
    buffer_load_dwordx4 a[20:23], v3, s[20:23], s47 offen offset:1024 sc1
    v_mov_b32 v189, 0
    v_mfma_f32_16x16x32_bf16 v[212:215], v[60:63], a[152:155], v[212:215]
    ds_read_b128 v[44:47], v3 offset:3072
    v_lshlrev_b64 v[184:185], v190, v[188:189]
    v_mfma_f32_16x16x32_bf16 v[220:223], v[60:63], a[156:159], v[220:223]
    s_waitcnt lgkmcnt(4)
    v_sin_f32 v102, v102
    v_mfma_f32_16x16x32_bf16 v[224:227], v[16:19], a[152:155], v[224:227]
    ds_read_b128 v[48:51], v3 offset:4096
    v_lshrrev_b32 v190, 2, v2
    v_mfma_f32_16x16x32_bf16 v[232:235], v[16:19], a[156:159], v[232:235]
    buffer_load_dwordx4 v0, s[20:23], m0 offen offset:2048 sc1 lds
    v_mfma_f32_16x16x32_bf16 v[228:231], v[20:23], a[152:155], v[228:231]
    ds_read_b128 v[52:55], v3 offset:5120
    v_cos_f32 v90, v106
    v_mfma_f32_16x16x32_bf16 v[236:239], v[20:23], a[156:159], v[236:239]
    v_sin_f32 v106, v106
    v_mfma_f32_16x16x32_bf16 v[240:243], v[24:27], a[152:155], v[240:243]
    ds_read_b128 v[56:59], v3 offset:6144
    v_lshlrev_b32 v190, 15, v190
    v_mfma_f32_16x16x32_bf16 v[248:251], v[24:27], a[156:159], v[248:251]
    buffer_load_dwordx4 v0, s[20:23], m0 offen offset:3072 sc1 lds
    v_mfma_f32_16x16x32_bf16 v[244:247], v[28:31], a[152:155], v[244:247]
    ds_read_b128 v[60:63], v3 offset:7168
    v_and_b32 v191, 48, v3
    v_mfma_f32_16x16x32_bf16 v[252:255], v[28:31], a[156:159], v[252:255]
    s_waitcnt lgkmcnt(4)
    v_cos_f32 v94, v110
    v_add_u32 v190, v190, v191
    v_mfma_f32_16x16x32_bf16 v[192:195], v[32:35], a[160:163], v[192:195]
    ds_read_b128 v[16:19], v3 offset:8192
    v_mov_b32 v186, 0
    v_mfma_f32_16x16x32_bf16 v[200:203], v[32:35], a[164:167], v[200:203]
    v_sin_f32 v110, v110
    v_mfma_f32_16x16x32_bf16 v[196:199], v[36:39], a[160:163], v[196:199]
    ds_read_b128 v[20:23], v3 offset:9216
    v_mov_b32 v187, 0
    v_mfma_f32_16x16x32_bf16 v[204:207], v[36:39], a[164:167], v[204:207]
    v_cos_f32 v67, v75
    v_mfma_f32_16x16x32_bf16 v[208:211], v[40:43], a[160:163], v[208:211]
    ds_read_b128 v[24:27], v3 offset:10240
    v_sin_f32 v75, v75
    v_mfma_f32_16x16x32_bf16 v[216:219], v[40:43], a[164:167], v[216:219]
    v_cos_f32 v71, v79
    v_mfma_f32_16x16x32_bf16 v[212:215], v[44:47], a[160:163], v[212:215]
    ds_read_b128 v[28:31], v3 offset:11264
    v_mov_b32 v188, v184
    v_mfma_f32_16x16x32_bf16 v[220:223], v[44:47], a[164:167], v[220:223]
    s_waitcnt lgkmcnt(4)
    v_sin_f32 v79, v79
    v_mfma_f32_16x16x32_bf16 v[224:227], v[48:51], a[160:163], v[224:227]
    ds_read_b128 v[32:35], v3 offset:12288
    s_add_u32 m0, s57, 81920
    v_mfma_f32_16x16x32_bf16 v[232:235], v[48:51], a[164:167], v[232:235]
    buffer_load_dwordx4 v0, s[20:23], m0 offen offset:0 sc1 lds
    v_mov_b32 v189, v185
    v_mfma_f32_16x16x32_bf16 v[228:231], v[52:55], a[160:163], v[228:231]
    ds_read_b128 v[36:39], v3 offset:13312
    v_mfma_f32_16x16x32_bf16 v[236:239], v[52:55], a[164:167], v[236:239]
    v_cos_f32 v83, v99
    v_mfma_f32_16x16x32_bf16 v[240:243], v[56:59], a[160:163], v[240:243]
    ds_read_b128 v[40:43], v3 offset:14336
    v_mfma_f32_16x16x32_bf16 v[248:251], v[56:59], a[164:167], v[248:251]
    buffer_load_dwordx4 v0, s[20:23], m0 offen offset:1024 sc1 lds
    v_mfma_f32_16x16x32_bf16 v[244:247], v[60:63], a[160:163], v[244:247]
    ds_read_b128 v[44:47], v3 offset:15360
    v_sin_f32 v99, v99
    v_mfma_f32_16x16x32_bf16 v[252:255], v[60:63], a[164:167], v[252:255]
    s_waitcnt lgkmcnt(4)
    v_cos_f32 v87, v103
    v_mfma_f32_16x16x32_bf16 v[192:195], v[16:19], a[168:171], v[192:195]
    ds_read_b128 v[48:51], v3 offset:16384
    v_mfma_f32_16x16x32_bf16 v[200:203], v[16:19], a[172:175], v[200:203]
    buffer_load_dwordx4 v0, s[20:23], m0 offen offset:2048 sc1 lds
    v_mfma_f32_16x16x32_bf16 v[196:199], v[20:23], a[168:171], v[196:199]
    ds_read_b128 v[52:55], v3 offset:17408
    v_mfma_f32_16x16x32_bf16 v[204:207], v[20:23], a[172:175], v[204:207]
    buffer_load_dwordx4 v0, s[20:23], m0 offen offset:3072 sc1 lds
    v_mfma_f32_16x16x32_bf16 v[208:211], v[24:27], a[168:171], v[208:211]
    ds_read_b128 v[56:59], v3 offset:18432
    v_mfma_f32_16x16x32_bf16 v[216:219], v[24:27], a[172:175], v[216:219]
    s_waitcnt vmcnt(15)
    v_readfirstlane_b32 s31, v14
    s_nop 0
    s_cmp_lt_u32 s31, 8
    s_cbranch_scc1 main_kernel_slow5
main_kernel_back5:
    v_mfma_f32_16x16x32_bf16 v[212:215], v[28:31], a[168:171], v[212:215]
    ds_read_b128 v[60:63], v3 offset:19456
    v_mfma_f32_16x16x32_bf16 v[220:223], v[28:31], a[172:175], v[220:223]
    s_waitcnt lgkmcnt(4)
    v_sin_f32 v103, v103
    v_mfma_f32_16x16x32_bf16 v[224:227], v[32:35], a[168:171], v[224:227]
    ds_read_b128 v[16:19], v3 offset:20480
    v_cos_f32 v91, v107
    v_mfma_f32_16x16x32_bf16 v[232:235], v[32:35], a[172:175], v[232:235]
    buffer_load_dwordx4 a[24:27], v4, s[20:23], s41 offen offset:0 sc1
    v_mfma_f32_16x16x32_bf16 v[228:231], v[36:39], a[168:171], v[228:231]
    ds_read_b128 v[20:23], v3 offset:21504
    v_mfma_f32_16x16x32_bf16 v[236:239], v[36:39], a[172:175], v[236:239]
    buffer_load_dwordx4 a[28:31], v4, s[20:23], s41 offen offset:1024 sc1
    v_mfma_f32_16x16x32_bf16 v[240:243], v[40:43], a[168:171], v[240:243]
    ds_read_b128 v[24:27], v3 offset:22528
    v_mfma_f32_16x16x32_bf16 v[248:251], v[40:43], a[172:175], v[248:251]
    buffer_load_dwordx4 a[32:35], v4, s[20:23], s42 offen offset:0 sc1
    v_mfma_f32_16x16x32_bf16 v[244:247], v[44:47], a[168:171], v[244:247]
    ds_read_b128 v[28:31], v3 offset:23552
    v_mfma_f32_16x16x32_bf16 v[252:255], v[44:47], a[172:175], v[252:255]
    s_waitcnt lgkmcnt(4)
    v_sin_f32 v107, v107
    v_mfma_f32_16x16x32_bf16 v[192:195], v[48:51], a[176:179], v[192:195]
    ds_read_b128 v[32:35], v3 offset:24576
    v_mfma_f32_16x16x32_bf16 v[200:203], v[48:51], a[180:183], v[200:203]
    buffer_load_dwordx4 a[36:39], v4, s[20:23], s42 offen offset:1024 sc1
    v_mfma_f32_16x16x32_bf16 v[196:199], v[52:55], a[176:179], v[196:199]
    ds_read_b128 v[36:39], v3 offset:25600
    v_cos_f32 v95, v111
    v_mfma_f32_16x16x32_bf16 v[204:207], v[52:55], a[180:183], v[204:207]
    v_sin_f32 v111, v111
    v_mfma_f32_16x16x32_bf16 v[208:211], v[56:59], a[176:179], v[208:211]
    ds_read_b128 v[40:43], v3 offset:26624
    v_mfma_f32_16x16x32_bf16 v[216:219], v[56:59], a[180:183], v[216:219]
    buffer_load_dwordx4 a[40:43], v4, s[20:23], s43 offen offset:0 sc1
    v_mfma_f32_16x16x32_bf16 v[212:215], v[60:63], a[176:179], v[212:215]
    ds_read_b128 v[44:47], v3 offset:27648
    v_mfma_f32_16x16x32_bf16 v[220:223], v[60:63], a[180:183], v[220:223]
    s_waitcnt lgkmcnt(4)
    v_mfma_f32_16x16x32_bf16 v[224:227], v[16:19], a[176:179], v[224:227]
    ds_read_b128 v[48:51], v3 offset:28672
    v_mfma_f32_16x16x32_bf16 v[232:235], v[16:19], a[180:183], v[232:235]
    buffer_load_dwordx4 a[44:47], v4, s[20:23], s43 offen offset:1024 sc1
    v_mfma_f32_16x16x32_bf16 v[228:231], v[20:23], a[176:179], v[228:231]
    ds_read_b128 v[52:55], v3 offset:29696
    v_mfma_f32_16x16x32_bf16 v[236:239], v[20:23], a[180:183], v[236:239]
    buffer_load_dwordx4 a[48:51], v4, s[20:23], s44 offen offset:0 sc1
    v_mfma_f32_16x16x32_bf16 v[240:243], v[24:27], a[176:179], v[240:243]
    ds_read_b128 v[56:59], v3 offset:30720
    v_mfma_f32_16x16x32_bf16 v[248:251], v[24:27], a[180:183], v[248:251]
    buffer_load_dwordx4 a[52:55], v4, s[20:23], s44 offen offset:1024 sc1
    v_mfma_f32_16x16x32_bf16 v[244:247], v[28:31], a[176:179], v[244:247]
    ds_read_b128 v[60:63], v3 offset:31744
    v_mfma_f32_16x16x32_bf16 v[252:255], v[28:31], a[180:183], v[252:255]
    s_waitcnt lgkmcnt(4)
    s_barrier
    v_mfma_f32_16x16x32_bf16 v[192:195], v[32:35], a[184:187], v[192:195]
    ds_read_b128 v[16:19], v3 offset:32768
    v_mfma_f32_16x16x32_bf16 v[200:203], v[32:35], a[188:191], v[200:203]
    buffer_load_dword v12, v8, s[20:23], s49 offen offset:1536 sc1
    v_mfma_f32_16x16x32_bf16 v[196:199], v[36:39], a[184:187], v[196:199]
    ds_read_b128 v[20:23], v3 offset:33792
    v_mfma_f32_16x16x32_bf16 v[204:207], v[36:39], a[188:191], v[204:207]
    v_mfma_f32_16x16x32_bf16 v[208:211], v[40:43], a[184:187], v[208:211]
    ds_read_b128 v[24:27], v3 offset:34816
    v_mfma_f32_16x16x32_bf16 v[216:219], v[40:43], a[188:191], v[216:219]
    v_mfma_f32_16x16x32_bf16 v[212:215], v[44:47], a[184:187], v[212:215]
    ds_read_b128 v[28:31], v3 offset:35840
    v_mfma_f32_16x16x32_bf16 v[220:223], v[44:47], a[188:191], v[220:223]
    s_waitcnt lgkmcnt(4)
    v_mfma_f32_16x16x32_bf16 v[224:227], v[48:51], a[184:187], v[224:227]
    ds_read_b128 v[32:35], v3 offset:36864
    s_add_u32 m0, s57, 98304
    v_mfma_f32_16x16x32_bf16 v[232:235], v[48:51], a[188:191], v[232:235]
    buffer_load_dwordx4 v0, s[20:23], m0 offen offset:0 sc1 lds
    v_mfma_f32_16x16x32_bf16 v[228:231], v[52:55], a[184:187], v[228:231]
    ds_read_b128 v[36:39], v3 offset:37888
    v_mfma_f32_16x16x32_bf16 v[236:239], v[52:55], a[188:191], v[236:239]
    buffer_load_dwordx4 v0, s[20:23], m0 offen offset:1024 sc1 lds
    v_mfma_f32_16x16x32_bf16 v[240:243], v[56:59], a[184:187], v[240:243]
    ds_read_b128 v[40:43], v3 offset:38912
    v_mfma_f32_16x16x32_bf16 v[248:251], v[56:59], a[188:191], v[248:251]
    buffer_load_dwordx4 a[56:59], v4, s[20:23], s45 offen offset:0 sc1
    v_mfma_f32_16x16x32_bf16 v[244:247], v[60:63], a[184:187], v[244:247]
    ds_read_b128 v[44:47], v3 offset:39936
    v_mfma_f32_16x16x32_bf16 v[252:255], v[60:63], a[188:191], v[252:255]
    s_waitcnt lgkmcnt(4)
    v_mfma_f32_16x16x32_bf16 v[192:195], v[16:19], a[192:195], v[192:195]
    ds_read_b128 v[48:51], v3 offset:40960
    v_mfma_f32_16x16x32_bf16 v[200:203], v[16:19], a[196:199], v[200:203]
    buffer_load_dwordx4 a[60:63], v4, s[20:23], s45 offen offset:1024 sc1
    v_mfma_f32_16x16x32_bf16 v[196:199], v[20:23], a[192:195], v[196:199]
    ds_read_b128 v[52:55], v3 offset:41984
    v_mfma_f32_16x16x32_bf16 v[204:207], v[20:23], a[196:199], v[204:207]
    buffer_load_dwordx4 a[64:67], v4, s[20:23], s46 offen offset:0 sc1
    v_mfma_f32_16x16x32_bf16 v[208:211], v[24:27], a[192:195], v[208:211]
main_kernel_stub14:
    s_cbranch_execz main_kernel_ret
    ds_read_b128 v[56:59], v3 offset:43008
    v_mfma_f32_16x16x32_bf16 v[216:219], v[24:27], a[196:199], v[216:219]
    buffer_load_dwordx4 a[68:71], v4, s[20:23], s46 offen offset:1024 sc1
    v_mfma_f32_16x16x32_bf16 v[212:215], v[28:31], a[192:195], v[212:215]
    ds_read_b128 v[60:63], v3 offset:44032
    v_mfma_f32_16x16x32_bf16 v[220:223], v[28:31], a[196:199], v[220:223]
    s_waitcnt lgkmcnt(4)
    v_mfma_f32_16x16x32_bf16 v[224:227], v[32:35], a[192:195], v[224:227]
    ds_read_b128 v[16:19], v3 offset:45056
    v_mfma_f32_16x16x32_bf16 v[232:235], v[32:35], a[196:199], v[232:235]
    buffer_load_dwordx4 v0, s[20:23], m0 offen offset:2048 sc1 lds
    v_mfma_f32_16x16x32_bf16 v[228:231], v[36:39], a[192:195], v[228:231]
    ds_read_b128 v[20:23], v3 offset:46080
    v_mfma_f32_16x16x32_bf16 v[236:239], v[36:39], a[196:199], v[236:239]
    buffer_load_dwordx4 v0, s[20:23], m0 offen offset:3072 sc1 lds
    v_mfma_f32_16x16x32_bf16 v[240:243], v[40:43], a[192:195], v[240:243]
    ds_read_b128 v[24:27], v3 offset:47104
    v_mfma_f32_16x16x32_bf16 v[248:251], v[40:43], a[196:199], v[248:251]
    v_mfma_f32_16x16x32_bf16 v[244:247], v[44:47], a[192:195], v[244:247]
    ds_read_b128 v[28:31], v3 offset:48128
    v_mfma_f32_16x16x32_bf16 v[252:255], v[44:47], a[196:199], v[252:255]
    s_waitcnt lgkmcnt(4)
    v_mfma_f32_16x16x32_bf16 v[192:195], v[48:51], a[200:203], v[192:195]
    ds_read_b128 v[32:35], v3 offset:49152
    s_add_u32 m0, s57, 114688
    v_mfma_f32_16x16x32_bf16 v[200:203], v[48:51], a[204:207], v[200:203]
    buffer_load_dwordx4 v0, s[20:23], m0 offen offset:0 sc1 lds
    v_mfma_f32_16x16x32_bf16 v[196:199], v[52:55], a[200:203], v[196:199]
    ds_read_b128 v[36:39], v3 offset:50176
    v_mfma_f32_16x16x32_bf16 v[204:207], v[52:55], a[204:207], v[204:207]
    buffer_load_dwordx4 v0, s[20:23], m0 offen offset:1024 sc1 lds
    v_mfma_f32_16x16x32_bf16 v[208:211], v[56:59], a[200:203], v[208:211]
    ds_read_b128 v[40:43], v3 offset:51200
    v_mfma_f32_16x16x32_bf16 v[216:219], v[56:59], a[204:207], v[216:219]
    buffer_load_dwordx4 a[72:75], v4, s[20:23], s47 offen offset:0 sc1
    v_mfma_f32_16x16x32_bf16 v[212:215], v[60:63], a[200:203], v[212:215]
    ds_read_b128 v[44:47], v3 offset:52224
    v_mfma_f32_16x16x32_bf16 v[220:223], v[60:63], a[204:207], v[220:223]
    s_waitcnt lgkmcnt(4)
    v_mfma_f32_16x16x32_bf16 v[224:227], v[16:19], a[200:203], v[224:227]
    ds_read_b128 v[48:51], v3 offset:53248
    v_mfma_f32_16x16x32_bf16 v[232:235], v[16:19], a[204:207], v[232:235]
    buffer_load_dwordx4 a[76:79], v4, s[20:23], s47 offen offset:1024 sc1
    v_mfma_f32_16x16x32_bf16 v[228:231], v[20:23], a[200:203], v[228:231]
    ds_read_b128 v[52:55], v3 offset:54272
    v_mfma_f32_16x16x32_bf16 v[236:239], v[20:23], a[204:207], v[236:239]
    buffer_load_dwordx4 v0, s[20:23], m0 offen offset:2048 sc1 lds
    v_mfma_f32_16x16x32_bf16 v[240:243], v[24:27], a[200:203], v[240:243]
    ds_read_b128 v[56:59], v3 offset:55296
    v_mfma_f32_16x16x32_bf16 v[248:251], v[24:27], a[204:207], v[248:251]
    buffer_load_dwordx4 v0, s[20:23], m0 offen offset:3072 sc1 lds
    v_mfma_f32_16x16x32_bf16 v[244:247], v[28:31], a[200:203], v[244:247]
    ds_read_b128 v[60:63], v3 offset:56320
    v_mfma_f32_16x16x32_bf16 v[252:255], v[28:31], a[204:207], v[252:255]
    s_waitcnt lgkmcnt(4)
    v_mfma_f32_16x16x32_bf16 v[192:195], v[32:35], a[208:211], v[192:195]
    ds_read_b128 v[16:19], v3 offset:57344
    v_mfma_f32_16x16x32_bf16 v[200:203], v[32:35], a[212:215], v[200:203]
    v_mfma_f32_16x16x32_bf16 v[196:199], v[36:39], a[208:211], v[196:199]
    ds_read_b128 v[20:23], v3 offset:58368
    v_mfma_f32_16x16x32_bf16 v[204:207], v[36:39], a[212:215], v[204:207]
    v_mfma_f32_16x16x32_bf16 v[208:211], v[40:43], a[208:211], v[208:211]
    ds_read_b128 v[24:27], v3 offset:59392
    v_mfma_f32_16x16x32_bf16 v[216:219], v[40:43], a[212:215], v[216:219]
    v_mfma_f32_16x16x32_bf16 v[212:215], v[44:47], a[208:211], v[212:215]
    ds_read_b128 v[28:31], v3 offset:60416
    v_mfma_f32_16x16x32_bf16 v[220:223], v[44:47], a[212:215], v[220:223]
    s_waitcnt lgkmcnt(4)
    v_mfma_f32_16x16x32_bf16 v[224:227], v[48:51], a[208:211], v[224:227]
    ds_read_b128 v[32:35], v3 offset:61440
    v_mfma_f32_16x16x32_bf16 v[232:235], v[48:51], a[212:215], v[232:235]
    v_mfma_f32_16x16x32_bf16 v[228:231], v[52:55], a[208:211], v[228:231]
    ds_read_b128 v[36:39], v3 offset:62464
    v_mfma_f32_16x16x32_bf16 v[236:239], v[52:55], a[212:215], v[236:239]
    v_mfma_f32_16x16x32_bf16 v[240:243], v[56:59], a[208:211], v[240:243]
    ds_read_b128 v[40:43], v3 offset:63488
    v_mfma_f32_16x16x32_bf16 v[248:251], v[56:59], a[212:215], v[248:251]
    v_mfma_f32_16x16x32_bf16 v[244:247], v[60:63], a[208:211], v[244:247]
    ds_read_b128 v[44:47], v3 offset:64512
    v_mfma_f32_16x16x32_bf16 v[252:255], v[60:63], a[212:215], v[252:255]
    s_waitcnt lgkmcnt(4) vmcnt(23)
    s_barrier
    v_mfma_f32_16x16x32_bf16 v[192:195], v[16:19], a[216:219], v[192:195]
    ds_read_b128 v[48:51], v4 offset:0
    v_mfma_f32_16x16x32_bf16 v[200:203], v[16:19], a[220:223], v[200:203]
    s_waitcnt vmcnt(14)
    v_readfirstlane_b32 s31, v12
    s_nop 0
    s_cmp_lt_u32 s31, 8
    s_cbranch_scc1 main_kernel_slow6
main_kernel_back6:
    v_mfma_f32_16x16x32_bf16 v[196:199], v[20:23], a[216:219], v[196:199]
    ds_read_b128 v[52:55], v4 offset:1024
    v_mfma_f32_16x16x32_bf16 v[204:207], v[20:23], a[220:223], v[204:207]
    buffer_load_dwordx4 a[80:83], v5, s[20:23], s41 offen offset:0 sc1
    v_mfma_f32_16x16x32_bf16 v[208:211], v[24:27], a[216:219], v[208:211]
    ds_read_b128 v[56:59], v4 offset:2048
    v_mfma_f32_16x16x32_bf16 v[216:219], v[24:27], a[220:223], v[216:219]
    buffer_load_dwordx4 a[84:87], v5, s[20:23], s41 offen offset:1024 sc1
    v_mfma_f32_16x16x32_bf16 v[212:215], v[28:31], a[216:219], v[212:215]
    ds_read_b128 v[60:63], v4 offset:3072
    v_mfma_f32_16x16x32_bf16 v[220:223], v[28:31], a[220:223], v[220:223]
    s_waitcnt lgkmcnt(4)
    v_mfma_f32_16x16x32_bf16 v[224:227], v[32:35], a[216:219], v[224:227]
    ds_read_b128 v[16:19], v4 offset:4096
    s_add_u32 m0, s57, 131072
    v_mfma_f32_16x16x32_bf16 v[232:235], v[32:35], a[220:223], v[232:235]
    buffer_load_dwordx4 v0, s[20:23], m0 offen offset:0 sc1 lds
    v_mfma_f32_16x16x32_bf16 v[228:231], v[36:39], a[216:219], v[228:231]
    ds_read_b128 v[20:23], v4 offset:5120
    v_mfma_f32_16x16x32_bf16 v[236:239], v[36:39], a[220:223], v[236:239]
    buffer_load_dwordx4 v0, s[20:23], m0 offen offset:1024 sc1 lds
    v_mfma_f32_16x16x32_bf16 v[240:243], v[40:43], a[216:219], v[240:243]
    ds_read_b128 v[24:27], v4 offset:6144
    v_mfma_f32_16x16x32_bf16 v[248:251], v[40:43], a[220:223], v[248:251]
    buffer_load_dwordx4 a[88:91], v5, s[20:23], s42 offen offset:0 sc1
    v_mfma_f32_16x16x32_bf16 v[244:247], v[44:47], a[216:219], v[244:247]
    ds_read_b128 v[28:31], v4 offset:7168
    v_mfma_f32_16x16x32_bf16 v[252:255], v[44:47], a[220:223], v[252:255]
    s_waitcnt lgkmcnt(4)
    v_mfma_f32_16x16x32_bf16 v[192:195], v[48:51], v[128:131], v[192:195]
    ds_read_b128 v[32:35], v4 offset:8192
    v_mfma_f32_16x16x32_bf16 v[200:203], v[48:51], v[136:139], v[200:203]
    buffer_load_dwordx4 a[92:95], v5, s[20:23], s42 offen offset:1024 sc1
    v_mfma_f32_16x16x32_bf16 v[196:199], v[52:55], v[128:131], v[196:199]
    ds_read_b128 v[36:39], v4 offset:9216
    v_mfma_f32_16x16x32_bf16 v[204:207], v[52:55], v[136:139], v[204:207]
    buffer_load_dwordx4 a[96:99], v5, s[20:23], s43 offen offset:0 sc1
    v_mfma_f32_16x16x32_bf16 v[192:195], v[56:59], a[224:227], v[192:195]
    ds_read_b128 v[40:43], v4 offset:10240
    v_mfma_f32_16x16x32_bf16 v[200:203], v[56:59], a[228:231], v[200:203]
    buffer_load_dwordx4 a[100:103], v5, s[20:23], s43 offen offset:1024 sc1
    v_mfma_f32_16x16x32_bf16 v[196:199], v[60:63], a[224:227], v[196:199]
    ds_read_b128 v[44:47], v4 offset:11264
    v_mfma_f32_16x16x32_bf16 v[204:207], v[60:63], a[228:231], v[204:207]
    s_waitcnt lgkmcnt(4)
    v_mfma_f32_16x16x32_bf16 v[192:195], v[16:19], a[232:235], v[192:195]
    ds_read_b128 v[48:51], v4 offset:12288
    v_mfma_f32_16x16x32_bf16 v[200:203], v[16:19], a[236:239], v[200:203]
    buffer_load_dwordx4 v0, s[20:23], m0 offen offset:2048 sc1 lds
    v_mfma_f32_16x16x32_bf16 v[196:199], v[20:23], a[232:235], v[196:199]
    ds_read_b128 v[52:55], v4 offset:13312
    v_mfma_f32_16x16x32_bf16 v[204:207], v[20:23], a[236:239], v[204:207]
    buffer_load_dwordx4 v0, s[20:23], m0 offen offset:3072 sc1 lds
    v_mfma_f32_16x16x32_bf16 v[192:195], v[24:27], a[240:243], v[192:195]
    ds_read_b128 v[56:59], v4 offset:14336
    v_mfma_f32_16x16x32_bf16 v[200:203], v[24:27], a[244:247], v[200:203]
    v_mfma_f32_16x16x32_bf16 v[196:199], v[28:31], a[240:243], v[196:199]
    ds_read_b128 v[60:63], v4 offset:15360
    v_mfma_f32_16x16x32_bf16 v[204:207], v[28:31], a[244:247], v[204:207]
    s_waitcnt lgkmcnt(4)
    v_mfma_f32_16x16x32_bf16 v[192:195], v[32:35], a[248:251], v[192:195]
    ds_read_b128 v[16:19], v4 offset:16384
    s_add_u32 m0, s57, 147456
    v_mfma_f32_16x16x32_bf16 v[200:203], v[32:35], a[252:255], v[200:203]
    buffer_load_dwordx4 v0, s[20:23], m0 offen offset:0 sc1 lds
    v_mfma_f32_16x16x32_bf16 v[196:199], v[36:39], a[248:251], v[196:199]
    ds_read_b128 v[20:23], v4 offset:17408
    v_mfma_f32_16x16x32_bf16 v[204:207], v[36:39], a[252:255], v[204:207]
    buffer_load_dwordx4 v0, s[20:23], m0 offen offset:1024 sc1 lds
    v_mfma_f32_16x16x32_bf16 v[192:195], v[40:43], a[0:3], v[192:195]
    ds_read_b128 v[24:27], v4 offset:18432
    v_mfma_f32_16x16x32_bf16 v[200:203], v[40:43], a[4:7], v[200:203]
    buffer_load_dwordx4 a[104:107], v5, s[20:23], s44 offen offset:0 sc1
    v_mfma_f32_16x16x32_bf16 v[196:199], v[44:47], a[0:3], v[196:199]
    ds_read_b128 v[28:31], v4 offset:19456
    v_mfma_f32_16x16x32_bf16 v[204:207], v[44:47], a[4:7], v[204:207]
    s_waitcnt lgkmcnt(4)
    v_mfma_f32_16x16x32_bf16 v[192:195], v[48:51], a[8:11], v[192:195]
    ds_read_b128 v[32:35], v4 offset:20480
    v_mfma_f32_16x16x32_bf16 v[200:203], v[48:51], a[12:15], v[200:203]
    buffer_load_dwordx4 a[108:111], v5, s[20:23], s44 offen offset:1024 sc1
    v_mfma_f32_16x16x32_bf16 v[196:199], v[52:55], a[8:11], v[196:199]
    ds_read_b128 v[36:39], v4 offset:21504
    v_mfma_f32_16x16x32_bf16 v[204:207], v[52:55], a[12:15], v[204:207]
    buffer_load_dwordx4 v0, s[20:23], m0 offen offset:2048 sc1 lds
    v_mfma_f32_16x16x32_bf16 v[192:195], v[56:59], a[16:19], v[192:195]
    ds_read_b128 v[40:43], v4 offset:22528
    v_mfma_f32_16x16x32_bf16 v[200:203], v[56:59], a[20:23], v[200:203]
    buffer_load_dwordx4 v0, s[20:23], m0 offen offset:3072 sc1 lds
    v_add_u32 v0, 163840, v0
    v_mfma_f32_16x16x32_bf16 v[196:199], v[60:63], a[16:19], v[196:199]
    ds_read_b128 v[44:47], v4 offset:23552
    v_mfma_f32_16x16x32_bf16 v[204:207], v[60:63], a[20:23], v[204:207]
    s_waitcnt lgkmcnt(4)
    v_mfma_f32_16x16x32_bf16 v[192:195], v[16:19], v[144:147], v[192:195]
    ds_read_b128 v[48:51], v4 offset:24576
    v_mfma_f32_16x16x32_bf16 v[200:203], v[16:19], v[152:155], v[200:203]
    buffer_load_dwordx4 a[112:115], v5, s[20:23], s45 offen offset:0 sc1
    v_mfma_f32_16x16x32_bf16 v[196:199], v[20:23], v[144:147], v[196:199]
    ds_read_b128 v[52:55], v4 offset:25600
    v_mfma_f32_16x16x32_bf16 v[204:207], v[20:23], v[152:155], v[204:207]
    buffer_load_dwordx4 a[116:119], v5, s[20:23], s45 offen offset:1024 sc1
    v_mfma_f32_16x16x32_bf16 v[192:195], v[24:27], a[24:27], v[192:195]
    ds_read_b128 v[56:59], v4 offset:26624
    v_mfma_f32_16x16x32_bf16 v[200:203], v[24:27], a[28:31], v[200:203]
    v_mfma_f32_16x16x32_bf16 v[196:199], v[28:31], a[24:27], v[196:199]
    ds_read_b128 v[60:63], v4 offset:27648
    v_mfma_f32_16x16x32_bf16 v[204:207], v[28:31], a[28:31], v[204:207]
    s_waitcnt lgkmcnt(4)
    v_mfma_f32_16x16x32_bf16 v[192:195], v[32:35], a[32:35], v[192:195]
    ds_read_b128 v[16:19], v4 offset:28672
    v_mfma_f32_16x16x32_bf16 v[200:203], v[32:35], a[36:39], v[200:203]
    buffer_load_dwordx4 a[120:123], v5, s[20:23], s46 offen offset:0 sc1
    v_mfma_f32_16x16x32_bf16 v[196:199], v[36:39], a[32:35], v[196:199]
    ds_read_b128 v[20:23], v4 offset:29696
    v_mfma_f32_16x16x32_bf16 v[204:207], v[36:39], a[36:39], v[204:207]
    buffer_load_dwordx4 a[124:127], v5, s[20:23], s46 offen offset:1024 sc1
    v_mfma_f32_16x16x32_bf16 v[192:195], v[40:43], a[40:43], v[192:195]
    ds_read_b128 v[24:27], v4 offset:30720
    v_mfma_f32_16x16x32_bf16 v[200:203], v[40:43], a[44:47], v[200:203]
    v_mfma_f32_16x16x32_bf16 v[196:199], v[44:47], a[40:43], v[196:199]
    ds_read_b128 v[28:31], v4 offset:31744
    v_mfma_f32_16x16x32_bf16 v[204:207], v[44:47], a[44:47], v[204:207]
    s_waitcnt lgkmcnt(4) vmcnt(20)
    s_barrier
    v_mfma_f32_16x16x32_bf16 v[192:195], v[48:51], a[48:51], v[192:195]
    ds_read_b128 v[32:35], v4 offset:32768
    v_mfma_f32_16x16x32_bf16 v[200:203], v[48:51], a[52:55], v[200:203]
    v_mfma_f32_16x16x32_bf16 v[196:199], v[52:55], a[48:51], v[196:199]
    ds_read_b128 v[36:39], v4 offset:33792
    v_mfma_f32_16x16x32_bf16 v[204:207], v[52:55], a[52:55], v[204:207]
    v_mfma_f32_16x16x32_bf16 v[192:195], v[56:59], a[56:59], v[192:195]
    ds_read_b128 v[40:43], v4 offset:34816
    v_mfma_f32_16x16x32_bf16 v[200:203], v[56:59], a[60:63], v[200:203]
    v_mfma_f32_16x16x32_bf16 v[196:199], v[60:63], a[56:59], v[196:199]
    ds_read_b128 v[44:47], v4 offset:35840
    v_mfma_f32_16x16x32_bf16 v[204:207], v[60:63], a[60:63], v[204:207]
    s_waitcnt lgkmcnt(4)
    v_mfma_f32_16x16x32_bf16 v[192:195], v[16:19], a[64:67], v[192:195]
    ds_read_b128 v[48:51], v4 offset:36864
    s_add_u32 m0, s57, 0
    v_mfma_f32_16x16x32_bf16 v[200:203], v[16:19], a[68:71], v[200:203]
    buffer_load_dwordx4 v0, s[20:23], m0 offen offset:0 sc1 lds
    v_mfma_f32_16x16x32_bf16 v[196:199], v[20:23], a[64:67], v[196:199]
    ds_read_b128 v[52:55], v4 offset:37888
    v_mfma_f32_16x16x32_bf16 v[204:207], v[20:23], a[68:71], v[204:207]
    buffer_load_dwordx4 v0, s[20:23], m0 offen offset:1024 sc1 lds
    v_mfma_f32_16x16x32_bf16 v[192:195], v[24:27], a[72:75], v[192:195]
    ds_read_b128 v[56:59], v4 offset:38912
    v_mfma_f32_16x16x32_bf16 v[200:203], v[24:27], a[76:79], v[200:203]
    buffer_load_dwordx4 a[128:131], v5, s[20:23], s47 offen offset:0 sc1
    v_mfma_f32_16x16x32_bf16 v[196:199], v[28:31], a[72:75], v[196:199]
    ds_read_b128 v[60:63], v4 offset:39936
    v_mfma_f32_16x16x32_bf16 v[204:207], v[28:31], a[76:79], v[204:207]
    s_waitcnt lgkmcnt(4)
    v_mfma_f32_16x16x32_bf16 v[208:211], v[32:35], v[128:131], v[208:211]
    ds_read_b128 v[16:19], v4 offset:40960
    v_mfma_f32_16x16x32_bf16 v[216:219], v[32:35], v[136:139], v[216:219]
    buffer_load_dwordx4 a[132:135], v5, s[20:23], s47 offen offset:1024 sc1
    v_mfma_f32_16x16x32_bf16 v[212:215], v[36:39], v[128:131], v[212:215]
    ds_read_b128 v[20:23], v4 offset:41984
    v_mfma_f32_16x16x32_bf16 v[220:223], v[36:39], v[136:139], v[220:223]
    v_mfma_f32_16x16x32_bf16 v[208:211], v[40:43], a[224:227], v[208:211]
    ds_read_b128 v[24:27], v4 offset:43008
    v_mfma_f32_16x16x32_bf16 v[216:219], v[40:43], a[228:231], v[216:219]
    v_mfma_f32_16x16x32_bf16 v[212:215], v[44:47], a[224:227], v[212:215]
    ds_read_b128 v[28:31], v4 offset:44032
    v_mfma_f32_16x16x32_bf16 v[220:223], v[44:47], a[228:231], v[220:223]
    s_waitcnt lgkmcnt(4)
    v_mfma_f32_16x16x32_bf16 v[208:211], v[48:51], a[232:235], v[208:211]
    ds_read_b128 v[32:35], v4 offset:45056
    v_mfma_f32_16x16x32_bf16 v[216:219], v[48:51], a[236:239], v[216:219]
    buffer_load_dwordx4 v0, s[20:23], m0 offen offset:2048 sc1 lds
    v_mfma_f32_16x16x32_bf16 v[212:215], v[52:55], a[232:235], v[212:215]
    ds_read_b128 v[36:39], v4 offset:46080
    v_mfma_f32_16x16x32_bf16 v[220:223], v[52:55], a[236:239], v[220:223]
    buffer_load_dwordx4 v0, s[20:23], m0 offen offset:3072 sc1 lds
    v_mfma_f32_16x16x32_bf16 v[208:211], v[56:59], a[240:243], v[208:211]
    ds_read_b128 v[40:43], v4 offset:47104
    v_mfma_f32_16x16x32_bf16 v[216:219], v[56:59], a[244:247], v[216:219]
    v_mfma_f32_16x16x32_bf16 v[212:215], v[60:63], a[240:243], v[212:215]
    ds_read_b128 v[44:47], v4 offset:48128
    v_mfma_f32_16x16x32_bf16 v[220:223], v[60:63], a[244:247], v[220:223]
    s_waitcnt lgkmcnt(4)
    v_mfma_f32_16x16x32_bf16 v[208:211], v[16:19], a[248:251], v[208:211]
    ds_read_b128 v[48:51], v4 offset:49152
    s_add_u32 m0, s57, 16384
    v_mfma_f32_16x16x32_bf16 v[216:219], v[16:19], a[252:255], v[216:219]
    buffer_load_dwordx4 v0, s[20:23], m0 offen offset:0 sc1 lds
    v_mfma_f32_16x16x32_bf16 v[212:215], v[20:23], a[248:251], v[212:215]
    ds_read_b128 v[52:55], v4 offset:50176
    v_mfma_f32_16x16x32_bf16 v[220:223], v[20:23], a[252:255], v[220:223]
    buffer_load_dwordx4 v0, s[20:23], m0 offen offset:1024 sc1 lds
    v_mfma_f32_16x16x32_bf16 v[208:211], v[24:27], a[0:3], v[208:211]
    ds_read_b128 v[56:59], v4 offset:51200
    v_mfma_f32_16x16x32_bf16 v[216:219], v[24:27], a[4:7], v[216:219]
    v_mfma_f32_16x16x32_bf16 v[212:215], v[28:31], a[0:3], v[212:215]
    ds_read_b128 v[60:63], v4 offset:52224
    v_mfma_f32_16x16x32_bf16 v[220:223], v[28:31], a[4:7], v[220:223]
    s_waitcnt lgkmcnt(4)
    v_mfma_f32_16x16x32_bf16 v[208:211], v[32:35], a[8:11], v[208:211]
    ds_read_b128 v[16:19], v4 offset:53248
    v_mfma_f32_16x16x32_bf16 v[216:219], v[32:35], a[12:15], v[216:219]
    buffer_load_dwordx4 v0, s[20:23], m0 offen offset:2048 sc1 lds
    v_mfma_f32_16x16x32_bf16 v[212:215], v[36:39], a[8:11], v[212:215]
    ds_read_b128 v[20:23], v4 offset:54272
    v_mfma_f32_16x16x32_bf16 v[220:223], v[36:39], a[12:15], v[220:223]
    buffer_load_dwordx4 v0, s[20:23], m0 offen offset:3072 sc1 lds
    v_mfma_f32_16x16x32_bf16 v[208:211], v[40:43], a[16:19], v[208:211]
    ds_read_b128 v[24:27], v4 offset:55296
    v_mfma_f32_16x16x32_bf16 v[216:219], v[40:43], a[20:23], v[216:219]
    v_mfma_f32_16x16x32_bf16 v[212:215], v[44:47], a[16:19], v[212:215]
    ds_read_b128 v[28:31], v4 offset:56320
    v_mfma_f32_16x16x32_bf16 v[220:223], v[44:47], a[20:23], v[220:223]
    s_waitcnt lgkmcnt(4)
    v_mfma_f32_16x16x32_bf16 v[208:211], v[48:51], v[144:147], v[208:211]
    ds_read_b128 v[32:35], v4 offset:57344
    v_mfma_f32_16x16x32_bf16 v[216:219], v[48:51], v[152:155], v[216:219]
    v_mfma_f32_16x16x32_bf16 v[212:215], v[52:55], v[144:147], v[212:215]
    ds_read_b128 v[36:39], v4 offset:58368
    v_mfma_f32_16x16x32_bf16 v[220:223], v[52:55], v[152:155], v[220:223]
    v_mfma_f32_16x16x32_bf16 v[208:211], v[56:59], a[24:27], v[208:211]
    ds_read_b128 v[40:43], v4 offset:59392
    v_mfma_f32_16x16x32_bf16 v[216:219], v[56:59], a[28:31], v[216:219]
    v_mfma_f32_16x16x32_bf16 v[212:215], v[60:63], a[24:27], v[212:215]
    ds_read_b128 v[44:47], v4 offset:60416
    v_mfma_f32_16x16x32_bf16 v[220:223], v[60:63], a[28:31], v[220:223]
    s_waitcnt lgkmcnt(4)
    v_mfma_f32_16x16x32_bf16 v[208:211], v[16:19], a[32:35], v[208:211]
    ds_read_b128 v[48:51], v4 offset:61440
    v_mfma_f32_16x16x32_bf16 v[216:219], v[16:19], a[36:39], v[216:219]
    v_mfma_f32_16x16x32_bf16 v[212:215], v[20:23], a[32:35], v[212:215]
    ds_read_b128 v[52:55], v4 offset:62464
    v_mfma_f32_16x16x32_bf16 v[220:223], v[20:23], a[36:39], v[220:223]
    v_mfma_f32_16x16x32_bf16 v[208:211], v[24:27], a[40:43], v[208:211]
    ds_read_b128 v[56:59], v4 offset:63488
    v_mfma_f32_16x16x32_bf16 v[216:219], v[24:27], a[44:47], v[216:219]
    v_mfma_f32_16x16x32_bf16 v[212:215], v[28:31], a[40:43], v[212:215]
    ds_read_b128 v[60:63], v4 offset:64512
    v_mfma_f32_16x16x32_bf16 v[220:223], v[28:31], a[44:47], v[220:223]
    s_waitcnt lgkmcnt(4) vmcnt(14)
    s_barrier
    v_mfma_f32_16x16x32_bf16 v[208:211], v[32:35], a[48:51], v[208:211]
    ds_read_b128 v[16:19], v5 offset:0
    v_mfma_f32_16x16x32_bf16 v[216:219], v[32:35], a[52:55], v[216:219]
    v_mfma_f32_16x16x32_bf16 v[212:215], v[36:39], a[48:51], v[212:215]
    ds_read_b128 v[20:23], v5 offset:1024
    v_mfma_f32_16x16x32_bf16 v[220:223], v[36:39], a[52:55], v[220:223]
    v_mfma_f32_16x16x32_bf16 v[208:211], v[40:43], a[56:59], v[208:211]
    ds_read_b128 v[24:27], v5 offset:2048
    v_mfma_f32_16x16x32_bf16 v[216:219], v[40:43], a[60:63], v[216:219]
    v_mfma_f32_16x16x32_bf16 v[212:215], v[44:47], a[56:59], v[212:215]
    ds_read_b128 v[28:31], v5 offset:3072
    v_mfma_f32_16x16x32_bf16 v[220:223], v[44:47], a[60:63], v[220:223]
    s_waitcnt lgkmcnt(4)
    v_mfma_f32_16x16x32_bf16 v[208:211], v[48:51], a[64:67], v[208:211]
    ds_read_b128 v[32:35], v5 offset:4096
    s_add_u32 m0, s57, 32768
    v_mfma_f32_16x16x32_bf16 v[216:219], v[48:51], a[68:71], v[216:219]
    buffer_load_dwordx4 v0, s[20:23], m0 offen offset:0 sc1 lds
    v_mfma_f32_16x16x32_bf16 v[212:215], v[52:55], a[64:67], v[212:215]
    ds_read_b128 v[36:39], v5 offset:5120
    v_mfma_f32_16x16x32_bf16 v[220:223], v[52:55], a[68:71], v[220:223]
    buffer_load_dwordx4 v0, s[20:23], m0 offen offset:1024 sc1 lds
    v_mfma_f32_16x16x32_bf16 v[208:211], v[56:59], a[72:75], v[208:211]
    ds_read_b128 v[40:43], v5 offset:6144
    v_mfma_f32_16x16x32_bf16 v[216:219], v[56:59], a[76:79], v[216:219]
    v_mfma_f32_16x16x32_bf16 v[212:215], v[60:63], a[72:75], v[212:215]
    ds_read_b128 v[44:47], v5 offset:7168
    v_mfma_f32_16x16x32_bf16 v[220:223], v[60:63], a[76:79], v[220:223]
    s_waitcnt lgkmcnt(4)
    v_mfma_f32_16x16x32_bf16 v[192:195], v[16:19], v[160:163], v[192:195]
    ds_read_b128 v[48:51], v5 offset:8192
    v_mfma_f32_16x16x32_bf16 v[200:203], v[16:19], v[168:171], v[200:203]
    v_mfma_f32_16x16x32_bf16 v[196:199], v[20:23], v[160:163], v[196:199]
    ds_read_b128 v[52:55], v5 offset:9216
    v_mfma_f32_16x16x32_bf16 v[204:207], v[20:23], v[168:171], v[204:207]
    v_mfma_f32_16x16x32_bf16 v[192:195], v[24:27], a[80:83], v[192:195]
    ds_read_b128 v[56:59], v5 offset:10240
    v_mfma_f32_16x16x32_bf16 v[200:203], v[24:27], a[84:87], v[200:203]
    v_mfma_f32_16x16x32_bf16 v[196:199], v[28:31], a[80:83], v[196:199]
    ds_read_b128 v[60:63], v5 offset:11264
    v_mfma_f32_16x16x32_bf16 v[204:207], v[28:31], a[84:87], v[204:207]
    s_waitcnt lgkmcnt(4)
    v_mfma_f32_16x16x32_bf16 v[192:195], v[32:35], a[88:91], v[192:195]
    ds_read_b128 v[16:19], v5 offset:12288
    v_mfma_f32_16x16x32_bf16 v[200:203], v[32:35], a[92:95], v[200:203]
    buffer_load_dwordx4 v0, s[20:23], m0 offen offset:2048 sc1 lds
    v_mfma_f32_16x16x32_bf16 v[196:199], v[36:39], a[88:91], v[196:199]
    ds_read_b128 v[20:23], v5 offset:13312
    v_mfma_f32_16x16x32_bf16 v[204:207], v[36:39], a[92:95], v[204:207]
    buffer_load_dwordx4 v0, s[20:23], m0 offen offset:3072 sc1 lds
    v_mfma_f32_16x16x32_bf16 v[192:195], v[40:43], a[96:99], v[192:195]
    ds_read_b128 v[24:27], v5 offset:14336
    v_mfma_f32_16x16x32_bf16 v[200:203], v[40:43], a[100:103], v[200:203]
    v_mfma_f32_16x16x32_bf16 v[196:199], v[44:47], a[96:99], v[196:199]
    ds_read_b128 v[28:31], v5 offset:15360
    v_mfma_f32_16x16x32_bf16 v[204:207], v[44:47], a[100:103], v[204:207]
    s_waitcnt lgkmcnt(4) vmcnt(16)
    v_mfma_f32_16x16x32_bf16 v[192:195], v[48:51], a[104:107], v[192:195]
    ds_read_b128 v[32:35], v5 offset:16384
    s_add_u32 m0, s57, 49152
    v_mfma_f32_16x16x32_bf16 v[200:203], v[48:51], a[108:111], v[200:203]
    buffer_load_dwordx4 v0, s[20:23], m0 offen offset:0 sc1 lds
    v_mfma_f32_16x16x32_bf16 v[196:199], v[52:55], a[104:107], v[196:199]
    ds_read_b128 v[36:39], v5 offset:17408
    v_mfma_f32_16x16x32_bf16 v[204:207], v[52:55], a[108:111], v[204:207]
    buffer_load_dwordx4 v0, s[20:23], m0 offen offset:1024 sc1 lds
    v_mfma_f32_16x16x32_bf16 v[192:195], v[56:59], a[112:115], v[192:195]
    ds_read_b128 v[40:43], v5 offset:18432
    v_mfma_f32_16x16x32_bf16 v[200:203], v[56:59], a[116:119], v[200:203]
    v_mfma_f32_16x16x32_bf16 v[196:199], v[60:63], a[112:115], v[196:199]
    ds_read_b128 v[44:47], v5 offset:19456
    v_mfma_f32_16x16x32_bf16 v[204:207], v[60:63], a[116:119], v[204:207]
    s_waitcnt lgkmcnt(4) vmcnt(12)
    v_mfma_f32_16x16x32_bf16 v[192:195], v[16:19], a[120:123], v[192:195]
    ds_read_b128 v[48:51], v5 offset:20480
    v_mfma_f32_16x16x32_bf16 v[200:203], v[16:19], a[124:127], v[200:203]
    buffer_load_dwordx4 v0, s[20:23], m0 offen offset:2048 sc1 lds
    v_mfma_f32_16x16x32_bf16 v[196:199], v[20:23], a[120:123], v[196:199]
    ds_read_b128 v[52:55], v5 offset:21504
    v_mfma_f32_16x16x32_bf16 v[204:207], v[20:23], a[124:127], v[204:207]
    buffer_load_dwordx4 v0, s[20:23], m0 offen offset:3072 sc1 lds
    v_mfma_f32_16x16x32_bf16 v[192:195], v[24:27], a[128:131], v[192:195]
    ds_read_b128 v[56:59], v5 offset:22528
    v_mfma_f32_16x16x32_bf16 v[200:203], v[24:27], a[132:135], v[200:203]
    v_mfma_f32_16x16x32_bf16 v[196:199], v[28:31], a[128:131], v[196:199]
    ds_read_b128 v[60:63], v5 offset:23552
    v_mfma_f32_16x16x32_bf16 v[204:207], v[28:31], a[132:135], v[204:207]
    s_waitcnt lgkmcnt(4)
    v_mfma_f32_16x16x32_bf16 v[208:211], v[32:35], v[160:163], v[208:211]
    ds_read_b128 v[16:19], v5 offset:24576
    v_mfma_f32_16x16x32_bf16 v[216:219], v[32:35], v[168:171], v[216:219]
    v_mfma_f32_16x16x32_bf16 v[212:215], v[36:39], v[160:163], v[212:215]
    ds_read_b128 v[20:23], v5 offset:25600
    v_mfma_f32_16x16x32_bf16 v[220:223], v[36:39], v[168:171], v[220:223]
    v_mfma_f32_16x16x32_bf16 v[208:211], v[40:43], a[80:83], v[208:211]
    ds_read_b128 v[24:27], v5 offset:26624
    v_mfma_f32_16x16x32_bf16 v[216:219], v[40:43], a[84:87], v[216:219]
    v_mfma_f32_16x16x32_bf16 v[212:215], v[44:47], a[80:83], v[212:215]
    ds_read_b128 v[28:31], v5 offset:27648
    v_mfma_f32_16x16x32_bf16 v[220:223], v[44:47], a[84:87], v[220:223]
    s_waitcnt lgkmcnt(4)
    v_mfma_f32_16x16x32_bf16 v[208:211], v[48:51], a[88:91], v[208:211]
    ds_read_b128 v[32:35], v5 offset:28672
    v_cvt_pk_bf16_f32 v192, v192, v193
    v_mfma_f32_16x16x32_bf16 v[216:219], v[48:51], a[92:95], v[216:219]
    v_cvt_pk_bf16_f32 v193, v194, v195
    v_cvt_pk_bf16_f32 v194, v196, v197
    v_mfma_f32_16x16x32_bf16 v[212:215], v[52:55], a[88:91], v[212:215]
    ds_read_b128 v[36:39], v5 offset:29696
    v_cvt_pk_bf16_f32 v195, v198, v199
    v_mfma_f32_16x16x32_bf16 v[220:223], v[52:55], a[92:95], v[220:223]
    v_cvt_pk_bf16_f32 v200, v200, v201
    v_cvt_pk_bf16_f32 v201, v202, v203
    v_mfma_f32_16x16x32_bf16 v[208:211], v[56:59], a[96:99], v[208:211]
    ds_read_b128 v[40:43], v5 offset:30720
    v_cvt_pk_bf16_f32 v202, v204, v205
    v_mfma_f32_16x16x32_bf16 v[216:219], v[56:59], a[100:103], v[216:219]
    buffer_store_dwordx4 v[192:195], v3, s[20:23], s68 offen offset:0 sc1
    v_mfma_f32_16x16x32_bf16 v[212:215], v[60:63], a[96:99], v[212:215]
    ds_read_b128 v[44:47], v5 offset:31744
    v_cvt_pk_bf16_f32 v203, v206, v207
    v_mfma_f32_16x16x32_bf16 v[220:223], v[60:63], a[100:103], v[220:223]
    s_waitcnt lgkmcnt(4) vmcnt(9)
    s_barrier
    v_mfma_f32_16x16x32_bf16 v[208:211], v[16:19], a[104:107], v[208:211]
    ds_read_b128 v[48:51], v3 offset:0
    v_mfma_f32_16x16x32_bf16 v[216:219], v[16:19], a[108:111], v[216:219]
    buffer_store_dwordx4 v[200:203], v3, s[20:23], s68 offen offset:1024 sc1
    v_mfma_f32_16x16x32_bf16 v[212:215], v[20:23], a[104:107], v[212:215]
    ds_read_b128 v[52:55], v3 offset:1024
    v_mfma_f32_16x16x32_bf16 v[220:223], v[20:23], a[108:111], v[220:223]
    v_mfma_f32_16x16x32_bf16 v[208:211], v[24:27], a[112:115], v[208:211]
    ds_read_b128 v[56:59], v3 offset:2048
    v_mfma_f32_16x16x32_bf16 v[216:219], v[24:27], a[116:119], v[216:219]
    v_mfma_f32_16x16x32_bf16 v[212:215], v[28:31], a[112:115], v[212:215]
    ds_read_b128 v[60:63], v3 offset:3072
    v_mfma_f32_16x16x32_bf16 v[220:223], v[28:31], a[116:119], v[220:223]
    s_waitcnt lgkmcnt(4)
    v_mfma_f32_16x16x32_bf16 v[208:211], v[32:35], a[120:123], v[208:211]
    ds_read_b128 v[16:19], v3 offset:4096
    s_add_u32 m0, s57, 65536
    v_mfma_f32_16x16x32_bf16 v[216:219], v[32:35], a[124:127], v[216:219]
    buffer_load_dwordx4 v0, s[20:23], m0 offen offset:0 sc1 lds
    v_mfma_f32_16x16x32_bf16 v[212:215], v[36:39], a[120:123], v[212:215]
    ds_read_b128 v[20:23], v3 offset:5120
    v_mfma_f32_16x16x32_bf16 v[220:223], v[36:39], a[124:127], v[220:223]
    buffer_load_dwordx4 v0, s[20:23], m0 offen offset:1024 sc1 lds
    v_mfma_f32_16x16x32_bf16 v[208:211], v[40:43], a[128:131], v[208:211]
    ds_read_b128 v[24:27], v3 offset:6144
    v_mfma_f32_16x16x32_bf16 v[216:219], v[40:43], a[132:135], v[216:219]
    v_mfma_f32_16x16x32_bf16 v[212:215], v[44:47], a[128:131], v[212:215]
    ds_read_b128 v[28:31], v3 offset:7168
    v_mfma_f32_16x16x32_bf16 v[220:223], v[44:47], a[132:135], v[220:223]
    s_waitcnt lgkmcnt(4)
    v_mfma_f32_16x16x32_bf16 v[224:227], v[48:51], v[128:131], v[224:227]
    ds_read_b128 v[32:35], v3 offset:8192
    v_mfma_f32_16x16x32_bf16 v[232:235], v[48:51], v[136:139], v[232:235]
    v_mfma_f32_16x16x32_bf16 v[228:231], v[52:55], v[128:131], v[228:231]
    ds_read_b128 v[36:39], v3 offset:9216
    v_mfma_f32_16x16x32_bf16 v[236:239], v[52:55], v[136:139], v[236:239]
    v_mfma_f32_16x16x32_bf16 v[224:227], v[56:59], a[224:227], v[224:227]
    ds_read_b128 v[40:43], v3 offset:10240
    v_mfma_f32_16x16x32_bf16 v[232:235], v[56:59], a[228:231], v[232:235]
    v_mfma_f32_16x16x32_bf16 v[228:231], v[60:63], a[224:227], v[228:231]
    ds_read_b128 v[44:47], v3 offset:11264
    v_mfma_f32_16x16x32_bf16 v[236:239], v[60:63], a[228:231], v[236:239]
    s_waitcnt lgkmcnt(4)
    v_mfma_f32_16x16x32_bf16 v[224:227], v[16:19], a[232:235], v[224:227]
    ds_read_b128 v[48:51], v3 offset:12288
    v_cvt_pk_bf16_f32 v208, v208, v209
    v_mfma_f32_16x16x32_bf16 v[232:235], v[16:19], a[236:239], v[232:235]
    buffer_load_dwordx4 v0, s[20:23], m0 offen offset:2048 sc1 lds
    v_mfma_f32_16x16x32_bf16 v[228:231], v[20:23], a[232:235], v[228:231]
    ds_read_b128 v[52:55], v3 offset:13312
    v_cvt_pk_bf16_f32 v209, v210, v211
    v_mfma_f32_16x16x32_bf16 v[236:239], v[20:23], a[236:239], v[236:239]
    v_cvt_pk_bf16_f32 v210, v212, v213
    v_cvt_pk_bf16_f32 v211, v214, v215
    v_mfma_f32_16x16x32_bf16 v[224:227], v[24:27], a[240:243], v[224:227]
    ds_read_b128 v[56:59], v3 offset:14336
    v_cvt_pk_bf16_f32 v216, v216, v217
    v_mfma_f32_16x16x32_bf16 v[232:235], v[24:27], a[244:247], v[232:235]
    buffer_load_dwordx4 v0, s[20:23], m0 offen offset:3072 sc1 lds
    v_mfma_f32_16x16x32_bf16 v[228:231], v[28:31], a[240:243], v[228:231]
    ds_read_b128 v[60:63], v3 offset:15360
    v_cvt_pk_bf16_f32 v217, v218, v219
    v_mfma_f32_16x16x32_bf16 v[236:239], v[28:31], a[244:247], v[236:239]
    s_waitcnt lgkmcnt(4)
    v_cvt_pk_bf16_f32 v218, v220, v221
    v_cvt_pk_bf16_f32 v219, v222, v223
    v_mfma_f32_16x16x32_bf16 v[224:227], v[32:35], a[248:251], v[224:227]
    ds_read_b128 v[16:19], v3 offset:16384
    v_mfma_f32_16x16x32_bf16 v[232:235], v[32:35], a[252:255], v[232:235]
    buffer_store_dwordx4 v[208:211], v3, s[20:23], s68 offen offset:2048 sc1
    v_mfma_f32_16x16x32_bf16 v[228:231], v[36:39], a[248:251], v[228:231]
    ds_read_b128 v[20:23], v3 offset:17408
    s_add_u32 m0, s57, 81920
    v_mfma_f32_16x16x32_bf16 v[236:239], v[36:39], a[252:255], v[236:239]
    buffer_load_dwordx4 v0, s[20:23], m0 offen offset:0 sc1 lds
    v_mfma_f32_16x16x32_bf16 v[224:227], v[40:43], a[0:3], v[224:227]
main_kernel_stub15:
    s_cbranch_execz main_kernel_ret
    ds_read_b128 v[24:27], v3 offset:18432
    v_mfma_f32_16x16x32_bf16 v[232:235], v[40:43], a[4:7], v[232:235]
    buffer_load_dwordx4 v0, s[20:23], m0 offen offset:1024 sc1 lds
    v_mfma_f32_16x16x32_bf16 v[228:231], v[44:47], a[0:3], v[228:231]
    ds_read_b128 v[28:31], v3 offset:19456
    v_mfma_f32_16x16x32_bf16 v[236:239], v[44:47], a[4:7], v[236:239]
    s_waitcnt lgkmcnt(4)
    v_mfma_f32_16x16x32_bf16 v[224:227], v[48:51], a[8:11], v[224:227]
    ds_read_b128 v[32:35], v3 offset:20480
    v_mfma_f32_16x16x32_bf16 v[232:235], v[48:51], a[12:15], v[232:235]
    buffer_store_dwordx4 v[216:219], v3, s[20:23], s68 offen offset:3072 sc1
    v_mfma_f32_16x16x32_bf16 v[228:231], v[52:55], a[8:11], v[228:231]
    ds_read_b128 v[36:39], v3 offset:21504
    v_mfma_f32_16x16x32_bf16 v[236:239], v[52:55], a[12:15], v[236:239]
    buffer_load_dwordx4 v0, s[20:23], m0 offen offset:2048 sc1 lds
    v_mfma_f32_16x16x32_bf16 v[224:227], v[56:59], a[16:19], v[224:227]
    ds_read_b128 v[40:43], v3 offset:22528
    v_mfma_f32_16x16x32_bf16 v[232:235], v[56:59], a[20:23], v[232:235]
    buffer_load_dwordx4 v0, s[20:23], m0 offen offset:3072 sc1 lds
    v_mfma_f32_16x16x32_bf16 v[228:231], v[60:63], a[16:19], v[228:231]
    ds_read_b128 v[44:47], v3 offset:23552
    v_mfma_f32_16x16x32_bf16 v[236:239], v[60:63], a[20:23], v[236:239]
    s_waitcnt lgkmcnt(4)
    v_mfma_f32_16x16x32_bf16 v[224:227], v[16:19], v[144:147], v[224:227]
    ds_read_b128 v[48:51], v3 offset:24576
    v_mfma_f32_16x16x32_bf16 v[232:235], v[16:19], v[152:155], v[232:235]
    v_mfma_f32_16x16x32_bf16 v[228:231], v[20:23], v[144:147], v[228:231]
    ds_read_b128 v[52:55], v3 offset:25600
    v_mfma_f32_16x16x32_bf16 v[236:239], v[20:23], v[152:155], v[236:239]
    v_mfma_f32_16x16x32_bf16 v[224:227], v[24:27], a[24:27], v[224:227]
    ds_read_b128 v[56:59], v3 offset:26624
    v_mfma_f32_16x16x32_bf16 v[232:235], v[24:27], a[28:31], v[232:235]
    v_mfma_f32_16x16x32_bf16 v[228:231], v[28:31], a[24:27], v[228:231]
    ds_read_b128 v[60:63], v3 offset:27648
    v_mfma_f32_16x16x32_bf16 v[236:239], v[28:31], a[28:31], v[236:239]
    s_waitcnt lgkmcnt(4)
    v_mfma_f32_16x16x32_bf16 v[224:227], v[32:35], a[32:35], v[224:227]
    ds_read_b128 v[16:19], v3 offset:28672
    v_mfma_f32_16x16x32_bf16 v[232:235], v[32:35], a[36:39], v[232:235]
    buffer_load_dwordx4 v[132:135], v3, s[20:23], s51 offen offset:0 sc1
    v_mfma_f32_16x16x32_bf16 v[228:231], v[36:39], a[32:35], v[228:231]
    ds_read_b128 v[20:23], v3 offset:29696
    v_mfma_f32_16x16x32_bf16 v[236:239], v[36:39], a[36:39], v[236:239]
    buffer_load_dwordx4 v[140:143], v3, s[20:23], s51 offen offset:1024 sc1
    v_mfma_f32_16x16x32_bf16 v[224:227], v[40:43], a[40:43], v[224:227]
    ds_read_b128 v[24:27], v3 offset:30720
    v_mfma_f32_16x16x32_bf16 v[232:235], v[40:43], a[44:47], v[232:235]
    v_mfma_f32_16x16x32_bf16 v[228:231], v[44:47], a[40:43], v[228:231]
    ds_read_b128 v[28:31], v3 offset:31744
    v_mfma_f32_16x16x32_bf16 v[236:239], v[44:47], a[44:47], v[236:239]
    s_waitcnt lgkmcnt(4) vmcnt(14)
    s_barrier
    v_mfma_f32_16x16x32_bf16 v[224:227], v[48:51], a[48:51], v[224:227]
    ds_read_b128 v[32:35], v3 offset:32768
    v_mfma_f32_16x16x32_bf16 v[232:235], v[48:51], a[52:55], v[232:235]
    v_mfma_f32_16x16x32_bf16 v[228:231], v[52:55], a[48:51], v[228:231]
    ds_read_b128 v[36:39], v3 offset:33792
    v_mfma_f32_16x16x32_bf16 v[236:239], v[52:55], a[52:55], v[236:239]
    v_mfma_f32_16x16x32_bf16 v[224:227], v[56:59], a[56:59], v[224:227]
    ds_read_b128 v[40:43], v3 offset:34816
    v_mfma_f32_16x16x32_bf16 v[232:235], v[56:59], a[60:63], v[232:235]
    v_mfma_f32_16x16x32_bf16 v[228:231], v[60:63], a[56:59], v[228:231]
    ds_read_b128 v[44:47], v3 offset:35840
    v_mfma_f32_16x16x32_bf16 v[236:239], v[60:63], a[60:63], v[236:239]
    s_waitcnt lgkmcnt(4)
    v_mfma_f32_16x16x32_bf16 v[224:227], v[16:19], a[64:67], v[224:227]
    ds_read_b128 v[48:51], v3 offset:36864
    v_mfma_f32_16x16x32_bf16 v[232:235], v[16:19], a[68:71], v[232:235]
    v_mfma_f32_16x16x32_bf16 v[228:231], v[20:23], a[64:67], v[228:231]
    ds_read_b128 v[52:55], v3 offset:37888
    v_mfma_f32_16x16x32_bf16 v[236:239], v[20:23], a[68:71], v[236:239]
    v_mfma_f32_16x16x32_bf16 v[224:227], v[24:27], a[72:75], v[224:227]
    ds_read_b128 v[56:59], v3 offset:38912
    v_mfma_f32_16x16x32_bf16 v[232:235], v[24:27], a[76:79], v[232:235]
    v_mfma_f32_16x16x32_bf16 v[228:231], v[28:31], a[72:75], v[228:231]
    ds_read_b128 v[60:63], v3 offset:39936
    v_mfma_f32_16x16x32_bf16 v[236:239], v[28:31], a[76:79], v[236:239]
    s_waitcnt lgkmcnt(4)
    v_mfma_f32_16x16x32_bf16 v[224:227], v[32:35], v[160:163], v[224:227]
    ds_read_b128 v[16:19], v3 offset:40960
    v_mfma_f32_16x16x32_bf16 v[232:235], v[32:35], v[168:171], v[232:235]
    v_mfma_f32_16x16x32_bf16 v[228:231], v[36:39], v[160:163], v[228:231]
    ds_read_b128 v[20:23], v3 offset:41984
    v_mfma_f32_16x16x32_bf16 v[236:239], v[36:39], v[168:171], v[236:239]
    v_mfma_f32_16x16x32_bf16 v[224:227], v[40:43], a[80:83], v[224:227]
    ds_read_b128 v[24:27], v3 offset:43008
    v_mfma_f32_16x16x32_bf16 v[232:235], v[40:43], a[84:87], v[232:235]
    v_mfma_f32_16x16x32_bf16 v[228:231], v[44:47], a[80:83], v[228:231]
    ds_read_b128 v[28:31], v3 offset:44032
    v_mfma_f32_16x16x32_bf16 v[236:239], v[44:47], a[84:87], v[236:239]
    s_waitcnt lgkmcnt(4)
    v_mfma_f32_16x16x32_bf16 v[224:227], v[48:51], a[88:91], v[224:227]
    ds_read_b128 v[32:35], v3 offset:45056
    v_mfma_f32_16x16x32_bf16 v[232:235], v[48:51], a[92:95], v[232:235]
    v_mfma_f32_16x16x32_bf16 v[228:231], v[52:55], a[88:91], v[228:231]
    ds_read_b128 v[36:39], v3 offset:46080
    v_mfma_f32_16x16x32_bf16 v[236:239], v[52:55], a[92:95], v[236:239]
    v_mfma_f32_16x16x32_bf16 v[224:227], v[56:59], a[96:99], v[224:227]
    ds_read_b128 v[40:43], v3 offset:47104
    v_mfma_f32_16x16x32_bf16 v[232:235], v[56:59], a[100:103], v[232:235]
    v_mfma_f32_16x16x32_bf16 v[228:231], v[60:63], a[96:99], v[228:231]
    ds_read_b128 v[44:47], v3 offset:48128
    v_mfma_f32_16x16x32_bf16 v[236:239], v[60:63], a[100:103], v[236:239]
    s_waitcnt lgkmcnt(4)
    v_mfma_f32_16x16x32_bf16 v[224:227], v[16:19], a[104:107], v[224:227]
    ds_read_b128 v[48:51], v3 offset:49152
    v_mfma_f32_16x16x32_bf16 v[232:235], v[16:19], a[108:111], v[232:235]
    v_mfma_f32_16x16x32_bf16 v[228:231], v[20:23], a[104:107], v[228:231]
    ds_read_b128 v[52:55], v3 offset:50176
    v_mfma_f32_16x16x32_bf16 v[236:239], v[20:23], a[108:111], v[236:239]
    v_mfma_f32_16x16x32_bf16 v[224:227], v[24:27], a[112:115], v[224:227]
    ds_read_b128 v[56:59], v3 offset:51200
    v_mfma_f32_16x16x32_bf16 v[232:235], v[24:27], a[116:119], v[232:235]
    v_mfma_f32_16x16x32_bf16 v[228:231], v[28:31], a[112:115], v[228:231]
    ds_read_b128 v[60:63], v3 offset:52224
    v_mfma_f32_16x16x32_bf16 v[236:239], v[28:31], a[116:119], v[236:239]
    s_waitcnt lgkmcnt(4) vmcnt(0)
    v_max3_u32 v9, v132, v133, v134
    v_max3_u32 v9, v9, v135, v140
    v_mfma_f32_16x16x32_bf16 v[224:227], v[32:35], a[120:123], v[224:227]
    ds_read_b128 v[16:19], v3 offset:53248
    v_max3_u32 v9, v9, v141, v142
    v_mfma_f32_16x16x32_bf16 v[232:235], v[32:35], a[124:127], v[232:235]
    v_max_u32 v9, v9, v143
    v_cmp_eq_u32 vcc, -1, v9
    v_mfma_f32_16x16x32_bf16 v[228:231], v[36:39], a[120:123], v[228:231]
    ds_read_b128 v[20:23], v3 offset:54272
    s_cbranch_vccnz main_kernel_slowrc0
main_kernel_backrc0:
    v_mfma_f32_16x16x32_bf16 v[236:239], v[36:39], a[124:127], v[236:239]
    v_mfma_f32_16x16x32_bf16 v[224:227], v[40:43], a[128:131], v[224:227]
    ds_read_b128 v[24:27], v3 offset:55296
    v_mfma_f32_16x16x32_bf16 v[232:235], v[40:43], a[132:135], v[232:235]
    v_mfma_f32_16x16x32_bf16 v[228:231], v[44:47], a[128:131], v[228:231]
    ds_read_b128 v[28:31], v3 offset:56320
    v_mfma_f32_16x16x32_bf16 v[236:239], v[44:47], a[132:135], v[236:239]
    s_waitcnt lgkmcnt(4)
    v_mfma_f32_16x16x32_bf16 v[224:227], v[184:187], v[132:135], v[224:227]
    v_mfma_f32_16x16x32_bf16 v[228:231], v[186:189], v[132:135], v[228:231]
    v_mfma_f32_16x16x32_bf16 v[232:235], v[184:187], v[140:143], v[232:235]
    v_mfma_f32_16x16x32_bf16 v[236:239], v[186:189], v[140:143], v[236:239]
    v_mfma_f32_16x16x32_bf16 v[240:243], v[48:51], v[128:131], v[240:243]
    ds_read_b128 v[32:35], v3 offset:57344
    v_mfma_f32_16x16x32_bf16 v[248:251], v[48:51], v[136:139], v[248:251]
    s_mul_i32 s31, s10, 10240
    s_add_u32 s17, s31, s17
    v_mfma_f32_16x16x32_bf16 v[244:247], v[52:55], v[128:131], v[244:247]
    ds_read_b128 v[36:39], v3 offset:58368
    s_add_u32 m0, s31, 98304
    v_mfma_f32_16x16x32_bf16 v[252:255], v[52:55], v[136:139], v[252:255]
    s_add_u32 s28, s17, 0
    v_mfma_f32_16x16x32_bf16 v[240:243], v[56:59], a[224:227], v[240:243]
    ds_read_b128 v[40:43], v3 offset:59392
    v_mfma_f32_16x16x32_bf16 v[248:251], v[56:59], a[228:231], v[248:251]
    buffer_load_dwordx4 v3, s[60:63], s28 offen offset:0 lds
    v_mfma_f32_16x16x32_bf16 v[244:247], v[60:63], a[224:227], v[244:247]
    ds_read_b128 v[44:47], v3 offset:60416
    v_mfma_f32_16x16x32_bf16 v[252:255], v[60:63], a[228:231], v[252:255]
    s_waitcnt lgkmcnt(4)
    v_mfma_f32_16x16x32_bf16 v[240:243], v[16:19], a[232:235], v[240:243]
    ds_read_b128 v[48:51], v3 offset:61440
    v_cvt_pk_bf16_f32 v192, v224, v225
    v_mfma_f32_16x16x32_bf16 v[248:251], v[16:19], a[236:239], v[248:251]
    buffer_load_dwordx4 v3, s[60:63], s28 offen offset:1024 lds
    v_mfma_f32_16x16x32_bf16 v[244:247], v[20:23], a[232:235], v[244:247]
    ds_read_b128 v[52:55], v3 offset:62464
    v_cvt_pk_bf16_f32 v193, v226, v227
    v_mfma_f32_16x16x32_bf16 v[252:255], v[20:23], a[236:239], v[252:255]
    buffer_load_dwordx4 v3, s[60:63], s28 offen offset:2048 lds
    v_mfma_f32_16x16x32_bf16 v[240:243], v[24:27], a[240:243], v[240:243]
    ds_read_b128 v[56:59], v3 offset:63488
    v_cvt_pk_bf16_f32 v194, v228, v229
    v_mfma_f32_16x16x32_bf16 v[248:251], v[24:27], a[244:247], v[248:251]
    buffer_load_dwordx4 v3, s[60:63], s28 offen offset:3072 lds
    v_mfma_f32_16x16x32_bf16 v[244:247], v[28:31], a[240:243], v[244:247]
    ds_read_b128 v[60:63], v3 offset:64512
    s_add_u32 m0, s31, 102400
    v_mfma_f32_16x16x32_bf16 v[252:255], v[28:31], a[244:247], v[252:255]
    s_waitcnt lgkmcnt(4)
    s_barrier
    v_mfma_f32_16x16x32_bf16 v[240:243], v[32:35], a[248:251], v[240:243]
    ds_read_b128 v[16:19], v4 offset:0
    s_add_u32 s29, s17, 4096
    v_mfma_f32_16x16x32_bf16 v[248:251], v[32:35], a[252:255], v[248:251]
    buffer_load_dwordx4 v3, s[60:63], s29 offen offset:0 lds
    v_mfma_f32_16x16x32_bf16 v[244:247], v[36:39], a[248:251], v[244:247]
    ds_read_b128 v[20:23], v4 offset:1024
    v_cvt_pk_bf16_f32 v195, v230, v231
    v_mfma_f32_16x16x32_bf16 v[252:255], v[36:39], a[252:255], v[252:255]
    buffer_load_dwordx4 v3, s[60:63], s29 offen offset:1024 lds
    v_mfma_f32_16x16x32_bf16 v[240:243], v[40:43], a[0:3], v[240:243]
    ds_read_b128 v[24:27], v4 offset:2048
    v_cvt_pk_bf16_f32 v196, v232, v233
    v_mfma_f32_16x16x32_bf16 v[248:251], v[40:43], a[4:7], v[248:251]
    buffer_load_dwordx4 v3, s[60:63], s29 offen offset:2048 lds
    v_mfma_f32_16x16x32_bf16 v[244:247], v[44:47], a[0:3], v[244:247]
    ds_read_b128 v[28:31], v4 offset:3072
    v_cvt_pk_bf16_f32 v197, v234, v235
    v_mfma_f32_16x16x32_bf16 v[252:255], v[44:47], a[4:7], v[252:255]
    s_waitcnt lgkmcnt(4)
    s_mov_b64 exec, s[66:67]
    v_swap_b32 v194, v196
    v_swap_b32 v195, v197
    s_mov_b64 exec, -1
    v_mfma_f32_16x16x32_bf16 v[240:243], v[48:51], a[8:11], v[240:243]
    ds_read_b128 v[32:35], v4 offset:4096
    v_cvt_pk_bf16_f32 v198, v236, v237
    v_mfma_f32_16x16x32_bf16 v[248:251], v[48:51], a[12:15], v[248:251]
    buffer_load_dwordx4 v3, s[60:63], s29 offen offset:3072 lds
    v_mfma_f32_16x16x32_bf16 v[244:247], v[52:55], a[8:11], v[244:247]
    ds_read_b128 v[36:39], v4 offset:5120
    s_add_u32 m0, s31, 106496
    v_mfma_f32_16x16x32_bf16 v[252:255], v[52:55], a[12:15], v[252:255]
    s_add_u32 s30, s17, 8192
    v_cvt_pk_bf16_f32 v199, v238, v239
    v_and_b32 v192, -2, v192
    v_mfma_f32_16x16x32_bf16 v[240:243], v[56:59], a[16:19], v[240:243]
    ds_read_b128 v[40:43], v4 offset:6144
    v_and_b32 v196, -2, v196
    v_mfma_f32_16x16x32_bf16 v[248:251], v[56:59], a[20:23], v[248:251]
    buffer_load_dwordx4 v3, s[60:63], s30 offen offset:0 lds
    v_mfma_f32_16x16x32_bf16 v[244:247], v[60:63], a[16:19], v[244:247]
    ds_read_b128 v[44:47], v4 offset:7168
    v_mul_f32 v182, v224, v181
    v_mfma_f32_16x16x32_bf16 v[252:255], v[60:63], a[20:23], v[252:255]
    s_waitcnt lgkmcnt(4)
    v_mul_f32 v182, v182, v224
    v_mul_f32 v183, v232, v181
    v_mfma_f32_16x16x32_bf16 v[240:243], v[16:19], v[144:147], v[240:243]
    ds_read_b128 v[48:51], v4 offset:8192
    v_mul_f32 v183, v183, v232
    v_mfma_f32_16x16x32_bf16 v[248:251], v[16:19], v[152:155], v[248:251]
    buffer_load_dwordx4 v3, s[60:63], s30 offen offset:1024 lds
    v_mfma_f32_16x16x32_bf16 v[244:247], v[20:23], v[144:147], v[244:247]
    ds_read_b128 v[52:55], v4 offset:9216
    v_fmac_f32 v182, v225, v225
    v_mfma_f32_16x16x32_bf16 v[252:255], v[20:23], v[152:155], v[252:255]
    buffer_load_dwordx4 v[148:151], v3, s[20:23], s51 offen offset:2048 sc1
    v_mfma_f32_16x16x32_bf16 v[240:243], v[24:27], a[24:27], v[240:243]
    ds_read_b128 v[56:59], v4 offset:10240
    v_fmac_f32 v183, v233, v233
    v_mfma_f32_16x16x32_bf16 v[248:251], v[24:27], a[28:31], v[248:251]
    buffer_load_dwordx4 v[156:159], v3, s[20:23], s51 offen offset:3072 sc1
    v_mfma_f32_16x16x32_bf16 v[244:247], v[28:31], a[24:27], v[244:247]
    ds_read_b128 v[60:63], v4 offset:11264
    s_add_u32 s53, s52, 0
    v_mfma_f32_16x16x32_bf16 v[252:255], v[28:31], a[28:31], v[252:255]
    s_waitcnt lgkmcnt(4)
    v_fmac_f32 v182, v226, v226
    v_fmac_f32 v183, v234, v234
    v_mfma_f32_16x16x32_bf16 v[240:243], v[32:35], a[32:35], v[240:243]
    ds_read_b128 v[16:19], v4 offset:12288
    v_fmac_f32 v182, v227, v227
    v_mfma_f32_16x16x32_bf16 v[248:251], v[32:35], a[36:39], v[248:251]
    buffer_store_dwordx4 v[192:195], v3, s[20:23], s53 offen offset:0 sc1
    v_mfma_f32_16x16x32_bf16 v[244:247], v[36:39], a[32:35], v[244:247]
    ds_read_b128 v[20:23], v4 offset:13312
    v_fmac_f32 v183, v235, v235
    v_mfma_f32_16x16x32_bf16 v[252:255], v[36:39], a[36:39], v[252:255]
    v_fmac_f32 v182, v228, v228
    v_fmac_f32 v183, v236, v236
    v_mfma_f32_16x16x32_bf16 v[240:243], v[40:43], a[40:43], v[240:243]
    ds_read_b128 v[24:27], v4 offset:14336
    v_fmac_f32 v182, v229, v229
    v_mfma_f32_16x16x32_bf16 v[248:251], v[40:43], a[44:47], v[248:251]
    buffer_store_dwordx4 v[196:199], v3, s[20:23], s53 offen offset:1024 sc1
    v_mfma_f32_16x16x32_bf16 v[244:247], v[44:47], a[40:43], v[244:247]
    ds_read_b128 v[28:31], v4 offset:15360
    v_fmac_f32 v183, v237, v237
    v_mfma_f32_16x16x32_bf16 v[252:255], v[44:47], a[44:47], v[252:255]
    s_waitcnt lgkmcnt(4)
    v_fmac_f32 v182, v230, v230
    v_fmac_f32 v183, v238, v238
    v_mfma_f32_16x16x32_bf16 v[240:243], v[48:51], a[48:51], v[240:243]
    ds_read_b128 v[32:35], v4 offset:16384
    v_fmac_f32 v182, v231, v231
    v_mfma_f32_16x16x32_bf16 v[248:251], v[48:51], a[52:55], v[248:251]
    v_fmac_f32 v183, v239, v239
    v_mfma_f32_16x16x32_bf16 v[244:247], v[52:55], a[48:51], v[244:247]
    ds_read_b128 v[36:39], v4 offset:17408
    v_mfma_f32_16x16x32_bf16 v[252:255], v[52:55], a[52:55], v[252:255]
    v_mfma_f32_16x16x32_bf16 v[240:243], v[56:59], a[56:59], v[240:243]
    ds_read_b128 v[40:43], v4 offset:18432
    v_mfma_f32_16x16x32_bf16 v[248:251], v[56:59], a[60:63], v[248:251]
    v_mfma_f32_16x16x32_bf16 v[244:247], v[60:63], a[56:59], v[244:247]
    ds_read_b128 v[44:47], v4 offset:19456
    v_mfma_f32_16x16x32_bf16 v[252:255], v[60:63], a[60:63], v[252:255]
    s_waitcnt lgkmcnt(4)
    v_mfma_f32_16x16x32_bf16 v[240:243], v[16:19], a[64:67], v[240:243]
    ds_read_b128 v[48:51], v4 offset:20480
    v_mfma_f32_16x16x32_bf16 v[248:251], v[16:19], a[68:71], v[248:251]
    v_mfma_f32_16x16x32_bf16 v[244:247], v[20:23], a[64:67], v[244:247]
    ds_read_b128 v[52:55], v4 offset:21504
    v_mfma_f32_16x16x32_bf16 v[252:255], v[20:23], a[68:71], v[252:255]
    v_mfma_f32_16x16x32_bf16 v[240:243], v[24:27], a[72:75], v[240:243]
    ds_read_b128 v[56:59], v4 offset:22528
    v_mfma_f32_16x16x32_bf16 v[248:251], v[24:27], a[76:79], v[248:251]
    v_mfma_f32_16x16x32_bf16 v[244:247], v[28:31], a[72:75], v[244:247]
    ds_read_b128 v[60:63], v4 offset:23552
    v_mfma_f32_16x16x32_bf16 v[252:255], v[28:31], a[76:79], v[252:255]
    s_waitcnt lgkmcnt(4)
    v_mfma_f32_16x16x32_bf16 v[240:243], v[32:35], v[160:163], v[240:243]
    ds_read_b128 v[16:19], v4 offset:24576
    v_mfma_f32_16x16x32_bf16 v[248:251], v[32:35], v[168:171], v[248:251]
    v_mfma_f32_16x16x32_bf16 v[244:247], v[36:39], v[160:163], v[244:247]
    ds_read_b128 v[20:23], v4 offset:25600
    v_mfma_f32_16x16x32_bf16 v[252:255], v[36:39], v[168:171], v[252:255]
    v_mfma_f32_16x16x32_bf16 v[240:243], v[40:43], a[80:83], v[240:243]
    ds_read_b128 v[24:27], v4 offset:26624
    v_mfma_f32_16x16x32_bf16 v[248:251], v[40:43], a[84:87], v[248:251]
    v_mfma_f32_16x16x32_bf16 v[244:247], v[44:47], a[80:83], v[244:247]
    ds_read_b128 v[28:31], v4 offset:27648
    v_mfma_f32_16x16x32_bf16 v[252:255], v[44:47], a[84:87], v[252:255]
    s_waitcnt lgkmcnt(4)
    v_mfma_f32_16x16x32_bf16 v[240:243], v[48:51], a[88:91], v[240:243]
    ds_read_b128 v[32:35], v4 offset:28672
    v_mfma_f32_16x16x32_bf16 v[248:251], v[48:51], a[92:95], v[248:251]
    v_mfma_f32_16x16x32_bf16 v[244:247], v[52:55], a[88:91], v[244:247]
    ds_read_b128 v[36:39], v4 offset:29696
    v_mfma_f32_16x16x32_bf16 v[252:255], v[52:55], a[92:95], v[252:255]
    v_mfma_f32_16x16x32_bf16 v[240:243], v[56:59], a[96:99], v[240:243]
    ds_read_b128 v[40:43], v4 offset:30720
    v_mfma_f32_16x16x32_bf16 v[248:251], v[56:59], a[100:103], v[248:251]
    v_mfma_f32_16x16x32_bf16 v[244:247], v[60:63], a[96:99], v[244:247]
    ds_read_b128 v[44:47], v4 offset:31744
    v_mfma_f32_16x16x32_bf16 v[252:255], v[60:63], a[100:103], v[252:255]
    s_waitcnt lgkmcnt(4)
    v_mfma_f32_16x16x32_bf16 v[240:243], v[16:19], a[104:107], v[240:243]
    v_mfma_f32_16x16x32_bf16 v[248:251], v[16:19], a[108:111], v[248:251]
    v_mfma_f32_16x16x32_bf16 v[244:247], v[20:23], a[104:107], v[244:247]
    v_mfma_f32_16x16x32_bf16 v[252:255], v[20:23], a[108:111], v[252:255]
    v_mfma_f32_16x16x32_bf16 v[240:243], v[24:27], a[112:115], v[240:243]
    v_mfma_f32_16x16x32_bf16 v[248:251], v[24:27], a[116:119], v[248:251]
    v_mfma_f32_16x16x32_bf16 v[244:247], v[28:31], a[112:115], v[244:247]
    v_mfma_f32_16x16x32_bf16 v[252:255], v[28:31], a[116:119], v[252:255]
    s_waitcnt vmcnt(2) lgkmcnt(0)
    v_max3_u32 v9, v148, v149, v150
    v_max3_u32 v9, v9, v151, v156
    v_mfma_f32_16x16x32_bf16 v[240:243], v[32:35], a[120:123], v[240:243]
    v_max3_u32 v9, v9, v157, v158
    v_max_u32 v9, v9, v159
    v_mfma_f32_16x16x32_bf16 v[248:251], v[32:35], a[124:127], v[248:251]
    v_cmp_eq_u32 vcc, -1, v9
    v_mfma_f32_16x16x32_bf16 v[244:247], v[36:39], a[120:123], v[244:247]
    s_cbranch_vccnz main_kernel_slowrc1
main_kernel_backrc1:
    v_mfma_f32_16x16x32_bf16 v[252:255], v[36:39], a[124:127], v[252:255]
    v_mfma_f32_16x16x32_bf16 v[240:243], v[40:43], a[128:131], v[240:243]
    v_mfma_f32_16x16x32_bf16 v[248:251], v[40:43], a[132:135], v[248:251]
    v_mfma_f32_16x16x32_bf16 v[244:247], v[44:47], a[128:131], v[244:247]
    v_mfma_f32_16x16x32_bf16 v[252:255], v[44:47], a[132:135], v[252:255]
    v_mfma_f32_16x16x32_bf16 v[240:243], v[184:187], v[148:151], v[240:243]
    v_mfma_f32_16x16x32_bf16 v[244:247], v[186:189], v[148:151], v[244:247]
    v_mfma_f32_16x16x32_bf16 v[248:251], v[184:187], v[156:159], v[248:251]
    v_mfma_f32_16x16x32_bf16 v[252:255], v[186:189], v[156:159], v[252:255]
    s_mov_b32 s18, 0
    s_mov_b32 s19, 0x42500000
    s_nop 2
    v_cvt_pk_bf16_f32 v208, v240, v241
    v_cvt_pk_bf16_f32 v209, v242, v243
    v_cvt_pk_bf16_f32 v210, v244, v245
    v_cvt_pk_bf16_f32 v211, v246, v247
    v_cvt_pk_bf16_f32 v212, v248, v249
    v_cvt_pk_bf16_f32 v213, v250, v251
    v_cvt_pk_bf16_f32 v214, v252, v253
    v_cvt_pk_bf16_f32 v215, v254, v255
    v_and_b32 v208, -2, v208
    s_mov_b64 exec, s[66:67]
    v_swap_b32 v210, v212
    v_swap_b32 v211, v213
    s_mov_b64 exec, -1
    v_and_b32 v212, -2, v212
    s_add_u32 s54, s52, 131072
    buffer_store_dwordx4 v[208:211], v3, s[20:23], s54 offen offset:0 sc1
    buffer_store_dwordx4 v[212:215], v3, s[20:23], s54 offen offset:1024 sc1
    s_cmp_lg_u32 s12, 0
    s_cbranch_scc1 main_kernel_tail1
    v_fmac_f32 v182, v240, v240
    v_fmac_f32 v183, v248, v248
    v_fmac_f32 v182, v241, v241
    v_fmac_f32 v183, v249, v249
    v_fmac_f32 v182, v242, v242
    v_fmac_f32 v183, v250, v250
    v_fmac_f32 v182, v243, v243
    v_fmac_f32 v183, v251, v251
    v_fmac_f32 v182, v244, v244
    v_fmac_f32 v183, v252, v252
    v_fmac_f32 v182, v245, v245
    v_fmac_f32 v183, v253, v253
    v_fmac_f32 v182, v246, v246
    v_fmac_f32 v183, v254, v254
    v_fmac_f32 v182, v247, v247
    v_fmac_f32 v183, v255, v255
    s_nop 1
    v_permlane32_swap_b32 v182, v183
    v_add_f32 v182, v182, v183
    v_mov_b32 v183, v182
    s_nop 1
    v_permlane16_swap_b32 v182, v183
    v_add_f32 v182, v182, v183
    v_mul_f32 v182, 0x45800000, v182
    s_lshl_b32 s15, s8, 10
    s_lshl_b32 s16, s10, 8
    s_add_u32 s15, s15, s16
    s_add_u32 s15, s15, 45088768
    v_cvt_f64_f32 v[182:183], v182
    v_add_f64 v[182:183], v[182:183], s[18:19]
    buffer_atomic_add_f64 v[182:183], v180, s[20:23], s15 offen
    s_add_u32 s27, s59, 0
    buffer_load_dwordx4 v[112:115], v190, s[20:23], s27 offen sc1
    s_add_u32 s28, s59, 524288
    buffer_load_dwordx4 v[116:119], v190, s[20:23], s28 offen sc1
    s_add_u32 s29, s59, 1048576
    buffer_load_dwordx4 v[120:123], v190, s[20:23], s29 offen sc1
    s_add_u32 s30, s59, 1572864
    buffer_load_dwordx4 v[124:127], v190, s[20:23], s30 offen sc1
    s_barrier
    v_add_u32 v0, s25, v3
    ds_read_b128 a[96:99], v4 offset:32768
    ds_read_b128 a[100:103], v4 offset:33792
    ds_read_b128 a[104:107], v4 offset:34816
    ds_read_b128 a[108:111], v4 offset:35840
    ds_read_b128 a[112:115], v4 offset:36864
    ds_read_b128 a[116:119], v4 offset:37888
    ds_read_b128 a[120:123], v4 offset:38912
    ds_read_b128 a[124:127], v4 offset:39936
    ds_read_b128 a[128:131], v4 offset:40960
    ds_read_b128 a[132:135], v4 offset:41984
    ds_read_b128 a[136:139], v4 offset:43008
    ds_read_b128 a[140:143], v4 offset:44032
    ds_read_b128 a[144:147], v4 offset:45056
    ds_read_b128 a[148:151], v4 offset:46080
    ds_read_b128 a[152:155], v4 offset:47104
    ds_read_b128 a[156:159], v4 offset:48128
    ds_read_b128 a[160:163], v4 offset:49152
    ds_read_b128 a[164:167], v4 offset:50176
    ds_read_b128 a[168:171], v4 offset:51200
    ds_read_b128 a[172:175], v4 offset:52224
    ds_read_b128 a[176:179], v4 offset:53248
    ds_read_b128 a[180:183], v4 offset:54272
    ds_read_b128 a[184:187], v4 offset:55296
    ds_read_b128 a[188:191], v4 offset:56320
    ds_read_b128 a[192:195], v4 offset:57344
    ds_read_b128 a[196:199], v4 offset:58368
    ds_read_b128 a[200:203], v4 offset:59392
    ds_read_b128 a[204:207], v4 offset:60416
    ds_read_b128 a[208:211], v4 offset:61440
    ds_read_b128 a[212:215], v4 offset:62464
    ds_read_b128 a[216:219], v4 offset:63488
    ds_read_b128 a[220:223], v4 offset:64512
    ds_read_b128 a[224:227], v5 offset:0
    ds_read_b128 a[228:231], v5 offset:1024
    ds_read_b128 a[232:235], v5 offset:2048
    ds_read_b128 a[236:239], v5 offset:3072
    ds_read_b128 a[240:243], v5 offset:4096
    ds_read_b128 a[244:247], v5 offset:5120
    ds_read_b128 a[248:251], v5 offset:6144
    ds_read_b128 a[252:255], v5 offset:7168
    s_mov_b32 s3, 17825792
    s_mov_b32 s12, 1
    s_mov_b64 s[66:67], 0
    s_bfe_u32 s15, s2, 0x10003
    s_lshr_b32 s16, s2, 4
    s_lshl_b32 s16, s16, 3
    s_add_u32 s16, s16, s6
    s_lshr_b32 s17, s16, 2
    s_and_b32 s18, s16, 3
    s_lshl_b32 s17, s17, 17
    s_lshl_b32 s18, s18, 8
    s_add_u32 s17, s17, s18
    s_lshl_b32 s18, s15, 10
    s_add_u32 s18, s17, s18
    s_add_u32 s18, s18, s26
    s_add_u32 s40, s18, 0
    s_add_u32 s41, s18, 8192
    s_add_u32 s42, s18, 65536
    s_add_u32 s43, s18, 73728
    s_lshl_b32 s44, s10, 8
    s_add_u32 s44, s44, 45088768
    s_add_u32 s45, s44, 8192
    s_cmp_eq_u32 s2, 0
    s_cselect_b32 s46, 0, 1.0
    s_mov_b32 s47, s46
    s_mov_b32 s38, 0
    s_mov_b32 s39, 0xc2900000
    s_mov_b32 s37, 0x42900000
    s_sleep 18
main_kernel_rcvz:
    s_sleep 8
main_kernel_rcvx:
    buffer_load_dwordx4 v[16:19], v176, s[20:23], s40 offen sc1
    buffer_load_dwordx4 v[20:23], v176, s[20:23], s41 offen sc1
    buffer_load_dwordx4 v[24:27], v176, s[20:23], s42 offen sc1
    buffer_load_dwordx4 v[28:31], v176, s[20:23], s43 offen sc1
    buffer_load_dwordx4 v[32:35], v177, s[20:23], s44 offen offset:0 sc1
    buffer_load_dwordx4 v[36:39], v177, s[20:23], s44 offen offset:1024 sc1
    buffer_load_dwordx4 v[40:43], v177, s[20:23], s45 offen offset:0 sc1
    buffer_load_dwordx4 v[44:47], v177, s[20:23], s45 offen offset:1024 sc1
    s_waitcnt vmcnt(4)
    v_or_b32 v9, v16, v20
    v_or3_b32 v9, v9, v24, v28
    v_and_b32 v9, 1, v9
    v_cmp_ne_u32 vcc, 0, v9
    v_lshlrev_b32 v160, 16, v16
    v_and_b32 v136, 0xffff0000, v16
    v_lshlrev_b32 v144, 16, v17
    v_and_b32 v152, 0xffff0000, v17
    v_lshlrev_b32 v161, 16, v18
    v_and_b32 v137, 0xffff0000, v18
    v_lshlrev_b32 v145, 16, v19
    v_and_b32 v153, 0xffff0000, v19
    v_lshlrev_b32 v162, 16, v20
    v_and_b32 v138, 0xffff0000, v20
    v_lshlrev_b32 v146, 16, v21
    v_and_b32 v154, 0xffff0000, v21
    v_lshlrev_b32 v163, 16, v22
    v_and_b32 v139, 0xffff0000, v22
    v_lshlrev_b32 v147, 16, v23
    v_and_b32 v155, 0xffff0000, v23
    v_lshlrev_b32 v164, 16, v24
    v_and_b32 v140, 0xffff0000, v24
    v_lshlrev_b32 v148, 16, v25
    v_and_b32 v156, 0xffff0000, v25
    v_lshlrev_b32 v165, 16, v26
    v_and_b32 v141, 0xffff0000, v26
    v_lshlrev_b32 v149, 16, v27
    v_and_b32 v157, 0xffff0000, v27
    v_lshlrev_b32 v166, 16, v28
    v_and_b32 v142, 0xffff0000, v28
    v_lshlrev_b32 v150, 16, v29
    v_and_b32 v158, 0xffff0000, v29
    v_lshlrev_b32 v167, 16, v30
    v_and_b32 v143, 0xffff0000, v30
    v_lshlrev_b32 v151, 16, v31
    v_and_b32 v159, 0xffff0000, v31
    s_waitcnt vmcnt(0)
    v_min3_u32 v8, v33, v35, v37
    v_min3_u32 v8, v8, v39, v41
    v_min3_u32 v8, v8, v43, v45
    v_min_u32 v8, v8, v47
    v_cmp_gt_u32 s[28:29], s37, v8
    s_nop 0
    s_or_b64 vcc, vcc, s[28:29]
    s_add_u32 s48, s48, 1
    s_cbranch_vccz main_kernel_rcvok
    s_mov_b64 exec, vcc
    s_cmp_lt_u32 s48, 32768
    s_cbranch_scc1 main_kernel_rcvz
main_kernel_rcvok:
    s_mov_b64 exec, -1
    s_branch main_kernel_k2body
main_kernel_tail1:
    buffer_load_dwordx4 a[136:139], v3, s[60:63], s16 offen offset:0
    buffer_load_dwordx4 a[140:143], v3, s[60:63], s16 offen offset:1024
    buffer_load_dwordx4 a[144:147], v3, s[60:63], s16 offen offset:2048
    buffer_load_dwordx4 a[148:151], v3, s[60:63], s16 offen offset:3072
    s_add_u32 s16, s16, 4096
    buffer_load_dwordx4 a[152:155], v3, s[60:63], s16 offen offset:0
    buffer_load_dwordx4 a[156:159], v3, s[60:63], s16 offen offset:1024
    buffer_load_dwordx4 a[160:163], v3, s[60:63], s16 offen offset:2048
    buffer_load_dwordx4 a[164:167], v3, s[60:63], s16 offen offset:3072
    s_add_u32 s16, s16, 4096
    buffer_load_dwordx4 a[168:171], v3, s[60:63], s16 offen offset:0
    buffer_load_dwordx4 a[172:175], v3, s[60:63], s16 offen offset:1024
    buffer_load_dwordx4 a[176:179], v3, s[60:63], s16 offen offset:2048
    buffer_load_dwordx4 a[180:183], v3, s[60:63], s16 offen offset:3072
    s_add_u32 s16, s16, 4096
    buffer_load_dwordx4 a[184:187], v3, s[60:63], s16 offen offset:0
    buffer_load_dwordx4 a[188:191], v3, s[60:63], s16 offen offset:1024
    buffer_load_dwordx4 a[192:195], v3, s[60:63], s16 offen offset:2048
    buffer_load_dwordx4 a[196:199], v3, s[60:63], s16 offen offset:3072
    buffer_load_dwordx4 a[200:203], v3, s[60:63], s15 offen offset:0
    buffer_load_dwordx4 a[204:207], v3, s[60:63], s15 offen offset:1024
    v_and_b32 v10, 0x370, v3
    s_lshl_b32 s40, s10, 20
    s_lshl_b32 s19, s8, 13
    s_add_u32 s40, s40, s19
    s_and_b32 s19, s14, 6
    s_lshl_b32 s19, s19, 10
    s_add_u32 s40, s40, s19
    s_lshl_b32 s19, s11, 10
    s_add_u32 s40, s40, s19
    s_and_b32 s19, s14, 1
    s_lshl_b32 s19, s19, 7
    s_add_u32 s40, s40, s19
    s_add_u32 s40, s40, 0
    s_add_u32 s41, s40, 131072
    s_add_u32 s42, s40, 262144
    s_add_u32 s43, s40, 393216
    s_add_u32 s44, s40, 524288
    s_add_u32 s45, s40, 655360
    s_add_u32 s46, s40, 786432
    s_add_u32 s47, s40, 917504
    buffer_load_dwordx4 v[16:19], v10, s[20:23], s40 offen sc1
    buffer_load_dwordx4 v[24:27], v10, s[20:23], s42 offen sc1
    buffer_load_dwordx4 v[32:35], v10, s[20:23], s44 offen sc1
    buffer_load_dwordx4 v[40:43], v10, s[20:23], s46 offen sc1
    s_mov_b32 s32, s64
    s_mov_b32 s33, s65
    s_mov_b32 s34, 4194304
    s_mov_b32 s35, 0x20000
    v_bfe_u32 v4, v2, 4, 2
    v_and_b32 v5, 15, v2
    v_lshlrev_b32 v6, 12, v4
main_kernel_stub16:
    s_cbranch_execz main_kernel_ret
    v_lshl_add_u32 v6, v5, 4, v6
    v_lshl_add_u32 v6, s10, 9, v6
    v_add_u32 v6, 147456, v6
    v_add_u32 v7, 147456, v3
    v_and_b32 v8, 1, v4
    v_lshlrev_b32 v8, 13, v8
    v_lshl_add_u32 v8, v5, 5, v8
    v_lshrrev_b32 v4, 1, v4
    v_lshl_add_u32 v8, v4, 4, v8
    s_lshl_b32 s36, s8, 18
    s_lshl_b32 s19, s14, 14
    s_add_u32 s36, s36, s19
    s_lshl_b32 s19, s10, 9
    s_add_u32 s36, s36, s19
    s_add_u32 s37, s36, 4096
    s_mov_b32 s38, 0x00ff00ff
    s_mov_b32 s39, 0x00ff00ff
    s_sleep 6
    buffer_load_dwordx4 v[20:23], v10, s[20:23], s41 offen sc1
    buffer_load_dwordx4 v[28:31], v10, s[20:23], s43 offen sc1
    buffer_load_dwordx4 v[36:39], v10, s[20:23], s45 offen sc1
    buffer_load_dwordx4 v[44:47], v10, s[20:23], s47 offen sc1
    s_waitcnt vmcnt(6)
main_kernel_och0:
    v_or_b32 v9, v16, v24
    v_and_b32 v9, 1, v9
    v_cmp_ne_u32 vcc, 0, v9
    s_nop 0
    s_cbranch_vccnz main_kernel_oslow0
main_kernel_ook0:
    v_mfma_f32_16x16x32_bf16 v[192:195], a[136:139], v[16:19], 0
    v_mfma_f32_16x16x32_bf16 v[196:199], a[140:143], v[16:19], 0
    v_mfma_f32_16x16x32_bf16 v[208:211], a[152:155], v[24:27], 0
    v_mfma_f32_16x16x32_bf16 v[212:215], a[156:159], v[24:27], 0
    s_waitcnt vmcnt(4)
main_kernel_och1:
    v_or_b32 v9, v32, v40
    v_and_b32 v9, 1, v9
    v_cmp_ne_u32 vcc, 0, v9
    s_nop 0
    s_cbranch_vccnz main_kernel_oslow1
main_kernel_ook1:
    v_mfma_f32_16x16x32_bf16 v[224:227], a[168:171], v[32:35], 0
    v_mfma_f32_16x16x32_bf16 v[228:231], a[172:175], v[32:35], 0
    v_mfma_f32_16x16x32_bf16 v[240:243], a[184:187], v[40:43], 0
    v_mfma_f32_16x16x32_bf16 v[244:247], a[188:191], v[40:43], 0
    s_mov_b64 exec, s[38:39]
    v_cvt_pk_bf16_f32 v96, v192, v193
    v_cvt_pk_bf16_f32 v100, v194, v195
    v_cvt_pk_bf16_f32 v98, v208, v209
    v_cvt_pk_bf16_f32 v102, v210, v211
    v_cvt_pk_bf16_f32 v104, v224, v225
    v_cvt_pk_bf16_f32 v108, v226, v227
    v_cvt_pk_bf16_f32 v106, v240, v241
    v_cvt_pk_bf16_f32 v110, v242, v243
    s_not_b64 exec, s[38:39]
    v_cvt_pk_bf16_f32 v96, v196, v197
    v_cvt_pk_bf16_f32 v100, v198, v199
    v_cvt_pk_bf16_f32 v98, v212, v213
    v_cvt_pk_bf16_f32 v102, v214, v215
    v_cvt_pk_bf16_f32 v104, v228, v229
    v_cvt_pk_bf16_f32 v108, v230, v231
    v_cvt_pk_bf16_f32 v106, v244, v245
    v_cvt_pk_bf16_f32 v110, v246, v247
    s_mov_b64 exec, -1
    s_waitcnt vmcnt(2)
main_kernel_och2:
    v_or_b32 v9, v20, v28
    v_and_b32 v9, 1, v9
    v_cmp_ne_u32 vcc, 0, v9
    s_nop 0
    s_cbranch_vccnz main_kernel_oslow2
main_kernel_ook2:
    v_mfma_f32_16x16x32_bf16 v[200:203], a[144:147], v[20:23], 0
    v_mfma_f32_16x16x32_bf16 v[204:207], a[148:151], v[20:23], 0
    v_mfma_f32_16x16x32_bf16 v[216:219], a[160:163], v[28:31], 0
    v_mfma_f32_16x16x32_bf16 v[220:223], a[164:167], v[28:31], 0
    s_waitcnt vmcnt(0)
main_kernel_och3:
    v_or_b32 v9, v36, v44
    v_and_b32 v9, 1, v9
    v_cmp_ne_u32 vcc, 0, v9
    s_nop 0
    s_cbranch_vccnz main_kernel_oslow3
main_kernel_ook3:
    v_mfma_f32_16x16x32_bf16 v[232:235], a[176:179], v[36:39], 0
    v_mfma_f32_16x16x32_bf16 v[236:239], a[180:183], v[36:39], 0
    v_mfma_f32_16x16x32_bf16 v[248:251], a[192:195], v[44:47], 0
    v_mfma_f32_16x16x32_bf16 v[252:255], a[196:199], v[44:47], 0
    s_mov_b64 exec, s[38:39]
    v_cvt_pk_bf16_f32 v97, v200, v201
    v_cvt_pk_bf16_f32 v101, v202, v203
    v_cvt_pk_bf16_f32 v99, v216, v217
    v_cvt_pk_bf16_f32 v103, v218, v219
    v_cvt_pk_bf16_f32 v105, v232, v233
    v_cvt_pk_bf16_f32 v109, v234, v235
    v_cvt_pk_bf16_f32 v107, v248, v249
    v_cvt_pk_bf16_f32 v111, v250, v251
    s_not_b64 exec, s[38:39]
    v_cvt_pk_bf16_f32 v97, v204, v205
    v_cvt_pk_bf16_f32 v101, v206, v207
    v_cvt_pk_bf16_f32 v99, v220, v221
    v_cvt_pk_bf16_f32 v103, v222, v223
    v_cvt_pk_bf16_f32 v105, v236, v237
    v_cvt_pk_bf16_f32 v109, v238, v239
    v_cvt_pk_bf16_f32 v107, v252, v253
    v_cvt_pk_bf16_f32 v111, v254, v255
    s_mov_b64 exec, -1
    ds_write_b128 v6, v[96:99] offset:0
    ds_write_b128 v6, v[100:103] offset:2048
    ds_write_b128 v6, v[104:107] offset:256
    ds_write_b128 v6, v[108:111] offset:2304
    s_waitcnt lgkmcnt(0)
    s_barrier
    ds_read_b128 v[112:115], v7 offset:0
    ds_read_b128 v[116:119], v7 offset:1024
    ds_read_b128 v[120:123], v7 offset:2048
    ds_read_b128 v[124:127], v7 offset:3072
    ds_read_b128 v[128:131], v7 offset:4096
    ds_read_b128 v[132:135], v7 offset:5120
    ds_read_b128 v[136:139], v7 offset:6144
    ds_read_b128 v[140:143], v7 offset:7168
    ds_read_b128 v[144:147], v7 offset:8192
    ds_read_b128 v[148:151], v7 offset:9216
    ds_read_b128 v[152:155], v7 offset:10240
    ds_read_b128 v[156:159], v7 offset:11264
    ds_read_b128 v[160:163], v7 offset:12288
    ds_read_b128 v[164:167], v7 offset:13312
    ds_read_b128 v[168:171], v7 offset:14336
    ds_read_b128 v[172:175], v7 offset:15360
    s_waitcnt lgkmcnt(15)
    v_mfma_f32_16x16x32_bf16 v[192:195], v[112:115], a[200:203], 0
    s_waitcnt lgkmcnt(14)
    v_mfma_f32_16x16x32_bf16 v[192:195], v[116:119], a[204:207], v[192:195]
    s_waitcnt lgkmcnt(13)
    v_mfma_f32_16x16x32_bf16 v[196:199], v[120:123], a[200:203], 0
    s_waitcnt lgkmcnt(12)
    v_mfma_f32_16x16x32_bf16 v[196:199], v[124:127], a[204:207], v[196:199]
    s_waitcnt lgkmcnt(11)
    v_mfma_f32_16x16x32_bf16 v[200:203], v[128:131], a[200:203], 0
    s_waitcnt lgkmcnt(10)
    v_mfma_f32_16x16x32_bf16 v[200:203], v[132:135], a[204:207], v[200:203]
    s_waitcnt lgkmcnt(9)
    v_mfma_f32_16x16x32_bf16 v[204:207], v[136:139], a[200:203], 0
    s_waitcnt lgkmcnt(8)
    v_mfma_f32_16x16x32_bf16 v[204:207], v[140:143], a[204:207], v[204:207]
    s_waitcnt lgkmcnt(7)
    v_mfma_f32_16x16x32_bf16 v[208:211], v[144:147], a[200:203], 0
    s_waitcnt lgkmcnt(6)
    v_mfma_f32_16x16x32_bf16 v[208:211], v[148:151], a[204:207], v[208:211]
    s_waitcnt lgkmcnt(5)
    v_mfma_f32_16x16x32_bf16 v[212:215], v[152:155], a[200:203], 0
    s_waitcnt lgkmcnt(4)
    v_mfma_f32_16x16x32_bf16 v[212:215], v[156:159], a[204:207], v[212:215]
    s_waitcnt lgkmcnt(3)
    v_mfma_f32_16x16x32_bf16 v[216:219], v[160:163], a[200:203], 0
    s_waitcnt lgkmcnt(2)
    v_mfma_f32_16x16x32_bf16 v[216:219], v[164:167], a[204:207], v[216:219]
    s_waitcnt lgkmcnt(1)
    v_mfma_f32_16x16x32_bf16 v[220:223], v[168:171], a[200:203], 0
    s_waitcnt lgkmcnt(0)
    v_mfma_f32_16x16x32_bf16 v[220:223], v[172:175], a[204:207], v[220:223]
    v_cvt_pk_bf16_f32 v224, v192, v196
    v_cvt_pk_bf16_f32 v225, v200, v204
    v_cvt_pk_bf16_f32 v226, v208, v212
    s_nop 4
    v_cvt_pk_bf16_f32 v227, v216, v220
    buffer_store_dwordx4 v[224:227], v8, s[32:35], s36 offen offset:0 nt
    v_cvt_pk_bf16_f32 v228, v193, v197
    v_cvt_pk_bf16_f32 v229, v201, v205
    v_cvt_pk_bf16_f32 v230, v209, v213
    v_cvt_pk_bf16_f32 v231, v217, v221
    buffer_store_dwordx4 v[228:231], v8, s[32:35], s36 offen offset:2048 nt
    v_cvt_pk_bf16_f32 v232, v194, v198
    v_cvt_pk_bf16_f32 v233, v202, v206
    v_cvt_pk_bf16_f32 v234, v210, v214
    v_cvt_pk_bf16_f32 v235, v218, v222
    buffer_store_dwordx4 v[232:235], v8, s[32:35], s37 offen offset:0 nt
    v_cvt_pk_bf16_f32 v236, v195, v199
    v_cvt_pk_bf16_f32 v237, v203, v207
    v_cvt_pk_bf16_f32 v238, v211, v215
    v_cvt_pk_bf16_f32 v239, v219, v223
    buffer_store_dwordx4 v[236:239], v8, s[32:35], s37 offen offset:2048 nt
main_kernel_end:
    s_endpgm
main_kernel_oslow0:
    s_add_u32 s48, s48, 1
    s_cmp_ge_u32 s48, 32768
    s_cbranch_scc1 main_kernel_ook0
    buffer_load_dwordx4 v[16:19], v10, s[20:23], s40 offen sc1
    buffer_load_dwordx4 v[24:27], v10, s[20:23], s42 offen sc1
    s_waitcnt vmcnt(0)
    s_branch main_kernel_och0
main_kernel_oslow1:
    s_add_u32 s48, s48, 1
    s_cmp_ge_u32 s48, 32768
    s_cbranch_scc1 main_kernel_ook1
    buffer_load_dwordx4 v[32:35], v10, s[20:23], s44 offen sc1
    buffer_load_dwordx4 v[40:43], v10, s[20:23], s46 offen sc1
    s_waitcnt vmcnt(0)
    s_branch main_kernel_och1
main_kernel_oslow2:
    s_add_u32 s48, s48, 1
    s_cmp_ge_u32 s48, 32768
    s_cbranch_scc1 main_kernel_ook2
    buffer_load_dwordx4 v[20:23], v10, s[20:23], s41 offen sc1
    buffer_load_dwordx4 v[28:31], v10, s[20:23], s43 offen sc1
    s_waitcnt vmcnt(0)
    s_branch main_kernel_och2
main_kernel_oslow3:
    s_add_u32 s48, s48, 1
    s_cmp_ge_u32 s48, 32768
    s_cbranch_scc1 main_kernel_ook3
    buffer_load_dwordx4 v[36:39], v10, s[20:23], s45 offen sc1
    buffer_load_dwordx4 v[44:47], v10, s[20:23], s47 offen sc1
    s_waitcnt vmcnt(0)
    s_branch main_kernel_och3
main_kernel_slow0:
    buffer_load_dword v12, v8, s[20:23], s49 offen offset:0 sc1
    s_waitcnt vmcnt(0)
    v_readfirstlane_b32 s31, v12
    s_add_u32 s48, s48, 1
    s_cmp_ge_u32 s31, 8
    s_cbranch_scc1 main_kernel_back0
    s_cmp_lt_u32 s48, 32768
    s_cbranch_scc1 main_kernel_slow0
    s_branch main_kernel_back0
main_kernel_slow1:
    buffer_load_dword v13, v8, s[20:23], s49 offen offset:256 sc1
    s_waitcnt vmcnt(0)
    v_readfirstlane_b32 s31, v13
    s_add_u32 s48, s48, 1
    s_cmp_ge_u32 s31, 8
    s_cbranch_scc1 main_kernel_back1
    s_cmp_lt_u32 s48, 32768
    s_cbranch_scc1 main_kernel_slow1
    s_branch main_kernel_back1
main_kernel_slow2:
    buffer_load_dword v14, v8, s[20:23], s49 offen offset:512 sc1
    s_waitcnt vmcnt(0)
    v_readfirstlane_b32 s31, v14
    s_add_u32 s48, s48, 1
    s_cmp_ge_u32 s31, 8
    s_cbranch_scc1 main_kernel_back2
    s_cmp_lt_u32 s48, 32768
    s_cbranch_scc1 main_kernel_slow2
    s_branch main_kernel_back2
main_kernel_slow3:
    buffer_load_dword v12, v8, s[20:23], s49 offen offset:768 sc1
    s_waitcnt vmcnt(0)
    v_readfirstlane_b32 s31, v12
    s_add_u32 s48, s48, 1
    s_cmp_ge_u32 s31, 8
    s_cbranch_scc1 main_kernel_back3
    s_cmp_lt_u32 s48, 32768
    s_cbranch_scc1 main_kernel_slow3
    s_branch main_kernel_back3
main_kernel_slow4:
    buffer_load_dword v13, v8, s[20:23], s49 offen offset:1024 sc1
    s_waitcnt vmcnt(0)
    v_readfirstlane_b32 s31, v13
    s_add_u32 s48, s48, 1
    s_cmp_ge_u32 s31, 8
    s_cbranch_scc1 main_kernel_back4
    s_cmp_lt_u32 s48, 32768
    s_cbranch_scc1 main_kernel_slow4
    s_branch main_kernel_back4
main_kernel_slow5:
    buffer_load_dword v14, v8, s[20:23], s49 offen offset:1280 sc1
    s_waitcnt vmcnt(0)
    v_readfirstlane_b32 s31, v14
    s_add_u32 s48, s48, 1
    s_cmp_ge_u32 s31, 8
    s_cbranch_scc1 main_kernel_back5
    s_cmp_lt_u32 s48, 32768
    s_cbranch_scc1 main_kernel_slow5
    s_branch main_kernel_back5
main_kernel_slow6:
    buffer_load_dword v12, v8, s[20:23], s49 offen offset:1536 sc1
    s_waitcnt vmcnt(0)
    v_readfirstlane_b32 s31, v12
    s_add_u32 s48, s48, 1
    s_cmp_ge_u32 s31, 8
    s_cbranch_scc1 main_kernel_back6
    s_cmp_lt_u32 s48, 32768
    s_cbranch_scc1 main_kernel_slow6
    s_branch main_kernel_back6
main_kernel_slow7:
    buffer_load_dword v15, v8, s[20:23], s55 offen offset:768 sc1
    s_waitcnt vmcnt(0)
    v_readfirstlane_b32 s31, v15
    s_add_u32 s48, s48, 1
    s_cmp_ge_u32 s31, 8
    s_cbranch_scc1 main_kernel_back7
    s_cmp_lt_u32 s48, 32768
    s_cbranch_scc1 main_kernel_slow7
    s_branch main_kernel_back7
main_kernel_xin:
    s_mov_b64 exec, vcc
    s_add_u32 s31, s24, 0
    buffer_load_dwordx4 v[112:115], v3, s[20:23], s31 offen offset:0 sc1
    buffer_load_dwordx4 v[116:119], v3, s[20:23], s31 offen offset:1024 sc1
    s_add_u32 s31, s24, 131072
    buffer_load_dwordx4 v[120:123], v3, s[20:23], s31 offen offset:0 sc1
    buffer_load_dwordx4 v[124:127], v3, s[20:23], s31 offen offset:1024 sc1
    s_add_u32 s31, s24, 262144
    buffer_load_dwordx4 v[128:131], v3, s[20:23], s31 offen offset:0 sc1
    buffer_load_dwordx4 v[132:135], v3, s[20:23], s31 offen offset:1024 sc1
    s_add_u32 s31, s24, 393216
    buffer_load_dwordx4 v[136:139], v3, s[20:23], s31 offen offset:0 sc1
    buffer_load_dwordx4 v[140:143], v3, s[20:23], s31 offen offset:1024 sc1
    s_waitcnt vmcnt(0)
    v_bitop3_b32 v9, v112, v116, 1 bitop3:0x80
    v_bitop3_b32 v9, v120, v124, v9 bitop3:0x80
    v_cmp_eq_u32 vcc, 0, v9
    s_add_u32 s48, s48, 1
    s_cbranch_vccz main_kernel_xok
    s_cmp_lt_u32 s48, 32768
    s_cbranch_scc1 main_kernel_xin
    s_mov_b64 exec, -1
    s_branch main_kernel_xok
main_kernel_slowx2:
    s_add_u32 s31, s24, 262144
    buffer_load_dwordx4 v[128:131], v3, s[20:23], s31 offen offset:0 sc1
    buffer_load_dwordx4 v[132:135], v3, s[20:23], s31 offen offset:1024 sc1
    s_waitcnt vmcnt(0)
    v_bitop3_b32 v9, v128, v132, 1 bitop3:0x80
    v_cmp_eq_u32 vcc, 0, v9
    s_add_u32 s48, s48, 1
    s_cbranch_vccz main_kernel_backx2
    s_cmp_lt_u32 s48, 32768
    s_cbranch_scc1 main_kernel_slowx2
    s_branch main_kernel_backx2
main_kernel_slowx3:
    s_add_u32 s31, s24, 393216
    buffer_load_dwordx4 v[136:139], v3, s[20:23], s31 offen offset:0 sc1
    buffer_load_dwordx4 v[140:143], v3, s[20:23], s31 offen offset:1024 sc1
    s_waitcnt vmcnt(0)
    v_bitop3_b32 v9, v136, v140, 1 bitop3:0x80
    v_cmp_eq_u32 vcc, 0, v9
    s_add_u32 s48, s48, 1
    s_cbranch_vccz main_kernel_backx3
    s_cmp_lt_u32 s48, 32768
    s_cbranch_scc1 main_kernel_slowx3
    s_branch main_kernel_backx3
main_kernel_slowx4:
    s_add_u32 s31, s24, 524288
    buffer_load_dwordx4 v[144:147], v3, s[20:23], s31 offen offset:0 sc1
    buffer_load_dwordx4 v[148:151], v3, s[20:23], s31 offen offset:1024 sc1
    s_waitcnt vmcnt(0)
    v_bitop3_b32 v9, v144, v148, 1 bitop3:0x80
    v_cmp_eq_u32 vcc, 0, v9
    s_add_u32 s48, s48, 1
    s_cbranch_vccz main_kernel_backx4
    s_cmp_lt_u32 s48, 32768
    s_cbranch_scc1 main_kernel_slowx4
    s_branch main_kernel_backx4
main_kernel_slowx5:
    s_add_u32 s31, s24, 655360
    buffer_load_dwordx4 v[152:155], v3, s[20:23], s31 offen offset:0 sc1
    buffer_load_dwordx4 v[156:159], v3, s[20:23], s31 offen offset:1024 sc1
    s_waitcnt vmcnt(0)
    v_bitop3_b32 v9, v152, v156, 1 bitop3:0x80
    v_cmp_eq_u32 vcc, 0, v9
    s_add_u32 s48, s48, 1
    s_cbranch_vccz main_kernel_backx5
    s_cmp_lt_u32 s48, 32768
    s_cbranch_scc1 main_kernel_slowx5
    s_branch main_kernel_backx5
main_kernel_slowx6:
    s_add_u32 s31, s24, 786432
    buffer_load_dwordx4 v[160:163], v3, s[20:23], s31 offen offset:0 sc1
    buffer_load_dwordx4 v[164:167], v3, s[20:23], s31 offen offset:1024 sc1
    s_waitcnt vmcnt(0)
    v_bitop3_b32 v9, v160, v164, 1 bitop3:0x80
    v_cmp_eq_u32 vcc, 0, v9
    s_add_u32 s48, s48, 1
    s_cbranch_vccz main_kernel_backx6
    s_cmp_lt_u32 s48, 32768
    s_cbranch_scc1 main_kernel_slowx6
    s_branch main_kernel_backx6
main_kernel_slowx7:
    s_add_u32 s31, s24, 917504
    buffer_load_dwordx4 v[168:171], v3, s[20:23], s31 offen offset:0 sc1
    buffer_load_dwordx4 v[172:175], v3, s[20:23], s31 offen offset:1024 sc1
    s_waitcnt vmcnt(0)
    v_bitop3_b32 v9, v168, v172, 1 bitop3:0x80
    v_cmp_eq_u32 vcc, 0, v9
    s_add_u32 s48, s48, 1
    s_cbranch_vccz main_kernel_backx7
    s_cmp_lt_u32 s48, 32768
    s_cbranch_scc1 main_kernel_slowx7
    s_branch main_kernel_backx7
main_kernel_slowx8:
    s_add_u32 s31, s24, 1048576
    buffer_load_dwordx4 v[176:179], v3, s[20:23], s31 offen offset:0 sc1
    buffer_load_dwordx4 v[180:183], v3, s[20:23], s31 offen offset:1024 sc1
    s_waitcnt vmcnt(0)
    v_bitop3_b32 v9, v176, v180, 1 bitop3:0x80
    v_cmp_eq_u32 vcc, 0, v9
    s_add_u32 s48, s48, 1
    s_cbranch_vccz main_kernel_backx8
    s_cmp_lt_u32 s48, 32768
    s_cbranch_scc1 main_kernel_slowx8
    s_branch main_kernel_backx8
main_kernel_slowx9:
    s_add_u32 s31, s24, 1179648
    buffer_load_dwordx4 v[184:187], v3, s[20:23], s31 offen offset:0 sc1
    buffer_load_dwordx4 v[188:191], v3, s[20:23], s31 offen offset:1024 sc1
    s_waitcnt vmcnt(0)
    v_bitop3_b32 v9, v184, v188, 1 bitop3:0x80
    v_cmp_eq_u32 vcc, 0, v9
    s_add_u32 s48, s48, 1
    s_cbranch_vccz main_kernel_backx9
    s_cmp_lt_u32 s48, 32768
    s_cbranch_scc1 main_kernel_slowx9
    s_branch main_kernel_backx9
main_kernel_slowx10:
    s_add_u32 s31, s24, 1310720
    buffer_load_dwordx4 v[112:115], v3, s[20:23], s31 offen offset:0 sc1
    buffer_load_dwordx4 v[116:119], v3, s[20:23], s31 offen offset:1024 sc1
    s_waitcnt vmcnt(0)
    v_bitop3_b32 v9, v112, v116, 1 bitop3:0x80
    v_cmp_eq_u32 vcc, 0, v9
    s_add_u32 s48, s48, 1
    s_cbranch_vccz main_kernel_backx10
    s_cmp_lt_u32 s48, 32768
    s_cbranch_scc1 main_kernel_slowx10
    s_branch main_kernel_backx10
main_kernel_slowx11:
    s_add_u32 s31, s24, 1441792
    buffer_load_dwordx4 v[120:123], v3, s[20:23], s31 offen offset:0 sc1
    buffer_load_dwordx4 v[124:127], v3, s[20:23], s31 offen offset:1024 sc1
    s_waitcnt vmcnt(0)
    v_bitop3_b32 v9, v120, v124, 1 bitop3:0x80
    v_cmp_eq_u32 vcc, 0, v9
    s_add_u32 s48, s48, 1
    s_cbranch_vccz main_kernel_backx11
    s_cmp_lt_u32 s48, 32768
    s_cbranch_scc1 main_kernel_slowx11
    s_branch main_kernel_backx11
main_kernel_slowx12:
    s_add_u32 s31, s24, 1572864
    buffer_load_dwordx4 v[128:131], v3, s[20:23], s31 offen offset:0 sc1
    buffer_load_dwordx4 v[132:135], v3, s[20:23], s31 offen offset:1024 sc1
    s_waitcnt vmcnt(0)
    v_bitop3_b32 v9, v128, v132, 1 bitop3:0x80
    v_cmp_eq_u32 vcc, 0, v9
    s_add_u32 s48, s48, 1
    s_cbranch_vccz main_kernel_backx12
    s_cmp_lt_u32 s48, 32768
    s_cbranch_scc1 main_kernel_slowx12
    s_branch main_kernel_backx12
main_kernel_slowx13:
    s_add_u32 s31, s24, 1703936
    buffer_load_dwordx4 v[136:139], v3, s[20:23], s31 offen offset:0 sc1
    buffer_load_dwordx4 v[140:143], v3, s[20:23], s31 offen offset:1024 sc1
    s_waitcnt vmcnt(0)
    v_bitop3_b32 v9, v136, v140, 1 bitop3:0x80
    v_cmp_eq_u32 vcc, 0, v9
    s_add_u32 s48, s48, 1
    s_cbranch_vccz main_kernel_backx13
    s_cmp_lt_u32 s48, 32768
    s_cbranch_scc1 main_kernel_slowx13
    s_branch main_kernel_backx13
main_kernel_slowx14:
    s_add_u32 s31, s24, 1835008
    buffer_load_dwordx4 v[144:147], v3, s[20:23], s31 offen offset:0 sc1
    buffer_load_dwordx4 v[148:151], v3, s[20:23], s31 offen offset:1024 sc1
    s_waitcnt vmcnt(0)
    v_bitop3_b32 v9, v144, v148, 1 bitop3:0x80
    v_cmp_eq_u32 vcc, 0, v9
    s_add_u32 s48, s48, 1
    s_cbranch_vccz main_kernel_backx14
    s_cmp_lt_u32 s48, 32768
    s_cbranch_scc1 main_kernel_slowx14
    s_branch main_kernel_backx14
main_kernel_slowx15:
    s_add_u32 s31, s24, 1966080
    buffer_load_dwordx4 v[152:155], v3, s[20:23], s31 offen offset:0 sc1
    buffer_load_dwordx4 v[156:159], v3, s[20:23], s31 offen offset:1024 sc1
    s_waitcnt vmcnt(0)
    v_bitop3_b32 v9, v152, v156, 1 bitop3:0x80
    v_cmp_eq_u32 vcc, 0, v9
    s_add_u32 s48, s48, 1
    s_cbranch_vccz main_kernel_backx15
    s_cmp_lt_u32 s48, 32768
    s_cbranch_scc1 main_kernel_slowx15
    s_branch main_kernel_backx15
main_kernel_slowx16:
    s_add_u32 s31, s24, 2097152
    buffer_load_dwordx4 v[160:163], v3, s[20:23], s31 offen offset:0 sc1
    buffer_load_dwordx4 v[164:167], v3, s[20:23], s31 offen offset:1024 sc1
    s_waitcnt vmcnt(0)
    v_bitop3_b32 v9, v160, v164, 1 bitop3:0x80
    v_cmp_eq_u32 vcc, 0, v9
    s_add_u32 s48, s48, 1
    s_cbranch_vccz main_kernel_backx16
    s_cmp_lt_u32 s48, 32768
    s_cbranch_scc1 main_kernel_slowx16
    s_branch main_kernel_backx16
main_kernel_slowx17:
    s_add_u32 s31, s24, 2228224
    buffer_load_dwordx4 v[168:171], v3, s[20:23], s31 offen offset:0 sc1
    buffer_load_dwordx4 v[172:175], v3, s[20:23], s31 offen offset:1024 sc1
    s_waitcnt vmcnt(0)
    v_bitop3_b32 v9, v168, v172, 1 bitop3:0x80
    v_cmp_eq_u32 vcc, 0, v9
    s_add_u32 s48, s48, 1
    s_cbranch_vccz main_kernel_backx17
    s_cmp_lt_u32 s48, 32768
    s_cbranch_scc1 main_kernel_slowx17
    s_branch main_kernel_backx17
main_kernel_slowx18:
    s_add_u32 s31, s24, 2359296
    buffer_load_dwordx4 v[176:179], v3, s[20:23], s31 offen offset:0 sc1
    buffer_load_dwordx4 v[180:183], v3, s[20:23], s31 offen offset:1024 sc1
    s_waitcnt vmcnt(0)
    v_bitop3_b32 v9, v176, v180, 1 bitop3:0x80
    v_cmp_eq_u32 vcc, 0, v9
    s_add_u32 s48, s48, 1
    s_cbranch_vccz main_kernel_backx18
    s_cmp_lt_u32 s48, 32768
    s_cbranch_scc1 main_kernel_slowx18
    s_branch main_kernel_backx18
main_kernel_slowx19:
    s_add_u32 s31, s24, 2490368
    buffer_load_dwordx4 v[184:187], v3, s[20:23], s31 offen offset:0 sc1
    buffer_load_dwordx4 v[188:191], v3, s[20:23], s31 offen offset:1024 sc1
    s_waitcnt vmcnt(0)
    v_bitop3_b32 v9, v184, v188, 1 bitop3:0x80
    v_cmp_eq_u32 vcc, 0, v9
    s_add_u32 s48, s48, 1
    s_cbranch_vccz main_kernel_backx19
    s_cmp_lt_u32 s48, 32768
    s_cbranch_scc1 main_kernel_slowx19
    s_branch main_kernel_backx19
main_kernel_slowx20:
    s_add_u32 s31, s24, 2621440
    buffer_load_dwordx4 v[112:115], v3, s[20:23], s31 offen offset:0 sc1
    buffer_load_dwordx4 v[116:119], v3, s[20:23], s31 offen offset:1024 sc1
    s_waitcnt vmcnt(0)
    v_bitop3_b32 v9, v112, v116, 1 bitop3:0x80
    v_cmp_eq_u32 vcc, 0, v9
    s_add_u32 s48, s48, 1
    s_cbranch_vccz main_kernel_backx20
    s_cmp_lt_u32 s48, 32768
    s_cbranch_scc1 main_kernel_slowx20
    s_branch main_kernel_backx20
main_kernel_slowx21:
    s_add_u32 s31, s24, 2752512
    buffer_load_dwordx4 v[120:123], v3, s[20:23], s31 offen offset:0 sc1
    buffer_load_dwordx4 v[124:127], v3, s[20:23], s31 offen offset:1024 sc1
    s_waitcnt vmcnt(0)
    v_bitop3_b32 v9, v120, v124, 1 bitop3:0x80
    v_cmp_eq_u32 vcc, 0, v9
    s_add_u32 s48, s48, 1
    s_cbranch_vccz main_kernel_backx21
    s_cmp_lt_u32 s48, 32768
    s_cbranch_scc1 main_kernel_slowx21
    s_branch main_kernel_backx21
main_kernel_slowx22:
    s_add_u32 s31, s24, 2883584
    buffer_load_dwordx4 v[128:131], v3, s[20:23], s31 offen offset:0 sc1
    buffer_load_dwordx4 v[132:135], v3, s[20:23], s31 offen offset:1024 sc1
    s_waitcnt vmcnt(0)
    v_bitop3_b32 v9, v128, v132, 1 bitop3:0x80
    v_cmp_eq_u32 vcc, 0, v9
    s_add_u32 s48, s48, 1
    s_cbranch_vccz main_kernel_backx22
    s_cmp_lt_u32 s48, 32768
    s_cbranch_scc1 main_kernel_slowx22
    s_branch main_kernel_backx22
main_kernel_slowx23:
    s_add_u32 s31, s24, 3014656
    buffer_load_dwordx4 v[136:139], v3, s[20:23], s31 offen offset:0 sc1
    buffer_load_dwordx4 v[140:143], v3, s[20:23], s31 offen offset:1024 sc1
    s_waitcnt vmcnt(0)
    v_bitop3_b32 v9, v136, v140, 1 bitop3:0x80
    v_cmp_eq_u32 vcc, 0, v9
    s_add_u32 s48, s48, 1
    s_cbranch_vccz main_kernel_backx23
    s_cmp_lt_u32 s48, 32768
    s_cbranch_scc1 main_kernel_slowx23
    s_branch main_kernel_backx23
main_kernel_slowx24:
    s_add_u32 s31, s24, 3145728
    buffer_load_dwordx4 v[144:147], v3, s[20:23], s31 offen offset:0 sc1
    buffer_load_dwordx4 v[148:151], v3, s[20:23], s31 offen offset:1024 sc1
    s_waitcnt vmcnt(0)
    v_bitop3_b32 v9, v144, v148, 1 bitop3:0x80
    v_cmp_eq_u32 vcc, 0, v9
    s_add_u32 s48, s48, 1
    s_cbranch_vccz main_kernel_backx24
    s_cmp_lt_u32 s48, 32768
    s_cbranch_scc1 main_kernel_slowx24
    s_branch main_kernel_backx24
main_kernel_slowx25:
    s_add_u32 s31, s24, 3276800
    buffer_load_dwordx4 v[152:155], v3, s[20:23], s31 offen offset:0 sc1
    buffer_load_dwordx4 v[156:159], v3, s[20:23], s31 offen offset:1024 sc1
    s_waitcnt vmcnt(0)
    v_bitop3_b32 v9, v152, v156, 1 bitop3:0x80
    v_cmp_eq_u32 vcc, 0, v9
    s_add_u32 s48, s48, 1
    s_cbranch_vccz main_kernel_backx25
    s_cmp_lt_u32 s48, 32768
    s_cbranch_scc1 main_kernel_slowx25
    s_branch main_kernel_backx25
main_kernel_slowx26:
    s_add_u32 s31, s24, 3407872
    buffer_load_dwordx4 v[160:163], v3, s[20:23], s31 offen offset:0 sc1
    buffer_load_dwordx4 v[164:167], v3, s[20:23], s31 offen offset:1024 sc1
    s_waitcnt vmcnt(0)
    v_bitop3_b32 v9, v160, v164, 1 bitop3:0x80
    v_cmp_eq_u32 vcc, 0, v9
    s_add_u32 s48, s48, 1
    s_cbranch_vccz main_kernel_backx26
    s_cmp_lt_u32 s48, 32768
    s_cbranch_scc1 main_kernel_slowx26
    s_branch main_kernel_backx26
main_kernel_slowx27:
    s_add_u32 s31, s24, 3538944
    buffer_load_dwordx4 v[168:171], v3, s[20:23], s31 offen offset:0 sc1
    buffer_load_dwordx4 v[172:175], v3, s[20:23], s31 offen offset:1024 sc1
    s_waitcnt vmcnt(0)
    v_bitop3_b32 v9, v168, v172, 1 bitop3:0x80
    v_cmp_eq_u32 vcc, 0, v9
    s_add_u32 s48, s48, 1
    s_cbranch_vccz main_kernel_backx27
    s_cmp_lt_u32 s48, 32768
    s_cbranch_scc1 main_kernel_slowx27
    s_branch main_kernel_backx27
main_kernel_slowx28:
    s_add_u32 s31, s24, 3670016
    buffer_load_dwordx4 v[176:179], v3, s[20:23], s31 offen offset:0 sc1
    buffer_load_dwordx4 v[180:183], v3, s[20:23], s31 offen offset:1024 sc1
    s_waitcnt vmcnt(0)
    v_bitop3_b32 v9, v176, v180, 1 bitop3:0x80
    v_cmp_eq_u32 vcc, 0, v9
    s_add_u32 s48, s48, 1
    s_cbranch_vccz main_kernel_backx28
    s_cmp_lt_u32 s48, 32768
    s_cbranch_scc1 main_kernel_slowx28
    s_branch main_kernel_backx28
main_kernel_slowx29:
    s_add_u32 s31, s24, 3801088
    buffer_load_dwordx4 v[184:187], v3, s[20:23], s31 offen offset:0 sc1
    buffer_load_dwordx4 v[188:191], v3, s[20:23], s31 offen offset:1024 sc1
    s_waitcnt vmcnt(0)
    v_bitop3_b32 v9, v184, v188, 1 bitop3:0x80
    v_cmp_eq_u32 vcc, 0, v9
    s_add_u32 s48, s48, 1
    s_cbranch_vccz main_kernel_backx29
    s_cmp_lt_u32 s48, 32768
    s_cbranch_scc1 main_kernel_slowx29
    s_branch main_kernel_backx29
main_kernel_slowx30:
    s_add_u32 s31, s24, 3932160
    buffer_load_dwordx4 v[112:115], v3, s[20:23], s31 offen offset:0 sc1
    buffer_load_dwordx4 v[116:119], v3, s[20:23], s31 offen offset:1024 sc1
    s_waitcnt vmcnt(0)
    v_bitop3_b32 v9, v112, v116, 1 bitop3:0x80
    v_cmp_eq_u32 vcc, 0, v9
    s_add_u32 s48, s48, 1
    s_cbranch_vccz main_kernel_backx30
    s_cmp_lt_u32 s48, 32768
    s_cbranch_scc1 main_kernel_slowx30
    s_branch main_kernel_backx30
main_kernel_slowx31:
    s_add_u32 s31, s24, 4063232
    buffer_load_dwordx4 v[120:123], v3, s[20:23], s31 offen offset:0 sc1
    buffer_load_dwordx4 v[124:127], v3, s[20:23], s31 offen offset:1024 sc1
    s_waitcnt vmcnt(0)
    v_bitop3_b32 v9, v120, v124, 1 bitop3:0x80
    v_cmp_eq_u32 vcc, 0, v9
    s_add_u32 s48, s48, 1
    s_cbranch_vccz main_kernel_backx31
    s_cmp_lt_u32 s48, 32768
    s_cbranch_scc1 main_kernel_slowx31
    s_branch main_kernel_backx31
main_kernel_slowst:
    buffer_load_dwordx4 v[192:195], v202, s[20:23], s56 offen sc1
    s_waitcnt vmcnt(0)
    v_min_u32 v203, v193, v195
    v_cmp_gt_u32 vcc, s58, v203
    s_add_u32 s48, s48, 1
    s_cbranch_vccz main_kernel_backst
    s_cmp_lt_u32 s48, 32768
    s_cbranch_scc1 main_kernel_slowst
    s_branch main_kernel_backst
main_kernel_sloww1:
    s_and_b32 s30, s14, 1
    s_mul_i32 s30, s30, 7
    s_lshr_b32 s31, s14, 1
    s_lshl_b32 s31, s31, 5
    s_add_u32 s30, s30, s31
    s_lshl_b32 s30, s30, 6
    s_add_u32 s30, s30, 27459588
    v_min_u32 v9, 6, v2
    v_lshlrev_b32 v9, 6, v9
    buffer_load_dword v9, v9, s[20:23], s30 offen sc1
    s_waitcnt vmcnt(0)
    v_cmp_eq_u32 vcc, 0, v9
    s_add_u32 s48, s48, 1
    s_cbranch_vccz main_kernel_backw1
    s_cmp_lt_u32 s48, 32768
    s_cbranch_scc1 main_kernel_sloww1
    s_branch main_kernel_backw1
main_kernel_sloww2:
    v_and_b32 v9, 7, v2
    v_mul_i32_i24 v9, -3, v9
    v_lshl_add_u32 v9, v2, 2, v9
    v_lshlrev_b32 v9, 6, v9
    buffer_load_dword v9, v9, s[20:23], s7 offen sc1
    s_waitcnt vmcnt(0)
    v_cmp_eq_u32 vcc, 0, v9
    s_add_u32 s48, s48, 1
    s_cbranch_vccz main_kernel_backw2
    s_cmp_lt_u32 s48, 32768
    s_cbranch_scc1 main_kernel_sloww2
    s_branch main_kernel_backw2
main_kernel_slowxr:
    buffer_load_dwordx4 v[208:211], v3, s[20:23], s53 offen sc1
    buffer_load_dwordx4 v[212:215], v3, s[20:23], s53 offen offset:1024 sc1
    buffer_load_dwordx4 v[216:219], v3, s[20:23], s54 offen sc1
    buffer_load_dwordx4 v[220:223], v3, s[20:23], s54 offen offset:1024 sc1
    s_waitcnt vmcnt(0)
    v_bitop3_b32 v206, v208, v212, 1 bitop3:0x80
    v_bitop3_b32 v206, v216, v220, v206 bitop3:0x80
    v_cmp_eq_u32 vcc, 0, v206
    s_add_u32 s48, s48, 1
    s_cbranch_vccz main_kernel_backxr
    s_cmp_lt_u32 s48, 32768
    s_cbranch_scc1 main_kernel_slowxr
    s_branch main_kernel_backxr
main_kernel_slowrc0:
    buffer_load_dwordx4 v[132:135], v3, s[20:23], s51 offen offset:0 sc1
    buffer_load_dwordx4 v[140:143], v3, s[20:23], s51 offen offset:1024 sc1
    s_waitcnt vmcnt(0)
    v_max3_u32 v9, v132, v133, v134
    v_max3_u32 v9, v9, v135, v140
    v_max3_u32 v9, v9, v141, v142
    v_max_u32 v9, v9, v143
    v_cmp_eq_u32 vcc, -1, v9
    s_add_u32 s48, s48, 1
    s_cbranch_vccz main_kernel_backrc0
    s_cmp_lt_u32 s48, 32768
    s_cbranch_scc1 main_kernel_slowrc0
    s_branch main_kernel_backrc0
main_kernel_slowrc1:
main_kernel_stub17:
    s_cbranch_execz main_kernel_ret
    buffer_load_dwordx4 v[148:151], v3, s[20:23], s51 offen offset:2048 sc1
    buffer_load_dwordx4 v[156:159], v3, s[20:23], s51 offen offset:3072 sc1
    s_waitcnt vmcnt(0)
    v_max3_u32 v9, v148, v149, v150
    v_max3_u32 v9, v9, v151, v156
    v_max3_u32 v9, v9, v157, v158
    v_max_u32 v9, v9, v159
    v_cmp_eq_u32 vcc, -1, v9
    s_add_u32 s48, s48, 1
    s_cbranch_vccz main_kernel_backrc1
    s_cmp_lt_u32 s48, 32768
    s_cbranch_scc1 main_kernel_slowrc1
    s_branch main_kernel_backrc1
main_kernel_ret:
    s_setpc_b64 s[92:93]
main_kernel_visit0:
    s_mov_b64 exec, 0
    s_mov_b32 s20, s4
    s_mov_b32 s21, s5
    s_mov_b32 s22, 268435456
    s_mov_b32 s23, 0x20000
    s_getpc_b64 s[60:61]
    s_add_u32 s60, s60, tab_k2@rel32@lo+4
    s_addc_u32 s61, s61, tab_k2@rel32@hi+12
    s_mov_b32 s62, 147456
    s_mov_b32 s63, 0x20000
    s_mov_b32 s32, s4
    s_mov_b32 s33, s5
    s_mov_b32 s34, 0
    s_mov_b32 s35, 0x20000
    s_cmp_lg_u32 s10, 0
    s_cbranch_scc1 main_kernel_vis0_1
    s_call_b64 s[92:93], main_kernel_stub6
    s_mov_b64 exec, -1
    s_setpc_b64 s[90:91]
main_kernel_vis0_1:
    s_cmp_lg_u32 s10, 1
    s_cbranch_scc1 main_kernel_vis0_2
    s_call_b64 s[92:93], main_kernel_stub7
    s_mov_b64 exec, -1
    s_setpc_b64 s[90:91]
main_kernel_vis0_2:
    s_cmp_lg_u32 s10, 2
    s_cbranch_scc1 main_kernel_vis0_3
    s_call_b64 s[92:93], main_kernel_stub8
    s_mov_b64 exec, -1
    s_setpc_b64 s[90:91]
main_kernel_vis0_3:
    s_call_b64 s[92:93], main_kernel_stub9
    s_mov_b64 exec, -1
    s_setpc_b64 s[90:91]
main_kernel_visit1:
    s_mov_b64 exec, 0
    s_mov_b32 s20, s4
    s_mov_b32 s21, s5
    s_mov_b32 s22, 268435456
    s_mov_b32 s23, 0x20000
    s_getpc_b64 s[60:61]
    s_add_u32 s60, s60, tab_k2@rel32@lo+4
    s_addc_u32 s61, s61, tab_k2@rel32@hi+12
    s_mov_b32 s62, 147456
    s_mov_b32 s63, 0x20000
    s_mov_b32 s32, s4
    s_mov_b32 s33, s5
    s_mov_b32 s34, 0
    s_mov_b32 s35, 0x20000
    s_cmp_lg_u32 s10, 0
    s_cbranch_scc1 main_kernel_vis1_1
    s_call_b64 s[92:93], main_kernel_stub10
    s_mov_b64 exec, -1
    s_setpc_b64 s[90:91]
main_kernel_vis1_1:
    s_cmp_lg_u32 s10, 1
    s_cbranch_scc1 main_kernel_vis1_2
    s_call_b64 s[92:93], main_kernel_stub11
    s_mov_b64 exec, -1
    s_setpc_b64 s[90:91]
main_kernel_vis1_2:
    s_cmp_lg_u32 s10, 2
    s_cbranch_scc1 main_kernel_vis1_3
    s_call_b64 s[92:93], main_kernel_stub12
    s_mov_b64 exec, -1
    s_setpc_b64 s[90:91]
main_kernel_vis1_3:
    s_call_b64 s[92:93], main_kernel_stub13
    s_mov_b64 exec, -1
    s_setpc_b64 s[90:91]
code_end:
.section .rodata,"a"
.p2align 6
.amdhsa_kernel main_kernel
  .amdhsa_next_free_vgpr 512
  .amdhsa_next_free_sgpr 102
  .amdhsa_accum_offset 256
  .amdhsa_group_segment_fixed_size 0
  .amdhsa_kernarg_size 72
  .amdhsa_user_sgpr_count 2
  .amdhsa_user_sgpr_kernarg_segment_ptr 1
  .amdhsa_system_sgpr_workgroup_id_x 1
  .amdhsa_float_denorm_mode_32 3
.end_amdhsa_kernel
.p2align 8
.type tab_k2,@object
tab_k2:
.quad 0x3f8000003f80,0x3f8000003f80,0x3e483f7b00003f80,0x3f0e3f553ec43f6d,0x3ec43f6d00003f80,0x3f6d3ec43f353f35,0x3f0e3f5500003f80,0x3f7bbe483f6d3ec4,0x3f353f3500003f80,0x3f35bf353f80248d,0x3f553f0e00003f80,0x3e48bf7b3f6dbec4,0x3f6d3ec400003f80,0xbec4bf6d3f35bf35,0x3f7b3e4800003f80,0xbf55bf0e3ec4bf6d
.quad 0x3f80248d00003f80,0xbf80a554250dbf80,0x3f7bbe4800003f80,0xbf553f0ebec4bf6d,0x3f6dbec400003f80,0xbec43f6dbf35bf35,0x3f55bf0e00003f80,0x3e483f7bbf6dbec4,0x3f35bf3500003f80,0x3f353f35bf80a554,0x3f0ebf5500003f80,0x3f7b3e48bf6d3ec4,0x3ec4bf6d00003f80,0x3f6dbec4bf353f35,0x3e48bf7b00003f80,0x3f0ebf55bec43f6d
.quad 0x3f8000003f80,0x3f8000003f80,0x3f553f0e3f353f35,0x3f7b3e483f6d3ec4,0x3f6dbec43f80248d,0x3ec4bf6d3f35bf35,0x3e48bf7b3f35bf35,0xbf55bf0ebec4bf6d,0xbf35bf35250dbf80,0xbf353f35bf80a554,0xbf7b3e48bf35bf35,0x3f0e3f55bec43f6d,0xbec43f6dbf80a554,0x3f6dbec43f353f35,0x3f0e3f55bf353f35,0xbe48bf7b3f6dbec4
.quad 0x3f8025b0a58d3f80,0xbf80a5f725d4bf80,0x3f0ebf553f353f35,0xbe483f7bbf6dbec4,0xbec4bf6d3f8025b0,0x3f6d3ec4bf353f35,0xbf7bbe483f35bf35,0x3f0ebf553ec43f6d,0xbf353f3525d4bf80,0xbf35bf353f80261f,0x3e483f7bbf35bf35,0xbf553f0e3ec4bf6d,0x3f6d3ec4bf80a5f7,0x3ec43f6dbf35bf35,0x3f55bf0ebf353f35,0x3f7bbe48bf6d3ec4
.quad 0x3f8000003f80,0x3f8000003f80,0x3f7bbe483f80248d,0x3f55bf0e3f6dbec4,0xbec4bf6d250dbf80,0xbf6dbec4bf35bf35,0xbf553f0ebf80a554,0x3e483f7bbec43f6d,0x3f353f35a58d3f80,0x3f35bf353f8025b0,0x3f0ebf553f8025b0,0xbf7bbe48bec4bf6d,0xbf6dbec425d4bf80,0x3ec43f6dbf353f35,0xbe483f7bbf80a5f7,0x3f0ebf553f6d3ec4
.quad 0x3f80261fa60d3f80,0xbf80a7312630bf80,0xbe48bf7b3f80261f,0x3f0e3f55bf6d3ec4,0xbf6d3ec42630bf80,0x3ec4bf6d3f353f35,0x3f0e3f55bf80a731,0xbf7b3e483ec4bf6d,0x3f35bf35a6543f80,0x3f353f35bf80a742,0xbf55bf0e3f80a68d,0x3e48bf7b3ec43f6d,0xbec43f6d2677bf80,0xbf6d3ec43f35bf35,0x3f7b3e48bf80a742,0x3f553f0ebf6dbec4
.quad 0x3f8000003f80,0x3f8000003f80,0x3f0ebf553f35bf35,0x3e48bf7b3ec4bf6d,0xbf6d3ec4bf80a554,0xbec43f6dbf353f35,0x3f7b3e483f353f35,0x3f0ebf553f6dbec4,0xbf35bf3525d4bf80,0xbf353f35bf80a5f7,0x3e483f7bbf353f35,0x3f55bf0e3f6d3ec4,0x3ec4bf6d3f80261f,0xbf6d3ec4bf35bf35,0xbf553f0ebf35bf35,0x3f7bbe483ec43f6d
.quad 0x3f80a68da6543f80,0xbf80a7422677bf80,0xbf55bf0e3f35bf35,0x3f7b3e48bec43f6d,0x3ec43f6dbf80a742,0xbf6dbec43f35bf35,0x3e48bf7b3f353f35,0x3f553f0ebf6d3ec4,0xbf353f35269fbf80,0xbf35bf353f80a60d,0x3f7bbe48bf353f35,0x3f0e3f55bf6dbec4,0xbf6dbec43f80a60d,0xbec4bf6d3f353f35,0x3f0e3f55bf35bf35,0x3e483f7bbec4bf6d
.quad 0x3f8000003f80,0x3f8000003f80,0xbe48bf7b250dbf80,0xbf0ebf55bec4bf6d,0x3ec43f6da58d3f80,0x3f6d3ec43f353f35,0xbf0ebf5525d4bf80,0xbf7b3e48bf6dbec4,0x3f353f35a60d3f80,0x3f35bf353f80261f,0xbf55bf0e2630bf80,0xbe483f7bbf6d3ec4,0x3f6d3ec4a6543f80,0xbec4bf6d3f35bf35,0xbf7bbe482677bf80,0x3f553f0ebec43f6d
.quad 0x3f80a654a68d3f80,0xbf80a754269fbf80,0xbf7b3e48269fbf80,0x3f55bf0e3ec43f6d,0x3f6dbec4a6b03f80,0xbec43f6dbf35bf35,0xbf553f0e27b1bf80,0xbe48bf7b3f6d3ec4,0x3f35bf35a6d43f80,0x3f353f35bf80a777,0xbf0e3f55a70dbf80,0xbf7bbe483f6dbec4,0x3ec4bf6da6f73f80,0x3f6dbec4bf353f35,0xbe483f7b27c2bf80,0xbf0e3f553ec4bf6d
.quad 0x3f8000003f80,0x3f8000003f80,0xbf55bf0ebf35bf35,0xbf7bbe48bf6dbec4,0x3f6dbec43f8025b0,0x3ec4bf6d3f35bf35,0xbe483f7bbf353f35,0x3f553f0e3ec43f6d,0xbf35bf352630bf80,0xbf353f35bf80a731,0x3f7bbe483f353f35,0xbf0ebf553ec4bf6d,0xbec43f6dbf80a742,0x3f6dbec43f353f35,0xbf0ebf553f35bf35,0x3e483f7bbf6d3ec4
.quad 0x3f80a60da6b03f80,0xbf80a76527b1bf80,0xbf0e3f55bf35bf35,0x3e48bf7b3f6d3ec4,0xbec4bf6d3f80a58e,0x3f6d3ec4bf353f35,0x3f7b3e48bf353f35,0xbf0e3f55bec4bf6d,0xbf353f3527c2bf80,0xbf35bf353f80258d,0xbe48bf7b3f353f35,0x3f55bf0ebec43f6d,0x3f6d3ec4bf80a78d,0x3ec43f6dbf35bf35,0xbf553f0e3f35bf35,0xbf7b3e483f6dbec4
.quad 0x3f8000003f80,0x3f8000003f80,0xbf7b3e48bf80a554,0xbf553f0ebf6d3ec4,0xbec4bf6d25d4bf80,0xbf6dbec4bf35bf35,0x3f55bf0e3f80261f,0xbe48bf7b3ec4bf6d,0x3f353f35a6543f80,0x3f35bf353f80a68d,0xbf0e3f55bf80a742,0x3f7b3e483ec43f6d,0xbf6dbec4269fbf80,0x3ec43f6dbf353f35,0x3e48bf7b3f80a60d,0xbf0e3f55bf6dbec4
.quad 0x3f80a58ea6d43f80,0xbf80a777a70dbf80,0x3e483f7bbf80a777,0xbf0ebf553f6dbec4,0xbf6d3ec427c2bf80,0x3ec4bf6d3f353f35,0xbf0ebf553f802804,0x3f7bbe48bec43f6d,0x3f35bf35a71f3f80,0x3f353f35bf80a796,0x3f553f0ebf802754,0xbe483f7bbec4bf6d,0xbec43f6da68dbf80,0xbf6d3ec43f35bf35,0xbf7bbe483f802889,0xbf55bf0e3f6d3ec4
.quad 0x3f8000003f80,0x3f8000003f80,0xbf0e3f55bf353f35,0xbe483f7bbec43f6d,0xbf6d3ec4bf80a5f7,0xbec43f6dbf353f35,0xbf7bbe48bf35bf35,0xbf0e3f55bf6d3ec4,0xbf35bf352677bf80,0xbf353f35bf80a742,0xbe48bf7b3f35bf35,0xbf553f0ebf6dbec4,0x3ec4bf6d3f80a60d,0xbf6d3ec4bf35bf35,0x3f55bf0e3f353f35,0xbf7b3e48bec4bf6d
.quad 0x3f80a137a6f73f80,0xbf80a78427c2bf80,0x3f553f0ebf353f35,0xbf7bbe483ec4bf6d,0x3ec43f6dbf80a78d,0xbf6dbec43f35bf35,0xbe483f7bbf35bf35,0xbf55bf0e3f6dbec4,0xbf353f35a68dbf80,0xbf35bf353f80268d,0xbf7b3e483f35bf35,0xbf0ebf553f6d3ec4,0xbf6dbec43f802816,0xbec4bf6d3f353f35,0xbf0ebf553f353f35,0xbe48bf7b3ec43f6d
.quad 0x250dbf8000003f80,0x25d4bf80a58d3f80,0xbe48bf7b00003f80,0xbf0ebf553ec43f6d,0xbec4bf6d00003f80,0xbf6dbec43f353f35,0xbf0ebf5500003f80,0xbf7b3e483f6d3ec4,0xbf35bf3500003f80,0xbf353f353f8025b0,0xbf55bf0e00003f80,0xbe483f7b3f6dbec4,0xbf6dbec400003f80,0x3ec43f6d3f35bf35,0xbf7bbe4800003f80,0x3f553f0e3ec4bf6d
.quad 0xbf80a55400003f80,0x3f80261f25d4bf80,0xbf7b3e4800003f80,0x3f55bf0ebec4bf6d,0xbf6d3ec400003f80,0x3ec4bf6dbf35bf35,0xbf553f0e00003f80,0xbe48bf7bbf6dbec4,0xbf353f3500003f80,0xbf35bf35bf80a5f7,0xbf0e3f5500003f80,0xbf7bbe48bf6d3ec4,0xbec43f6d00003f80,0xbf6d3ec4bf353f35,0xbe483f7b00003f80,0xbf0e3f55bec43f6d
.quad 0x2630bf80a60d3f80,0x2677bf80a6543f80,0xbf55bf0e3f353f35,0xbf7bbe483f6d3ec4,0xbf6d3ec43f80261f,0xbec43f6d3f35bf35,0xbe483f7b3f35bf35,0x3f553f0ebec4bf6d,0x3f353f352630bf80,0x3f35bf35bf80a742,0x3f7bbe48bf35bf35,0xbf0ebf55bec43f6d,0x3ec4bf6dbf80a731,0xbf6d3ec43f353f35,0xbf0ebf55bf353f35,0x3e483f7b3f6dbec4
.quad 0xbf80a742a6543f80,0x3f80a60d269fbf80,0xbf0e3f553f353f35,0x3e48bf7bbf6dbec4,0x3ec43f6d3f80a68d,0xbf6dbec4bf353f35,0x3f7b3e483f35bf35,0xbf0e3f553ec43f6d,0x3f35bf352677bf80,0x3f353f353f80a60d,0xbe48bf7bbf35bf35,0x3f55bf0e3ec4bf6d,0xbf6dbec4bf80a742,0xbec4bf6dbf35bf35,0xbf553f0ebf353f35,0xbf7b3e48bf6d3ec4
.quad 0x269fbf80a68d3f80,0x27b1bf80a6b03f80,0xbf7b3e483f80a654,0xbf553f0e3f6dbec4,0x3ec43f6d269fbf80,0x3f6d3ec4bf35bf35,0x3f55bf0ebf80a754,0xbe48bf7bbec43f6d,0xbf35bf35a6b03f80,0xbf353f353f80a58e,0xbf0e3f553f80a60d,0x3f7b3e48bec4bf6d,0x3f6d3ec427b1bf80,0xbec4bf6dbf353f35,0x3e48bf7bbf80a765,0xbf0e3f553f6d3ec4
.quad 0xbf80a777a6d43f80,0x3f80258d27c2bf80,0x3e483f7b3f80a58e,0xbf0ebf55bf6d3ec4,0x3f6dbec4a70dbf80,0xbec43f6d3f353f35,0xbf0ebf55bf80a777,0x3f7bbe483ec4bf6d,0xbf353f35a6f73f80,0xbf35bf35bf80a78d,0x3f553f0e3f80a137,0xbe483f7b3ec43f6d,0x3ec4bf6d27c2bf80,0x3f6dbec43f35bf35,0xbf7bbe48bf80a784,0xbf55bf0ebf6dbec4
.quad 0xa70dbf80a6d43f80,0x27c2bf80a6f73f80,0xbf0e3f553f35bf35,0xbe483f7b3ec4bf6d,0x3f6dbec4bf80a777,0x3ec4bf6dbf353f35,0xbf7bbe483f353f35,0xbf0e3f553f6dbec4,0x3f353f3527c2bf80,0x3f35bf35bf80a78d,0xbe48bf7bbf353f35,0xbf553f0e3f6d3ec4,0xbec43f6d3f802804,0x3f6dbec4bf35bf35,0x3f55bf0ebf35bf35,0xbf7b3e483ec43f6d
.quad 0xbf80a796a71f3f80,0x3f80268da68dbf80,0x3f553f0e3f35bf35,0xbf7bbe48bec43f6d,0xbec4bf6dbf802754,0x3f6d3ec43f35bf35,0xbe483f7b3f353f35,0xbf55bf0ebf6d3ec4,0x3f35bf35a68dbf80,0x3f353f353f802816,0xbf7b3e48bf353f35,0xbf0ebf55bf6dbec4,0x3f6d3ec43f802889,0x3ec43f6d3f353f35,0xbf0ebf55bf35bf35,0xbe48bf7bbec4bf6d
.quad 0xa6d4bf80a70d3f80,0x27d4bf80a71f3f80,0x3e483f7ba6d4bf80,0x3f0e3f55bec4bf6d,0xbec4bf6da71f3f80,0xbf6dbec43f353f35,0x3f0e3f5527d4bf80,0x3f7bbe48bf6dbec4,0xbf35bf35a7303f80,0xbf353f353f80268d,0x3f553f0ea68dbf80,0x3e48bf7bbf6d3ec4,0xbf6dbec4a8313f80,0x3ec43f6d3f35bf35,0x3f7b3e4827e5bf80,0xbf55bf0ebec43f6d
.quad 0xbf80a7b1a7543f80,0x3f80281f27f7bf80,0x3f7bbe48a60ebf80,0xbf553f0e3ec43f6d,0xbf6d3ec4278d3f80,0x3ec4bf6dbf35bf35,0x3f55bf0e27f7bf80,0x3e483f7b3f6d3ec4,0xbf353f35a7773f80,0xbf35bf35bf8026d4,0x3f0ebf55a1b7bf80,0x3f7b3e483f6dbec4,0xbec43f6da8423f80,0xbf6d3ec4bf353f35,0x3e48bf7b2804bf80,0x3f0ebf553ec4bf6d
.quad 0xa68dbf80a7303f80,0x27e5bf80a8313f80,0x3f553f0ebf35bf35,0x3f7b3e48bf6dbec4,0xbf6d3ec43f80268d,0xbec43f6d3f35bf35,0x3e48bf7bbf353f35,0xbf55bf0e3ec43f6d,0x3f353f35a60ebf80,0x3f35bf35bf80270d,0xbf7b3e483f353f35,0x3f0e3f553ec4bf6d,0x3ec4bf6dbf80a85d,0xbf6d3ec43f353f35,0x3f0e3f553f35bf35,0xbe48bf7bbf6d3ec4
.quad 0xbf8026d4a8423f80,0x3f802730260dbf80,0x3f0ebf55bf35bf35,0xbe483f7b3f6d3ec4,0x3ec43f6d3f80a7b1,0xbf6dbec4bf353f35,0xbf7bbe48bf353f35,0x3f0ebf55bec4bf6d,0x3f35bf35280dbf80,0x3f353f353f802754,0x3e483f7b3f353f35,0xbf553f0ebec43f6d,0xbf6dbec4bf80a7e5,0xbec4bf6dbf35bf35,0x3f55bf0e3f35bf35,0x3f7bbe483f6dbec4
.quad 0xa60ebf80a7543f80,0x27f7bf80278d3f80,0x3f7bbe48bf802828,0x3f55bf0ebf6d3ec4,0x3ec43f6d27f7bf80,0x3f6d3ec4bf35bf35,0xbf553f0e3f80281f,0x3e483f7b3ec4bf6d,0xbf35bf35a8423f80,0xbf353f353f802828,0x3f0ebf55bf8026d4,0xbf7bbe483ec43f6d,0x3f6d3ec42884bf80,0xbec4bf6dbf353f35,0xbe483f7b3f802730,0x3f0ebf55bf6dbec4
.quad 0xbf80a7e5a79f3f80,0x3f8028392816bf80,0xbe48bf7bbf80a7e5,0x3f0e3f553f6dbec4,0x3f6dbec4a7d4bf80,0xbec43f6d3f353f35,0x3f0e3f553f802839,0xbf7b3e48bec43f6d,0xbf353f35270d3f80,0xbf35bf35bf80a804,0xbf55bf0ebf80a880,0x3e48bf7bbec4bf6d,0x3ec4bf6d2909bf80,0x3f6dbec43f35bf35,0x3f7b3e483f8028a3,0x3f553f0e3f6d3ec4
.quad 0xa1b7bf80a7773f80,0x2804bf80a8423f80,0x3f0ebf55bf353f35,0x3e48bf7bbec43f6d,0x3f6dbec4bf8026d4,0x3ec4bf6dbf353f35,0x3f7b3e48bf35bf35,0x3f0ebf55bf6d3ec4,0x3f353f35280dbf80,0x3f35bf35bf80a7e5,0x3e483f7b3f35bf35,0x3f55bf0ebf6dbec4,0xbec43f6d3f80289a,0x3f6dbec4bf35bf35,0xbf553f0e3f353f35,0x3f7bbe48bec4bf6d
.quad 0xbf80a880270d3f80,0x3f8028a3270dbf80,0xbf55bf0ebf353f35,0x3f7b3e483ec4bf6d,0xbec4bf6dbf8028be,0x3f6d3ec43f35bf35,0x3e48bf7bbf35bf35,0x3f553f0e3f6dbec4,0x3f35bf352896bf80,0x3f353f353f80a731,0x3f7bbe483f35bf35,0x3f0e3f553f6d3ec4,0x3f6d3ec43f8028ea,0x3ec43f6d3f353f35,0x3f0e3f553f353f35,0x3e483f7b3ec43f6d
.quad 0x3f8080003f808000,0x3f8080003f808000,0x3f7bbe483f808000,0x3f55bf0e3f6dbec4,0x3f6dbec43f808000,0x3ec4bf6d3f35bf35,0x3f55bf0e3f808000,0xbe48bf7b3ec4bf6d,0x3f35bf353f808000,0xbf35bf35248dbf80,0x3f0ebf553f808000,0xbf7bbe48bec4bf6d,0x3ec4bf6d3f808000,0xbf6d3ec4bf35bf35,0x3e48bf7b3f808000,0xbf0e3f55bf6dbec4
.quad 0x248dbf803f808000,0xa5543f80bf80a50d,0xbe48bf7b3f808000,0x3f0e3f55bf6d3ec4,0xbec4bf6d3f808000,0x3f6d3ec4bf353f35,0xbf0ebf553f808000,0x3f7bbe48bec43f6d,0xbf35bf353f808000,0x3f35bf35a5543f80,0xbf55bf0e3f808000,0x3e48bf7b3ec43f6d,0xbf6dbec43f808000,0xbec4bf6d3f353f35,0xbf7bbe483f808000,0xbf55bf0e3f6d3ec4
.quad 0x3f8080003f808000,0x3f8080003f808000,0x3f0ebf553f35bf35,0x3e48bf7b3ec4bf6d,0xbec4bf6d248dbf80,0xbf6dbec4bf35bf35,0xbf7bbe48bf35bf35,0xbf0e3f55bf6d3ec4,0xbf353f35bf80a50d,0x3f353f35a5543f80,0x3e483f7bbf353f35,0x3f55bf0e3f6d3ec4,0x3f6d3ec4a5543f80,0xbec4bf6d3f35bf35,0x3f55bf0e3f353f35,0xbf7b3e48bec4bf6d
.quad 0x25b0bf803f80258d,0xa5f73f80bf80a5d4,0xbf55bf0e3f35bf35,0x3f7b3e48bec43f6d,0xbf6d3ec425b0bf80,0x3ec4bf6d3f353f35,0xbe483f7bbf35bf35,0xbf55bf0e3f6dbec4,0x3f353f35bf80a5d4,0xbf353f35261fbf80,0x3f7bbe48bf353f35,0x3f0e3f55bf6dbec4,0x3ec4bf6da5f73f80,0x3f6dbec4bf353f35,0xbf0ebf553f353f35,0xbe48bf7b3ec43f6d
.quad 0x3f8080003f808000,0x3f8080003f808000,0xbe48bf7b248dbf80,0xbf0ebf55bec4bf6d,0xbf6d3ec4bf80a50d,0xbec43f6dbf353f35,0x3f0e3f55a5543f80,0x3f7bbe483f6d3ec4,0x3f35bf353f80258d,0xbf35bf3525b0bf80,0xbf55bf0e25b0bf80,0xbe483f7bbf6d3ec4,0xbec43f6dbf80a5d4,0x3f6dbec43f353f35,0x3f7b3e48a5f73f80,0xbf55bf0e3ec4bf6d
.quad 0x261fbf803f80260d,0xa7313f80bf80a630,0xbf7b3e48261fbf80,0x3f55bf0e3ec43f6d,0x3ec43f6dbf80a630,0xbf6dbec43f35bf35,0x3f55bf0ea7313f80,0x3e483f7bbf6dbec4,0xbf35bf353f802654,0x3f35bf35a7423f80,0xbf0e3f55a68dbf80,0xbf7bbe483f6dbec4,0x3f6d3ec4bf80a677,0x3ec43f6dbf35bf35,0x3e48bf7ba7423f80,0x3f0ebf55bec43f6d
.quad 0x3f8080003f808000,0x3f8080003f808000,0xbf55bf0ebf35bf35,0xbf7bbe48bf6dbec4,0x3ec43f6da5543f80,0x3f6d3ec43f353f35,0x3e48bf7b3f35bf35,0xbf55bf0ebec4bf6d,0xbf353f35bf80a5d4,0x3f353f35a5f73f80,0x3f7bbe483f353f35,0xbf0ebf553ec4bf6d,0xbf6dbec4261fbf80,0x3ec43f6dbf353f35,0x3f0e3f55bf353f35,0xbe48bf7b3f6dbec4
.quad 0xa68dbf803f802654,0xa7423f80bf80a677,0xbf0e3f55bf35bf35,0x3e48bf7b3f6d3ec4,0x3f6dbec4a7423f80,0xbec43f6dbf35bf35,0xbf7bbe483f35bf35,0x3f0ebf553ec43f6d,0x3f353f35bf80a69f,0xbf353f35a60dbf80,0xbe48bf7b3f353f35,0x3f55bf0ebec43f6d,0xbec43f6da60dbf80,0xbf6d3ec43f35bf35,0x3f55bf0ebf353f35,0x3f7bbe48bf6d3ec4
.quad 0x3f8080003f808000,0x3f8080003f808000,0xbf7b3e48bf80a50d,0xbf553f0ebf6d3ec4,0x3f6dbec43f80258d,0x3ec4bf6d3f35bf35,0xbf553f0ebf80a5d4,0x3e483f7bbec43f6d,0x3f35bf353f80260d,0xbf35bf35261fbf80,0xbf0e3f55bf80a630,0x3f7b3e483ec43f6d,0x3ec4bf6d3f802654,0xbf6d3ec4bf35bf35,0xbe483f7bbf80a677,0x3f0ebf553f6d3ec4
.quad 0xa654bf803f80268d,0xa7543f80bf80a69f,0x3e483f7bbf80a69f,0xbf0ebf553f6dbec4,0xbec4bf6d3f8026b0,0x3f6d3ec4bf353f35,0x3f0e3f55bf80a7b1,0xbf7b3e483ec4bf6d,0xbf35bf353f8026d4,0x3f35bf35a7773f80,0x3f553f0ebf80270d,0xbe483f7bbec4bf6d,0xbf6dbec43f8026f7,0xbec4bf6d3f353f35,0x3f7b3e48bf80a7c2,0x3f553f0ebf6dbec4
.quad 0x3f8080003f808000,0x3f8080003f808000,0xbf0e3f55bf353f35,0xbe483f7bbec43f6d,0xbec4bf6d25b0bf80,0xbf6dbec4bf35bf35,0x3f7b3e483f353f35,0x3f0ebf553f6dbec4,0xbf353f35bf80a630,0x3f353f35a7313f80,0xbe48bf7b3f35bf35,0xbf553f0ebf6dbec4,0x3f6d3ec4a7423f80,0xbec4bf6d3f35bf35,0xbf553f0ebf35bf35,0x3f7bbe483ec43f6d
.quad 0xa60dbf803f8026b0,0xa7653f80bf80a7b1,0x3f553f0ebf353f35,0xbf7bbe483ec4bf6d,0xbf6d3ec4a58ebf80,0x3ec4bf6d3f353f35,0x3e48bf7b3f353f35,0x3f553f0ebf6d3ec4,0x3f353f35bf80a7c2,0xbf353f35258dbf80,0xbf7b3e483f35bf35,0xbf0ebf553f6d3ec4,0x3ec4bf6da78d3f80,0x3f6dbec4bf353f35,0x3f0e3f55bf35bf35,0x3e483f7bbec4bf6d
.quad 0x3f8080003f808000,0x3f8080003f808000,0x3e483f7ba5543f80,0x3f0e3f553ec43f6d,0xbf6d3ec4bf80a5d4,0xbec43f6dbf353f35,0xbf0ebf55261fbf80,0xbf7b3e48bf6dbec4,0x3f35bf353f802654,0xbf35bf35a68dbf80,0x3f553f0ea7423f80,0x3e48bf7b3f6dbec4,0xbec43f6dbf80a69f,0x3f6dbec43f353f35,0xbf7bbe48a60dbf80,0x3f553f0ebec43f6d
.quad 0xa58ebf803f8026d4,0xa7773f80bf80270d,0x3f7bbe48a7773f80,0xbf553f0ebec4bf6d,0x3ec43f6dbf80a7c2,0xbf6dbec43f35bf35,0xbf553f0e2804bf80,0xbe48bf7b3f6d3ec4,0xbf35bf353f80271f,0x3f35bf35a7963f80,0x3f0ebf5527543f80,0x3f7b3e48bf6d3ec4,0x3f6d3ec4bf80268d,0x3ec43f6dbf35bf35,0xbe483f7b2889bf80,0xbf0e3f553ec4bf6d
.quad 0x3f8080003f808000,0x3f8080003f808000,0x3f553f0e3f353f35,0x3f7b3e483f6d3ec4,0x3ec43f6da5f73f80,0x3f6d3ec43f353f35,0xbe483f7bbf353f35,0x3f553f0e3ec43f6d,0xbf353f35bf80a677,0x3f353f35a7423f80,0xbf7b3e48bf35bf35,0x3f0e3f55bec43f6d,0xbf6dbec4a60dbf80,0x3ec43f6dbf353f35,0xbf0ebf553f35bf35,0x3e483f7bbf6d3ec4
.quad 0xa137bf803f8026f7,0xa7843f80bf80a7c2,0x3f0ebf553f353f35,0xbe483f7bbf6dbec4,0x3f6dbec4a78d3f80,0xbec43f6dbf35bf35,0x3f7b3e48bf353f35,0xbf0e3f55bec4bf6d,0x3f353f35bf80268d,0xbf353f35268dbf80,0x3e483f7bbf35bf35,0xbf553f0e3ec4bf6d,0xbec43f6d2816bf80,0xbf6d3ec43f35bf35,0xbf553f0e3f35bf35,0xbf7b3e483f6dbec4
.quad 0xbf80a50d3f808000,0xbf80a5d43f80258d,0xbf7b3e483f808000,0xbf553f0e3f6dbec4,0xbf6d3ec43f808000,0xbec43f6d3f35bf35,0xbf553f0e3f808000,0x3e483f7b3ec4bf6d,0xbf353f353f808000,0x3f353f3525b0bf80,0xbf0e3f553f808000,0x3f7b3e48bec4bf6d,0xbec43f6d3f808000,0x3f6dbec4bf35bf35,0xbe483f7b3f808000,0x3f0ebf55bf6dbec4
.quad 0xa5543f803f808000,0x261fbf80bf80a5d4,0x3e483f7b3f808000,0xbf0ebf55bf6d3ec4,0x3ec43f6d3f808000,0xbf6dbec4bf353f35,0x3f0e3f553f808000,0xbf7b3e48bec43f6d,0x3f353f353f808000,0xbf353f35a5f73f80,0x3f553f0e3f808000,0xbe483f7b3ec43f6d,0x3f6d3ec43f808000,0x3ec43f6d3f353f35,0x3f7b3e483f808000,0x3f553f0e3f6d3ec4
.quad 0xbf80a6303f80260d,0xbf80a6773f802654,0xbf0e3f553f35bf35,0xbe483f7b3ec4bf6d,0x3ec43f6d261fbf80,0x3f6d3ec4bf35bf35,0x3f7b3e48bf35bf35,0x3f0ebf55bf6d3ec4,0x3f35bf35bf80a630,0xbf35bf35a7423f80,0xbe48bf7bbf353f35,0xbf553f0e3f6d3ec4,0xbf6dbec4a7313f80,0x3ec43f6d3f35bf35,0xbf553f0e3f353f35,0x3f7bbe48bec4bf6d
.quad 0xa7423f803f802654,0xa60dbf80bf80a69f,0x3f553f0e3f35bf35,0xbf7bbe48bec43f6d,0x3f6dbec4a68dbf80,0xbec43f6d3f353f35,0x3e48bf7bbf35bf35,0x3f553f0e3f6dbec4,0xbf35bf35bf80a677,0x3f35bf35a60dbf80,0xbf7b3e48bf353f35,0xbf0ebf55bf6dbec4,0xbec43f6da7423f80,0xbf6d3ec4bf353f35,0x3f0e3f553f353f35,0x3e483f7b3ec43f6d
.quad 0xbf80a69f3f80268d,0xbf80a7b13f8026b0,0x3e483f7ba654bf80,0x3f0e3f55bec4bf6d,0x3f6dbec4bf80a69f,0x3ec4bf6dbf353f35,0xbf0ebf55a7543f80,0xbf7b3e483f6d3ec4,0xbf353f353f8026b0,0x3f353f35a58ebf80,0x3f553f0ea60dbf80,0x3e48bf7bbf6d3ec4,0x3ec4bf6dbf80a7b1,0xbf6d3ec43f353f35,0xbf7bbe48a7653f80,0x3f553f0e3ec4bf6d
.quad 0xa7773f803f8026d4,0x258dbf80bf80a7c2,0x3f7bbe48a58ebf80,0xbf553f0e3ec43f6d,0xbec4bf6dbf80270d,0x3f6d3ec43f35bf35,0xbf553f0ea7773f80,0xbe48bf7bbf6dbec4,0x3f353f353f8026f7,0xbf353f35a78d3f80,0x3f0ebf55a137bf80,0x3f7b3e483f6dbec4,0xbf6dbec4bf80a7c2,0xbec4bf6dbf35bf35,0xbe483f7ba7843f80,0xbf0e3f55bec43f6d
.quad 0xbf80270d3f8026d4,0xbf80a7c23f8026f7,0x3f553f0ebf35bf35,0x3f7b3e48bf6dbec4,0xbec4bf6da7773f80,0xbf6dbec43f353f35,0xbe483f7b3f35bf35,0x3f553f0ebec4bf6d,0x3f35bf35bf80a7c2,0xbf35bf35a78d3f80,0xbf7b3e483f353f35,0x3f0e3f553ec4bf6d,0x3f6d3ec42804bf80,0xbec4bf6dbf353f35,0xbf0ebf55bf353f35,0x3e483f7b3f6dbec4
.quad 0xa7963f803f80271f,0x268dbf80bf80268d,0x3f0ebf55bf35bf35,0xbe483f7b3f6d3ec4,0xbf6d3ec427543f80,0x3ec4bf6dbf35bf35,0x3f7b3e483f35bf35,0xbf0e3f553ec43f6d,0xbf35bf35bf80268d,0x3f35bf352816bf80,0x3e483f7b3f353f35,0xbf553f0ebec43f6d,0x3ec4bf6d2889bf80,0x3f6dbec43f35bf35,0xbf553f0ebf353f35,0xbf7b3e48bf6d3ec4
.quad 0xbf8026d43f80270d,0xbf80a7d43f80271f,0x3f7bbe48bf8026d4,0x3f55bf0ebf6d3ec4,0xbf6d3ec43f80271f,0xbec43f6d3f35bf35,0x3f55bf0ebf80a7d4,0xbe48bf7bbec43f6d,0xbf353f353f802730,0x3f353f35268dbf80,0x3f0ebf55bf80268d,0xbf7bbe483ec43f6d,0xbec43f6d3f802831,0x3f6dbec4bf35bf35,0x3e48bf7bbf80a7e5,0xbf0e3f553f6d3ec4
.quad 0xa7b13f803f802754,0x281fbf80bf80a7f7,0xbe48bf7bbf80260e,0x3f0e3f553f6dbec4,0x3ec43f6d3f80a78d,0xbf6dbec4bf353f35,0xbf0ebf55bf80a7f7,0x3f7bbe483ec4bf6d,0x3f353f353f802777,0xbf353f3526d43f80,0xbf55bf0ebf8021b7,0x3e48bf7bbec4bf6d,0x3f6d3ec43f802842,0x3ec43f6d3f353f35,0xbf7bbe48bf80a804,0xbf55bf0ebf6dbec4
.quad 0xbf80268d3f802730,0xbf80a7e53f802831,0x3f0ebf55bf353f35,0x3e48bf7bbec43f6d,0x3ec43f6d268dbf80,0x3f6d3ec4bf35bf35,0xbf7bbe483f353f35,0xbf0e3f553f6dbec4,0x3f35bf35bf80260e,0xbf35bf35270d3f80,0x3e483f7b3f35bf35,0x3f55bf0ebf6dbec4,0xbf6dbec4a85d3f80,0x3ec43f6d3f35bf35,0x3f55bf0ebf35bf35,0xbf7b3e483ec43f6d
.quad 0x26d43f803f802842,0x2730bf80bf80a60d,0xbf55bf0ebf353f35,0x3f7b3e483ec4bf6d,0x3f6dbec4a7b1bf80,0xbec43f6d3f353f35,0xbe483f7b3f353f35,0xbf55bf0ebf6d3ec4,0xbf35bf35bf80a80d,0x3f35bf352754bf80,0x3f7bbe483f35bf35,0x3f0e3f553f6d3ec4,0xbec43f6da7e53f80,0xbf6d3ec4bf353f35,0xbf0ebf55bf35bf35,0xbe48bf7bbec4bf6d
.quad 0xbf80260e3f802754,0xbf80a7f73f80a78d,0xbe48bf7b28283f80,0xbf0ebf553ec43f6d,0x3f6dbec4bf80a7f7,0x3ec4bf6dbf353f35,0x3f0e3f55281fbf80,0x3f7bbe48bf6dbec4,0xbf353f353f802842,0x3f353f352828bf80,0xbf55bf0e26d43f80,0xbe483f7b3f6dbec4,0x3ec4bf6dbf80a884,0xbf6d3ec43f353f35,0x3f7b3e482730bf80,0xbf55bf0ebec43f6d
.quad 0xa7e53f803f80279f,0x2839bf80bf80a816,0xbf7b3e48a7e53f80,0x3f55bf0ebec4bf6d,0xbec4bf6dbf8027d4,0x3f6d3ec43f35bf35,0x3f55bf0e2839bf80,0x3e483f7b3f6d3ec4,0x3f353f353f80a70d,0xbf353f35a8043f80,0xbf0e3f55a8803f80,0xbf7bbe48bf6d3ec4,0xbf6dbec4bf80a909,0xbec4bf6dbf35bf35,0x3e48bf7b28a3bf80,0x3f0ebf553ec4bf6d
.quad 0xbf8021b73f802777,0xbf80a8043f802842,0xbf55bf0e3f353f35,0xbf7bbe483f6d3ec4,0xbec4bf6d26d43f80,0xbf6dbec43f353f35,0x3e48bf7bbf353f35,0xbf55bf0e3ec43f6d,0x3f35bf35bf80a80d,0xbf35bf35a7e53f80,0x3f7bbe48bf35bf35,0xbf0ebf55bec43f6d,0x3f6d3ec4289abf80,0xbec4bf6dbf353f35,0x3f0e3f553f35bf35,0xbe48bf7bbf6d3ec4
.quad 0xa8803f803f80a70d,0x28a3bf80bf80a70d,0xbf0e3f553f353f35,0x3e48bf7bbf6dbec4,0xbf6d3ec428be3f80,0x3ec4bf6dbf35bf35,0xbf7bbe48bf353f35,0x3f0ebf55bec4bf6d,0xbf35bf35bf80a896,0x3f35bf35a731bf80,0xbe48bf7bbf35bf35,0x3f55bf0e3ec4bf6d,0x3ec4bf6d28eabf80,0x3f6dbec43f35bf35,0x3f55bf0e3f35bf35,0x3f7bbe483f6dbec4
.quad 0x3f8000003f80,0x3f8000003f80,0x3dc93f7f00003f80,0x3e953f753e483f7b,0x3e483f7b00003f80,0x3f0e3f553ec43f6d,0x3e953f7500003f80,0x3f463f223f0e3f55,0x3ec43f6d00003f80,0x3f6d3ec43f353f35,0x3ef13f6200003f80,0x3f7f3dc93f553f0e,0x3f0e3f5500003f80,0x3f7bbe483f6d3ec4,0x3f223f4600003f80,0x3f62bef13f7b3e48
.quad 0x3f353f3500003f80,0x3f35bf353f80248d,0x3f463f2200003f80,0x3ef1bf623f7bbe48,0x3f553f0e00003f80,0x3e48bf7b3f6dbec4,0x3f623ef100003f80,0xbdc9bf7f3f55bf0e,0x3f6d3ec400003f80,0xbec4bf6d3f35bf35,0x3f753e9500003f80,0xbf22bf463f0ebf55,0x3f7b3e4800003f80,0xbf55bf0e3ec4bf6d,0x3f7f3dc900003f80,0xbf75be953e48bf7b
.quad 0x3f8000003f80,0x3f8000003f80,0x3ef13f623ec43f6d,0x3f223f463f0e3f55,0x3f553f0e3f353f35,0x3f7b3e483f6d3ec4,0x3f7f3dc93f6d3ec4,0x3f62bef13f7bbe48,0x3f6dbec43f80248d,0x3ec4bf6d3f35bf35,0x3f22bf463f6dbec4,0xbe95bf753e48bf7b,0x3e48bf7b3f35bf35,0xbf55bf0ebec4bf6d,0xbe95bf753ec4bf6d,0xbf7f3dc9bf55bf0e
.quad 0xbf35bf35250dbf80,0xbf353f35bf80a554,0xbf75be95bec4bf6d,0xbdc93f7fbf553f0e,0xbf7b3e48bf35bf35,0x3f0e3f55bec43f6d,0xbf463f22bf6dbec4,0x3f753e953e483f7b,0xbec43f6dbf80a554,0x3f6dbec43f353f35,0x3dc93f7fbf6d3ec4,0x3ef1bf623f7b3e48,0x3f0e3f55bf353f35,0xbe48bf7b3f6dbec4,0x3f623ef1bec43f6d,0xbf46bf223f0ebf55
.quad 0x3f8000003f80,0x3f8000003f80,0x3f463f223f353f35,0x3f623ef13f553f0e,0x3f7bbe483f80248d,0x3f55bf0e3f6dbec4,0x3ef1bf623f35bf35,0xbdc9bf7f3e48bf7b,0xbec4bf6d250dbf80,0xbf6dbec4bf35bf35,0xbf75be95bf35bf35,0xbf463f22bf7b3e48,0xbf553f0ebf80a554,0x3e483f7bbec43f6d,0xbdc93f7fbf353f35,0x3f753e953f0e3f55
.quad 0x3f353f35a58d3f80,0x3f35bf353f8025b0,0x3f7fbdc93f353f35,0xbe95bf753f0ebf55,0x3f0ebf553f8025b0,0xbf7bbe48bec4bf6d,0xbe95bf753f35bf35,0xbf223f46bf7bbe48,0xbf6dbec425d4bf80,0x3ec43f6dbf353f35,0xbf623ef1bf35bf35,0x3f7f3dc93e483f7b,0xbe483f7bbf80a5f7,0x3f0ebf553f6d3ec4,0x3f223f46bf353f35,0xbef1bf623f55bf0e
.quad 0x3f8000003f80,0x3f8000003f80,0x3f753e953f6d3ec4,0x3f7f3dc93f7b3e48,0x3f0ebf553f35bf35,0x3e48bf7b3ec4bf6d,0xbf22bf46bec4bf6d,0xbf75be95bf55bf0e,0xbf6d3ec4bf80a554,0xbec43f6dbf353f35,0x3dc93f7fbec43f6d,0x3f623ef13f0e3f55,0x3f7b3e483f353f35,0x3f0ebf553f6dbec4,0x3ef1bf623f6dbec4,0xbf46bf22be48bf7b
.quad 0xbf35bf3525d4bf80,0xbf353f35bf80a5f7,0xbf623ef1bf6dbec4,0x3f223f46be483f7b,0x3e483f7bbf353f35,0x3f55bf0e3f6d3ec4,0x3f7f3dc93ec43f6d,0xbef1bf623f0ebf55,0x3ec4bf6d3f80261f,0xbf6d3ec4bf35bf35,0xbf46bf223ec4bf6d,0x3e953f75bf553f0e,0xbf553f0ebf35bf35,0x3f7bbe483ec43f6d,0x3e953f75bf6d3ec4,0xbdc9bf7f3f7bbe48
.quad 0x3f8000003f80,0x3f8000003f80,0x3f7fbdc93f80248d,0x3f75be953f7bbe48,0xbe48bf7b250dbf80,0xbf0ebf55bec4bf6d,0xbf753e95bf80a554,0xbf223f46bf553f0e,0x3ec43f6da58d3f80,0x3f6d3ec43f353f35,0x3f62bef13f8025b0,0x3dc9bf7f3f0ebf55,0xbf0ebf5525d4bf80,0xbf7b3e48bf6dbec4,0xbf463f22bf80a5f7,0x3ef13f62be483f7b
.quad 0x3f353f35a60d3f80,0x3f35bf353f80261f,0x3f22bf463f80261f,0xbf62bef1be48bf7b,0xbf55bf0e2630bf80,0xbe483f7bbf6d3ec4,0xbef13f62bf80a731,0x3f7fbdc93f0e3f55,0x3f6d3ec4a6543f80,0xbec4bf6d3f35bf35,0x3e95bf753f80a68d,0xbf463f22bf55bf0e,0xbf7bbe482677bf80,0x3f553f0ebec43f6d,0xbdc93f7fbf80a742,0x3e95bf753f7b3e48
.quad 0x3f8000003f80,0x3f8000003f80,0x3f62bef13f6dbec4,0x3f46bf223f55bf0e,0xbf55bf0ebf35bf35,0xbf7bbe48bf6dbec4,0xbdc93f7fbec43f6d,0x3ef13f623e483f7b,0x3f6dbec43f8025b0,0x3ec4bf6d3f35bf35,0xbf46bf22bec4bf6d,0xbf753e95bf7bbe48,0xbe483f7bbf353f35,0x3f553f0e3ec43f6d,0x3f75be953f6d3ec4,0xbdc9bf7f3f0ebf55
.quad 0xbf35bf352630bf80,0xbf353f35bf80a731,0xbe953f75bf6d3ec4,0x3f7f3dc93f0e3f55,0x3f7bbe483f353f35,0xbf0ebf553ec4bf6d,0xbf22bf463ec4bf6d,0xbe953f75bf7b3e48,0xbec43f6dbf80a742,0x3f6dbec43f353f35,0x3f7fbdc93ec43f6d,0xbf62bef13e48bf7b,0xbf0ebf553f35bf35,0x3e483f7bbf6d3ec4,0xbef13f62bf6dbec4,0x3f22bf463f553f0e
.quad 0x3f8000003f80,0x3f8000003f80,0x3f22bf463f35bf35,0x3ef1bf623f0ebf55,0xbf7b3e48bf80a554,0xbf553f0ebf6d3ec4,0x3f623ef13f353f35,0x3f7fbdc93f7b3e48,0xbec4bf6d25d4bf80,0xbf6dbec4bf35bf35,0xbe953f75bf353f35,0x3f223f463e483f7b,0x3f55bf0e3f80261f,0xbe48bf7b3ec4bf6d,0xbf7fbdc9bf35bf35,0xbe953f75bf553f0e
.quad 0x3f353f35a6543f80,0x3f35bf353f80a68d,0xbdc9bf7f3f35bf35,0xbf753e95bf55bf0e,0xbf0e3f55bf80a742,0x3f7b3e483ec43f6d,0x3f75be953f353f35,0xbf46bf223e48bf7b,0xbf6dbec4269fbf80,0x3ec43f6dbf353f35,0x3ef13f62bf353f35,0x3dc9bf7f3f7bbe48,0x3e48bf7b3f80a60d,0xbf0e3f55bf6dbec4,0xbf463f22bf35bf35,0x3f62bef13f0e3f55
.quad 0x3f8000003f80,0x3f8000003f80,0x3e95bf753ec4bf6d,0x3dc9bf7f3e48bf7b,0xbf0e3f55bf353f35,0xbe483f7bbec43f6d,0x3f46bf223f6dbec4,0x3e95bf753f0ebf55,0xbf6d3ec4bf80a5f7,0xbec43f6dbf353f35,0x3f7fbdc93f6d3ec4,0x3ef1bf623f55bf0e,0xbf7bbe48bf35bf35,0xbf0e3f55bf6d3ec4,0x3f623ef13ec43f6d,0x3f22bf463f7bbe48
.quad 0xbf35bf352677bf80,0xbf353f35bf80a742,0x3ef13f62bec43f6d,0x3f46bf223f7b3e48,0xbe48bf7b3f35bf35,0xbf553f0ebf6dbec4,0xbdc93f7fbf6d3ec4,0x3f62bef13f553f0e,0x3ec4bf6d3f80a60d,0xbf6d3ec4bf35bf35,0xbf223f46bf6dbec4,0x3f75be953f0e3f55,0x3f55bf0e3f353f35,0xbf7b3e48bec4bf6d,0xbf753e95bec4bf6d,0x3f7fbdc93e483f7b
.quad 0x3f8000003f80,0x3f8000003f80,0xbdc9bf7f250dbf80,0xbe95bf75be48bf7b,0x3e483f7ba58d3f80,0x3f0e3f553ec43f6d,0xbe95bf7525d4bf80,0xbf46bf22bf0ebf55,0x3ec43f6da60d3f80,0x3f6d3ec43f353f35,0xbef1bf622630bf80,0xbf7fbdc9bf55bf0e,0x3f0e3f55a6543f80,0x3f7bbe483f6d3ec4,0xbf22bf462677bf80,0xbf623ef1bf7bbe48
.quad 0x3f353f35a68d3f80,0x3f35bf353f80a654,0xbf46bf22269fbf80,0xbef13f62bf7b3e48,0x3f553f0ea6b03f80,0x3e48bf7b3f6dbec4,0xbf62bef127b1bf80,0x3dc93f7fbf553f0e,0x3f6d3ec4a6d43f80,0xbec4bf6d3f35bf35,0xbf75be95a70dbf80,0x3f223f46bf0e3f55,0x3f7b3e48a6f73f80,0xbf55bf0e3ec4bf6d,0xbf7fbdc927c2bf80,0x3f753e95be483f7b
.quad 0x3f8000003f80,0x3f8000003f80,0xbef1bf62bec4bf6d,0xbf22bf46bf0ebf55,0x3f553f0e3f353f35,0x3f7b3e483f6d3ec4,0xbf7fbdc9bf6dbec4,0xbf623ef1bf7b3e48,0x3f6dbec43f80261f,0x3ec4bf6d3f35bf35,0xbf223f46bf6d3ec4,0x3e953f75be483f7b,0x3e48bf7b3f35bf35,0xbf55bf0ebec4bf6d,0x3e953f75bec43f6d,0x3f7fbdc93f553f0e
.quad 0xbf35bf35269fbf80,0xbf353f35bf80a754,0x3f753e953ec43f6d,0x3dc9bf7f3f55bf0e,0xbf7b3e48bf35bf35,0x3f0e3f55bec43f6d,0x3f46bf223f6d3ec4,0xbf75be95be48bf7b,0xbec43f6dbf80a777,0x3f6dbec43f353f35,0xbdc9bf7f3f6dbec4,0xbef13f62bf7bbe48,0x3f0e3f55bf353f35,0xbe48bf7b3f6dbec4,0xbf62bef13ec4bf6d,0x3f463f22bf0e3f55
.quad 0x3f8000003f80,0x3f8000003f80,0xbf46bf22bf35bf35,0xbf62bef1bf55bf0e,0x3f7bbe483f8025b0,0x3f55bf0e3f6dbec4,0xbef13f62bf353f35,0x3dc93f7fbe483f7b,0xbec4bf6d2630bf80,0xbf6dbec4bf35bf35,0x3f753e953f353f35,0x3f46bf223f7bbe48,0xbf553f0ebf80a742,0x3e483f7bbec43f6d,0x3dc9bf7f3f35bf35,0xbf75be95bf0ebf55
.quad 0x3f353f35a6b03f80,0x3f35bf353f80a60d,0xbf7f3dc9bf35bf35,0x3e953f75bf0e3f55,0x3f0ebf553f80a58e,0xbf7bbe48bec4bf6d,0x3e953f75bf353f35,0x3f22bf463f7b3e48,0xbf6dbec427c2bf80,0x3ec43f6dbf353f35,0x3f62bef13f353f35,0xbf7fbdc9be48bf7b,0xbe483f7bbf80a78d,0x3f0ebf553f6d3ec4,0xbf22bf463f35bf35,0x3ef13f62bf553f0e
.quad 0x3f8000003f80,0x3f8000003f80,0xbf75be95bf6dbec4,0xbf7fbdc9bf7bbe48,0x3f0ebf553f35bf35,0x3e48bf7b3ec4bf6d,0x3f223f463ec43f6d,0x3f753e953f553f0e,0xbf6d3ec4bf80a731,0xbec43f6dbf353f35,0xbdc9bf7f3ec4bf6d,0xbf62bef1bf0ebf55,0x3f7b3e483f353f35,0x3f0ebf553f6dbec4,0xbef13f62bf6d3ec4,0x3f463f223e483f7b
.quad 0xbf35bf3527b1bf80,0xbf353f35bf80a765,0x3f62bef13f6d3ec4,0xbf22bf463e48bf7b,0x3e483f7bbf353f35,0x3f55bf0e3f6d3ec4,0xbf7fbdc9bec4bf6d,0x3ef13f62bf0e3f55,0x3ec4bf6d3f80258d,0xbf6d3ec4bf35bf35,0x3f463f22bec43f6d,0xbe95bf753f55bf0e,0xbf553f0ebf35bf35,0x3f7bbe483ec43f6d,0xbe95bf753f6dbec4,0x3dc93f7fbf7b3e48
.quad 0x3f8000003f80,0x3f8000003f80,0xbf7f3dc9bf80a554,0xbf753e95bf7b3e48,0xbe48bf7b25d4bf80,0xbf0ebf55bec4bf6d,0x3f75be953f80261f,0x3f22bf463f55bf0e,0x3ec43f6da6543f80,0x3f6d3ec43f353f35,0xbf623ef1bf80a742,0xbdc93f7fbf0e3f55,0xbf0ebf55269fbf80,0xbf7b3e48bf6dbec4,0x3f46bf223f80a60d,0xbef1bf623e48bf7b
.quad 0x3f353f35a6d43f80,0x3f35bf353f80a58e,0xbf223f46bf80a777,0x3f623ef13e483f7b,0xbf55bf0e27c2bf80,0xbe483f7bbf6d3ec4,0x3ef1bf623f802804,0xbf7f3dc9bf0ebf55,0x3f6d3ec4a71f3f80,0xbec4bf6d3f35bf35,0xbe953f75bf802754,0x3f46bf223f553f0e,0xbf7bbe48a68dbf80,0x3f553f0ebec43f6d,0x3dc9bf7f3f802889,0xbe953f75bf7bbe48
.quad 0x3f8000003f80,0x3f8000003f80,0xbf623ef1bf6d3ec4,0xbf463f22bf553f0e,0xbf55bf0ebf35bf35,0xbf7bbe48bf6dbec4,0x3dc9bf7f3ec4bf6d,0xbef1bf62be48bf7b,0x3f6dbec43f80a68d,0x3ec4bf6d3f35bf35,0x3f463f223ec43f6d,0x3f75be953f7b3e48,0xbe483f7bbf353f35,0x3f553f0e3ec43f6d,0xbf753e95bf6dbec4,0x3dc93f7fbf0e3f55
.quad 0xbf35bf35a70dbf80,0xbf353f35bf80a777,0x3e95bf753f6dbec4,0xbf7fbdc9bf0ebf55,0x3f7bbe483f353f35,0xbf0ebf553ec4bf6d,0x3f223f46bec43f6d,0x3e95bf753f7bbe48,0xbec43f6dbf80a796,0x3f6dbec43f353f35,0xbf7f3dc9bec4bf6d,0x3f623ef1be483f7b,0xbf0ebf553f35bf35,0x3e483f7bbf6d3ec4,0x3ef1bf623f6d3ec4,0xbf223f46bf55bf0e
.quad 0x3f8000003f80,0x3f8000003f80,0xbf223f46bf353f35,0xbef13f62bf0e3f55,0xbf7b3e48bf80a5f7,0xbf553f0ebf6d3ec4,0xbf62bef1bf35bf35,0xbf7f3dc9bf7bbe48,0xbec4bf6d2677bf80,0xbf6dbec4bf35bf35,0x3e95bf753f35bf35,0xbf22bf46be48bf7b,0x3f55bf0e3f80a60d,0xbe48bf7b3ec4bf6d,0x3f7f3dc93f353f35,0x3e95bf753f55bf0e
.quad 0x3f353f35a6f73f80,0x3f35bf353f80a137,0x3dc93f7fbf353f35,0x3f75be953f553f0e,0xbf0e3f55bf80a78d,0x3f7b3e483ec43f6d,0xbf753e95bf35bf35,0x3f463f22be483f7b,0xbf6dbec4a68dbf80,0x3ec43f6dbf353f35,0xbef1bf623f35bf35,0xbdc93f7fbf7b3e48,0x3e48bf7b3f802816,0xbf0e3f55bf6dbec4,0x3f46bf223f353f35,0xbf623ef1bf0ebf55
.quad 0x3f8000003f80,0x3f8000003f80,0xbe953f75bec43f6d,0xbdc93f7fbe483f7b,0xbf0e3f55bf353f35,0xbe483f7bbec43f6d,0xbf463f22bf6d3ec4,0xbe953f75bf0e3f55,0xbf6d3ec4bf80a742,0xbec43f6dbf353f35,0xbf7f3dc9bf6dbec4,0xbef13f62bf553f0e,0xbf7bbe48bf35bf35,0xbf0e3f55bf6d3ec4,0xbf62bef1bec4bf6d,0xbf223f46bf7b3e48
.quad 0xbf35bf3527c2bf80,0xbf353f35bf80a784,0xbef1bf623ec4bf6d,0xbf463f22bf7bbe48,0xbe48bf7b3f35bf35,0xbf553f0ebf6dbec4,0x3dc9bf7f3f6dbec4,0xbf623ef1bf55bf0e,0x3ec4bf6d3f80268d,0xbf6d3ec4bf35bf35,0x3f22bf463f6d3ec4,0xbf753e95bf0ebf55,0x3f55bf0e3f353f35,0xbf7b3e48bec4bf6d,0x3f75be953ec43f6d,0xbf7f3dc9be48bf7b
.quad 0x3f80248d00003f80,0xbf80a554250dbf80,0x3f7fbdc900003f80,0xbf753e95be48bf7b,0x3f7bbe4800003f80,0xbf553f0ebec4bf6d,0x3f75be9500003f80,0xbf223f46bf0ebf55,0x3f6dbec400003f80,0xbec43f6dbf35bf35,0x3f62bef100003f80,0xbdc93f7fbf55bf0e,0x3f55bf0e00003f80,0x3e483f7bbf6dbec4,0x3f46bf2200003f80,0x3ef13f62bf7bbe48
.quad 0x3f35bf3500003f80,0x3f353f35bf80a554,0x3f22bf4600003f80,0x3f623ef1bf7b3e48,0x3f0ebf5500003f80,0x3f7b3e48bf6d3ec4,0x3ef1bf6200003f80,0x3f7fbdc9bf553f0e,0x3ec4bf6d00003f80,0x3f6dbec4bf353f35,0x3e95bf7500003f80,0x3f46bf22bf0e3f55,0x3e48bf7b00003f80,0x3f0ebf55bec43f6d,0x3dc9bf7f00003f80,0x3e95bf75be483f7b
.quad 0x3f8025b0a58d3f80,0xbf80a5f725d4bf80,0x3f62bef13ec43f6d,0xbf463f22bf0ebf55,0x3f0ebf553f353f35,0xbe483f7bbf6dbec4,0x3dc9bf7f3f6d3ec4,0x3ef13f62bf7b3e48,0xbec4bf6d3f8025b0,0x3f6d3ec4bf353f35,0xbf46bf223f6dbec4,0x3f75be95be483f7b,0xbf7bbe483f35bf35,0x3f0ebf553ec43f6d,0xbf753e953ec4bf6d,0xbdc9bf7f3f553f0e
.quad 0xbf353f3525d4bf80,0xbf35bf353f80261f,0xbe953f75bec4bf6d,0xbf7fbdc93f55bf0e,0x3e483f7bbf35bf35,0xbf553f0e3ec4bf6d,0x3f223f46bf6dbec4,0xbe953f75be48bf7b,0x3f6d3ec4bf80a5f7,0x3ec43f6dbf35bf35,0x3f7fbdc9bf6d3ec4,0x3f623ef1bf7bbe48,0x3f55bf0ebf353f35,0x3f7bbe48bf6d3ec4,0x3ef1bf62bec43f6d,0x3f22bf46bf0e3f55
.quad 0x3f80261fa60d3f80,0xbf80a7312630bf80,0x3f22bf463f353f35,0xbef13f62bf55bf0e,0xbe48bf7b3f80261f,0x3f0e3f55bf6d3ec4,0xbf62bef13f35bf35,0x3f7fbdc9be483f7b,0xbf6d3ec42630bf80,0x3ec4bf6d3f353f35,0xbe953f75bf35bf35,0xbf22bf463f7bbe48,0x3f0e3f55bf80a731,0xbf7b3e483ec4bf6d,0x3f7f3dc9bf353f35,0xbe953f75bf0ebf55
.quad 0x3f35bf35a6543f80,0x3f353f35bf80a742,0xbdc9bf7f3f353f35,0x3f75be95bf0e3f55,0xbf55bf0e3f80a68d,0x3e48bf7b3ec43f6d,0xbf753e953f35bf35,0xbf46bf223f7b3e48,0xbec43f6d2677bf80,0xbf6d3ec43f35bf35,0x3ef13f62bf35bf35,0xbdc93f7fbe48bf7b,0x3f7b3e48bf80a742,0x3f553f0ebf6dbec4,0x3f46bf22bf353f35,0x3f62bef1bf553f0e
.quad 0x3f80a68da6543f80,0xbf80a7422677bf80,0x3e95bf753f6d3ec4,0xbdc93f7fbf7bbe48,0xbf55bf0e3f35bf35,0x3f7b3e48bec43f6d,0xbf463f22bec4bf6d,0x3e95bf753f553f0e,0x3ec43f6dbf80a742,0xbf6dbec43f35bf35,0x3f7fbdc9bec43f6d,0xbef13f62bf0ebf55,0x3e48bf7b3f353f35,0x3f553f0ebf6d3ec4,0xbf62bef13f6dbec4,0x3f22bf463e483f7b
.quad 0xbf353f35269fbf80,0xbf35bf353f80a60d,0x3ef13f62bf6dbec4,0xbf463f223e48bf7b,0x3f7bbe48bf353f35,0x3f0e3f55bf6dbec4,0x3dc9bf7f3ec43f6d,0x3f62bef1bf0e3f55,0xbf6dbec43f80a60d,0xbec4bf6d3f353f35,0xbf223f463ec4bf6d,0xbf753e953f55bf0e,0x3f0e3f55bf35bf35,0x3e483f7bbec4bf6d,0x3f75be95bf6d3ec4,0x3f7fbdc9bf7b3e48
.quad 0x3f80a654a68d3f80,0xbf80a754269fbf80,0xbdc9bf7f3f80a654,0x3e953f75bf7b3e48,0xbf7b3e48269fbf80,0x3f55bf0e3ec43f6d,0x3e953f75bf80a754,0xbf46bf223f55bf0e,0x3f6dbec4a6b03f80,0xbec43f6dbf35bf35,0xbef1bf623f80a60d,0x3f7f3dc9bf0e3f55,0xbf553f0e27b1bf80,0xbe48bf7b3f6d3ec4,0x3f223f46bf80a765,0xbf623ef13e48bf7b
.quad 0x3f35bf35a6d43f80,0x3f353f35bf80a777,0xbf46bf223f80a58e,0x3ef1bf623e483f7b,0xbf0e3f55a70dbf80,0xbf7bbe483f6dbec4,0x3f623ef1bf80a777,0x3dc93f7fbf0ebf55,0x3ec4bf6da6f73f80,0x3f6dbec4bf353f35,0xbf75be953f80a137,0xbf22bf463f553f0e,0xbe483f7b27c2bf80,0xbf0e3f553ec4bf6d,0x3f7f3dc9bf80a784,0x3f753e95bf7bbe48
.quad 0x3f80a60da6b03f80,0xbf80a76527b1bf80,0xbef1bf623f6dbec4,0x3f223f46bf553f0e,0xbf0e3f55bf35bf35,0x3e48bf7b3f6d3ec4,0x3f7f3dc9bec43f6d,0xbf623ef1be48bf7b,0xbec4bf6d3f80a58e,0x3f6d3ec4bf353f35,0xbf223f46bec4bf6d,0xbe95bf753f7b3e48,0x3f7b3e48bf353f35,0xbf0e3f55bec4bf6d,0xbe95bf753f6d3ec4,0x3f7fbdc9bf0e3f55
.quad 0xbf353f3527c2bf80,0xbf35bf353f80258d,0x3f753e95bf6d3ec4,0xbdc93f7fbf0ebf55,0xbe48bf7b3f353f35,0x3f55bf0ebec43f6d,0xbf463f223ec4bf6d,0xbf75be953f7bbe48,0x3f6d3ec4bf80a78d,0x3ec43f6dbf35bf35,0xbdc9bf7f3ec43f6d,0x3ef1bf62be483f7b,0xbf553f0e3f35bf35,0xbf7b3e483f6dbec4,0x3f623ef1bf6dbec4,0x3f463f22bf55bf0e
.quad 0x3f80a58ea6d43f80,0xbf80a777a70dbf80,0xbf46bf223f35bf35,0x3f623ef1bf0e3f55,0x3e483f7bbf80a777,0xbf0ebf553f6dbec4,0x3ef1bf623f353f35,0x3dc93f7fbf7bbe48,0xbf6d3ec427c2bf80,0x3ec4bf6d3f353f35,0x3f753e95bf353f35,0xbf463f22be48bf7b,0xbf0ebf553f802804,0x3f7bbe48bec43f6d,0xbdc93f7fbf35bf35,0xbf75be953f55bf0e
.quad 0x3f35bf35a71f3f80,0x3f353f35bf80a796,0xbf7f3dc93f35bf35,0xbe95bf753f553f0e,0x3f553f0ebf802754,0xbe483f7bbec4bf6d,0xbe95bf753f353f35,0x3f22bf46be483f7b,0xbec43f6da68dbf80,0xbf6d3ec43f35bf35,0x3f62bef1bf353f35,0x3f7f3dc9bf7b3e48,0xbf7bbe483f802889,0xbf55bf0e3f6d3ec4,0x3f223f46bf35bf35,0x3ef13f62bf0ebf55
.quad 0x3f80a137a6f73f80,0xbf80a78427c2bf80,0xbf75be953ec4bf6d,0x3f7f3dc9be483f7b,0x3f553f0ebf353f35,0xbf7bbe483ec4bf6d,0xbf22bf463f6dbec4,0x3f753e95bf0e3f55,0x3ec43f6dbf80a78d,0xbf6dbec43f35bf35,0xbdc9bf7f3f6d3ec4,0x3f623ef1bf553f0e,0xbe483f7bbf35bf35,0xbf55bf0e3f6dbec4,0x3ef1bf623ec43f6d,0x3f463f22bf7b3e48
.quad 0xbf353f35a68dbf80,0xbf35bf353f80268d,0x3f62bef1bec43f6d,0x3f223f46bf7bbe48,0xbf7b3e483f35bf35,0xbf0ebf553f6d3ec4,0x3f7f3dc9bf6d3ec4,0x3ef13f62bf55bf0e,0xbf6dbec43f802816,0xbec4bf6d3f353f35,0x3f463f22bf6dbec4,0x3e953f75bf0ebf55,0xbf0ebf553f353f35,0xbe48bf7b3ec43f6d,0x3e953f75bec4bf6d,0x3dc93f7fbe48bf7b
.quad 0x3f80258da70d3f80,0xbf80a78da6d4bf80,0xbf7f3dc9a6d4bf80,0x3f75be953e483f7b,0x3f7bbe48a71f3f80,0xbf553f0ebec4bf6d,0xbf753e9527d4bf80,0x3f22bf463f0e3f55,0x3f6dbec4a7303f80,0xbec43f6dbf35bf35,0xbf623ef1a68dbf80,0x3dc9bf7f3f553f0e,0x3f55bf0ea8313f80,0x3e483f7bbf6dbec4,0xbf463f2227e5bf80,0xbef1bf623f7b3e48
.quad 0x3f35bf35a7543f80,0x3f353f35bf80a7b1,0xbf223f46a60ebf80,0xbf62bef13f7bbe48,0x3f0ebf55278d3f80,0x3f7b3e48bf6d3ec4,0xbef13f6227f7bf80,0xbf7f3dc93f55bf0e,0x3ec4bf6da7773f80,0x3f6dbec4bf353f35,0xbe953f75a1b7bf80,0xbf463f223f0ebf55,0x3e48bf7ba8423f80,0x3f0ebf55bec43f6d,0xbdc93f7f2804bf80,0xbe953f753e48bf7b
.quad 0x3f80260da71f3f80,0xbf80a79627d4bf80,0xbf623ef1bec4bf6d,0x3f46bf223f0e3f55,0x3f0ebf553f353f35,0xbe483f7bbf6dbec4,0xbdc93f7fbf6dbec4,0xbef1bf623f7bbe48,0xbec4bf6d3f80268d,0x3f6d3ec4bf353f35,0x3f463f22bf6d3ec4,0xbf753e953e48bf7b,0xbf7bbe483f35bf35,0x3f0ebf553ec43f6d,0x3f75be95bec43f6d,0x3dc93f7fbf55bf0e
.quad 0xbf353f3527f7bf80,0xbf35bf353f80281f,0x3e95bf753ec43f6d,0x3f7f3dc9bf553f0e,0x3e483f7bbf35bf35,0xbf553f0e3ec4bf6d,0xbf22bf463f6d3ec4,0x3e95bf753e483f7b,0x3f6d3ec4bf8026d4,0x3ec43f6dbf35bf35,0xbf7f3dc93f6dbec4,0xbf62bef13f7b3e48,0x3f55bf0ebf353f35,0x3f7bbe48bf6d3ec4,0xbef13f623ec4bf6d,0xbf223f463f0ebf55
.quad 0x3f80280da7303f80,0xbf80a79fa68dbf80,0xbf223f46bf35bf35,0x3ef1bf623f553f0e,0xbe48bf7b3f80268d,0x3f0e3f55bf6d3ec4,0x3f623ef1bf353f35,0xbf7f3dc93e48bf7b,0xbf6d3ec4a60ebf80,0x3ec4bf6d3f353f35,0x3e95bf753f353f35,0x3f223f46bf7b3e48,0x3f0e3f55bf80a85d,0xbf7b3e483ec4bf6d,0xbf7fbdc93f35bf35,0x3e95bf753f0e3f55
.quad 0x3f35bf35a8423f80,0x3f353f35bf8026d4,0x3dc93f7fbf35bf35,0xbf753e953f0ebf55,0xbf55bf0e3f80a7b1,0x3e48bf7b3ec43f6d,0x3f75be95bf353f35,0x3f463f22bf7bbe48,0xbec43f6d280dbf80,0xbf6d3ec43f35bf35,0xbef1bf623f353f35,0x3dc9bf7f3e483f7b,0x3f7b3e48bf80a7e5,0x3f553f0ebf6dbec4,0xbf463f223f35bf35,0xbf623ef13f55bf0e
.quad 0x3f80268da8313f80,0xbf80273127e5bf80,0xbe953f75bf6dbec4,0x3dc9bf7f3f7b3e48,0xbf55bf0e3f35bf35,0x3f7b3e48bec43f6d,0x3f46bf223ec43f6d,0xbe953f75bf55bf0e,0x3ec43f6dbf80270d,0xbf6dbec43f35bf35,0xbf7f3dc93ec4bf6d,0x3ef1bf623f0e3f55,0x3e48bf7b3f353f35,0x3f553f0ebf6d3ec4,0x3f623ef1bf6d3ec4,0xbf223f46be48bf7b
.quad 0xbf353f35260dbf80,0xbf35bf353f802730,0xbef1bf623f6d3ec4,0x3f46bf22be483f7b,0x3f7bbe48bf353f35,0x3f0e3f55bf6dbec4,0xbdc93f7fbec4bf6d,0xbf623ef13f0ebf55,0xbf6dbec43f802754,0xbec4bf6d3f353f35,0x3f22bf46bec43f6d,0x3f75be95bf553f0e,0x3f0e3f55bf35bf35,0x3e483f7bbec4bf6d,0xbf753e953f6dbec4,0xbf7f3dc93f7bbe48
.quad 0x3f802816a7543f80,0xbf80a7b1a60ebf80,0x3dc93f7fbf802828,0xbe95bf753f7bbe48,0xbf7b3e4827f7bf80,0x3f55bf0e3ec43f6d,0xbe95bf753f80281f,0x3f463f22bf553f0e,0x3f6dbec4a8423f80,0xbec43f6dbf35bf35,0x3ef13f62bf8026d4,0xbf7fbdc93f0ebf55,0xbf553f0e2884bf80,0xbe48bf7b3f6d3ec4,0xbf22bf463f802730,0x3f62bef1be483f7b
.quad 0x3f35bf35a79f3f80,0x3f353f35bf80a7e5,0x3f463f22bf80a7e5,0xbef13f62be48bf7b,0xbf0e3f55a7d4bf80,0xbf7bbe483f6dbec4,0xbf62bef13f802839,0xbdc9bf7f3f0e3f55,0x3ec4bf6d270d3f80,0x3f6dbec4bf353f35,0x3f753e95bf80a880,0x3f223f46bf55bf0e,0xbe483f7b2909bf80,0xbf0e3f553ec4bf6d,0xbf7fbdc93f8028a3,0xbf75be953f7b3e48
.quad 0x3f8026d4278d3f80,0xbf80270d27f7bf80,0x3ef13f62bf6d3ec4,0xbf22bf463f55bf0e,0xbf0e3f55bf35bf35,0x3e48bf7b3f6d3ec4,0xbf7fbdc93ec4bf6d,0x3f62bef13e483f7b,0xbec4bf6d3f802828,0x3f6d3ec4bf353f35,0x3f22bf463ec43f6d,0x3e953f75bf7bbe48,0x3f7b3e48bf353f35,0xbf0e3f55bec4bf6d,0x3e953f75bf6dbec4,0xbf7f3dc93f0ebf55
.quad 0xbf353f352816bf80,0xbf35bf353f802839,0xbf75be953f6dbec4,0x3dc9bf7f3f0e3f55,0xbe48bf7b3f353f35,0x3f55bf0ebec43f6d,0x3f46bf22bec43f6d,0x3f753e95bf7b3e48,0x3f6d3ec4bf80a804,0x3ec43f6dbf35bf35,0x3dc93f7fbec4bf6d,0xbef13f623e48bf7b,0xbf553f0e3f35bf35,0xbf7b3e483f6dbec4,0xbf62bef13f6d3ec4,0xbf46bf223f553f0e
.quad 0x3f80281fa7773f80,0xbf80a7c2a1b7bf80,0x3f463f22bf353f35,0xbf62bef13f0ebf55,0x3e483f7bbf8026d4,0xbf0ebf553f6dbec4,0xbef13f62bf35bf35,0xbdc9bf7f3f7b3e48,0xbf6d3ec4280dbf80,0x3ec4bf6d3f353f35,0xbf75be953f35bf35,0x3f46bf223e483f7b,0xbf0ebf553f80289a,0x3f7bbe48bec43f6d,0x3dc9bf7f3f353f35,0x3f753e95bf553f0e
.quad 0x3f35bf35270d3f80,0x3f353f35bf80a880,0x3f7fbdc9bf353f35,0x3e953f75bf55bf0e,0x3f553f0ebf8028be,0xbe483f7bbec4bf6d,0x3e953f75bf35bf35,0xbf223f463e48bf7b,0xbec43f6d2896bf80,0xbf6d3ec43f35bf35,0xbf623ef13f35bf35,0xbf7fbdc93f7bbe48,0xbf7bbe483f8028ea,0xbf55bf0e3f6d3ec4,0xbf22bf463f353f35,0xbef1bf623f0e3f55
.quad 0x3f80270da8423f80,0xbf8026d42804bf80,0x3f753e95bec43f6d,0xbf7fbdc93e48bf7b,0x3f553f0ebf353f35,0xbf7bbe483ec4bf6d,0x3f223f46bf6d3ec4,0xbf75be953f0ebf55,0x3ec43f6dbf80a7e5,0xbf6dbec43f35bf35,0x3dc93f7fbf6dbec4,0xbf62bef13f55bf0e,0xbe483f7bbf35bf35,0xbf55bf0e3f6dbec4,0xbef13f62bec4bf6d,0xbf46bf223f7bbe48
.quad 0xbf353f35270dbf80,0xbf35bf353f8028a3,0xbf623ef13ec4bf6d,0xbf22bf463f7b3e48,0xbf7b3e483f35bf35,0xbf0ebf553f6d3ec4,0xbf7fbdc93f6dbec4,0xbef1bf623f553f0e,0xbf6dbec43f80a731,0xbec4bf6d3f353f35,0xbf46bf223f6d3ec4,0xbe95bf753f0e3f55,0xbf0ebf553f353f35,0xbe48bf7b3ec43f6d,0xbe95bf753ec43f6d,0xbdc9bf7f3e483f7b
.quad 0x250dbf8000003f80,0x25d4bf80a58d3f80,0xbdc9bf7f00003f80,0xbe95bf753e483f7b,0xbe48bf7b00003f80,0xbf0ebf553ec43f6d,0xbe95bf7500003f80,0xbf46bf223f0e3f55,0xbec4bf6d00003f80,0xbf6dbec43f353f35,0xbef1bf6200003f80,0xbf7fbdc93f553f0e,0xbf0ebf5500003f80,0xbf7b3e483f6d3ec4,0xbf22bf4600003f80,0xbf623ef13f7b3e48
.quad 0xbf35bf3500003f80,0xbf353f353f8025b0,0xbf46bf2200003f80,0xbef13f623f7bbe48,0xbf55bf0e00003f80,0xbe483f7b3f6dbec4,0xbf62bef100003f80,0x3dc93f7f3f55bf0e,0xbf6dbec400003f80,0x3ec43f6d3f35bf35,0xbf75be9500003f80,0x3f223f463f0ebf55,0xbf7bbe4800003f80,0x3f553f0e3ec4bf6d,0xbf7fbdc900003f80,0x3f753e953e48bf7b
.quad 0x2630bf80a60d3f80,0x2677bf80a6543f80,0xbef1bf623ec43f6d,0xbf22bf463f0e3f55,0xbf55bf0e3f353f35,0xbf7bbe483f6d3ec4,0xbf7fbdc93f6d3ec4,0xbf623ef13f7bbe48,0xbf6d3ec43f80261f,0xbec43f6d3f35bf35,0xbf223f463f6dbec4,0x3e953f753e48bf7b,0xbe483f7b3f35bf35,0x3f553f0ebec4bf6d,0x3e953f753ec4bf6d,0x3f7fbdc9bf55bf0e
.quad 0x3f353f352630bf80,0x3f35bf35bf80a742,0x3f753e95bec4bf6d,0x3dc9bf7fbf553f0e,0x3f7bbe48bf35bf35,0xbf0ebf55bec43f6d,0x3f46bf22bf6dbec4,0xbf75be953e483f7b,0x3ec4bf6dbf80a731,0xbf6d3ec43f353f35,0xbdc9bf7fbf6d3ec4,0xbef13f623f7b3e48,0xbf0ebf55bf353f35,0x3e483f7b3f6dbec4,0xbf62bef1bec43f6d,0x3f463f223f0ebf55
.quad 0x269fbf80a68d3f80,0x27b1bf80a6b03f80,0xbf46bf223f353f35,0xbf62bef13f553f0e,0xbf7b3e483f80a654,0xbf553f0e3f6dbec4,0xbef13f623f35bf35,0x3dc93f7f3e48bf7b,0x3ec43f6d269fbf80,0x3f6d3ec4bf35bf35,0x3f753e95bf35bf35,0x3f46bf22bf7b3e48,0x3f55bf0ebf80a754,0xbe48bf7bbec43f6d,0x3dc9bf7fbf353f35,0xbf75be953f0e3f55
.quad 0xbf35bf35a6b03f80,0xbf353f353f80a58e,0xbf7f3dc93f353f35,0x3e953f753f0ebf55,0xbf0e3f553f80a60d,0x3f7b3e48bec4bf6d,0x3e953f753f35bf35,0x3f22bf46bf7bbe48,0x3f6d3ec427b1bf80,0xbec4bf6dbf353f35,0x3f62bef1bf35bf35,0xbf7fbdc93e483f7b,0x3e48bf7bbf80a765,0xbf0e3f553f6d3ec4,0xbf22bf46bf353f35,0x3ef13f623f55bf0e
.quad 0xa70dbf80a6d43f80,0x27c2bf80a6f73f80,0xbf75be953f6d3ec4,0xbf7fbdc93f7b3e48,0xbf0e3f553f35bf35,0xbe483f7b3ec4bf6d,0x3f223f46bec4bf6d,0x3f753e95bf55bf0e,0x3f6dbec4bf80a777,0x3ec4bf6dbf353f35,0xbdc9bf7fbec43f6d,0xbf62bef13f0e3f55,0xbf7bbe483f353f35,0xbf0e3f553f6dbec4,0xbef13f623f6dbec4,0x3f463f22be48bf7b
.quad 0x3f353f3527c2bf80,0x3f35bf35bf80a78d,0x3f62bef1bf6dbec4,0xbf22bf46be483f7b,0xbe48bf7bbf353f35,0xbf553f0e3f6d3ec4,0xbf7fbdc93ec43f6d,0x3ef13f623f0ebf55,0xbec43f6d3f802804,0x3f6dbec4bf35bf35,0x3f463f223ec4bf6d,0xbe95bf75bf553f0e,0x3f55bf0ebf35bf35,0xbf7b3e483ec43f6d,0xbe95bf75bf6d3ec4,0x3dc93f7f3f7bbe48
.quad 0xa6d4bf80a70d3f80,0x27d4bf80a71f3f80,0xbf7f3dc93f80258d,0xbf753e953f7bbe48,0x3e483f7ba6d4bf80,0x3f0e3f55bec4bf6d,0x3f75be95bf80a78d,0x3f22bf46bf553f0e,0xbec4bf6da71f3f80,0xbf6dbec43f353f35,0xbf623ef13f80260d,0xbdc93f7f3f0ebf55,0x3f0e3f5527d4bf80,0x3f7bbe48bf6dbec4,0x3f46bf22bf80a796,0xbef1bf62be483f7b
.quad 0xbf35bf35a7303f80,0xbf353f353f80268d,0xbf223f463f80280d,0x3f623ef1be48bf7b,0x3f553f0ea68dbf80,0x3e48bf7bbf6d3ec4,0x3ef1bf62bf80a79f,0xbf7f3dc93f0e3f55,0xbf6dbec4a8313f80,0x3ec43f6d3f35bf35,0xbe953f753f80268d,0x3f46bf22bf55bf0e,0x3f7b3e4827e5bf80,0xbf55bf0ebec43f6d,0x3dc9bf7fbf802731,0xbe953f753f7b3e48
.quad 0xa68dbf80a7303f80,0x27e5bf80a8313f80,0xbf623ef13f6dbec4,0xbf463f223f55bf0e,0x3f553f0ebf35bf35,0x3f7b3e48bf6dbec4,0x3dc9bf7fbec43f6d,0xbef1bf623e483f7b,0xbf6d3ec43f80268d,0xbec43f6d3f35bf35,0x3f463f22bec4bf6d,0x3f75be95bf7bbe48,0x3e48bf7bbf353f35,0xbf55bf0e3ec43f6d,0xbf753e953f6d3ec4,0x3dc93f7f3f0ebf55
.quad 0x3f353f35a60ebf80,0x3f35bf35bf80270d,0x3e95bf75bf6d3ec4,0xbf7fbdc93f0e3f55,0xbf7b3e483f353f35,0x3f0e3f553ec4bf6d,0x3f223f463ec4bf6d,0x3e95bf75bf7b3e48,0x3ec4bf6dbf80a85d,0xbf6d3ec43f353f35,0xbf7f3dc93ec43f6d,0x3f623ef13e48bf7b,0x3f0e3f553f35bf35,0xbe48bf7bbf6d3ec4,0x3ef1bf62bf6dbec4,0xbf223f463f553f0e
.quad 0xa60ebf80a7543f80,0x27f7bf80278d3f80,0xbf223f463f35bf35,0xbef13f623f0ebf55,0x3f7bbe48bf802828,0x3f55bf0ebf6d3ec4,0xbf62bef13f353f35,0xbf7f3dc93f7b3e48,0x3ec43f6d27f7bf80,0x3f6d3ec4bf35bf35,0x3e95bf75bf353f35,0xbf22bf463e483f7b,0xbf553f0e3f80281f,0x3e483f7b3ec4bf6d,0x3f7f3dc9bf35bf35,0x3e95bf75bf553f0e
.quad 0xbf35bf35a8423f80,0xbf353f353f802828,0x3dc93f7f3f35bf35,0x3f75be95bf55bf0e,0x3f0ebf55bf8026d4,0xbf7bbe483ec43f6d,0xbf753e953f353f35,0x3f463f223e48bf7b,0x3f6d3ec42884bf80,0xbec4bf6dbf353f35,0xbef1bf62bf353f35,0xbdc93f7f3f7bbe48,0xbe483f7b3f802730,0x3f0ebf55bf6dbec4,0x3f46bf22bf35bf35,0xbf623ef13f0e3f55
.quad 0xa1b7bf80a7773f80,0x2804bf80a8423f80,0xbe953f753ec4bf6d,0xbdc93f7f3e48bf7b,0x3f0ebf55bf353f35,0x3e48bf7bbec43f6d,0xbf463f223f6dbec4,0xbe953f753f0ebf55,0x3f6dbec4bf8026d4,0x3ec4bf6dbf353f35,0xbf7f3dc93f6d3ec4,0xbef13f623f55bf0e,0x3f7b3e48bf35bf35,0x3f0ebf55bf6d3ec4,0xbf62bef13ec43f6d,0xbf223f463f7bbe48
.quad 0x3f353f35280dbf80,0x3f35bf35bf80a7e5,0xbef1bf62bec43f6d,0xbf463f223f7b3e48,0x3e483f7b3f35bf35,0x3f55bf0ebf6dbec4,0x3dc9bf7fbf6d3ec4,0xbf623ef13f553f0e,0xbec43f6d3f80289a,0x3f6dbec4bf35bf35,0x3f22bf46bf6dbec4,0xbf753e953f0e3f55,0xbf553f0e3f353f35,0x3f7bbe48bec4bf6d,0x3f75be95bec4bf6d,0xbf7f3dc93e483f7b
.quad 0x260dbf80a78d3f80,0x280dbf8027543f80,0x3dc93f7f260dbf80,0x3e953f75be48bf7b,0xbe48bf7b27543f80,0xbf0ebf553ec43f6d,0x3e953f75280dbf80,0x3f463f22bf0ebf55,0xbec4bf6da79f3f80,0xbf6dbec43f353f35,0x3ef13f62268dbf80,0x3f7f3dc9bf55bf0e,0xbf0ebf55a8543f80,0xbf7b3e483f6d3ec4,0x3f223f462816bf80,0x3f62bef1bf7bbe48
.quad 0xbf35bf35a7b03f80,0xbf353f353f802777,0x3f463f22288dbf80,0x3ef1bf62bf7b3e48,0xbf55bf0e270d3f80,0xbe483f7b3f6dbec4,0x3f623ef1281fbf80,0xbdc9bf7fbf553f0e,0xbf6dbec4a8b13f80,0x3ec43f6d3f35bf35,0x3f753e95270dbf80,0xbf22bf46bf0e3f55,0xbf7bbe48a8653f80,0x3f553f0e3ec4bf6d,0x3f7f3dc9a7b1bf80,0xbf75be95be483f7b
.quad 0x268dbf80a79f3f80,0x2816bf80a8543f80,0x3ef13f62bec4bf6d,0x3f223f46bf0ebf55,0xbf55bf0e3f353f35,0xbf7bbe483f6d3ec4,0x3f7f3dc9bf6dbec4,0x3f62bef1bf7b3e48,0xbf6d3ec43f802839,0xbec43f6d3f35bf35,0x3f22bf46bf6d3ec4,0xbe95bf75be483f7b,0xbe483f7b3f35bf35,0x3f553f0ebec4bf6d,0xbe95bf75bec43f6d,0xbf7f3dc93f553f0e
.quad 0x3f353f35270dbf80,0x3f35bf35bf80a60d,0xbf75be953ec43f6d,0xbdc93f7f3f55bf0e,0x3f7bbe48bf35bf35,0xbf0ebf55bec43f6d,0xbf463f223f6d3ec4,0x3f753e95be48bf7b,0x3ec4bf6dbf80a8c7,0xbf6d3ec43f353f35,0x3dc93f7f3f6dbec4,0x3ef1bf62bf7bbe48,0xbf0ebf55bf353f35,0x3e483f7b3f6dbec4,0x3f623ef13ec4bf6d,0xbf46bf22bf0e3f55
.quad 0x288dbf80a7b03f80,0x281fbf80270d3f80,0x3f463f22bf35bf35,0x3f623ef1bf55bf0e,0xbf7b3e483f802777,0xbf553f0e3f6dbec4,0x3ef1bf62bf353f35,0xbdc9bf7fbe483f7b,0x3ec43f6d270dbf80,0x3f6d3ec4bf35bf35,0xbf75be953f353f35,0xbf463f223f7bbe48,0x3f55bf0ebf80a60d,0xbe48bf7bbec43f6d,0xbdc93f7f3f35bf35,0x3f753e95bf0ebf55
.quad 0xbf35bf35268e3f80,0xbf353f353f80a731,0x3f7fbdc9bf35bf35,0xbe95bf75bf0e3f55,0xbf0e3f553f80a731,0x3f7b3e48bec4bf6d,0xbe95bf75bf353f35,0xbf223f463f7b3e48,0x3f6d3ec428ddbf80,0xbec4bf6dbf353f35,0xbf623ef13f353f35,0x3f7f3dc9be48bf7b,0x3e48bf7bbf80a8cf,0xbf0e3f553f6d3ec4,0x3f223f463f35bf35,0xbef1bf62bf553f0e
.quad 0x270dbf80a8b13f80,0xa7b1bf80a8653f80,0x3f753e95bf6dbec4,0x3f7f3dc9bf7bbe48,0xbf0e3f553f35bf35,0xbe483f7b3ec4bf6d,0xbf22bf463ec43f6d,0xbf75be953f553f0e,0x3f6dbec4bf8027e6,0x3ec4bf6dbf353f35,0x3dc93f7f3ec4bf6d,0x3f623ef1bf0ebf55,0xbf7bbe483f353f35,0xbf0e3f553f6dbec4,0x3ef1bf62bf6d3ec4,0xbf46bf223e483f7b
.quad 0x3f353f35a78dbf80,0x3f35bf35bf8027c2,0xbf623ef13f6d3ec4,0x3f223f463e48bf7b,0xbe48bf7bbf353f35,0xbf553f0e3f6d3ec4,0x3f7f3dc9bec4bf6d,0xbef1bf62bf0e3f55,0xbec43f6d3f8028f3,0x3f6dbec4bf35bf35,0xbf46bf22bec43f6d,0x3e953f753f55bf0e,0x3f55bf0ebf35bf35,0xbf7b3e483ec43f6d,0x3e953f753f6dbec4,0xbdc9bf7fbf7b3e48
.quad 0x2896bf80a7d43f80,0x2831bf80268e3f80,0x3f7fbdc9bf8027e6,0x3f75be95bf7b3e48,0x3e483f7ba8a8bf80,0x3f0e3f55bec4bf6d,0xbf753e953f80a731,0xbf223f463f55bf0e,0xbec4bf6da8773f80,0xbf6dbec43f353f35,0x3f62bef1bf80a6d4,0x3dc9bf7fbf0e3f55,0x3f0e3f55289fbf80,0x3f7bbe48bf6dbec4,0xbf463f223f8027c2,0x3ef13f623e48bf7b
.quad 0xbf35bf35a8c23f80,0xbf353f353f8028b5,0x3f22bf46bf80a92a,0xbf62bef13e483f7b,0x3f553f0ea754bf80,0x3e48bf7bbf6d3ec4,0xbef13f623f80286e,0x3f7fbdc9bf0ebf55,0xbf6dbec4a9043f80,0x3ec43f6d3f35bf35,0x3e95bf75bf80284b,0xbf463f223f553f0e,0x3f7b3e4827b0bf80,0xbf55bf0ebec43f6d,0xbdc93f7f3f80a804,0x3e95bf75bf7bbe48
.quad 0x2754bf80280d3f80,0xa78dbf80a8773f80,0x3f62bef1bf6d3ec4,0x3f46bf22bf553f0e,0x3f553f0ebf35bf35,0x3f7b3e48bf6dbec4,0xbdc93f7f3ec4bf6d,0x3ef13f62be48bf7b,0xbf6d3ec43f8027c2,0xbec43f6d3f35bf35,0xbf46bf223ec43f6d,0xbf753e953f7b3e48,0x3e48bf7bbf353f35,0xbf55bf0e3ec43f6d,0x3f75be95bf6dbec4,0xbdc9bf7fbf0e3f55
.quad 0x3f353f3528a8bf80,0x3f35bf35bf80a89a,0xbe953f753f6dbec4,0x3f7f3dc9bf0ebf55,0xbf7b3e483f353f35,0x3f0e3f553ec4bf6d,0xbf22bf46bec43f6d,0xbe953f753f7bbe48,0x3ec4bf6dbf80a90f,0xbf6d3ec43f353f35,0x3f7fbdc9bec4bf6d,0xbf62bef1be483f7b,0x3f0e3f553f35bf35,0xbe48bf7bbf6d3ec4,0xbef13f623f6d3ec4,0x3f22bf46bf55bf0e
.quad 0x289fbf80a7f73f80,0x2842bf8022373f80,0x3f22bf46bf353f35,0x3ef1bf62bf0e3f55,0x3f7bbe48bf80285d,0x3f55bf0ebf6d3ec4,0x3f623ef1bf35bf35,0x3f7fbdc9bf7bbe48,0x3ec43f6da754bf80,0x3f6d3ec4bf35bf35,0xbe953f753f35bf35,0x3f223f46be48bf7b,0xbf553f0e3f80291d,0x3e483f7b3ec4bf6d,0xbf7fbdc93f353f35,0xbe953f753f55bf0e
.quad 0xbf35bf35a88d3f80,0xbf353f353f802880,0xbdc9bf7fbf353f35,0xbf753e953f553f0e,0x3f0ebf55bf802777,0xbf7bbe483ec43f6d,0x3f75be95bf35bf35,0xbf46bf22be483f7b,0x3f6d3ec4291abf80,0xbec4bf6dbf353f35,0x3ef13f623f35bf35,0x3dc9bf7fbf7b3e48,0xbe483f7b3f802889,0x3f0ebf55bf6dbec4,0xbf463f223f353f35,0x3f62bef1bf0ebf55
.quad 0x278dbf80a8c23f80,0xa754bf80a8843f80,0x3e95bf75bec43f6d,0x3dc9bf7fbe483f7b,0x3f0ebf55bf353f35,0x3e48bf7bbec43f6d,0x3f46bf22bf6d3ec4,0x3e95bf75bf0e3f55,0x3f6dbec4bf80a89a,0x3ec4bf6dbf353f35,0x3f7fbdc9bf6dbec4,0x3ef1bf62bf553f0e,0x3f7b3e48bf35bf35,0x3f0ebf55bf6d3ec4,0x3f623ef1bec4bf6d,0x3f22bf46bf7b3e48
.quad 0x3f353f352865bf80,0x3f35bf35bf80a84b,0x3ef13f623ec4bf6d,0x3f46bf22bf7bbe48,0x3e483f7b3f35bf35,0x3f55bf0ebf6dbec4,0xbdc93f7f3f6dbec4,0x3f62bef1bf55bf0e,0xbec43f6d3f802926,0x3f6dbec4bf35bf35,0xbf223f463f6d3ec4,0x3f75be95bf0ebf55,0xbf553f0e3f353f35,0x3f7bbe48bec4bf6d,0xbf753e953ec43f6d,0x3f7fbdc9be48bf7b
.quad 0xbf80a55400003f80,0x3f80261f25d4bf80,0xbf7f3dc900003f80,0x3f75be95be48bf7b,0xbf7b3e4800003f80,0x3f55bf0ebec4bf6d,0xbf753e9500003f80,0x3f22bf46bf0ebf55,0xbf6d3ec400003f80,0x3ec4bf6dbf35bf35,0xbf623ef100003f80,0x3dc9bf7fbf55bf0e,0xbf553f0e00003f80,0xbe48bf7bbf6dbec4,0xbf463f2200003f80,0xbef1bf62bf7bbe48
.quad 0xbf353f3500003f80,0xbf35bf35bf80a5f7,0xbf223f4600003f80,0xbf62bef1bf7b3e48,0xbf0e3f5500003f80,0xbf7bbe48bf6d3ec4,0xbef13f6200003f80,0xbf7f3dc9bf553f0e,0xbec43f6d00003f80,0xbf6d3ec4bf353f35,0xbe953f7500003f80,0xbf463f22bf0e3f55,0xbe483f7b00003f80,0xbf0e3f55bec43f6d,0xbdc93f7f00003f80,0xbe953f75be483f7b
.quad 0xbf80a742a6543f80,0x3f80a60d269fbf80,0xbf623ef13ec43f6d,0x3f46bf22bf0ebf55,0xbf0e3f553f353f35,0x3e48bf7bbf6dbec4,0xbdc93f7f3f6d3ec4,0xbef1bf62bf7b3e48,0x3ec43f6d3f80a68d,0xbf6dbec4bf353f35,0x3f463f223f6dbec4,0xbf753e95be483f7b,0x3f7b3e483f35bf35,0xbf0e3f553ec43f6d,0x3f75be953ec4bf6d,0x3dc93f7f3f553f0e
.quad 0x3f35bf352677bf80,0x3f353f353f80a60d,0x3e95bf75bec4bf6d,0x3f7f3dc93f55bf0e,0xbe48bf7bbf35bf35,0x3f55bf0e3ec4bf6d,0xbf22bf46bf6dbec4,0x3e95bf75be48bf7b,0xbf6dbec4bf80a742,0xbec4bf6dbf35bf35,0xbf7f3dc9bf6d3ec4,0xbf62bef1bf7bbe48,0xbf553f0ebf353f35,0xbf7b3e48bf6d3ec4,0xbef13f62bec43f6d,0xbf223f46bf0e3f55
.quad 0xbf80a777a6d43f80,0x3f80258d27c2bf80,0xbf223f463f353f35,0x3ef1bf62bf55bf0e,0x3e483f7b3f80a58e,0xbf0ebf55bf6d3ec4,0x3f623ef13f35bf35,0xbf7f3dc9be483f7b,0x3f6dbec4a70dbf80,0xbec43f6d3f353f35,0x3e95bf75bf35bf35,0x3f223f463f7bbe48,0xbf0ebf55bf80a777,0x3f7bbe483ec4bf6d,0xbf7fbdc9bf353f35,0x3e95bf75bf0ebf55
.quad 0xbf353f35a6f73f80,0xbf35bf35bf80a78d,0x3dc93f7f3f353f35,0xbf753e95bf0e3f55,0x3f553f0e3f80a137,0xbe483f7b3ec43f6d,0x3f75be953f35bf35,0x3f463f223f7b3e48,0x3ec4bf6d27c2bf80,0x3f6dbec43f35bf35,0xbef1bf62bf35bf35,0x3dc9bf7fbe48bf7b,0xbf7bbe48bf80a784,0xbf55bf0ebf6dbec4,0xbf463f22bf353f35,0xbf623ef1bf553f0e
.quad 0xbf80a796a71f3f80,0x3f80268da68dbf80,0xbe953f753f6d3ec4,0x3dc9bf7fbf7bbe48,0x3f553f0e3f35bf35,0xbf7bbe48bec43f6d,0x3f46bf22bec4bf6d,0xbe953f753f553f0e,0xbec4bf6dbf802754,0x3f6d3ec43f35bf35,0xbf7f3dc9bec43f6d,0x3ef1bf62bf0ebf55,0xbe483f7b3f353f35,0xbf55bf0ebf6d3ec4,0x3f623ef13f6dbec4,0xbf223f463e483f7b
.quad 0x3f35bf35a68dbf80,0x3f353f353f802816,0xbef1bf62bf6dbec4,0x3f46bf223e48bf7b,0xbf7b3e48bf353f35,0xbf0ebf55bf6dbec4,0xbdc93f7f3ec43f6d,0xbf623ef1bf0e3f55,0x3f6d3ec43f802889,0x3ec43f6d3f353f35,0x3f22bf463ec4bf6d,0x3f75be953f55bf0e,0xbf0ebf55bf35bf35,0xbe48bf7bbec4bf6d,0xbf753e95bf6d3ec4,0xbf7f3dc9bf7b3e48
.quad 0xbf80a7b1a7543f80,0x3f80281f27f7bf80,0x3dc93f7f3f802816,0xbe95bf75bf7b3e48,0x3f7bbe48a60ebf80,0xbf553f0e3ec43f6d,0xbe95bf75bf80a7b1,0x3f463f223f55bf0e,0xbf6d3ec4278d3f80,0x3ec4bf6dbf35bf35,0x3ef13f623f8026d4,0xbf7fbdc9bf0e3f55,0x3f55bf0e27f7bf80,0x3e483f7b3f6d3ec4,0xbf22bf46bf80270d,0x3f62bef13e48bf7b
.quad 0xbf353f35a7773f80,0xbf35bf35bf8026d4,0x3f463f223f80281f,0xbef13f623e483f7b,0x3f0ebf55a1b7bf80,0x3f7b3e483f6dbec4,0xbf62bef1bf80a7c2,0xbdc9bf7fbf0ebf55,0xbec43f6da8423f80,0xbf6d3ec4bf353f35,0x3f753e953f80270d,0x3f223f463f553f0e,0x3e48bf7b2804bf80,0x3f0ebf553ec4bf6d,0xbf7fbdc9bf8026d4,0xbf75be95bf7bbe48
.quad 0xbf8026d4a8423f80,0x3f802730260dbf80,0x3ef13f623f6dbec4,0xbf22bf46bf553f0e,0x3f0ebf55bf35bf35,0xbe483f7b3f6d3ec4,0xbf7fbdc9bec43f6d,0x3f62bef1be48bf7b,0x3ec43f6d3f80a7b1,0xbf6dbec4bf353f35,0x3f22bf46bec4bf6d,0x3e953f753f7b3e48,0xbf7bbe48bf353f35,0x3f0ebf55bec4bf6d,0x3e953f753f6d3ec4,0xbf7f3dc9bf0e3f55
.quad 0x3f35bf35280dbf80,0x3f353f353f802754,0xbf75be95bf6d3ec4,0x3dc9bf7fbf0ebf55,0x3e483f7b3f353f35,0xbf553f0ebec43f6d,0x3f46bf223ec4bf6d,0x3f753e953f7bbe48,0xbf6dbec4bf80a7e5,0xbec4bf6dbf35bf35,0x3dc93f7f3ec43f6d,0xbef13f62be483f7b,0x3f55bf0e3f35bf35,0x3f7bbe483f6dbec4,0xbf62bef1bf6dbec4,0xbf46bf22bf55bf0e
.quad 0xbf80a7e5a79f3f80,0x3f8028392816bf80,0x3f463f223f35bf35,0xbf62bef1bf0e3f55,0xbe48bf7bbf80a7e5,0x3f0e3f553f6dbec4,0xbef13f623f353f35,0xbdc9bf7fbf7bbe48,0x3f6dbec4a7d4bf80,0xbec43f6d3f353f35,0xbf75be95bf353f35,0x3f46bf22be48bf7b,0x3f0e3f553f802839,0xbf7b3e48bec43f6d,0x3dc9bf7fbf35bf35,0x3f753e953f55bf0e
.quad 0xbf353f35270d3f80,0xbf35bf35bf80a804,0x3f7fbdc93f35bf35,0x3e953f753f553f0e,0xbf55bf0ebf80a880,0x3e48bf7bbec4bf6d,0x3e953f753f353f35,0xbf223f46be483f7b,0x3ec4bf6d2909bf80,0x3f6dbec43f35bf35,0xbf623ef1bf353f35,0xbf7fbdc9bf7b3e48,0x3f7b3e483f8028a3,0x3f553f0e3f6d3ec4,0xbf22bf46bf35bf35,0xbef1bf62bf0ebf55
.quad 0xbf80a880270d3f80,0x3f8028a3270dbf80,0x3f753e953ec4bf6d,0xbf7fbdc9be483f7b,0xbf55bf0ebf353f35,0x3f7b3e483ec4bf6d,0x3f223f463f6dbec4,0xbf75be95bf0e3f55,0xbec4bf6dbf8028be,0x3f6d3ec43f35bf35,0x3dc93f7f3f6d3ec4,0xbf62bef1bf553f0e,0x3e48bf7bbf35bf35,0x3f553f0e3f6dbec4,0xbef13f623ec43f6d,0xbf46bf22bf7b3e48
.quad 0x3f35bf352896bf80,0x3f353f353f80a731,0xbf623ef1bec43f6d,0xbf22bf46bf7bbe48,0x3f7bbe483f35bf35,0x3f0e3f553f6d3ec4,0xbf7fbdc9bf6d3ec4,0xbef1bf62bf55bf0e,0x3f6d3ec43f8028ea,0x3ec43f6d3f353f35,0xbf46bf22bf6dbec4,0xbe95bf75bf0ebf55,0x3f0e3f553f353f35,0x3e483f7b3ec43f6d,0xbe95bf75bec4bf6d,0xbdc9bf7fbe48bf7b
.quad 0xbf8027e6a7d43f80,0x3f80a7312831bf80,0x3f7fbdc92896bf80,0xbf753e953e483f7b,0xbf7b3e48268e3f80,0x3f55bf0ebec4bf6d,0x3f75be952831bf80,0xbf223f463f0e3f55,0xbf6d3ec4280d3f80,0x3ec4bf6dbf35bf35,0x3f62bef12754bf80,0xbdc93f7f3f553f0e,0xbf553f0ea8773f80,0xbe48bf7bbf6dbec4,0x3f46bf22a78dbf80,0x3ef13f623f7b3e48
.quad 0xbf353f35a7f73f80,0xbf35bf35bf80a892,0x3f22bf46289fbf80,0x3f623ef13f7bbe48,0xbf0e3f5522373f80,0xbf7bbe48bf6d3ec4,0x3ef1bf622842bf80,0x3f7fbdc93f55bf0e,0xbec43f6da8c23f80,0xbf6d3ec4bf353f35,0x3e95bf75278dbf80,0x3f46bf223f0ebf55,0xbe483f7ba8843f80,0xbf0e3f55bec43f6d,0x3dc9bf7fa754bf80,0x3e95bf753e48bf7b
.quad 0xbf80a6d4a8773f80,0x3f8027c2289fbf80,0x3f62bef1bec4bf6d,0xbf463f223f0e3f55,0xbf0e3f553f353f35,0x3e48bf7bbf6dbec4,0x3dc9bf7fbf6dbec4,0x3ef13f623f7bbe48,0x3ec43f6d3f8027c2,0xbf6dbec4bf353f35,0xbf46bf22bf6d3ec4,0x3f75be953e48bf7b,0x3f7b3e483f35bf35,0xbf0e3f553ec43f6d,0xbf753e95bec43f6d,0xbdc9bf7fbf55bf0e
.quad 0x3f35bf35a754bf80,0x3f353f353f8027e5,0xbe953f753ec43f6d,0xbf7fbdc9bf553f0e,0xbe48bf7bbf35bf35,0x3f55bf0e3ec4bf6d,0x3f223f463f6d3ec4,0xbe953f753e483f7b,0xbf6dbec4bf80a89a,0xbec4bf6dbf35bf35,0x3f7fbdc93f6dbec4,0x3f623ef13f7b3e48,0xbf553f0ebf353f35,0xbf7b3e48bf6d3ec4,0x3ef1bf623ec4bf6d,0x3f22bf463f0ebf55
.quad 0xbf80a828a8c23f80,0x3f80286ea754bf80,0x3f22bf46bf35bf35,0xbef13f623f553f0e,0x3e483f7b3f80a816,0xbf0ebf55bf6d3ec4,0xbf62bef1bf353f35,0x3f7fbdc93e48bf7b,0x3f6dbec4a831bf80,0xbec43f6d3f353f35,0xbe953f753f353f35,0xbf22bf46bf7b3e48,0xbf0ebf55bf80a89a,0x3f7bbe483ec4bf6d,0x3f7f3dc93f35bf35,0xbe953f753f0e3f55
.quad 0xbf353f35a88d3f80,0xbf35bf35bf802777,0xbdc9bf7fbf35bf35,0x3f75be953f0ebf55,0x3f553f0e3f80a880,0xbe483f7b3ec43f6d,0xbf753e95bf353f35,0xbf46bf22bf7bbe48,0x3ec4bf6d2865bf80,0x3f6dbec43f35bf35,0x3ef13f623f353f35,0xbdc93f7f3e483f7b,0xbf7bbe48bf80a84b,0xbf55bf0ebf6dbec4,0x3f46bf223f35bf35,0x3f62bef13f55bf0e
.quad 0xbf80a89aa68d3f80,0x3f8028be27b0bf80,0x3e95bf75bf6dbec4,0xbdc93f7f3f7b3e48,0x3f553f0e3f35bf35,0xbf7bbe48bec43f6d,0xbf463f223ec43f6d,0x3e95bf75bf55bf0e,0xbec4bf6dbf8028e1,0x3f6d3ec43f35bf35,0x3f7fbdc93ec4bf6d,0xbef13f623f0e3f55,0xbe483f7b3f353f35,0xbf55bf0ebf6d3ec4,0xbf62bef1bf6d3ec4,0x3f22bf46be48bf7b
.quad 0x3f35bf3527d4bf80,0x3f353f353f802889,0x3ef13f623f6d3ec4,0xbf463f22be483f7b,0xbf7b3e48bf353f35,0xbf0ebf55bf6dbec4,0x3dc9bf7fbec4bf6d,0x3f62bef13f0ebf55,0x3f6d3ec43f802926,0x3ec43f6d3f353f35,0xbf223f46bec43f6d,0xbf753e95bf553f0e,0xbf0ebf55bf35bf35,0xbe48bf7bbec4bf6d,0x3f75be953f6dbec4,0x3f7fbdc93f7bbe48
.quad 0xbf802777a81f3f80,0x3f80260c2865bf80,0xbdc9bf7fbf80a8e1,0x3e953f753f7bbe48,0x3f7bbe482865bf80,0xbf553f0e3ec43f6d,0x3e953f753f802902,0xbf46bf22bf553f0e,0xbf6d3ec428543f80,0x3ec4bf6dbf35bf35,0xbef1bf62bf80a79f,0x3f7f3dc93f0ebf55,0x3f55bf0e28b9bf80,0x3e483f7b3f6d3ec4,0x3f223f463f80a8b5,0xbf623ef1be483f7b
.quad 0xbf353f35278d3f80,0xbf35bf35bf80a918,0xbf46bf22bf80a85d,0x3ef1bf62be48bf7b,0x3f0ebf552900bf80,0x3f7b3e483f6dbec4,0x3f623ef13f80a85d,0x3dc93f7f3f0e3f55,0xbec43f6da9893f80,0xbf6d3ec4bf353f35,0xbf75be95bf80a8b5,0xbf22bf46bf55bf0e,0x3e48bf7b2923bf80,0x3f0ebf553ec4bf6d,0x3f7f3dc93f80a79f,0x3f753e953f7b3e48
.quad 0xbf80a79fa8963f80,0x3f80292628b9bf80,0xbef1bf62bf6d3ec4,0x3f223f463f55bf0e,0x3f0ebf55bf35bf35,0xbe483f7b3f6d3ec4,0x3f7f3dc93ec4bf6d,0xbf623ef13e483f7b,0x3ec43f6d3f8026d3,0xbf6dbec4bf353f35,0xbf223f463ec43f6d,0xbe95bf75bf7bbe48,0xbf7bbe48bf353f35,0x3f0ebf55bec4bf6d,0xbe95bf75bf6dbec4,0x3f7fbdc93f0ebf55
.quad 0x3f35bf352884bf80,0x3f353f353f80a79f,0x3f753e953f6dbec4,0xbdc93f7f3f0e3f55,0x3e483f7b3f353f35,0xbf553f0ebec43f6d,0xbf463f22bec43f6d,0xbf75be95bf7b3e48,0xbf6dbec4bf80a8fc,0xbec4bf6dbf35bf35,0xbdc9bf7fbec4bf6d,0x3ef1bf623e48bf7b,0x3f55bf0e3f35bf35,0x3f7bbe483f6dbec4,0x3f623ef13f6d3ec4,0x3f463f223f553f0e
.quad 0xbf80a85d278d3f80,0x3f80a85d2900bf80,0xbf46bf22bf353f35,0x3f623ef13f0ebf55,0xbe48bf7bbf8028cf,0x3f0e3f553f6dbec4,0x3ef1bf62bf35bf35,0x3dc93f7f3f7b3e48,0x3f6dbec4a93ebf80,0xbec43f6d3f353f35,0x3f753e953f35bf35,0xbf463f223e483f7b,0x3f0e3f553f80296c,0xbf7b3e48bec43f6d,0xbdc93f7f3f353f35,0xbf75be95bf553f0e
.quad 0xbf353f35a9163f80,0xbf35bf35bf80a880,0xbf7f3dc9bf353f35,0xbe95bf75bf55bf0e,0xbf55bf0ebf80a880,0x3e48bf7bbec4bf6d,0xbe95bf75bf35bf35,0x3f22bf463e48bf7b,0x3ec4bf6d296abf80,0x3f6dbec43f35bf35,0x3f62bef13f35bf35,0x3f7f3dc93f7bbe48,0x3f7b3e483f802914,0x3f553f0e3f6d3ec4,0x3f223f463f353f35,0x3ef13f623f0e3f55
.quad 0xbf80a8b5a78d3f80,0x3f80a79f2923bf80,0xbf75be95bec43f6d,0x3f7f3dc93e48bf7b,0xbf55bf0ebf353f35,0x3f7b3e483ec4bf6d,0xbf22bf46bf6d3ec4,0x3f753e953f0ebf55,0xbec4bf6dbf802902,0x3f6d3ec43f35bf35,0xbdc9bf7fbf6dbec4,0x3f623ef13f55bf0e,0x3e48bf7bbf35bf35,0x3f553f0e3f6dbec4,0x3ef1bf62bec4bf6d,0x3f463f223f7bbe48
.quad 0x3f35bf35a7b1bf80,0x3f353f353f802914,0x3f62bef13ec4bf6d,0x3f223f463f7b3e48,0x3f7bbe483f35bf35,0x3f0e3f553f6d3ec4,0x3f7f3dc93f6dbec4,0x3ef13f623f553f0e,0x3f6d3ec43f8028ac,0x3ec43f6d3f353f35,0x3f463f223f6d3ec4,0x3e953f753f0e3f55,0x3f0e3f553f353f35,0x3e483f7b3ec43f6d,0x3e953f753ec43f6d,0x3dc93f7f3e483f7b
.quad 0x3f8080003f808000,0x3f8080003f808000,0x3f7fbdc93f808000,0x3f75be953f7bbe48,0x3f7bbe483f808000,0x3f55bf0e3f6dbec4,0x3f75be953f808000,0x3f22bf463f55bf0e,0x3f6dbec43f808000,0x3ec4bf6d3f35bf35,0x3f62bef13f808000,0x3dc9bf7f3f0ebf55,0x3f55bf0e3f808000,0xbe48bf7b3ec4bf6d,0x3f46bf223f808000,0xbef1bf623e48bf7b
.quad 0x3f35bf353f808000,0xbf35bf35248dbf80,0x3f22bf463f808000,0xbf62bef1be48bf7b,0x3f0ebf553f808000,0xbf7bbe48bec4bf6d,0x3ef1bf623f808000,0xbf7f3dc9bf0ebf55,0x3ec4bf6d3f808000,0xbf6d3ec4bf35bf35,0x3e95bf753f808000,0xbf463f22bf55bf0e,0x3e48bf7b3f808000,0xbf0e3f55bf6dbec4,0x3dc9bf7f3f808000,0xbe953f75bf7bbe48
.quad 0x3f8080003f808000,0x3f8080003f808000,0x3f62bef13f6dbec4,0x3f46bf223f55bf0e,0x3f0ebf553f35bf35,0x3e48bf7b3ec4bf6d,0x3dc9bf7f3ec4bf6d,0xbef1bf62be48bf7b,0xbec4bf6d248dbf80,0xbf6dbec4bf35bf35,0xbf46bf22bec4bf6d,0xbf753e95bf7bbe48,0xbf7bbe48bf35bf35,0xbf0e3f55bf6d3ec4,0xbf753e95bf6dbec4,0x3dc93f7fbf0e3f55
.quad 0xbf353f35bf80a50d,0x3f353f35a5543f80,0xbe953f75bf6d3ec4,0x3f7f3dc93f0e3f55,0x3e483f7bbf353f35,0x3f55bf0e3f6d3ec4,0x3f223f46bec43f6d,0x3e95bf753f7bbe48,0x3f6d3ec4a5543f80,0xbec4bf6d3f35bf35,0x3f7fbdc93ec43f6d,0xbf62bef13e48bf7b,0x3f55bf0e3f353f35,0xbf7b3e48bec4bf6d,0x3ef1bf623f6d3ec4,0xbf223f46bf55bf0e
.quad 0x3f8080003f808000,0x3f8080003f808000,0x3f22bf463f35bf35,0x3ef1bf623f0ebf55,0xbe48bf7b248dbf80,0xbf0ebf55bec4bf6d,0xbf62bef1bf35bf35,0xbf7f3dc9bf7bbe48,0xbf6d3ec4bf80a50d,0xbec43f6dbf353f35,0xbe953f75bf353f35,0x3f223f463e483f7b,0x3f0e3f55a5543f80,0x3f7bbe483f6d3ec4,0x3f7f3dc93f353f35,0x3e95bf753f55bf0e
.quad 0x3f35bf353f80258d,0xbf35bf3525b0bf80,0xbdc9bf7f3f35bf35,0xbf753e95bf55bf0e,0xbf55bf0e25b0bf80,0xbe483f7bbf6d3ec4,0xbf753e95bf35bf35,0x3f463f22be483f7b,0xbec43f6dbf80a5d4,0x3f6dbec43f353f35,0x3ef13f62bf353f35,0x3dc9bf7f3f7bbe48,0x3f7b3e48a5f73f80,0xbf55bf0e3ec4bf6d,0x3f46bf223f353f35,0xbf623ef1bf0ebf55
.quad 0x3f8080003f808000,0x3f8080003f808000,0x3e95bf753ec4bf6d,0x3dc9bf7f3e48bf7b,0xbf55bf0ebf35bf35,0xbf7bbe48bf6dbec4,0xbf463f22bf6d3ec4,0xbe953f75bf0e3f55,0x3ec43f6da5543f80,0x3f6d3ec43f353f35,0x3f7fbdc93f6d3ec4,0x3ef1bf623f55bf0e,0x3e48bf7b3f35bf35,0xbf55bf0ebec4bf6d,0xbf62bef1bec4bf6d,0xbf223f46bf7b3e48
.quad 0xbf353f35bf80a5d4,0x3f353f35a5f73f80,0x3ef13f62bec43f6d,0x3f46bf223f7b3e48,0x3f7bbe483f353f35,0xbf0ebf553ec4bf6d,0x3dc9bf7f3f6dbec4,0xbf623ef1bf55bf0e,0xbf6dbec4261fbf80,0x3ec43f6dbf353f35,0xbf223f46bf6dbec4,0x3f75be953f0e3f55,0x3f0e3f55bf353f35,0xbe48bf7b3f6dbec4,0x3f75be953ec43f6d,0xbf7f3dc9be48bf7b
.quad 0x3f8080003f808000,0x3f8080003f808000,0xbdc9bf7f248dbf80,0xbe95bf75be48bf7b,0xbf7b3e48bf80a50d,0xbf553f0ebf6d3ec4,0x3e953f75a5543f80,0x3f463f223f0e3f55,0x3f6dbec43f80258d,0x3ec4bf6d3f35bf35,0xbef1bf6225b0bf80,0xbf7fbdc9bf55bf0e,0xbf553f0ebf80a5d4,0x3e483f7bbec43f6d,0x3f223f46a5f73f80,0x3f62bef13f7b3e48
.quad 0x3f35bf353f80260d,0xbf35bf35261fbf80,0xbf46bf22261fbf80,0xbef13f62bf7b3e48,0xbf0e3f55bf80a630,0x3f7b3e483ec43f6d,0x3f623ef1a7313f80,0xbdc9bf7f3f55bf0e,0x3ec4bf6d3f802654,0xbf6d3ec4bf35bf35,0xbf75be95a68dbf80,0x3f223f46bf0e3f55,0xbe483f7bbf80a677,0x3f0ebf553f6d3ec4,0x3f7f3dc9a7423f80,0xbf75be953e48bf7b
.quad 0x3f8080003f808000,0x3f8080003f808000,0xbef1bf62bec4bf6d,0xbf22bf46bf0ebf55,0xbf0e3f55bf353f35,0xbe483f7bbec43f6d,0x3f7f3dc93f6d3ec4,0x3f62bef13f7bbe48,0xbec4bf6d25b0bf80,0xbf6dbec4bf35bf35,0xbf223f46bf6d3ec4,0x3e953f75be483f7b,0x3f7b3e483f353f35,0x3f0ebf553f6dbec4,0xbe95bf753ec4bf6d,0xbf7f3dc9bf55bf0e
.quad 0xbf353f35bf80a630,0x3f353f35a7313f80,0x3f753e953ec43f6d,0x3dc9bf7f3f55bf0e,0xbe48bf7b3f35bf35,0xbf553f0ebf6dbec4,0xbf463f22bf6dbec4,0x3f753e953e483f7b,0x3f6d3ec4a7423f80,0xbec4bf6d3f35bf35,0xbdc9bf7f3f6dbec4,0xbef13f62bf7bbe48,0xbf553f0ebf35bf35,0x3f7bbe483ec43f6d,0x3f623ef1bec43f6d,0xbf46bf223f0ebf55
.quad 0x3f8080003f808000,0x3f8080003f808000,0xbf46bf22bf35bf35,0xbf62bef1bf55bf0e,0x3e483f7ba5543f80,0x3f0e3f553ec43f6d,0x3ef1bf623f35bf35,0xbdc9bf7f3e48bf7b,0xbf6d3ec4bf80a5d4,0xbec43f6dbf353f35,0x3f753e953f353f35,0x3f46bf223f7bbe48,0xbf0ebf55261fbf80,0xbf7b3e48bf6dbec4,0xbdc93f7fbf353f35,0x3f753e953f0e3f55
.quad 0x3f35bf353f802654,0xbf35bf35a68dbf80,0xbf7f3dc9bf35bf35,0x3e953f75bf0e3f55,0x3f553f0ea7423f80,0x3e48bf7b3f6dbec4,0xbe95bf753f35bf35,0xbf223f46bf7bbe48,0xbec43f6dbf80a69f,0x3f6dbec43f353f35,0x3f62bef13f353f35,0xbf7fbdc9be48bf7b,0xbf7bbe48a60dbf80,0x3f553f0ebec43f6d,0x3f223f46bf353f35,0xbef1bf623f55bf0e
.quad 0x3f8080003f808000,0x3f8080003f808000,0xbf75be95bf6dbec4,0xbf7fbdc9bf7bbe48,0x3f553f0e3f353f35,0x3f7b3e483f6d3ec4,0xbf22bf46bec4bf6d,0xbf75be95bf55bf0e,0x3ec43f6da5f73f80,0x3f6d3ec43f353f35,0xbdc9bf7f3ec4bf6d,0xbf62bef1bf0ebf55,0xbe483f7bbf353f35,0x3f553f0e3ec43f6d,0x3ef1bf623f6dbec4,0xbf46bf22be48bf7b
.quad 0xbf353f35bf80a677,0x3f353f35a7423f80,0x3f62bef13f6d3ec4,0xbf22bf463e48bf7b,0xbf7b3e48bf35bf35,0x3f0e3f55bec43f6d,0x3f7f3dc93ec43f6d,0xbef1bf623f0ebf55,0xbf6dbec4a60dbf80,0x3ec43f6dbf353f35,0x3f463f22bec43f6d,0xbe95bf753f55bf0e,0xbf0ebf553f35bf35,0x3e483f7bbf6d3ec4,0x3e953f75bf6d3ec4,0xbdc9bf7f3f7bbe48
.quad 0x3f8080003f808000,0x3f8080003f808000,0xbf7f3dc9bf80a50d,0xbf753e95bf7b3e48,0x3f7bbe483f80258d,0x3f55bf0e3f6dbec4,0xbf753e95bf80a5d4,0xbf223f46bf553f0e,0x3f6dbec43f80260d,0x3ec4bf6d3f35bf35,0xbf623ef1bf80a630,0xbdc93f7fbf0e3f55,0x3f55bf0e3f802654,0xbe48bf7b3ec4bf6d,0xbf463f22bf80a677,0x3ef13f62be483f7b
.quad 0x3f35bf353f80268d,0xbf35bf35a654bf80,0xbf223f46bf80a69f,0x3f623ef13e483f7b,0x3f0ebf553f8026b0,0xbf7bbe48bec4bf6d,0xbef13f62bf80a7b1,0x3f7fbdc93f0e3f55,0x3ec4bf6d3f8026d4,0xbf6d3ec4bf35bf35,0xbe953f75bf80270d,0x3f46bf223f553f0e,0x3e48bf7b3f8026f7,0xbf0e3f55bf6dbec4,0xbdc93f7fbf80a7c2,0x3e95bf753f7b3e48
.quad 0x3f8080003f808000,0x3f8080003f808000,0xbf623ef1bf6d3ec4,0xbf463f22bf553f0e,0x3f0ebf553f35bf35,0x3e48bf7b3ec4bf6d,0xbdc93f7fbec43f6d,0x3ef13f623e483f7b,0xbec4bf6d261fbf80,0xbf6dbec4bf35bf35,0x3f463f223ec43f6d,0x3f75be953f7b3e48,0xbf7bbe48bf35bf35,0xbf0e3f55bf6d3ec4,0x3f75be953f6d3ec4,0xbdc9bf7f3f0ebf55
.quad 0xbf353f35bf80a69f,0x3f353f35a7543f80,0x3e95bf753f6dbec4,0xbf7fbdc9bf0ebf55,0x3e483f7bbf353f35,0x3f55bf0e3f6d3ec4,0xbf22bf463ec4bf6d,0xbe953f75bf7b3e48,0x3f6d3ec4a7773f80,0xbec4bf6d3f35bf35,0xbf7f3dc9bec4bf6d,0x3f623ef1be483f7b,0x3f55bf0e3f353f35,0xbf7b3e48bec4bf6d,0xbef13f62bf6dbec4,0x3f22bf463f553f0e
.quad 0x3f8080003f808000,0x3f8080003f808000,0xbf223f46bf353f35,0xbef13f62bf0e3f55,0xbe48bf7b25b0bf80,0xbf0ebf55bec4bf6d,0x3f623ef13f353f35,0x3f7fbdc93f7b3e48,0xbf6d3ec4bf80a630,0xbec43f6dbf353f35,0x3e95bf753f35bf35,0xbf22bf46be48bf7b,0x3f0e3f55a7423f80,0x3f7bbe483f6d3ec4,0xbf7fbdc9bf35bf35,0xbe953f75bf553f0e
.quad 0x3f35bf353f8026b0,0xbf35bf35a60dbf80,0x3dc93f7fbf353f35,0x3f75be953f553f0e,0xbf55bf0ea58ebf80,0xbe483f7bbf6d3ec4,0x3f75be953f353f35,0xbf46bf223e48bf7b,0xbec43f6dbf80a7c2,0x3f6dbec43f353f35,0xbef1bf623f35bf35,0xbdc93f7fbf7b3e48,0x3f7b3e48a78d3f80,0xbf55bf0e3ec4bf6d,0xbf463f22bf35bf35,0x3f62bef13f0e3f55
.quad 0x3f8080003f808000,0x3f8080003f808000,0xbe953f75bec43f6d,0xbdc93f7fbe483f7b,0xbf55bf0ebf35bf35,0xbf7bbe48bf6dbec4,0x3f46bf223f6dbec4,0x3e95bf753f0ebf55,0x3ec43f6da7313f80,0x3f6d3ec43f353f35,0xbf7f3dc9bf6dbec4,0xbef13f62bf553f0e,0x3e48bf7b3f35bf35,0xbf55bf0ebec4bf6d,0x3f623ef13ec43f6d,0x3f22bf463f7bbe48
.quad 0xbf353f35bf80a7b1,0x3f353f35a7653f80,0xbef1bf623ec4bf6d,0xbf463f22bf7bbe48,0x3f7bbe483f353f35,0xbf0ebf553ec4bf6d,0xbdc93f7fbf6d3ec4,0x3f62bef13f553f0e,0xbf6dbec4258dbf80,0x3ec43f6dbf353f35,0x3f22bf463f6d3ec4,0xbf753e95bf0ebf55,0x3f0e3f55bf353f35,0xbe48bf7b3f6dbec4,0xbf753e95bec4bf6d,0x3f7fbdc93e483f7b
.quad 0x3f8080003f808000,0x3f8080003f808000,0x3dc93f7fa5543f80,0x3e953f753e483f7b,0xbf7b3e48bf80a5d4,0xbf553f0ebf6d3ec4,0xbe95bf75261fbf80,0xbf46bf22bf0ebf55,0x3f6dbec43f802654,0x3ec4bf6d3f35bf35,0x3ef13f62a7423f80,0x3f7f3dc93f553f0e,0xbf553f0ebf80a69f,0x3e483f7bbec43f6d,0xbf22bf46a60dbf80,0xbf623ef1bf7bbe48
.quad 0x3f35bf353f8026d4,0xbf35bf35a58ebf80,0x3f463f22a7773f80,0x3ef1bf623f7bbe48,0xbf0e3f55bf80a7c2,0x3f7b3e483ec43f6d,0xbf62bef12804bf80,0x3dc93f7fbf553f0e,0x3ec4bf6d3f80271f,0xbf6d3ec4bf35bf35,0x3f753e9527543f80,0xbf22bf463f0ebf55,0xbe483f7bbf80268d,0x3f0ebf553f6d3ec4,0xbf7fbdc92889bf80,0x3f753e95be483f7b
.quad 0x3f8080003f808000,0x3f8080003f808000,0x3ef13f623ec43f6d,0x3f223f463f0e3f55,0xbf0e3f55bf353f35,0xbe483f7bbec43f6d,0xbf7fbdc9bf6dbec4,0xbf623ef1bf7b3e48,0xbec4bf6da68dbf80,0xbf6dbec4bf35bf35,0x3f22bf463f6dbec4,0xbe95bf753e48bf7b,0x3f7b3e483f353f35,0x3f0ebf553f6dbec4,0x3e953f75bec43f6d,0x3f7fbdc93f553f0e
.quad 0xbf353f35bf80270d,0x3f353f35a7773f80,0xbf75be95bec4bf6d,0xbdc93f7fbf553f0e,0xbe48bf7b3f35bf35,0xbf553f0ebf6dbec4,0x3f46bf223f6d3ec4,0xbf75be95be48bf7b,0x3f6d3ec4a7963f80,0xbec4bf6d3f35bf35,0x3dc93f7fbf6d3ec4,0x3ef1bf623f7b3e48,0xbf553f0ebf35bf35,0x3f7bbe483ec43f6d,0xbf62bef13ec4bf6d,0x3f463f22bf0e3f55
.quad 0x3f8080003f808000,0x3f8080003f808000,0x3f463f223f353f35,0x3f623ef13f553f0e,0x3e483f7ba5f73f80,0x3f0e3f553ec43f6d,0xbef13f62bf353f35,0x3dc93f7fbe483f7b,0xbf6d3ec4bf80a677,0xbec43f6dbf353f35,0xbf75be95bf35bf35,0xbf463f22bf7b3e48,0xbf0ebf55a60dbf80,0xbf7b3e48bf6dbec4,0x3dc9bf7f3f35bf35,0xbf75be95bf0ebf55
.quad 0x3f35bf353f8026f7,0xbf35bf35a137bf80,0x3f7fbdc93f353f35,0xbe95bf753f0ebf55,0x3f553f0ea78d3f80,0x3e48bf7b3f6dbec4,0x3e953f75bf353f35,0x3f22bf463f7b3e48,0xbec43f6dbf80268d,0x3f6dbec43f353f35,0xbf623ef1bf35bf35,0x3f7f3dc93e483f7b,0xbf7bbe482816bf80,0x3f553f0ebec43f6d,0xbf22bf463f35bf35,0x3ef13f62bf553f0e
.quad 0x3f8080003f808000,0x3f8080003f808000,0x3f753e953f6d3ec4,0x3f7f3dc93f7b3e48,0x3f553f0e3f353f35,0x3f7b3e483f6d3ec4,0x3f223f463ec43f6d,0x3f753e953f553f0e,0x3ec43f6da7423f80,0x3f6d3ec43f353f35,0x3dc93f7fbec43f6d,0x3f623ef13f0e3f55,0xbe483f7bbf353f35,0x3f553f0e3ec43f6d,0xbef13f62bf6d3ec4,0x3f463f223e483f7b
.quad 0xbf353f35bf80a7c2,0x3f353f35a7843f80,0xbf623ef1bf6dbec4,0x3f223f46be483f7b,0xbf7b3e48bf35bf35,0x3f0e3f55bec43f6d,0xbf7fbdc9bec4bf6d,0x3ef13f62bf0e3f55,0xbf6dbec4268dbf80,0x3ec43f6dbf353f35,0xbf46bf223ec4bf6d,0x3e953f75bf553f0e,0xbf0ebf553f35bf35,0x3e483f7bbf6d3ec4,0xbe95bf753f6dbec4,0x3dc93f7fbf7b3e48
.quad 0x248dbf803f808000,0xa5543f80bf80a50d,0xbdc9bf7f3f808000,0x3e953f75bf7b3e48,0xbe48bf7b3f808000,0x3f0e3f55bf6d3ec4,0xbe95bf753f808000,0x3f463f22bf553f0e,0xbec4bf6d3f808000,0x3f6d3ec4bf353f35,0xbef1bf623f808000,0x3f7f3dc9bf0e3f55,0xbf0ebf553f808000,0x3f7bbe48bec43f6d,0xbf22bf463f808000,0x3f62bef1be483f7b
.quad 0xbf35bf353f808000,0x3f35bf35a5543f80,0xbf46bf223f808000,0x3ef1bf623e483f7b,0xbf55bf0e3f808000,0x3e48bf7b3ec43f6d,0xbf62bef13f808000,0xbdc9bf7f3f0e3f55,0xbf6dbec43f808000,0xbec4bf6d3f353f35,0xbf75be953f808000,0xbf22bf463f553f0e,0xbf7bbe483f808000,0xbf55bf0e3f6d3ec4,0xbf7fbdc93f808000,0xbf75be953f7b3e48
.quad 0x25b0bf803f80258d,0xa5f73f80bf80a5d4,0xbef1bf623f6dbec4,0x3f223f46bf553f0e,0xbf55bf0e3f35bf35,0x3f7b3e48bec43f6d,0xbf7fbdc93ec4bf6d,0x3f62bef13e483f7b,0xbf6d3ec425b0bf80,0x3ec4bf6d3f353f35,0xbf223f46bec4bf6d,0xbe95bf753f7b3e48,0xbe483f7bbf35bf35,0xbf55bf0e3f6dbec4,0x3e953f75bf6dbec4,0xbf7f3dc93f0ebf55
.quad 0x3f353f35bf80a5d4,0xbf353f35261fbf80,0x3f753e95bf6d3ec4,0xbdc93f7fbf0ebf55,0x3f7bbe48bf353f35,0x3f0e3f55bf6dbec4,0x3f46bf22bec43f6d,0x3f753e95bf7b3e48,0x3ec4bf6da5f73f80,0x3f6dbec4bf353f35,0xbdc9bf7f3ec43f6d,0x3ef1bf62be483f7b,0xbf0ebf553f353f35,0xbe48bf7b3ec43f6d,0xbf62bef13f6d3ec4,0xbf46bf223f553f0e
.quad 0x261fbf803f80260d,0xa7313f80bf80a630,0xbf46bf223f35bf35,0x3f623ef1bf0e3f55,0xbf7b3e48261fbf80,0x3f55bf0e3ec43f6d,0xbef13f62bf35bf35,0xbdc9bf7f3f7b3e48,0x3ec43f6dbf80a630,0xbf6dbec43f35bf35,0x3f753e95bf353f35,0xbf463f22be48bf7b,0x3f55bf0ea7313f80,0x3e483f7bbf6dbec4,0x3dc9bf7f3f353f35,0x3f753e95bf553f0e
.quad 0xbf35bf353f802654,0x3f35bf35a7423f80,0xbf7f3dc93f35bf35,0xbe95bf753f553f0e,0xbf0e3f55a68dbf80,0xbf7bbe483f6dbec4,0x3e953f75bf35bf35,0xbf223f463e48bf7b,0x3f6d3ec4bf80a677,0x3ec43f6dbf35bf35,0x3f62bef1bf353f35,0x3f7f3dc9bf7b3e48,0x3e48bf7ba7423f80,0x3f0ebf55bec43f6d,0xbf22bf463f353f35,0xbef1bf623f0e3f55
.quad 0xa68dbf803f802654,0xa7423f80bf80a677,0xbf75be953ec4bf6d,0x3f7f3dc9be483f7b,0xbf0e3f55bf35bf35,0x3e48bf7b3f6d3ec4,0x3f223f46bf6d3ec4,0xbf75be953f0ebf55,0x3f6dbec4a7423f80,0xbec43f6dbf35bf35,0xbdc9bf7f3f6d3ec4,0x3f623ef1bf553f0e,0xbf7bbe483f35bf35,0x3f0ebf553ec43f6d,0xbef13f62bec4bf6d,0xbf46bf223f7bbe48
.quad 0x3f353f35bf80a69f,0xbf353f35a60dbf80,0x3f62bef1bec43f6d,0x3f223f46bf7bbe48,0xbe48bf7b3f353f35,0x3f55bf0ebec43f6d,0xbf7fbdc93f6dbec4,0xbef1bf623f553f0e,0xbec43f6da60dbf80,0xbf6d3ec43f35bf35,0x3f463f22bf6dbec4,0x3e953f75bf0ebf55,0x3f55bf0ebf353f35,0x3f7bbe48bf6d3ec4,0xbe95bf753ec43f6d,0xbdc9bf7f3e483f7b
.quad 0xa654bf803f80268d,0xa7543f80bf80a69f,0xbf7f3dc9a654bf80,0x3f75be953e483f7b,0x3e483f7bbf80a69f,0xbf0ebf553f6dbec4,0x3f75be95a7543f80,0xbf223f46bf0ebf55,0xbec4bf6d3f8026b0,0x3f6d3ec4bf353f35,0xbf623ef1a60dbf80,0x3dc9bf7f3f553f0e,0x3f0e3f55bf80a7b1,0xbf7b3e483ec4bf6d,0x3f46bf22a7653f80,0x3ef13f62bf7bbe48
.quad 0xbf35bf353f8026d4,0x3f35bf35a7773f80,0xbf223f46a58ebf80,0xbf62bef13f7bbe48,0x3f553f0ebf80270d,0xbe483f7bbec4bf6d,0x3ef1bf62a7773f80,0x3f7fbdc9bf553f0e,0xbf6dbec43f8026f7,0xbec4bf6d3f353f35,0xbe953f75a137bf80,0xbf463f223f0ebf55,0x3f7b3e48bf80a7c2,0x3f553f0ebf6dbec4,0x3dc9bf7fa7843f80,0x3e95bf75be483f7b
.quad 0xa60dbf803f8026b0,0xa7653f80bf80a7b1,0xbf623ef1bec4bf6d,0x3f46bf223f0e3f55,0x3f553f0ebf353f35,0xbf7bbe483ec4bf6d,0x3dc9bf7f3f6d3ec4,0x3ef13f62bf7b3e48,0xbf6d3ec4a58ebf80,0x3ec4bf6d3f353f35,0x3f463f22bf6d3ec4,0xbf753e953e48bf7b,0x3e48bf7b3f353f35,0x3f553f0ebf6d3ec4,0xbf753e953ec4bf6d,0xbdc9bf7f3f553f0e
.quad 0x3f353f35bf80a7c2,0xbf353f35258dbf80,0x3e95bf753ec43f6d,0x3f7f3dc9bf553f0e,0xbf7b3e483f35bf35,0xbf0ebf553f6d3ec4,0x3f223f46bf6dbec4,0xbe953f75be48bf7b,0x3ec4bf6da78d3f80,0x3f6dbec4bf353f35,0xbf7f3dc93f6dbec4,0xbf62bef13f7b3e48,0x3f0e3f55bf35bf35,0x3e483f7bbec4bf6d,0x3ef1bf62bec43f6d,0x3f22bf46bf0e3f55
.quad 0xa58ebf803f8026d4,0xa7773f80bf80270d,0xbf223f46bf35bf35,0x3ef1bf623f553f0e,0x3f7bbe48a7773f80,0xbf553f0ebec4bf6d,0xbf62bef13f35bf35,0x3f7fbdc9be483f7b,0x3ec43f6dbf80a7c2,0xbf6dbec43f35bf35,0x3e95bf753f353f35,0x3f223f46bf7b3e48,0xbf553f0e2804bf80,0xbe48bf7b3f6d3ec4,0x3f7f3dc9bf353f35,0xbe953f75bf0ebf55
.quad 0xbf35bf353f80271f,0x3f35bf35a7963f80,0x3dc93f7fbf35bf35,0xbf753e953f0ebf55,0x3f0ebf5527543f80,0x3f7b3e48bf6d3ec4,0xbf753e953f35bf35,0xbf46bf223f7b3e48,0x3f6d3ec4bf80268d,0x3ec43f6dbf35bf35,0xbef1bf623f353f35,0x3dc9bf7f3e483f7b,0xbe483f7b2889bf80,0xbf0e3f553ec4bf6d,0x3f46bf22bf353f35,0x3f62bef1bf553f0e
.quad 0xa137bf803f8026f7,0xa7843f80bf80a7c2,0xbe953f75bf6dbec4,0x3dc9bf7f3f7b3e48,0x3f0ebf553f353f35,0xbe483f7bbf6dbec4,0xbf463f22bec4bf6d,0x3e95bf753f553f0e,0x3f6dbec4a78d3f80,0xbec43f6dbf35bf35,0xbf7f3dc93ec4bf6d,0x3ef1bf623f0e3f55,0x3f7b3e48bf353f35,0xbf0e3f55bec4bf6d,0xbf62bef13f6dbec4,0x3f22bf463e483f7b
.quad 0x3f353f35bf80268d,0xbf353f35268dbf80,0xbef1bf623f6d3ec4,0x3f46bf22be483f7b,0x3e483f7bbf35bf35,0xbf553f0e3ec4bf6d,0x3dc9bf7f3ec43f6d,0x3f62bef1bf0e3f55,0xbec43f6d2816bf80,0xbf6d3ec43f35bf35,0x3f22bf46bec43f6d,0x3f75be95bf553f0e,0xbf553f0e3f35bf35,0xbf7b3e483f6dbec4,0x3f75be95bf6d3ec4,0x3f7fbdc9bf7b3e48
.quad 0x258dbf803f80270d,0xa78d3f80bf8026d4,0x3dc93f7fbf8026d4,0xbe95bf753f7bbe48,0xbe48bf7b3f80271f,0x3f0e3f55bf6d3ec4,0x3e953f75bf80a7d4,0xbf46bf223f55bf0e,0xbec4bf6d3f802730,0x3f6d3ec4bf353f35,0x3ef13f62bf80268d,0xbf7fbdc93f0ebf55,0xbf0ebf553f802831,0x3f7bbe48bec43f6d,0x3f223f46bf80a7e5,0xbf623ef13e48bf7b
.quad 0xbf35bf353f802754,0x3f35bf35a7b13f80,0x3f463f22bf80260e,0xbef13f62be48bf7b,0xbf55bf0e3f80a78d,0x3e48bf7b3ec43f6d,0x3f623ef1bf80a7f7,0x3dc93f7fbf0ebf55,0xbf6dbec43f802777,0xbec4bf6d3f353f35,0x3f753e95bf8021b7,0x3f223f46bf55bf0e,0xbf7bbe483f802842,0xbf55bf0e3f6d3ec4,0x3f7f3dc9bf80a804,0x3f753e95bf7bbe48
.quad 0x260dbf803f80271f,0xa7963f80bf80a7d4,0x3ef13f62bf6d3ec4,0xbf22bf463f55bf0e,0xbf55bf0e3f35bf35,0x3f7b3e48bec43f6d,0x3f7f3dc9bec43f6d,0xbf623ef1be48bf7b,0xbf6d3ec4268dbf80,0x3ec4bf6d3f353f35,0x3f22bf463ec43f6d,0x3e953f75bf7bbe48,0xbe483f7bbf35bf35,0xbf55bf0e3f6dbec4,0xbe95bf753f6d3ec4,0x3f7fbdc9bf0e3f55
.quad 0x3f353f35bf80a7f7,0xbf353f35281fbf80,0xbf75be953f6dbec4,0x3dc9bf7f3f0e3f55,0x3f7bbe48bf353f35,0x3f0e3f55bf6dbec4,0xbf463f223ec4bf6d,0xbf75be953f7bbe48,0x3ec4bf6d26d43f80,0x3f6dbec4bf353f35,0x3dc93f7fbec4bf6d,0xbef13f623e48bf7b,0xbf0ebf553f353f35,0xbe48bf7b3ec43f6d,0x3f623ef1bf6dbec4,0x3f463f22bf55bf0e
.quad 0x280dbf803f802730,0xa79f3f80bf80268d,0x3f463f22bf353f35,0xbf62bef13f0ebf55,0xbf7b3e48268dbf80,0x3f55bf0e3ec43f6d,0x3ef1bf623f353f35,0x3dc93f7fbf7bbe48,0x3ec43f6dbf80260e,0xbf6dbec43f35bf35,0xbf75be953f35bf35,0x3f46bf223e483f7b,0x3f55bf0ea85d3f80,0x3e483f7bbf6dbec4,0xbdc93f7fbf35bf35,0xbf75be953f55bf0e
.quad 0xbf35bf353f802842,0x3f35bf3526d43f80,0x3f7fbdc9bf353f35,0x3e953f75bf55bf0e,0xbf0e3f55a7b1bf80,0xbf7bbe483f6dbec4,0xbe95bf753f353f35,0x3f22bf46be483f7b,0x3f6d3ec4bf80a80d,0x3ec43f6dbf35bf35,0xbf623ef13f35bf35,0xbf7fbdc93f7bbe48,0x3e48bf7ba7e53f80,0x3f0ebf55bec43f6d,0x3f223f46bf35bf35,0x3ef13f62bf0ebf55
.quad 0x268dbf803f802831,0x27313f80bf80a7e5,0x3f753e95bec43f6d,0xbf7fbdc93e48bf7b,0xbf0e3f55bf35bf35,0x3e48bf7b3f6d3ec4,0xbf22bf463f6dbec4,0x3f753e95bf0e3f55,0x3f6dbec4270d3f80,0xbec43f6dbf35bf35,0x3dc93f7fbf6dbec4,0xbf62bef13f55bf0e,0xbf7bbe483f35bf35,0x3f0ebf553ec43f6d,0x3ef1bf623ec43f6d,0x3f463f22bf7b3e48
.quad 0x3f353f35bf80a60d,0xbf353f352730bf80,0xbf623ef13ec4bf6d,0xbf22bf463f7b3e48,0xbe48bf7b3f353f35,0x3f55bf0ebec43f6d,0x3f7f3dc9bf6d3ec4,0x3ef13f62bf55bf0e,0xbec43f6d2754bf80,0xbf6d3ec43f35bf35,0xbf46bf223f6d3ec4,0xbe95bf753f0e3f55,0x3f55bf0ebf353f35,0x3f7bbe48bf6d3ec4,0x3e953f75bec4bf6d,0x3dc93f7fbe48bf7b
.quad 0x2816bf803f802754,0xa7b13f80bf80260e,0x3f7fbdc928283f80,0xbf753e95be48bf7b,0x3e483f7bbf80a7f7,0xbf0ebf553f6dbec4,0xbf753e95281fbf80,0x3f22bf463f0e3f55,0xbec4bf6d3f802842,0x3f6d3ec4bf353f35,0x3f62bef126d43f80,0xbdc93f7fbf55bf0e,0x3f0e3f55bf80a884,0xbf7b3e483ec4bf6d,0xbf463f222730bf80,0xbef1bf623f7b3e48
.quad 0xbf35bf353f80279f,0x3f35bf35a7e53f80,0x3f22bf46a7e53f80,0x3f623ef1bf7b3e48,0x3f553f0ebf8027d4,0xbe483f7bbec4bf6d,0xbef13f622839bf80,0xbf7f3dc93f55bf0e,0xbf6dbec43f80a70d,0xbec4bf6d3f353f35,0x3e95bf75a8803f80,0x3f46bf22bf0e3f55,0x3f7b3e48bf80a909,0x3f553f0ebf6dbec4,0xbdc93f7f28a3bf80,0xbe953f753e48bf7b
.quad 0x26d4bf803f80a78d,0x270d3f80bf80a7f7,0x3f62bef13ec43f6d,0xbf463f22bf0ebf55,0x3f553f0ebf353f35,0xbf7bbe483ec4bf6d,0xbdc93f7fbf6dbec4,0xbef1bf623f7bbe48,0xbf6d3ec42828bf80,0x3ec4bf6d3f353f35,0xbf46bf223f6dbec4,0x3f75be95be483f7b,0x3e48bf7b3f353f35,0x3f553f0ebf6d3ec4,0x3f75be95bec43f6d,0x3dc93f7fbf55bf0e
.quad 0x3f353f35bf80a816,0xbf353f352839bf80,0xbe953f75bec4bf6d,0xbf7fbdc93f55bf0e,0xbf7b3e483f35bf35,0xbf0ebf553f6d3ec4,0xbf22bf463f6d3ec4,0x3e95bf753e483f7b,0x3ec4bf6da8043f80,0x3f6dbec4bf353f35,0x3f7fbdc9bf6d3ec4,0x3f623ef1bf7bbe48,0x3f0e3f55bf35bf35,0x3e483f7bbec4bf6d,0xbef13f623ec4bf6d,0xbf223f463f0ebf55
.quad 0x281fbf803f802777,0xa7c23f80bf8021b7,0x3f22bf463f353f35,0xbef13f62bf55bf0e,0x3f7bbe4826d43f80,0xbf553f0ebec4bf6d,0x3f623ef1bf353f35,0xbf7f3dc93e48bf7b,0x3ec43f6dbf80a80d,0xbf6dbec43f35bf35,0xbe953f75bf35bf35,0xbf22bf463f7bbe48,0xbf553f0e289abf80,0xbe48bf7b3f6d3ec4,0xbf7fbdc93f35bf35,0x3e95bf753f0e3f55
.quad 0xbf35bf353f80a70d,0x3f35bf35a8803f80,0xbdc9bf7f3f353f35,0x3f75be95bf0e3f55,0x3f0ebf5528be3f80,0x3f7b3e48bf6d3ec4,0x3f75be95bf353f35,0x3f463f22bf7bbe48,0x3f6d3ec4bf80a896,0x3ec43f6dbf35bf35,0x3ef13f62bf35bf35,0xbdc93f7fbe48bf7b,0xbe483f7b28eabf80,0xbf0e3f553ec4bf6d,0xbf463f223f35bf35,0xbf623ef13f55bf0e
.quad 0x270dbf803f802842,0x26d43f80bf80a804,0x3e95bf753f6d3ec4,0xbdc93f7fbf7bbe48,0x3f0ebf553f353f35,0xbe483f7bbf6dbec4,0x3f46bf223ec43f6d,0xbe953f75bf55bf0e,0x3f6dbec4a7e53f80,0xbec43f6dbf35bf35,0x3f7fbdc9bec43f6d,0xbef13f62bf0ebf55,0x3f7b3e48bf353f35,0xbf0e3f55bec4bf6d,0x3f623ef1bf6d3ec4,0xbf223f46be48bf7b
.quad 0x3f353f35bf80a70d,0xbf353f3528a3bf80,0x3ef13f62bf6dbec4,0xbf463f223e48bf7b,0x3e483f7bbf35bf35,0xbf553f0e3ec4bf6d,0xbdc93f7fbec4bf6d,0xbf623ef13f0ebf55,0xbec43f6da731bf80,0xbf6d3ec43f35bf35,0xbf223f463ec4bf6d,0xbf753e953f55bf0e,0xbf553f0e3f35bf35,0xbf7b3e483f6dbec4,0xbf753e953f6dbec4,0xbf7f3dc93f7bbe48
.quad 0xbf80a50d3f808000,0xbf80a5d43f80258d,0xbf7f3dc93f808000,0xbf753e953f7bbe48,0xbf7b3e483f808000,0xbf553f0e3f6dbec4,0xbf753e953f808000,0xbf223f463f55bf0e,0xbf6d3ec43f808000,0xbec43f6d3f35bf35,0xbf623ef13f808000,0xbdc93f7f3f0ebf55,0xbf553f0e3f808000,0x3e483f7b3ec4bf6d,0xbf463f223f808000,0x3ef13f623e48bf7b
.quad 0xbf353f353f808000,0x3f353f3525b0bf80,0xbf223f463f808000,0x3f623ef1be48bf7b,0xbf0e3f553f808000,0x3f7b3e48bec4bf6d,0xbef13f623f808000,0x3f7fbdc9bf0ebf55,0xbec43f6d3f808000,0x3f6dbec4bf35bf35,0xbe953f753f808000,0x3f46bf22bf55bf0e,0xbe483f7b3f808000,0x3f0ebf55bf6dbec4,0xbdc93f7f3f808000,0x3e95bf75bf7bbe48
.quad 0xbf80a6303f80260d,0xbf80a6773f802654,0xbf623ef13f6dbec4,0xbf463f223f55bf0e,0xbf0e3f553f35bf35,0xbe483f7b3ec4bf6d,0xbdc93f7f3ec4bf6d,0x3ef13f62be48bf7b,0x3ec43f6d261fbf80,0x3f6d3ec4bf35bf35,0x3f463f22bec4bf6d,0x3f75be95bf7bbe48,0x3f7b3e48bf35bf35,0x3f0ebf55bf6d3ec4,0x3f75be95bf6dbec4,0xbdc9bf7fbf0e3f55
.quad 0x3f35bf35bf80a630,0xbf35bf35a7423f80,0x3e95bf75bf6d3ec4,0xbf7fbdc93f0e3f55,0xbe48bf7bbf353f35,0xbf553f0e3f6d3ec4,0xbf22bf46bec43f6d,0xbe953f753f7bbe48,0xbf6dbec4a7313f80,0x3ec43f6d3f35bf35,0xbf7f3dc93ec43f6d,0x3f623ef13e48bf7b,0xbf553f0e3f353f35,0x3f7bbe48bec4bf6d,0xbef13f623f6d3ec4,0x3f22bf46bf55bf0e
.quad 0xbf80a69f3f80268d,0xbf80a7b13f8026b0,0xbf223f463f35bf35,0xbef13f623f0ebf55,0x3e483f7ba654bf80,0x3f0e3f55bec4bf6d,0x3f623ef1bf35bf35,0x3f7fbdc9bf7bbe48,0x3f6dbec4bf80a69f,0x3ec4bf6dbf353f35,0x3e95bf75bf353f35,0xbf22bf463e483f7b,0xbf0ebf55a7543f80,0xbf7b3e483f6d3ec4,0xbf7fbdc93f353f35,0xbe953f753f55bf0e
.quad 0xbf353f353f8026b0,0x3f353f35a58ebf80,0x3dc93f7f3f35bf35,0x3f75be95bf55bf0e,0x3f553f0ea60dbf80,0x3e48bf7bbf6d3ec4,0x3f75be95bf35bf35,0xbf46bf22be483f7b,0x3ec4bf6dbf80a7b1,0xbf6d3ec43f353f35,0xbef1bf62bf353f35,0xbdc93f7f3f7bbe48,0xbf7bbe48a7653f80,0x3f553f0e3ec4bf6d,0xbf463f223f353f35,0x3f62bef1bf0ebf55
.quad 0xbf80270d3f8026d4,0xbf80a7c23f8026f7,0xbe953f753ec4bf6d,0xbdc93f7f3e48bf7b,0x3f553f0ebf35bf35,0x3f7b3e48bf6dbec4,0x3f46bf22bf6d3ec4,0x3e95bf75bf0e3f55,0xbec4bf6da7773f80,0xbf6dbec43f353f35,0xbf7f3dc93f6d3ec4,0xbef13f623f55bf0e,0xbe483f7b3f35bf35,0x3f553f0ebec4bf6d,0x3f623ef1bec4bf6d,0x3f22bf46bf7b3e48
.quad 0x3f35bf35bf80a7c2,0xbf35bf35a78d3f80,0xbef1bf62bec43f6d,0xbf463f223f7b3e48,0xbf7b3e483f353f35,0x3f0e3f553ec4bf6d,0xbdc93f7f3f6dbec4,0x3f62bef1bf55bf0e,0x3f6d3ec42804bf80,0xbec4bf6dbf353f35,0x3f22bf46bf6dbec4,0xbf753e953f0e3f55,0xbf0ebf55bf353f35,0x3e483f7b3f6dbec4,0xbf753e953ec43f6d,0x3f7fbdc9be48bf7b
.quad 0xbf8026d43f80270d,0xbf80a7d43f80271f,0x3dc93f7f258dbf80,0x3e953f75be48bf7b,0x3f7bbe48bf8026d4,0x3f55bf0ebf6d3ec4,0xbe95bf75a78d3f80,0xbf46bf223f0e3f55,0xbf6d3ec43f80271f,0xbec43f6d3f35bf35,0x3ef13f62260dbf80,0x3f7f3dc9bf55bf0e,0x3f55bf0ebf80a7d4,0xbe48bf7bbec43f6d,0xbf22bf46a7963f80,0xbf623ef13f7b3e48
.quad 0xbf353f353f802730,0x3f353f35268dbf80,0x3f463f22280dbf80,0x3ef1bf62bf7b3e48,0x3f0ebf55bf80268d,0xbf7bbe483ec43f6d,0xbf62bef1a79f3f80,0x3dc93f7f3f55bf0e,0xbec43f6d3f802831,0x3f6dbec4bf35bf35,0x3f753e95268dbf80,0xbf22bf46bf0e3f55,0x3e48bf7bbf80a7e5,0xbf0e3f553f6d3ec4,0xbf7fbdc927313f80,0x3f753e953e48bf7b
.quad 0xbf80268d3f802730,0xbf80a7e53f802831,0x3ef13f62bec4bf6d,0x3f223f46bf0ebf55,0x3f0ebf55bf353f35,0x3e48bf7bbec43f6d,0xbf7fbdc93f6d3ec4,0xbf623ef13f7bbe48,0x3ec43f6d268dbf80,0x3f6d3ec4bf35bf35,0x3f22bf46bf6d3ec4,0xbe95bf75be483f7b,0xbf7bbe483f353f35,0xbf0e3f553f6dbec4,0x3e953f753ec4bf6d,0x3f7fbdc9bf55bf0e
.quad 0x3f35bf35bf80260e,0xbf35bf35270d3f80,0xbf75be953ec43f6d,0xbdc93f7f3f55bf0e,0x3e483f7b3f35bf35,0x3f55bf0ebf6dbec4,0x3f46bf22bf6dbec4,0xbf75be953e483f7b,0xbf6dbec4a85d3f80,0x3ec43f6d3f35bf35,0x3dc93f7f3f6dbec4,0x3ef1bf62bf7bbe48,0x3f55bf0ebf35bf35,0xbf7b3e483ec43f6d,0xbf62bef1bec43f6d,0x3f463f223f0ebf55
.quad 0xbf80260e3f802754,0xbf80a7f73f80a78d,0x3f463f22bf35bf35,0x3f623ef1bf55bf0e,0xbe48bf7b28283f80,0xbf0ebf553ec43f6d,0xbef13f623f35bf35,0x3dc93f7f3e48bf7b,0x3f6dbec4bf80a7f7,0x3ec4bf6dbf353f35,0xbf75be953f353f35,0xbf463f223f7bbe48,0x3f0e3f55281fbf80,0x3f7bbe48bf6dbec4,0x3dc9bf7fbf353f35,0xbf75be953f0e3f55
.quad 0xbf353f353f802842,0x3f353f352828bf80,0x3f7fbdc9bf35bf35,0xbe95bf75bf0e3f55,0xbf55bf0e26d43f80,0xbe483f7b3f6dbec4,0x3e953f753f35bf35,0x3f22bf46bf7bbe48,0x3ec4bf6dbf80a884,0xbf6d3ec43f353f35,0xbf623ef13f353f35,0x3f7f3dc9be48bf7b,0x3f7b3e482730bf80,0xbf55bf0ebec43f6d,0xbf22bf46bf353f35,0x3ef13f623f55bf0e
.quad 0xbf8021b73f802777,0xbf80a8043f802842,0x3f753e95bf6dbec4,0x3f7f3dc9bf7bbe48,0xbf55bf0e3f353f35,0xbf7bbe483f6d3ec4,0x3f223f46bec4bf6d,0x3f753e95bf55bf0e,0xbec4bf6d26d43f80,0xbf6dbec43f353f35,0x3dc93f7f3ec4bf6d,0x3f623ef1bf0ebf55,0x3e48bf7bbf353f35,0xbf55bf0e3ec43f6d,0xbef13f623f6dbec4,0x3f463f22be48bf7b
.quad 0x3f35bf35bf80a80d,0xbf35bf35a7e53f80,0xbf623ef13f6d3ec4,0x3f223f463e48bf7b,0x3f7bbe48bf35bf35,0xbf0ebf55bec43f6d,0xbf7fbdc93ec43f6d,0x3ef13f623f0ebf55,0x3f6d3ec4289abf80,0xbec4bf6dbf353f35,0xbf46bf22bec43f6d,0x3e953f753f55bf0e,0x3f0e3f553f35bf35,0xbe48bf7bbf6d3ec4,0xbe95bf75bf6d3ec4,0x3dc93f7f3f7bbe48
.quad 0xbf80a60d3f80278d,0xbf80a80d3f80a754,0x3f7fbdc9bf80a60d,0x3f75be95bf7b3e48,0xbf7b3e483f80a754,0xbf553f0e3f6dbec4,0x3f75be95bf80a80d,0x3f22bf46bf553f0e,0xbf6d3ec43f80279f,0xbec43f6d3f35bf35,0x3f62bef1bf80a68d,0x3dc9bf7fbf0e3f55,0xbf553f0e3f802854,0x3e483f7b3ec4bf6d,0x3f46bf22bf80a816,0xbef1bf62be483f7b
.quad 0xbf353f353f8027b0,0x3f353f352777bf80,0x3f22bf46bf80a88d,0xbf62bef13e483f7b,0xbf0e3f553f80a70d,0x3f7b3e48bec4bf6d,0x3ef1bf62bf80a81f,0xbf7f3dc93f0e3f55,0xbec43f6d3f8028b1,0x3f6dbec4bf35bf35,0x3e95bf75bf80a70d,0xbf463f223f553f0e,0xbe483f7b3f802865,0x3f0ebf55bf6dbec4,0x3dc9bf7fbf8027b1,0xbe953f753f7b3e48
.quad 0xbf80a68d3f80279f,0xbf80a8163f802854,0x3f62bef1bf6d3ec4,0x3f46bf22bf553f0e,0xbf0e3f553f35bf35,0xbe483f7b3ec4bf6d,0x3dc9bf7fbec43f6d,0xbef1bf623e483f7b,0x3ec43f6d2839bf80,0x3f6d3ec4bf35bf35,0xbf46bf223ec43f6d,0xbf753e953f7b3e48,0x3f7b3e48bf35bf35,0x3f0ebf55bf6d3ec4,0xbf753e953f6d3ec4,0x3dc93f7f3f0ebf55
.quad 0x3f35bf35bf80a70d,0xbf35bf35a60d3f80,0xbe953f753f6dbec4,0x3f7f3dc9bf0ebf55,0xbe48bf7bbf353f35,0xbf553f0e3f6d3ec4,0x3f223f463ec4bf6d,0x3e95bf75bf7b3e48,0xbf6dbec4a8c73f80,0x3ec43f6d3f35bf35,0x3f7fbdc9bec4bf6d,0xbf62bef1be483f7b,0xbf553f0e3f353f35,0x3f7bbe48bec4bf6d,0x3ef1bf62bf6dbec4,0xbf223f463f553f0e
.quad 0xbf80a88d3f8027b0,0xbf80a81f3f80a70d,0x3f22bf46bf353f35,0x3ef1bf62bf0e3f55,0x3e483f7b2777bf80,0x3f0e3f55bec4bf6d,0xbf62bef13f353f35,0xbf7f3dc93f7b3e48,0x3f6dbec4bf80a70d,0x3ec4bf6dbf353f35,0xbe953f753f35bf35,0x3f223f46be48bf7b,0xbf0ebf55a60d3f80,0xbf7b3e483f6d3ec4,0x3f7f3dc9bf35bf35,0x3e95bf75bf553f0e
.quad 0xbf353f353f80a68e,0x3f353f35a731bf80,0xbdc9bf7fbf353f35,0xbf753e953f553f0e,0x3f553f0ea731bf80,0x3e48bf7bbf6d3ec4,0xbf753e953f353f35,0x3f463f223e48bf7b,0x3ec4bf6dbf80a8dd,0xbf6d3ec43f353f35,0x3ef13f623f35bf35,0x3dc9bf7fbf7b3e48,0xbf7bbe48a8cf3f80,0x3f553f0e3ec4bf6d,0x3f46bf22bf35bf35,0xbf623ef13f0e3f55
.quad 0xbf80a70d3f8028b1,0xbf8027b13f802865,0x3e95bf75bec43f6d,0x3dc9bf7fbe483f7b,0x3f553f0ebf35bf35,0x3f7b3e48bf6dbec4,0xbf463f223f6dbec4,0xbe953f753f0ebf55,0xbec4bf6d27e63f80,0xbf6dbec43f353f35,0x3f7fbdc9bf6dbec4,0x3ef1bf62bf553f0e,0xbe483f7b3f35bf35,0x3f553f0ebec4bf6d,0xbf62bef13ec43f6d,0xbf223f463f7bbe48
.quad 0x3f35bf35bf80278d,0xbf35bf3527c23f80,0x3ef13f623ec4bf6d,0x3f46bf22bf7bbe48,0xbf7b3e483f353f35,0x3f0e3f553ec4bf6d,0x3dc9bf7fbf6d3ec4,0xbf623ef13f553f0e,0x3f6d3ec428f3bf80,0xbec4bf6dbf353f35,0xbf223f463f6d3ec4,0x3f75be95bf0ebf55,0xbf0ebf55bf353f35,0x3e483f7b3f6dbec4,0x3f75be95bec4bf6d,0xbf7f3dc93e483f7b
.quad 0xbf80a8963f8027d4,0xbf80a8313f80a68e,0xbdc9bf7f27e63f80,0xbe95bf753e483f7b,0x3f7bbe48bf8028a8,0x3f55bf0ebf6d3ec4,0x3e953f75a731bf80,0x3f463f22bf0ebf55,0xbf6d3ec43f802877,0xbec43f6d3f35bf35,0xbef1bf62a6d43f80,0xbf7fbdc93f553f0e,0x3f55bf0ebf80a89f,0xbe48bf7bbec43f6d,0x3f223f4627c2bf80,0x3f62bef1bf7bbe48
.quad 0xbf353f353f8028c2,0x3f353f3528b5bf80,0xbf46bf22a92a3f80,0xbef13f623f7bbe48,0x3f0ebf55bf802754,0xbf7bbe483ec43f6d,0x3f623ef1286ebf80,0xbdc9bf7fbf553f0e,0xbec43f6d3f802904,0x3f6dbec4bf35bf35,0xbf75be95284b3f80,0x3f223f463f0ebf55,0x3e48bf7bbf80a7b0,0xbf0e3f553f6d3ec4,0x3f7f3dc9a804bf80,0xbf75be95be483f7b
.quad 0xbf80a7543f80a80d,0xbf80278d3f802877,0xbef1bf623ec43f6d,0xbf22bf463f0e3f55,0x3f0ebf55bf353f35,0x3e48bf7bbec43f6d,0x3f7f3dc9bf6dbec4,0x3f62bef1bf7b3e48,0x3ec43f6d27c2bf80,0x3f6d3ec4bf35bf35,0xbf223f463f6dbec4,0x3e953f753e48bf7b,0xbf7bbe483f353f35,0xbf0e3f553f6dbec4,0xbe95bf75bec43f6d,0xbf7f3dc93f553f0e
.quad 0x3f35bf35bf80a8a8,0xbf35bf35a89a3f80,0x3f753e95bec4bf6d,0x3dc9bf7fbf553f0e,0x3e483f7b3f35bf35,0x3f55bf0ebf6dbec4,0xbf463f223f6d3ec4,0x3f753e95be48bf7b,0xbf6dbec4a90f3f80,0x3ec43f6d3f35bf35,0xbdc9bf7fbf6d3ec4,0xbef13f623f7b3e48,0x3f55bf0ebf35bf35,0xbf7b3e483ec43f6d,0x3f623ef13ec4bf6d,0xbf46bf22bf0e3f55
.quad 0xbf80a89f3f8027f7,0xbf80a8423f80a237,0xbf46bf223f353f35,0xbf62bef13f553f0e,0xbe48bf7b285d3f80,0xbf0ebf553ec43f6d,0x3ef1bf62bf353f35,0xbdc9bf7fbe483f7b,0x3f6dbec4bf802754,0x3ec4bf6dbf353f35,0x3f753e95bf35bf35,0x3f46bf22bf7b3e48,0x3f0e3f55291dbf80,0x3f7bbe48bf6dbec4,0xbdc93f7f3f35bf35,0x3f753e95bf0ebf55
.quad 0xbf353f353f80288d,0x3f353f352880bf80,0xbf7f3dc93f353f35,0x3e953f753f0ebf55,0xbf55bf0e27773f80,0xbe483f7b3f6dbec4,0xbe95bf75bf353f35,0xbf223f463f7b3e48,0x3ec4bf6dbf80a91a,0xbf6d3ec43f353f35,0x3f62bef1bf35bf35,0xbf7fbdc93e483f7b,0x3f7b3e482889bf80,0xbf55bf0ebec43f6d,0x3f223f463f35bf35,0xbef1bf62bf553f0e
.quad 0xbf80a78d3f8028c2,0xbf8027543f802884,0xbf75be953f6d3ec4,0xbf7fbdc93f7b3e48,0xbf55bf0e3f353f35,0xbf7bbe483f6d3ec4,0xbf22bf463ec43f6d,0xbf75be953f553f0e,0xbec4bf6da89a3f80,0xbf6dbec43f353f35,0xbdc9bf7fbec43f6d,0xbf62bef13f0e3f55,0x3e48bf7bbf353f35,0xbf55bf0e3ec43f6d,0x3ef1bf62bf6d3ec4,0xbf46bf223e483f7b
.quad 0x3f35bf35bf80a865,0xbf35bf35a84b3f80,0x3f62bef1bf6dbec4,0xbf22bf46be483f7b,0x3f7bbe48bf35bf35,0xbf0ebf55bec43f6d,0x3f7f3dc9bec4bf6d,0xbef1bf62bf0e3f55,0x3f6d3ec42926bf80,0xbec4bf6dbf353f35,0x3f463f223ec4bf6d,0xbe95bf75bf553f0e,0x3f0e3f553f35bf35,0xbe48bf7bbf6d3ec4,0x3e953f753f6dbec4,0xbdc9bf7fbf7b3e48
.quad 0xa5543f803f808000,0x261fbf80bf80a5d4,0x3dc93f7f3f808000,0xbe95bf75bf7b3e48,0x3e483f7b3f808000,0xbf0ebf55bf6d3ec4,0x3e953f753f808000,0xbf46bf22bf553f0e,0x3ec43f6d3f808000,0xbf6dbec4bf353f35,0x3ef13f623f808000,0xbf7fbdc9bf0e3f55,0x3f0e3f553f808000,0xbf7b3e48bec43f6d,0x3f223f463f808000,0xbf623ef1be483f7b
.quad 0x3f353f353f808000,0xbf353f35a5f73f80,0x3f463f223f808000,0xbef13f623e483f7b,0x3f553f0e3f808000,0xbe483f7b3ec43f6d,0x3f623ef13f808000,0x3dc93f7f3f0e3f55,0x3f6d3ec43f808000,0x3ec43f6d3f353f35,0x3f753e953f808000,0x3f223f463f553f0e,0x3f7b3e483f808000,0x3f553f0e3f6d3ec4,0x3f7f3dc93f808000,0x3f753e953f7b3e48
.quad 0xa7423f803f802654,0xa60dbf80bf80a69f,0x3ef13f623f6dbec4,0xbf22bf46bf553f0e,0x3f553f0e3f35bf35,0xbf7bbe48bec43f6d,0x3f7f3dc93ec4bf6d,0xbf623ef13e483f7b,0x3f6dbec4a68dbf80,0xbec43f6d3f353f35,0x3f22bf46bec4bf6d,0x3e953f753f7b3e48,0x3e48bf7bbf35bf35,0x3f553f0e3f6dbec4,0xbe95bf75bf6dbec4,0x3f7fbdc93f0ebf55
.quad 0xbf35bf35bf80a677,0x3f35bf35a60dbf80,0xbf75be95bf6d3ec4,0x3dc9bf7fbf0ebf55,0xbf7b3e48bf353f35,0xbf0ebf55bf6dbec4,0xbf463f22bec43f6d,0xbf75be95bf7b3e48,0xbec43f6da7423f80,0xbf6d3ec4bf353f35,0x3dc93f7f3ec43f6d,0xbef13f62be483f7b,0x3f0e3f553f353f35,0x3e483f7b3ec43f6d,0x3f623ef13f6d3ec4,0x3f463f223f553f0e
.quad 0xa7773f803f8026d4,0x258dbf80bf80a7c2,0x3f463f223f35bf35,0xbf62bef1bf0e3f55,0x3f7bbe48a58ebf80,0xbf553f0e3ec43f6d,0x3ef1bf62bf35bf35,0x3dc93f7f3f7b3e48,0xbec4bf6dbf80270d,0x3f6d3ec43f35bf35,0xbf75be95bf353f35,0x3f46bf22be48bf7b,0xbf553f0ea7773f80,0xbe48bf7bbf6dbec4,0xbdc93f7f3f353f35,0xbf75be95bf553f0e
.quad 0x3f353f353f8026f7,0xbf353f35a78d3f80,0x3f7fbdc93f35bf35,0x3e953f753f553f0e,0x3f0ebf55a137bf80,0x3f7b3e483f6dbec4,0xbe95bf75bf35bf35,0x3f22bf463e48bf7b,0xbf6dbec4bf80a7c2,0xbec4bf6dbf35bf35,0xbf623ef1bf353f35,0xbf7fbdc9bf7b3e48,0xbe483f7ba7843f80,0xbf0e3f55bec43f6d,0x3f223f463f353f35,0x3ef13f623f0e3f55
.quad 0xa7963f803f80271f,0x268dbf80bf80268d,0x3f753e953ec4bf6d,0xbf7fbdc9be483f7b,0x3f0ebf55bf35bf35,0xbe483f7b3f6d3ec4,0xbf22bf46bf6d3ec4,0x3f753e953f0ebf55,0xbf6d3ec427543f80,0x3ec4bf6dbf35bf35,0x3dc93f7f3f6d3ec4,0xbf62bef1bf553f0e,0x3f7b3e483f35bf35,0xbf0e3f553ec43f6d,0x3ef1bf62bec4bf6d,0x3f463f223f7bbe48
.quad 0xbf35bf35bf80268d,0x3f35bf352816bf80,0xbf623ef1bec43f6d,0xbf22bf46bf7bbe48,0x3e483f7b3f353f35,0xbf553f0ebec43f6d,0x3f7f3dc93f6dbec4,0x3ef13f623f553f0e,0x3ec4bf6d2889bf80,0x3f6dbec43f35bf35,0xbf46bf22bf6dbec4,0xbe95bf75bf0ebf55,0xbf553f0ebf353f35,0xbf7b3e48bf6d3ec4,0x3e953f753ec43f6d,0x3dc93f7f3e483f7b
.quad 0xa7b13f803f802754,0x281fbf80bf80a7f7,0x3f7fbdc92816bf80,0xbf753e953e483f7b,0xbe48bf7bbf80260e,0x3f0e3f553f6dbec4,0xbf753e95a7b13f80,0x3f22bf46bf0ebf55,0x3ec43f6d3f80a78d,0xbf6dbec4bf353f35,0x3f62bef126d4bf80,0xbdc93f7f3f553f0e,0xbf0ebf55bf80a7f7,0x3f7bbe483ec4bf6d,0xbf463f22270d3f80,0xbef1bf62bf7bbe48
.quad 0x3f353f353f802777,0xbf353f3526d43f80,0x3f22bf46281fbf80,0x3f623ef13f7bbe48,0xbf55bf0ebf8021b7,0x3e48bf7bbec4bf6d,0xbef13f62a7c23f80,0xbf7f3dc9bf553f0e,0x3f6d3ec43f802842,0x3ec43f6d3f353f35,0x3e95bf75270dbf80,0x3f46bf223f0ebf55,0xbf7bbe48bf80a804,0xbf55bf0ebf6dbec4,0xbdc93f7f26d43f80,0xbe953f75be483f7b
.quad 0x26d43f803f802842,0x2730bf80bf80a60d,0x3f62bef1bec4bf6d,0xbf463f223f0e3f55,0xbf55bf0ebf353f35,0x3f7b3e483ec4bf6d,0xbdc93f7f3f6d3ec4,0xbef1bf62bf7b3e48,0x3f6dbec4a7b1bf80,0xbec43f6d3f353f35,0xbf46bf22bf6d3ec4,0x3f75be953e48bf7b,0xbe483f7b3f353f35,0xbf55bf0ebf6d3ec4,0x3f75be953ec4bf6d,0x3dc93f7f3f553f0e
.quad 0xbf35bf35bf80a80d,0x3f35bf352754bf80,0xbe953f753ec43f6d,0xbf7fbdc9bf553f0e,0x3f7bbe483f35bf35,0x3f0e3f553f6d3ec4,0xbf22bf46bf6dbec4,0x3e95bf75be48bf7b,0xbec43f6da7e53f80,0xbf6d3ec4bf353f35,0x3f7fbdc93f6dbec4,0x3f623ef13f7b3e48,0xbf0ebf55bf35bf35,0xbe48bf7bbec4bf6d,0xbef13f62bec43f6d,0xbf223f46bf0e3f55
.quad 0xa7e53f803f80279f,0x2839bf80bf80a816,0x3f22bf46bf35bf35,0xbef13f623f553f0e,0xbf7b3e48a7e53f80,0x3f55bf0ebec4bf6d,0x3f623ef13f35bf35,0xbf7f3dc9be483f7b,0xbec4bf6dbf8027d4,0x3f6d3ec43f35bf35,0xbe953f753f353f35,0xbf22bf46bf7b3e48,0x3f55bf0e2839bf80,0x3e483f7b3f6d3ec4,0xbf7fbdc9bf353f35,0x3e95bf75bf0ebf55
.quad 0x3f353f353f80a70d,0xbf353f35a8043f80,0xbdc9bf7fbf35bf35,0x3f75be953f0ebf55,0xbf0e3f55a8803f80,0xbf7bbe48bf6d3ec4,0x3f75be953f35bf35,0x3f463f223f7b3e48,0xbf6dbec4bf80a909,0xbec4bf6dbf35bf35,0x3ef13f623f353f35,0xbdc93f7f3e483f7b,0x3e48bf7b28a3bf80,0x3f0ebf553ec4bf6d,0xbf463f22bf353f35,0xbf623ef1bf553f0e
.quad 0xa8803f803f80a70d,0x28a3bf80bf80a70d,0x3e95bf75bf6dbec4,0xbdc93f7f3f7b3e48,0xbf0e3f553f353f35,0x3e48bf7bbf6dbec4,0x3f46bf22bec4bf6d,0xbe953f753f553f0e,0xbf6d3ec428be3f80,0x3ec4bf6dbf35bf35,0x3f7fbdc93ec4bf6d,0xbef13f623f0e3f55,0xbf7bbe48bf353f35,0x3f0ebf55bec4bf6d,0x3f623ef13f6dbec4,0xbf223f463e483f7b
.quad 0xbf35bf35bf80a896,0x3f35bf35a731bf80,0x3ef13f623f6d3ec4,0xbf463f22be483f7b,0xbe48bf7bbf35bf35,0x3f55bf0e3ec4bf6d,0xbdc93f7f3ec43f6d,0xbf623ef1bf0e3f55,0x3ec4bf6d28eabf80,0x3f6dbec43f35bf35,0xbf223f46bec43f6d,0xbf753e95bf553f0e,0x3f55bf0e3f35bf35,0x3f7bbe483f6dbec4,0xbf753e95bf6d3ec4,0xbf7f3dc9bf7b3e48
.quad 0x27e63f803f8027d4,0xa731bf80bf80a831,0xbdc9bf7fbf80a896,0x3e953f753f7bbe48,0x3e483f7b3f80a68e,0xbf0ebf55bf6d3ec4,0xbe95bf75bf80a831,0x3f463f223f55bf0e,0x3ec43f6d3f80a80d,0xbf6dbec4bf353f35,0xbef1bf62bf80a754,0x3f7f3dc93f0ebf55,0x3f0e3f553f802877,0xbf7b3e48bec43f6d,0xbf22bf46bf80278d,0x3f62bef13e48bf7b
.quad 0x3f353f353f8027f7,0xbf353f35a8923f80,0xbf46bf22bf80a89f,0x3ef1bf62be48bf7b,0x3f553f0e3f80a237,0xbe483f7b3ec43f6d,0xbf62bef1bf80a842,0xbdc9bf7fbf0ebf55,0x3f6d3ec43f8028c2,0x3ec43f6d3f353f35,0xbf75be95bf80a78d,0xbf22bf46bf55bf0e,0x3f7b3e483f802884,0x3f553f0e3f6d3ec4,0xbf7fbdc9bf802754,0xbf75be95bf7bbe48
.quad 0xa6d43f803f802877,0x27c2bf80bf80a89f,0xbef1bf62bf6d3ec4,0x3f223f463f55bf0e,0x3f553f0e3f35bf35,0xbf7bbe48bec43f6d,0xbf7fbdc9bec43f6d,0x3f62bef1be48bf7b,0x3f6dbec427c2bf80,0xbec43f6d3f353f35,0xbf223f463ec43f6d,0xbe95bf75bf7bbe48,0x3e48bf7bbf35bf35,0x3f553f0e3f6dbec4,0x3e953f753f6d3ec4,0xbf7f3dc9bf0e3f55
.quad 0xbf35bf35bf802754,0x3f35bf3527e5bf80,0x3f753e953f6dbec4,0xbdc93f7f3f0e3f55,0xbf7b3e48bf353f35,0xbf0ebf55bf6dbec4,0x3f46bf223ec4bf6d,0x3f753e953f7bbe48,0xbec43f6da89a3f80,0xbf6d3ec4bf353f35,0xbdc9bf7fbec4bf6d,0x3ef1bf623e48bf7b,0x3f0e3f553f353f35,0x3e483f7b3ec43f6d,0xbf62bef1bf6dbec4,0xbf46bf22bf55bf0e
.quad 0xa8283f803f8028c2,0x286ebf80bf802754,0xbf46bf22bf353f35,0x3f623ef13f0ebf55,0x3f7bbe48a816bf80,0xbf553f0e3ec43f6d,0xbef13f623f353f35,0xbdc9bf7fbf7bbe48,0xbec4bf6dbf802831,0x3f6d3ec43f35bf35,0x3f753e953f35bf35,0xbf463f223e483f7b,0xbf553f0ea89a3f80,0xbe48bf7bbf6dbec4,0x3dc9bf7fbf35bf35,0x3f753e953f55bf0e
.quad 0x3f353f353f80288d,0xbf353f3527773f80,0xbf7f3dc9bf353f35,0xbe95bf75bf55bf0e,0x3f0ebf55a880bf80,0x3f7b3e483f6dbec4,0x3e953f753f353f35,0xbf223f46be483f7b,0xbf6dbec4bf80a865,0xbec4bf6dbf35bf35,0x3f62bef13f35bf35,0x3f7f3dc93f7bbe48,0xbe483f7ba84b3f80,0xbf0e3f55bec43f6d,0xbf22bf46bf35bf35,0xbef1bf62bf0ebf55
.quad 0xa89a3f803f80268d,0x28bebf80bf80a7b0,0xbf75be95bec43f6d,0x3f7f3dc93e48bf7b,0x3f0ebf55bf35bf35,0xbe483f7b3f6d3ec4,0x3f223f463f6dbec4,0xbf75be95bf0e3f55,0xbf6d3ec428e13f80,0x3ec4bf6dbf35bf35,0xbdc9bf7fbf6dbec4,0x3f623ef13f55bf0e,0x3f7b3e483f35bf35,0xbf0e3f553ec43f6d,0xbef13f623ec43f6d,0xbf46bf22bf7b3e48
.quad 0xbf35bf35bf80a7d4,0x3f35bf352889bf80,0x3f62bef13ec4bf6d,0x3f223f463f7b3e48,0x3e483f7b3f353f35,0xbf553f0ebec43f6d,0xbf7fbdc9bf6d3ec4,0xbef1bf62bf55bf0e,0x3ec4bf6d2926bf80,0x3f6dbec43f35bf35,0x3f463f223f6d3ec4,0x3e953f753f0e3f55,0xbf553f0ebf353f35,0xbf7b3e48bf6d3ec4,0xbe95bf75bec4bf6d,0xbdc9bf7fbe48bf7b
.quad 0x27773f803f80281f,0x260cbf80bf80a865,0xbf7f3dc9a8e13f80,0x3f75be95be48bf7b,0xbe48bf7bbf80a865,0x3f0e3f553f6dbec4,0x3f75be952902bf80,0xbf223f463f0e3f55,0x3ec43f6d3f80a854,0xbf6dbec4bf353f35,0xbf623ef1a79f3f80,0x3dc9bf7fbf55bf0e,0xbf0ebf55bf80a8b9,0x3f7bbe483ec4bf6d,0x3f46bf22a8b5bf80,0x3ef13f623f7b3e48
.quad 0x3f353f353f80a78d,0xbf353f35a9183f80,0xbf223f46a85d3f80,0xbf62bef1bf7b3e48,0xbf55bf0ebf80a900,0x3e48bf7bbec4bf6d,0x3ef1bf62a85dbf80,0x3f7fbdc93f55bf0e,0x3f6d3ec43f802989,0x3ec43f6d3f353f35,0xbe953f75a8b53f80,0xbf463f22bf0e3f55,0xbf7bbe48bf80a923,0xbf55bf0ebf6dbec4,0x3dc9bf7fa79fbf80,0x3e95bf753e48bf7b
.quad 0xa79f3f803f802896,0x2926bf80bf80a8b9,0xbf623ef13ec43f6d,0x3f46bf22bf0ebf55,0xbf55bf0ebf353f35,0x3f7b3e483ec4bf6d,0x3dc9bf7fbf6dbec4,0x3ef13f623f7bbe48,0x3f6dbec426d3bf80,0xbec43f6d3f353f35,0x3f463f223f6dbec4,0xbf753e95be483f7b,0xbe483f7b3f353f35,0xbf55bf0ebf6d3ec4,0xbf753e95bec43f6d,0xbdc9bf7fbf55bf0e
.quad 0xbf35bf35bf80a884,0x3f35bf35a79fbf80,0x3e95bf75bec4bf6d,0x3f7f3dc93f55bf0e,0x3f7bbe483f35bf35,0x3f0e3f553f6d3ec4,0x3f223f463f6d3ec4,0xbe953f753e483f7b,0xbec43f6da8fc3f80,0xbf6d3ec4bf353f35,0xbf7f3dc9bf6d3ec4,0xbf62bef1bf7bbe48,0xbf0ebf55bf35bf35,0xbe48bf7bbec4bf6d,0x3ef1bf623ec4bf6d,0x3f22bf463f0ebf55
.quad 0xa85d3f803f80a78d,0xa85dbf80bf80a900,0xbf223f463f353f35,0x3ef1bf62bf55bf0e,0xbf7b3e4828cf3f80,0x3f55bf0ebec4bf6d,0xbf62bef1bf353f35,0x3f7fbdc93e48bf7b,0xbec4bf6dbf80293e,0x3f6d3ec43f35bf35,0x3e95bf75bf35bf35,0x3f223f463f7bbe48,0x3f55bf0e296cbf80,0x3e483f7b3f6d3ec4,0x3f7f3dc93f35bf35,0xbe953f753f0e3f55
.quad 0x3f353f353f802916,0xbf353f35a8803f80,0x3dc93f7f3f353f35,0xbf753e95bf0e3f55,0xbf0e3f55a8803f80,0xbf7bbe48bf6d3ec4,0xbf753e95bf353f35,0xbf46bf22bf7bbe48,0xbf6dbec4bf80a96a,0xbec4bf6dbf35bf35,0xbef1bf62bf35bf35,0x3dc9bf7fbe48bf7b,0x3e48bf7b2914bf80,0x3f0ebf553ec4bf6d,0x3f46bf223f35bf35,0x3f62bef13f55bf0e
.quad 0xa8b53f803f80278d,0xa79fbf80bf80a923,0xbe953f753f6d3ec4,0x3dc9bf7fbf7bbe48,0xbf0e3f553f353f35,0x3e48bf7bbf6dbec4,0xbf463f223ec43f6d,0x3e95bf75bf55bf0e,0xbf6d3ec429023f80,0x3ec4bf6dbf35bf35,0xbf7f3dc9bec43f6d,0x3ef1bf62bf0ebf55,0xbf7bbe48bf353f35,0x3f0ebf55bec4bf6d,0xbf62bef1bf6d3ec4,0x3f22bf46be48bf7b
.quad 0xbf35bf35bf8027b1,0x3f35bf352914bf80,0xbef1bf62bf6dbec4,0x3f46bf223e48bf7b,0xbe48bf7bbf35bf35,0x3f55bf0e3ec4bf6d,0x3dc9bf7fbec4bf6d,0x3f62bef13f0ebf55,0x3ec4bf6d28acbf80,0x3f6dbec43f35bf35,0x3f22bf463ec4bf6d,0x3f75be953f55bf0e,0x3f55bf0e3f35bf35,0x3f7bbe483f6dbec4,0x3f75be953f6dbec4,0x3f7fbdc93f7bbe48
.size tab_k2, 40960
.p2align 8
.type tab_t,@object
tab_t:
.quad 0x3d353d353d353d35,0x3d353d353d353d35,0x3d2d3d323d343d35,0xbc52bc0dbb8e2248,0x3d173d273d323d35,0xbd17bd27bd32bd35,0x3ce63d173d2d3d35,0x3d0c3cc93c52a316,0x3c8b3d003d273d35,0x3c8b3d003d273d35,0x3b8e3cc93d203d35,0xbd34bd17bcab237a,0xbc0d3c8b3d173d35,0x3c0dbc8bbd17bd35,0xbcab3c0d3d0c3d35,0x3d203d323ce6a3af
.quad 0xbd0022483d003d35,0xbd0023e13d003d35,0xbd20bc0d3ce63d35,0xbcabbd32bd0c23e1,0xbd32bc8b3cc93d35,0x3d323c8bbcc9bd35,0xbd34bcc93cab3d35,0xbb8e3d173d20a4fa,0xbd27bd003c8b3d35,0xbd27bd003c8b3d35,0xbd0cbd173c523d35,0x3ce6bcc9bd2da448,0xbcc9bd273c0d3d35,0x3cc93d27bc0dbd35,0xbc52bd323b8e3d35,0xbd2d3c0d3d34a509
.quad 0x3d353d353d353d35,0x3d353d353d353d35,0x3d0c3d173d203d27,0xbce6bcc9bcabbc8b,0x3c0d3c8b3cc93d00,0xbc0dbc8bbcc9bd00,0xbcabbc0d3b8e3c8b,0x3d203d323d343d27,0xbd27bd00bc8b2248,0xbd27bd00bc8b237a,0xbd2dbd32bd0cbc8b,0x3c52bc0dbce6bd27,0xbcc9bd27bd32bd00,0x3cc93d273d323d00,0x3b8ebcc9bd2dbd27,0xbd34bd17bc523c8b
.quad 0x3d00a316bd00bd35,0x3d00a4fabd00bd35,0x3d343cc9bc52bd27,0x3b8e3d173d2d3c8b,0x3d173d273c0dbd00,0xbd17bd27bc0d3d00,0x3c523d323ce6bc8b,0x3d2d3c0dbd0cbd27,0xbc8b3d003d27a316,0xbc8b3d003d27a509,0xbd203c0d3d343c8b,0xbcabbd32bb8e3d27,0xbd32bc8b3d173d00,0x3d323c8bbd17bd00,0xbce6bd173cab3d27,0xbd0c3cc93d20bc8b
.quad 0x3d353d353d353d35,0x3d353d353d353d35,0x3cab3cc93ce63d00,0xbd20bd17bd0cbd00,0xbcc9bc8bbc0d2248,0x3cc93c8b3c0da316,0xbd34bd32bd20bd00,0xbb8e3c0d3cab3d00,0xbc8bbd00bd27bd35,0xbc8bbd00bd27bd35,0x3ce63c0dbc52bd00,0x3d0c3d323d2d3d00,0x3d323d273cc9a316,0xbd32bd27bcc923e1,0x3c523d173d343d00,0x3d2d3cc9bb8ebd00
.quad 0xbd00237a3d003d35,0xbd00a4483d003d35,0xbd2dbd17bb8e3d00,0x3c52bcc9bd34bd00,0xbc0dbd27bd17237a,0x3c0d3d273d17a509,0x3d0cbc0dbd2dbd00,0xbce6bd32bc523d00,0x3d273d00bc8bbd35,0x3d273d00bc8bbd35,0x3b8e3d323cabbd00,0xbd34bc0d3d203d00,0xbd173c8b3d32a3af,0x3d17bc8bbd32a3c8,0xbd20bcc93d0c3d00,0xbcab3d173ce6bd00
.quad 0x3d353d353d353d35,0x3d353d353d353d35,0x3b8e3c0d3c523c8b,0xbd34bd32bd2dbd27,0xbd32bd27bd17bd00,0x3d323d273d173d00,0xbc52bcc9bd0cbd27,0xbd2dbd17bce6bc8b,0x3d273d003c8ba316,0x3d273d003c8ba3af,0x3cab3d173d343d27,0xbd20bcc9bb8e3c8b,0xbd17bc8b3c0d3d00,0x3d173c8bbc0dbd00,0xbce6bd32bd20bc8b,0xbd0cbc0d3cab3d27
.quad 0x3d00a3afbd00bd35,0x3d00a509bd00bd35,0x3d0c3d323cabbc8b,0xbce63c0d3d203d27,0xbcc93c8b3d323d00,0x3cc9bc8bbd32bd00,0xbd20bd173b8e3d27,0xbcab3cc93d343c8b,0x3c8bbd00bd2723e1,0x3c8bbd00bd27a3c8,0x3d2d3cc9bce6bd27,0xbc523d173d0cbc8b,0xbc0d3d273cc9bd00,0x3c0dbd27bcc93d00,0xbd34bc0d3d2d3c8b,0xbb8e3d323c52bd27
.quad 0x3d353d353d353d35,0x3d353d353d353d35,0xbd2dbd32bd34bd35,0x3c523c0d3b8ea316,0x3d173d273d323d35,0xbd17bd27bd32bd35,0xbce6bd17bd2dbd35,0xbd0cbcc9bc5223e1,0x3c8b3d003d273d35,0x3c8b3d003d273d35,0xbb8ebcc9bd20bd35,0x3d343d173caba509,0xbc0d3c8b3d173d35,0x3c0dbc8bbd17bd35,0x3cabbc0dbd0cbd35,0xbd20bd32bce6a3c8
.quad 0xbd00a4163d003d35,0xbd00a3483d003d35,0x3d203c0dbce6bd35,0x3cab3d323d0ca52f,0xbd32bc8b3cc93d35,0x3d323c8bbcc9bd35,0x3d343cc9bcabbd35,0x3b8ebd17bd202347,0xbd27bd003c8b3d35,0xbd27bd003c8b3d35,0x3d0c3d17bc52bd35,0xbce63cc93d2da554,0xbcc9bd273c0d3d35,0x3cc93d27bc0dbd35,0x3c523d32bb8ebd35,0x3d2dbc0dbd342448
.quad 0x3d353d353d353d35,0x3d353d353d353d35,0xbd0cbd17bd20bd27,0x3ce63cc93cab3c8b,0x3c0d3c8b3cc93d00,0xbc0dbc8bbcc9bd00,0x3cab3c0dbb8ebc8b,0xbd20bd32bd34bd27,0xbd27bd00bc8b23e1,0xbd27bd00bc8ba448,0x3d2d3d323d0c3c8b,0xbc523c0d3ce63d27,0xbcc9bd27bd32bd00,0x3cc93d273d323d00,0xbb8e3cc93d2d3d27,0x3d343d173c52bc8b
.quad 0x3d00a516bd00bd35,0x3d00a52fbd00bd35,0xbd34bcc93c523d27,0xbb8ebd17bd2dbc8b,0x3d173d273c0dbd00,0xbd17bd27bc0d3d00,0xbc52bd32bce63c8b,0xbd2dbc0d3d0c3d27,0xbc8b3d003d27a52f,0xbc8b3d003d272516,0x3d20bc0dbd34bc8b,0x3cab3d323b8ebd27,0xbd32bc8b3d173d00,0x3d323c8bbd17bd00,0x3ce63d17bcabbd27,0x3d0cbcc9bd203c8b
.quad 0x3d353d353d353d35,0x3d353d353d353d35,0xbcabbcc9bce6bd00,0x3d203d173d0c3d00,0xbcc9bc8bbc0d237a,0x3cc93c8b3c0da3af,0x3d343d323d203d00,0x3b8ebc0dbcabbd00,0xbc8bbd00bd27bd35,0xbc8bbd00bd27bd35,0xbce6bc0d3c523d00,0xbd0cbd32bd2dbd00,0x3d323d273cc9a509,0xbd32bd27bcc9a3c8,0xbc52bd17bd34bd00,0xbd2dbcc93b8e3d00
.quad 0xbd00a3c83d003d35,0xbd009f013d003d35,0x3d2d3d173b8ebd00,0xbc523cc93d343d00,0xbc0dbd27bd17a348,0x3c0d3d273d17a548,0xbd0c3c0d3d2d3d00,0x3ce63d323c52bd00,0x3d273d00bc8bbd35,0x3d273d00bc8bbd35,0xbb8ebd32bcab3d00,0x3d343c0dbd20bd00,0xbd173c8b3d32a548,0x3d17bc8bbd3225d4,0x3d203cc9bd0cbd00,0x3cabbd17bce63d00
.quad 0x3d353d353d353d35,0x3d353d353d353d35,0xbb8ebc0dbc52bc8b,0x3d343d323d2d3d27,0xbd32bd27bd17bd00,0x3d323d273d173d00,0x3c523cc93d0c3d27,0x3d2d3d173ce63c8b,0x3d273d003c8ba4fa,0x3d273d003c8ba509,0xbcabbd17bd34bd27,0x3d203cc93b8ebc8b,0xbd17bc8b3c0d3d00,0x3d173c8bbc0dbd00,0x3ce63d323d203c8b,0x3d0c3c0dbcabbd27
.quad 0x3d00a522bd00bd35,0x3d00a53bbd00bd35,0xbd0cbd32bcab3c8b,0x3ce6bc0dbd20bd27,0xbcc93c8b3d323d00,0x3cc9bc8bbd32bd00,0x3d203d17bb8ebd27,0x3cabbcc9bd34bc8b,0x3c8bbd00bd2725bb,0x3c8bbd00bd272641,0xbd2dbcc93ce63d27,0x3c52bd17bd0c3c8b,0xbc0d3d273cc9bd00,0x3c0dbd27bcc93d00,0x3d343c0dbd2dbc8b,0x3b8ebd32bc523d27
.quad 0xbd353d35bd353d35,0xbd353d35bd353d35,0xbc52bc0dbb8e8000,0xbd2dbd32bd34bd35,0xbcc9bc8bbc0d8000,0x3cc93c8b3c0da2c8,0xbd0cbcc9bc528000,0x3ce63d173d2d3d35,0xbd27bd00bc8b8000,0xbd27bd00bc8b2348,0xbd34bd17bcab8000,0xbb8ebcc9bd20bd35,0xbd32bd27bcc98000,0x3d323d273cc9a396,0xbd20bd32bce68000,0xbcab3c0d3d0c3d35
.quad 0xbd00bd35bd008000,0xbd00bd35bd0023c8,0xbcabbd32bd0c8000,0x3d203c0dbce6bd35,0xbc0dbd27bd178000,0x3c0d3d273d17a3fa,0x3b8ebd17bd208000,0xbd34bcc93cab3d35,0x3c8bbd00bd278000,0x3c8bbd00bd272416,0x3ce6bcc9bd2d8000,0x3d0c3d17bc52bd35,0x3d17bc8bbd328000,0xbd173c8b3d32a42f,0x3d2dbc0dbd348000,0xbc52bd323b8e3d35
.quad 0xbd353d35bd353d35,0xbd353d35bd353d35,0xbce6bcc9bcabbc8b,0xbd0cbd17bd20bd27,0xbd32bd27bd17bd00,0x3d323d273d173d00,0xbd20bd32bd34bd27,0xbcabbc0d3b8e3c8b,0xbc8bbd00bd27bd35,0xbc8bbd00bd27bd35,0x3c52bc0dbce6bd27,0x3d2d3d323d0c3c8b,0x3d173c8bbc0dbd00,0xbd17bc8b3c0d3d00,0x3d343d173c52bc8b,0x3b8ebcc9bd2dbd27
.quad 0x3d003d353d00a2c8,0x3d003d353d00a3fa,0x3b8e3d173d2d3c8b,0xbd34bcc93c523d27,0xbcc93c8b3d323d00,0x3cc9bc8bbd32bd00,0xbd2dbc0d3d0c3d27,0x3c523d323ce6bc8b,0xbd27bd003c8b3d35,0xbd27bd003c8b3d35,0xbcabbd32bb8e3d27,0x3d20bc0dbd34bc8b,0x3c0dbd27bcc93d00,0xbc0d3d273cc9bd00,0x3d0cbcc9bd203c8b,0xbce6bd173cab3d27
.quad 0xbd353d35bd353d35,0xbd353d35bd353d35,0xbd20bd17bd0cbd00,0xbcabbcc9bce6bd00,0xbd17bd27bd32bd35,0x3d173d273d323d35,0x3b8ebc0dbcabbd00,0xbd34bd32bd20bd00,0x3d273d003c8ba2c8,0x3d273d003c8ba396,0x3d0c3d323d2d3d00,0xbce6bc0d3c523d00,0xbc0d3c8b3d173d35,0x3c0dbc8bbd17bd35,0xbd2dbcc93b8e3d00,0x3c523d173d343d00
.quad 0xbd00bd35bd002348,0xbd00bd35bd002416,0x3c52bcc9bd34bd00,0x3d2d3d173b8ebd00,0x3d323c8bbcc9bd35,0xbd32bc8b3cc93d35,0x3ce63d323c52bd00,0x3d0cbc0dbd2dbd00,0xbc8b3d003d27a396,0xbc8b3d003d27a461,0xbd34bc0d3d203d00,0xbb8ebd32bcab3d00,0xbcc9bd273c0d3d35,0x3cc93d27bc0dbd35,0x3cabbd17bce63d00,0xbd20bcc93d0c3d00
.quad 0xbd353d35bd353d35,0xbd353d35bd353d35,0xbd34bd32bd2dbd27,0xbb8ebc0dbc52bc8b,0xbc0dbc8bbcc9bd00,0x3c0d3c8b3cc93d00,0x3d2d3d173ce63c8b,0xbc52bcc9bd0cbd27,0x3c8b3d003d273d35,0x3c8b3d003d273d35,0xbd20bcc9bb8e3c8b,0xbcabbd17bd34bd27,0xbcc9bd27bd32bd00,0x3cc93d273d323d00,0x3d0c3c0dbcabbd27,0xbce6bd32bd20bc8b
.quad 0x3d003d353d00a396,0x3d003d353d00a42f,0xbce63c0d3d203d27,0xbd0cbd32bcab3c8b,0xbd17bd27bc0d3d00,0x3d173d273c0dbd00,0x3cabbcc9bd34bc8b,0xbd20bd173b8e3d27,0x3d273d00bc8bbd35,0x3d273d00bc8bbd35,0xbc523d173d0cbc8b,0xbd2dbcc93ce63d27,0xbd32bc8b3d173d00,0x3d323c8bbd17bd00,0x3b8ebd32bc523d27,0xbd34bc0d3d2d3c8b
.quad 0xbd353d35bd353d35,0xbd353d35bd353d35,0x3c523c0d3b8ea2c8,0x3d2d3d323d343d35,0xbcc9bc8bbc0d2348,0x3cc93c8b3c0da396,0x3d0c3cc93c52a396,0xbce6bd17bd2dbd35,0xbd27bd00bc8b23c8,0xbd27bd00bc8b2416,0x3d343d173caba3fa,0x3b8e3cc93d203d35,0xbd32bd27bcc92416,0x3d323d273cc9a461,0x3d203d323ce6a42f,0x3cabbc0dbd0cbd35
.quad 0xbd00bd35bd002448,0xbd00bd35bd002496,0x3cab3d323d0ca461,0xbd20bc0d3ce63d35,0xbc0dbd27bd17247a,0x3c0d3d273d17a589,0xbb8e3d173d20a57a,0x3d343cc9bcabbd35,0x3c8bbd00bd272496,0x3c8bbd00bd2724e1,0xbce63cc93d2d24c8,0xbd0cbd173c523d35,0x3d17bc8bbd3224af,0xbd173c8b3d322448,0xbd2d3c0d3d34a589,0x3c523d32bb8ebd35
.quad 0xbd353d35bd353d35,0xbd353d35bd353d35,0x3ce63cc93cab3c8b,0x3d0c3d173d203d27,0xbd32bd27bd17bd00,0x3d323d273d173d00,0x3d203d323d343d27,0x3cab3c0dbb8ebc8b,0xbc8bbd00bd27bd35,0xbc8bbd00bd27bd35,0xbc523c0d3ce63d27,0xbd2dbd32bd0cbc8b,0x3d173c8bbc0dbd00,0xbd17bc8b3c0d3d00,0xbd34bd17bc523c8b,0xbb8e3cc93d2d3d27
.quad 0x3d003d353d00a461,0x3d003d353d0024c8,0xbb8ebd17bd2dbc8b,0x3d343cc9bc52bd27,0xbcc93c8b3d323d00,0x3cc9bc8bbd32bd00,0x3d2d3c0dbd0cbd27,0xbc52bd32bce63c8b,0xbd27bd003c8b3d35,0xbd27bd003c8b3d35,0x3cab3d323b8ebd27,0xbd203c0d3d343c8b,0x3c0dbd27bcc93d00,0xbc0d3d273cc9bd00,0xbd0c3cc93d20bc8b,0x3ce63d17bcabbd27
.quad 0xbd353d35bd353d35,0xbd353d35bd353d35,0x3d203d173d0c3d00,0x3cab3cc93ce63d00,0xbd17bd27bd32bd35,0x3d173d273d323d35,0xbb8e3c0d3cab3d00,0x3d343d323d203d00,0x3d273d003c8ba3fa,0x3d273d003c8ba42f,0xbd0cbd32bd2dbd00,0x3ce63c0dbc52bd00,0xbc0d3c8b3d173d35,0x3c0dbc8bbd17bd35,0x3d2d3cc9bb8ebd00,0xbc52bd17bd34bd00
.quad 0xbd00bd35bd00247a,0xbd00bd35bd0024af,0xbc523cc93d343d00,0xbd2dbd17bb8e3d00,0x3d323c8bbcc9bd35,0xbd32bc8b3cc93d35,0xbce6bd32bc523d00,0xbd0c3c0d3d2d3d00,0xbc8b3d003d27a589,0xbc8b3d003d272448,0x3d343c0dbd20bd00,0x3b8e3d323cabbd00,0xbcc9bd273c0d3d35,0x3cc93d27bc0dbd35,0xbcab3d173ce6bd00,0x3d203cc9bd0cbd00
.quad 0xbd353d35bd353d35,0xbd353d35bd353d35,0x3d343d323d2d3d27,0x3b8e3c0d3c523c8b,0xbc0dbc8bbcc9bd00,0x3c0d3c8b3cc93d00,0xbd2dbd17bce6bc8b,0x3c523cc93d0c3d27,0x3c8b3d003d273d35,0x3c8b3d003d273d35,0x3d203cc93b8ebc8b,0x3cab3d173d343d27,0xbcc9bd27bd32bd00,0x3cc93d273d323d00,0xbd0cbc0d3cab3d27,0x3ce63d323d203c8b
.quad 0x3d003d353d00a57a,0x3d003d353d00a589,0x3ce6bc0dbd20bd27,0x3d0c3d323cabbc8b,0xbd17bd27bc0d3d00,0x3d173d273c0dbd00,0xbcab3cc93d343c8b,0x3d203d17bb8ebd27,0x3d273d00bc8bbd35,0x3d273d00bc8bbd35,0x3c52bd17bd0c3c8b,0x3d2d3cc9bce6bd27,0xbd32bc8b3d173d00,0x3d323c8bbd17bd00,0xbb8e3d323c52bd27,0x3d343c0dbd2dbc8b
.quad 0xa316bd3522483d35,0xa516bd35a4163d35,0x3c52bd32bb8e3d35,0x3d2d3c0dbd34a416,0x3cc9bd27bc0d3d35,0xbcc93d273c0dbd35,0x3d0cbd17bc523d35,0xbce6bcc93d2da516,0x3d27bd00bc8b3d35,0x3d27bd00bc8b3d35,0x3d34bcc9bcab3d35,0x3b8e3d17bd20a3c8,0x3d32bc8bbcc93d35,0xbd323c8b3cc9bd35,0x3d20bc0dbce63d35,0x3cabbd323d0ca522
.quad 0x3d00a316bd003d35,0x3d00a52fbd003d35,0x3cab3c0dbd0c3d35,0xbd203d32bce6a348,0x3c0d3c8bbd173d35,0xbc0dbc8b3d17bd35,0xbb8e3cc9bd203d35,0x3d34bd173caba52f,0xbc8b3d00bd273d35,0xbc8b3d00bd273d35,0xbce63d17bd2d3d35,0xbd0c3cc9bc529f01,0xbd173d27bd323d35,0x3d17bd273d32bd35,0xbd2d3d32bd343d35,0x3c52bc0d3b8ea53b
.quad 0xa3afbd35237a3d35,0xa522bd35a3c83d35,0x3ce6bd17bcab3d27,0x3d0c3cc9bd20bc8b,0x3d32bc8bbd173d00,0xbd323c8b3d17bd00,0x3d203c0dbd343c8b,0x3cabbd323b8e3d27,0x3c8b3d00bd27237a,0x3c8b3d00bd27a348,0xbc523d32bce6bc8b,0xbd2d3c0d3d0cbd27,0xbd173d27bc0dbd00,0x3d17bd273c0d3d00,0xbd343cc93c52bd27,0xbb8e3d17bd2d3c8b
.quad 0xbd0023e13d00bd35,0xbd0025bb3d00bd35,0xbb8ebcc93d2dbd27,0x3d34bd173c523c8b,0x3cc9bd273d32bd00,0xbcc93d27bd323d00,0x3d2dbd323d0cbc8b,0xbc52bc0d3ce6bd27,0x3d27bd003c8ba3af,0x3d27bd003c8ba548,0x3cabbc0dbb8e3c8b,0xbd203d32bd343d27,0xbc0d3c8bbcc93d00,0x3c0dbc8b3cc9bd00,0xbd0c3d17bd203d27,0x3ce6bcc93cabbc8b
.quad 0xa4fabd3523e13d35,0xa52fbd35a3483d35,0x3d20bcc9bd0c3d00,0x3cab3d17bce6bd00,0x3d173c8bbd3223e1,0xbd17bc8b3d32a52f,0xbb8e3d32bcabbd00,0x3d34bc0dbd203d00,0xbd273d003c8bbd35,0xbd273d003c8bbd35,0xbd0cbc0d3d2dbd00,0x3ce6bd323c523d00,0x3c0dbd273d17a4fa,0xbc0d3d27bd172347,0x3d2dbd173b8e3d00,0xbc52bcc93d34bd00
.quad 0x3d00a509bd003d35,0x3d002516bd003d35,0xbc523d17bd343d00,0xbd2d3cc93b8ebd00,0xbd323d27bcc9a448,0x3d32bd273cc9a554,0xbce63c0d3c52bd00,0xbd0c3d32bd2d3d00,0x3c8bbd003d27bd35,0x3c8bbd003d27bd35,0x3d34bd323d20bd00,0x3b8e3c0dbcab3d00,0x3cc9bc8b3c0da509,0xbcc93c8bbc0d2448,0xbcab3cc9bce63d00,0x3d20bd173d0cbd00
.quad 0xa509bd35a4483d35,0xa53bbd359f013d35,0x3d34bc0dbd2d3c8b,0x3b8e3d32bc52bd27,0x3c0d3d27bcc9bd00,0xbc0dbd273cc93d00,0xbd2d3cc93ce6bd27,0x3c523d17bd0cbc8b,0xbc8bbd003d27a509,0xbc8bbd003d27a548,0x3d20bd17bb8e3d27,0x3cab3cc9bd343c8b,0x3cc93c8bbd323d00,0xbcc9bc8b3d32bd00,0xbd0c3d32bcabbc8b,0x3ce63c0dbd203d27
.quad 0xbd00a3c83d00bd35,0xbd0026413d00bd35,0x3ce6bd323d20bc8b,0x3d0cbc0dbcab3d27,0x3d17bc8bbc0d3d00,0xbd173c8b3c0dbd00,0xbcab3d17bd343d27,0x3d20bcc93b8e3c8b,0xbd273d00bc8ba3c8,0xbd273d00bc8b25d4,0x3c52bcc93d0cbd27,0x3d2dbd173ce6bc8b,0x3d32bd273d17bd00,0xbd323d27bd173d00,0xbb8e3c0dbc523c8b,0x3d34bd323d2dbd27
.quad 0xa548bd3523473d35,0xa57abd3525d43d35,0xbc523d323b8ebd35,0xbd2dbc0d3d34a57a,0x3cc9bd27bc0d3d35,0xbcc93d273c0dbd35,0xbd0c3d173c52bd35,0x3ce63cc9bd2d25e1,0x3d27bd00bc8b3d35,0x3d27bd00bc8b3d35,0xbd343cc93cabbd35,0xbb8ebd173d202496,0x3d32bc8bbcc93d35,0xbd323c8b3cc9bd35,0xbd203c0d3ce6bd35,0xbcab3d32bd0c24fa
.quad 0x3d0025edbd003d35,0x3d00a5a2bd003d35,0xbcabbc0d3d0cbd35,0x3d20bd323ce6a5a2,0x3c0d3c8bbd173d35,0xbc0dbc8b3d17bd35,0x3b8ebcc93d20bd35,0xbd343d17bcab2603,0xbc8b3d00bd273d35,0xbc8b3d00bd273d35,0x3ce6bd173d2dbd35,0x3d0cbcc93c52a635,0xbd173d27bd323d35,0x3d17bd273d32bd35,0x3d2dbd323d34bd35,0xbc523c0dbb8e2667
.quad 0xa554bd3523c73d35,0x24c8bd3524963d35,0xbce63d173cabbd27,0xbd0cbcc93d203c8b,0x3d32bc8bbd173d00,0xbd323c8b3d17bd00,0xbd20bc0d3d34bc8b,0xbcab3d32bb8ebd27,0x3c8b3d00bd272448,0x3c8b3d00bd27a57a,0x3c52bd323ce63c8b,0x3d2dbc0dbd0c3d27,0xbd173d27bc0dbd00,0x3d17bd273c0d3d00,0x3d34bcc9bc523d27,0x3b8ebd173d2dbc8b
.quad 0xbd0025e13d00bd35,0xbd0026033d00bd35,0x3b8e3cc9bd2d3d27,0xbd343d17bc52bc8b,0x3cc9bd273d32bd00,0xbcc93d27bd323d00,0xbd2d3d32bd0c3c8b,0x3c523c0dbce63d27,0x3d27bd003c8b2496,0x3d27bd003c8b2686,0xbcab3c0d3b8ebc8b,0x3d20bd323d34bd27,0xbc0d3c8bbcc93d00,0x3c0dbc8b3cc9bd00,0x3d0cbd173d20bd27,0xbce63cc9bcab3c8b
.quad 0xa561bd3525c83d35,0xa589bd3525e13d35,0xbd203cc93d0cbd00,0xbcabbd173ce63d00,0x3d173c8bbd322448,0xbd17bc8b3d322496,0x3b8ebd323cab3d00,0xbd343c0d3d20bd00,0xbd273d003c8bbd35,0xbd273d003c8bbd35,0x3d0c3c0dbd2d3d00,0xbce63d32bc52bd00,0x3c0dbd273d1724c8,0xbc0d3d27bd172516,0xbd2d3d17bb8ebd00,0x3c523cc9bd343d00
.quad 0x3d002496bd003d35,0x3d00a635bd003d35,0x3c52bd173d34bd00,0x3d2dbcc9bb8e3d00,0xbd323d27bcc925ed,0x3d32bd273cc9a5bb,0x3ce6bc0dbc523d00,0x3d0cbd323d2dbd00,0x3c8bbd003d27bd35,0x3c8bbd003d27bd35,0xbd343d32bd203d00,0xbb8ebc0d3cabbd00,0x3cc9bc8b3c0da5a2,0xbcc93c8bbc0da4fa,0x3cabbcc93ce6bd00,0xbd203d17bd0c3d00
.quad 0x24fabd3524483d35,0x2496bd3524c83d35,0xbd343c0d3d2dbc8b,0xbb8ebd323c523d27,0x3c0d3d27bcc9bd00,0xbc0dbd273cc93d00,0x3d2dbcc9bce63d27,0xbc52bd173d0c3c8b,0xbc8bbd003d27a61c,0xbc8bbd003d27a5a2,0xbd203d173b8ebd27,0xbcabbcc93d34bc8b,0x3cc93c8bbd323d00,0xbcc9bc8b3d32bd00,0x3d0cbd323cab3c8b,0xbce6bc0d3d20bd27
.quad 0xbd0024fa3d00bd35,0xbd0026673d00bd35,0xbce63d32bd203c8b,0xbd0c3c0d3cabbd27,0x3d17bc8bbc0d3d00,0xbd173c8b3c0dbd00,0x3cabbd173d34bd27,0xbd203cc9bb8ebc8b,0xbd273d00bc8b265a,0xbd273d00bc8b26a5,0xbc523cc9bd0c3d27,0xbd2d3d17bce63c8b,0x3d32bd273d17bd00,0xbd323d27bd173d00,0x3b8ebc0d3c52bc8b,0xbd343d32bd2d3d27
.quad 0x3d35a2c8bd358000,0x3d35a461bd352448,0x3d2d3c0dbd348000,0xbc523d323b8ebd35,0x3d173c8bbd328000,0xbd17bc8b3d32a461,0x3ce63cc9bd2d8000,0x3d0cbd17bc523d35,0x3c8b3d00bd278000,0x3c8b3d00bd27247a,0x3b8e3d17bd208000,0xbd343cc93cabbd35,0xbc0d3d27bd178000,0x3c0dbd273d17a57a,0xbcab3d32bd0c8000,0x3d20bc0dbce63d35
.quad 0xbd003d35bd008000,0xbd003d35bd002496,0xbd203d32bce68000,0xbcabbc0d3d0cbd35,0xbd323d27bcc98000,0x3d32bd273cc924c8,0xbd343d17bcab8000,0xbb8e3cc9bd203d35,0xbd273d00bc8b8000,0xbd273d00bc8b24af,0xbd0c3cc9bc528000,0x3ce6bd173d2dbd35,0xbcc93c8bbc0d8000,0x3cc9bc8b3c0da589,0xbc523c0dbb8e8000,0xbd2d3d32bd343d35
.quad 0x3d35a396bd352348,0x3d35a57abd35247a,0x3d0c3cc9bd20bc8b,0xbce63d173cabbd27,0x3c0d3d27bcc9bd00,0xbc0dbd273cc93d00,0xbcab3d32bb8ebd27,0x3d203c0dbd343c8b,0xbd273d003c8bbd35,0xbd273d003c8bbd35,0xbd2d3c0d3d0cbd27,0x3c52bd323ce63c8b,0xbcc9bc8b3d32bd00,0x3cc93c8bbd323d00,0x3b8ebd173d2dbc8b,0xbd343cc93c52bd27
.quad 0x3d00bd353d00a396,0x3d00bd353d00a589,0x3d34bd173c523c8b,0x3b8e3cc9bd2d3d27,0x3d17bc8bbc0d3d00,0xbd173c8b3c0dbd00,0x3c523c0dbce63d27,0x3d2dbd323d0cbc8b,0xbc8b3d00bd273d35,0xbc8b3d00bd273d35,0xbd203d32bd343d27,0xbcab3c0d3b8ebc8b,0xbd323d27bd173d00,0x3d32bd273d17bd00,0xbce63cc9bcab3c8b,0xbd0c3d17bd203d27
.quad 0x3d35a3fabd3523c8,0x3d3524c8bd352496,0x3cab3d17bce6bd00,0xbd203cc93d0cbd00,0xbcc93d273c0dbd35,0x3cc9bd27bc0d3d35,0xbd343c0d3d20bd00,0xbb8e3d32bcabbd00,0xbc8bbd003d27a3fa,0xbc8bbd003d27a589,0x3ce6bd323c523d00,0x3d0c3c0dbd2d3d00,0x3d32bc8bbcc93d35,0xbd323c8b3cc9bd35,0x3c523cc9bd343d00,0x3d2dbd173b8e3d00
.quad 0xbd003d35bd002416,0xbd003d35bd0024e1,0xbd2d3cc93b8ebd00,0x3c52bd173d34bd00,0xbc0dbc8b3d17bd35,0x3c0d3c8bbd173d35,0x3d0cbd323d2dbd00,0xbce63c0d3c52bd00,0x3d27bd003c8ba42f,0x3d27bd003c8b2448,0x3b8e3c0dbcab3d00,0xbd343d32bd203d00,0xbd173d27bd323d35,0x3d17bd273d32bd35,0xbd203d17bd0c3d00,0xbcab3cc9bce63d00
.quad 0x3d35a42fbd352416,0x3d35a589bd3524af,0x3b8e3d32bc52bd27,0xbd343c0d3d2dbc8b,0xbd323c8b3d17bd00,0x3d32bc8bbd173d00,0xbc52bd173d0c3c8b,0xbd2d3cc93ce6bd27,0x3d27bd00bc8b3d35,0x3d27bd00bc8b3d35,0x3cab3cc9bd343c8b,0xbd203d173b8ebd27,0xbd173d27bc0dbd00,0x3d17bd273c0d3d00,0xbce6bc0d3d20bd27,0xbd0c3d32bcabbc8b
.quad 0x3d00bd353d00a461,0x3d00bd353d002448,0x3d0cbc0dbcab3d27,0xbce63d32bd203c8b,0xbcc93d27bd323d00,0x3cc9bd273d32bd00,0xbd203cc9bb8ebc8b,0xbcab3d17bd343d27,0x3c8bbd003d27bd35,0x3c8bbd003d27bd35,0x3d2dbd173ce6bc8b,0xbc523cc9bd0c3d27,0xbc0d3c8bbcc93d00,0x3c0dbc8b3cc9bd00,0xbd343d32bd2d3d27,0xbb8e3c0dbc523c8b
.quad 0x3d352496bd3524c8,0x3d3523c8bd352516,0xbd2dbc0d3d342496,0x3c52bd32bb8e3d35,0x3d173c8bbd3224e1,0xbd17bc8b3d32a5af,0xbce6bcc93d2da596,0xbd0c3d173c52bd35,0x3c8b3d00bd2724fa,0x3c8b3d00bd272609,0xbb8ebd173d202448,0x3d34bcc9bcab3d35,0xbc0d3d27bd1725fa,0x3c0dbd273d17a3c7,0x3cabbd323d0ca5a2,0xbd203c0d3ce6bd35
.quad 0xbd003d35bd002516,0xbd003d35bd002561,0x3d20bd323ce623c8,0x3cab3c0dbd0c3d35,0xbd323d27bcc9a548,0x3d32bd273cc9a5d4,0x3d34bd173caba5af,0x3b8ebcc93d20bd35,0xbd273d00bc8b252f,0xbd273d00bc8ba4c8,0x3d0cbcc93c521f81,0xbce63d17bd2d3d35,0xbcc93c8bbc0d2609,0x3cc9bc8b3c0da4c8,0x3c52bc0d3b8ea5bb,0x3d2dbd323d34bd35
.quad 0x3d35a596bd3524e1,0x3d35a5afbd35a548,0xbd0cbcc93d203c8b,0x3ce6bd17bcab3d27,0x3c0d3d27bcc9bd00,0xbc0dbd273cc93d00,0x3cabbd323b8e3d27,0xbd20bc0d3d34bc8b,0xbd273d003c8bbd35,0xbd273d003c8bbd35,0x3d2dbc0dbd0c3d27,0xbc523d32bce6bc8b,0xbcc9bc8b3d32bd00,0x3cc93c8bbd323d00,0xbb8e3d17bd2d3c8b,0x3d34bcc9bc523d27
.quad 0x3d00bd353d00a5af,0x3d00bd353d002596,0xbd343d17bc52bc8b,0xbb8ebcc93d2dbd27,0x3d17bc8bbc0d3d00,0xbd173c8b3c0dbd00,0xbc52bc0d3ce6bd27,0xbd2d3d32bd0c3c8b,0xbc8b3d00bd273d35,0xbc8b3d00bd273d35,0x3d20bd323d34bd27,0x3cabbc0dbb8e3c8b,0xbd323d27bd173d00,0x3d32bd273d17bd00,0x3ce6bcc93cabbc8b,0x3d0cbd173d20bd27
.quad 0x3d352448bd3524fa,0x3d351f81bd35252f,0xbcabbd173ce63d00,0x3d20bcc9bd0c3d00,0xbcc93d273c0dbd35,0x3cc9bd27bc0d3d35,0x3d34bc0dbd203d00,0x3b8ebd323cab3d00,0xbc8bbd003d2723c8,0xbc8bbd003d27a5c8,0xbce63d32bc52bd00,0xbd0cbc0d3d2dbd00,0x3d32bc8bbcc93d35,0xbd323c8b3cc9bd35,0xbc52bcc93d34bd00,0xbd2d3d17bb8ebd00
.quad 0xbd003d35bd002609,0xbd003d35bd00a4c8,0x3d2dbcc9bb8e3d00,0xbc523d17bd343d00,0xbc0dbc8b3d17bd35,0x3c0d3c8bbd173d35,0xbd0c3d32bd2d3d00,0x3ce6bc0dbc523d00,0x3d27bd003c8ba5c8,0x3d27bd003c8ba654,0xbb8ebc0d3cabbd00,0x3d34bd323d20bd00,0xbd173d27bd323d35,0x3d17bd273d32bd35,0x3d20bd173d0cbd00,0x3cabbcc93ce6bd00
.quad 0x3d35a5a2bd3525fa,0x3d35a5bbbd352609,0xbb8ebd323c523d27,0x3d34bc0dbd2d3c8b,0xbd323c8b3d17bd00,0x3d32bc8bbd173d00,0x3c523d17bd0cbc8b,0x3d2dbcc9bce63d27,0x3d27bd00bc8b3d35,0x3d27bd00bc8b3d35,0xbcabbcc93d34bc8b,0x3d20bd17bb8e3d27,0xbd173d27bc0dbd00,0x3d17bd273c0d3d00,0x3ce63c0dbd203d27,0x3d0cbd323cab3c8b
.quad 0x3d00bd353d00a63b,0x3d00bd353d00a6c1,0xbd0c3c0d3cabbd27,0x3ce6bd323d20bc8b,0xbcc93d27bd323d00,0x3cc9bd273d32bd00,0x3d20bcc93b8e3c8b,0x3cabbd173d34bd27,0x3c8bbd003d27bd35,0x3c8bbd003d27bd35,0xbd2d3d17bce63c8b,0x3c52bcc93d0cbd27,0xbc0d3c8bbcc93d00,0x3c0dbc8b3cc9bd00,0x3d34bd323d2dbd27,0x3b8ebc0d3c52bc8b
.quad 0x3d353d353d353d35,0x3d353d353d353d35,0xbd353d35bd353d35,0xbd353d35bd353d35,0x3d2d3d323d343d35,0xbc52bc0dbb8e2248,0xbc52bc0dbb8e8000,0xbd2dbd32bd34bd35,0x3d173d273d323d35,0xbd17bd27bd32bd35,0xbcc9bc8bbc0d8000,0x3cc93c8b3c0da2c8,0x3ce63d173d2d3d35,0x3d0c3cc93c52a316,0xbd0cbcc9bc528000,0x3ce63d173d2d3d35
.quad 0x3c8b3d003d273d35,0x3c8b3d003d273d35,0xbd27bd00bc8b8000,0xbd27bd00bc8b2348,0x3b8e3cc93d203d35,0xbd34bd17bcab237a,0xbd34bd17bcab8000,0xbb8ebcc9bd20bd35,0xbc0d3c8b3d173d35,0x3c0dbc8bbd17bd35,0xbd32bd27bcc98000,0x3d323d273cc9a396,0xbcab3c0d3d0c3d35,0x3d203d323ce6a3af,0xbd20bd32bce68000,0xbcab3c0d3d0c3d35
.quad 0x3d353d353d353d35,0x3d353d353d353d35,0xbd353d35bd353d35,0xbd353d35bd353d35,0x3d0c3d173d203d27,0xbce6bcc9bcabbc8b,0xbce6bcc9bcabbc8b,0xbd0cbd17bd20bd27,0x3c0d3c8b3cc93d00,0xbc0dbc8bbcc9bd00,0xbd32bd27bd17bd00,0x3d323d273d173d00,0xbcabbc0d3b8e3c8b,0x3d203d323d343d27,0xbd20bd32bd34bd27,0xbcabbc0d3b8e3c8b
.quad 0xbd27bd00bc8b2248,0xbd27bd00bc8b237a,0xbc8bbd00bd27bd35,0xbc8bbd00bd27bd35,0xbd2dbd32bd0cbc8b,0x3c52bc0dbce6bd27,0x3c52bc0dbce6bd27,0x3d2d3d323d0c3c8b,0xbcc9bd27bd32bd00,0x3cc93d273d323d00,0x3d173c8bbc0dbd00,0xbd17bc8b3c0d3d00,0x3b8ebcc9bd2dbd27,0xbd34bd17bc523c8b,0x3d343d173c52bc8b,0x3b8ebcc9bd2dbd27
.quad 0x3d353d353d353d35,0x3d353d353d353d35,0xbd353d35bd353d35,0xbd353d35bd353d35,0x3cab3cc93ce63d00,0xbd20bd17bd0cbd00,0xbd20bd17bd0cbd00,0xbcabbcc9bce6bd00,0xbcc9bc8bbc0d2248,0x3cc93c8b3c0da316,0xbd17bd27bd32bd35,0x3d173d273d323d35,0xbd34bd32bd20bd00,0xbb8e3c0d3cab3d00,0x3b8ebc0dbcabbd00,0xbd34bd32bd20bd00
.quad 0xbc8bbd00bd27bd35,0xbc8bbd00bd27bd35,0x3d273d003c8ba2c8,0x3d273d003c8ba396,0x3ce63c0dbc52bd00,0x3d0c3d323d2d3d00,0x3d0c3d323d2d3d00,0xbce6bc0d3c523d00,0x3d323d273cc9a316,0xbd32bd27bcc923e1,0xbc0d3c8b3d173d35,0x3c0dbc8bbd17bd35,0x3c523d173d343d00,0x3d2d3cc9bb8ebd00,0xbd2dbcc93b8e3d00,0x3c523d173d343d00
.quad 0x3d353d353d353d35,0x3d353d353d353d35,0xbd353d35bd353d35,0xbd353d35bd353d35,0x3b8e3c0d3c523c8b,0xbd34bd32bd2dbd27,0xbd34bd32bd2dbd27,0xbb8ebc0dbc52bc8b,0xbd32bd27bd17bd00,0x3d323d273d173d00,0xbc0dbc8bbcc9bd00,0x3c0d3c8b3cc93d00,0xbc52bcc9bd0cbd27,0xbd2dbd17bce6bc8b,0x3d2d3d173ce63c8b,0xbc52bcc9bd0cbd27
.quad 0x3d273d003c8ba316,0x3d273d003c8ba3af,0x3c8b3d003d273d35,0x3c8b3d003d273d35,0x3cab3d173d343d27,0xbd20bcc9bb8e3c8b,0xbd20bcc9bb8e3c8b,0xbcabbd17bd34bd27,0xbd17bc8b3c0d3d00,0x3d173c8bbc0dbd00,0xbcc9bd27bd32bd00,0x3cc93d273d323d00,0xbce6bd32bd20bc8b,0xbd0cbc0d3cab3d27,0x3d0c3c0dbcabbd27,0xbce6bd32bd20bc8b
.quad 0x3d353d353d353d35,0x3d353d353d353d35,0xbd353d35bd353d35,0xbd353d35bd353d35,0xbd2dbd32bd34bd35,0x3c523c0d3b8ea316,0x3c523c0d3b8ea2c8,0x3d2d3d323d343d35,0x3d173d273d323d35,0xbd17bd27bd32bd35,0xbcc9bc8bbc0d2348,0x3cc93c8b3c0da396,0xbce6bd17bd2dbd35,0xbd0cbcc9bc5223e1,0x3d0c3cc93c52a396,0xbce6bd17bd2dbd35
.quad 0x3c8b3d003d273d35,0x3c8b3d003d273d35,0xbd27bd00bc8b23c8,0xbd27bd00bc8b2416,0xbb8ebcc9bd20bd35,0x3d343d173caba509,0x3d343d173caba3fa,0x3b8e3cc93d203d35,0xbc0d3c8b3d173d35,0x3c0dbc8bbd17bd35,0xbd32bd27bcc92416,0x3d323d273cc9a461,0x3cabbc0dbd0cbd35,0xbd20bd32bce6a3c8,0x3d203d323ce6a42f,0x3cabbc0dbd0cbd35
.quad 0x3d353d353d353d35,0x3d353d353d353d35,0xbd353d35bd353d35,0xbd353d35bd353d35,0xbd0cbd17bd20bd27,0x3ce63cc93cab3c8b,0x3ce63cc93cab3c8b,0x3d0c3d173d203d27,0x3c0d3c8b3cc93d00,0xbc0dbc8bbcc9bd00,0xbd32bd27bd17bd00,0x3d323d273d173d00,0x3cab3c0dbb8ebc8b,0xbd20bd32bd34bd27,0x3d203d323d343d27,0x3cab3c0dbb8ebc8b
.quad 0xbd27bd00bc8b23e1,0xbd27bd00bc8ba448,0xbc8bbd00bd27bd35,0xbc8bbd00bd27bd35,0x3d2d3d323d0c3c8b,0xbc523c0d3ce63d27,0xbc523c0d3ce63d27,0xbd2dbd32bd0cbc8b,0xbcc9bd27bd32bd00,0x3cc93d273d323d00,0x3d173c8bbc0dbd00,0xbd17bc8b3c0d3d00,0xbb8e3cc93d2d3d27,0x3d343d173c52bc8b,0xbd34bd17bc523c8b,0xbb8e3cc93d2d3d27
.quad 0x3d353d353d353d35,0x3d353d353d353d35,0xbd353d35bd353d35,0xbd353d35bd353d35,0xbcabbcc9bce6bd00,0x3d203d173d0c3d00,0x3d203d173d0c3d00,0x3cab3cc93ce63d00,0xbcc9bc8bbc0d237a,0x3cc93c8b3c0da3af,0xbd17bd27bd32bd35,0x3d173d273d323d35,0x3d343d323d203d00,0x3b8ebc0dbcabbd00,0xbb8e3c0d3cab3d00,0x3d343d323d203d00
.quad 0xbc8bbd00bd27bd35,0xbc8bbd00bd27bd35,0x3d273d003c8ba3fa,0x3d273d003c8ba42f,0xbce6bc0d3c523d00,0xbd0cbd32bd2dbd00,0xbd0cbd32bd2dbd00,0x3ce63c0dbc52bd00,0x3d323d273cc9a509,0xbd32bd27bcc9a3c8,0xbc0d3c8b3d173d35,0x3c0dbc8bbd17bd35,0xbc52bd17bd34bd00,0xbd2dbcc93b8e3d00,0x3d2d3cc9bb8ebd00,0xbc52bd17bd34bd00
.quad 0x3d353d353d353d35,0x3d353d353d353d35,0xbd353d35bd353d35,0xbd353d35bd353d35,0xbb8ebc0dbc52bc8b,0x3d343d323d2d3d27,0x3d343d323d2d3d27,0x3b8e3c0d3c523c8b,0xbd32bd27bd17bd00,0x3d323d273d173d00,0xbc0dbc8bbcc9bd00,0x3c0d3c8b3cc93d00,0x3c523cc93d0c3d27,0x3d2d3d173ce63c8b,0xbd2dbd17bce6bc8b,0x3c523cc93d0c3d27
.quad 0x3d273d003c8ba4fa,0x3d273d003c8ba509,0x3c8b3d003d273d35,0x3c8b3d003d273d35,0xbcabbd17bd34bd27,0x3d203cc93b8ebc8b,0x3d203cc93b8ebc8b,0x3cab3d173d343d27,0xbd17bc8b3c0d3d00,0x3d173c8bbc0dbd00,0xbcc9bd27bd32bd00,0x3cc93d273d323d00,0x3ce63d323d203c8b,0x3d0c3c0dbcabbd27,0xbd0cbc0d3cab3d27,0x3ce63d323d203c8b
.quad 0xbd0022483d003d35,0xbd0023e13d003d35,0xbd00bd35bd008000,0xbd00bd35bd0023c8,0xbd20bc0d3ce63d35,0xbcabbd32bd0c23e1,0xbcabbd32bd0c8000,0x3d203c0dbce6bd35,0xbd32bc8b3cc93d35,0x3d323c8bbcc9bd35,0xbc0dbd27bd178000,0x3c0d3d273d17a3fa,0xbd34bcc93cab3d35,0xbb8e3d173d20a4fa,0x3b8ebd17bd208000,0xbd34bcc93cab3d35
.quad 0xbd27bd003c8b3d35,0xbd27bd003c8b3d35,0x3c8bbd00bd278000,0x3c8bbd00bd272416,0xbd0cbd173c523d35,0x3ce6bcc9bd2da448,0x3ce6bcc9bd2d8000,0x3d0c3d17bc52bd35,0xbcc9bd273c0d3d35,0x3cc93d27bc0dbd35,0x3d17bc8bbd328000,0xbd173c8b3d32a42f,0xbc52bd323b8e3d35,0xbd2d3c0d3d34a509,0x3d2dbc0dbd348000,0xbc52bd323b8e3d35
.quad 0x3d00a316bd00bd35,0x3d00a4fabd00bd35,0x3d003d353d00a2c8,0x3d003d353d00a3fa,0x3d343cc9bc52bd27,0x3b8e3d173d2d3c8b,0x3b8e3d173d2d3c8b,0xbd34bcc93c523d27,0x3d173d273c0dbd00,0xbd17bd27bc0d3d00,0xbcc93c8b3d323d00,0x3cc9bc8bbd32bd00,0x3c523d323ce6bc8b,0x3d2d3c0dbd0cbd27,0xbd2dbc0d3d0c3d27,0x3c523d323ce6bc8b
.quad 0xbc8b3d003d27a316,0xbc8b3d003d27a509,0xbd27bd003c8b3d35,0xbd27bd003c8b3d35,0xbd203c0d3d343c8b,0xbcabbd32bb8e3d27,0xbcabbd32bb8e3d27,0x3d20bc0dbd34bc8b,0xbd32bc8b3d173d00,0x3d323c8bbd17bd00,0x3c0dbd27bcc93d00,0xbc0d3d273cc9bd00,0xbce6bd173cab3d27,0xbd0c3cc93d20bc8b,0x3d0cbcc9bd203c8b,0xbce6bd173cab3d27
.quad 0xbd00237a3d003d35,0xbd00a4483d003d35,0xbd00bd35bd002348,0xbd00bd35bd002416,0xbd2dbd17bb8e3d00,0x3c52bcc9bd34bd00,0x3c52bcc9bd34bd00,0x3d2d3d173b8ebd00,0xbc0dbd27bd17237a,0x3c0d3d273d17a509,0x3d323c8bbcc9bd35,0xbd32bc8b3cc93d35,0x3d0cbc0dbd2dbd00,0xbce6bd32bc523d00,0x3ce63d323c52bd00,0x3d0cbc0dbd2dbd00
.quad 0x3d273d00bc8bbd35,0x3d273d00bc8bbd35,0xbc8b3d003d27a396,0xbc8b3d003d27a461,0x3b8e3d323cabbd00,0xbd34bc0d3d203d00,0xbd34bc0d3d203d00,0xbb8ebd32bcab3d00,0xbd173c8b3d32a3af,0x3d17bc8bbd32a3c8,0xbcc9bd273c0d3d35,0x3cc93d27bc0dbd35,0xbd20bcc93d0c3d00,0xbcab3d173ce6bd00,0x3cabbd17bce63d00,0xbd20bcc93d0c3d00
.quad 0x3d00a3afbd00bd35,0x3d00a509bd00bd35,0x3d003d353d00a396,0x3d003d353d00a42f,0x3d0c3d323cabbc8b,0xbce63c0d3d203d27,0xbce63c0d3d203d27,0xbd0cbd32bcab3c8b,0xbcc93c8b3d323d00,0x3cc9bc8bbd32bd00,0xbd17bd27bc0d3d00,0x3d173d273c0dbd00,0xbd20bd173b8e3d27,0xbcab3cc93d343c8b,0x3cabbcc9bd34bc8b,0xbd20bd173b8e3d27
.quad 0x3c8bbd00bd2723e1,0x3c8bbd00bd27a3c8,0x3d273d00bc8bbd35,0x3d273d00bc8bbd35,0x3d2d3cc9bce6bd27,0xbc523d173d0cbc8b,0xbc523d173d0cbc8b,0xbd2dbcc93ce63d27,0xbc0d3d273cc9bd00,0x3c0dbd27bcc93d00,0xbd32bc8b3d173d00,0x3d323c8bbd17bd00,0xbd34bc0d3d2d3c8b,0xbb8e3d323c52bd27,0x3b8ebd32bc523d27,0xbd34bc0d3d2d3c8b
.quad 0xbd00a4163d003d35,0xbd00a3483d003d35,0xbd00bd35bd002448,0xbd00bd35bd002496,0x3d203c0dbce6bd35,0x3cab3d323d0ca52f,0x3cab3d323d0ca461,0xbd20bc0d3ce63d35,0xbd32bc8b3cc93d35,0x3d323c8bbcc9bd35,0xbc0dbd27bd17247a,0x3c0d3d273d17a589,0x3d343cc9bcabbd35,0x3b8ebd17bd202347,0xbb8e3d173d20a57a,0x3d343cc9bcabbd35
.quad 0xbd27bd003c8b3d35,0xbd27bd003c8b3d35,0x3c8bbd00bd272496,0x3c8bbd00bd2724e1,0x3d0c3d17bc52bd35,0xbce63cc93d2da554,0xbce63cc93d2d24c8,0xbd0cbd173c523d35,0xbcc9bd273c0d3d35,0x3cc93d27bc0dbd35,0x3d17bc8bbd3224af,0xbd173c8b3d322448,0x3c523d32bb8ebd35,0x3d2dbc0dbd342448,0xbd2d3c0d3d34a589,0x3c523d32bb8ebd35
.quad 0x3d00a516bd00bd35,0x3d00a52fbd00bd35,0x3d003d353d00a461,0x3d003d353d0024c8,0xbd34bcc93c523d27,0xbb8ebd17bd2dbc8b,0xbb8ebd17bd2dbc8b,0x3d343cc9bc52bd27,0x3d173d273c0dbd00,0xbd17bd27bc0d3d00,0xbcc93c8b3d323d00,0x3cc9bc8bbd32bd00,0xbc52bd32bce63c8b,0xbd2dbc0d3d0c3d27,0x3d2d3c0dbd0cbd27,0xbc52bd32bce63c8b
.quad 0xbc8b3d003d27a52f,0xbc8b3d003d272516,0xbd27bd003c8b3d35,0xbd27bd003c8b3d35,0x3d20bc0dbd34bc8b,0x3cab3d323b8ebd27,0x3cab3d323b8ebd27,0xbd203c0d3d343c8b,0xbd32bc8b3d173d00,0x3d323c8bbd17bd00,0x3c0dbd27bcc93d00,0xbc0d3d273cc9bd00,0x3ce63d17bcabbd27,0x3d0cbcc9bd203c8b,0xbd0c3cc93d20bc8b,0x3ce63d17bcabbd27
.quad 0xbd00a3c83d003d35,0xbd009f013d003d35,0xbd00bd35bd00247a,0xbd00bd35bd0024af,0x3d2d3d173b8ebd00,0xbc523cc93d343d00,0xbc523cc93d343d00,0xbd2dbd17bb8e3d00,0xbc0dbd27bd17a348,0x3c0d3d273d17a548,0x3d323c8bbcc9bd35,0xbd32bc8b3cc93d35,0xbd0c3c0d3d2d3d00,0x3ce63d323c52bd00,0xbce6bd32bc523d00,0xbd0c3c0d3d2d3d00
.quad 0x3d273d00bc8bbd35,0x3d273d00bc8bbd35,0xbc8b3d003d27a589,0xbc8b3d003d272448,0xbb8ebd32bcab3d00,0x3d343c0dbd20bd00,0x3d343c0dbd20bd00,0x3b8e3d323cabbd00,0xbd173c8b3d32a548,0x3d17bc8bbd3225d4,0xbcc9bd273c0d3d35,0x3cc93d27bc0dbd35,0x3d203cc9bd0cbd00,0x3cabbd17bce63d00,0xbcab3d173ce6bd00,0x3d203cc9bd0cbd00
.quad 0x3d00a522bd00bd35,0x3d00a53bbd00bd35,0x3d003d353d00a57a,0x3d003d353d00a589,0xbd0cbd32bcab3c8b,0x3ce6bc0dbd20bd27,0x3ce6bc0dbd20bd27,0x3d0c3d323cabbc8b,0xbcc93c8b3d323d00,0x3cc9bc8bbd32bd00,0xbd17bd27bc0d3d00,0x3d173d273c0dbd00,0x3d203d17bb8ebd27,0x3cabbcc9bd34bc8b,0xbcab3cc93d343c8b,0x3d203d17bb8ebd27
.quad 0x3c8bbd00bd2725bb,0x3c8bbd00bd272641,0x3d273d00bc8bbd35,0x3d273d00bc8bbd35,0xbd2dbcc93ce63d27,0x3c52bd17bd0c3c8b,0x3c52bd17bd0c3c8b,0x3d2d3cc9bce6bd27,0xbc0d3d273cc9bd00,0x3c0dbd27bcc93d00,0xbd32bc8b3d173d00,0x3d323c8bbd17bd00,0x3d343c0dbd2dbc8b,0x3b8ebd32bc523d27,0xbb8e3d323c52bd27,0x3d343c0dbd2dbc8b
.quad 0xa316bd3522483d35,0xa516bd35a4163d35,0x3d35a2c8bd358000,0x3d35a461bd352448,0x3c52bd32bb8e3d35,0x3d2d3c0dbd34a416,0x3d2d3c0dbd348000,0xbc523d323b8ebd35,0x3cc9bd27bc0d3d35,0xbcc93d273c0dbd35,0x3d173c8bbd328000,0xbd17bc8b3d32a461,0x3d0cbd17bc523d35,0xbce6bcc93d2da516,0x3ce63cc9bd2d8000,0x3d0cbd17bc523d35
.quad 0x3d27bd00bc8b3d35,0x3d27bd00bc8b3d35,0x3c8b3d00bd278000,0x3c8b3d00bd27247a,0x3d34bcc9bcab3d35,0x3b8e3d17bd20a3c8,0x3b8e3d17bd208000,0xbd343cc93cabbd35,0x3d32bc8bbcc93d35,0xbd323c8b3cc9bd35,0xbc0d3d27bd178000,0x3c0dbd273d17a57a,0x3d20bc0dbce63d35,0x3cabbd323d0ca522,0xbcab3d32bd0c8000,0x3d20bc0dbce63d35
.quad 0xa3afbd35237a3d35,0xa522bd35a3c83d35,0x3d35a396bd352348,0x3d35a57abd35247a,0x3ce6bd17bcab3d27,0x3d0c3cc9bd20bc8b,0x3d0c3cc9bd20bc8b,0xbce63d173cabbd27,0x3d32bc8bbd173d00,0xbd323c8b3d17bd00,0x3c0d3d27bcc9bd00,0xbc0dbd273cc93d00,0x3d203c0dbd343c8b,0x3cabbd323b8e3d27,0xbcab3d32bb8ebd27,0x3d203c0dbd343c8b
.quad 0x3c8b3d00bd27237a,0x3c8b3d00bd27a348,0xbd273d003c8bbd35,0xbd273d003c8bbd35,0xbc523d32bce6bc8b,0xbd2d3c0d3d0cbd27,0xbd2d3c0d3d0cbd27,0x3c52bd323ce63c8b,0xbd173d27bc0dbd00,0x3d17bd273c0d3d00,0xbcc9bc8b3d32bd00,0x3cc93c8bbd323d00,0xbd343cc93c52bd27,0xbb8e3d17bd2d3c8b,0x3b8ebd173d2dbc8b,0xbd343cc93c52bd27
.quad 0xa4fabd3523e13d35,0xa52fbd35a3483d35,0x3d35a3fabd3523c8,0x3d3524c8bd352496,0x3d20bcc9bd0c3d00,0x3cab3d17bce6bd00,0x3cab3d17bce6bd00,0xbd203cc93d0cbd00,0x3d173c8bbd3223e1,0xbd17bc8b3d32a52f,0xbcc93d273c0dbd35,0x3cc9bd27bc0d3d35,0xbb8e3d32bcabbd00,0x3d34bc0dbd203d00,0xbd343c0d3d20bd00,0xbb8e3d32bcabbd00
.quad 0xbd273d003c8bbd35,0xbd273d003c8bbd35,0xbc8bbd003d27a3fa,0xbc8bbd003d27a589,0xbd0cbc0d3d2dbd00,0x3ce6bd323c523d00,0x3ce6bd323c523d00,0x3d0c3c0dbd2d3d00,0x3c0dbd273d17a4fa,0xbc0d3d27bd172347,0x3d32bc8bbcc93d35,0xbd323c8b3cc9bd35,0x3d2dbd173b8e3d00,0xbc52bcc93d34bd00,0x3c523cc9bd343d00,0x3d2dbd173b8e3d00
.quad 0xa509bd35a4483d35,0xa53bbd359f013d35,0x3d35a42fbd352416,0x3d35a589bd3524af,0x3d34bc0dbd2d3c8b,0x3b8e3d32bc52bd27,0x3b8e3d32bc52bd27,0xbd343c0d3d2dbc8b,0x3c0d3d27bcc9bd00,0xbc0dbd273cc93d00,0xbd323c8b3d17bd00,0x3d32bc8bbd173d00,0xbd2d3cc93ce6bd27,0x3c523d17bd0cbc8b,0xbc52bd173d0c3c8b,0xbd2d3cc93ce6bd27
.quad 0xbc8bbd003d27a509,0xbc8bbd003d27a548,0x3d27bd00bc8b3d35,0x3d27bd00bc8b3d35,0x3d20bd17bb8e3d27,0x3cab3cc9bd343c8b,0x3cab3cc9bd343c8b,0xbd203d173b8ebd27,0x3cc93c8bbd323d00,0xbcc9bc8b3d32bd00,0xbd173d27bc0dbd00,0x3d17bd273c0d3d00,0xbd0c3d32bcabbc8b,0x3ce63c0dbd203d27,0xbce6bc0d3d20bd27,0xbd0c3d32bcabbc8b
.quad 0xa548bd3523473d35,0xa57abd3525d43d35,0x3d352496bd3524c8,0x3d3523c8bd352516,0xbc523d323b8ebd35,0xbd2dbc0d3d34a57a,0xbd2dbc0d3d342496,0x3c52bd32bb8e3d35,0x3cc9bd27bc0d3d35,0xbcc93d273c0dbd35,0x3d173c8bbd3224e1,0xbd17bc8b3d32a5af,0xbd0c3d173c52bd35,0x3ce63cc9bd2d25e1,0xbce6bcc93d2da596,0xbd0c3d173c52bd35
.quad 0x3d27bd00bc8b3d35,0x3d27bd00bc8b3d35,0x3c8b3d00bd2724fa,0x3c8b3d00bd272609,0xbd343cc93cabbd35,0xbb8ebd173d202496,0xbb8ebd173d202448,0x3d34bcc9bcab3d35,0x3d32bc8bbcc93d35,0xbd323c8b3cc9bd35,0xbc0d3d27bd1725fa,0x3c0dbd273d17a3c7,0xbd203c0d3ce6bd35,0xbcab3d32bd0c24fa,0x3cabbd323d0ca5a2,0xbd203c0d3ce6bd35
.quad 0xa554bd3523c73d35,0x24c8bd3524963d35,0x3d35a596bd3524e1,0x3d35a5afbd35a548,0xbce63d173cabbd27,0xbd0cbcc93d203c8b,0xbd0cbcc93d203c8b,0x3ce6bd17bcab3d27,0x3d32bc8bbd173d00,0xbd323c8b3d17bd00,0x3c0d3d27bcc9bd00,0xbc0dbd273cc93d00,0xbd20bc0d3d34bc8b,0xbcab3d32bb8ebd27,0x3cabbd323b8e3d27,0xbd20bc0d3d34bc8b
.quad 0x3c8b3d00bd272448,0x3c8b3d00bd27a57a,0xbd273d003c8bbd35,0xbd273d003c8bbd35,0x3c52bd323ce63c8b,0x3d2dbc0dbd0c3d27,0x3d2dbc0dbd0c3d27,0xbc523d32bce6bc8b,0xbd173d27bc0dbd00,0x3d17bd273c0d3d00,0xbcc9bc8b3d32bd00,0x3cc93c8bbd323d00,0x3d34bcc9bc523d27,0x3b8ebd173d2dbc8b,0xbb8e3d17bd2d3c8b,0x3d34bcc9bc523d27
.quad 0xa561bd3525c83d35,0xa589bd3525e13d35,0x3d352448bd3524fa,0x3d351f81bd35252f,0xbd203cc93d0cbd00,0xbcabbd173ce63d00,0xbcabbd173ce63d00,0x3d20bcc9bd0c3d00,0x3d173c8bbd322448,0xbd17bc8b3d322496,0xbcc93d273c0dbd35,0x3cc9bd27bc0d3d35,0x3b8ebd323cab3d00,0xbd343c0d3d20bd00,0x3d34bc0dbd203d00,0x3b8ebd323cab3d00
.quad 0xbd273d003c8bbd35,0xbd273d003c8bbd35,0xbc8bbd003d2723c8,0xbc8bbd003d27a5c8,0x3d0c3c0dbd2d3d00,0xbce63d32bc52bd00,0xbce63d32bc52bd00,0xbd0cbc0d3d2dbd00,0x3c0dbd273d1724c8,0xbc0d3d27bd172516,0x3d32bc8bbcc93d35,0xbd323c8b3cc9bd35,0xbd2d3d17bb8ebd00,0x3c523cc9bd343d00,0xbc52bcc93d34bd00,0xbd2d3d17bb8ebd00
.quad 0x24fabd3524483d35,0x2496bd3524c83d35,0x3d35a5a2bd3525fa,0x3d35a5bbbd352609,0xbd343c0d3d2dbc8b,0xbb8ebd323c523d27,0xbb8ebd323c523d27,0x3d34bc0dbd2d3c8b,0x3c0d3d27bcc9bd00,0xbc0dbd273cc93d00,0xbd323c8b3d17bd00,0x3d32bc8bbd173d00,0x3d2dbcc9bce63d27,0xbc52bd173d0c3c8b,0x3c523d17bd0cbc8b,0x3d2dbcc9bce63d27
.quad 0xbc8bbd003d27a61c,0xbc8bbd003d27a5a2,0x3d27bd00bc8b3d35,0x3d27bd00bc8b3d35,0xbd203d173b8ebd27,0xbcabbcc93d34bc8b,0xbcabbcc93d34bc8b,0x3d20bd17bb8e3d27,0x3cc93c8bbd323d00,0xbcc9bc8b3d32bd00,0xbd173d27bc0dbd00,0x3d17bd273c0d3d00,0x3d0cbd323cab3c8b,0xbce6bc0d3d20bd27,0x3ce63c0dbd203d27,0x3d0cbd323cab3c8b
.quad 0x3d00a316bd003d35,0x3d00a52fbd003d35,0xbd003d35bd008000,0xbd003d35bd002496,0x3cab3c0dbd0c3d35,0xbd203d32bce6a348,0xbd203d32bce68000,0xbcabbc0d3d0cbd35,0x3c0d3c8bbd173d35,0xbc0dbc8b3d17bd35,0xbd323d27bcc98000,0x3d32bd273cc924c8,0xbb8e3cc9bd203d35,0x3d34bd173caba52f,0xbd343d17bcab8000,0xbb8e3cc9bd203d35
.quad 0xbc8b3d00bd273d35,0xbc8b3d00bd273d35,0xbd273d00bc8b8000,0xbd273d00bc8b24af,0xbce63d17bd2d3d35,0xbd0c3cc9bc529f01,0xbd0c3cc9bc528000,0x3ce6bd173d2dbd35,0xbd173d27bd323d35,0x3d17bd273d32bd35,0xbcc93c8bbc0d8000,0x3cc9bc8b3c0da589,0xbd2d3d32bd343d35,0x3c52bc0d3b8ea53b,0xbc523c0dbb8e8000,0xbd2d3d32bd343d35
.quad 0xbd0023e13d00bd35,0xbd0025bb3d00bd35,0x3d00bd353d00a396,0x3d00bd353d00a589,0xbb8ebcc93d2dbd27,0x3d34bd173c523c8b,0x3d34bd173c523c8b,0x3b8e3cc9bd2d3d27,0x3cc9bd273d32bd00,0xbcc93d27bd323d00,0x3d17bc8bbc0d3d00,0xbd173c8b3c0dbd00,0x3d2dbd323d0cbc8b,0xbc52bc0d3ce6bd27,0x3c523c0dbce63d27,0x3d2dbd323d0cbc8b
.quad 0x3d27bd003c8ba3af,0x3d27bd003c8ba548,0xbc8b3d00bd273d35,0xbc8b3d00bd273d35,0x3cabbc0dbb8e3c8b,0xbd203d32bd343d27,0xbd203d32bd343d27,0xbcab3c0d3b8ebc8b,0xbc0d3c8bbcc93d00,0x3c0dbc8b3cc9bd00,0xbd323d27bd173d00,0x3d32bd273d17bd00,0xbd0c3d17bd203d27,0x3ce6bcc93cabbc8b,0xbce63cc9bcab3c8b,0xbd0c3d17bd203d27
.quad 0x3d00a509bd003d35,0x3d002516bd003d35,0xbd003d35bd002416,0xbd003d35bd0024e1,0xbc523d17bd343d00,0xbd2d3cc93b8ebd00,0xbd2d3cc93b8ebd00,0x3c52bd173d34bd00,0xbd323d27bcc9a448,0x3d32bd273cc9a554,0xbc0dbc8b3d17bd35,0x3c0d3c8bbd173d35,0xbce63c0d3c52bd00,0xbd0c3d32bd2d3d00,0x3d0cbd323d2dbd00,0xbce63c0d3c52bd00
.quad 0x3c8bbd003d27bd35,0x3c8bbd003d27bd35,0x3d27bd003c8ba42f,0x3d27bd003c8b2448,0x3d34bd323d20bd00,0x3b8e3c0dbcab3d00,0x3b8e3c0dbcab3d00,0xbd343d32bd203d00,0x3cc9bc8b3c0da509,0xbcc93c8bbc0d2448,0xbd173d27bd323d35,0x3d17bd273d32bd35,0xbcab3cc9bce63d00,0x3d20bd173d0cbd00,0xbd203d17bd0c3d00,0xbcab3cc9bce63d00
.quad 0xbd00a3c83d00bd35,0xbd0026413d00bd35,0x3d00bd353d00a461,0x3d00bd353d002448,0x3ce6bd323d20bc8b,0x3d0cbc0dbcab3d27,0x3d0cbc0dbcab3d27,0xbce63d32bd203c8b,0x3d17bc8bbc0d3d00,0xbd173c8b3c0dbd00,0xbcc93d27bd323d00,0x3cc9bd273d32bd00,0xbcab3d17bd343d27,0x3d20bcc93b8e3c8b,0xbd203cc9bb8ebc8b,0xbcab3d17bd343d27
.quad 0xbd273d00bc8ba3c8,0xbd273d00bc8b25d4,0x3c8bbd003d27bd35,0x3c8bbd003d27bd35,0x3c52bcc93d0cbd27,0x3d2dbd173ce6bc8b,0x3d2dbd173ce6bc8b,0xbc523cc9bd0c3d27,0x3d32bd273d17bd00,0xbd323d27bd173d00,0xbc0d3c8bbcc93d00,0x3c0dbc8b3cc9bd00,0xbb8e3c0dbc523c8b,0x3d34bd323d2dbd27,0xbd343d32bd2d3d27,0xbb8e3c0dbc523c8b
.quad 0x3d0025edbd003d35,0x3d00a5a2bd003d35,0xbd003d35bd002516,0xbd003d35bd002561,0xbcabbc0d3d0cbd35,0x3d20bd323ce6a5a2,0x3d20bd323ce623c8,0x3cab3c0dbd0c3d35,0x3c0d3c8bbd173d35,0xbc0dbc8b3d17bd35,0xbd323d27bcc9a548,0x3d32bd273cc9a5d4,0x3b8ebcc93d20bd35,0xbd343d17bcab2603,0x3d34bd173caba5af,0x3b8ebcc93d20bd35
.quad 0xbc8b3d00bd273d35,0xbc8b3d00bd273d35,0xbd273d00bc8b252f,0xbd273d00bc8ba4c8,0x3ce6bd173d2dbd35,0x3d0cbcc93c52a635,0x3d0cbcc93c521f81,0xbce63d17bd2d3d35,0xbd173d27bd323d35,0x3d17bd273d32bd35,0xbcc93c8bbc0d2609,0x3cc9bc8b3c0da4c8,0x3d2dbd323d34bd35,0xbc523c0dbb8e2667,0x3c52bc0d3b8ea5bb,0x3d2dbd323d34bd35
.quad 0xbd0025e13d00bd35,0xbd0026033d00bd35,0x3d00bd353d00a5af,0x3d00bd353d002596,0x3b8e3cc9bd2d3d27,0xbd343d17bc52bc8b,0xbd343d17bc52bc8b,0xbb8ebcc93d2dbd27,0x3cc9bd273d32bd00,0xbcc93d27bd323d00,0x3d17bc8bbc0d3d00,0xbd173c8b3c0dbd00,0xbd2d3d32bd0c3c8b,0x3c523c0dbce63d27,0xbc52bc0d3ce6bd27,0xbd2d3d32bd0c3c8b
.quad 0x3d27bd003c8b2496,0x3d27bd003c8b2686,0xbc8b3d00bd273d35,0xbc8b3d00bd273d35,0xbcab3c0d3b8ebc8b,0x3d20bd323d34bd27,0x3d20bd323d34bd27,0x3cabbc0dbb8e3c8b,0xbc0d3c8bbcc93d00,0x3c0dbc8b3cc9bd00,0xbd323d27bd173d00,0x3d32bd273d17bd00,0x3d0cbd173d20bd27,0xbce63cc9bcab3c8b,0x3ce6bcc93cabbc8b,0x3d0cbd173d20bd27
.quad 0x3d002496bd003d35,0x3d00a635bd003d35,0xbd003d35bd002609,0xbd003d35bd00a4c8,0x3c52bd173d34bd00,0x3d2dbcc9bb8e3d00,0x3d2dbcc9bb8e3d00,0xbc523d17bd343d00,0xbd323d27bcc925ed,0x3d32bd273cc9a5bb,0xbc0dbc8b3d17bd35,0x3c0d3c8bbd173d35,0x3ce6bc0dbc523d00,0x3d0cbd323d2dbd00,0xbd0c3d32bd2d3d00,0x3ce6bc0dbc523d00
.quad 0x3c8bbd003d27bd35,0x3c8bbd003d27bd35,0x3d27bd003c8ba5c8,0x3d27bd003c8ba654,0xbd343d32bd203d00,0xbb8ebc0d3cabbd00,0xbb8ebc0d3cabbd00,0x3d34bd323d20bd00,0x3cc9bc8b3c0da5a2,0xbcc93c8bbc0da4fa,0xbd173d27bd323d35,0x3d17bd273d32bd35,0x3cabbcc93ce6bd00,0xbd203d17bd0c3d00,0x3d20bd173d0cbd00,0x3cabbcc93ce6bd00
.quad 0xbd0024fa3d00bd35,0xbd0026673d00bd35,0x3d00bd353d00a63b,0x3d00bd353d00a6c1,0xbce63d32bd203c8b,0xbd0c3c0d3cabbd27,0xbd0c3c0d3cabbd27,0x3ce6bd323d20bc8b,0x3d17bc8bbc0d3d00,0xbd173c8b3c0dbd00,0xbcc93d27bd323d00,0x3cc9bd273d32bd00,0x3cabbd173d34bd27,0xbd203cc9bb8ebc8b,0x3d20bcc93b8e3c8b,0x3cabbd173d34bd27
.quad 0xbd273d00bc8b265a,0xbd273d00bc8b26a5,0x3c8bbd003d27bd35,0x3c8bbd003d27bd35,0xbc523cc9bd0c3d27,0xbd2d3d17bce63c8b,0xbd2d3d17bce63c8b,0x3c52bcc93d0cbd27,0x3d32bd273d17bd00,0xbd323d27bd173d00,0xbc0d3c8bbcc93d00,0x3c0dbc8b3cc9bd00,0x3b8ebc0d3c52bc8b,0xbd343d32bd2d3d27,0x3d34bd323d2dbd27,0x3b8ebc0d3c52bc8b
.quad 0x3f353f353f353f35,0x0,0xbf353f35bf353f35,0x0,0x3ec43f353f6d3f80,0x0,0xbf6dbf35bec48000,0x0,0xa554bf80248d3f80,0x0,0x3f80a50dbf808000,0x0,0x3f6dbf35bec43f80,0x0,0x3ec43f35bf6d8000,0x0
.quad 0x0,0x3f553f6d3f7b3f80,0x0,0xbf0ebec4be488000,0x0,0xbe483ec43f553f80,0x0,0xbf7bbf6dbf0e8000,0x0,0x3f0ebf6dbe483f80,0x0,0x3f553ec4bf7b8000,0x0,0x3f7bbec4bf0e3f80,0x0,0xbe483f6dbf558000
.quad 0x3f353f353f353f35,0x0,0xbf353f35bf353f35,0x0,0xbf6dbf35bec4248d,0x0,0xbec4bf35bf6dbf80,0x0,0xa5f7bf8025b03f80,0x0,0x3f80a5d4bf80258d,0x0,0x3ec43f35bf6d25b0,0x0,0xbf6d3f353ec4bf80,0x0
.quad 0x0,0x3e483ec43f0e3f35,0x0,0xbf7bbf6dbf55bf35,0x0,0xbf0ebf6dbf7bbf35,0x0,0x3f553ec4be48bf35,0x0,0x3f7bbec4bf553f35,0x0,0x3e483f6dbf0ebf35,0x0,0xbf553f6dbe48bf35,0x0,0xbf0ebec43f7bbf35
.quad 0x3f353f353f353f35,0x0,0xbf353f35bf353f35,0x0,0xbec4bf35bf6dbf80,0x0,0x3f6d3f353ec4a50d,0x0,0xa731bf80261f3f80,0x0,0x3f80a630bf80260d,0x0,0xbf6d3f353ec4bf80,0x0,0xbec4bf353f6da630,0x0
.quad 0x0,0xbf0ebec4be48248d,0x0,0xbf55bf6dbf7bbf80,0x0,0x3f7b3f6d3f0ea554,0x0,0xbe483ec43f553f80,0x0,0x3f553ec4bf7b261f,0x0,0xbf0e3f6d3e48bf80,0x0,0x3e48bf6d3f55a731,0x0,0x3f7bbec4bf0e3f80
.quad 0x3f353f353f353f35,0x0,0xbf353f35bf353f35,0x0,0x3f6d3f353ec4a554,0x0,0x3ec43f353f6d3f80,0x0,0xa742bf80a68d3f80,0x0,0x3f80a677bf802654,0x0,0xbec4bf353f6da742,0x0,0x3f6dbf35bec43f80,0x0
.quad 0x0,0xbf7bbf6dbf55bf35,0x0,0xbe48bec4bf0ebf35,0x0,0xbf55bec43e483f35,0x0,0xbf0ebf6dbf7bbf35,0x0,0x3e483f6dbf0ebf35,0x0,0xbf7b3ec43f55bf35,0x0,0x3f0e3ec4bf7b3f35,0x0,0xbf553f6dbe48bf35
.quad 0xbf35248d3f353f80,0x0,0xbf35bf80bf358000,0x0,0xbf6dbf353ec43f80,0x0,0x3ec4bf35bf6d8000,0x0,0x3f35a554bf353f80,0x0,0xbf353f80bf358000,0x0,0xbec43f35bf6d3f80,0x0,0xbf6d3f35bec48000,0x0
.quad 0x0,0xbf7bbec43f0e3f80,0x0,0xbe48bf6dbf558000,0x0,0xbf0ebf6d3e483f80,0x0,0x3f55bec4bf7b8000,0x0,0x3e483ec4bf553f80,0x0,0xbf7b3f6dbf0e8000,0x0,0xbf553f6dbf7b3f80,0x0,0xbf0e3ec4be488000
.quad 0x3f35a554bf35bf80,0x0,0x3f353f803f35a50d,0x0,0xbec43f353f6da554,0x0,0xbf6dbf353ec43f80,0x0,0xbf35261f3f35bf80,0x0,0x3f35bf803f35a5d4,0x0,0x3f6dbf353ec4a5f7,0x0,0xbec43f35bf6d3f80,0x0
.quad 0x0,0x3f553f6d3e48bf35,0x0,0xbf0e3ec43f7b3f35,0x0,0xbf7bbec43f553f35,0x0,0x3e48bf6dbf0e3f35,0x0,0x3f0ebf6d3f7bbf35,0x0,0x3f55bec4be483f35,0x0,0xbe483ec4bf0e3f35,0x0,0xbf7b3f6dbf553f35
.quad 0xbf3525b03f353f80,0x0,0xbf35bf80bf35258d,0x0,0x3f6d3f35bec4bf80,0x0,0xbec43f353f6da5d4,0x0,0x3f35a742bf353f80,0x0,0xbf353f80bf352654,0x0,0x3ec4bf353f6dbf80,0x0,0x3f6dbf353ec4a677,0x0
.quad 0x0,0xbe48bf6dbf5525b0,0x0,0x3f7b3ec4bf0ebf80,0x0,0xbf553ec43f7ba5f7,0x0,0xbf0ebf6d3e483f80,0x0,0xbf7b3f6dbf0ea68d,0x0,0xbe48bec43f55bf80,0x0,0x3f0ebec43e48a742,0x0,0xbf553f6dbf7b3f80
.quad 0x3f35a5f7bf35bf80,0x0,0x3f353f803f35a5d4,0x0,0x3ec4bf35bf6d261f,0x0,0x3f6d3f35bec4bf80,0x0,0xbf35a60d3f35bf80,0x0,0x3f35bf803f35a69f,0x0,0xbf6d3f35bec4a60d,0x0,0x3ec4bf353f6dbf80,0x0
.quad 0x0,0xbf0e3ec43f7b3f35,0x0,0xbf55bf6dbe483f35,0x0,0xbe483f6d3f0ebf35,0x0,0xbf7bbec43f553f35,0x0,0x3f55bec4be483f35,0x0,0xbf0e3f6dbf7b3f35,0x0,0x3f7bbf6d3f55bf35,0x0,0xbe483ec4bf0e3f35
.size tab_t, 18432
.p2align 8
.type tab_i,@object
tab_i:
.quad 0x80003e003e003e00,0x80003e0080003e00,0xbc493dffbe003e00,0xbd153df5bcc83dfb,0xbcc83dfb3e003e00,0xbd8e3dd5bd443ded,0xbd153df5be003e00,0xbdc63da2bd8e3dd5,0xbd443ded3e003e00,0xbded3d44bdb53db5,0xbd713de2be003e00,0xbdff3c49bdd53d8e,0xbd8e3dd53e003e00,0xbdfbbcc8bded3d44,0xbda23dc6be003e00,0xbde2bd71bdfb3cc8
.quad 0xbdb53db53e003e00,0xbdb5bdb5be00230d,0xbdc63da2be003e00,0xbd71bde2bdfbbcc8,0xbdd53d8e3e003e00,0xbcc8bdfbbdedbd44,0xbde23d71be003e00,0x3c49bdffbdd5bd8e,0xbded3d443e003e00,0x3d44bdedbdb5bdb5,0xbdf53d15be003e00,0x3da2bdc6bd8ebdd5,0xbdfb3cc83e003e00,0x3dd5bd8ebd44bded,0xbdff3c49be003e00,0x3df5bd15bcc8bdfb
.quad 0x80003e0080003e00,0x80003e0080003e00,0xbd713de2bd443ded,0xbda23dc6bd8e3dd5,0xbdd53d8ebdb53db5,0xbdfb3cc8bded3d44,0xbdff3c49bded3d44,0xbde2bd71bdfbbcc8,0xbdedbd44be00230d,0xbd44bdedbdb5bdb5,0xbda2bdc6bdedbd44,0x3d15bdf5bcc8bdfb,0xbcc8bdfbbdb5bdb5,0x3dd5bd8e3d44bded,0x3d15bdf5bd44bded,0x3dff3c493dd5bd8e
.quad 0x3db5bdb5a38dbe00,0x3db53db53e00a3d4,0x3df5bd153d44bded,0x3c493dff3dd53d8e,0x3dfb3cc83db5bdb5,0xbd8e3dd53d443ded,0x3dc63da23dedbd44,0xbdf53d15bcc83dfb,0x3d443ded3e00a3d4,0xbdedbd44bdb53db5,0xbc493dff3ded3d44,0xbd71bde2bdfb3cc8,0xbd8e3dd53db53db5,0x3cc8bdfbbdedbd44,0xbde23d713d443ded,0x3dc6bda2bd8ebdd5
.quad 0x80003e0080003e00,0x80003e0080003e00,0xbdc63da2bdb53db5,0xbde23d71bdd53d8e,0xbdfbbcc8be00230d,0xbdd5bd8ebdedbd44,0xbd71bde2bdb5bdb5,0x3c49bdffbcc8bdfb,0x3d44bdeda38dbe00,0x3dedbd443db5bdb5,0x3df5bd153db5bdb5,0x3dc63da23dfb3cc8,0x3dd53d8e3e00a3d4,0xbcc83dfb3d443ded,0x3c493dff3db53db5,0xbdf53d15bd8e3dd5
.quad 0xbdb53db5240d3e00,0xbdb5bdb5be002430,0xbdffbc49bdb53db5,0x3d15bdf5bd8ebdd5,0xbd8ebdd5be002430,0x3dfbbcc83d44bded,0x3d15bdf5bdb5bdb5,0x3da23dc63dfbbcc8,0x3dedbd44a454be00,0xbd443ded3db53db5,0x3de23d713db5bdb5,0xbdff3c49bcc83dfb,0x3cc83dfb3e00a477,0xbd8ebdd5bded3d44,0xbda23dc63db53db5,0x3d71bde2bdd5bd8e
.quad 0x80003e0080003e00,0x80003e0080003e00,0xbdf53d15bded3d44,0xbdff3c49bdfb3cc8,0xbd8ebdd5bdb5bdb5,0xbcc8bdfbbd44bded,0x3da2bdc63d44bded,0x3df5bd153dd5bd8e,0x3ded3d443e00a3d4,0x3d443ded3db53db5,0xbc493dff3d443ded,0xbde23d71bd8e3dd5,0xbdfb3cc8bdb53db5,0xbd8ebdd5bdedbd44,0xbd71bde2bdedbd44,0x3dc6bda23cc8bdfb
.quad 0x3db5bdb5a454be00,0x3db53db53e00a477,0x3de23d713dedbd44,0xbda23dc63cc83dfb,0xbcc83dfb3db53db5,0xbdd5bd8ebded3d44,0xbdff3c49bd443ded,0x3d71bde2bd8ebdd5,0xbd44bdedbe00249f,0x3ded3d443db5bdb5,0x3dc6bda2bd44bded,0xbd153df53dd53d8e,0x3dd53d8e3db5bdb5,0xbdfbbcc8bd443ded,0xbd153df53ded3d44,0x3c49bdffbdfbbcc8
.quad 0x80003e0080003e00,0x80003e0080003e00,0xbdffbc49be00230d,0xbdf5bd15bdfbbcc8,0x3cc8bdfba38dbe00,0x3d8ebdd53d44bded,0x3df53d153e00a3d4,0x3da23dc63dd53d8e,0xbd443ded240d3e00,0xbded3d44bdb53db5,0xbde2bd71be002430,0xbc49bdffbd8ebdd5,0x3d8ebdd5a454be00,0x3dfb3cc83dedbd44,0x3dc63da23e00a477,0xbd713de23cc83dfb
.quad 0xbdb53db5248d3e00,0xbdb5bdb5be00249f,0xbda2bdc6be00249f,0x3de2bd713cc8bdfb,0x3dd5bd8ea4b0be00,0x3cc83dfb3ded3d44,0x3d713de23e00a5b1,0xbdffbc49bd8e3dd5,0xbded3d4424d43e00,0x3d44bdedbdb5bdb5,0xbd15bdf5be00a50d,0x3dc63da23dd5bd8e,0x3dfbbcc8a4f7be00,0xbdd53d8e3d443ded,0x3c493dff3e00a5c2,0xbd15bdf5bdfb3cc8
.quad 0x80003e0080003e00,0x80003e0080003e00,0xbde2bd71bdedbd44,0xbdc6bda2bdd5bd8e,0x3dd5bd8e3db5bdb5,0x3dfbbcc83dedbd44,0x3c493dff3d443ded,0xbd713de2bcc83dfb,0xbdedbd44be002430,0xbd44bdedbdb5bdb5,0x3dc6bda23d44bded,0x3df53d153dfbbcc8,0x3cc83dfb3db53db5,0xbdd53d8ebd443ded,0xbdf5bd15bded3d44,0x3c49bdffbd8ebdd5
.quad 0x3db5bdb5a4b0be00,0x3db53db53e00a5b1,0x3d153df53ded3d44,0xbdff3c49bd8e3dd5,0xbdfbbcc8bdb53db5,0x3d8ebdd5bd44bded,0x3da2bdc6bd44bded,0x3d153df53dfb3cc8,0x3d443ded3e00a5c2,0xbdedbd44bdb53db5,0xbdffbc49bd443ded,0x3de2bd71bcc8bdfb,0x3d8ebdd5bdb5bdb5,0xbcc83dfb3ded3d44,0x3d713de23dedbd44,0xbda2bdc6bdd53d8e
.quad 0x80003e0080003e00,0x80003e0080003e00,0xbda2bdc6bdb5bdb5,0xbd71bde2bd8ebdd5,0x3dfb3cc83e00a3d4,0x3dd53d8e3ded3d44,0xbde23d71bdb53db5,0xbdffbc49bdfb3cc8,0x3d44bdeda454be00,0x3dedbd443db5bdb5,0x3d153df53db53db5,0xbda23dc6bcc83dfb,0xbdd5bd8ebe00249f,0x3cc8bdfbbd44bded,0x3dffbc493db5bdb5,0x3d153df53dd53d8e
.quad 0xbdb53db524d43e00,0xbdb5bdb5be00a50d,0x3c49bdffbdb5bdb5,0x3df53d153dd5bd8e,0x3d8e3dd53e00a5c2,0xbdfb3cc8bd443ded,0xbdf5bd15bdb53db5,0x3dc6bda2bcc8bdfb,0x3dedbd44a51fbe00,0xbd443ded3db53db5,0xbd713de23db53db5,0xbc49bdffbdfbbcc8,0xbcc8bdfbbe00a48d,0x3d8e3dd53dedbd44,0x3dc63da23db5bdb5,0xbde2bd71bd8e3dd5
.quad 0x80003e0080003e00,0x80003e0080003e00,0xbd15bdf5bd44bded,0xbc49bdffbcc8bdfb,0x3d8e3dd53db53db5,0x3cc83dfb3d443ded,0xbdc6bda2bdedbd44,0xbd15bdf5bd8ebdd5,0x3ded3d443e00a477,0x3d443ded3db53db5,0xbdffbc49bded3d44,0xbd71bde2bdd5bd8e,0x3dfbbcc83db5bdb5,0x3d8e3dd53ded3d44,0xbde23d71bd443ded,0xbda2bdc6bdfbbcc8
.quad 0x3db5bdb5a4f7be00,0x3db53db53e00a5c2,0xbd713de23d443ded,0xbdc6bda2bdfb3cc8,0x3cc8bdfbbdb5bdb5,0x3dd53d8e3dedbd44,0x3c493dff3ded3d44,0xbde2bd71bdd53d8e,0xbd44bdedbe00a48d,0x3ded3d443db5bdb5,0x3da23dc63dedbd44,0xbdf5bd15bd8e3dd5,0xbdd5bd8ebdb53db5,0x3dfb3cc83d44bded,0x3df53d153d44bded,0xbdffbc49bcc83dfb
.quad 0xbe00230d3e003e00,0x3e00a3d4a38dbe00,0xbdffbc49be003e00,0x3df53d153cc8bdfb,0xbdfbbcc83e003e00,0x3dd53d8e3d44bded,0xbdf5bd15be003e00,0x3da23dc63d8ebdd5,0xbdedbd443e003e00,0x3d443ded3db5bdb5,0xbde2bd71be003e00,0x3c493dff3dd5bd8e,0xbdd5bd8e3e003e00,0xbcc83dfb3dedbd44,0xbdc6bda2be003e00,0xbd713de23dfbbcc8
.quad 0xbdb5bdb53e003e00,0xbdb53db53e00a3d4,0xbda2bdc6be003e00,0xbde23d713dfb3cc8,0xbd8ebdd53e003e00,0xbdfb3cc83ded3d44,0xbd71bde2be003e00,0xbdffbc493dd53d8e,0xbd44bded3e003e00,0xbdedbd443db53db5,0xbd15bdf5be003e00,0xbdc6bda23d8e3dd5,0xbcc8bdfb3e003e00,0xbd8ebdd53d443ded,0xbc49bdffbe003e00,0xbd15bdf53cc83dfb
.quad 0xbe002430240d3e00,0x3e00a477a454be00,0xbde2bd71bd443ded,0x3dc63da23d8ebdd5,0xbd8ebdd5bdb53db5,0x3cc83dfb3dedbd44,0xbc49bdffbded3d44,0xbd713de23dfb3cc8,0x3d44bdedbe002430,0xbded3d443db53db5,0x3dc6bda2bdedbd44,0xbdf5bd153cc83dfb,0x3dfbbcc8bdb5bdb5,0xbd8ebdd5bd443ded,0x3df53d15bd44bded,0x3c49bdffbdd53d8e
.quad 0x3db53db5a454be00,0x3db5bdb5be00249f,0x3d153df53d44bded,0x3dffbc49bdd5bd8e,0xbcc83dfb3db5bdb5,0x3dd53d8ebd44bded,0xbda23dc63dedbd44,0x3d153df53cc8bdfb,0xbded3d443e00a477,0xbd443ded3db5bdb5,0xbdffbc493ded3d44,0xbde23d713dfbbcc8,0xbdd5bd8e3db53db5,0xbdfbbcc83ded3d44,0xbd71bde23d443ded,0xbda2bdc63d8e3dd5
.quad 0xbe00249f248d3e00,0x3e00a5b1a4b0be00,0xbda2bdc6bdb53db5,0x3d713de23dd5bd8e,0x3cc8bdfbbe00249f,0xbd8e3dd53ded3d44,0x3de2bd71bdb5bdb5,0xbdffbc493cc83dfb,0x3ded3d44a4b0be00,0xbd44bdedbdb53db5,0x3d153df53db5bdb5,0x3da2bdc6bdfbbcc8,0xbd8e3dd53e00a5b1,0x3dfb3cc8bd44bded,0xbdff3c493db53db5,0x3d153df53d8ebdd5
.quad 0xbdb5bdb524d43e00,0xbdb53db53e00a5c2,0x3c49bdffbdb53db5,0xbdf5bd153d8e3dd5,0x3dd5bd8ebe00a50d,0xbcc8bdfbbd443ded,0x3df53d15bdb5bdb5,0x3dc6bda2bdfb3cc8,0x3d443deda4f7be00,0x3ded3d44bdb5bdb5,0xbd713de23db5bdb5,0x3c493dff3cc8bdfb,0xbdfb3cc83e00a5c2,0xbdd53d8e3dedbd44,0xbdc6bda23db53db5,0xbde2bd713dd53d8e
.quad 0xbe00a50d24d43e00,0x3e00a5c2a4f7be00,0xbd15bdf5bded3d44,0x3c493dff3dfbbcc8,0x3dd5bd8ebdb5bdb5,0xbdfb3cc83d443ded,0x3dc63da23d44bded,0xbd15bdf5bdd53d8e,0xbd443ded3e00a5c2,0x3dedbd44bdb5bdb5,0xbdffbc493d443ded,0x3d713de23d8ebdd5,0xbcc8bdfbbdb53db5,0xbdd53d8e3ded3d44,0x3de2bd71bdedbd44,0xbda2bdc6bcc83dfb
.quad 0x3db53db5a51fbe00,0x3db5bdb5be00a48d,0xbd713de23dedbd44,0x3dc63da2bcc8bdfb,0xbdfbbcc83db53db5,0xbd8e3dd53dedbd44,0xbc49bdffbd443ded,0xbde2bd713d8e3dd5,0x3dedbd44be00a48d,0x3d44bdedbdb53db5,0x3da23dc6bd44bded,0x3df53d15bdd5bd8e,0xbd8e3dd53db5bdb5,0xbcc83dfb3d44bded,0xbdf5bd153ded3d44,0xbdffbc493dfb3cc8
.quad 0xbe00a4d4250d3e00,0x3e00a5d4a51fbe00,0x3c49bdffbe00a4d4,0xbd153df53dfb3cc8,0x3dfb3cc8a51fbe00,0xbdd5bd8ebd443ded,0xbd153df53e00a5d4,0x3dc6bda2bdd5bd8e,0xbdedbd4425303e00,0x3d443ded3db5bdb5,0x3d71bde2be00a48d,0xbdff3c493d8e3dd5,0x3dd53d8ea631be00,0x3cc8bdfbbded3d44,0xbda23dc63e00a5e5,0x3de23d71bcc8bdfb
.quad 0xbdb5bdb525543e00,0xbdb53db53e00a5f7,0x3dc6bda2be00a40e,0xbd71bde2bcc83dfb,0x3d8e3dd5258dbe00,0x3dfbbcc8bdedbd44,0xbde23d713e00a5f7,0xbc493dff3d8ebdd5,0xbd44bded25773e00,0xbdedbd443db53db5,0x3df5bd15be009fb7,0x3da2bdc6bdd53d8e,0x3cc83dfba642be00,0x3d8e3dd5bd44bded,0xbdff3c493e00a604,0xbdf53d153dfbbcc8
.quad 0xbe00a48d25303e00,0x3e00a5e5a631be00,0x3d71bde2bdedbd44,0xbda23dc63dd53d8e,0x3d8e3dd53db5bdb5,0xbcc8bdfbbded3d44,0xbdff3c493d443ded,0x3de23d713cc8bdfb,0x3d44bdedbe00a40e,0xbded3d443db53db5,0x3da23dc63d44bded,0x3d15bdf5bdfb3cc8,0xbdfb3cc83db53db5,0x3d8e3dd53d44bded,0x3d15bdf5bded3d44,0xbdffbc493d8e3dd5
.quad 0x3db53db5a642be00,0x3db5bdb5be00240d,0xbdf53d153ded3d44,0x3c493dff3d8ebdd5,0x3cc8bdfbbdb53db5,0xbdd5bd8e3d443ded,0x3dc63da2bd44bded,0x3df5bd15bdfbbcc8,0xbded3d443e00a60d,0xbd443ded3db5bdb5,0x3c49bdffbd443ded,0xbd71bde23cc83dfb,0x3dd53d8ebdb5bdb5,0x3dfb3cc8bdedbd44,0xbde23d713dedbd44,0xbdc63da23dd5bd8e
.quad 0xbe00a40e25543e00,0x3e00a5f7258dbe00,0x3dc6bda2bdb5bdb5,0xbde23d713d8e3dd5,0xbcc83dfb3e00a5f7,0x3d8ebdd5bdedbd44,0xbd71bde2bdb53db5,0xbc493dff3dfbbcc8,0x3ded3d44a642be00,0xbd44bdedbdb53db5,0xbdf53d153db53db5,0x3dc63da23cc8bdfb,0x3d8ebdd5be002684,0xbdfbbcc83d443ded,0x3c493dff3db5bdb5,0x3df5bd15bdd5bd8e
.quad 0xbdb5bdb5259f3e00,0xbdb53db53e00a616,0x3dff3c49bdb5bdb5,0x3d15bdf5bdd53d8e,0xbdd53d8e3e0025d4,0x3cc83dfb3d44bded,0x3d15bdf5bdb53db5,0xbda2bdc63cc83dfb,0x3d443ded250dbe00,0x3ded3d44bdb5bdb5,0xbde2bd713db53db5,0xbdff3c493dfb3cc8,0x3dfbbcc8be002709,0x3dd5bd8ebded3d44,0xbda23dc63db5bdb5,0xbd713de23d8ebdd5
.quad 0xbe009fb725773e00,0x3e00a604a642be00,0x3df5bd15bd44bded,0xbdff3c493cc83dfb,0xbdd53d8e3db53db5,0x3dfbbcc8bd44bded,0x3da2bdc6bdedbd44,0xbdf53d153d8e3dd5,0xbd443ded3e00a60d,0x3dedbd44bdb5bdb5,0x3c49bdffbded3d44,0xbde23d713dd53d8e,0x3cc83dfb3db5bdb5,0x3dd5bd8ebdedbd44,0xbd71bde2bd443ded,0xbdc63da23dfb3cc8
.quad 0x3db53db5250dbe00,0x3db5bdb5be00250d,0xbde2bd713d443ded,0xbda23dc63dfbbcc8,0x3dfb3cc8bdb5bdb5,0x3d8ebdd5bded3d44,0xbdff3c493ded3d44,0xbd713de23dd5bd8e,0x3dedbd44be002696,0x3d44bdedbdb53db5,0xbdc63da23dedbd44,0xbd153df53d8ebdd5,0x3d8ebdd5bdb53db5,0x3cc8bdfbbd443ded,0xbd153df53d44bded,0xbc493dff3cc8bdfb
.quad 0xa38dbe003e003e00,0xa454be00240d3e00,0x3c49bdffbe003e00,0x3d15bdf5bcc83dfb,0x3cc8bdfb3e003e00,0x3d8ebdd5bd443ded,0x3d15bdf5be003e00,0x3dc6bda2bd8e3dd5,0x3d44bded3e003e00,0x3dedbd44bdb53db5,0x3d71bde2be003e00,0x3dffbc49bdd53d8e,0x3d8ebdd53e003e00,0x3dfb3cc8bded3d44,0x3da2bdc6be003e00,0x3de23d71bdfb3cc8
.quad 0x3db5bdb53e003e00,0x3db53db5be002430,0x3dc6bda2be003e00,0x3d713de2bdfbbcc8,0x3dd5bd8e3e003e00,0x3cc83dfbbdedbd44,0x3de2bd71be003e00,0xbc493dffbdd5bd8e,0x3dedbd443e003e00,0xbd443dedbdb5bdb5,0x3df5bd15be003e00,0xbda23dc6bd8ebdd5,0x3dfbbcc83e003e00,0xbdd53d8ebd44bded,0x3dffbc49be003e00,0xbdf53d15bcc8bdfb
.quad 0xa4b0be00248d3e00,0xa4f7be0024d43e00,0x3d71bde2bd443ded,0x3da2bdc6bd8e3dd5,0x3dd5bd8ebdb53db5,0x3dfbbcc8bded3d44,0x3dffbc49bded3d44,0x3de23d71bdfbbcc8,0x3ded3d44be00249f,0x3d443dedbdb5bdb5,0x3da23dc6bdedbd44,0xbd153df5bcc8bdfb,0x3cc83dfbbdb5bdb5,0xbdd53d8e3d44bded,0xbd153df5bd44bded,0xbdffbc493dd5bd8e
.quad 0xbdb53db5a4b0be00,0xbdb5bdb53e00a5c2,0xbdf53d153d44bded,0xbc49bdff3dd53d8e,0xbdfbbcc83db5bdb5,0x3d8ebdd53d443ded,0xbdc6bda23dedbd44,0x3df5bd15bcc83dfb,0xbd44bded3e00a5b1,0x3ded3d44bdb53db5,0x3c49bdff3ded3d44,0x3d713de2bdfb3cc8,0x3d8ebdd53db53db5,0xbcc83dfbbdedbd44,0x3de2bd713d443ded,0xbdc63da2bd8ebdd5
.quad 0xa51fbe00250d3e00,0xa631be0025303e00,0x3dc6bda2bdb53db5,0x3de2bd71bdd53d8e,0x3dfb3cc8be00a4d4,0x3dd53d8ebdedbd44,0x3d713de2bdb5bdb5,0xbc493dffbcc8bdfb,0xbd443deda51fbe00,0xbded3d443db5bdb5,0xbdf53d153db5bdb5,0xbdc6bda23dfb3cc8,0xbdd5bd8e3e00a5d4,0x3cc8bdfb3d443ded,0xbc49bdff3db53db5,0x3df5bd15bd8e3dd5
.quad 0x3db5bdb525303e00,0x3db53db5be00a40e,0x3dff3c49bdb53db5,0xbd153df5bd8ebdd5,0x3d8e3dd5be00a48d,0xbdfb3cc83d44bded,0xbd153df5bdb5bdb5,0xbda2bdc63dfbbcc8,0xbded3d44a631be00,0x3d44bded3db53db5,0xbde2bd713db5bdb5,0x3dffbc49bcc83dfb,0xbcc8bdfb3e00a5e5,0x3d8e3dd5bded3d44,0x3da2bdc63db53db5,0xbd713de2bdd5bd8e
.quad 0x258dbe0025543e00,0xa642be0025773e00,0x3df5bd15bded3d44,0x3dffbc49bdfb3cc8,0x3d8e3dd5bdb5bdb5,0x3cc83dfbbd44bded,0xbda23dc63d44bded,0xbdf53d153dd5bd8e,0xbdedbd443e00a5f7,0xbd44bded3db53db5,0x3c49bdff3d443ded,0x3de2bd71bd8e3dd5,0x3dfbbcc8bdb53db5,0x3d8e3dd5bdedbd44,0x3d713de2bdedbd44,0xbdc63da23cc8bdfb
.quad 0xbdb53db5a642be00,0xbdb5bdb53e00a60d,0xbde2bd713dedbd44,0x3da2bdc63cc83dfb,0x3cc8bdfb3db53db5,0x3dd53d8ebded3d44,0x3dffbc49bd443ded,0xbd713de2bd8ebdd5,0x3d443dedbe002684,0xbdedbd443db5bdb5,0xbdc63da2bd44bded,0x3d15bdf53dd53d8e,0xbdd5bd8e3db5bdb5,0x3dfb3cc8bd443ded,0x3d15bdf53ded3d44,0xbc493dffbdfbbcc8
.quad 0x2554be00258d3e00,0xa654be00259f3e00,0x3dff3c49be00240d,0x3df53d15bdfbbcc8,0xbcc83dfb2554be00,0xbd8e3dd53d44bded,0xbdf5bd153e00a60d,0xbda2bdc63dd53d8e,0x3d44bded259f3e00,0x3dedbd44bdb53db5,0x3de23d71be00248d,0x3c493dffbd8ebdd5,0xbd8e3dd5a654be00,0xbdfbbcc83dedbd44,0xbdc6bda23e00a616,0x3d71bde23cc83dfb
.quad 0x3db5bdb525b03e00,0x3db53db5be00250d,0x3da23dc6be00268d,0xbde23d713cc8bdfb,0xbdd53d8e250dbe00,0xbcc8bdfb3ded3d44,0xbd71bde23e00a61f,0x3dff3c49bd8e3dd5,0x3dedbd4426b13e00,0xbd443dedbdb5bdb5,0x3d153df5be00250d,0xbdc6bda23dd5bd8e,0xbdfb3cc8a665be00,0x3dd5bd8e3d443ded,0xbc49bdff3e0025b1,0x3d153df5bdfb3cc8
.quad 0x250dbe0025b03e00,0xa665be0026b13e00,0x3de23d71bdedbd44,0x3dc63da2bdd5bd8e,0xbdd53d8e3db5bdb5,0xbdfb3cc83dedbd44,0xbc49bdff3d443ded,0x3d71bde2bcc83dfb,0x3ded3d44be00250d,0x3d443dedbdb5bdb5,0xbdc63da23d44bded,0xbdf5bd153dfbbcc8,0xbcc8bdfb3db53db5,0x3dd5bd8ebd443ded,0x3df53d15bded3d44,0xbc493dffbd8ebdd5
.quad 0xbdb53db5248ebe00,0xbdb5bdb53e00258d,0xbd15bdf53ded3d44,0x3dffbc49bd8e3dd5,0x3dfb3cc8bdb53db5,0xbd8e3dd5bd44bded,0xbda23dc6bd44bded,0xbd15bdf53dfb3cc8,0xbd44bded3e00a6dd,0x3ded3d44bdb53db5,0x3dff3c49bd443ded,0xbde23d71bcc8bdfb,0xbd8e3dd5bdb5bdb5,0x3cc8bdfb3ded3d44,0xbd71bde23dedbd44,0x3da23dc6bdd53d8e
.quad 0x248ebe0025d43e00,0xa677be00a60d3e00,0x3da23dc6bdb5bdb5,0x3d713de2bd8ebdd5,0xbdfbbcc83e0026a8,0xbdd5bd8e3ded3d44,0x3de2bd71bdb53db5,0x3dff3c49bdfb3cc8,0xbd443deda677be00,0xbded3d443db5bdb5,0xbd15bdf53db53db5,0x3da2bdc6bcc83dfb,0x3dd53d8ebe00269f,0xbcc83dfbbd44bded,0xbdff3c493db5bdb5,0xbd15bdf53dd53d8e
.quad 0x3db5bdb526c23e00,0x3db53db5be0026a8,0xbc493dffbdb5bdb5,0xbdf5bd153dd5bd8e,0xbd8ebdd53e002554,0x3dfbbcc8bd443ded,0x3df53d15bdb53db5,0xbdc63da2bcc8bdfb,0xbded3d44a704be00,0x3d44bded3db53db5,0x3d71bde23db53db5,0x3c493dffbdfbbcc8,0x3cc83dfbbe0025b0,0xbd8ebdd53dedbd44,0xbdc6bda23db5bdb5,0x3de23d71bd8e3dd5
.quad 0x2037be0025f73e00,0xa684be0026c23e00,0x3d153df5bd44bded,0x3c493dffbcc8bdfb,0xbd8ebdd53db53db5,0xbcc8bdfb3d443ded,0x3dc63da2bdedbd44,0x3d153df5bd8ebdd5,0xbdedbd443e002554,0xbd44bded3db53db5,0x3dff3c49bded3d44,0x3d713de2bdd5bd8e,0xbdfb3cc83db5bdb5,0xbd8ebdd53ded3d44,0x3de2bd71bd443ded,0x3da23dc6bdfbbcc8
.quad 0xbdb53db5a68dbe00,0xbdb5bdb53e00a665,0x3d71bde23d443ded,0x3dc63da2bdfb3cc8,0xbcc83dfbbdb5bdb5,0xbdd5bd8e3dedbd44,0xbc49bdff3ded3d44,0x3de23d71bdd53d8e,0x3d443dedbe00271a,0xbdedbd443db5bdb5,0xbda2bdc63dedbd44,0x3df53d15bd8e3dd5,0x3dd53d8ebdb53db5,0xbdfbbcc83d44bded,0xbdf5bd153d44bded,0x3dff3c49bcc83dfb
.quad 0x3e00a3d43e003e00,0xbe00249fa454be00,0x3dff3c49be003e00,0xbdf5bd153cc8bdfb,0x3dfb3cc83e003e00,0xbdd5bd8e3d44bded,0x3df53d15be003e00,0xbda2bdc63d8ebdd5,0x3ded3d443e003e00,0xbd44bded3db5bdb5,0x3de23d71be003e00,0xbc49bdff3dd5bd8e,0x3dd53d8e3e003e00,0x3cc8bdfb3dedbd44,0x3dc63da2be003e00,0x3d71bde23dfbbcc8
.quad 0x3db53db53e003e00,0x3db5bdb53e00a477,0x3da23dc6be003e00,0x3de2bd713dfb3cc8,0x3d8e3dd53e003e00,0x3dfbbcc83ded3d44,0x3d713de2be003e00,0x3dff3c493dd53d8e,0x3d443ded3e003e00,0x3ded3d443db53db5,0x3d153df5be003e00,0x3dc63da23d8e3dd5,0x3cc83dfb3e003e00,0x3d8e3dd53d443ded,0x3c493dffbe003e00,0x3d153df53cc83dfb
.quad 0x3e00a5c224d43e00,0xbe00a48da51fbe00,0x3de23d71bd443ded,0xbdc6bda23d8ebdd5,0x3d8e3dd5bdb53db5,0xbcc8bdfb3dedbd44,0x3c493dffbded3d44,0x3d71bde23dfb3cc8,0xbd443dedbe00a50d,0x3dedbd443db53db5,0xbdc63da2bdedbd44,0x3df53d153cc83dfb,0xbdfb3cc8bdb5bdb5,0x3d8e3dd5bd443ded,0xbdf5bd15bd44bded,0xbc493dffbdd53d8e
.quad 0xbdb5bdb5a4f7be00,0xbdb53db5be00a48d,0xbd15bdf53d44bded,0xbdff3c49bdd5bd8e,0x3cc8bdfb3db5bdb5,0xbdd5bd8ebd44bded,0x3da2bdc63dedbd44,0xbd15bdf53cc8bdfb,0x3dedbd443e00a5c2,0x3d44bded3db5bdb5,0x3dff3c493ded3d44,0x3de2bd713dfbbcc8,0x3dd53d8e3db53db5,0x3dfb3cc83ded3d44,0x3d713de23d443ded,0x3da23dc63d8e3dd5
.quad 0x3e00a5f725543e00,0xbe00240da642be00,0x3da23dc6bdb53db5,0xbd71bde23dd5bd8e,0xbcc83dfbbe00a40e,0x3d8ebdd53ded3d44,0xbde23d71bdb5bdb5,0x3dff3c493cc83dfb,0xbdedbd44258dbe00,0x3d443dedbdb53db5,0xbd15bdf53db5bdb5,0xbda23dc6bdfbbcc8,0x3d8ebdd53e00a5f7,0xbdfbbcc8bd44bded,0x3dffbc493db53db5,0xbd15bdf53d8ebdd5
.quad 0x3db53db525773e00,0x3db5bdb53e00a60d,0xbc493dffbdb53db5,0x3df53d153d8e3dd5,0xbdd53d8ebe009fb7,0x3cc83dfbbd443ded,0xbdf5bd15bdb5bdb5,0xbdc63da2bdfb3cc8,0xbd44bdeda642be00,0xbdedbd44bdb5bdb5,0x3d71bde23db5bdb5,0xbc49bdff3cc8bdfb,0x3dfbbcc83e00a604,0x3dd5bd8e3dedbd44,0x3dc63da23db53db5,0x3de23d713dd53d8e
.quad 0x3e00a616259f3e00,0xbe00250d250dbe00,0x3d153df5bded3d44,0xbc49bdff3dfbbcc8,0xbdd53d8ebdb5bdb5,0x3dfbbcc83d443ded,0xbdc6bda23d44bded,0x3d153df5bdd53d8e,0x3d44bded3e0025d4,0xbded3d44bdb5bdb5,0x3dff3c493d443ded,0xbd71bde23d8ebdd5,0x3cc83dfbbdb53db5,0x3dd5bd8e3ded3d44,0xbde23d71bdedbd44,0x3da23dc6bcc83dfb
.quad 0xbdb5bdb5250dbe00,0xbdb53db5be002696,0x3d71bde23dedbd44,0xbdc6bda2bcc8bdfb,0x3dfb3cc83db53db5,0x3d8ebdd53dedbd44,0x3c493dffbd443ded,0x3de23d713d8e3dd5,0xbded3d44be002709,0xbd443dedbdb53db5,0xbda2bdc6bd44bded,0xbdf5bd15bdd5bd8e,0x3d8ebdd53db5bdb5,0x3cc8bdfb3d44bded,0x3df53d153ded3d44,0x3dff3c493dfb3cc8
.quad 0x3e00a63125d43e00,0xbe00269fa677be00,0xbc493dffbe002696,0x3d15bdf53dfb3cc8,0xbdfbbcc8248ebe00,0x3dd53d8ebd443ded,0x3d15bdf53e00a631,0xbdc63da2bdd5bd8e,0x3ded3d44a60d3e00,0xbd44bded3db5bdb5,0xbd713de2be002554,0x3dffbc493d8e3dd5,0xbdd5bd8ea677be00,0xbcc83dfbbded3d44,0x3da2bdc63e00258d,0xbde2bd71bcc8bdfb
.quad 0x3db53db525f73e00,0x3db5bdb53e002554,0xbdc63da2be00269f,0x3d713de2bcc83dfb,0xbd8ebdd52037be00,0xbdfb3cc8bdedbd44,0x3de2bd713e00a642,0x3c49bdff3d8ebdd5,0x3d443ded26c23e00,0x3ded3d443db53db5,0xbdf53d15be00258d,0xbda23dc6bdd53d8e,0xbcc8bdfba684be00,0xbd8ebdd5bd44bded,0x3dffbc493e002554,0x3df5bd153dfbbcc8
.quad 0x3e00255426c23e00,0xbe0025b0a48dbe00,0xbd713de2bdedbd44,0x3da2bdc63dd53d8e,0xbd8ebdd53db5bdb5,0x3cc83dfbbded3d44,0x3dffbc493d443ded,0xbde2bd713cc8bdfb,0xbd443dedbe00a631,0x3dedbd443db53db5,0xbda2bdc63d44bded,0xbd153df5bdfb3cc8,0x3dfbbcc83db53db5,0xbd8ebdd53d44bded,0xbd153df5bded3d44,0x3dff3c493d8e3dd5
.quad 0xbdb5bdb5a68dbe00,0xbdb53db5be0025d4,0x3df5bd153ded3d44,0xbc49bdff3d8ebdd5,0xbcc83dfbbdb53db5,0x3dd53d8e3d443ded,0xbdc6bda2bd44bded,0xbdf53d15bdfbbcc8,0x3dedbd443e00a665,0x3d44bded3db5bdb5,0xbc493dffbd443ded,0x3d713de23cc83dfb,0xbdd5bd8ebdb5bdb5,0xbdfbbcc8bdedbd44,0x3de2bd713dedbd44,0x3dc6bda23dd5bd8e
.quad 0x3e00a665261f3e00,0xbe0026b9a696be00,0xbdc63da2bdb5bdb5,0x3de2bd713d8e3dd5,0x3cc8bdfb3e00a665,0xbd8e3dd5bdedbd44,0x3d713de2bdb53db5,0x3c49bdff3dfbbcc8,0xbdedbd442654be00,0x3d443dedbdb53db5,0x3df5bd153db53db5,0xbdc6bda23cc8bdfb,0xbd8e3dd5be0026b9,0x3dfb3cc83d443ded,0xbc49bdff3db5bdb5,0xbdf53d15bdd5bd8e
.quad 0x3db53db5a58d3e00,0x3db5bdb53e00a684,0xbdffbc49bdb5bdb5,0xbd153df5bdd53d8e,0x3dd5bd8e3e00a700,0xbcc8bdfb3d44bded,0xbd153df5bdb53db5,0x3da23dc63cc83dfb,0xbd44bdeda789be00,0xbdedbd44bdb5bdb5,0x3de23d713db53db5,0x3dffbc493dfb3cc8,0xbdfb3cc8be002723,0xbdd53d8ebded3d44,0x3da2bdc63db5bdb5,0x3d71bde23d8ebdd5
.quad 0x3e00a700a58d3e00,0xbe002723a58dbe00,0xbdf53d15bd44bded,0x3dffbc493cc83dfb,0x3dd5bd8e3db53db5,0xbdfb3cc8bd44bded,0xbda23dc6bdedbd44,0x3df5bd153d8e3dd5,0x3d44bded3e00273e,0xbded3d44bdb5bdb5,0xbc493dffbded3d44,0x3de2bd713dd53d8e,0xbcc8bdfb3db5bdb5,0xbdd53d8ebdedbd44,0x3d713de2bd443ded,0x3dc6bda23dfb3cc8
.quad 0xbdb5bdb5a716be00,0xbdb53db5be00a5b1,0x3de23d713d443ded,0x3da2bdc63dfbbcc8,0xbdfbbcc8bdb5bdb5,0xbd8e3dd5bded3d44,0x3dffbc493ded3d44,0x3d71bde23dd5bd8e,0xbded3d44be00276a,0xbd443dedbdb53db5,0x3dc6bda23dedbd44,0x3d15bdf53d8ebdd5,0xbd8e3dd5bdb53db5,0xbcc83dfbbd443ded,0x3d15bdf53d44bded,0x3c49bdff3cc8bdfb
.quad 0x80003eb53e803e80,0x80003eb580003eb5,0x0,0x0,0xbe0b3ea7be803e80,0xbea73e0bbe803e80,0x0,0x0,0xbe803e803e803e80,0xbe80be80beb523c8,0x0,0x0,0xbea73e0bbe803e80,0x3e0bbea7be80be80,0x0,0x0
.quad 0xbeb523c83e803e80,0x3eb5a496a448beb5,0x0,0x0,0xbea7be0bbe803e80,0x3e0b3ea73e80be80,0x0,0x0,0xbe80be803e803e80,0xbe803e803eb5a496,0x0,0x0,0xbe0bbea7be803e80,0xbea7be0b3e803e80,0x0,0x0
.quad 0x80003eb580003eb5,0x80003eb580003eb5,0x0,0x0,0xbea7be0bbeb523c8,0xbe0bbea7be80be80,0x0,0x0,0x3e80be80a448beb5,0x3e803e803eb5a496,0x0,0x0,0x3e0b3ea73eb5a496,0xbea7be0bbe803e80,0x0,0x0
.quad 0xbeb524fa24c83eb5,0x3eb5a52fa516beb5,0x0,0x0,0x3e0bbea7beb524fa,0xbea73e0b3e803e80,0x0,0x0,0x3e803e80a516beb5,0x3e80be80beb52561,0x0,0x0,0xbea73e0b3eb5a52f,0xbe0b3ea73e80be80,0x0,0x0
.quad 0x0,0x0,0x80003eb580003eb5,0x80003eb580003eb5,0x0,0x0,0xbe493e97bd8d3eb2,0xbeb23d8dbe973e49,0x0,0x0,0xbea73e0bbe0b3ea7,0xbe0bbea7bea7be0b,0x0,0x0,0xbeb2bd8dbe493e97,0x3e97be49bd8dbeb2
.quad 0x0,0x0,0xbe80be80be803e80,0x3e803e803e80be80,0x0,0x0,0xbd8dbeb2be973e49,0xbe493e973eb23d8d,0x0,0x0,0x3e0bbea7bea73e0b,0xbea7be0b3e0b3ea7,0x0,0x0,0x3e97be49beb23d8d,0x3d8dbeb2be493e97
.quad 0x0,0x0,0x80003eb580003eb5,0x80003eb580003eb5,0x0,0x0,0xbe97be49beb2bd8d,0xbd8dbeb2be49be97,0x0,0x0,0x3ea7be0b3e0bbea7,0x3e0b3ea73ea73e0b,0x0,0x0,0xbd8d3eb23e973e49,0xbe49be97beb23d8d
.quad 0x0,0x0,0xbe80be80be803e80,0x3e803e803e80be80,0x0,0x0,0x3eb2bd8dbe49be97,0xbe97be49bd8d3eb2,0x0,0x0,0xbe0b3ea73ea7be0b,0x3ea73e0bbe0bbea7,0x0,0x0,0xbe49be973d8d3eb2,0xbeb2bd8d3e973e49
.quad 0xa448beb53e803e80,0xa516beb524c83eb5,0x0,0x0,0x3e0bbea7be803e80,0x3ea7be0bbe803e80,0x0,0x0,0x3e80be803e803e80,0x3e803e80beb524fa,0x0,0x0,0x3ea7be0bbe803e80,0xbe0b3ea7be80be80,0x0,0x0
.quad 0x3eb5a4963e803e80,0xbeb52561a516beb5,0x0,0x0,0x3ea73e0bbe803e80,0xbe0bbea73e80be80,0x0,0x0,0x3e803e803e803e80,0x3e80be803eb5a52f,0x0,0x0,0x3e0b3ea7be803e80,0x3ea73e0b3e803e80,0x0,0x0
.quad 0xa57abeb525483eb5,0xa5afbeb525963eb5,0x0,0x0,0x3ea73e0bbeb52561,0x3e0b3ea7be80be80,0x0,0x0,0xbe803e80a57abeb5,0xbe80be803eb5a689,0x0,0x0,0xbe0bbea73eb5a67a,0x3ea73e0bbe803e80,0x0,0x0
.quad 0x3eb5a68925963eb5,0xbeb5a548a5e1beb5,0x0,0x0,0xbe0b3ea7beb5a5c8,0x3ea7be0b3e803e80,0x0,0x0,0xbe80be80a5afbeb5,0xbe803e80beb5a548,0x0,0x0,0x3ea7be0b3eb5a689,0x3e0bbea73e80be80,0x0,0x0
.quad 0x0,0x0,0x3eb5a496beb523c8,0x3eb5a52fbeb524fa,0x0,0x0,0x3e973e49beb2bd8d,0x3d8d3eb2be49be97,0x0,0x0,0x3e0b3ea7bea7be0b,0xbea73e0b3e0bbea7,0x0,0x0,0xbd8d3eb2be97be49,0xbe49be973eb2bd8d
.quad 0x0,0x0,0xbe803e80be80be80,0x3e80be803e803e80,0x0,0x0,0xbeb23d8dbe49be97,0x3e973e49bd8d3eb2,0x0,0x0,0xbea7be0bbe0bbea7,0xbe0b3ea7bea73e0b,0x0,0x0,0xbe49be97bd8dbeb2,0xbeb2bd8dbe97be49
.quad 0x0,0x0,0x3eb5a67abeb52561,0x3eb5a689beb5a5c8,0x0,0x0,0xbe493e973d8dbeb2,0xbeb23d8d3e97be49,0x0,0x0,0xbe0bbea73ea73e0b,0x3ea7be0bbe0b3ea7,0x0,0x0,0x3eb23d8dbe493e97,0xbe973e49bd8dbeb2
.quad 0x0,0x0,0xbe803e80be80be80,0x3e80be803e803e80,0x0,0x0,0xbd8dbeb23e97be49,0xbe493e97beb2bd8d,0x0,0x0,0x3ea73e0b3e0b3ea7,0x3e0bbea73ea7be0b,0x0,0x0,0xbe973e49beb23d8d,0xbd8d3eb2be493e97
.quad 0x80003eb580003eb5,0x80003eb580003eb5,0x3eb500003eb50000,0x3eb500003eb50000,0xbe0d3ea7bb0e3eb5,0xbea83e08be813e7e,0x3ea73e0d3eb53b0e,0x3e083ea83e7e3e81,0xbe823e7dbb8e3eb5,0xbe7dbe82beb5bb8e,0x3e7d3e823eb53b8e,0xbe823e7dbb8e3eb5,0xbea83e04bbd53eb5,0x3e11bea6be7bbe82,0x3e043ea83eb53bd5,0xbea6be11be823e7b
.quad 0xbeb5bc0ebc0e3eb5,0x3eb53c0e3c0ebeb5,0xbc0e3eb53eb53c0e,0x3c0ebeb5beb5bc0e,0xbea5be15bc323eb5,0x3e003ea93e84be78,0xbe153ea53eb53c32,0x3ea9be00be78be84,0xbe76be85bc553eb5,0xbe853e763eb53c55,0xbe853e763eb53c55,0x3e763e853c55beb5,0xbdf8beaabc793eb5,0xbea4be193e753e85,0xbeaa3df83eb53c79,0xbe193ea43e85be75
.quad 0x80003eb580003eb5,0x80003eb580003eb5,0x3eb500003eb50000,0x3eb500003eb50000,0xbea7be0dbeb5bb0e,0xbe08bea8be7ebe81,0xbe0d3ea7bb0e3eb5,0xbea83e08be813e7e,0x3e82be7d3b8ebeb5,0x3e7d3e823eb53b8e,0xbe7dbe82beb5bb8e,0x3e82be7d3b8ebeb5,0x3e043ea83eb53bd5,0xbea6be11be823e7b,0x3ea8be043bd5beb5,0xbe113ea63e7b3e82
.quad 0xbeb5bc0ebc0e3eb5,0x3eb53c0e3c0ebeb5,0xbc0e3eb53eb53c0e,0x3c0ebeb5beb5bc0e,0x3e15bea5beb5bc32,0xbea93e003e783e84,0xbea5be15bc323eb5,0x3e003ea93e84be78,0x3e763e853c55beb5,0x3e85be76beb5bc55,0x3e85be76beb5bc55,0xbe76be85bc553eb5,0xbeaa3df83eb53c79,0xbe193ea43e85be75,0x3df83eaa3c79beb5,0x3ea43e19be75be85
.quad 0x3eb500003eb5,0x3eb500003eb5,0xbeb50000beb50000,0xbeb50000beb50000,0xbe0dbea7bb0ebeb5,0xbea8be08be81be7e,0x3ea7be0d3eb5bb0e,0x3e08bea83e7ebe81,0x3e823e7d3b8e3eb5,0x3e7dbe823eb5bb8e,0xbe7d3e82beb53b8e,0x3e823e7d3b8e3eb5,0xbea8be04bbd5beb5,0x3e113ea6be7b3e82,0x3e04bea83eb5bbd5,0xbea63e11be82be7b
.quad 0x3eb5bc0e3c0e3eb5,0xbeb53c0ebc0ebeb5,0x3c0e3eb5beb53c0e,0xbc0ebeb53eb5bc0e,0xbea53e15bc32beb5,0x3e00bea93e843e78,0xbe15bea53eb5bc32,0x3ea93e00be783e84,0x3e76be853c553eb5,0x3e853e76beb53c55,0x3e853e76beb53c55,0xbe763e85bc55beb5,0xbdf83eaabc79beb5,0xbea43e193e75be85,0xbeaabdf83eb5bc79,0xbe19bea43e853e75
.quad 0x3eb500003eb5,0x3eb500003eb5,0xbeb50000beb50000,0xbeb50000beb50000,0xbea73e0dbeb53b0e,0xbe083ea8be7e3e81,0xbe0dbea7bb0ebeb5,0xbea8be08be81be7e,0xbe82be7dbb8ebeb5,0xbe7d3e82beb53b8e,0x3e7dbe823eb5bb8e,0xbe82be7dbb8ebeb5,0x3e04bea83eb5bbd5,0xbea63e11be82be7b,0x3ea83e043bd53eb5,0xbe11bea63e7bbe82
.quad 0x3eb5bc0e3c0e3eb5,0xbeb53c0ebc0ebeb5,0x3c0e3eb5beb53c0e,0xbc0ebeb53eb5bc0e,0x3e153ea5beb53c32,0xbea9be003e78be84,0xbea53e15bc32beb5,0x3e00bea93e843e78,0xbe763e85bc55beb5,0xbe85be763eb5bc55,0xbe85be763eb5bc55,0x3e76be853c553eb5,0xbeaabdf83eb5bc79,0xbe19bea43e853e75,0x3df8beaa3c793eb5,0x3ea4be19be753e85
.quad 0x3c8ebeb5bc8e3eb5,0x3c8ebeb5bc8e3eb5,0xbeb5bc8e3eb53c8e,0xbeb5bc8e3eb53c8e,0x3e1dbea3bca03eb5,0x3eabbdf0be873e71,0xbea3be1d3eb53ca0,0xbdf0beab3e713e87,0x3e88be70bcb23eb5,0x3e703e88beb5bcb2,0xbe70be883eb53cb2,0x3e88be70bcb23eb5,0x3eacbde7bcc33eb5,0xbe213ea2be6ebe88,0xbde7beac3eb53cc3,0x3ea23e21be883e6e
.quad 0x3eb53cd5bcd53eb5,0xbeb5bcd53cd5beb5,0x3cd5beb53eb53cd5,0xbcd53eb5beb5bcd5,0x3ea13e25bce73eb4,0xbddfbeac3e8abe6b,0x3e25bea13eb43ce7,0xbeac3ddfbe6bbe8a,0x3e693e8bbcf83eb4,0x3e8bbe693eb43cf8,0x3e8bbe693eb43cf8,0xbe69be8b3cf8beb4,0x3dd63eadbd053eb4,0x3ea03e293e673e8b,0x3eadbdd63eb43d05,0x3e29bea03e8bbe67
.quad 0x3c8ebeb5bc8e3eb5,0x3c8ebeb5bc8e3eb5,0xbeb5bc8e3eb53c8e,0xbeb5bc8e3eb53c8e,0x3ea33e1dbeb5bca0,0x3df03eabbe71be87,0x3e1dbea3bca03eb5,0x3eabbdf0be873e71,0xbe883e703cb2beb5,0xbe70be883eb53cb2,0x3e703e88beb5bcb2,0xbe883e703cb2beb5,0xbde7beac3eb53cc3,0x3ea23e21be883e6e,0xbeac3de73cc3beb5,0x3e21bea23e6e3e88
.quad 0x3eb53cd5bcd53eb5,0xbeb5bcd53cd5beb5,0x3cd5beb53eb53cd5,0xbcd53eb5beb5bcd5,0xbe253ea1beb4bce7,0x3eacbddf3e6b3e8a,0x3ea13e25bce73eb4,0xbddfbeac3e8abe6b,0xbe69be8b3cf8beb4,0xbe8b3e69beb4bcf8,0xbe8b3e69beb4bcf8,0x3e693e8bbcf83eb4,0x3eadbdd63eb43d05,0x3e29bea03e8bbe67,0xbdd6bead3d05beb4,0xbea0be29be67be8b
.quad 0xbc8ebeb53c8e3eb5,0xbc8ebeb53c8e3eb5,0x3eb5bc8ebeb53c8e,0x3eb5bc8ebeb53c8e,0x3e1d3ea3bca0beb5,0x3eab3df0be87be71,0xbea33e1d3eb5bca0,0xbdf03eab3e71be87,0xbe88be703cb23eb5,0xbe703e883eb5bcb2,0x3e70be88beb53cb2,0xbe88be703cb23eb5,0x3eac3de7bcc3beb5,0xbe21bea2be6e3e88,0xbde73eac3eb5bcc3,0x3ea2be21be88be6e
.quad 0xbeb53cd53cd53eb5,0x3eb5bcd5bcd5beb5,0xbcd5beb5beb53cd5,0x3cd53eb53eb5bcd5,0x3ea1be25bce7beb4,0xbddf3eac3e8a3e6b,0x3e253ea13eb4bce7,0xbeacbddfbe6b3e8a,0xbe693e8b3cf83eb4,0xbe8bbe69beb43cf8,0xbe8bbe69beb43cf8,0x3e69be8bbcf8beb4,0x3dd6beadbd05beb4,0x3ea0be293e67be8b,0x3ead3dd63eb4bd05,0x3e293ea03e8b3e67
.quad 0xbc8ebeb53c8e3eb5,0xbc8ebeb53c8e3eb5,0x3eb5bc8ebeb53c8e,0x3eb5bc8ebeb53c8e,0x3ea3be1dbeb53ca0,0x3df0beabbe713e87,0x3e1d3ea3bca0beb5,0x3eab3df0be87be71,0x3e883e70bcb2beb5,0x3e70be88beb53cb2,0xbe703e883eb5bcb2,0x3e883e70bcb2beb5,0xbde73eac3eb5bcc3,0x3ea2be21be88be6e,0xbeacbde73cc33eb5,0x3e213ea23e6ebe88
.quad 0xbeb53cd53cd53eb5,0x3eb5bcd5bcd5beb5,0xbcd5beb5beb53cd5,0x3cd53eb53eb5bcd5,0xbe25bea1beb43ce7,0x3eac3ddf3e6bbe8a,0x3ea1be25bce7beb4,0xbddf3eac3e8a3e6b,0x3e69be8bbcf8beb4,0x3e8b3e693eb4bcf8,0x3e8b3e693eb4bcf8,0xbe693e8b3cf83eb4,0x3ead3dd63eb4bd05,0x3e293ea03e8b3e67,0xbdd63ead3d053eb4,0xbea03e29be673e8b
.quad 0x80003eb580003eb5,0x80003eb580003eb5,0x3eb500003eb50000,0x3eb500003eb50000,0xbe0f3ea6bb8e3eb5,0xbea83e06be823e7d,0x3ea63e0f3eb53b8e,0x3e063ea83e7d3e82,0xbe833e7abc0e3eb5,0xbe7abe83beb5bc0e,0x3e7a3e833eb53c0e,0xbe833e7abc0e3eb5,0xbeaa3dfcbc553eb5,0x3e17bea5be76be85,0x3dfc3eaa3eb53c55,0xbea5be17be853e76
.quad 0xbeb5bc8ebc8e3eb5,0x3eb53c8e3c8ebeb5,0xbc8e3eb53eb53c8e,0x3c8ebeb5beb5bc8e,0xbea3be1fbcb23eb5,0x3dec3eab3e88be70,0xbe1f3ea33eb53cb2,0x3eabbdecbe70be88,0xbe6cbe89bcd53eb5,0xbe893e6c3eb53cd5,0xbe893e6c3eb53cd5,0x3e6c3e893cd5beb5,0xbddbbeadbcf83eb4,0xbea1be273e693e8b,0xbead3ddb3eb43cf8,0xbe273ea13e8bbe69
.quad 0x80003eb580003eb5,0x80003eb580003eb5,0x3eb500003eb50000,0x3eb500003eb50000,0xbea6be0fbeb5bb8e,0xbe06bea8be7dbe82,0xbe0f3ea6bb8e3eb5,0xbea83e06be823e7d,0x3e83be7a3c0ebeb5,0x3e7a3e833eb53c0e,0xbe7abe83beb5bc0e,0x3e83be7a3c0ebeb5,0x3dfc3eaa3eb53c55,0xbea5be17be853e76,0x3eaabdfc3c55beb5,0xbe173ea53e763e85
.quad 0xbeb5bc8ebc8e3eb5,0x3eb53c8e3c8ebeb5,0xbc8e3eb53eb53c8e,0x3c8ebeb5beb5bc8e,0x3e1fbea3beb5bcb2,0xbeab3dec3e703e88,0xbea3be1fbcb23eb5,0x3dec3eab3e88be70,0x3e6c3e893cd5beb5,0x3e89be6cbeb5bcd5,0x3e89be6cbeb5bcd5,0xbe6cbe89bcd53eb5,0xbead3ddb3eb43cf8,0xbe273ea13e8bbe69,0x3ddb3ead3cf8beb4,0x3ea13e27be69be8b
.quad 0x3eb500003eb5,0x3eb500003eb5,0xbeb50000beb50000,0xbeb50000beb50000,0xbe0fbea6bb8ebeb5,0xbea8be06be82be7d,0x3ea6be0f3eb5bb8e,0x3e06bea83e7dbe82,0x3e833e7a3c0e3eb5,0x3e7abe833eb5bc0e,0xbe7a3e83beb53c0e,0x3e833e7a3c0e3eb5,0xbeaabdfcbc55beb5,0x3e173ea5be763e85,0x3dfcbeaa3eb5bc55,0xbea53e17be85be76
.quad 0x3eb5bc8e3c8e3eb5,0xbeb53c8ebc8ebeb5,0x3c8e3eb5beb53c8e,0xbc8ebeb53eb5bc8e,0xbea33e1fbcb2beb5,0x3decbeab3e883e70,0xbe1fbea33eb5bcb2,0x3eab3decbe703e88,0x3e6cbe893cd53eb5,0x3e893e6cbeb53cd5,0x3e893e6cbeb53cd5,0xbe6c3e89bcd5beb5,0xbddb3eadbcf8beb4,0xbea13e273e69be8b,0xbeadbddb3eb4bcf8,0xbe27bea13e8b3e69
.quad 0x3eb500003eb5,0x3eb500003eb5,0xbeb50000beb50000,0xbeb50000beb50000,0xbea63e0fbeb53b8e,0xbe063ea8be7d3e82,0xbe0fbea6bb8ebeb5,0xbea8be06be82be7d,0xbe83be7abc0ebeb5,0xbe7a3e83beb53c0e,0x3e7abe833eb5bc0e,0xbe83be7abc0ebeb5,0x3dfcbeaa3eb5bc55,0xbea53e17be85be76,0x3eaa3dfc3c553eb5,0xbe17bea53e76be85
.quad 0x3eb5bc8e3c8e3eb5,0xbeb53c8ebc8ebeb5,0x3c8e3eb5beb53c8e,0xbc8ebeb53eb5bc8e,0x3e1f3ea3beb53cb2,0xbeabbdec3e70be88,0xbea33e1fbcb2beb5,0x3decbeab3e883e70,0xbe6c3e89bcd5beb5,0xbe89be6c3eb5bcd5,0xbe89be6c3eb5bcd5,0x3e6cbe893cd53eb5,0xbeadbddb3eb4bcf8,0xbe27bea13e8b3e69,0x3ddbbead3cf83eb4,0x3ea1be27be693e8b
.quad 0x3d0ebeb4bd0e3eb4,0x3d0ebeb4bd0e3eb4,0xbeb4bd0e3eb43d0e,0xbeb4bd0e3eb43d0e,0x3e2fbe9fbd203eb4,0x3eaebdcabe8d3e62,0xbe9fbe2f3eb43d20,0xbdcabeae3e623e8d,0x3e8fbe5fbd313eb4,0x3e5f3e8fbeb4bd31,0xbe5fbe8f3eb43d31,0x3e8fbe5fbd313eb4,0x3eafbdb9bd433eb3,0xbe363e9cbe5bbe90,0xbdb9beaf3eb33d43,0x3e9c3e36be903e5b
.quad 0x3eb33d54bd543eb3,0xbeb3bd543d54beb3,0x3d54beb33eb33d54,0xbd543eb3beb3bd54,0x3e9a3e3ebd663eb3,0xbda7beb03e93be54,0x3e3ebe9a3eb33d66,0xbeb03da7be54be93,0x3e503e94bd783eb2,0x3e94be503eb23d78,0x3e94be503eb23d78,0xbe50be943d78beb2,0x3d963eb1bd853eb2,0x3e983e453e4d3e95,0x3eb1bd963eb23d85,0x3e45be983e95be4d
.quad 0x3d0ebeb4bd0e3eb4,0x3d0ebeb4bd0e3eb4,0xbeb4bd0e3eb43d0e,0xbeb4bd0e3eb43d0e,0x3e9f3e2fbeb4bd20,0x3dca3eaebe62be8d,0x3e2fbe9fbd203eb4,0x3eaebdcabe8d3e62,0xbe8f3e5f3d31beb4,0xbe5fbe8f3eb43d31,0x3e5f3e8fbeb4bd31,0xbe8f3e5f3d31beb4,0xbdb9beaf3eb33d43,0x3e9c3e36be903e5b,0xbeaf3db93d43beb3,0x3e36be9c3e5b3e90
.quad 0x3eb33d54bd543eb3,0xbeb3bd543d54beb3,0x3d54beb33eb33d54,0xbd543eb3beb3bd54,0xbe3e3e9abeb3bd66,0x3eb0bda73e543e93,0x3e9a3e3ebd663eb3,0xbda7beb03e93be54,0xbe50be943d78beb2,0xbe943e50beb2bd78,0xbe943e50beb2bd78,0x3e503e94bd783eb2,0x3eb1bd963eb23d85,0x3e45be983e95be4d,0xbd96beb13d85beb2,0xbe98be45be4dbe95
.quad 0xbd0ebeb43d0e3eb4,0xbd0ebeb43d0e3eb4,0x3eb4bd0ebeb43d0e,0x3eb4bd0ebeb43d0e,0x3e2f3e9fbd20beb4,0x3eae3dcabe8dbe62,0xbe9f3e2f3eb4bd20,0xbdca3eae3e62be8d,0xbe8fbe5f3d313eb4,0xbe5f3e8f3eb4bd31,0x3e5fbe8fbeb43d31,0xbe8fbe5f3d313eb4,0x3eaf3db9bd43beb3,0xbe36be9cbe5b3e90,0xbdb93eaf3eb3bd43,0x3e9cbe36be90be5b
.quad 0xbeb33d543d543eb3,0x3eb3bd54bd54beb3,0xbd54beb3beb33d54,0x3d543eb33eb3bd54,0x3e9abe3ebd66beb3,0xbda73eb03e933e54,0x3e3e3e9a3eb3bd66,0xbeb0bda7be543e93,0xbe503e943d783eb2,0xbe94be50beb23d78,0xbe94be50beb23d78,0x3e50be94bd78beb2,0x3d96beb1bd85beb2,0x3e98be453e4dbe95,0x3eb13d963eb2bd85,0x3e453e983e953e4d
.quad 0xbd0ebeb43d0e3eb4,0xbd0ebeb43d0e3eb4,0x3eb4bd0ebeb43d0e,0x3eb4bd0ebeb43d0e,0x3e9fbe2fbeb43d20,0x3dcabeaebe623e8d,0x3e2f3e9fbd20beb4,0x3eae3dcabe8dbe62,0x3e8f3e5fbd31beb4,0x3e5fbe8fbeb43d31,0xbe5f3e8f3eb4bd31,0x3e8f3e5fbd31beb4,0xbdb93eaf3eb3bd43,0x3e9cbe36be90be5b,0xbeafbdb93d433eb3,0x3e363e9c3e5bbe90
.quad 0xbeb33d543d543eb3,0x3eb3bd54bd54beb3,0xbd54beb3beb33d54,0x3d543eb33eb3bd54,0xbe3ebe9abeb33d66,0x3eb03da73e54be93,0x3e9abe3ebd66beb3,0xbda73eb03e933e54,0x3e50be94bd78beb2,0x3e943e503eb2bd78,0x3e943e503eb2bd78,0xbe503e943d783eb2,0x3eb13d963eb2bd85,0x3e453e983e953e4d,0xbd963eb13d853eb2,0xbe983e45be4d3e95
.quad 0x80003eb580003eb5,0x80003eb580003eb5,0x3eb500003eb50000,0x3eb500003eb50000,0xbe113ea6bbd53eb5,0xbea83e04be823e7b,0x3ea63e113eb53bd5,0x3e043ea83e7b3e82,0xbe853e76bc553eb5,0xbe76be85beb5bc55,0x3e763e853eb53c55,0xbe853e76bc553eb5,0xbeab3df0bca03eb5,0x3e1dbea3be71be87,0x3df03eab3eb53ca0,0xbea3be1dbe873e71
.quad 0xbeb5bcd5bcd53eb5,0x3eb53cd53cd5beb5,0xbcd53eb53eb53cd5,0x3cd5beb5beb5bcd5,0xbea0be29bd053eb4,0x3dd63ead3e8bbe67,0xbe293ea03eb43d05,0x3eadbdd6be67be8b,0xbe62be8dbd203eb4,0xbe8d3e623eb43d20,0xbe8d3e623eb43d20,0x3e623e8d3d20beb4,0xbdbdbeafbd3a3eb4,0xbe9dbe343e5d3e8f,0xbeaf3dbd3eb43d3a,0xbe343e9d3e8fbe5d
.quad 0x80003eb580003eb5,0x80003eb580003eb5,0x3eb500003eb50000,0x3eb500003eb50000,0xbea6be11beb5bbd5,0xbe04bea8be7bbe82,0xbe113ea6bbd53eb5,0xbea83e04be823e7b,0x3e85be763c55beb5,0x3e763e853eb53c55,0xbe76be85beb5bc55,0x3e85be763c55beb5,0x3df03eab3eb53ca0,0xbea3be1dbe873e71,0x3eabbdf03ca0beb5,0xbe1d3ea33e713e87
.quad 0xbeb5bcd5bcd53eb5,0x3eb53cd53cd5beb5,0xbcd53eb53eb53cd5,0x3cd5beb5beb5bcd5,0x3e29bea0beb4bd05,0xbead3dd63e673e8b,0xbea0be29bd053eb4,0x3dd63ead3e8bbe67,0x3e623e8d3d20beb4,0x3e8dbe62beb4bd20,0x3e8dbe62beb4bd20,0xbe62be8dbd203eb4,0xbeaf3dbd3eb43d3a,0xbe343e9d3e8fbe5d,0x3dbd3eaf3d3abeb4,0x3e9d3e34be5dbe8f
.quad 0x3eb500003eb5,0x3eb500003eb5,0xbeb50000beb50000,0xbeb50000beb50000,0xbe11bea6bbd5beb5,0xbea8be04be82be7b,0x3ea6be113eb5bbd5,0x3e04bea83e7bbe82,0x3e853e763c553eb5,0x3e76be853eb5bc55,0xbe763e85beb53c55,0x3e853e763c553eb5,0xbeabbdf0bca0beb5,0x3e1d3ea3be713e87,0x3df0beab3eb5bca0,0xbea33e1dbe87be71
.quad 0x3eb5bcd53cd53eb5,0xbeb53cd5bcd5beb5,0x3cd53eb5beb53cd5,0xbcd5beb53eb5bcd5,0xbea03e29bd05beb4,0x3dd6bead3e8b3e67,0xbe29bea03eb4bd05,0x3ead3dd6be673e8b,0x3e62be8d3d203eb4,0x3e8d3e62beb43d20,0x3e8d3e62beb43d20,0xbe623e8dbd20beb4,0xbdbd3eafbd3abeb4,0xbe9d3e343e5dbe8f,0xbeafbdbd3eb4bd3a,0xbe34be9d3e8f3e5d
.quad 0x3eb500003eb5,0x3eb500003eb5,0xbeb50000beb50000,0xbeb50000beb50000,0xbea63e11beb53bd5,0xbe043ea8be7b3e82,0xbe11bea6bbd5beb5,0xbea8be04be82be7b,0xbe85be76bc55beb5,0xbe763e85beb53c55,0x3e76be853eb5bc55,0xbe85be76bc55beb5,0x3df0beab3eb5bca0,0xbea33e1dbe87be71,0x3eab3df03ca03eb5,0xbe1dbea33e71be87
.quad 0x3eb5bcd53cd53eb5,0xbeb53cd5bcd5beb5,0x3cd53eb5beb53cd5,0xbcd5beb53eb5bcd5,0x3e293ea0beb43d05,0xbeadbdd63e67be8b,0xbea03e29bd05beb4,0x3dd6bead3e8b3e67,0xbe623e8dbd20beb4,0xbe8dbe623eb4bd20,0xbe8dbe623eb4bd20,0x3e62be8d3d203eb4,0xbeafbdbd3eb4bd3a,0xbe34be9d3e8f3e5d,0x3dbdbeaf3d3a3eb4,0x3e9dbe34be5d3e8f
.quad 0x3d54beb3bd543eb3,0x3d54beb3bd543eb3,0xbeb3bd543eb33d54,0xbeb3bd543eb33d54,0x3e40be9abd6f3eb3,0x3eb0bda3be933e52,0xbe9abe403eb33d6f,0xbda3beb03e523e93,0x3e95be4dbd853eb2,0x3e4d3e95beb2bd85,0xbe4dbe953eb23d85,0x3e95be4dbd853eb2,0x3eb2bd89bd923eb1,0xbe4b3e96be47be97,0xbd89beb23eb13d92,0x3e963e4bbe973e47
.quad 0x3eb13d9fbd9f3eb1,0xbeb1bd9f3d9fbeb1,0x3d9fbeb13eb13d9f,0xbd9f3eb1beb1bd9f,0x3e923e56bdac3eb0,0xbd5dbeb33e9bbe3c,0x3e56be923eb03dac,0xbeb33d5dbe3cbe9b,0x3e363e9cbdb93eaf,0x3e9cbe363eaf3db9,0x3e9cbe363eaf3db9,0xbe36be9c3db9beaf,0x3d283eb4bdc53eae,0x3e8e3e603e313e9e,0x3eb4bd283eae3dc5,0x3e60be8e3e9ebe31
.quad 0x3d54beb3bd543eb3,0x3d54beb3bd543eb3,0xbeb3bd543eb33d54,0xbeb3bd543eb33d54,0x3e9a3e40beb3bd6f,0x3da33eb0be52be93,0x3e40be9abd6f3eb3,0x3eb0bda3be933e52,0xbe953e4d3d85beb2,0xbe4dbe953eb23d85,0x3e4d3e95beb2bd85,0xbe953e4d3d85beb2,0xbd89beb23eb13d92,0x3e963e4bbe973e47,0xbeb23d893d92beb1,0x3e4bbe963e473e97
.quad 0x3eb13d9fbd9f3eb1,0xbeb1bd9f3d9fbeb1,0x3d9fbeb13eb13d9f,0xbd9f3eb1beb1bd9f,0xbe563e92beb0bdac,0x3eb3bd5d3e3c3e9b,0x3e923e56bdac3eb0,0xbd5dbeb33e9bbe3c,0xbe36be9c3db9beaf,0xbe9c3e36beafbdb9,0xbe9c3e36beafbdb9,0x3e363e9cbdb93eaf,0x3eb4bd283eae3dc5,0x3e60be8e3e9ebe31,0xbd28beb43dc5beae,0xbe8ebe60be31be9e
.quad 0xbd54beb33d543eb3,0xbd54beb33d543eb3,0x3eb3bd54beb33d54,0x3eb3bd54beb33d54,0x3e403e9abd6fbeb3,0x3eb03da3be93be52,0xbe9a3e403eb3bd6f,0xbda33eb03e52be93,0xbe95be4d3d853eb2,0xbe4d3e953eb2bd85,0x3e4dbe95beb23d85,0xbe95be4d3d853eb2,0x3eb23d89bd92beb1,0xbe4bbe96be473e97,0xbd893eb23eb1bd92,0x3e96be4bbe97be47
.quad 0xbeb13d9f3d9f3eb1,0x3eb1bd9fbd9fbeb1,0xbd9fbeb1beb13d9f,0x3d9f3eb13eb1bd9f,0x3e92be56bdacbeb0,0xbd5d3eb33e9b3e3c,0x3e563e923eb0bdac,0xbeb3bd5dbe3c3e9b,0xbe363e9c3db93eaf,0xbe9cbe36beaf3db9,0xbe9cbe36beaf3db9,0x3e36be9cbdb9beaf,0x3d28beb4bdc5beae,0x3e8ebe603e31be9e,0x3eb43d283eaebdc5,0x3e603e8e3e9e3e31
.quad 0xbd54beb33d543eb3,0xbd54beb33d543eb3,0x3eb3bd54beb33d54,0x3eb3bd54beb33d54,0x3e9abe40beb33d6f,0x3da3beb0be523e93,0x3e403e9abd6fbeb3,0x3eb03da3be93be52,0x3e953e4dbd85beb2,0x3e4dbe95beb23d85,0xbe4d3e953eb2bd85,0x3e953e4dbd85beb2,0xbd893eb23eb1bd92,0x3e96be4bbe97be47,0xbeb2bd893d923eb1,0x3e4b3e963e47be97
.quad 0xbeb13d9f3d9f3eb1,0x3eb1bd9fbd9fbeb1,0xbd9fbeb1beb13d9f,0x3d9f3eb13eb1bd9f,0xbe56be92beb03dac,0x3eb33d5d3e3cbe9b,0x3e92be56bdacbeb0,0xbd5d3eb33e9b3e3c,0x3e36be9cbdb9beaf,0x3e9c3e363eafbdb9,0x3e9c3e363eafbdb9,0xbe363e9c3db93eaf,0x3eb43d283eaebdc5,0x3e603e8e3e9e3e31,0xbd283eb43dc53eae,0xbe8e3e60be313e9e
.quad 0x80003eb580003eb5,0x80003eb580003eb5,0x3eb500003eb50000,0x3eb500003eb50000,0xbe133ea5bc0e3eb5,0xbea93e02be833e7a,0x3ea53e133eb53c0e,0x3e023ea93e7a3e83,0xbe863e73bc8e3eb5,0xbe73be86beb5bc8e,0x3e733e863eb53c8e,0xbe863e73bc8e3eb5,0xbeac3de3bcd53eb5,0x3e23bea2be6cbe89,0x3de33eac3eb53cd5,0xbea2be23be893e6c
.quad 0xbeb4bd0ebd0e3eb4,0x3eb43d0e3d0ebeb4,0xbd0e3eb43eb43d0e,0x3d0ebeb4beb4bd0e,0xbe9ebe32bd313eb4,0x3dc13eae3e8fbe5f,0xbe323e9e3eb43d31,0x3eaebdc1be5fbe8f,0xbe58be91bd543eb3,0xbe913e583eb33d54,0xbe913e583eb33d54,0x3e583e913d54beb3,0xbd9fbeb1bd783eb2,0xbe99be423e503e94,0xbeb13d9f3eb23d78,0xbe423e993e94be50
.quad 0x80003eb580003eb5,0x80003eb580003eb5,0x3eb500003eb50000,0x3eb500003eb50000,0xbea5be13beb5bc0e,0xbe02bea9be7abe83,0xbe133ea5bc0e3eb5,0xbea93e02be833e7a,0x3e86be733c8ebeb5,0x3e733e863eb53c8e,0xbe73be86beb5bc8e,0x3e86be733c8ebeb5,0x3de33eac3eb53cd5,0xbea2be23be893e6c,0x3eacbde33cd5beb5,0xbe233ea23e6c3e89
.quad 0xbeb4bd0ebd0e3eb4,0x3eb43d0e3d0ebeb4,0xbd0e3eb43eb43d0e,0x3d0ebeb4beb4bd0e,0x3e32be9ebeb4bd31,0xbeae3dc13e5f3e8f,0xbe9ebe32bd313eb4,0x3dc13eae3e8fbe5f,0x3e583e913d54beb3,0x3e91be58beb3bd54,0x3e91be58beb3bd54,0xbe58be91bd543eb3,0xbeb13d9f3eb23d78,0xbe423e993e94be50,0x3d9f3eb13d78beb2,0x3e993e42be50be94
.quad 0x3eb500003eb5,0x3eb500003eb5,0xbeb50000beb50000,0xbeb50000beb50000,0xbe13bea5bc0ebeb5,0xbea9be02be83be7a,0x3ea5be133eb5bc0e,0x3e02bea93e7abe83,0x3e863e733c8e3eb5,0x3e73be863eb5bc8e,0xbe733e86beb53c8e,0x3e863e733c8e3eb5,0xbeacbde3bcd5beb5,0x3e233ea2be6c3e89,0x3de3beac3eb5bcd5,0xbea23e23be89be6c
.quad 0x3eb4bd0e3d0e3eb4,0xbeb43d0ebd0ebeb4,0x3d0e3eb4beb43d0e,0xbd0ebeb43eb4bd0e,0xbe9e3e32bd31beb4,0x3dc1beae3e8f3e5f,0xbe32be9e3eb4bd31,0x3eae3dc1be5f3e8f,0x3e58be913d543eb3,0x3e913e58beb33d54,0x3e913e58beb33d54,0xbe583e91bd54beb3,0xbd9f3eb1bd78beb2,0xbe993e423e50be94,0xbeb1bd9f3eb2bd78,0xbe42be993e943e50
.quad 0x3eb500003eb5,0x3eb500003eb5,0xbeb50000beb50000,0xbeb50000beb50000,0xbea53e13beb53c0e,0xbe023ea9be7a3e83,0xbe13bea5bc0ebeb5,0xbea9be02be83be7a,0xbe86be73bc8ebeb5,0xbe733e86beb53c8e,0x3e73be863eb5bc8e,0xbe86be73bc8ebeb5,0x3de3beac3eb5bcd5,0xbea23e23be89be6c,0x3eac3de33cd53eb5,0xbe23bea23e6cbe89
.quad 0x3eb4bd0e3d0e3eb4,0xbeb43d0ebd0ebeb4,0x3d0e3eb4beb43d0e,0xbd0ebeb43eb4bd0e,0x3e323e9ebeb43d31,0xbeaebdc13e5fbe8f,0xbe9e3e32bd31beb4,0x3dc1beae3e8f3e5f,0xbe583e91bd54beb3,0xbe91be583eb3bd54,0xbe91be583eb3bd54,0x3e58be913d543eb3,0xbeb1bd9f3eb2bd78,0xbe42be993e943e50,0x3d9fbeb13d783eb2,0x3e99be42be503e94
.quad 0x3d8dbeb2bd8d3eb2,0x3d8dbeb2bd8d3eb2,0xbeb2bd8d3eb23d8d,0xbeb2bd8d3eb23d8d,0x3e50be94bd9f3eb1,0x3eb2bd78be993e42,0xbe94be503eb13d9f,0xbd78beb23e423e99,0x3e9bbe3abdb03eb0,0x3e3a3e9bbeb0bdb0,0xbe3abe9b3eb03db0,0x3e9bbe3abdb03eb0,0x3eb4bd31bdc13eae,0xbe5f3e8fbe32be9e,0xbd31beb43eae3dc1,0x3e8f3e5fbe9e3e32
.quad 0x3ead3dd2bdd23ead,0xbeadbdd23dd2bead,0x3dd2bead3ead3dd2,0xbdd23eadbeadbdd2,0x3e893e6cbde33eac,0xbcd5beb53ea2be23,0x3e6cbe893eac3de3,0xbeb53cd5be23bea2,0x3e1b3ea4bdf43eaa,0x3ea4be1b3eaa3df4,0x3ea4be1b3eaa3df4,0xbe1bbea43df4beaa,0x3c0e3eb5be023ea9,0x3e833e7a3e133ea5,0x3eb5bc0e3ea93e02,0x3e7abe833ea5be13
.quad 0x3d8dbeb2bd8d3eb2,0x3d8dbeb2bd8d3eb2,0xbeb2bd8d3eb23d8d,0xbeb2bd8d3eb23d8d,0x3e943e50beb1bd9f,0x3d783eb2be42be99,0x3e50be94bd9f3eb1,0x3eb2bd78be993e42,0xbe9b3e3a3db0beb0,0xbe3abe9b3eb03db0,0x3e3a3e9bbeb0bdb0,0xbe9b3e3a3db0beb0,0xbd31beb43eae3dc1,0x3e8f3e5fbe9e3e32,0xbeb43d313dc1beae,0x3e5fbe8f3e323e9e
.quad 0x3ead3dd2bdd23ead,0xbeadbdd23dd2bead,0x3dd2bead3ead3dd2,0xbdd23eadbeadbdd2,0xbe6c3e89beacbde3,0x3eb5bcd53e233ea2,0x3e893e6cbde33eac,0xbcd5beb53ea2be23,0xbe1bbea43df4beaa,0xbea43e1bbeaabdf4,0xbea43e1bbeaabdf4,0x3e1b3ea4bdf43eaa,0x3eb5bc0e3ea93e02,0x3e7abe833ea5be13,0xbc0ebeb53e02bea9,0xbe83be7abe13bea5
.quad 0xbd8dbeb23d8d3eb2,0xbd8dbeb23d8d3eb2,0x3eb2bd8dbeb23d8d,0x3eb2bd8dbeb23d8d,0x3e503e94bd9fbeb1,0x3eb23d78be99be42,0xbe943e503eb1bd9f,0xbd783eb23e42be99,0xbe9bbe3a3db03eb0,0xbe3a3e9b3eb0bdb0,0x3e3abe9bbeb03db0,0xbe9bbe3a3db03eb0,0x3eb43d31bdc1beae,0xbe5fbe8fbe323e9e,0xbd313eb43eaebdc1,0x3e8fbe5fbe9ebe32
.quad 0xbead3dd23dd23ead,0x3eadbdd2bdd2bead,0xbdd2beadbead3dd2,0x3dd23ead3eadbdd2,0x3e89be6cbde3beac,0xbcd53eb53ea23e23,0x3e6c3e893eacbde3,0xbeb5bcd5be233ea2,0xbe1b3ea43df43eaa,0xbea4be1bbeaa3df4,0xbea4be1bbeaa3df4,0x3e1bbea4bdf4beaa,0x3c0ebeb5be02bea9,0x3e83be7a3e13bea5,0x3eb53c0e3ea9be02,0x3e7a3e833ea53e13
.quad 0xbd8dbeb23d8d3eb2,0xbd8dbeb23d8d3eb2,0x3eb2bd8dbeb23d8d,0x3eb2bd8dbeb23d8d,0x3e94be50beb13d9f,0x3d78beb2be423e99,0x3e503e94bd9fbeb1,0x3eb23d78be99be42,0x3e9b3e3abdb0beb0,0x3e3abe9bbeb03db0,0xbe3a3e9b3eb0bdb0,0x3e9b3e3abdb0beb0,0xbd313eb43eaebdc1,0x3e8fbe5fbe9ebe32,0xbeb4bd313dc13eae,0x3e5f3e8f3e32be9e
.quad 0xbead3dd23dd23ead,0x3eadbdd2bdd2bead,0xbdd2beadbead3dd2,0x3dd23ead3eadbdd2,0xbe6cbe89beac3de3,0x3eb53cd53e23bea2,0x3e89be6cbde3beac,0xbcd53eb53ea23e23,0x3e1bbea4bdf4beaa,0x3ea43e1b3eaabdf4,0x3ea43e1b3eaabdf4,0xbe1b3ea43df43eaa,0x3eb53c0e3ea9be02,0x3e7a3e833ea53e13,0xbc0e3eb53e023ea9,0xbe833e7abe133ea5
.quad 0x80003eb580003eb5,0x80003eb580003eb5,0x3eb500003eb50000,0x3eb500003eb50000,0xbe153ea5bc323eb5,0xbea93e00be843e78,0x3ea53e153eb53c32,0x3e003ea93e783e84,0xbe883e70bcb23eb5,0xbe70be88beb5bcb2,0x3e703e883eb53cb2,0xbe883e70bcb23eb5,0xbead3dd6bd053eb4,0x3e29bea0be67be8b,0x3dd63ead3eb43d05,0xbea0be29be8b3e67
.quad 0xbeb4bd31bd313eb4,0x3eb43d313d31beb4,0xbd313eb43eb43d31,0x3d31beb4beb4bd31,0xbe9bbe3cbd5d3eb3,0x3dac3eb03e92be56,0xbe3c3e9b3eb33d5d,0x3eb0bdacbe56be92,0xbe4dbe95bd853eb2,0xbe953e4d3eb23d85,0xbe953e4d3eb23d85,0x3e4d3e953d85beb2,0xbd80beb2bd9a3eb1,0xbe95be4f3e443e98,0xbeb23d803eb13d9a,0xbe4f3e953e98be44
.quad 0x80003eb580003eb5,0x80003eb580003eb5,0x3eb500003eb50000,0x3eb500003eb50000,0xbea5be15beb5bc32,0xbe00bea9be78be84,0xbe153ea5bc323eb5,0xbea93e00be843e78,0x3e88be703cb2beb5,0x3e703e883eb53cb2,0xbe70be88beb5bcb2,0x3e88be703cb2beb5,0x3dd63ead3eb43d05,0xbea0be29be8b3e67,0x3eadbdd63d05beb4,0xbe293ea03e673e8b
.quad 0xbeb4bd31bd313eb4,0x3eb43d313d31beb4,0xbd313eb43eb43d31,0x3d31beb4beb4bd31,0x3e3cbe9bbeb3bd5d,0xbeb03dac3e563e92,0xbe9bbe3cbd5d3eb3,0x3dac3eb03e92be56,0x3e4d3e953d85beb2,0x3e95be4dbeb2bd85,0x3e95be4dbeb2bd85,0xbe4dbe95bd853eb2,0xbeb23d803eb13d9a,0xbe4f3e953e98be44,0x3d803eb23d9abeb1,0x3e953e4fbe44be98
.quad 0x3eb500003eb5,0x3eb500003eb5,0xbeb50000beb50000,0xbeb50000beb50000,0xbe15bea5bc32beb5,0xbea9be00be84be78,0x3ea5be153eb5bc32,0x3e00bea93e78be84,0x3e883e703cb23eb5,0x3e70be883eb5bcb2,0xbe703e88beb53cb2,0x3e883e703cb23eb5,0xbeadbdd6bd05beb4,0x3e293ea0be673e8b,0x3dd6bead3eb4bd05,0xbea03e29be8bbe67
.quad 0x3eb4bd313d313eb4,0xbeb43d31bd31beb4,0x3d313eb4beb43d31,0xbd31beb43eb4bd31,0xbe9b3e3cbd5dbeb3,0x3dacbeb03e923e56,0xbe3cbe9b3eb3bd5d,0x3eb03dacbe563e92,0x3e4dbe953d853eb2,0x3e953e4dbeb23d85,0x3e953e4dbeb23d85,0xbe4d3e95bd85beb2,0xbd803eb2bd9abeb1,0xbe953e4f3e44be98,0xbeb2bd803eb1bd9a,0xbe4fbe953e983e44
.quad 0x3eb500003eb5,0x3eb500003eb5,0xbeb50000beb50000,0xbeb50000beb50000,0xbea53e15beb53c32,0xbe003ea9be783e84,0xbe15bea5bc32beb5,0xbea9be00be84be78,0xbe88be70bcb2beb5,0xbe703e88beb53cb2,0x3e70be883eb5bcb2,0xbe88be70bcb2beb5,0x3dd6bead3eb4bd05,0xbea03e29be8bbe67,0x3ead3dd63d053eb4,0xbe29bea03e67be8b
.quad 0x3eb4bd313d313eb4,0xbeb43d31bd31beb4,0x3d313eb4beb43d31,0xbd31beb43eb4bd31,0x3e3c3e9bbeb33d5d,0xbeb0bdac3e56be92,0xbe9b3e3cbd5dbeb3,0x3dacbeb03e923e56,0xbe4d3e95bd85beb2,0xbe95be4d3eb2bd85,0xbe95be4d3eb2bd85,0x3e4dbe953d853eb2,0xbeb2bd803eb1bd9a,0xbe4fbe953e983e44,0x3d80beb23d9a3eb1,0x3e95be4fbe443e98
.quad 0x3db0beb0bdb03eb0,0x3db0beb0bdb03eb0,0xbeb0bdb03eb03db0,0xbeb0bdb03eb03db0,0x3e60be8ebdc53eae,0x3eb4bd28be9e3e31,0xbe8ebe603eae3dc5,0xbd28beb43e313e9e,0x3ea1be27bddb3ead,0x3e273ea1beadbddb,0xbe27bea13ead3ddb,0x3ea1be27bddb3ead,0x3eb5bca0bdf03eab,0xbe713e87be1dbea3,0xbca0beb53eab3df0,0x3e873e71bea33e1d
.quad 0x3ea93e02be023ea9,0xbea9be023e02bea9,0x3e02bea93ea93e02,0xbe023ea9bea9be02,0x3e7e3e81be0d3ea7,0x3b0ebeb53ea8be08,0x3e81be7e3ea73e0d,0xbeb5bb0ebe08bea8,0x3dfc3eaabe173ea5,0x3eaabdfc3ea53e17,0x3eaabdfc3ea53e17,0xbdfcbeaa3e17bea5,0xbcc33eb5be213ea2,0x3e6e3e883de73eac,0x3eb53cc33ea23e21,0x3e88be6e3eacbde7
.quad 0x3db0beb0bdb03eb0,0x3db0beb0bdb03eb0,0xbeb0bdb03eb03db0,0xbeb0bdb03eb03db0,0x3e8e3e60beaebdc5,0x3d283eb4be31be9e,0x3e60be8ebdc53eae,0x3eb4bd28be9e3e31,0xbea13e273ddbbead,0xbe27bea13ead3ddb,0x3e273ea1beadbddb,0xbea13e273ddbbead,0xbca0beb53eab3df0,0x3e873e71bea33e1d,0xbeb53ca03df0beab,0x3e71be873e1d3ea3
.quad 0x3ea93e02be023ea9,0xbea9be023e02bea9,0x3e02bea93ea93e02,0xbe023ea9bea9be02,0xbe813e7ebea7be0d,0x3eb53b0e3e083ea8,0x3e7e3e81be0d3ea7,0x3b0ebeb53ea8be08,0xbdfcbeaa3e17bea5,0xbeaa3dfcbea5be17,0xbeaa3dfcbea5be17,0x3dfc3eaabe173ea5,0x3eb53cc33ea23e21,0x3e88be6e3eacbde7,0x3cc3beb53e21bea2,0xbe6ebe88bde7beac
.quad 0xbdb0beb03db03eb0,0xbdb0beb03db03eb0,0x3eb0bdb0beb03db0,0x3eb0bdb0beb03db0,0x3e603e8ebdc5beae,0x3eb43d28be9ebe31,0xbe8e3e603eaebdc5,0xbd283eb43e31be9e,0xbea1be273ddb3ead,0xbe273ea13eadbddb,0x3e27bea1bead3ddb,0xbea1be273ddb3ead,0x3eb53ca0bdf0beab,0xbe71be87be1d3ea3,0xbca03eb53eabbdf0,0x3e87be71bea3be1d
.quad 0xbea93e023e023ea9,0x3ea9be02be02bea9,0xbe02bea9bea93e02,0x3e023ea93ea9be02,0x3e7ebe81be0dbea7,0x3b0e3eb53ea83e08,0x3e813e7e3ea7be0d,0xbeb53b0ebe083ea8,0xbdfc3eaa3e173ea5,0xbeaabdfcbea53e17,0xbeaabdfcbea53e17,0x3dfcbeaabe17bea5,0xbcc3beb5be21bea2,0x3e6ebe883de7beac,0x3eb5bcc33ea2be21,0x3e883e6e3eac3de7
.quad 0xbdb0beb03db03eb0,0xbdb0beb03db03eb0,0x3eb0bdb0beb03db0,0x3eb0bdb0beb03db0,0x3e8ebe60beae3dc5,0x3d28beb4be313e9e,0x3e603e8ebdc5beae,0x3eb43d28be9ebe31,0x3ea13e27bddbbead,0x3e27bea1bead3ddb,0xbe273ea13eadbddb,0x3ea13e27bddbbead,0xbca03eb53eabbdf0,0x3e87be71bea3be1d,0xbeb5bca03df03eab,0x3e713e873e1dbea3
.quad 0xbea93e023e023ea9,0x3ea9be02be02bea9,0xbe02bea9bea93e02,0x3e023ea93ea9be02,0xbe81be7ebea73e0d,0x3eb5bb0e3e08bea8,0x3e7ebe81be0dbea7,0x3b0e3eb53ea83e08,0x3dfcbeaabe17bea5,0x3eaa3dfc3ea5be17,0x3eaa3dfc3ea5be17,0xbdfc3eaa3e173ea5,0x3eb5bcc33ea2be21,0x3e883e6e3eac3de7,0x3cc33eb53e213ea2,0xbe6e3e88bde73eac
.quad 0x80003eb580003eb5,0x80003eb580003eb5,0x3eb500003eb50000,0x3eb500003eb50000,0xbe173ea5bc553eb5,0xbeaa3dfcbe853e76,0x3ea53e173eb53c55,0x3dfc3eaa3e763e85,0xbe893e6cbcd53eb5,0xbe6cbe89beb5bcd5,0x3e6c3e893eb53cd5,0xbe893e6cbcd53eb5,0xbeae3dcabd203eb4,0x3e2fbe9fbe62be8d,0x3dca3eae3eb43d20,0xbe9fbe2fbe8d3e62
.quad 0xbeb3bd54bd543eb3,0x3eb33d543d54beb3,0xbd543eb33eb33d54,0x3d54beb3beb3bd54,0xbe98be45bd853eb2,0x3d963eb13e95be4d,0xbe453e983eb23d85,0x3eb1bd96be4dbe95,0xbe42be99bd9f3eb1,0xbe993e423eb13d9f,0xbe993e423eb13d9f,0x3e423e993d9fbeb1,0xbd43beb3bdb93eaf,0xbe90be5b3e363e9c,0xbeb33d433eaf3db9,0xbe5b3e903e9cbe36
.quad 0x80003eb580003eb5,0x80003eb580003eb5,0x3eb500003eb50000,0x3eb500003eb50000,0xbea5be17beb5bc55,0xbdfcbeaabe76be85,0xbe173ea5bc553eb5,0xbeaa3dfcbe853e76,0x3e89be6c3cd5beb5,0x3e6c3e893eb53cd5,0xbe6cbe89beb5bcd5,0x3e89be6c3cd5beb5,0x3dca3eae3eb43d20,0xbe9fbe2fbe8d3e62,0x3eaebdca3d20beb4,0xbe2f3e9f3e623e8d
.quad 0xbeb3bd54bd543eb3,0x3eb33d543d54beb3,0xbd543eb33eb33d54,0x3d54beb3beb3bd54,0x3e45be98beb2bd85,0xbeb13d963e4d3e95,0xbe98be45bd853eb2,0x3d963eb13e95be4d,0x3e423e993d9fbeb1,0x3e99be42beb1bd9f,0x3e99be42beb1bd9f,0xbe42be99bd9f3eb1,0xbeb33d433eaf3db9,0xbe5b3e903e9cbe36,0x3d433eb33db9beaf,0x3e903e5bbe36be9c
.quad 0x3eb500003eb5,0x3eb500003eb5,0xbeb50000beb50000,0xbeb50000beb50000,0xbe17bea5bc55beb5,0xbeaabdfcbe85be76,0x3ea5be173eb5bc55,0x3dfcbeaa3e76be85,0x3e893e6c3cd53eb5,0x3e6cbe893eb5bcd5,0xbe6c3e89beb53cd5,0x3e893e6c3cd53eb5,0xbeaebdcabd20beb4,0x3e2f3e9fbe623e8d,0x3dcabeae3eb4bd20,0xbe9f3e2fbe8dbe62
.quad 0x3eb3bd543d543eb3,0xbeb33d54bd54beb3,0x3d543eb3beb33d54,0xbd54beb33eb3bd54,0xbe983e45bd85beb2,0x3d96beb13e953e4d,0xbe45be983eb2bd85,0x3eb13d96be4d3e95,0x3e42be993d9f3eb1,0x3e993e42beb13d9f,0x3e993e42beb13d9f,0xbe423e99bd9fbeb1,0xbd433eb3bdb9beaf,0xbe903e5b3e36be9c,0xbeb3bd433eafbdb9,0xbe5bbe903e9c3e36
.quad 0x3eb500003eb5,0x3eb500003eb5,0xbeb50000beb50000,0xbeb50000beb50000,0xbea53e17beb53c55,0xbdfc3eaabe763e85,0xbe17bea5bc55beb5,0xbeaabdfcbe85be76,0xbe89be6cbcd5beb5,0xbe6c3e89beb53cd5,0x3e6cbe893eb5bcd5,0xbe89be6cbcd5beb5,0x3dcabeae3eb4bd20,0xbe9f3e2fbe8dbe62,0x3eae3dca3d203eb4,0xbe2fbe9f3e62be8d
.quad 0x3eb3bd543d543eb3,0xbeb33d54bd54beb3,0x3d543eb3beb33d54,0xbd54beb33eb3bd54,0x3e453e98beb23d85,0xbeb1bd963e4dbe95,0xbe983e45bd85beb2,0x3d96beb13e953e4d,0xbe423e99bd9fbeb1,0xbe99be423eb1bd9f,0xbe99be423eb1bd9f,0x3e42be993d9f3eb1,0xbeb3bd433eafbdb9,0xbe5bbe903e9c3e36,0x3d43beb33db93eaf,0x3e90be5bbe363e9c
.quad 0x3dd2beadbdd23ead,0x3dd2beadbdd23ead,0xbeadbdd23ead3dd2,0xbeadbdd23ead3dd2,0x3e70be88bdec3eab,0x3eb5bcb2bea33e1f,0xbe88be703eab3dec,0xbcb2beb53e1f3ea3,0x3ea5be13be023ea9,0x3e133ea5bea9be02,0xbe13bea53ea93e02,0x3ea5be13be023ea9,0x3eb53b8ebe0f3ea6,0xbe823e7dbe06bea8,0x3b8ebeb53ea63e0f,0x3e7d3e82bea83e06
.quad 0x3ea43e1bbe1b3ea4,0xbea4be1b3e1bbea4,0x3e1bbea43ea43e1b,0xbe1b3ea4bea4be1b,0x3e693e8bbe273ea1,0x3cf8beb43eadbddb,0x3e8bbe693ea13e27,0xbeb4bcf8bddbbead,0x3dc13eaebe323e9e,0x3eaebdc13e9e3e32,0x3eaebdc13e9e3e32,0xbdc1beae3e32be9e,0xbd663eb3be3e3e9a,0x3e543e933da73eb0,0x3eb33d663e9a3e3e,0x3e93be543eb0bda7
.quad 0x3dd2beadbdd23ead,0x3dd2beadbdd23ead,0xbeadbdd23ead3dd2,0xbeadbdd23ead3dd2,0x3e883e70beabbdec,0x3cb23eb5be1fbea3,0x3e70be88bdec3eab,0x3eb5bcb2bea33e1f,0xbea53e133e02bea9,0xbe13bea53ea93e02,0x3e133ea5bea9be02,0xbea53e133e02bea9,0x3b8ebeb53ea63e0f,0x3e7d3e82bea83e06,0xbeb5bb8e3e0fbea6,0x3e82be7d3e063ea8
.quad 0x3ea43e1bbe1b3ea4,0xbea4be1b3e1bbea4,0x3e1bbea43ea43e1b,0xbe1b3ea4bea4be1b,0xbe8b3e69bea1be27,0x3eb43cf83ddb3ead,0x3e693e8bbe273ea1,0x3cf8beb43eadbddb,0xbdc1beae3e32be9e,0xbeae3dc1be9ebe32,0xbeae3dc1be9ebe32,0x3dc13eaebe323e9e,0x3eb33d663e9a3e3e,0x3e93be543eb0bda7,0x3d66beb33e3ebe9a,0xbe54be93bda7beb0
.quad 0xbdd2bead3dd23ead,0xbdd2bead3dd23ead,0x3eadbdd2bead3dd2,0x3eadbdd2bead3dd2,0x3e703e88bdecbeab,0x3eb53cb2bea3be1f,0xbe883e703eabbdec,0xbcb23eb53e1fbea3,0xbea5be133e023ea9,0xbe133ea53ea9be02,0x3e13bea5bea93e02,0xbea5be133e023ea9,0x3eb5bb8ebe0fbea6,0xbe82be7dbe063ea8,0x3b8e3eb53ea6be0f,0x3e7dbe82bea8be06
.quad 0xbea43e1b3e1b3ea4,0x3ea4be1bbe1bbea4,0xbe1bbea4bea43e1b,0x3e1b3ea43ea4be1b,0x3e69be8bbe27bea1,0x3cf83eb43ead3ddb,0x3e8b3e693ea1be27,0xbeb43cf8bddb3ead,0xbdc13eae3e323e9e,0xbeaebdc1be9e3e32,0xbeaebdc1be9e3e32,0x3dc1beaebe32be9e,0xbd66beb3be3ebe9a,0x3e54be933da7beb0,0x3eb3bd663e9abe3e,0x3e933e543eb03da7
.quad 0xbdd2bead3dd23ead,0xbdd2bead3dd23ead,0x3eadbdd2bead3dd2,0x3eadbdd2bead3dd2,0x3e88be70beab3dec,0x3cb2beb5be1f3ea3,0x3e703e88bdecbeab,0x3eb53cb2bea3be1f,0x3ea53e13be02bea9,0x3e13bea5bea93e02,0xbe133ea53ea9be02,0x3ea53e13be02bea9,0x3b8e3eb53ea6be0f,0x3e7dbe82bea8be06,0xbeb53b8e3e0f3ea6,0x3e823e7d3e06bea8
.quad 0xbea43e1b3e1b3ea4,0x3ea4be1bbe1bbea4,0xbe1bbea4bea43e1b,0x3e1b3ea43ea4be1b,0xbe8bbe69bea13e27,0x3eb4bcf83ddbbead,0x3e69be8bbe27bea1,0x3cf83eb43ead3ddb,0x3dc1beaebe32be9e,0x3eae3dc13e9ebe32,0x3eae3dc13e9ebe32,0xbdc13eae3e323e9e,0x3eb3bd663e9abe3e,0x3e933e543eb03da7,0x3d663eb33e3e3e9a,0xbe543e93bda73eb0
.quad 0x80003eb580003eb5,0x80003eb580003eb5,0x3eb500003eb50000,0x3eb500003eb50000,0xbe193ea4bc793eb5,0xbeaa3df8be853e75,0x3ea43e193eb53c79,0x3df83eaa3e753e85,0xbe8b3e69bcf83eb4,0xbe69be8bbeb4bcf8,0x3e693e8b3eb43cf8,0xbe8b3e69bcf83eb4,0xbeaf3dbdbd3a3eb4,0x3e34be9dbe5dbe8f,0x3dbd3eaf3eb43d3a,0xbe9dbe34be8f3e5d
.quad 0xbeb2bd78bd783eb2,0x3eb23d783d78beb2,0xbd783eb23eb23d78,0x3d78beb2beb2bd78,0xbe95be4fbd9a3eb1,0x3d803eb23e98be44,0xbe4f3e953eb13d9a,0x3eb2bd80be44be98,0xbe36be9cbdb93eaf,0xbe9c3e363eaf3db9,0xbe9c3e363eaf3db9,0x3e363e9c3db9beaf,0xbd05beb4bdd63ead,0xbe8bbe673e293ea0,0xbeb43d053ead3dd6,0xbe673e8b3ea0be29
.quad 0x80003eb580003eb5,0x80003eb580003eb5,0x3eb500003eb50000,0x3eb500003eb50000,0xbea4be19beb5bc79,0xbdf8beaabe75be85,0xbe193ea4bc793eb5,0xbeaa3df8be853e75,0x3e8bbe693cf8beb4,0x3e693e8b3eb43cf8,0xbe69be8bbeb4bcf8,0x3e8bbe693cf8beb4,0x3dbd3eaf3eb43d3a,0xbe9dbe34be8f3e5d,0x3eafbdbd3d3abeb4,0xbe343e9d3e5d3e8f
.quad 0xbeb2bd78bd783eb2,0x3eb23d783d78beb2,0xbd783eb23eb23d78,0x3d78beb2beb2bd78,0x3e4fbe95beb1bd9a,0xbeb23d803e443e98,0xbe95be4fbd9a3eb1,0x3d803eb23e98be44,0x3e363e9c3db9beaf,0x3e9cbe36beafbdb9,0x3e9cbe36beafbdb9,0xbe36be9cbdb93eaf,0xbeb43d053ead3dd6,0xbe673e8b3ea0be29,0x3d053eb43dd6bead,0x3e8b3e67be29bea0
.quad 0x3eb500003eb5,0x3eb500003eb5,0xbeb50000beb50000,0xbeb50000beb50000,0xbe19bea4bc79beb5,0xbeaabdf8be85be75,0x3ea4be193eb5bc79,0x3df8beaa3e75be85,0x3e8b3e693cf83eb4,0x3e69be8b3eb4bcf8,0xbe693e8bbeb43cf8,0x3e8b3e693cf83eb4,0xbeafbdbdbd3abeb4,0x3e343e9dbe5d3e8f,0x3dbdbeaf3eb4bd3a,0xbe9d3e34be8fbe5d
.quad 0x3eb2bd783d783eb2,0xbeb23d78bd78beb2,0x3d783eb2beb23d78,0xbd78beb23eb2bd78,0xbe953e4fbd9abeb1,0x3d80beb23e983e44,0xbe4fbe953eb1bd9a,0x3eb23d80be443e98,0x3e36be9c3db93eaf,0x3e9c3e36beaf3db9,0x3e9c3e36beaf3db9,0xbe363e9cbdb9beaf,0xbd053eb4bdd6bead,0xbe8b3e673e29bea0,0xbeb4bd053eadbdd6,0xbe67be8b3ea03e29
.quad 0x3eb500003eb5,0x3eb500003eb5,0xbeb50000beb50000,0xbeb50000beb50000,0xbea43e19beb53c79,0xbdf83eaabe753e85,0xbe19bea4bc79beb5,0xbeaabdf8be85be75,0xbe8bbe69bcf8beb4,0xbe693e8bbeb43cf8,0x3e69be8b3eb4bcf8,0xbe8bbe69bcf8beb4,0x3dbdbeaf3eb4bd3a,0xbe9d3e34be8fbe5d,0x3eaf3dbd3d3a3eb4,0xbe34be9d3e5dbe8f
.quad 0x3eb2bd783d783eb2,0xbeb23d78bd78beb2,0x3d783eb2beb23d78,0xbd78beb23eb2bd78,0x3e4f3e95beb13d9a,0xbeb2bd803e44be98,0xbe953e4fbd9abeb1,0x3d80beb23e983e44,0xbe363e9cbdb9beaf,0xbe9cbe363eafbdb9,0xbe9cbe363eafbdb9,0x3e36be9c3db93eaf,0xbeb4bd053eadbdd6,0xbe67be8b3ea03e29,0x3d05beb43dd63ead,0x3e8bbe67be293ea0
.quad 0x3df4beaabdf43eaa,0x3df4beaabdf43eaa,0xbeaabdf43eaa3df4,0xbeaabdf43eaa3df4,0x3e7ebe81be083ea8,0x3eb5bb0ebea73e0d,0xbe81be7e3ea83e08,0xbb0ebeb53e0d3ea7,0x3eaabdfcbe173ea5,0x3dfc3eaabea5be17,0xbdfcbeaa3ea53e17,0x3eaabdfcbe173ea5,0x3eb43ce7be253ea1,0xbe8a3e6bbddfbeac,0x3ce7beb43ea13e25,0x3e6b3e8abeac3ddf
.quad 0x3e9e3e32be323e9e,0xbe9ebe323e32be9e,0x3e32be9e3e9e3e32,0xbe323e9ebe9ebe32,0x3e523e93be403e9a,0x3d6fbeb33eb0bda3,0x3e93be523e9a3e40,0xbeb3bd6fbda3beb0,0x3d853eb2be4d3e95,0x3eb2bd853e953e4d,0x3eb2bd853e953e4d,0xbd85beb23e4dbe95,0xbdb43eafbe593e91,0x3e383e9c3d4c3eb3,0x3eaf3db43e913e59,0x3e9cbe383eb3bd4c
.quad 0x3df4beaabdf43eaa,0x3df4beaabdf43eaa,0xbeaabdf43eaa3df4,0xbeaabdf43eaa3df4,0x3e813e7ebea8be08,0x3b0e3eb5be0dbea7,0x3e7ebe81be083ea8,0x3eb5bb0ebea73e0d,0xbeaa3dfc3e17bea5,0xbdfcbeaa3ea53e17,0x3dfc3eaabea5be17,0xbeaa3dfc3e17bea5,0x3ce7beb43ea13e25,0x3e6b3e8abeac3ddf,0xbeb4bce73e25bea1,0x3e8abe6b3ddf3eac
.quad 0x3e9e3e32be323e9e,0xbe9ebe323e32be9e,0x3e32be9e3e9e3e32,0xbe323e9ebe9ebe32,0xbe933e52be9abe40,0x3eb33d6f3da33eb0,0x3e523e93be403e9a,0x3d6fbeb33eb0bda3,0xbd85beb23e4dbe95,0xbeb23d85be95be4d,0xbeb23d85be95be4d,0x3d853eb2be4d3e95,0x3eaf3db43e913e59,0x3e9cbe383eb3bd4c,0x3db4beaf3e59be91,0xbe38be9cbd4cbeb3
.quad 0xbdf4beaa3df43eaa,0xbdf4beaa3df43eaa,0x3eaabdf4beaa3df4,0x3eaabdf4beaa3df4,0x3e7e3e81be08bea8,0x3eb53b0ebea7be0d,0xbe813e7e3ea8be08,0xbb0e3eb53e0dbea7,0xbeaabdfc3e173ea5,0xbdfc3eaa3ea5be17,0x3dfcbeaabea53e17,0xbeaabdfc3e173ea5,0x3eb4bce7be25bea1,0xbe8abe6bbddf3eac,0x3ce73eb43ea1be25,0x3e6bbe8abeacbddf
.quad 0xbe9e3e323e323e9e,0x3e9ebe32be32be9e,0xbe32be9ebe9e3e32,0x3e323e9e3e9ebe32,0x3e52be93be40be9a,0x3d6f3eb33eb03da3,0x3e933e523e9abe40,0xbeb33d6fbda33eb0,0xbd853eb23e4d3e95,0xbeb2bd85be953e4d,0xbeb2bd85be953e4d,0x3d85beb2be4dbe95,0xbdb4beafbe59be91,0x3e38be9c3d4cbeb3,0x3eafbdb43e91be59,0x3e9c3e383eb33d4c
.quad 0xbdf4beaa3df43eaa,0xbdf4beaa3df43eaa,0x3eaabdf4beaa3df4,0x3eaabdf4beaa3df4,0x3e81be7ebea83e08,0x3b0ebeb5be0d3ea7,0x3e7e3e81be08bea8,0x3eb53b0ebea7be0d,0x3eaa3dfcbe17bea5,0x3dfcbeaabea53e17,0xbdfc3eaa3ea5be17,0x3eaa3dfcbe17bea5,0x3ce73eb43ea1be25,0x3e6bbe8abeacbddf,0xbeb43ce73e253ea1,0x3e8a3e6b3ddfbeac
.quad 0xbe9e3e323e323e9e,0x3e9ebe32be32be9e,0xbe32be9ebe9e3e32,0x3e323e9e3e9ebe32,0xbe93be52be9a3e40,0x3eb3bd6f3da3beb0,0x3e52be93be40be9a,0x3d6f3eb33eb03da3,0x3d85beb2be4dbe95,0x3eb23d853e95be4d,0x3eb23d853e95be4d,0xbd853eb23e4d3e95,0x3eafbdb43e91be59,0x3e9c3e383eb33d4c,0x3db43eaf3e593e91,0xbe383e9cbd4c3eb3
.quad 0x80003eb580003eb5,0x80003eb580003eb5,0x3eb500003eb50000,0x3eb500003eb50000,0xbe1b3ea4bc8e3eb5,0xbeaa3df4be863e73,0x3ea43e1b3eb53c8e,0x3df43eaa3e733e86,0xbe8c3e66bd0e3eb4,0xbe66be8cbeb4bd0e,0x3e663e8c3eb43d0e,0xbe8c3e66bd0e3eb4,0xbeb03db0bd543eb3,0x3e3abe9bbe58be91,0x3db03eb03eb33d54,0xbe9bbe3abe913e58
.quad 0xbeb2bd8dbd8d3eb2,0x3eb23d8d3d8dbeb2,0xbd8d3eb23eb23d8d,0x3d8dbeb2beb2bd8d,0xbe91be58bdb03eb0,0x3d543eb33e9bbe3a,0xbe583e913eb03db0,0x3eb3bd54be3abe9b,0xbe2bbea0bdd23ead,0xbea03e2b3ead3dd2,0xbea03e2b3ead3dd2,0x3e2b3ea03dd2bead,0xbc8ebeb5bdf43eaa,0xbe86be733e1b3ea4,0xbeb53c8e3eaa3df4,0xbe733e863ea4be1b
.quad 0x80003eb580003eb5,0x80003eb580003eb5,0x3eb500003eb50000,0x3eb500003eb50000,0xbea4be1bbeb5bc8e,0xbdf4beaabe73be86,0xbe1b3ea4bc8e3eb5,0xbeaa3df4be863e73,0x3e8cbe663d0ebeb4,0x3e663e8c3eb43d0e,0xbe66be8cbeb4bd0e,0x3e8cbe663d0ebeb4,0x3db03eb03eb33d54,0xbe9bbe3abe913e58,0x3eb0bdb03d54beb3,0xbe3a3e9b3e583e91
.quad 0xbeb2bd8dbd8d3eb2,0x3eb23d8d3d8dbeb2,0xbd8d3eb23eb23d8d,0x3d8dbeb2beb2bd8d,0x3e58be91beb0bdb0,0xbeb33d543e3a3e9b,0xbe91be58bdb03eb0,0x3d543eb33e9bbe3a,0x3e2b3ea03dd2bead,0x3ea0be2bbeadbdd2,0x3ea0be2bbeadbdd2,0xbe2bbea0bdd23ead,0xbeb53c8e3eaa3df4,0xbe733e863ea4be1b,0x3c8e3eb53df4beaa,0x3e863e73be1bbea4
.quad 0x3eb500003eb5,0x3eb500003eb5,0xbeb50000beb50000,0xbeb50000beb50000,0xbe1bbea4bc8ebeb5,0xbeaabdf4be86be73,0x3ea4be1b3eb5bc8e,0x3df4beaa3e73be86,0x3e8c3e663d0e3eb4,0x3e66be8c3eb4bd0e,0xbe663e8cbeb43d0e,0x3e8c3e663d0e3eb4,0xbeb0bdb0bd54beb3,0x3e3a3e9bbe583e91,0x3db0beb03eb3bd54,0xbe9b3e3abe91be58
.quad 0x3eb2bd8d3d8d3eb2,0xbeb23d8dbd8dbeb2,0x3d8d3eb2beb23d8d,0xbd8dbeb23eb2bd8d,0xbe913e58bdb0beb0,0x3d54beb33e9b3e3a,0xbe58be913eb0bdb0,0x3eb33d54be3a3e9b,0x3e2bbea03dd23ead,0x3ea03e2bbead3dd2,0x3ea03e2bbead3dd2,0xbe2b3ea0bdd2bead,0xbc8e3eb5bdf4beaa,0xbe863e733e1bbea4,0xbeb5bc8e3eaabdf4,0xbe73be863ea43e1b
.quad 0x3eb500003eb5,0x3eb500003eb5,0xbeb50000beb50000,0xbeb50000beb50000,0xbea43e1bbeb53c8e,0xbdf43eaabe733e86,0xbe1bbea4bc8ebeb5,0xbeaabdf4be86be73,0xbe8cbe66bd0ebeb4,0xbe663e8cbeb43d0e,0x3e66be8c3eb4bd0e,0xbe8cbe66bd0ebeb4,0x3db0beb03eb3bd54,0xbe9b3e3abe91be58,0x3eb03db03d543eb3,0xbe3abe9b3e58be91
.quad 0x3eb2bd8d3d8d3eb2,0xbeb23d8dbd8dbeb2,0x3d8d3eb2beb23d8d,0xbd8dbeb23eb2bd8d,0x3e583e91beb03db0,0xbeb3bd543e3abe9b,0xbe913e58bdb0beb0,0x3d54beb33e9b3e3a,0xbe2b3ea0bdd2bead,0xbea0be2b3eadbdd2,0xbea0be2b3eadbdd2,0x3e2bbea03dd23ead,0xbeb5bc8e3eaabdf4,0xbe73be863ea43e1b,0x3c8ebeb53df43eaa,0x3e86be73be1b3ea4
.quad 0x3e0bbea7be0b3ea7,0x3e0bbea7be0b3ea7,0xbea7be0b3ea73e0b,0xbea7be0b3ea73e0b,0x3e86be73be1b3ea4,0x3eb53c8ebeaa3df4,0xbe73be863ea43e1b,0x3c8ebeb53df43eaa,0x3eadbdd2be2b3ea0,0x3dd23eadbea0be2b,0xbdd2bead3ea03e2b,0x3eadbdd2be2b3ea0,0x3eb33d54be3a3e9b,0xbe913e58bdb0beb0,0x3d54beb33e9b3e3a,0x3e583e91beb03db0
.quad 0x3e973e49be493e97,0xbe97be493e49be97,0x3e49be973e973e49,0xbe493e97be97be49,0x3e3a3e9bbe583e91,0x3db0beb03eb3bd54,0x3e9bbe3a3e913e58,0xbeb0bdb0bd54beb3,0x3d0e3eb4be663e8c,0x3eb4bd0e3e8c3e66,0x3eb4bd0e3e8c3e66,0xbd0ebeb43e66be8c,0xbdf43eaabe733e86,0x3e1b3ea43c8e3eb5,0x3eaa3df43e863e73,0x3ea4be1b3eb5bc8e
.quad 0x3e0bbea7be0b3ea7,0x3e0bbea7be0b3ea7,0xbea7be0b3ea73e0b,0xbea7be0b3ea73e0b,0x3e733e86bea4be1b,0xbc8e3eb5bdf4beaa,0x3e86be73be1b3ea4,0x3eb53c8ebeaa3df4,0xbead3dd23e2bbea0,0xbdd2bead3ea03e2b,0x3dd23eadbea0be2b,0xbead3dd23e2bbea0,0x3d54beb33e9b3e3a,0x3e583e91beb03db0,0xbeb3bd543e3abe9b,0x3e91be583db03eb0
.quad 0x3e973e49be493e97,0xbe97be493e49be97,0x3e49be973e973e49,0xbe493e97be97be49,0xbe9b3e3abe91be58,0x3eb03db03d543eb3,0x3e3a3e9bbe583e91,0x3db0beb03eb3bd54,0xbd0ebeb43e66be8c,0xbeb43d0ebe8cbe66,0xbeb43d0ebe8cbe66,0x3d0e3eb4be663e8c,0x3eaa3df43e863e73,0x3ea4be1b3eb5bc8e,0x3df4beaa3e73be86,0xbe1bbea4bc8ebeb5
.quad 0xbe0bbea73e0b3ea7,0xbe0bbea73e0b3ea7,0x3ea7be0bbea73e0b,0x3ea7be0bbea73e0b,0x3e863e73be1bbea4,0x3eb5bc8ebeaabdf4,0xbe733e863ea4be1b,0x3c8e3eb53df4beaa,0xbeadbdd23e2b3ea0,0xbdd23ead3ea0be2b,0x3dd2beadbea03e2b,0xbeadbdd23e2b3ea0,0x3eb3bd54be3abe9b,0xbe91be58bdb03eb0,0x3d543eb33e9bbe3a,0x3e58be91beb0bdb0
.quad 0xbe973e493e493e97,0x3e97be49be49be97,0xbe49be97be973e49,0x3e493e973e97be49,0x3e3abe9bbe58be91,0x3db03eb03eb33d54,0x3e9b3e3a3e91be58,0xbeb03db0bd543eb3,0xbd0e3eb43e663e8c,0xbeb4bd0ebe8c3e66,0xbeb4bd0ebe8c3e66,0x3d0ebeb4be66be8c,0xbdf4beaabe73be86,0x3e1bbea43c8ebeb5,0x3eaabdf43e86be73,0x3ea43e1b3eb53c8e
.quad 0xbe0bbea73e0b3ea7,0xbe0bbea73e0b3ea7,0x3ea7be0bbea73e0b,0x3ea7be0bbea73e0b,0x3e73be86bea43e1b,0xbc8ebeb5bdf43eaa,0x3e863e73be1bbea4,0x3eb5bc8ebeaabdf4,0x3ead3dd2be2bbea0,0x3dd2beadbea03e2b,0xbdd23ead3ea0be2b,0x3ead3dd2be2bbea0,0x3d543eb33e9bbe3a,0x3e58be91beb0bdb0,0xbeb33d543e3a3e9b,0x3e913e583db0beb0
.quad 0xbe973e493e493e97,0x3e97be49be49be97,0xbe49be97be973e49,0x3e493e973e97be49,0xbe9bbe3abe913e58,0x3eb0bdb03d54beb3,0x3e3abe9bbe58be91,0x3db03eb03eb33d54,0x3d0ebeb4be66be8c,0x3eb43d0e3e8cbe66,0x3eb43d0e3e8cbe66,0xbd0e3eb43e663e8c,0x3eaabdf43e86be73,0x3ea43e1b3eb53c8e,0x3df43eaa3e733e86,0xbe1b3ea4bc8e3eb5
.quad 0x80003eb580003eb5,0x80003eb580003eb5,0x3eb500003eb50000,0x3eb500003eb50000,0xbe1d3ea3bca03eb5,0xbeab3df0be873e71,0x3ea33e1d3eb53ca0,0x3df03eab3e713e87,0xbe8d3e62bd203eb4,0xbe62be8dbeb4bd20,0x3e623e8d3eb43d20,0xbe8d3e62bd203eb4,0xbeb03da3bd6f3eb3,0x3e40be9abe52be93,0x3da33eb03eb33d6f,0xbe9abe40be933e52
.quad 0xbeb1bd9fbd9f3eb1,0x3eb13d9f3d9fbeb1,0xbd9f3eb13eb13d9f,0x3d9fbeb1beb1bd9f,0xbe8ebe60bdc53eae,0x3d283eb43e9ebe31,0xbe603e8e3eae3dc5,0x3eb4bd28be31be9e,0xbe1fbea3bdec3eab,0xbea33e1f3eab3dec,0xbea33e1f3eab3dec,0x3e1f3ea33decbeab,0xbb0ebeb5be083ea8,0xbe81be7e3e0d3ea7,0xbeb53b0e3ea83e08,0xbe7e3e813ea7be0d
.quad 0x80003eb580003eb5,0x80003eb580003eb5,0x3eb500003eb50000,0x3eb500003eb50000,0xbea3be1dbeb5bca0,0xbdf0beabbe71be87,0xbe1d3ea3bca03eb5,0xbeab3df0be873e71,0x3e8dbe623d20beb4,0x3e623e8d3eb43d20,0xbe62be8dbeb4bd20,0x3e8dbe623d20beb4,0x3da33eb03eb33d6f,0xbe9abe40be933e52,0x3eb0bda33d6fbeb3,0xbe403e9a3e523e93
.quad 0xbeb1bd9fbd9f3eb1,0x3eb13d9f3d9fbeb1,0xbd9f3eb13eb13d9f,0x3d9fbeb1beb1bd9f,0x3e60be8ebeaebdc5,0xbeb43d283e313e9e,0xbe8ebe60bdc53eae,0x3d283eb43e9ebe31,0x3e1f3ea33decbeab,0x3ea3be1fbeabbdec,0x3ea3be1fbeabbdec,0xbe1fbea3bdec3eab,0xbeb53b0e3ea83e08,0xbe7e3e813ea7be0d,0x3b0e3eb53e08bea8,0x3e813e7ebe0dbea7
.quad 0x3eb500003eb5,0x3eb500003eb5,0xbeb50000beb50000,0xbeb50000beb50000,0xbe1dbea3bca0beb5,0xbeabbdf0be87be71,0x3ea3be1d3eb5bca0,0x3df0beab3e71be87,0x3e8d3e623d203eb4,0x3e62be8d3eb4bd20,0xbe623e8dbeb43d20,0x3e8d3e623d203eb4,0xbeb0bda3bd6fbeb3,0x3e403e9abe523e93,0x3da3beb03eb3bd6f,0xbe9a3e40be93be52
.quad 0x3eb1bd9f3d9f3eb1,0xbeb13d9fbd9fbeb1,0x3d9f3eb1beb13d9f,0xbd9fbeb13eb1bd9f,0xbe8e3e60bdc5beae,0x3d28beb43e9e3e31,0xbe60be8e3eaebdc5,0x3eb43d28be313e9e,0x3e1fbea33dec3eab,0x3ea33e1fbeab3dec,0x3ea33e1fbeab3dec,0xbe1f3ea3bdecbeab,0xbb0e3eb5be08bea8,0xbe813e7e3e0dbea7,0xbeb5bb0e3ea8be08,0xbe7ebe813ea73e0d
.quad 0x3eb500003eb5,0x3eb500003eb5,0xbeb50000beb50000,0xbeb50000beb50000,0xbea33e1dbeb53ca0,0xbdf03eabbe713e87,0xbe1dbea3bca0beb5,0xbeabbdf0be87be71,0xbe8dbe62bd20beb4,0xbe623e8dbeb43d20,0x3e62be8d3eb4bd20,0xbe8dbe62bd20beb4,0x3da3beb03eb3bd6f,0xbe9a3e40be93be52,0x3eb03da33d6f3eb3,0xbe40be9a3e52be93
.quad 0x3eb1bd9f3d9f3eb1,0xbeb13d9fbd9fbeb1,0x3d9f3eb1beb13d9f,0xbd9fbeb13eb1bd9f,0x3e603e8ebeae3dc5,0xbeb4bd283e31be9e,0xbe8e3e60bdc5beae,0x3d28beb43e9e3e31,0xbe1f3ea3bdecbeab,0xbea3be1f3eabbdec,0xbea3be1f3eabbdec,0x3e1fbea33dec3eab,0xbeb5bb0e3ea8be08,0xbe7ebe813ea73e0d,0x3b0ebeb53e083ea8,0x3e81be7ebe0d3ea7
.quad 0x3e1bbea4be1b3ea4,0x3e1bbea4be1b3ea4,0xbea4be1b3ea43e1b,0xbea4be1b3ea43e1b,0x3e8dbe64be2d3e9f,0x3eb43d17beae3dce,0xbe64be8d3e9f3e2d,0x3d17beb43dce3eae,0x3eb0bda7be3e3e9a,0x3da73eb0be9abe3e,0xbda7beb03e9a3e3e,0x3eb0bda7be3e3e9a,0x3eb13d9abe4f3e95,0xbe983e44bd80beb2,0x3d9abeb13e953e4f,0x3e443e98beb23d80
.quad 0x3e8f3e5fbe5f3e8f,0xbe8fbe5f3e5fbe8f,0x3e5fbe8f3e8f3e5f,0xbe5f3e8fbe8fbe5f,0x3e213ea2be6e3e88,0x3de7beac3eb5bcc3,0x3ea2be213e883e6e,0xbeacbde7bcc3beb5,0x3b8e3eb5be7d3e82,0x3eb5bb8e3e823e7d,0x3eb5bb8e3e823e7d,0xbb8ebeb53e7dbe82,0xbe193ea4be853e75,0x3df83eaabc793eb5,0x3ea43e193e753e85,0x3eaabdf83eb53c79
.quad 0x3e1bbea4be1b3ea4,0x3e1bbea4be1b3ea4,0xbea4be1b3ea43e1b,0xbea4be1b3ea43e1b,0x3e643e8dbe9fbe2d,0xbd173eb4bdcebeae,0x3e8dbe64be2d3e9f,0x3eb43d17beae3dce,0xbeb03da73e3ebe9a,0xbda7beb03e9a3e3e,0x3da73eb0be9abe3e,0xbeb03da73e3ebe9a,0x3d9abeb13e953e4f,0x3e443e98beb23d80,0xbeb1bd9a3e4fbe95,0x3e98be443d803eb2
.quad 0x3e8f3e5fbe5f3e8f,0xbe8fbe5f3e5fbe8f,0x3e5fbe8f3e8f3e5f,0xbe5f3e8fbe8fbe5f,0xbea23e21be88be6e,0x3eac3de73cc33eb5,0x3e213ea2be6e3e88,0x3de7beac3eb5bcc3,0xbb8ebeb53e7dbe82,0xbeb53b8ebe82be7d,0xbeb53b8ebe82be7d,0x3b8e3eb5be7d3e82,0x3ea43e193e753e85,0x3eaabdf83eb53c79,0x3e19bea43e85be75,0xbdf8beaa3c79beb5
.quad 0xbe1bbea43e1b3ea4,0xbe1bbea43e1b3ea4,0x3ea4be1bbea43e1b,0x3ea4be1bbea43e1b,0x3e8d3e64be2dbe9f,0x3eb4bd17beaebdce,0xbe643e8d3e9fbe2d,0x3d173eb43dcebeae,0xbeb0bda73e3e3e9a,0xbda73eb03e9abe3e,0x3da7beb0be9a3e3e,0xbeb0bda73e3e3e9a,0x3eb1bd9abe4fbe95,0xbe98be44bd803eb2,0x3d9a3eb13e95be4f,0x3e44be98beb2bd80
.quad 0xbe8f3e5f3e5f3e8f,0x3e8fbe5fbe5fbe8f,0xbe5fbe8fbe8f3e5f,0x3e5f3e8f3e8fbe5f,0x3e21bea2be6ebe88,0x3de73eac3eb53cc3,0x3ea23e213e88be6e,0xbeac3de7bcc33eb5,0xbb8e3eb53e7d3e82,0xbeb5bb8ebe823e7d,0xbeb5bb8ebe823e7d,0x3b8ebeb5be7dbe82,0xbe19bea4be85be75,0x3df8beaabc79beb5,0x3ea4be193e75be85,0x3eaa3df83eb5bc79
.quad 0xbe1bbea43e1b3ea4,0xbe1bbea43e1b3ea4,0x3ea4be1bbea43e1b,0x3ea4be1bbea43e1b,0x3e64be8dbe9f3e2d,0xbd17beb4bdce3eae,0x3e8d3e64be2dbe9f,0x3eb4bd17beaebdce,0x3eb03da7be3ebe9a,0x3da7beb0be9a3e3e,0xbda73eb03e9abe3e,0x3eb03da7be3ebe9a,0x3d9a3eb13e95be4f,0x3e44be98beb2bd80,0xbeb13d9a3e4f3e95,0x3e983e443d80beb2
.quad 0xbe8f3e5f3e5f3e8f,0x3e8fbe5fbe5fbe8f,0xbe5fbe8fbe8f3e5f,0x3e5f3e8f3e8fbe5f,0xbea2be21be883e6e,0x3eacbde73cc3beb5,0x3e21bea2be6ebe88,0x3de73eac3eb53cc3,0x3b8ebeb5be7dbe82,0x3eb53b8e3e82be7d,0x3eb53b8e3e82be7d,0xbb8e3eb53e7d3e82,0x3ea4be193e75be85,0x3eaa3df83eb5bc79,0x3e193ea43e853e75,0xbdf83eaa3c793eb5
.quad 0x80003eb580003eb5,0x80003eb580003eb5,0x3eb500003eb50000,0x3eb500003eb50000,0xbe1f3ea3bcb23eb5,0xbeab3decbe883e70,0x3ea33e1f3eb53cb2,0x3dec3eab3e703e88,0xbe8f3e5fbd313eb4,0xbe5fbe8fbeb4bd31,0x3e5f3e8f3eb43d31,0xbe8f3e5fbd313eb4,0xbeb13d96bd853eb2,0x3e45be98be4dbe95,0x3d963eb13eb23d85,0xbe98be45be953e4d
.quad 0xbeb0bdb0bdb03eb0,0x3eb03db03db0beb0,0xbdb03eb03eb03db0,0x3db0beb0beb0bdb0,0xbe8bbe69bddb3ead,0x3cf83eb43ea1be27,0xbe693e8b3ead3ddb,0x3eb4bcf8be27bea1,0xbe13bea5be023ea9,0xbea53e133ea93e02,0xbea53e133ea93e02,0x3e133ea53e02bea9,0x3c55beb5be173ea5,0xbe76be853dfc3eaa,0xbeb5bc553ea53e17,0xbe853e763eaabdfc
.quad 0x80003eb580003eb5,0x80003eb580003eb5,0x3eb500003eb50000,0x3eb500003eb50000,0xbea3be1fbeb5bcb2,0xbdecbeabbe70be88,0xbe1f3ea3bcb23eb5,0xbeab3decbe883e70,0x3e8fbe5f3d31beb4,0x3e5f3e8f3eb43d31,0xbe5fbe8fbeb4bd31,0x3e8fbe5f3d31beb4,0x3d963eb13eb23d85,0xbe98be45be953e4d,0x3eb1bd963d85beb2,0xbe453e983e4d3e95
.quad 0xbeb0bdb0bdb03eb0,0x3eb03db03db0beb0,0xbdb03eb03eb03db0,0x3db0beb0beb0bdb0,0x3e69be8bbeadbddb,0xbeb43cf83e273ea1,0xbe8bbe69bddb3ead,0x3cf83eb43ea1be27,0x3e133ea53e02bea9,0x3ea5be13bea9be02,0x3ea5be13bea9be02,0xbe13bea5be023ea9,0xbeb5bc553ea53e17,0xbe853e763eaabdfc,0xbc553eb53e17bea5,0x3e763e85bdfcbeaa
.quad 0x3eb500003eb5,0x3eb500003eb5,0xbeb50000beb50000,0xbeb50000beb50000,0xbe1fbea3bcb2beb5,0xbeabbdecbe88be70,0x3ea3be1f3eb5bcb2,0x3decbeab3e70be88,0x3e8f3e5f3d313eb4,0x3e5fbe8f3eb4bd31,0xbe5f3e8fbeb43d31,0x3e8f3e5f3d313eb4,0xbeb1bd96bd85beb2,0x3e453e98be4d3e95,0x3d96beb13eb2bd85,0xbe983e45be95be4d
.quad 0x3eb0bdb03db03eb0,0xbeb03db0bdb0beb0,0x3db03eb0beb03db0,0xbdb0beb03eb0bdb0,0xbe8b3e69bddbbead,0x3cf8beb43ea13e27,0xbe69be8b3eadbddb,0x3eb43cf8be273ea1,0x3e13bea53e023ea9,0x3ea53e13bea93e02,0x3ea53e13bea93e02,0xbe133ea5be02bea9,0x3c553eb5be17bea5,0xbe763e853dfcbeaa,0xbeb53c553ea5be17,0xbe85be763eaa3dfc
.quad 0x3eb500003eb5,0x3eb500003eb5,0xbeb50000beb50000,0xbeb50000beb50000,0xbea33e1fbeb53cb2,0xbdec3eabbe703e88,0xbe1fbea3bcb2beb5,0xbeabbdecbe88be70,0xbe8fbe5fbd31beb4,0xbe5f3e8fbeb43d31,0x3e5fbe8f3eb4bd31,0xbe8fbe5fbd31beb4,0x3d96beb13eb2bd85,0xbe983e45be95be4d,0x3eb13d963d853eb2,0xbe45be983e4dbe95
.quad 0x3eb0bdb03db03eb0,0xbeb03db0bdb0beb0,0x3db03eb0beb03db0,0xbdb0beb03eb0bdb0,0x3e693e8bbead3ddb,0xbeb4bcf83e27bea1,0xbe8b3e69bddbbead,0x3cf8beb43ea13e27,0xbe133ea5be02bea9,0xbea5be133ea9be02,0xbea5be133ea9be02,0x3e13bea53e023ea9,0xbeb53c553ea5be17,0xbe85be763eaa3dfc,0xbc55beb53e173ea5,0x3e76be85bdfc3eaa
.quad 0x3e2bbea0be2b3ea0,0x3e2bbea0be2b3ea0,0xbea0be2b3ea03e2b,0xbea0be2b3ea03e2b,0x3e93be54be3e3e9a,0x3eb33d66beb03da7,0xbe54be933e9a3e3e,0x3d66beb33da73eb0,0x3eb2bd78be503e94,0x3d783eb2be94be50,0xbd78beb23e943e50,0x3eb2bd78be503e94,0x3eae3dcabe623e8d,0xbe9f3e2fbd20beb4,0x3dcabeae3e8d3e62,0x3e2f3e9fbeb43d20
.quad 0x3e863e73be733e86,0xbe86be733e73be86,0x3e73be863e863e73,0xbe733e86be86be73,0x3e063ea8be823e7d,0x3e0fbea63eb53b8e,0x3ea8be063e7d3e82,0xbea6be0f3b8ebeb5,0xbcd53eb5be893e6c,0x3eb53cd53e6c3e89,0x3eb53cd53e6c3e89,0x3cd5beb53e89be6c,0xbe363e9cbe903e5b,0x3db93eafbd433eb3,0x3e9c3e363e5b3e90,0x3eafbdb93eb33d43
.quad 0x3e2bbea0be2b3ea0,0x3e2bbea0be2b3ea0,0xbea0be2b3ea03e2b,0xbea0be2b3ea03e2b,0x3e543e93be9abe3e,0xbd663eb3bda7beb0,0x3e93be54be3e3e9a,0x3eb33d66beb03da7,0xbeb23d783e50be94,0xbd78beb23e943e50,0x3d783eb2be94be50,0xbeb23d783e50be94,0x3dcabeae3e8d3e62,0x3e2f3e9fbeb43d20,0xbeaebdca3e62be8d,0x3e9fbe2f3d203eb4
.quad 0x3e863e73be733e86,0xbe86be733e73be86,0x3e73be863e863e73,0xbe733e86be86be73,0xbea83e06be7dbe82,0x3ea63e0fbb8e3eb5,0x3e063ea8be823e7d,0x3e0fbea63eb53b8e,0x3cd5beb53e89be6c,0xbeb5bcd5be6cbe89,0xbeb5bcd5be6cbe89,0xbcd53eb5be893e6c,0x3e9c3e363e5b3e90,0x3eafbdb93eb33d43,0x3e36be9c3e90be5b,0xbdb9beaf3d43beb3
.quad 0xbe2bbea03e2b3ea0,0xbe2bbea03e2b3ea0,0x3ea0be2bbea03e2b,0x3ea0be2bbea03e2b,0x3e933e54be3ebe9a,0x3eb3bd66beb0bda7,0xbe543e933e9abe3e,0x3d663eb33da7beb0,0xbeb2bd783e503e94,0xbd783eb23e94be50,0x3d78beb2be943e50,0xbeb2bd783e503e94,0x3eaebdcabe62be8d,0xbe9fbe2fbd203eb4,0x3dca3eae3e8dbe62,0x3e2fbe9fbeb4bd20
.quad 0xbe863e733e733e86,0x3e86be73be73be86,0xbe73be86be863e73,0x3e733e863e86be73,0x3e06bea8be82be7d,0x3e0f3ea63eb5bb8e,0x3ea83e063e7dbe82,0xbea63e0f3b8e3eb5,0x3cd53eb53e893e6c,0xbeb53cd5be6c3e89,0xbeb53cd5be6c3e89,0xbcd5beb5be89be6c,0xbe36be9cbe90be5b,0x3db9beafbd43beb3,0x3e9cbe363e5bbe90,0x3eaf3db93eb3bd43
.quad 0xbe2bbea03e2b3ea0,0xbe2bbea03e2b3ea0,0x3ea0be2bbea03e2b,0x3ea0be2bbea03e2b,0x3e54be93be9a3e3e,0xbd66beb3bda73eb0,0x3e933e54be3ebe9a,0x3eb3bd66beb0bda7,0x3eb23d78be50be94,0x3d78beb2be943e50,0xbd783eb23e94be50,0x3eb23d78be50be94,0x3dca3eae3e8dbe62,0x3e2fbe9fbeb4bd20,0xbeae3dca3e623e8d,0x3e9f3e2f3d20beb4
.quad 0xbe863e733e733e86,0x3e86be73be73be86,0xbe73be86be863e73,0x3e733e863e86be73,0xbea8be06be7d3e82,0x3ea6be0fbb8ebeb5,0x3e06bea8be82be7d,0x3e0f3ea63eb5bb8e,0xbcd5beb5be89be6c,0x3eb5bcd53e6cbe89,0x3eb5bcd53e6cbe89,0x3cd53eb53e893e6c,0x3e9cbe363e5bbe90,0x3eaf3db93eb3bd43,0x3e363e9c3e903e5b,0xbdb93eaf3d433eb3
.quad 0x80003eb580003eb5,0x80003eb580003eb5,0x3eb500003eb50000,0x3eb500003eb50000,0xbe213ea2bcc33eb5,0xbeac3de7be883e6e,0x3ea23e213eb53cc3,0x3de73eac3e6e3e88,0xbe903e5bbd433eb3,0xbe5bbe90beb3bd43,0x3e5b3e903eb33d43,0xbe903e5bbd433eb3,0xbeb23d89bd923eb1,0x3e4bbe96be47be97,0x3d893eb23eb13d92,0xbe96be4bbe973e47
.quad 0xbeaebdc1bdc13eae,0x3eae3dc13dc1beae,0xbdc13eae3eae3dc1,0x3dc1beaebeaebdc1,0xbe87be71bdf03eab,0x3ca03eb53ea3be1d,0xbe713e873eab3df0,0x3eb5bca0be1dbea3,0xbe06bea8be0f3ea6,0xbea83e063ea63e0f,0xbea83e063ea63e0f,0x3e063ea83e0fbea6,0x3ce7beb4be253ea1,0xbe6bbe8a3ddf3eac,0xbeb4bce73ea13e25,0xbe8a3e6b3eacbddf
.quad 0x80003eb580003eb5,0x80003eb580003eb5,0x3eb500003eb50000,0x3eb500003eb50000,0xbea2be21beb5bcc3,0xbde7beacbe6ebe88,0xbe213ea2bcc33eb5,0xbeac3de7be883e6e,0x3e90be5b3d43beb3,0x3e5b3e903eb33d43,0xbe5bbe90beb3bd43,0x3e90be5b3d43beb3,0x3d893eb23eb13d92,0xbe96be4bbe973e47,0x3eb2bd893d92beb1,0xbe4b3e963e473e97
.quad 0xbeaebdc1bdc13eae,0x3eae3dc13dc1beae,0xbdc13eae3eae3dc1,0x3dc1beaebeaebdc1,0x3e71be87beabbdf0,0xbeb53ca03e1d3ea3,0xbe87be71bdf03eab,0x3ca03eb53ea3be1d,0x3e063ea83e0fbea6,0x3ea8be06bea6be0f,0x3ea8be06bea6be0f,0xbe06bea8be0f3ea6,0xbeb4bce73ea13e25,0xbe8a3e6b3eacbddf,0xbce73eb43e25bea1,0x3e6b3e8abddfbeac
.quad 0x3eb500003eb5,0x3eb500003eb5,0xbeb50000beb50000,0xbeb50000beb50000,0xbe21bea2bcc3beb5,0xbeacbde7be88be6e,0x3ea2be213eb5bcc3,0x3de7beac3e6ebe88,0x3e903e5b3d433eb3,0x3e5bbe903eb3bd43,0xbe5b3e90beb33d43,0x3e903e5b3d433eb3,0xbeb2bd89bd92beb1,0x3e4b3e96be473e97,0x3d89beb23eb1bd92,0xbe963e4bbe97be47
.quad 0x3eaebdc13dc13eae,0xbeae3dc1bdc1beae,0x3dc13eaebeae3dc1,0xbdc1beae3eaebdc1,0xbe873e71bdf0beab,0x3ca0beb53ea33e1d,0xbe71be873eabbdf0,0x3eb53ca0be1d3ea3,0x3e06bea83e0f3ea6,0x3ea83e06bea63e0f,0x3ea83e06bea63e0f,0xbe063ea8be0fbea6,0x3ce73eb4be25bea1,0xbe6b3e8a3ddfbeac,0xbeb43ce73ea1be25,0xbe8abe6b3eac3ddf
.quad 0x3eb500003eb5,0x3eb500003eb5,0xbeb50000beb50000,0xbeb50000beb50000,0xbea23e21beb53cc3,0xbde73eacbe6e3e88,0xbe21bea2bcc3beb5,0xbeacbde7be88be6e,0xbe90be5bbd43beb3,0xbe5b3e90beb33d43,0x3e5bbe903eb3bd43,0xbe90be5bbd43beb3,0x3d89beb23eb1bd92,0xbe963e4bbe97be47,0x3eb23d893d923eb1,0xbe4bbe963e47be97
.quad 0x3eaebdc13dc13eae,0xbeae3dc1bdc1beae,0x3dc13eaebeae3dc1,0xbdc1beae3eaebdc1,0x3e713e87beab3df0,0xbeb5bca03e1dbea3,0xbe873e71bdf0beab,0x3ca0beb53ea33e1d,0xbe063ea8be0fbea6,0xbea8be063ea6be0f,0xbea8be063ea6be0f,0x3e06bea83e0f3ea6,0xbeb43ce73ea1be25,0xbe8abe6b3eac3ddf,0xbce7beb43e253ea1,0x3e6bbe8abddf3eac
.quad 0x3e3abe9bbe3a3e9b,0x3e3abe9bbe3a3e9b,0xbe9bbe3a3e9b3e3a,0xbe9bbe3a3e9b3e3a,0x3e98be44be4f3e95,0x3eb13d9abeb23d80,0xbe44be983e953e4f,0x3d9abeb13d803eb2,0x3eb4bd20be623e8d,0x3d203eb4be8dbe62,0xbd20beb43e8d3e62,0x3eb4bd20be623e8d,0x3eaa3df8be753e85,0xbea43e19bc79beb5,0x3df8beaa3e853e75,0x3e193ea4beb53c79
.quad 0x3e7a3e83be833e7a,0xbe7abe833e83be7a,0x3e83be7a3e7a3e83,0xbe833e7abe7abe83,0x3dd63eadbe8b3e67,0x3e29bea03eb43d05,0x3eadbdd63e673e8b,0xbea0be293d05beb4,0xbd663eb3be933e54,0x3eb33d663e543e93,0x3eb33d663e543e93,0x3d66beb33e93be54,0xbe523e93be9a3e40,0x3d6f3eb3bda33eb0,0x3e933e523e403e9a,0x3eb3bd6f3eb03da3
.quad 0x3e3abe9bbe3a3e9b,0x3e3abe9bbe3a3e9b,0xbe9bbe3a3e9b3e3a,0xbe9bbe3a3e9b3e3a,0x3e443e98be95be4f,0xbd9a3eb1bd80beb2,0x3e98be44be4f3e95,0x3eb13d9abeb23d80,0xbeb43d203e62be8d,0xbd20beb43e8d3e62,0x3d203eb4be8dbe62,0xbeb43d203e62be8d,0x3df8beaa3e853e75,0x3e193ea4beb53c79,0xbeaabdf83e75be85,0x3ea4be193c793eb5
.quad 0x3e7a3e83be833e7a,0xbe7abe833e83be7a,0x3e83be7a3e7a3e83,0xbe833e7abe7abe83,0xbead3dd6be67be8b,0x3ea03e29bd053eb4,0x3dd63eadbe8b3e67,0x3e29bea03eb43d05,0x3d66beb33e93be54,0xbeb3bd66be54be93,0xbeb3bd66be54be93,0xbd663eb3be933e54,0x3e933e523e403e9a,0x3eb3bd6f3eb03da3,0x3e52be933e9abe40,0xbd6fbeb33da3beb0
.quad 0xbe3abe9b3e3a3e9b,0xbe3abe9b3e3a3e9b,0x3e9bbe3abe9b3e3a,0x3e9bbe3abe9b3e3a,0x3e983e44be4fbe95,0x3eb1bd9abeb2bd80,0xbe443e983e95be4f,0x3d9a3eb13d80beb2,0xbeb4bd203e623e8d,0xbd203eb43e8dbe62,0x3d20beb4be8d3e62,0xbeb4bd203e623e8d,0x3eaabdf8be75be85,0xbea4be19bc793eb5,0x3df83eaa3e85be75,0x3e19bea4beb5bc79
.quad 0xbe7a3e833e833e7a,0x3e7abe83be83be7a,0xbe83be7abe7a3e83,0x3e833e7a3e7abe83,0x3dd6beadbe8bbe67,0x3e293ea03eb4bd05,0x3ead3dd63e67be8b,0xbea03e293d053eb4,0x3d663eb33e933e54,0xbeb33d66be543e93,0xbeb33d66be543e93,0xbd66beb3be93be54,0xbe52be93be9abe40,0x3d6fbeb3bda3beb0,0x3e93be523e40be9a,0x3eb33d6f3eb0bda3
.quad 0xbe3abe9b3e3a3e9b,0xbe3abe9b3e3a3e9b,0x3e9bbe3abe9b3e3a,0x3e9bbe3abe9b3e3a,0x3e44be98be953e4f,0xbd9abeb1bd803eb2,0x3e983e44be4fbe95,0x3eb1bd9abeb2bd80,0x3eb43d20be62be8d,0x3d20beb4be8d3e62,0xbd203eb43e8dbe62,0x3eb43d20be62be8d,0x3df83eaa3e85be75,0x3e19bea4beb5bc79,0xbeaa3df83e753e85,0x3ea43e193c79beb5
.quad 0xbe7a3e833e833e7a,0x3e7abe83be83be7a,0xbe83be7abe7a3e83,0x3e833e7a3e7abe83,0xbeadbdd6be673e8b,0x3ea0be29bd05beb4,0x3dd6beadbe8bbe67,0x3e293ea03eb4bd05,0xbd66beb3be93be54,0x3eb3bd663e54be93,0x3eb3bd663e54be93,0x3d663eb33e933e54,0x3e93be523e40be9a,0x3eb33d6f3eb0bda3,0x3e523e933e9a3e40,0xbd6f3eb33da33eb0
.quad 0x80003eb580003eb5,0x80003eb580003eb5,0x3eb500003eb50000,0x3eb500003eb50000,0xbe233ea2bcd53eb5,0xbeac3de3be893e6c,0x3ea23e233eb53cd5,0x3de33eac3e6c3e89,0xbe913e58bd543eb3,0xbe58be91beb3bd54,0x3e583e913eb33d54,0xbe913e58bd543eb3,0xbeb23d78bd9f3eb1,0x3e50be94be42be99,0x3d783eb23eb13d9f,0xbe94be50be993e42
.quad 0xbeadbdd2bdd23ead,0x3ead3dd23dd2bead,0xbdd23ead3ead3dd2,0x3dd2beadbeadbdd2,0xbe83be7abe023ea9,0x3c0e3eb53ea5be13,0xbe7a3e833ea93e02,0x3eb5bc0ebe13bea5,0xbdf4beaabe1b3ea4,0xbeaa3df43ea43e1b,0xbeaa3df43ea43e1b,0x3df43eaa3e1bbea4,0x3d31beb4be323e9e,0xbe5fbe8f3dc13eae,0xbeb4bd313e9e3e32,0xbe8f3e5f3eaebdc1
.quad 0x80003eb580003eb5,0x80003eb580003eb5,0x3eb500003eb50000,0x3eb500003eb50000,0xbea2be23beb5bcd5,0xbde3beacbe6cbe89,0xbe233ea2bcd53eb5,0xbeac3de3be893e6c,0x3e91be583d54beb3,0x3e583e913eb33d54,0xbe58be91beb3bd54,0x3e91be583d54beb3,0x3d783eb23eb13d9f,0xbe94be50be993e42,0x3eb2bd783d9fbeb1,0xbe503e943e423e99
.quad 0xbeadbdd2bdd23ead,0x3ead3dd23dd2bead,0xbdd23ead3ead3dd2,0x3dd2beadbeadbdd2,0x3e7abe83bea9be02,0xbeb53c0e3e133ea5,0xbe83be7abe023ea9,0x3c0e3eb53ea5be13,0x3df43eaa3e1bbea4,0x3eaabdf4bea4be1b,0x3eaabdf4bea4be1b,0xbdf4beaabe1b3ea4,0xbeb4bd313e9e3e32,0xbe8f3e5f3eaebdc1,0xbd313eb43e32be9e,0x3e5f3e8fbdc1beae
.quad 0x3eb500003eb5,0x3eb500003eb5,0xbeb50000beb50000,0xbeb50000beb50000,0xbe23bea2bcd5beb5,0xbeacbde3be89be6c,0x3ea2be233eb5bcd5,0x3de3beac3e6cbe89,0x3e913e583d543eb3,0x3e58be913eb3bd54,0xbe583e91beb33d54,0x3e913e583d543eb3,0xbeb2bd78bd9fbeb1,0x3e503e94be423e99,0x3d78beb23eb1bd9f,0xbe943e50be99be42
.quad 0x3eadbdd23dd23ead,0xbead3dd2bdd2bead,0x3dd23eadbead3dd2,0xbdd2bead3eadbdd2,0xbe833e7abe02bea9,0x3c0ebeb53ea53e13,0xbe7abe833ea9be02,0x3eb53c0ebe133ea5,0x3df4beaa3e1b3ea4,0x3eaa3df4bea43e1b,0x3eaa3df4bea43e1b,0xbdf43eaabe1bbea4,0x3d313eb4be32be9e,0xbe5f3e8f3dc1beae,0xbeb43d313e9ebe32,0xbe8fbe5f3eae3dc1
.quad 0x3eb500003eb5,0x3eb500003eb5,0xbeb50000beb50000,0xbeb50000beb50000,0xbea23e23beb53cd5,0xbde33eacbe6c3e89,0xbe23bea2bcd5beb5,0xbeacbde3be89be6c,0xbe91be58bd54beb3,0xbe583e91beb33d54,0x3e58be913eb3bd54,0xbe91be58bd54beb3,0x3d78beb23eb1bd9f,0xbe943e50be99be42,0x3eb23d783d9f3eb1,0xbe50be943e42be99
.quad 0x3eadbdd23dd23ead,0xbead3dd2bdd2bead,0x3dd23eadbead3dd2,0xbdd2bead3eadbdd2,0x3e7a3e83bea93e02,0xbeb5bc0e3e13bea5,0xbe833e7abe02bea9,0x3c0ebeb53ea53e13,0xbdf43eaabe1bbea4,0xbeaabdf43ea4be1b,0xbeaabdf43ea4be1b,0x3df4beaa3e1b3ea4,0xbeb43d313e9ebe32,0xbe8fbe5f3eae3dc1,0xbd31beb43e323e9e,0x3e5fbe8fbdc13eae
.quad 0x3e49be97be493e97,0x3e49be97be493e97,0xbe97be493e973e49,0xbe97be493e973e49,0x3e9ebe32be5f3e8f,0x3eae3dc1beb43d31,0xbe32be9e3e8f3e5f,0x3dc1beae3d313eb4,0x3eb5bc8ebe733e86,0x3c8e3eb5be86be73,0xbc8ebeb53e863e73,0x3eb5bc8ebe733e86,0x3ea53e13be833e7a,0xbea93e023c0ebeb5,0x3e13bea53e7a3e83,0x3e023ea9beb5bc0e
.quad 0x3e663e8cbe8c3e66,0xbe66be8c3e8cbe66,0x3e8cbe663e663e8c,0xbe8c3e66be66be8c,0x3d9f3eb1be943e50,0x3e42be993eb23d78,0x3eb1bd9f3e503e94,0xbe99be423d78beb2,0xbdb03eb0be9b3e3a,0x3eb03db03e3a3e9b,0x3eb03db03e3a3e9b,0x3db0beb03e9bbe3a,0xbe6c3e89bea23e23,0x3cd53eb5bde33eac,0x3e893e6c3e233ea2,0x3eb5bcd53eac3de3
.quad 0x3e49be97be493e97,0x3e49be97be493e97,0xbe97be493e973e49,0xbe97be493e973e49,0x3e323e9ebe8fbe5f,0xbdc13eaebd31beb4,0x3e9ebe32be5f3e8f,0x3eae3dc1beb43d31,0xbeb53c8e3e73be86,0xbc8ebeb53e863e73,0x3c8e3eb5be86be73,0xbeb53c8e3e73be86,0x3e13bea53e7a3e83,0x3e023ea9beb5bc0e,0xbea5be133e83be7a,0x3ea9be02bc0e3eb5
.quad 0x3e663e8cbe8c3e66,0xbe66be8c3e8cbe66,0x3e8cbe663e663e8c,0xbe8c3e66be66be8c,0xbeb13d9fbe50be94,0x3e993e42bd783eb2,0x3d9f3eb1be943e50,0x3e42be993eb23d78,0x3db0beb03e9bbe3a,0xbeb0bdb0be3abe9b,0xbeb0bdb0be3abe9b,0xbdb03eb0be9b3e3a,0x3e893e6c3e233ea2,0x3eb5bcd53eac3de3,0x3e6cbe893ea2be23,0xbcd5beb53de3beac
.quad 0xbe49be973e493e97,0xbe49be973e493e97,0x3e97be49be973e49,0x3e97be49be973e49,0x3e9e3e32be5fbe8f,0x3eaebdc1beb4bd31,0xbe323e9e3e8fbe5f,0x3dc13eae3d31beb4,0xbeb5bc8e3e733e86,0xbc8e3eb53e86be73,0x3c8ebeb5be863e73,0xbeb5bc8e3e733e86,0x3ea5be13be83be7a,0xbea9be023c0e3eb5,0x3e133ea53e7abe83,0x3e02bea9beb53c0e
.quad 0xbe663e8c3e8c3e66,0x3e66be8cbe8cbe66,0xbe8cbe66be663e8c,0x3e8c3e663e66be8c,0x3d9fbeb1be94be50,0x3e423e993eb2bd78,0x3eb13d9f3e50be94,0xbe993e423d783eb2,0x3db03eb03e9b3e3a,0xbeb03db0be3a3e9b,0xbeb03db0be3a3e9b,0xbdb0beb0be9bbe3a,0xbe6cbe89bea2be23,0x3cd5beb5bde3beac,0x3e89be6c3e23bea2,0x3eb53cd53eacbde3
.quad 0xbe49be973e493e97,0xbe49be973e493e97,0x3e97be49be973e49,0x3e97be49be973e49,0x3e32be9ebe8f3e5f,0xbdc1beaebd313eb4,0x3e9e3e32be5fbe8f,0x3eaebdc1beb4bd31,0x3eb53c8ebe73be86,0x3c8ebeb5be863e73,0xbc8e3eb53e86be73,0x3eb53c8ebe73be86,0x3e133ea53e7abe83,0x3e02bea9beb53c0e,0xbea53e133e833e7a,0x3ea93e02bc0ebeb5
.quad 0xbe663e8c3e8c3e66,0x3e66be8cbe8cbe66,0xbe8cbe66be663e8c,0x3e8c3e663e66be8c,0xbeb1bd9fbe503e94,0x3e99be42bd78beb2,0x3d9fbeb1be94be50,0x3e423e993eb2bd78,0xbdb0beb0be9bbe3a,0x3eb0bdb03e3abe9b,0x3eb0bdb03e3abe9b,0x3db03eb03e9b3e3a,0x3e89be6c3e23bea2,0x3eb53cd53eacbde3,0x3e6c3e893ea23e23,0xbcd53eb53de33eac
.quad 0x80003eb580003eb5,0x80003eb580003eb5,0x3eb500003eb50000,0x3eb500003eb50000,0xbe253ea1bce73eb4,0xbeac3ddfbe8a3e6b,0x3ea13e253eb43ce7,0x3ddf3eac3e6b3e8a,0xbe933e54bd663eb3,0xbe54be93beb3bd66,0x3e543e933eb33d66,0xbe933e54bd663eb3,0xbeb33d5dbdac3eb0,0x3e56be92be3cbe9b,0x3d5d3eb33eb03dac,0xbe92be56be9b3e3c
.quad 0xbeacbde3bde33eac,0x3eac3de33de3beac,0xbde33eac3eac3de3,0x3de3beacbeacbde3,0xbe7ebe81be0d3ea7,0xbb0e3eb53ea8be08,0xbe813e7e3ea73e0d,0x3eb53b0ebe08bea8,0xbddbbeadbe273ea1,0xbead3ddb3ea13e27,0xbead3ddb3ea13e27,0x3ddb3ead3e27bea1,0x3d6fbeb3be403e9a,0xbe52be933da33eb0,0xbeb3bd6f3e9a3e40,0xbe933e523eb0bda3
.quad 0x80003eb580003eb5,0x80003eb580003eb5,0x3eb500003eb50000,0x3eb500003eb50000,0xbea1be25beb4bce7,0xbddfbeacbe6bbe8a,0xbe253ea1bce73eb4,0xbeac3ddfbe8a3e6b,0x3e93be543d66beb3,0x3e543e933eb33d66,0xbe54be93beb3bd66,0x3e93be543d66beb3,0x3d5d3eb33eb03dac,0xbe92be56be9b3e3c,0x3eb3bd5d3dacbeb0,0xbe563e923e3c3e9b
.quad 0xbeacbde3bde33eac,0x3eac3de33de3beac,0xbde33eac3eac3de3,0x3de3beacbeacbde3,0x3e81be7ebea7be0d,0xbeb5bb0e3e083ea8,0xbe7ebe81be0d3ea7,0xbb0e3eb53ea8be08,0x3ddb3ead3e27bea1,0x3eadbddbbea1be27,0x3eadbddbbea1be27,0xbddbbeadbe273ea1,0xbeb3bd6f3e9a3e40,0xbe933e523eb0bda3,0xbd6f3eb33e40be9a,0x3e523e93bda3beb0
.quad 0x3eb500003eb5,0x3eb500003eb5,0xbeb50000beb50000,0xbeb50000beb50000,0xbe25bea1bce7beb4,0xbeacbddfbe8abe6b,0x3ea1be253eb4bce7,0x3ddfbeac3e6bbe8a,0x3e933e543d663eb3,0x3e54be933eb3bd66,0xbe543e93beb33d66,0x3e933e543d663eb3,0xbeb3bd5dbdacbeb0,0x3e563e92be3c3e9b,0x3d5dbeb33eb0bdac,0xbe923e56be9bbe3c
.quad 0x3eacbde33de33eac,0xbeac3de3bde3beac,0x3de33eacbeac3de3,0xbde3beac3eacbde3,0xbe7e3e81be0dbea7,0xbb0ebeb53ea83e08,0xbe81be7e3ea7be0d,0x3eb5bb0ebe083ea8,0x3ddbbead3e273ea1,0x3ead3ddbbea13e27,0x3ead3ddbbea13e27,0xbddb3eadbe27bea1,0x3d6f3eb3be40be9a,0xbe523e933da3beb0,0xbeb33d6f3e9abe40,0xbe93be523eb03da3
.quad 0x3eb500003eb5,0x3eb500003eb5,0xbeb50000beb50000,0xbeb50000beb50000,0xbea13e25beb43ce7,0xbddf3eacbe6b3e8a,0xbe25bea1bce7beb4,0xbeacbddfbe8abe6b,0xbe93be54bd66beb3,0xbe543e93beb33d66,0x3e54be933eb3bd66,0xbe93be54bd66beb3,0x3d5dbeb33eb0bdac,0xbe923e56be9bbe3c,0x3eb33d5d3dac3eb0,0xbe56be923e3cbe9b
.quad 0x3eacbde33de33eac,0xbeac3de3bde3beac,0x3de33eacbeac3de3,0xbde3beac3eacbde3,0x3e813e7ebea73e0d,0xbeb53b0e3e08bea8,0xbe7e3e81be0dbea7,0xbb0ebeb53ea83e08,0xbddb3eadbe27bea1,0xbeadbddb3ea1be27,0xbeadbddb3ea1be27,0x3ddbbead3e273ea1,0xbeb33d6f3e9abe40,0xbe93be523eb03da3,0xbd6fbeb33e403e9a,0x3e52be93bda33eb0
.quad 0x3e58be91be583e91,0x3e58be91be583e91,0xbe91be583e913e58,0xbe91be583e913e58,0x3ea2be21be6e3e88,0x3eac3de7beb53cc3,0xbe21bea23e883e6e,0x3de7beac3cc33eb5,0x3eb53b8ebe823e7d,0xbb8e3eb5be7dbe82,0x3b8ebeb53e7d3e82,0x3eb53b8ebe823e7d,0x3ea03e29be8b3e67,0xbead3dd63d05beb4,0x3e29bea03e673e8b,0x3dd63eadbeb4bd05
.quad 0x3e503e94be943e50,0xbe50be943e94be50,0x3e94be503e503e94,0xbe943e50be50be94,0x3d4c3eb3be9c3e38,0x3e59be913eaf3db4,0x3eb3bd4c3e383e9c,0xbe91be593db4beaf,0xbdec3eabbea33e1f,0x3eab3dec3e1f3ea3,0x3eab3dec3e1f3ea3,0x3decbeab3ea3be1f,0xbe823e7bbea83e04,0xbbd53eb5be113ea6,0x3e7b3e823e043ea8,0x3eb53bd53ea63e11
.quad 0x3e58be91be583e91,0x3e58be91be583e91,0xbe91be583e913e58,0xbe91be583e913e58,0x3e213ea2be88be6e,0xbde73eacbcc3beb5,0x3ea2be21be6e3e88,0x3eac3de7beb53cc3,0xbeb5bb8e3e82be7d,0x3b8ebeb53e7d3e82,0xbb8e3eb5be7dbe82,0xbeb5bb8e3e82be7d,0x3e29bea03e673e8b,0x3dd63eadbeb4bd05,0xbea0be293e8bbe67,0x3eadbdd6bd053eb4
.quad 0x3e503e94be943e50,0xbe50be943e94be50,0x3e94be503e503e94,0xbe943e50be50be94,0xbeb33d4cbe38be9c,0x3e913e59bdb43eaf,0x3d4c3eb3be9c3e38,0x3e59be913eaf3db4,0x3decbeab3ea3be1f,0xbeabbdecbe1fbea3,0xbeabbdecbe1fbea3,0xbdec3eabbea33e1f,0x3e7b3e823e043ea8,0x3eb53bd53ea63e11,0x3e82be7b3ea8be04,0x3bd5beb53e11bea6
.quad 0xbe58be913e583e91,0xbe58be913e583e91,0x3e91be58be913e58,0x3e91be58be913e58,0x3ea23e21be6ebe88,0x3eacbde7beb5bcc3,0xbe213ea23e88be6e,0x3de73eac3cc3beb5,0xbeb53b8e3e823e7d,0x3b8e3eb53e7dbe82,0xbb8ebeb5be7d3e82,0xbeb53b8e3e823e7d,0x3ea0be29be8bbe67,0xbeadbdd63d053eb4,0x3e293ea03e67be8b,0x3dd6beadbeb43d05
.quad 0xbe503e943e943e50,0x3e50be94be94be50,0xbe94be50be503e94,0x3e943e503e50be94,0x3d4cbeb3be9cbe38,0x3e593e913eafbdb4,0x3eb33d4c3e38be9c,0xbe913e593db43eaf,0x3dec3eab3ea33e1f,0xbeab3decbe1f3ea3,0xbeab3decbe1f3ea3,0xbdecbeabbea3be1f,0xbe82be7bbea8be04,0xbbd5beb5be11bea6,0x3e7bbe823e04bea8,0x3eb5bbd53ea6be11
.quad 0xbe58be913e583e91,0xbe58be913e583e91,0x3e91be58be913e58,0x3e91be58be913e58,0x3e21bea2be883e6e,0xbde7beacbcc33eb5,0x3ea23e21be6ebe88,0x3eacbde7beb5bcc3,0x3eb5bb8ebe82be7d,0xbb8ebeb5be7d3e82,0x3b8e3eb53e7dbe82,0x3eb5bb8ebe82be7d,0x3e293ea03e67be8b,0x3dd6beadbeb43d05,0xbea03e293e8b3e67,0x3ead3dd6bd05beb4
.quad 0xbe503e943e943e50,0x3e50be94be94be50,0xbe94be50be503e94,0x3e943e503e50be94,0xbeb3bd4cbe383e9c,0x3e91be59bdb4beaf,0x3d4cbeb3be9cbe38,0x3e593e913eafbdb4,0xbdecbeabbea3be1f,0x3eabbdec3e1fbea3,0x3eabbdec3e1fbea3,0x3dec3eab3ea33e1f,0x3e7bbe823e04bea8,0x3eb5bbd53ea6be11,0x3e823e7b3ea83e04,0x3bd53eb53e113ea6
.quad 0x80003eb580003eb5,0x80003eb580003eb5,0x3eb500003eb50000,0x3eb500003eb50000,0xbe273ea1bcf83eb4,0xbead3ddbbe8b3e69,0x3ea13e273eb43cf8,0x3ddb3ead3e693e8b,0xbe943e50bd783eb2,0xbe50be94beb2bd78,0x3e503e943eb23d78,0xbe943e50bd783eb2,0xbeb33d43bdb93eaf,0x3e5bbe90be36be9c,0x3d433eb33eaf3db9,0xbe90be5bbe9c3e36
.quad 0xbeaabdf4bdf43eaa,0x3eaa3df43df4beaa,0xbdf43eaa3eaa3df4,0x3df4beaabeaabdf4,0xbe76be85be173ea5,0xbc553eb53eaabdfc,0xbe853e763ea53e17,0x3eb53c55bdfcbeaa,0xbdc1beaebe323e9e,0xbeae3dc13e9e3e32,0xbeae3dc13e9e3e32,0x3dc13eae3e32be9e,0x3d96beb1be4d3e95,0xbe45be983d853eb2,0xbeb1bd963e953e4d,0xbe983e453eb2bd85
.quad 0x80003eb580003eb5,0x80003eb580003eb5,0x3eb500003eb50000,0x3eb500003eb50000,0xbea1be27beb4bcf8,0xbddbbeadbe69be8b,0xbe273ea1bcf83eb4,0xbead3ddbbe8b3e69,0x3e94be503d78beb2,0x3e503e943eb23d78,0xbe50be94beb2bd78,0x3e94be503d78beb2,0x3d433eb33eaf3db9,0xbe90be5bbe9c3e36,0x3eb3bd433db9beaf,0xbe5b3e903e363e9c
.quad 0xbeaabdf4bdf43eaa,0x3eaa3df43df4beaa,0xbdf43eaa3eaa3df4,0x3df4beaabeaabdf4,0x3e85be76bea5be17,0xbeb5bc553dfc3eaa,0xbe76be85be173ea5,0xbc553eb53eaabdfc,0x3dc13eae3e32be9e,0x3eaebdc1be9ebe32,0x3eaebdc1be9ebe32,0xbdc1beaebe323e9e,0xbeb1bd963e953e4d,0xbe983e453eb2bd85,0xbd963eb13e4dbe95,0x3e453e98bd85beb2
.quad 0x3eb500003eb5,0x3eb500003eb5,0xbeb50000beb50000,0xbeb50000beb50000,0xbe27bea1bcf8beb4,0xbeadbddbbe8bbe69,0x3ea1be273eb4bcf8,0x3ddbbead3e69be8b,0x3e943e503d783eb2,0x3e50be943eb2bd78,0xbe503e94beb23d78,0x3e943e503d783eb2,0xbeb3bd43bdb9beaf,0x3e5b3e90be363e9c,0x3d43beb33eafbdb9,0xbe903e5bbe9cbe36
.quad 0x3eaabdf43df43eaa,0xbeaa3df4bdf4beaa,0x3df43eaabeaa3df4,0xbdf4beaa3eaabdf4,0xbe763e85be17bea5,0xbc55beb53eaa3dfc,0xbe85be763ea5be17,0x3eb5bc55bdfc3eaa,0x3dc1beae3e323e9e,0x3eae3dc1be9e3e32,0x3eae3dc1be9e3e32,0xbdc13eaebe32be9e,0x3d963eb1be4dbe95,0xbe453e983d85beb2,0xbeb13d963e95be4d,0xbe98be453eb23d85
.quad 0x3eb500003eb5,0x3eb500003eb5,0xbeb50000beb50000,0xbeb50000beb50000,0xbea13e27beb43cf8,0xbddb3eadbe693e8b,0xbe27bea1bcf8beb4,0xbeadbddbbe8bbe69,0xbe94be50bd78beb2,0xbe503e94beb23d78,0x3e50be943eb2bd78,0xbe94be50bd78beb2,0x3d43beb33eafbdb9,0xbe903e5bbe9cbe36,0x3eb33d433db93eaf,0xbe5bbe903e36be9c
.quad 0x3eaabdf43df43eaa,0xbeaa3df4bdf4beaa,0x3df43eaabeaa3df4,0xbdf4beaa3eaabdf4,0x3e853e76bea53e17,0xbeb53c553dfcbeaa,0xbe763e85be17bea5,0xbc55beb53eaa3dfc,0xbdc13eaebe32be9e,0xbeaebdc13e9ebe32,0xbeaebdc13e9ebe32,0x3dc1beae3e323e9e,0xbeb13d963e95be4d,0xbe98be453eb23d85,0xbd96beb13e4d3e95,0x3e45be98bd853eb2
.quad 0x3e66be8cbe663e8c,0x3e66be8cbe663e8c,0xbe8cbe663e8c3e66,0xbe8cbe663e8c3e66,0x3ea6be0fbe7d3e82,0x3ea83e06beb53b8e,0xbe0fbea63e823e7d,0x3e06bea83b8e3eb5,0x3eb53cd5be893e6c,0xbcd53eb5be6cbe89,0x3cd5beb53e6c3e89,0x3eb53cd5be893e6c,0x3e9a3e3ebe933e54,0xbeb03da73d66beb3,0x3e3ebe9a3e543e93,0x3da73eb0beb3bd66
.quad 0x3e3a3e9bbe9b3e3a,0xbe3abe9b3e9bbe3a,0x3e9bbe3a3e3a3e9b,0xbe9b3e3abe3abe9b,0x3cb23eb5bea33e1f,0x3e70be883eab3dec,0x3eb5bcb23e1f3ea3,0xbe88be703decbeab,0xbe133ea5bea93e02,0x3ea53e133e023ea9,0x3ea53e133e023ea9,0x3e13bea53ea9be02,0xbe8d3e62beae3dca,0xbd203eb4be2f3e9f,0x3e623e8d3dca3eae,0x3eb43d203e9f3e2f
.quad 0x3e66be8cbe663e8c,0x3e66be8cbe663e8c,0xbe8cbe663e8c3e66,0xbe8cbe663e8c3e66,0x3e0f3ea6be82be7d,0xbe063ea8bb8ebeb5,0x3ea6be0fbe7d3e82,0x3ea83e06beb53b8e,0xbeb5bcd53e89be6c,0x3cd5beb53e6c3e89,0xbcd53eb5be6cbe89,0xbeb5bcd53e89be6c,0x3e3ebe9a3e543e93,0x3da73eb0beb3bd66,0xbe9abe3e3e93be54,0x3eb0bda7bd663eb3
.quad 0x3e3a3e9bbe9b3e3a,0xbe3abe9b3e9bbe3a,0x3e9bbe3a3e3a3e9b,0xbe9b3e3abe3abe9b,0xbeb53cb2be1fbea3,0x3e883e70bdec3eab,0x3cb23eb5bea33e1f,0x3e70be883eab3dec,0x3e13bea53ea9be02,0xbea5be13be02bea9,0xbea5be13be02bea9,0xbe133ea5bea93e02,0x3e623e8d3dca3eae,0x3eb43d203e9f3e2f,0x3e8dbe623eaebdca,0x3d20beb43e2fbe9f
.quad 0xbe66be8c3e663e8c,0xbe66be8c3e663e8c,0x3e8cbe66be8c3e66,0x3e8cbe66be8c3e66,0x3ea63e0fbe7dbe82,0x3ea8be06beb5bb8e,0xbe0f3ea63e82be7d,0x3e063ea83b8ebeb5,0xbeb53cd53e893e6c,0x3cd53eb53e6cbe89,0xbcd5beb5be6c3e89,0xbeb53cd53e893e6c,0x3e9abe3ebe93be54,0xbeb0bda73d663eb3,0x3e3e3e9a3e54be93,0x3da7beb0beb33d66
.quad 0xbe3a3e9b3e9b3e3a,0x3e3abe9bbe9bbe3a,0xbe9bbe3abe3a3e9b,0x3e9b3e3a3e3abe9b,0x3cb2beb5bea3be1f,0x3e703e883eabbdec,0x3eb53cb23e1fbea3,0xbe883e703dec3eab,0x3e133ea53ea93e02,0xbea53e13be023ea9,0xbea53e13be023ea9,0xbe13bea5bea9be02,0xbe8dbe62beaebdca,0xbd20beb4be2fbe9f,0x3e62be8d3dcabeae,0x3eb4bd203e9fbe2f
.quad 0xbe66be8c3e663e8c,0xbe66be8c3e663e8c,0x3e8cbe66be8c3e66,0x3e8cbe66be8c3e66,0x3e0fbea6be823e7d,0xbe06bea8bb8e3eb5,0x3ea63e0fbe7dbe82,0x3ea8be06beb5bb8e,0x3eb5bcd5be89be6c,0xbcd5beb5be6c3e89,0x3cd53eb53e6cbe89,0x3eb5bcd5be89be6c,0x3e3e3e9a3e54be93,0x3da7beb0beb33d66,0xbe9a3e3e3e933e54,0x3eb03da7bd66beb3
.quad 0xbe3a3e9b3e9b3e3a,0x3e3abe9bbe9bbe3a,0xbe9bbe3abe3a3e9b,0x3e9b3e3a3e3abe9b,0xbeb5bcb2be1f3ea3,0x3e88be70bdecbeab,0x3cb2beb5bea3be1f,0x3e703e883eabbdec,0xbe13bea5bea9be02,0x3ea5be133e02bea9,0x3ea5be133e02bea9,0x3e133ea53ea93e02,0x3e62be8d3dcabeae,0x3eb4bd203e9fbe2f,0x3e8d3e623eae3dca,0x3d203eb43e2f3e9f
.quad 0x80003eb580003eb5,0x80003eb580003eb5,0x3eb500003eb50000,0x3eb500003eb50000,0xbe293ea0bd053eb4,0xbead3dd6be8b3e67,0x3ea03e293eb43d05,0x3dd63ead3e673e8b,0xbe953e4dbd853eb2,0xbe4dbe95beb2bd85,0x3e4d3e953eb23d85,0xbe953e4dbd853eb2,0xbeb43d28bdc53eae,0x3e60be8ebe31be9e,0x3d283eb43eae3dc5,0xbe8ebe60be9e3e31
.quad 0xbea9be02be023ea9,0x3ea93e023e02bea9,0xbe023ea93ea93e02,0x3e02bea9bea9be02,0xbe6ebe88be213ea2,0xbcc33eb53eacbde7,0xbe883e6e3ea23e21,0x3eb53cc3bde7beac,0xbda7beb0be3e3e9a,0xbeb03da73e9a3e3e,0xbeb03da73e9a3e3e,0x3da73eb03e3ebe9a,0x3db4beafbe593e91,0xbe38be9c3d4c3eb3,0xbeafbdb43e913e59,0xbe9c3e383eb3bd4c
.quad 0x80003eb580003eb5,0x80003eb580003eb5,0x3eb500003eb50000,0x3eb500003eb50000,0xbea0be29beb4bd05,0xbdd6beadbe67be8b,0xbe293ea0bd053eb4,0xbead3dd6be8b3e67,0x3e95be4d3d85beb2,0x3e4d3e953eb23d85,0xbe4dbe95beb2bd85,0x3e95be4d3d85beb2,0x3d283eb43eae3dc5,0xbe8ebe60be9e3e31,0x3eb4bd283dc5beae,0xbe603e8e3e313e9e
.quad 0xbea9be02be023ea9,0x3ea93e023e02bea9,0xbe023ea93ea93e02,0x3e02bea9bea9be02,0x3e88be6ebea2be21,0xbeb5bcc33de73eac,0xbe6ebe88be213ea2,0xbcc33eb53eacbde7,0x3da73eb03e3ebe9a,0x3eb0bda7be9abe3e,0x3eb0bda7be9abe3e,0xbda7beb0be3e3e9a,0xbeafbdb43e913e59,0xbe9c3e383eb3bd4c,0xbdb43eaf3e59be91,0x3e383e9cbd4cbeb3
.quad 0x3eb500003eb5,0x3eb500003eb5,0xbeb50000beb50000,0xbeb50000beb50000,0xbe29bea0bd05beb4,0xbeadbdd6be8bbe67,0x3ea0be293eb4bd05,0x3dd6bead3e67be8b,0x3e953e4d3d853eb2,0x3e4dbe953eb2bd85,0xbe4d3e95beb23d85,0x3e953e4d3d853eb2,0xbeb4bd28bdc5beae,0x3e603e8ebe313e9e,0x3d28beb43eaebdc5,0xbe8e3e60be9ebe31
.quad 0x3ea9be023e023ea9,0xbea93e02be02bea9,0x3e023ea9bea93e02,0xbe02bea93ea9be02,0xbe6e3e88be21bea2,0xbcc3beb53eac3de7,0xbe88be6e3ea2be21,0x3eb5bcc3bde73eac,0x3da7beb03e3e3e9a,0x3eb03da7be9a3e3e,0x3eb03da7be9a3e3e,0xbda73eb0be3ebe9a,0x3db43eafbe59be91,0xbe383e9c3d4cbeb3,0xbeaf3db43e91be59,0xbe9cbe383eb33d4c
.quad 0x3eb500003eb5,0x3eb500003eb5,0xbeb50000beb50000,0xbeb50000beb50000,0xbea03e29beb43d05,0xbdd63eadbe673e8b,0xbe29bea0bd05beb4,0xbeadbdd6be8bbe67,0xbe95be4dbd85beb2,0xbe4d3e95beb23d85,0x3e4dbe953eb2bd85,0xbe95be4dbd85beb2,0x3d28beb43eaebdc5,0xbe8e3e60be9ebe31,0x3eb43d283dc53eae,0xbe60be8e3e31be9e
.quad 0x3ea9be023e023ea9,0xbea93e02be02bea9,0x3e023ea9bea93e02,0xbe02bea93ea9be02,0x3e883e6ebea23e21,0xbeb53cc33de7beac,0xbe6e3e88be21bea2,0xbcc3beb53eac3de7,0xbda73eb0be3ebe9a,0xbeb0bda73e9abe3e,0xbeb0bda73e9abe3e,0x3da7beb03e3e3e9a,0xbeaf3db43e91be59,0xbe9cbe383eb33d4c,0xbdb4beaf3e593e91,0x3e38be9cbd4c3eb3
.quad 0x3e73be86be733e86,0x3e73be86be733e86,0xbe86be733e863e73,0xbe86be733e863e73,0x3eaabdf8be853e75,0x3ea43e19beb5bc79,0xbdf8beaa3e753e85,0x3e19bea4bc793eb5,0x3eb33d43be903e5b,0xbd433eb3be5bbe90,0x3d43beb33e5b3e90,0x3eb33d43be903e5b,0x3e933e52be9a3e40,0xbeb33d6f3da3beb0,0x3e52be933e403e9a,0x3d6f3eb3beb0bda3
.quad 0x3e233ea2bea23e23,0xbe23bea23ea2be23,0x3ea2be233e233ea2,0xbea23e23be23bea2,0xbbd53eb5bea83e04,0x3e82be7b3ea63e11,0x3eb53bd53e043ea8,0xbe7bbe823e11bea6,0xbe2f3e9fbeae3dca,0x3e9f3e2f3dca3eae,0x3e9f3e2f3dca3eae,0x3e2fbe9f3eaebdca,0xbe973e47beb23d89,0xbd923eb1be4b3e96,0x3e473e973d893eb2,0x3eb13d923e963e4b
.quad 0x3e73be86be733e86,0x3e73be86be733e86,0xbe86be733e863e73,0xbe86be733e863e73,0x3df83eaabe75be85,0xbe193ea43c79beb5,0x3eaabdf8be853e75,0x3ea43e19beb5bc79,0xbeb3bd433e90be5b,0x3d43beb33e5b3e90,0xbd433eb3be5bbe90,0xbeb3bd433e90be5b,0x3e52be933e403e9a,0x3d6f3eb3beb0bda3,0xbe93be523e9abe40,0x3eb3bd6fbda33eb0
.quad 0x3e233ea2bea23e23,0xbe23bea23ea2be23,0x3ea2be233e233ea2,0xbea23e23be23bea2,0xbeb5bbd5be04bea8,0x3e7b3e82be113ea6,0xbbd53eb5bea83e04,0x3e82be7b3ea63e11,0x3e2fbe9f3eaebdca,0xbe9fbe2fbdcabeae,0xbe9fbe2fbdcabeae,0xbe2f3e9fbeae3dca,0x3e473e973d893eb2,0x3eb13d923e963e4b,0x3e97be473eb2bd89,0x3d92beb13e4bbe96
.quad 0xbe73be863e733e86,0xbe73be863e733e86,0x3e86be73be863e73,0x3e86be73be863e73,0x3eaa3df8be85be75,0x3ea4be19beb53c79,0xbdf83eaa3e75be85,0x3e193ea4bc79beb5,0xbeb33d433e903e5b,0x3d433eb33e5bbe90,0xbd43beb3be5b3e90,0xbeb33d433e903e5b,0x3e93be52be9abe40,0xbeb3bd6f3da33eb0,0x3e523e933e40be9a,0x3d6fbeb3beb03da3
.quad 0xbe233ea23ea23e23,0x3e23bea2bea2be23,0xbea2be23be233ea2,0x3ea23e233e23bea2,0xbbd5beb5bea8be04,0x3e823e7b3ea6be11,0x3eb5bbd53e04bea8,0xbe7b3e823e113ea6,0x3e2f3e9f3eae3dca,0xbe9f3e2fbdca3eae,0xbe9f3e2fbdca3eae,0xbe2fbe9fbeaebdca,0xbe97be47beb2bd89,0xbd92beb1be4bbe96,0x3e47be973d89beb2,0x3eb1bd923e96be4b
.quad 0xbe73be863e733e86,0xbe73be863e733e86,0x3e86be73be863e73,0x3e86be73be863e73,0x3df8beaabe753e85,0xbe19bea43c793eb5,0x3eaa3df8be85be75,0x3ea4be19beb53c79,0x3eb3bd43be90be5b,0xbd43beb3be5b3e90,0x3d433eb33e5bbe90,0x3eb3bd43be90be5b,0x3e523e933e40be9a,0x3d6fbeb3beb03da3,0xbe933e523e9a3e40,0x3eb33d6fbda3beb0
.quad 0xbe233ea23ea23e23,0x3e23bea2bea2be23,0xbea2be23be233ea2,0x3ea23e233e23bea2,0xbeb53bd5be043ea8,0x3e7bbe82be11bea6,0xbbd5beb5bea8be04,0x3e823e7b3ea6be11,0xbe2fbe9fbeaebdca,0x3e9fbe2f3dcabeae,0x3e9fbe2f3dcabeae,0x3e2f3e9f3eae3dca,0x3e47be973d89beb2,0x3eb1bd923e96be4b,0x3e973e473eb23d89,0x3d923eb13e4b3e96
.quad 0x80003eb580003eb5,0x80003eb580003eb5,0x3eb500003eb50000,0x3eb500003eb50000,0xbe2b3ea0bd0e3eb4,0xbead3dd2be8c3e66,0x3ea03e2b3eb43d0e,0x3dd23ead3e663e8c,0xbe973e49bd8d3eb2,0xbe49be97beb2bd8d,0x3e493e973eb23d8d,0xbe973e49bd8d3eb2,0xbeb43d0ebdd23ead,0x3e66be8cbe2bbea0,0x3d0e3eb43ead3dd2,0xbe8cbe66bea03e2b
.quad 0xbea7be0bbe0b3ea7,0x3ea73e0b3e0bbea7,0xbe0b3ea73ea73e0b,0x3e0bbea7bea7be0b,0xbe66be8cbe2b3ea0,0xbd0e3eb43eadbdd2,0xbe8c3e663ea03e2b,0x3eb43d0ebdd2bead,0xbd8dbeb2be493e97,0xbeb23d8d3e973e49,0xbeb23d8d3e973e49,0x3d8d3eb23e49be97,0x3dd2beadbe663e8c,0xbe2bbea03d0e3eb4,0xbeadbdd23e8c3e66,0xbea03e2b3eb4bd0e
.quad 0x80003eb580003eb5,0x80003eb580003eb5,0x3eb500003eb50000,0x3eb500003eb50000,0xbea0be2bbeb4bd0e,0xbdd2beadbe66be8c,0xbe2b3ea0bd0e3eb4,0xbead3dd2be8c3e66,0x3e97be493d8dbeb2,0x3e493e973eb23d8d,0xbe49be97beb2bd8d,0x3e97be493d8dbeb2,0x3d0e3eb43ead3dd2,0xbe8cbe66bea03e2b,0x3eb4bd0e3dd2bead,0xbe663e8c3e2b3ea0
.quad 0xbea7be0bbe0b3ea7,0x3ea73e0b3e0bbea7,0xbe0b3ea73ea73e0b,0x3e0bbea7bea7be0b,0x3e8cbe66bea0be2b,0xbeb4bd0e3dd23ead,0xbe66be8cbe2b3ea0,0xbd0e3eb43eadbdd2,0x3d8d3eb23e49be97,0x3eb2bd8dbe97be49,0x3eb2bd8dbe97be49,0xbd8dbeb2be493e97,0xbeadbdd23e8c3e66,0xbea03e2b3eb4bd0e,0xbdd23ead3e66be8c,0x3e2b3ea0bd0ebeb4
.quad 0x3eb500003eb5,0x3eb500003eb5,0xbeb50000beb50000,0xbeb50000beb50000,0xbe2bbea0bd0ebeb4,0xbeadbdd2be8cbe66,0x3ea0be2b3eb4bd0e,0x3dd2bead3e66be8c,0x3e973e493d8d3eb2,0x3e49be973eb2bd8d,0xbe493e97beb23d8d,0x3e973e493d8d3eb2,0xbeb4bd0ebdd2bead,0x3e663e8cbe2b3ea0,0x3d0ebeb43eadbdd2,0xbe8c3e66bea0be2b
.quad 0x3ea7be0b3e0b3ea7,0xbea73e0bbe0bbea7,0x3e0b3ea7bea73e0b,0xbe0bbea73ea7be0b,0xbe663e8cbe2bbea0,0xbd0ebeb43ead3dd2,0xbe8cbe663ea0be2b,0x3eb4bd0ebdd23ead,0x3d8dbeb23e493e97,0x3eb23d8dbe973e49,0x3eb23d8dbe973e49,0xbd8d3eb2be49be97,0x3dd23eadbe66be8c,0xbe2b3ea03d0ebeb4,0xbead3dd23e8cbe66,0xbea0be2b3eb43d0e
.quad 0x3eb500003eb5,0x3eb500003eb5,0xbeb50000beb50000,0xbeb50000beb50000,0xbea03e2bbeb43d0e,0xbdd23eadbe663e8c,0xbe2bbea0bd0ebeb4,0xbeadbdd2be8cbe66,0xbe97be49bd8dbeb2,0xbe493e97beb23d8d,0x3e49be973eb2bd8d,0xbe97be49bd8dbeb2,0x3d0ebeb43eadbdd2,0xbe8c3e66bea0be2b,0x3eb43d0e3dd23ead,0xbe66be8c3e2bbea0
.quad 0x3ea7be0b3e0b3ea7,0xbea73e0bbe0bbea7,0x3e0b3ea7bea73e0b,0xbe0bbea73ea7be0b,0x3e8c3e66bea03e2b,0xbeb43d0e3dd2bead,0xbe663e8cbe2bbea0,0xbd0ebeb43ead3dd2,0xbd8d3eb2be49be97,0xbeb2bd8d3e97be49,0xbeb2bd8d3e97be49,0x3d8dbeb23e493e97,0xbead3dd23e8cbe66,0xbea0be2b3eb43d0e,0xbdd2bead3e663e8c,0x3e2bbea0bd0e3eb4
.quad 0x3e80be80be803e80,0x3e80be80be803e80,0xbe80be803e803e80,0xbe80be803e803e80,0x3eadbdd2be8c3e66,0x3ea03e2bbeb4bd0e,0xbdd2bead3e663e8c,0x3e2bbea0bd0e3eb4,0x3eb23d8dbe973e49,0xbd8d3eb2be49be97,0x3d8dbeb23e493e97,0x3eb23d8dbe973e49,0x3e8c3e66bea03e2b,0xbeb43d0e3dd2bead,0x3e66be8c3e2b3ea0,0x3d0e3eb4beadbdd2
.quad 0x3e0b3ea7bea73e0b,0xbe0bbea73ea7be0b,0x3ea7be0b3e0b3ea7,0xbea73e0bbe0bbea7,0xbd0e3eb4bead3dd2,0x3e8cbe663ea03e2b,0x3eb43d0e3dd23ead,0xbe66be8c3e2bbea0,0xbe493e97beb23d8d,0x3e973e493d8d3eb2,0x3e973e493d8d3eb2,0x3e49be973eb2bd8d,0xbea03e2bbeb43d0e,0xbdd23eadbe663e8c,0x3e2b3ea03d0e3eb4,0x3ead3dd23e8c3e66
.quad 0x3e80be80be803e80,0x3e80be80be803e80,0xbe80be803e803e80,0xbe80be803e803e80,0x3dd23eadbe66be8c,0xbe2b3ea03d0ebeb4,0x3eadbdd2be8c3e66,0x3ea03e2bbeb4bd0e,0xbeb2bd8d3e97be49,0x3d8dbeb23e493e97,0xbd8d3eb2be49be97,0xbeb2bd8d3e97be49,0x3e66be8c3e2b3ea0,0x3d0e3eb4beadbdd2,0xbe8cbe663ea0be2b,0x3eb4bd0ebdd23ead
.quad 0x3e0b3ea7bea73e0b,0xbe0bbea73ea7be0b,0x3ea7be0b3e0b3ea7,0xbea73e0bbe0bbea7,0xbeb4bd0ebdd2bead,0x3e663e8cbe2b3ea0,0xbd0e3eb4bead3dd2,0x3e8cbe663ea03e2b,0x3e49be973eb2bd8d,0xbe97be49bd8dbeb2,0xbe97be49bd8dbeb2,0xbe493e97beb23d8d,0x3e2b3ea03d0e3eb4,0x3ead3dd23e8c3e66,0x3ea0be2b3eb4bd0e,0x3dd2bead3e66be8c
.quad 0xbe80be803e803e80,0xbe80be803e803e80,0x3e80be80be803e80,0x3e80be80be803e80,0x3ead3dd2be8cbe66,0x3ea0be2bbeb43d0e,0xbdd23ead3e66be8c,0x3e2b3ea0bd0ebeb4,0xbeb23d8d3e973e49,0x3d8d3eb23e49be97,0xbd8dbeb2be493e97,0xbeb23d8d3e973e49,0x3e8cbe66bea0be2b,0xbeb4bd0e3dd23ead,0x3e663e8c3e2bbea0,0x3d0ebeb4bead3dd2
.quad 0xbe0b3ea73ea73e0b,0x3e0bbea7bea7be0b,0xbea7be0bbe0b3ea7,0x3ea73e0b3e0bbea7,0xbd0ebeb4beadbdd2,0x3e8c3e663ea0be2b,0x3eb4bd0e3dd2bead,0xbe663e8c3e2b3ea0,0x3e493e973eb23d8d,0xbe973e49bd8d3eb2,0xbe973e49bd8d3eb2,0xbe49be97beb2bd8d,0xbea0be2bbeb4bd0e,0xbdd2beadbe66be8c,0x3e2bbea03d0ebeb4,0x3eadbdd23e8cbe66
.quad 0xbe80be803e803e80,0xbe80be803e803e80,0x3e80be80be803e80,0x3e80be80be803e80,0x3dd2beadbe663e8c,0xbe2bbea03d0e3eb4,0x3ead3dd2be8cbe66,0x3ea0be2bbeb43d0e,0x3eb2bd8dbe97be49,0xbd8dbeb2be493e97,0x3d8d3eb23e49be97,0x3eb2bd8dbe97be49,0x3e663e8c3e2bbea0,0x3d0ebeb4bead3dd2,0xbe8c3e663ea03e2b,0x3eb43d0ebdd2bead
.quad 0xbe0b3ea73ea73e0b,0x3e0bbea7bea7be0b,0xbea7be0bbe0b3ea7,0x3ea73e0b3e0bbea7,0xbeb43d0ebdd23ead,0x3e66be8cbe2bbea0,0xbd0ebeb4beadbdd2,0x3e8c3e663ea0be2b,0xbe49be97beb2bd8d,0x3e97be493d8dbeb2,0x3e97be493d8dbeb2,0x3e493e973eb23d8d,0x3e2bbea03d0ebeb4,0x3eadbdd23e8cbe66,0x3ea03e2b3eb43d0e,0x3dd23ead3e663e8c
.quad 0x80003eb580003eb5,0x80003eb580003eb5,0x3eb500003eb50000,0x3eb500003eb50000,0xbe2d3e9fbd173eb4,0xbeae3dcebe8d3e64,0x3e9f3e2d3eb43d17,0x3dce3eae3e643e8d,0xbe983e45bd963eb1,0xbe45be98beb1bd96,0x3e453e983eb13d96,0xbe983e45bd963eb1,0xbeb43ce7bddf3eac,0x3e6bbe8abe25bea1,0x3ce73eb43eac3ddf,0xbe8abe6bbea13e25
.quad 0xbea5be13be133ea5,0x3ea53e133e13bea5,0xbe133ea53ea53e13,0x3e13bea5bea5be13,0xbe5dbe8fbe343e9d,0xbd3a3eb43eafbdbd,0xbe8f3e5d3e9d3e34,0x3eb43d3abdbdbeaf,0xbd66beb3be543e93,0xbeb33d663e933e54,0xbeb33d663e933e54,0x3d663eb33e54be93,0x3df0beabbe713e87,0xbe1dbea33ca03eb5,0xbeabbdf03e873e71,0xbea33e1d3eb5bca0
.quad 0x80003eb580003eb5,0x80003eb580003eb5,0x3eb500003eb50000,0x3eb500003eb50000,0xbe9fbe2dbeb4bd17,0xbdcebeaebe64be8d,0xbe2d3e9fbd173eb4,0xbeae3dcebe8d3e64,0x3e98be453d96beb1,0x3e453e983eb13d96,0xbe45be98beb1bd96,0x3e98be453d96beb1,0x3ce73eb43eac3ddf,0xbe8abe6bbea13e25,0x3eb4bce73ddfbeac,0xbe6b3e8a3e253ea1
.quad 0xbea5be13be133ea5,0x3ea53e133e13bea5,0xbe133ea53ea53e13,0x3e13bea5bea5be13,0x3e8fbe5dbe9dbe34,0xbeb4bd3a3dbd3eaf,0xbe5dbe8fbe343e9d,0xbd3a3eb43eafbdbd,0x3d663eb33e54be93,0x3eb3bd66be93be54,0x3eb3bd66be93be54,0xbd66beb3be543e93,0xbeabbdf03e873e71,0xbea33e1d3eb5bca0,0xbdf03eab3e71be87,0x3e1d3ea3bca0beb5
.quad 0x3eb500003eb5,0x3eb500003eb5,0xbeb50000beb50000,0xbeb50000beb50000,0xbe2dbe9fbd17beb4,0xbeaebdcebe8dbe64,0x3e9fbe2d3eb4bd17,0x3dcebeae3e64be8d,0x3e983e453d963eb1,0x3e45be983eb1bd96,0xbe453e98beb13d96,0x3e983e453d963eb1,0xbeb4bce7bddfbeac,0x3e6b3e8abe253ea1,0x3ce7beb43eacbddf,0xbe8a3e6bbea1be25
.quad 0x3ea5be133e133ea5,0xbea53e13be13bea5,0x3e133ea5bea53e13,0xbe13bea53ea5be13,0xbe5d3e8fbe34be9d,0xbd3abeb43eaf3dbd,0xbe8fbe5d3e9dbe34,0x3eb4bd3abdbd3eaf,0x3d66beb33e543e93,0x3eb33d66be933e54,0x3eb33d66be933e54,0xbd663eb3be54be93,0x3df03eabbe71be87,0xbe1d3ea33ca0beb5,0xbeab3df03e87be71,0xbea3be1d3eb53ca0
.quad 0x3eb500003eb5,0x3eb500003eb5,0xbeb50000beb50000,0xbeb50000beb50000,0xbe9f3e2dbeb43d17,0xbdce3eaebe643e8d,0xbe2dbe9fbd17beb4,0xbeaebdcebe8dbe64,0xbe98be45bd96beb1,0xbe453e98beb13d96,0x3e45be983eb1bd96,0xbe98be45bd96beb1,0x3ce7beb43eacbddf,0xbe8a3e6bbea1be25,0x3eb43ce73ddf3eac,0xbe6bbe8a3e25bea1
.quad 0x3ea5be133e133ea5,0xbea53e13be13bea5,0x3e133ea5bea53e13,0xbe13bea53ea5be13,0x3e8f3e5dbe9d3e34,0xbeb43d3a3dbdbeaf,0xbe5d3e8fbe34be9d,0xbd3abeb43eaf3dbd,0xbd663eb3be54be93,0xbeb3bd663e93be54,0xbeb3bd663e93be54,0x3d66beb33e543e93,0xbeab3df03e87be71,0xbea3be1d3eb53ca0,0xbdf0beab3e713e87,0x3e1dbea3bca03eb5
.quad 0x3e86be73be863e73,0x3e86be73be863e73,0xbe73be863e733e86,0xbe73be863e733e86,0x3eb0bdacbe923e56,0x3e9b3e3cbeb3bd5d,0xbdacbeb03e563e92,0x3e3cbe9bbd5d3eb3,0x3eaf3db9be9c3e36,0xbdb93eafbe36be9c,0x3db9beaf3e363e9c,0x3eaf3db9be9c3e36,0x3e843e78bea53e15,0xbeb53c323e00bea9,0x3e78be843e153ea5,0x3c323eb5bea9be00
.quad 0x3de33eacbeac3de3,0xbde3beac3eacbde3,0x3eacbde33de33eac,0xbeac3de3bde3beac,0xbd803eb2beb13d9a,0x3e95be4f3e983e44,0x3eb23d803d9a3eb1,0xbe4fbe953e44be98,0xbe623e8dbeb43d20,0x3e8d3e623d203eb4,0x3e8d3e623d203eb4,0x3e62be8d3eb4bd20,0xbea73e0dbeb53b0e,0xbe083ea8be7e3e81,0x3e0d3ea73b0e3eb5,0x3ea83e083e813e7e
.quad 0x3e86be73be863e73,0x3e86be73be863e73,0xbe73be863e733e86,0xbe73be863e733e86,0x3dac3eb0be56be92,0xbe3c3e9b3d5dbeb3,0x3eb0bdacbe923e56,0x3e9b3e3cbeb3bd5d,0xbeafbdb93e9cbe36,0x3db9beaf3e363e9c,0xbdb93eafbe36be9c,0xbeafbdb93e9cbe36,0x3e78be843e153ea5,0x3c323eb5bea9be00,0xbe84be783ea5be15,0x3eb5bc32be003ea9
.quad 0x3de33eacbeac3de3,0xbde3beac3eacbde3,0x3eacbde33de33eac,0xbeac3de3bde3beac,0xbeb2bd80bd9abeb1,0x3e4f3e95be443e98,0xbd803eb2beb13d9a,0x3e95be4f3e983e44,0x3e62be8d3eb4bd20,0xbe8dbe62bd20beb4,0xbe8dbe62bd20beb4,0xbe623e8dbeb43d20,0x3e0d3ea73b0e3eb5,0x3ea83e083e813e7e,0x3ea7be0d3eb5bb0e,0x3e08bea83e7ebe81
.quad 0xbe86be733e863e73,0xbe86be733e863e73,0x3e73be86be733e86,0x3e73be86be733e86,0x3eb03dacbe92be56,0x3e9bbe3cbeb33d5d,0xbdac3eb03e56be92,0x3e3c3e9bbd5dbeb3,0xbeaf3db93e9c3e36,0x3db93eaf3e36be9c,0xbdb9beafbe363e9c,0xbeaf3db93e9c3e36,0x3e84be78bea5be15,0xbeb5bc323e003ea9,0x3e783e843e15bea5,0x3c32beb5bea93e00
.quad 0xbde33eac3eac3de3,0x3de3beacbeacbde3,0xbeacbde3bde33eac,0x3eac3de33de3beac,0xbd80beb2beb1bd9a,0x3e953e4f3e98be44,0x3eb2bd803d9abeb1,0xbe4f3e953e443e98,0x3e623e8d3eb43d20,0xbe8d3e62bd203eb4,0xbe8d3e62bd203eb4,0xbe62be8dbeb4bd20,0xbea7be0dbeb5bb0e,0xbe08bea8be7ebe81,0x3e0dbea73b0ebeb5,0x3ea8be083e81be7e
.quad 0xbe86be733e863e73,0xbe86be733e863e73,0x3e73be86be733e86,0x3e73be86be733e86,0x3dacbeb0be563e92,0xbe3cbe9b3d5d3eb3,0x3eb03dacbe92be56,0x3e9bbe3cbeb33d5d,0x3eafbdb9be9cbe36,0xbdb9beafbe363e9c,0x3db93eaf3e36be9c,0x3eafbdb9be9cbe36,0x3e783e843e15bea5,0x3c32beb5bea93e00,0xbe843e783ea53e15,0x3eb53c32be00bea9
.quad 0xbde33eac3eac3de3,0x3de3beacbeacbde3,0xbeacbde3bde33eac,0x3eac3de33de3beac,0xbeb23d80bd9a3eb1,0x3e4fbe95be44be98,0xbd80beb2beb1bd9a,0x3e953e4f3e98be44,0xbe62be8dbeb4bd20,0x3e8dbe623d20beb4,0x3e8dbe623d20beb4,0x3e623e8d3eb43d20,0x3e0dbea73b0ebeb5,0x3ea8be083e81be7e,0x3ea73e0d3eb53b0e,0x3e083ea83e7e3e81
.quad 0x80003eb580003eb5,0x80003eb580003eb5,0x3eb500003eb50000,0x3eb500003eb50000,0xbe2f3e9fbd203eb4,0xbeae3dcabe8d3e62,0x3e9f3e2f3eb43d20,0x3dca3eae3e623e8d,0xbe993e42bd9f3eb1,0xbe42be99beb1bd9f,0x3e423e993eb13d9f,0xbe993e42bd9f3eb1,0xbeb53cb2bdec3eab,0x3e70be88be1fbea3,0x3cb23eb53eab3dec,0xbe88be70bea33e1f
.quad 0xbea4be1bbe1b3ea4,0x3ea43e1b3e1bbea4,0xbe1b3ea43ea43e1b,0x3e1bbea4bea4be1b,0xbe54be93be3e3e9a,0xbd663eb33eb0bda7,0xbe933e543e9a3e3e,0x3eb33d66bda7beb0,0xbd31beb4be5f3e8f,0xbeb43d313e8f3e5f,0xbeb43d313e8f3e5f,0x3d313eb43e5fbe8f,0x3e06bea8be7d3e82,0xbe0fbea63b8e3eb5,0xbea8be063e823e7d,0xbea63e0f3eb5bb8e
.quad 0x80003eb580003eb5,0x80003eb580003eb5,0x3eb500003eb50000,0x3eb500003eb50000,0xbe9fbe2fbeb4bd20,0xbdcabeaebe62be8d,0xbe2f3e9fbd203eb4,0xbeae3dcabe8d3e62,0x3e99be423d9fbeb1,0x3e423e993eb13d9f,0xbe42be99beb1bd9f,0x3e99be423d9fbeb1,0x3cb23eb53eab3dec,0xbe88be70bea33e1f,0x3eb5bcb23decbeab,0xbe703e883e1f3ea3
.quad 0xbea4be1bbe1b3ea4,0x3ea43e1b3e1bbea4,0xbe1b3ea43ea43e1b,0x3e1bbea4bea4be1b,0x3e93be54be9abe3e,0xbeb3bd663da73eb0,0xbe54be93be3e3e9a,0xbd663eb33eb0bda7,0x3d313eb43e5fbe8f,0x3eb4bd31be8fbe5f,0x3eb4bd31be8fbe5f,0xbd31beb4be5f3e8f,0xbea8be063e823e7d,0xbea63e0f3eb5bb8e,0xbe063ea83e7dbe82,0x3e0f3ea6bb8ebeb5
.quad 0x3eb500003eb5,0x3eb500003eb5,0xbeb50000beb50000,0xbeb50000beb50000,0xbe2fbe9fbd20beb4,0xbeaebdcabe8dbe62,0x3e9fbe2f3eb4bd20,0x3dcabeae3e62be8d,0x3e993e423d9f3eb1,0x3e42be993eb1bd9f,0xbe423e99beb13d9f,0x3e993e423d9f3eb1,0xbeb5bcb2bdecbeab,0x3e703e88be1f3ea3,0x3cb2beb53eabbdec,0xbe883e70bea3be1f
.quad 0x3ea4be1b3e1b3ea4,0xbea43e1bbe1bbea4,0x3e1b3ea4bea43e1b,0xbe1bbea43ea4be1b,0xbe543e93be3ebe9a,0xbd66beb33eb03da7,0xbe93be543e9abe3e,0x3eb3bd66bda73eb0,0x3d31beb43e5f3e8f,0x3eb43d31be8f3e5f,0x3eb43d31be8f3e5f,0xbd313eb4be5fbe8f,0x3e063ea8be7dbe82,0xbe0f3ea63b8ebeb5,0xbea83e063e82be7d,0xbea6be0f3eb53b8e
.quad 0x3eb500003eb5,0x3eb500003eb5,0xbeb50000beb50000,0xbeb50000beb50000,0xbe9f3e2fbeb43d20,0xbdca3eaebe623e8d,0xbe2fbe9fbd20beb4,0xbeaebdcabe8dbe62,0xbe99be42bd9fbeb1,0xbe423e99beb13d9f,0x3e42be993eb1bd9f,0xbe99be42bd9fbeb1,0x3cb2beb53eabbdec,0xbe883e70bea3be1f,0x3eb53cb23dec3eab,0xbe70be883e1fbea3
.quad 0x3ea4be1b3e1b3ea4,0xbea43e1bbe1bbea4,0x3e1b3ea4bea43e1b,0xbe1bbea43ea4be1b,0x3e933e54be9a3e3e,0xbeb33d663da7beb0,0xbe543e93be3ebe9a,0xbd66beb33eb03da7,0xbd313eb4be5fbe8f,0xbeb4bd313e8fbe5f,0xbeb4bd313e8fbe5f,0x3d31beb43e5f3e8f,0xbea83e063e82be7d,0xbea6be0f3eb53b8e,0xbe06bea83e7d3e82,0x3e0fbea6bb8e3eb5
.quad 0x3e8cbe66be8c3e66,0x3e8cbe66be8c3e66,0xbe66be8c3e663e8c,0xbe66be8c3e663e8c,0x3eb2bd85be983e45,0x3e953e4dbeb1bd96,0xbd85beb23e453e98,0x3e4dbe95bd963eb1,0x3eac3de3bea23e23,0xbde33eacbe23bea2,0x3de3beac3e233ea2,0x3eac3de3bea23e23,0x3e763e85beaa3dfc,0xbeb5bc553e17bea5,0x3e85be763dfc3eaa,0xbc553eb5bea5be17
.quad 0x3db03eb0beb03db0,0xbdb0beb03eb0bdb0,0x3eb0bdb03db03eb0,0xbeb03db0bdb0beb0,0xbdb93eafbeb33d43,0x3e9cbe363e903e5b,0x3eaf3db93d433eb3,0xbe36be9c3e5bbe90,0xbe7a3e83beb53c0e,0x3e833e7a3c0e3eb5,0x3e833e7a3c0e3eb5,0x3e7abe833eb5bc0e,0xbead3ddbbeb4bcf8,0xbe273ea1be8b3e69,0x3ddb3eadbcf83eb4,0x3ea13e273e693e8b
.quad 0x3e8cbe66be8c3e66,0x3e8cbe66be8c3e66,0xbe66be8c3e663e8c,0xbe66be8c3e663e8c,0x3d853eb2be45be98,0xbe4d3e953d96beb1,0x3eb2bd85be983e45,0x3e953e4dbeb1bd96,0xbeacbde33ea2be23,0x3de3beac3e233ea2,0xbde33eacbe23bea2,0xbeacbde33ea2be23,0x3e85be763dfc3eaa,0xbc553eb5bea5be17,0xbe76be853eaabdfc,0x3eb53c55be173ea5
.quad 0x3db03eb0beb03db0,0xbdb0beb03eb0bdb0,0x3eb0bdb03db03eb0,0xbeb03db0bdb0beb0,0xbeafbdb9bd43beb3,0x3e363e9cbe5b3e90,0xbdb93eafbeb33d43,0x3e9cbe363e903e5b,0x3e7abe833eb5bc0e,0xbe83be7abc0ebeb5,0xbe83be7abc0ebeb5,0xbe7a3e83beb53c0e,0x3ddb3eadbcf83eb4,0x3ea13e273e693e8b,0x3eadbddb3eb43cf8,0x3e27bea13e8bbe69
.quad 0xbe8cbe663e8c3e66,0xbe8cbe663e8c3e66,0x3e66be8cbe663e8c,0x3e66be8cbe663e8c,0x3eb23d85be98be45,0x3e95be4dbeb13d96,0xbd853eb23e45be98,0x3e4d3e95bd96beb1,0xbeac3de33ea23e23,0x3de33eac3e23bea2,0xbde3beacbe233ea2,0xbeac3de33ea23e23,0x3e76be85beaabdfc,0xbeb53c553e173ea5,0x3e853e763dfcbeaa,0xbc55beb5bea53e17
.quad 0xbdb03eb03eb03db0,0x3db0beb0beb0bdb0,0xbeb0bdb0bdb03eb0,0x3eb03db03db0beb0,0xbdb9beafbeb3bd43,0x3e9c3e363e90be5b,0x3eafbdb93d43beb3,0xbe363e9c3e5b3e90,0x3e7a3e833eb53c0e,0xbe833e7abc0e3eb5,0xbe833e7abc0e3eb5,0xbe7abe83beb5bc0e,0xbeadbddbbeb43cf8,0xbe27bea1be8bbe69,0x3ddbbeadbcf8beb4,0x3ea1be273e69be8b
.quad 0xbe8cbe663e8c3e66,0xbe8cbe663e8c3e66,0x3e66be8cbe663e8c,0x3e66be8cbe663e8c,0x3d85beb2be453e98,0xbe4dbe953d963eb1,0x3eb23d85be98be45,0x3e95be4dbeb13d96,0x3eacbde3bea2be23,0xbde3beacbe233ea2,0x3de33eac3e23bea2,0x3eacbde3bea2be23,0x3e853e763dfcbeaa,0xbc55beb5bea53e17,0xbe763e853eaa3dfc,0x3eb5bc55be17bea5
.quad 0xbdb03eb03eb03db0,0x3db0beb0beb0bdb0,0xbeb0bdb0bdb03eb0,0x3eb03db03db0beb0,0xbeaf3db9bd433eb3,0x3e36be9cbe5bbe90,0xbdb9beafbeb3bd43,0x3e9c3e363e90be5b,0xbe7abe83beb5bc0e,0x3e83be7a3c0ebeb5,0x3e83be7a3c0ebeb5,0x3e7a3e833eb53c0e,0x3ddbbeadbcf8beb4,0x3ea1be273e69be8b,0x3ead3ddb3eb4bcf8,0x3e273ea13e8b3e69
.quad 0x80003eb580003eb5,0x80003eb580003eb5,0x3eb500003eb50000,0x3eb500003eb50000,0xbe313e9ebd283eb4,0xbeae3dc5be8e3e60,0x3e9e3e313eb43d28,0x3dc53eae3e603e8e,0xbe9a3e3ebda73eb0,0xbe3ebe9abeb0bda7,0x3e3e3e9a3eb03da7,0xbe9a3e3ebda73eb0,0xbeb53c79bdf83eaa,0x3e75be85be19bea4,0x3c793eb53eaa3df8,0xbe85be75bea43e19
.quad 0xbea2be23be233ea2,0x3ea23e233e23bea2,0xbe233ea23ea23e23,0x3e23bea2bea2be23,0xbe4bbe96be473e97,0xbd893eb23eb1bd92,0xbe963e4b3e973e47,0x3eb23d89bd92beb1,0xbcf8beb4be693e8b,0xbeb43cf83e8b3e69,0xbeb43cf83e8b3e69,0x3cf83eb43e69be8b,0x3e15bea5be843e78,0xbe00bea9bc323eb5,0xbea5be153e783e84,0xbea93e003eb53c32
.quad 0x80003eb580003eb5,0x80003eb580003eb5,0x3eb500003eb50000,0x3eb500003eb50000,0xbe9ebe31beb4bd28,0xbdc5beaebe60be8e,0xbe313e9ebd283eb4,0xbeae3dc5be8e3e60,0x3e9abe3e3da7beb0,0x3e3e3e9a3eb03da7,0xbe3ebe9abeb0bda7,0x3e9abe3e3da7beb0,0x3c793eb53eaa3df8,0xbe85be75bea43e19,0x3eb5bc793df8beaa,0xbe753e853e193ea4
.quad 0xbea2be23be233ea2,0x3ea23e233e23bea2,0xbe233ea23ea23e23,0x3e23bea2bea2be23,0x3e96be4bbe97be47,0xbeb2bd893d923eb1,0xbe4bbe96be473e97,0xbd893eb23eb1bd92,0x3cf83eb43e69be8b,0x3eb4bcf8be8bbe69,0x3eb4bcf8be8bbe69,0xbcf8beb4be693e8b,0xbea5be153e783e84,0xbea93e003eb53c32,0xbe153ea53e84be78,0x3e003ea93c32beb5
.quad 0x3eb500003eb5,0x3eb500003eb5,0xbeb50000beb50000,0xbeb50000beb50000,0xbe31be9ebd28beb4,0xbeaebdc5be8ebe60,0x3e9ebe313eb4bd28,0x3dc5beae3e60be8e,0x3e9a3e3e3da73eb0,0x3e3ebe9a3eb0bda7,0xbe3e3e9abeb03da7,0x3e9a3e3e3da73eb0,0xbeb5bc79bdf8beaa,0x3e753e85be193ea4,0x3c79beb53eaabdf8,0xbe853e75bea4be19
.quad 0x3ea2be233e233ea2,0xbea23e23be23bea2,0x3e233ea2bea23e23,0xbe23bea23ea2be23,0xbe4b3e96be47be97,0xbd89beb23eb13d92,0xbe96be4b3e97be47,0x3eb2bd89bd923eb1,0x3cf8beb43e693e8b,0x3eb43cf8be8b3e69,0x3eb43cf8be8b3e69,0xbcf83eb4be69be8b,0x3e153ea5be84be78,0xbe003ea9bc32beb5,0xbea53e153e78be84,0xbea9be003eb5bc32
.quad 0x3eb500003eb5,0x3eb500003eb5,0xbeb50000beb50000,0xbeb50000beb50000,0xbe9e3e31beb43d28,0xbdc53eaebe603e8e,0xbe31be9ebd28beb4,0xbeaebdc5be8ebe60,0xbe9abe3ebda7beb0,0xbe3e3e9abeb03da7,0x3e3ebe9a3eb0bda7,0xbe9abe3ebda7beb0,0x3c79beb53eaabdf8,0xbe853e75bea4be19,0x3eb53c793df83eaa,0xbe75be853e19bea4
.quad 0x3ea2be233e233ea2,0xbea23e23be23bea2,0x3e233ea2bea23e23,0xbe23bea23ea2be23,0x3e963e4bbe973e47,0xbeb23d893d92beb1,0xbe4b3e96be47be97,0xbd89beb23eb13d92,0xbcf83eb4be69be8b,0xbeb4bcf83e8bbe69,0xbeb4bcf83e8bbe69,0x3cf8beb43e693e8b,0xbea53e153e78be84,0xbea9be003eb5bc32,0xbe15bea53e843e78,0x3e00bea93c323eb5
.quad 0x3e91be58be913e58,0x3e91be58be913e58,0xbe58be913e583e91,0xbe58be913e583e91,0x3eb4bd3abe9d3e34,0x3e8f3e5dbeafbdbd,0xbd3abeb43e343e9d,0x3e5dbe8fbdbd3eaf,0x3ea83e06bea63e0f,0xbe063ea8be0fbea6,0x3e06bea83e0f3ea6,0x3ea83e06bea63e0f,0x3e643e8dbeae3dce,0xbeb4bd173e2dbe9f,0x3e8dbe643dce3eae,0xbd173eb4be9fbe2d
.quad 0x3d783eb2beb23d78,0xbd78beb23eb2bd78,0x3eb2bd783d783eb2,0xbeb23d78bd78beb2,0xbdf03eabbeb53ca0,0x3ea3be1d3e873e71,0x3eab3df03ca03eb5,0xbe1dbea33e71be87,0xbe883e70beb5bcb2,0x3e703e88bcb23eb5,0x3e703e88bcb23eb5,0x3e88be703eb53cb2,0xbeb13d9abeb2bd80,0xbe443e98be953e4f,0x3d9a3eb1bd803eb2,0x3e983e443e4f3e95
.quad 0x3e91be58be913e58,0x3e91be58be913e58,0xbe58be913e583e91,0xbe58be913e583e91,0x3d3a3eb4be34be9d,0xbe5d3e8f3dbdbeaf,0x3eb4bd3abe9d3e34,0x3e8f3e5dbeafbdbd,0xbea8be063ea6be0f,0x3e06bea83e0f3ea6,0xbe063ea8be0fbea6,0xbea8be063ea6be0f,0x3e8dbe643dce3eae,0xbd173eb4be9fbe2d,0xbe64be8d3eaebdce,0x3eb43d17be2d3e9f
.quad 0x3d783eb2beb23d78,0xbd78beb23eb2bd78,0x3eb2bd783d783eb2,0xbeb23d78bd78beb2,0xbeabbdf0bca0beb5,0x3e1d3ea3be713e87,0xbdf03eabbeb53ca0,0x3ea3be1d3e873e71,0x3e88be703eb53cb2,0xbe70be883cb2beb5,0xbe70be883cb2beb5,0xbe883e70beb5bcb2,0x3d9a3eb1bd803eb2,0x3e983e443e4f3e95,0x3eb1bd9a3eb23d80,0x3e44be983e95be4f
.quad 0xbe91be583e913e58,0xbe91be583e913e58,0x3e58be91be583e91,0x3e58be91be583e91,0x3eb43d3abe9dbe34,0x3e8fbe5dbeaf3dbd,0xbd3a3eb43e34be9d,0x3e5d3e8fbdbdbeaf,0xbea83e063ea63e0f,0x3e063ea83e0fbea6,0xbe06bea8be0f3ea6,0xbea83e063ea63e0f,0x3e64be8dbeaebdce,0xbeb43d173e2d3e9f,0x3e8d3e643dcebeae,0xbd17beb4be9f3e2d
.quad 0xbd783eb23eb23d78,0x3d78beb2beb2bd78,0xbeb2bd78bd783eb2,0x3eb23d783d78beb2,0xbdf0beabbeb5bca0,0x3ea33e1d3e87be71,0x3eabbdf03ca0beb5,0xbe1d3ea33e713e87,0x3e883e703eb5bcb2,0xbe703e883cb23eb5,0xbe703e883cb23eb5,0xbe88be70beb53cb2,0xbeb1bd9abeb23d80,0xbe44be98be95be4f,0x3d9abeb1bd80beb2,0x3e98be443e4fbe95
.quad 0xbe91be583e913e58,0xbe91be583e913e58,0x3e58be91be583e91,0x3e58be91be583e91,0x3d3abeb4be343e9d,0xbe5dbe8f3dbd3eaf,0x3eb43d3abe9dbe34,0x3e8fbe5dbeaf3dbd,0x3ea8be06bea6be0f,0xbe06bea8be0f3ea6,0x3e063ea83e0fbea6,0x3ea8be06bea6be0f,0x3e8d3e643dcebeae,0xbd17beb4be9f3e2d,0xbe643e8d3eae3dce,0x3eb4bd17be2dbe9f
.quad 0xbd783eb23eb23d78,0x3d78beb2beb2bd78,0xbeb2bd78bd783eb2,0x3eb23d783d78beb2,0xbeab3df0bca03eb5,0x3e1dbea3be71be87,0xbdf0beabbeb5bca0,0x3ea33e1d3e87be71,0xbe88be70beb53cb2,0x3e70be88bcb2beb5,0x3e70be88bcb2beb5,0x3e883e703eb5bcb2,0x3d9abeb1bd80beb2,0x3e98be443e4fbe95,0x3eb13d9a3eb2bd80,0x3e443e983e953e4f
.quad 0x80003eb580003eb5,0x80003eb580003eb5,0x3eb500003eb50000,0x3eb500003eb50000,0xbe323e9ebd313eb4,0xbeae3dc1be8f3e5f,0x3e9e3e323eb43d31,0x3dc13eae3e5f3e8f,0xbe9b3e3abdb03eb0,0xbe3abe9bbeb0bdb0,0x3e3a3e9b3eb03db0,0xbe9b3e3abdb03eb0,0xbeb53c0ebe023ea9,0x3e7abe83be13bea5,0x3c0e3eb53ea93e02,0xbe83be7abea53e13
.quad 0xbea0be2bbe2b3ea0,0x3ea03e2b3e2bbea0,0xbe2b3ea03ea03e2b,0x3e2bbea0bea0be2b,0xbe42be99be503e94,0xbd9f3eb13eb2bd78,0xbe993e423e943e50,0x3eb13d9fbd78beb2,0xbc8ebeb5be733e86,0xbeb53c8e3e863e73,0xbeb53c8e3e863e73,0x3c8e3eb53e73be86,0x3e23bea2be893e6c,0xbde3beacbcd53eb5,0xbea2be233e6c3e89,0xbeac3de33eb53cd5
.quad 0x80003eb580003eb5,0x80003eb580003eb5,0x3eb500003eb50000,0x3eb500003eb50000,0xbe9ebe32beb4bd31,0xbdc1beaebe5fbe8f,0xbe323e9ebd313eb4,0xbeae3dc1be8f3e5f,0x3e9bbe3a3db0beb0,0x3e3a3e9b3eb03db0,0xbe3abe9bbeb0bdb0,0x3e9bbe3a3db0beb0,0x3c0e3eb53ea93e02,0xbe83be7abea53e13,0x3eb5bc0e3e02bea9,0xbe7a3e833e133ea5
.quad 0xbea0be2bbe2b3ea0,0x3ea03e2b3e2bbea0,0xbe2b3ea03ea03e2b,0x3e2bbea0bea0be2b,0x3e99be42be94be50,0xbeb1bd9f3d783eb2,0xbe42be99be503e94,0xbd9f3eb13eb2bd78,0x3c8e3eb53e73be86,0x3eb5bc8ebe86be73,0x3eb5bc8ebe86be73,0xbc8ebeb5be733e86,0xbea2be233e6c3e89,0xbeac3de33eb53cd5,0xbe233ea23e89be6c,0x3de33eac3cd5beb5
.quad 0x3eb500003eb5,0x3eb500003eb5,0xbeb50000beb50000,0xbeb50000beb50000,0xbe32be9ebd31beb4,0xbeaebdc1be8fbe5f,0x3e9ebe323eb4bd31,0x3dc1beae3e5fbe8f,0x3e9b3e3a3db03eb0,0x3e3abe9b3eb0bdb0,0xbe3a3e9bbeb03db0,0x3e9b3e3a3db03eb0,0xbeb5bc0ebe02bea9,0x3e7a3e83be133ea5,0x3c0ebeb53ea9be02,0xbe833e7abea5be13
.quad 0x3ea0be2b3e2b3ea0,0xbea03e2bbe2bbea0,0x3e2b3ea0bea03e2b,0xbe2bbea03ea0be2b,0xbe423e99be50be94,0xbd9fbeb13eb23d78,0xbe99be423e94be50,0x3eb1bd9fbd783eb2,0x3c8ebeb53e733e86,0x3eb53c8ebe863e73,0x3eb53c8ebe863e73,0xbc8e3eb5be73be86,0x3e233ea2be89be6c,0xbde33eacbcd5beb5,0xbea23e233e6cbe89,0xbeacbde33eb5bcd5
.quad 0x3eb500003eb5,0x3eb500003eb5,0xbeb50000beb50000,0xbeb50000beb50000,0xbe9e3e32beb43d31,0xbdc13eaebe5f3e8f,0xbe32be9ebd31beb4,0xbeaebdc1be8fbe5f,0xbe9bbe3abdb0beb0,0xbe3a3e9bbeb03db0,0x3e3abe9b3eb0bdb0,0xbe9bbe3abdb0beb0,0x3c0ebeb53ea9be02,0xbe833e7abea5be13,0x3eb53c0e3e023ea9,0xbe7abe833e13bea5
.quad 0x3ea0be2b3e2b3ea0,0xbea03e2bbe2bbea0,0x3e2b3ea0bea03e2b,0xbe2bbea03ea0be2b,0x3e993e42be943e50,0xbeb13d9f3d78beb2,0xbe423e99be50be94,0xbd9fbeb13eb23d78,0xbc8e3eb5be73be86,0xbeb5bc8e3e86be73,0xbeb5bc8e3e86be73,0x3c8ebeb53e733e86,0xbea23e233e6cbe89,0xbeacbde33eb5bcd5,0xbe23bea23e893e6c,0x3de3beac3cd53eb5
.quad 0x3e97be49be973e49,0x3e97be49be973e49,0xbe49be973e493e97,0xbe49be973e493e97,0x3eb5bcd5bea23e23,0x3e893e6cbeacbde3,0xbcd5beb53e233ea2,0x3e6cbe89bde33eac,0x3ea43e1bbeaa3df4,0xbe1b3ea4bdf4beaa,0x3e1bbea43df43eaa,0x3ea43e1bbeaa3df4,0x3e503e94beb13d9f,0xbeb2bd783e42be99,0x3e94be503d9f3eb1,0xbd783eb2be99be42
.quad 0x3d0e3eb4beb43d0e,0xbd0ebeb43eb4bd0e,0x3eb4bd0e3d0e3eb4,0xbeb43d0ebd0ebeb4,0xbe133ea5beb5bc0e,0x3ea9be023e7a3e83,0x3ea53e13bc0e3eb5,0xbe02bea93e83be7a,0xbe913e58beb3bd54,0x3e583e91bd543eb3,0x3e583e91bd543eb3,0x3e91be583eb33d54,0xbeb43d31beaebdc1,0xbe5f3e8fbe9e3e32,0x3d313eb4bdc13eae,0x3e8f3e5f3e323e9e
.quad 0x3e97be49be973e49,0x3e97be49be973e49,0xbe49be973e493e97,0xbe49be973e493e97,0x3cd53eb5be23bea2,0xbe6c3e893de3beac,0x3eb5bcd5bea23e23,0x3e893e6cbeacbde3,0xbea4be1b3eaabdf4,0x3e1bbea43df43eaa,0xbe1b3ea4bdf4beaa,0xbea4be1b3eaabdf4,0x3e94be503d9f3eb1,0xbd783eb2be99be42,0xbe50be943eb1bd9f,0x3eb23d78be423e99
.quad 0x3d0e3eb4beb43d0e,0xbd0ebeb43eb4bd0e,0x3eb4bd0e3d0e3eb4,0xbeb43d0ebd0ebeb4,0xbea5be133c0ebeb5,0x3e023ea9be833e7a,0xbe133ea5beb5bc0e,0x3ea9be023e7a3e83,0x3e91be583eb33d54,0xbe58be913d54beb3,0xbe58be913d54beb3,0xbe913e58beb3bd54,0x3d313eb4bdc13eae,0x3e8f3e5f3e323e9e,0x3eb4bd313eae3dc1,0x3e5fbe8f3e9ebe32
.quad 0xbe97be493e973e49,0xbe97be493e973e49,0x3e49be97be493e97,0x3e49be97be493e97,0x3eb53cd5bea2be23,0x3e89be6cbeac3de3,0xbcd53eb53e23bea2,0x3e6c3e89bde3beac,0xbea43e1b3eaa3df4,0x3e1b3ea43df4beaa,0xbe1bbea4bdf43eaa,0xbea43e1b3eaa3df4,0x3e50be94beb1bd9f,0xbeb23d783e423e99,0x3e943e503d9fbeb1,0xbd78beb2be993e42
.quad 0xbd0e3eb43eb43d0e,0x3d0ebeb4beb4bd0e,0xbeb4bd0ebd0e3eb4,0x3eb43d0e3d0ebeb4,0xbe13bea5beb53c0e,0x3ea93e023e7abe83,0x3ea5be13bc0ebeb5,0xbe023ea93e833e7a,0x3e913e583eb3bd54,0xbe583e913d543eb3,0xbe583e913d543eb3,0xbe91be58beb33d54,0xbeb4bd31beae3dc1,0xbe5fbe8fbe9ebe32,0x3d31beb4bdc1beae,0x3e8fbe5f3e32be9e
.quad 0xbe97be493e973e49,0xbe97be493e973e49,0x3e49be97be493e97,0x3e49be97be493e97,0x3cd5beb5be233ea2,0xbe6cbe893de33eac,0x3eb53cd5bea2be23,0x3e89be6cbeac3de3,0x3ea4be1bbeaabdf4,0xbe1bbea4bdf43eaa,0x3e1b3ea43df4beaa,0x3ea4be1bbeaabdf4,0x3e943e503d9fbeb1,0xbd78beb2be993e42,0xbe503e943eb13d9f,0x3eb2bd78be42be99
.quad 0xbd0e3eb43eb43d0e,0x3d0ebeb4beb4bd0e,0xbeb4bd0ebd0e3eb4,0x3eb43d0e3d0ebeb4,0xbea53e133c0e3eb5,0x3e02bea9be83be7a,0xbe13bea5beb53c0e,0x3ea93e023e7abe83,0xbe91be58beb33d54,0x3e58be91bd54beb3,0x3e58be91bd54beb3,0x3e913e583eb3bd54,0x3d31beb4bdc1beae,0x3e8fbe5f3e32be9e,0x3eb43d313eaebdc1,0x3e5f3e8f3e9e3e32
.quad 0x80003eb580003eb5,0x80003eb580003eb5,0x3eb500003eb50000,0x3eb500003eb50000,0xbe343e9dbd3a3eb4,0xbeaf3dbdbe8f3e5d,0x3e9d3e343eb43d3a,0x3dbd3eaf3e5d3e8f,0xbe9c3e36bdb93eaf,0xbe36be9cbeafbdb9,0x3e363e9c3eaf3db9,0xbe9c3e36bdb93eaf,0xbeb53b0ebe083ea8,0x3e7ebe81be0dbea7,0x3b0e3eb53ea83e08,0xbe81be7ebea73e0d
.quad 0xbe9ebe32be323e9e,0x3e9e3e323e32be9e,0xbe323e9e3e9e3e32,0x3e32be9ebe9ebe32,0xbe38be9cbe593e91,0xbdb43eaf3eb3bd4c,0xbe9c3e383e913e59,0x3eaf3db4bd4cbeb3,0xbb8ebeb5be7d3e82,0xbeb53b8e3e823e7d,0xbeb53b8e3e823e7d,0x3b8e3eb53e7dbe82,0x3e31be9ebe8e3e60,0xbdc5beaebd283eb4,0xbe9ebe313e603e8e,0xbeae3dc53eb43d28
.quad 0x80003eb580003eb5,0x80003eb580003eb5,0x3eb500003eb50000,0x3eb500003eb50000,0xbe9dbe34beb4bd3a,0xbdbdbeafbe5dbe8f,0xbe343e9dbd3a3eb4,0xbeaf3dbdbe8f3e5d,0x3e9cbe363db9beaf,0x3e363e9c3eaf3db9,0xbe36be9cbeafbdb9,0x3e9cbe363db9beaf,0x3b0e3eb53ea83e08,0xbe81be7ebea73e0d,0x3eb5bb0e3e08bea8,0xbe7e3e813e0d3ea7
.quad 0xbe9ebe32be323e9e,0x3e9e3e323e32be9e,0xbe323e9e3e9e3e32,0x3e32be9ebe9ebe32,0x3e9cbe38be91be59,0xbeafbdb43d4c3eb3,0xbe38be9cbe593e91,0xbdb43eaf3eb3bd4c,0x3b8e3eb53e7dbe82,0x3eb5bb8ebe82be7d,0x3eb5bb8ebe82be7d,0xbb8ebeb5be7d3e82,0xbe9ebe313e603e8e,0xbeae3dc53eb43d28,0xbe313e9e3e8ebe60,0x3dc53eae3d28beb4
.quad 0x3eb500003eb5,0x3eb500003eb5,0xbeb50000beb50000,0xbeb50000beb50000,0xbe34be9dbd3abeb4,0xbeafbdbdbe8fbe5d,0x3e9dbe343eb4bd3a,0x3dbdbeaf3e5dbe8f,0x3e9c3e363db93eaf,0x3e36be9c3eafbdb9,0xbe363e9cbeaf3db9,0x3e9c3e363db93eaf,0xbeb5bb0ebe08bea8,0x3e7e3e81be0d3ea7,0x3b0ebeb53ea8be08,0xbe813e7ebea7be0d
.quad 0x3e9ebe323e323e9e,0xbe9e3e32be32be9e,0x3e323e9ebe9e3e32,0xbe32be9e3e9ebe32,0xbe383e9cbe59be91,0xbdb4beaf3eb33d4c,0xbe9cbe383e91be59,0x3eafbdb4bd4c3eb3,0x3b8ebeb53e7d3e82,0x3eb53b8ebe823e7d,0x3eb53b8ebe823e7d,0xbb8e3eb5be7dbe82,0x3e313e9ebe8ebe60,0xbdc53eaebd28beb4,0xbe9e3e313e60be8e,0xbeaebdc53eb4bd28
.quad 0x3eb500003eb5,0x3eb500003eb5,0xbeb50000beb50000,0xbeb50000beb50000,0xbe9d3e34beb43d3a,0xbdbd3eafbe5d3e8f,0xbe34be9dbd3abeb4,0xbeafbdbdbe8fbe5d,0xbe9cbe36bdb9beaf,0xbe363e9cbeaf3db9,0x3e36be9c3eafbdb9,0xbe9cbe36bdb9beaf,0x3b0ebeb53ea8be08,0xbe813e7ebea7be0d,0x3eb53b0e3e083ea8,0xbe7ebe813e0dbea7
.quad 0x3e9ebe323e323e9e,0xbe9e3e32be32be9e,0x3e323e9ebe9e3e32,0xbe32be9e3e9ebe32,0x3e9c3e38be913e59,0xbeaf3db43d4cbeb3,0xbe383e9cbe59be91,0xbdb4beaf3eb33d4c,0xbb8e3eb5be7dbe82,0xbeb5bb8e3e82be7d,0xbeb5bb8e3e82be7d,0x3b8ebeb53e7d3e82,0xbe9e3e313e60be8e,0xbeaebdc53eb4bd28,0xbe31be9e3e8e3e60,0x3dc5beae3d283eb4
.quad 0x3e9bbe3abe9b3e3a,0x3e9bbe3abe9b3e3a,0xbe3abe9b3e3a3e9b,0xbe3abe9b3e3a3e9b,0x3eb5bbd5bea63e11,0x3e823e7bbea8be04,0xbbd5beb53e113ea6,0x3e7bbe82be043ea8,0x3e9f3e2fbeae3dca,0xbe2f3e9fbdcabeae,0x3e2fbe9f3dca3eae,0x3e9f3e2fbeae3dca,0x3e3c3e9bbeb33d5d,0xbeb0bdac3e56be92,0x3e9bbe3c3d5d3eb3,0xbdac3eb0be92be56
.quad 0x3c0e3eb5beb53c0e,0xbc0ebeb53eb5bc0e,0x3eb5bc0e3c0e3eb5,0xbeb53c0ebc0ebeb5,0xbe2d3e9fbeb4bd17,0x3eaebdce3e643e8d,0x3e9f3e2dbd173eb4,0xbdcebeae3e8dbe64,0xbe9a3e3ebeb0bda7,0x3e3e3e9abda73eb0,0x3e3e3e9abda73eb0,0x3e9abe3e3eb03da7,0xbeb53c32bea9be00,0xbe783e84bea53e15,0x3c323eb5be003ea9,0x3e843e783e153ea5
.quad 0x3e9bbe3abe9b3e3a,0x3e9bbe3abe9b3e3a,0xbe3abe9b3e3a3e9b,0xbe3abe9b3e3a3e9b,0x3bd53eb5be11bea6,0xbe7b3e823e04bea8,0x3eb5bbd5bea63e11,0x3e823e7bbea8be04,0xbe9fbe2f3eaebdca,0x3e2fbe9f3dca3eae,0xbe2f3e9fbdcabeae,0xbe9fbe2f3eaebdca,0x3e9bbe3c3d5d3eb3,0xbdac3eb0be92be56,0xbe3cbe9b3eb3bd5d,0x3eb03dacbe563e92
.quad 0x3c0e3eb5beb53c0e,0xbc0ebeb53eb5bc0e,0x3eb5bc0e3c0e3eb5,0xbeb53c0ebc0ebeb5,0xbe9fbe2d3d17beb4,0x3dce3eaebe8d3e64,0xbe2d3e9fbeb4bd17,0x3eaebdce3e643e8d,0x3e9abe3e3eb03da7,0xbe3ebe9a3da7beb0,0xbe3ebe9a3da7beb0,0xbe9a3e3ebeb0bda7,0x3c323eb5be003ea9,0x3e843e783e153ea5,0x3eb5bc323ea93e00,0x3e78be843ea5be15
.quad 0xbe9bbe3a3e9b3e3a,0xbe9bbe3a3e9b3e3a,0x3e3abe9bbe3a3e9b,0x3e3abe9bbe3a3e9b,0x3eb53bd5bea6be11,0x3e82be7bbea83e04,0xbbd53eb53e11bea6,0x3e7b3e82be04bea8,0xbe9f3e2f3eae3dca,0x3e2f3e9f3dcabeae,0xbe2fbe9fbdca3eae,0xbe9f3e2f3eae3dca,0x3e3cbe9bbeb3bd5d,0xbeb03dac3e563e92,0x3e9b3e3c3d5dbeb3,0xbdacbeb0be923e56
.quad 0xbc0e3eb53eb53c0e,0x3c0ebeb5beb5bc0e,0xbeb5bc0ebc0e3eb5,0x3eb53c0e3c0ebeb5,0xbe2dbe9fbeb43d17,0x3eae3dce3e64be8d,0x3e9fbe2dbd17beb4,0xbdce3eae3e8d3e64,0x3e9a3e3e3eb0bda7,0xbe3e3e9a3da73eb0,0xbe3e3e9a3da73eb0,0xbe9abe3ebeb03da7,0xbeb5bc32bea93e00,0xbe78be84bea5be15,0x3c32beb5be00bea9,0x3e84be783e15bea5
.quad 0xbe9bbe3a3e9b3e3a,0xbe9bbe3a3e9b3e3a,0x3e3abe9bbe3a3e9b,0x3e3abe9bbe3a3e9b,0x3bd5beb5be113ea6,0xbe7bbe823e043ea8,0x3eb53bd5bea6be11,0x3e82be7bbea83e04,0x3e9fbe2fbeaebdca,0xbe2fbe9fbdca3eae,0x3e2f3e9f3dcabeae,0x3e9fbe2fbeaebdca,0x3e9b3e3c3d5dbeb3,0xbdacbeb0be923e56,0xbe3c3e9b3eb33d5d,0x3eb0bdacbe56be92
.quad 0xbc0e3eb53eb53c0e,0x3c0ebeb5beb5bc0e,0xbeb5bc0ebc0e3eb5,0x3eb53c0e3c0ebeb5,0xbe9f3e2d3d173eb4,0x3dcebeaebe8dbe64,0xbe2dbe9fbeb43d17,0x3eae3dce3e64be8d,0xbe9abe3ebeb03da7,0x3e3ebe9abda7beb0,0x3e3ebe9abda7beb0,0x3e9a3e3e3eb0bda7,0x3c32beb5be00bea9,0x3e84be783e15bea5,0x3eb53c323ea9be00,0x3e783e843ea53e15
.quad 0x80003eb580003eb5,0x80003eb580003eb5,0x3eb500003eb50000,0x3eb500003eb50000,0xbe363e9cbd433eb3,0xbeaf3db9be903e5b,0x3e9c3e363eb33d43,0x3db93eaf3e5b3e90,0xbe9e3e32bdc13eae,0xbe32be9ebeaebdc1,0x3e323e9e3eae3dc1,0xbe9e3e32bdc13eae,0xbeb5bb8ebe0f3ea6,0x3e82be7dbe06bea8,0xbb8e3eb53ea63e0f,0xbe7dbe82bea83e06
.quad 0xbe9bbe3abe3a3e9b,0x3e9b3e3a3e3abe9b,0xbe3a3e9b3e9b3e3a,0x3e3abe9bbe9bbe3a,0xbe2fbe9fbe623e8d,0xbdca3eae3eb4bd20,0xbe9f3e2f3e8d3e62,0x3eae3dcabd20beb4,0x3c0ebeb5be833e7a,0xbeb5bc0e3e7a3e83,0xbeb5bc0e3e7a3e83,0xbc0e3eb53e83be7a,0x3e3ebe9abe933e54,0xbda7beb0bd663eb3,0xbe9abe3e3e543e93,0xbeb03da73eb33d66
.quad 0x80003eb580003eb5,0x80003eb580003eb5,0x3eb500003eb50000,0x3eb500003eb50000,0xbe9cbe36beb3bd43,0xbdb9beafbe5bbe90,0xbe363e9cbd433eb3,0xbeaf3db9be903e5b,0x3e9ebe323dc1beae,0x3e323e9e3eae3dc1,0xbe32be9ebeaebdc1,0x3e9ebe323dc1beae,0xbb8e3eb53ea63e0f,0xbe7dbe82bea83e06,0x3eb53b8e3e0fbea6,0xbe823e7d3e063ea8
.quad 0xbe9bbe3abe3a3e9b,0x3e9b3e3a3e3abe9b,0xbe3a3e9b3e9b3e3a,0x3e3abe9bbe9bbe3a,0x3e9fbe2fbe8dbe62,0xbeaebdca3d203eb4,0xbe2fbe9fbe623e8d,0xbdca3eae3eb4bd20,0xbc0e3eb53e83be7a,0x3eb53c0ebe7abe83,0x3eb53c0ebe7abe83,0x3c0ebeb5be833e7a,0xbe9abe3e3e543e93,0xbeb03da73eb33d66,0xbe3e3e9a3e93be54,0x3da73eb03d66beb3
.quad 0x3eb500003eb5,0x3eb500003eb5,0xbeb50000beb50000,0xbeb50000beb50000,0xbe36be9cbd43beb3,0xbeafbdb9be90be5b,0x3e9cbe363eb3bd43,0x3db9beaf3e5bbe90,0x3e9e3e323dc13eae,0x3e32be9e3eaebdc1,0xbe323e9ebeae3dc1,0x3e9e3e323dc13eae,0xbeb53b8ebe0fbea6,0x3e823e7dbe063ea8,0xbb8ebeb53ea6be0f,0xbe7d3e82bea8be06
.quad 0x3e9bbe3a3e3a3e9b,0xbe9b3e3abe3abe9b,0x3e3a3e9bbe9b3e3a,0xbe3abe9b3e9bbe3a,0xbe2f3e9fbe62be8d,0xbdcabeae3eb43d20,0xbe9fbe2f3e8dbe62,0x3eaebdcabd203eb4,0xbc0ebeb53e833e7a,0x3eb5bc0ebe7a3e83,0x3eb5bc0ebe7a3e83,0x3c0e3eb5be83be7a,0x3e3e3e9abe93be54,0xbda73eb0bd66beb3,0xbe9a3e3e3e54be93,0xbeb0bda73eb3bd66
.quad 0x3eb500003eb5,0x3eb500003eb5,0xbeb50000beb50000,0xbeb50000beb50000,0xbe9c3e36beb33d43,0xbdb93eafbe5b3e90,0xbe36be9cbd43beb3,0xbeafbdb9be90be5b,0xbe9ebe32bdc1beae,0xbe323e9ebeae3dc1,0x3e32be9e3eaebdc1,0xbe9ebe32bdc1beae,0xbb8ebeb53ea6be0f,0xbe7d3e82bea8be06,0x3eb5bb8e3e0f3ea6,0xbe82be7d3e06bea8
.quad 0x3e9bbe3a3e3a3e9b,0xbe9b3e3abe3abe9b,0x3e3a3e9bbe9b3e3a,0xbe3abe9b3e9bbe3a,0x3e9f3e2fbe8d3e62,0xbeae3dca3d20beb4,0xbe2f3e9fbe62be8d,0xbdcabeae3eb43d20,0x3c0e3eb5be83be7a,0xbeb53c0e3e7abe83,0xbeb53c0e3e7abe83,0xbc0ebeb53e833e7a,0xbe9a3e3e3e54be93,0xbeb0bda73eb3bd66,0xbe3ebe9a3e933e54,0x3da7beb03d663eb3
.quad 0x3ea0be2bbea03e2b,0x3ea0be2bbea03e2b,0xbe2bbea03e2b3ea0,0xbe2bbea03e2b3ea0,0x3eb53c55beaa3dfc,0x3e763e85bea5be17,0x3c55beb53dfc3eaa,0x3e85be76be173ea5,0x3e993e42beb13d9f,0xbe423e99bd9fbeb1,0x3e42be993d9f3eb1,0x3e993e42beb13d9f,0x3e273ea1beb43cf8,0xbeadbddb3e69be8b,0x3ea1be273cf83eb4,0xbddb3eadbe8bbe69
.quad 0xbc8e3eb5beb5bc8e,0x3c8ebeb53eb53c8e,0x3eb53c8ebc8e3eb5,0xbeb5bc8e3c8ebeb5,0xbe453e98beb2bd85,0x3eb1bd963e4d3e95,0x3e983e45bd853eb2,0xbd96beb13e95be4d,0xbea23e23beacbde3,0x3e233ea2bde33eac,0x3e233ea2bde33eac,0x3ea2be233eac3de3,0xbeb5bcb2bea3be1f,0xbe883e70beab3dec,0xbcb23eb5be1f3ea3,0x3e703e883dec3eab
.quad 0x3ea0be2bbea03e2b,0x3ea0be2bbea03e2b,0xbe2bbea03e2b3ea0,0xbe2bbea03e2b3ea0,0xbc553eb5bdfcbeaa,0xbe853e763e17bea5,0x3eb53c55beaa3dfc,0x3e763e85bea5be17,0xbe99be423eb1bd9f,0x3e42be993d9f3eb1,0xbe423e99bd9fbeb1,0xbe99be423eb1bd9f,0x3ea1be273cf83eb4,0xbddb3eadbe8bbe69,0xbe27bea13eb4bcf8,0x3ead3ddbbe693e8b
.quad 0xbc8e3eb5beb5bc8e,0x3c8ebeb53eb53c8e,0x3eb53c8ebc8e3eb5,0xbeb5bc8e3c8ebeb5,0xbe98be453d85beb2,0x3d963eb1be953e4d,0xbe453e98beb2bd85,0x3eb1bd963e4d3e95,0x3ea2be233eac3de3,0xbe23bea23de3beac,0xbe23bea23de3beac,0xbea23e23beacbde3,0xbcb23eb5be1f3ea3,0x3e703e883dec3eab,0x3eb53cb23ea33e1f,0x3e88be703eabbdec
.quad 0xbea0be2b3ea03e2b,0xbea0be2b3ea03e2b,0x3e2bbea0be2b3ea0,0x3e2bbea0be2b3ea0,0x3eb5bc55beaabdfc,0x3e76be85bea53e17,0x3c553eb53dfcbeaa,0x3e853e76be17bea5,0xbe993e423eb13d9f,0x3e423e993d9fbeb1,0xbe42be99bd9f3eb1,0xbe993e423eb13d9f,0x3e27bea1beb4bcf8,0xbead3ddb3e693e8b,0x3ea13e273cf8beb4,0xbddbbeadbe8b3e69
.quad 0x3c8e3eb53eb5bc8e,0xbc8ebeb5beb53c8e,0xbeb53c8e3c8e3eb5,0x3eb5bc8ebc8ebeb5,0xbe45be98beb23d85,0x3eb13d963e4dbe95,0x3e98be45bd85beb2,0xbd963eb13e953e4d,0x3ea23e233eacbde3,0xbe233ea23de33eac,0xbe233ea23de33eac,0xbea2be23beac3de3,0xbeb53cb2bea33e1f,0xbe88be70beabbdec,0xbcb2beb5be1fbea3,0x3e70be883decbeab
.quad 0xbea0be2b3ea03e2b,0xbea0be2b3ea03e2b,0x3e2bbea0be2b3ea0,0x3e2bbea0be2b3ea0,0xbc55beb5bdfc3eaa,0xbe85be763e173ea5,0x3eb5bc55beaabdfc,0x3e76be85bea53e17,0x3e99be42beb1bd9f,0xbe42be99bd9f3eb1,0x3e423e993d9fbeb1,0x3e99be42beb1bd9f,0x3ea13e273cf8beb4,0xbddbbeadbe8b3e69,0xbe273ea13eb43cf8,0x3eadbddbbe69be8b
.quad 0x3c8e3eb53eb5bc8e,0xbc8ebeb5beb53c8e,0xbeb53c8e3c8e3eb5,0x3eb5bc8ebc8ebeb5,0xbe983e453d853eb2,0x3d96beb1be95be4d,0xbe45be98beb23d85,0x3eb13d963e4dbe95,0xbea2be23beac3de3,0x3e23bea2bde3beac,0x3e23bea2bde3beac,0x3ea23e233eacbde3,0xbcb2beb5be1fbea3,0x3e70be883decbeab,0x3eb5bcb23ea3be1f,0x3e883e703eab3dec
.quad 0x80003eb580003eb5,0x80003eb580003eb5,0x3eb500003eb50000,0x3eb500003eb50000,0xbe383e9cbd4c3eb3,0xbeaf3db4be913e59,0x3e9c3e383eb33d4c,0x3db43eaf3e593e91,0xbe9f3e2fbdca3eae,0xbe2fbe9fbeaebdca,0x3e2f3e9f3eae3dca,0xbe9f3e2fbdca3eae,0xbeb5bc32be153ea5,0x3e84be78be00bea9,0xbc323eb53ea53e15,0xbe78be84bea93e00
.quad 0xbe99be42be423e99,0x3e993e423e42be99,0xbe423e993e993e42,0x3e42be99be99be42,0xbe25bea1be6b3e8a,0xbddf3eac3eb4bce7,0xbea13e253e8a3e6b,0x3eac3ddfbce7beb4,0x3cb2beb5be883e70,0xbeb5bcb23e703e88,0xbeb5bcb23e703e88,0xbcb23eb53e88be70,0x3e4bbe96be973e47,0xbd89beb2bd923eb1,0xbe96be4b3e473e97,0xbeb23d893eb13d92
.quad 0x80003eb580003eb5,0x80003eb580003eb5,0x3eb500003eb50000,0x3eb500003eb50000,0xbe9cbe38beb3bd4c,0xbdb4beafbe59be91,0xbe383e9cbd4c3eb3,0xbeaf3db4be913e59,0x3e9fbe2f3dcabeae,0x3e2f3e9f3eae3dca,0xbe2fbe9fbeaebdca,0x3e9fbe2f3dcabeae,0xbc323eb53ea53e15,0xbe78be84bea93e00,0x3eb53c323e15bea5,0xbe843e783e003ea9
.quad 0xbe99be42be423e99,0x3e993e423e42be99,0xbe423e993e993e42,0x3e42be99be99be42,0x3ea1be25be8abe6b,0xbeacbddf3ce73eb4,0xbe25bea1be6b3e8a,0xbddf3eac3eb4bce7,0xbcb23eb53e88be70,0x3eb53cb2be70be88,0x3eb53cb2be70be88,0x3cb2beb5be883e70,0xbe96be4b3e473e97,0xbeb23d893eb13d92,0xbe4b3e963e97be47,0x3d893eb23d92beb1
.quad 0x3eb500003eb5,0x3eb500003eb5,0xbeb50000beb50000,0xbeb50000beb50000,0xbe38be9cbd4cbeb3,0xbeafbdb4be91be59,0x3e9cbe383eb3bd4c,0x3db4beaf3e59be91,0x3e9f3e2f3dca3eae,0x3e2fbe9f3eaebdca,0xbe2f3e9fbeae3dca,0x3e9f3e2f3dca3eae,0xbeb53c32be15bea5,0x3e843e78be003ea9,0xbc32beb53ea5be15,0xbe783e84bea9be00
.quad 0x3e99be423e423e99,0xbe993e42be42be99,0x3e423e99be993e42,0xbe42be993e99be42,0xbe253ea1be6bbe8a,0xbddfbeac3eb43ce7,0xbea1be253e8abe6b,0x3eacbddfbce73eb4,0xbcb2beb53e883e70,0x3eb5bcb2be703e88,0x3eb5bcb2be703e88,0x3cb23eb5be88be70,0x3e4b3e96be97be47,0xbd893eb2bd92beb1,0xbe963e4b3e47be97,0xbeb2bd893eb1bd92
.quad 0x3eb500003eb5,0x3eb500003eb5,0xbeb50000beb50000,0xbeb50000beb50000,0xbe9c3e38beb33d4c,0xbdb43eafbe593e91,0xbe38be9cbd4cbeb3,0xbeafbdb4be91be59,0xbe9fbe2fbdcabeae,0xbe2f3e9fbeae3dca,0x3e2fbe9f3eaebdca,0xbe9fbe2fbdcabeae,0xbc32beb53ea5be15,0xbe783e84bea9be00,0x3eb5bc323e153ea5,0xbe84be783e00bea9
.quad 0x3e99be423e423e99,0xbe993e42be42be99,0x3e423e99be993e42,0xbe42be993e99be42,0x3ea13e25be8a3e6b,0xbeac3ddf3ce7beb4,0xbe253ea1be6bbe8a,0xbddfbeac3eb43ce7,0x3cb23eb5be88be70,0xbeb53cb23e70be88,0xbeb53cb23e70be88,0xbcb2beb53e883e70,0xbe963e4b3e47be97,0xbeb2bd893eb1bd92,0xbe4bbe963e973e47,0x3d89beb23d923eb1
.quad 0x3ea4be1bbea43e1b,0x3ea4be1bbea43e1b,0xbe1bbea43e1b3ea4,0xbe1bbea43e1b3ea4,0x3eb43d05bead3dd6,0x3e673e8bbea0be29,0x3d05beb43dd63ead,0x3e8bbe67be293ea0,0x3e933e54beb33d66,0xbe543e93bd66beb3,0x3e54be933d663eb3,0x3e933e54beb33d66,0x3e113ea6beb53bd5,0xbea8be043e7bbe82,0x3ea6be113bd53eb5,0xbe043ea8be82be7b
.quad 0xbd313eb4beb4bd31,0x3d31beb43eb43d31,0x3eb43d31bd313eb4,0xbeb4bd313d31beb4,0xbe5d3e8fbeafbdbd,0x3eb4bd3a3e343e9d,0x3e8f3e5dbdbd3eaf,0xbd3abeb43e9dbe34,0xbea83e06bea6be0f,0x3e063ea8be0f3ea6,0x3e063ea8be0f3ea6,0x3ea8be063ea63e0f,0xbeb3bd5dbe9bbe3c,0xbe923e56beb03dac,0xbd5d3eb3be3c3e9b,0x3e563e923dac3eb0
.quad 0x3ea4be1bbea43e1b,0x3ea4be1bbea43e1b,0xbe1bbea43e1b3ea4,0xbe1bbea43e1b3ea4,0xbd053eb4bdd6bead,0xbe8b3e673e29bea0,0x3eb43d05bead3dd6,0x3e673e8bbea0be29,0xbe93be543eb3bd66,0x3e54be933d663eb3,0xbe543e93bd66beb3,0xbe93be543eb3bd66,0x3ea6be113bd53eb5,0xbe043ea8be82be7b,0xbe11bea63eb5bbd5,0x3ea83e04be7b3e82
.quad 0xbd313eb4beb4bd31,0x3d31beb43eb43d31,0x3eb43d31bd313eb4,0xbeb4bd313d31beb4,0xbe8fbe5d3dbdbeaf,0x3d3a3eb4be9d3e34,0xbe5d3e8fbeafbdbd,0x3eb4bd3a3e343e9d,0x3ea8be063ea63e0f,0xbe06bea83e0fbea6,0xbe06bea83e0fbea6,0xbea83e06bea6be0f,0xbd5d3eb3be3c3e9b,0x3e563e923dac3eb0,0x3eb33d5d3e9b3e3c,0x3e92be563eb0bdac
.quad 0xbea4be1b3ea43e1b,0xbea4be1b3ea43e1b,0x3e1bbea4be1b3ea4,0x3e1bbea4be1b3ea4,0x3eb4bd05beadbdd6,0x3e67be8bbea03e29,0x3d053eb43dd6bead,0x3e8b3e67be29bea0,0xbe933e543eb33d66,0x3e543e933d66beb3,0xbe54be93bd663eb3,0xbe933e543eb33d66,0x3e11bea6beb5bbd5,0xbea83e043e7b3e82,0x3ea63e113bd5beb5,0xbe04bea8be823e7b
.quad 0x3d313eb43eb4bd31,0xbd31beb4beb43d31,0xbeb43d313d313eb4,0x3eb4bd31bd31beb4,0xbe5dbe8fbeaf3dbd,0x3eb43d3a3e34be9d,0x3e8fbe5dbdbdbeaf,0xbd3a3eb43e9d3e34,0x3ea83e063ea6be0f,0xbe063ea83e0f3ea6,0xbe063ea83e0f3ea6,0xbea8be06bea63e0f,0xbeb33d5dbe9b3e3c,0xbe92be56beb0bdac,0xbd5dbeb3be3cbe9b,0x3e56be923dacbeb0
.quad 0xbea4be1b3ea43e1b,0xbea4be1b3ea43e1b,0x3e1bbea4be1b3ea4,0x3e1bbea4be1b3ea4,0xbd05beb4bdd63ead,0xbe8bbe673e293ea0,0x3eb4bd05beadbdd6,0x3e67be8bbea03e29,0x3e93be54beb3bd66,0xbe54be93bd663eb3,0x3e543e933d66beb3,0x3e93be54beb3bd66,0x3ea63e113bd5beb5,0xbe04bea8be823e7b,0xbe113ea63eb53bd5,0x3ea8be04be7bbe82
.quad 0x3d313eb43eb4bd31,0xbd31beb4beb43d31,0xbeb43d313d313eb4,0x3eb4bd31bd31beb4,0xbe8f3e5d3dbd3eaf,0x3d3abeb4be9dbe34,0xbe5dbe8fbeaf3dbd,0x3eb43d3a3e34be9d,0xbea8be06bea63e0f,0x3e06bea8be0fbea6,0x3e06bea8be0fbea6,0x3ea83e063ea6be0f,0xbd5dbeb3be3cbe9b,0x3e56be923dacbeb0,0x3eb3bd5d3e9bbe3c,0x3e923e563eb03dac
.quad 0x80003eb580003eb5,0x80003eb580003eb5,0x3eb500003eb50000,0x3eb500003eb50000,0xbe3a3e9bbd543eb3,0xbeb03db0be913e58,0x3e9b3e3a3eb33d54,0x3db03eb03e583e91,0xbea03e2bbdd23ead,0xbe2bbea0beadbdd2,0x3e2b3ea03ead3dd2,0xbea03e2bbdd23ead,0xbeb5bc8ebe1b3ea4,0x3e86be73bdf4beaa,0xbc8e3eb53ea43e1b,0xbe73be86beaa3df4
.quad 0xbe97be49be493e97,0x3e973e493e49be97,0xbe493e973e973e49,0x3e49be97be97be49,0xbe1bbea4be733e86,0xbdf43eaa3eb5bc8e,0xbea43e1b3e863e73,0x3eaa3df4bc8ebeb5,0x3d0ebeb4be8c3e66,0xbeb4bd0e3e663e8c,0xbeb4bd0e3e663e8c,0xbd0e3eb43e8cbe66,0x3e58be91be9b3e3a,0xbd54beb3bdb03eb0,0xbe91be583e3a3e9b,0xbeb33d543eb03db0
.quad 0x80003eb580003eb5,0x80003eb580003eb5,0x3eb500003eb50000,0x3eb500003eb50000,0xbe9bbe3abeb3bd54,0xbdb0beb0be58be91,0xbe3a3e9bbd543eb3,0xbeb03db0be913e58,0x3ea0be2b3dd2bead,0x3e2b3ea03ead3dd2,0xbe2bbea0beadbdd2,0x3ea0be2b3dd2bead,0xbc8e3eb53ea43e1b,0xbe73be86beaa3df4,0x3eb53c8e3e1bbea4,0xbe863e733df43eaa
.quad 0xbe97be49be493e97,0x3e973e493e49be97,0xbe493e973e973e49,0x3e49be97be97be49,0x3ea4be1bbe86be73,0xbeaabdf43c8e3eb5,0xbe1bbea4be733e86,0xbdf43eaa3eb5bc8e,0xbd0e3eb43e8cbe66,0x3eb43d0ebe66be8c,0x3eb43d0ebe66be8c,0x3d0ebeb4be8c3e66,0xbe91be583e3a3e9b,0xbeb33d543eb03db0,0xbe583e913e9bbe3a,0x3d543eb33db0beb0
.quad 0x3eb500003eb5,0x3eb500003eb5,0xbeb50000beb50000,0xbeb50000beb50000,0xbe3abe9bbd54beb3,0xbeb0bdb0be91be58,0x3e9bbe3a3eb3bd54,0x3db0beb03e58be91,0x3ea03e2b3dd23ead,0x3e2bbea03eadbdd2,0xbe2b3ea0bead3dd2,0x3ea03e2b3dd23ead,0xbeb53c8ebe1bbea4,0x3e863e73bdf43eaa,0xbc8ebeb53ea4be1b,0xbe733e86beaabdf4
.quad 0x3e97be493e493e97,0xbe973e49be49be97,0x3e493e97be973e49,0xbe49be973e97be49,0xbe1b3ea4be73be86,0xbdf4beaa3eb53c8e,0xbea4be1b3e86be73,0x3eaabdf4bc8e3eb5,0xbd0ebeb43e8c3e66,0x3eb4bd0ebe663e8c,0x3eb4bd0ebe663e8c,0x3d0e3eb4be8cbe66,0x3e583e91be9bbe3a,0xbd543eb3bdb0beb0,0xbe913e583e3abe9b,0xbeb3bd543eb0bdb0
.quad 0x3eb500003eb5,0x3eb500003eb5,0xbeb50000beb50000,0xbeb50000beb50000,0xbe9b3e3abeb33d54,0xbdb03eb0be583e91,0xbe3abe9bbd54beb3,0xbeb0bdb0be91be58,0xbea0be2bbdd2bead,0xbe2b3ea0bead3dd2,0x3e2bbea03eadbdd2,0xbea0be2bbdd2bead,0xbc8ebeb53ea4be1b,0xbe733e86beaabdf4,0x3eb5bc8e3e1b3ea4,0xbe86be733df4beaa
.quad 0x3e97be493e493e97,0xbe973e49be49be97,0x3e493e97be973e49,0xbe49be973e97be49,0x3ea43e1bbe863e73,0xbeaa3df43c8ebeb5,0xbe1b3ea4be73be86,0xbdf4beaa3eb53c8e,0x3d0e3eb4be8cbe66,0xbeb43d0e3e66be8c,0xbeb43d0e3e66be8c,0xbd0ebeb43e8c3e66,0xbe913e583e3abe9b,0xbeb3bd543eb0bdb0,0xbe58be913e9b3e3a,0x3d54beb33db03eb0
.quad 0x3ea7be0bbea73e0b,0x3ea7be0bbea73e0b,0xbe0bbea73e0b3ea7,0xbe0bbea73e0b3ea7,0x3eb33d54beb03db0,0x3e583e91be9bbe3a,0x3d54beb33db03eb0,0x3e91be58be3a3e9b,0x3e8c3e66beb43d0e,0xbe663e8cbd0ebeb4,0x3e66be8c3d0e3eb4,0x3e8c3e66beb43d0e,0x3df43eaabeb5bc8e,0xbea4be1b3e86be73,0x3eaabdf4bc8e3eb5,0xbe1b3ea4be73be86
.quad 0xbd8d3eb2beb2bd8d,0x3d8dbeb23eb23d8d,0x3eb23d8dbd8d3eb2,0xbeb2bd8d3d8dbeb2,0xbe733e86beaabdf4,0x3eb5bc8e3e1b3ea4,0x3e863e73bdf43eaa,0xbc8ebeb53ea4be1b,0xbead3dd2bea0be2b,0x3dd23eadbe2b3ea0,0x3dd23eadbe2b3ea0,0x3eadbdd23ea03e2b,0xbeb0bdb0be91be58,0xbe9b3e3abeb33d54,0xbdb03eb0be583e91,0x3e3a3e9b3d543eb3
.quad 0x3ea7be0bbea73e0b,0x3ea7be0bbea73e0b,0xbe0bbea73e0b3ea7,0xbe0bbea73e0b3ea7,0xbd543eb3bdb0beb0,0xbe913e583e3abe9b,0x3eb33d54beb03db0,0x3e583e91be9bbe3a,0xbe8cbe663eb4bd0e,0x3e66be8c3d0e3eb4,0xbe663e8cbd0ebeb4,0xbe8cbe663eb4bd0e,0x3eaabdf4bc8e3eb5,0xbe1b3ea4be73be86,0xbdf4beaa3eb53c8e,0x3ea43e1bbe863e73
.quad 0xbd8d3eb2beb2bd8d,0x3d8dbeb23eb23d8d,0x3eb23d8dbd8d3eb2,0xbeb2bd8d3d8dbeb2,0xbe86be733df4beaa,0x3c8e3eb5bea43e1b,0xbe733e86beaabdf4,0x3eb5bc8e3e1b3ea4,0x3eadbdd23ea03e2b,0xbdd2bead3e2bbea0,0xbdd2bead3e2bbea0,0xbead3dd2bea0be2b,0xbdb03eb0be583e91,0x3e3a3e9b3d543eb3,0x3eb03db03e913e58,0x3e9bbe3a3eb3bd54
.quad 0xbea7be0b3ea73e0b,0xbea7be0b3ea73e0b,0x3e0bbea7be0b3ea7,0x3e0bbea7be0b3ea7,0x3eb3bd54beb0bdb0,0x3e58be91be9b3e3a,0x3d543eb33db0beb0,0x3e913e58be3abe9b,0xbe8c3e663eb43d0e,0x3e663e8c3d0ebeb4,0xbe66be8cbd0e3eb4,0xbe8c3e663eb43d0e,0x3df4beaabeb53c8e,0xbea43e1b3e863e73,0x3eaa3df4bc8ebeb5,0xbe1bbea4be733e86
.quad 0x3d8d3eb23eb2bd8d,0xbd8dbeb2beb23d8d,0xbeb23d8d3d8d3eb2,0x3eb2bd8dbd8dbeb2,0xbe73be86beaa3df4,0x3eb53c8e3e1bbea4,0x3e86be73bdf4beaa,0xbc8e3eb53ea43e1b,0x3ead3dd23ea0be2b,0xbdd23ead3e2b3ea0,0xbdd23ead3e2b3ea0,0xbeadbdd2bea03e2b,0xbeb03db0be913e58,0xbe9bbe3abeb3bd54,0xbdb0beb0be58be91,0x3e3abe9b3d54beb3
.quad 0xbea7be0b3ea73e0b,0xbea7be0b3ea73e0b,0x3e0bbea7be0b3ea7,0x3e0bbea7be0b3ea7,0xbd54beb3bdb03eb0,0xbe91be583e3a3e9b,0x3eb3bd54beb0bdb0,0x3e58be91be9b3e3a,0x3e8cbe66beb4bd0e,0xbe66be8cbd0e3eb4,0x3e663e8c3d0ebeb4,0x3e8cbe66beb4bd0e,0x3eaa3df4bc8ebeb5,0xbe1bbea4be733e86,0xbdf43eaa3eb5bc8e,0x3ea4be1bbe86be73
.quad 0x3d8d3eb23eb2bd8d,0xbd8dbeb2beb23d8d,0xbeb23d8d3d8d3eb2,0x3eb2bd8dbd8dbeb2,0xbe863e733df43eaa,0x3c8ebeb5bea4be1b,0xbe73be86beaa3df4,0x3eb53c8e3e1bbea4,0xbeadbdd2bea03e2b,0x3dd2beadbe2bbea0,0x3dd2beadbe2bbea0,0x3ead3dd23ea0be2b,0xbdb0beb0be58be91,0x3e3abe9b3d54beb3,0x3eb0bdb03e91be58,0x3e9b3e3a3eb33d54
.quad 0x80003eb580003eb5,0x80003eb580003eb5,0x3eb500003eb50000,0x3eb500003eb50000,0xbe3c3e9bbd5d3eb3,0xbeb03dacbe923e56,0x3e9b3e3c3eb33d5d,0x3dac3eb03e563e92,0xbea13e27bddb3ead,0xbe27bea1beadbddb,0x3e273ea13ead3ddb,0xbea13e27bddb3ead,0xbeb5bcc3be213ea2,0x3e88be6ebde7beac,0xbcc33eb53ea23e21,0xbe6ebe88beac3de7
.quad 0xbe94be50be503e94,0x3e943e503e50be94,0xbe503e943e943e50,0x3e50be94be94be50,0xbe11bea6be7b3e82,0xbe043ea83eb5bbd5,0xbea63e113e823e7b,0x3ea83e04bbd5beb5,0x3d43beb3be903e5b,0xbeb3bd433e5b3e90,0xbeb3bd433e5b3e90,0xbd433eb33e90be5b,0x3e64be8dbe9f3e2d,0xbd17beb4bdce3eae,0xbe8dbe643e2d3e9f,0xbeb43d173eae3dce
.quad 0x80003eb580003eb5,0x80003eb580003eb5,0x3eb500003eb50000,0x3eb500003eb50000,0xbe9bbe3cbeb3bd5d,0xbdacbeb0be56be92,0xbe3c3e9bbd5d3eb3,0xbeb03dacbe923e56,0x3ea1be273ddbbead,0x3e273ea13ead3ddb,0xbe27bea1beadbddb,0x3ea1be273ddbbead,0xbcc33eb53ea23e21,0xbe6ebe88beac3de7,0x3eb53cc33e21bea2,0xbe883e6e3de73eac
.quad 0xbe94be50be503e94,0x3e943e503e50be94,0xbe503e943e943e50,0x3e50be94be94be50,0x3ea6be11be82be7b,0xbea8be043bd53eb5,0xbe11bea6be7b3e82,0xbe043ea83eb5bbd5,0xbd433eb33e90be5b,0x3eb33d43be5bbe90,0x3eb33d43be5bbe90,0x3d43beb3be903e5b,0xbe8dbe643e2d3e9f,0xbeb43d173eae3dce,0xbe643e8d3e9fbe2d,0x3d173eb43dcebeae
.quad 0x3eb500003eb5,0x3eb500003eb5,0xbeb50000beb50000,0xbeb50000beb50000,0xbe3cbe9bbd5dbeb3,0xbeb0bdacbe92be56,0x3e9bbe3c3eb3bd5d,0x3dacbeb03e56be92,0x3ea13e273ddb3ead,0x3e27bea13eadbddb,0xbe273ea1bead3ddb,0x3ea13e273ddb3ead,0xbeb53cc3be21bea2,0x3e883e6ebde73eac,0xbcc3beb53ea2be21,0xbe6e3e88beacbde7
.quad 0x3e94be503e503e94,0xbe943e50be50be94,0x3e503e94be943e50,0xbe50be943e94be50,0xbe113ea6be7bbe82,0xbe04bea83eb53bd5,0xbea6be113e82be7b,0x3ea8be04bbd53eb5,0xbd43beb33e903e5b,0x3eb3bd43be5b3e90,0x3eb3bd43be5b3e90,0x3d433eb3be90be5b,0x3e643e8dbe9fbe2d,0xbd173eb4bdcebeae,0xbe8d3e643e2dbe9f,0xbeb4bd173eaebdce
.quad 0x3eb500003eb5,0x3eb500003eb5,0xbeb50000beb50000,0xbeb50000beb50000,0xbe9b3e3cbeb33d5d,0xbdac3eb0be563e92,0xbe3cbe9bbd5dbeb3,0xbeb0bdacbe92be56,0xbea1be27bddbbead,0xbe273ea1bead3ddb,0x3e27bea13eadbddb,0xbea1be27bddbbead,0xbcc3beb53ea2be21,0xbe6e3e88beacbde7,0x3eb5bcc33e213ea2,0xbe88be6e3de7beac
.quad 0x3e94be503e503e94,0xbe943e50be50be94,0x3e503e94be943e50,0xbe50be943e94be50,0x3ea63e11be823e7b,0xbea83e043bd5beb5,0xbe113ea6be7bbe82,0xbe04bea83eb53bd5,0x3d433eb3be90be5b,0xbeb33d433e5bbe90,0xbeb33d433e5bbe90,0xbd43beb33e903e5b,0xbe8d3e643e2dbe9f,0xbeb4bd173eaebdce,0xbe64be8d3e9f3e2d,0x3d17beb43dce3eae
.quad 0x3eaabdf4beaa3df4,0x3eaabdf4beaa3df4,0xbdf4beaa3df43eaa,0xbdf4beaa3df43eaa,0x3eb13d92beb23d89,0x3e473e97be96be4b,0x3d92beb13d893eb2,0x3e97be47be4b3e96,0x3e853e76beb53c55,0xbe763e85bc55beb5,0x3e76be853c553eb5,0x3e853e76beb53c55,0x3dc53eaebeb4bd28,0xbe9ebe313e8ebe60,0x3eaebdc5bd283eb4,0xbe313e9ebe60be8e
.quad 0xbdc13eaebeaebdc1,0x3dc1beae3eae3dc1,0x3eae3dc1bdc13eae,0xbeaebdc13dc1beae,0xbe843e78bea5be15,0x3eb53c323e003ea9,0x3e783e84be153ea5,0x3c32beb53ea9be00,0xbeb13d96be98be45,0x3d963eb1be453e98,0x3d963eb1be453e98,0x3eb1bd963e983e45,0xbeabbdf0be87be71,0xbea33e1dbeb53ca0,0xbdf03eabbe713e87,0x3e1d3ea33ca03eb5
.quad 0x3eaabdf4beaa3df4,0x3eaabdf4beaa3df4,0xbdf4beaa3df43eaa,0xbdf4beaa3df43eaa,0xbd923eb1bd89beb2,0xbe973e473e4bbe96,0x3eb13d92beb23d89,0x3e473e97be96be4b,0xbe85be763eb5bc55,0x3e76be853c553eb5,0xbe763e85bc55beb5,0xbe85be763eb5bc55,0x3eaebdc5bd283eb4,0xbe313e9ebe60be8e,0xbdc5beae3eb43d28,0x3e9e3e31be8e3e60
.quad 0xbdc13eaebeaebdc1,0x3dc1beae3eae3dc1,0x3eae3dc1bdc13eae,0xbeaebdc13dc1beae,0xbe78be843e15bea5,0xbc323eb5bea93e00,0xbe843e78bea5be15,0x3eb53c323e003ea9,0x3eb1bd963e983e45,0xbd96beb13e45be98,0xbd96beb13e45be98,0xbeb13d96be98be45,0xbdf03eabbe713e87,0x3e1d3ea33ca03eb5,0x3eab3df03e873e71,0x3ea3be1d3eb5bca0
.quad 0xbeaabdf43eaa3df4,0xbeaabdf43eaa3df4,0x3df4beaabdf43eaa,0x3df4beaabdf43eaa,0x3eb1bd92beb2bd89,0x3e47be97be963e4b,0x3d923eb13d89beb2,0x3e973e47be4bbe96,0xbe853e763eb53c55,0x3e763e853c55beb5,0xbe76be85bc553eb5,0xbe853e763eb53c55,0x3dc5beaebeb43d28,0xbe9e3e313e8e3e60,0x3eae3dc5bd28beb4,0xbe31be9ebe603e8e
.quad 0x3dc13eae3eaebdc1,0xbdc1beaebeae3dc1,0xbeae3dc13dc13eae,0x3eaebdc1bdc1beae,0xbe84be78bea53e15,0x3eb5bc323e00bea9,0x3e78be84be15bea5,0x3c323eb53ea93e00,0x3eb13d963e98be45,0xbd963eb13e453e98,0xbd963eb13e453e98,0xbeb1bd96be983e45,0xbeab3df0be873e71,0xbea3be1dbeb5bca0,0xbdf0beabbe71be87,0x3e1dbea33ca0beb5
.quad 0xbeaabdf43eaa3df4,0xbeaabdf43eaa3df4,0x3df4beaabdf43eaa,0x3df4beaabdf43eaa,0xbd92beb1bd893eb2,0xbe97be473e4b3e96,0x3eb1bd92beb2bd89,0x3e47be97be963e4b,0x3e85be76beb5bc55,0xbe76be85bc553eb5,0x3e763e853c55beb5,0x3e85be76beb5bc55,0x3eae3dc5bd28beb4,0xbe31be9ebe603e8e,0xbdc53eae3eb4bd28,0x3e9ebe31be8ebe60
.quad 0x3dc13eae3eaebdc1,0xbdc1beaebeae3dc1,0xbeae3dc13dc13eae,0x3eaebdc1bdc1beae,0xbe783e843e153ea5,0xbc32beb5bea9be00,0xbe84be78bea53e15,0x3eb5bc323e00bea9,0xbeb1bd96be983e45,0x3d96beb1be45be98,0x3d96beb1be45be98,0x3eb13d963e98be45,0xbdf0beabbe71be87,0x3e1dbea33ca0beb5,0x3eabbdf03e87be71,0x3ea33e1d3eb53ca0
.quad 0x80003eb580003eb5,0x80003eb580003eb5,0x3eb500003eb50000,0x3eb500003eb50000,0xbe3e3e9abd663eb3,0xbeb03da7be933e54,0x3e9a3e3e3eb33d66,0x3da73eb03e543e93,0xbea23e23bde33eac,0xbe23bea2beacbde3,0x3e233ea23eac3de3,0xbea23e23bde33eac,0xbeb4bcf8be273ea1,0x3e8bbe69bddbbead,0xbcf83eb43ea13e27,0xbe69be8bbead3ddb
.quad 0xbe91be58be583e91,0x3e913e583e58be91,0xbe583e913e913e58,0x3e58be91be91be58,0xbe06bea8be823e7d,0xbe0f3ea63eb53b8e,0xbea83e063e7d3e82,0x3ea63e0f3b8ebeb5,0x3d78beb2be943e50,0xbeb2bd783e503e94,0xbeb2bd783e503e94,0xbd783eb23e94be50,0x3e70be88bea33e1f,0xbcb2beb5bdec3eab,0xbe88be703e1f3ea3,0xbeb53cb23eab3dec
.quad 0x80003eb580003eb5,0x80003eb580003eb5,0x3eb500003eb50000,0x3eb500003eb50000,0xbe9abe3ebeb3bd66,0xbda7beb0be54be93,0xbe3e3e9abd663eb3,0xbeb03da7be933e54,0x3ea2be233de3beac,0x3e233ea23eac3de3,0xbe23bea2beacbde3,0x3ea2be233de3beac,0xbcf83eb43ea13e27,0xbe69be8bbead3ddb,0x3eb43cf83e27bea1,0xbe8b3e693ddb3ead
.quad 0xbe91be58be583e91,0x3e913e583e58be91,0xbe583e913e913e58,0x3e58be91be91be58,0x3ea8be06be7dbe82,0xbea6be0fbb8e3eb5,0xbe06bea8be823e7d,0xbe0f3ea63eb53b8e,0xbd783eb23e94be50,0x3eb23d78be50be94,0x3eb23d78be50be94,0x3d78beb2be943e50,0xbe88be703e1f3ea3,0xbeb53cb23eab3dec,0xbe703e883ea3be1f,0x3cb23eb53decbeab
.quad 0x3eb500003eb5,0x3eb500003eb5,0xbeb50000beb50000,0xbeb50000beb50000,0xbe3ebe9abd66beb3,0xbeb0bda7be93be54,0x3e9abe3e3eb3bd66,0x3da7beb03e54be93,0x3ea23e233de33eac,0x3e23bea23eacbde3,0xbe233ea2beac3de3,0x3ea23e233de33eac,0xbeb43cf8be27bea1,0x3e8b3e69bddb3ead,0xbcf8beb43ea1be27,0xbe693e8bbeadbddb
.quad 0x3e91be583e583e91,0xbe913e58be58be91,0x3e583e91be913e58,0xbe58be913e91be58,0xbe063ea8be82be7d,0xbe0fbea63eb5bb8e,0xbea8be063e7dbe82,0x3ea6be0f3b8e3eb5,0xbd78beb23e943e50,0x3eb2bd78be503e94,0x3eb2bd78be503e94,0x3d783eb2be94be50,0x3e703e88bea3be1f,0xbcb23eb5bdecbeab,0xbe883e703e1fbea3,0xbeb5bcb23eabbdec
.quad 0x3eb500003eb5,0x3eb500003eb5,0xbeb50000beb50000,0xbeb50000beb50000,0xbe9a3e3ebeb33d66,0xbda73eb0be543e93,0xbe3ebe9abd66beb3,0xbeb0bda7be93be54,0xbea2be23bde3beac,0xbe233ea2beac3de3,0x3e23bea23eacbde3,0xbea2be23bde3beac,0xbcf8beb43ea1be27,0xbe693e8bbeadbddb,0x3eb4bcf83e273ea1,0xbe8bbe693ddbbead
.quad 0x3e91be583e583e91,0xbe913e58be58be91,0x3e583e91be913e58,0xbe58be913e91be58,0x3ea83e06be7d3e82,0xbea63e0fbb8ebeb5,0xbe063ea8be82be7d,0xbe0fbea63eb5bb8e,0x3d783eb2be94be50,0xbeb23d783e50be94,0xbeb23d783e50be94,0xbd78beb23e943e50,0xbe883e703e1fbea3,0xbeb5bcb23eabbdec,0xbe70be883ea33e1f,0x3cb2beb53dec3eab
.quad 0x3eadbdd2bead3dd2,0x3eadbdd2bead3dd2,0xbdd2bead3dd23ead,0xbdd2bead3dd23ead,0x3eaf3db9beb33d43,0x3e363e9cbe90be5b,0x3db9beaf3d433eb3,0x3e9cbe36be5b3e90,0x3e7a3e83beb5bc0e,0xbe833e7a3c0ebeb5,0x3e83be7abc0e3eb5,0x3e7a3e83beb5bc0e,0x3d963eb1beb2bd85,0xbe98be453e95be4d,0x3eb1bd96bd853eb2,0xbe453e98be4dbe95
.quad 0xbdf43eaabeaabdf4,0x3df4beaa3eaa3df4,0x3eaa3df4bdf43eaa,0xbeaabdf43df4beaa,0xbe8d3e62be9fbe2f,0x3eb43d203dca3eae,0x3e623e8dbe2f3e9f,0x3d20beb43eaebdca,0xbeb43d31be8fbe5f,0x3d313eb4be5f3e8f,0x3d313eb4be5f3e8f,0x3eb4bd313e8f3e5f,0xbea5be17be76be85,0xbeaa3dfcbeb5bc55,0xbe173ea5be853e76,0x3dfc3eaabc553eb5
.quad 0x3eadbdd2bead3dd2,0x3eadbdd2bead3dd2,0xbdd2bead3dd23ead,0xbdd2bead3dd23ead,0xbdb93eafbd43beb3,0xbe9c3e363e5bbe90,0x3eaf3db9beb33d43,0x3e363e9cbe90be5b,0xbe7abe833eb53c0e,0x3e83be7abc0e3eb5,0xbe833e7a3c0ebeb5,0xbe7abe833eb53c0e,0x3eb1bd96bd853eb2,0xbe453e98be4dbe95,0xbd96beb13eb23d85,0x3e983e45be953e4d
.quad 0xbdf43eaabeaabdf4,0x3df4beaa3eaa3df4,0x3eaa3df4bdf43eaa,0xbeaabdf43df4beaa,0xbe62be8d3e2fbe9f,0xbd203eb4beae3dca,0xbe8d3e62be9fbe2f,0x3eb43d203dca3eae,0x3eb4bd313e8f3e5f,0xbd31beb43e5fbe8f,0xbd31beb43e5fbe8f,0xbeb43d31be8fbe5f,0xbe173ea5be853e76,0x3dfc3eaabc553eb5,0x3ea53e173e763e85,0x3eaabdfc3eb53c55
.quad 0xbeadbdd23ead3dd2,0xbeadbdd23ead3dd2,0x3dd2beadbdd23ead,0x3dd2beadbdd23ead,0x3eafbdb9beb3bd43,0x3e36be9cbe903e5b,0x3db93eaf3d43beb3,0x3e9c3e36be5bbe90,0xbe7a3e833eb5bc0e,0x3e833e7abc0ebeb5,0xbe83be7a3c0e3eb5,0xbe7a3e833eb5bc0e,0x3d96beb1beb23d85,0xbe983e453e953e4d,0x3eb13d96bd85beb2,0xbe45be98be4d3e95
.quad 0x3df43eaa3eaabdf4,0xbdf4beaabeaa3df4,0xbeaa3df43df43eaa,0x3eaabdf4bdf4beaa,0xbe8dbe62be9f3e2f,0x3eb4bd203dcabeae,0x3e62be8dbe2fbe9f,0x3d203eb43eae3dca,0x3eb43d313e8fbe5f,0xbd313eb43e5f3e8f,0xbd313eb43e5f3e8f,0xbeb4bd31be8f3e5f,0xbea53e17be763e85,0xbeaabdfcbeb53c55,0xbe17bea5be85be76,0x3dfcbeaabc55beb5
.quad 0xbeadbdd23ead3dd2,0xbeadbdd23ead3dd2,0x3dd2beadbdd23ead,0x3dd2beadbdd23ead,0xbdb9beafbd433eb3,0xbe9cbe363e5b3e90,0x3eafbdb9beb3bd43,0x3e36be9cbe903e5b,0x3e7abe83beb53c0e,0xbe83be7a3c0e3eb5,0x3e833e7abc0ebeb5,0x3e7abe83beb53c0e,0x3eb13d96bd85beb2,0xbe45be98be4d3e95,0xbd963eb13eb2bd85,0x3e98be45be95be4d
.quad 0x3df43eaa3eaabdf4,0xbdf4beaabeaa3df4,0xbeaa3df43df43eaa,0x3eaabdf4bdf4beaa,0xbe623e8d3e2f3e9f,0xbd20beb4beaebdca,0xbe8dbe62be9f3e2f,0x3eb4bd203dcabeae,0xbeb4bd31be8f3e5f,0x3d31beb4be5fbe8f,0x3d31beb4be5fbe8f,0x3eb43d313e8fbe5f,0xbe17bea5be85be76,0x3dfcbeaabc55beb5,0x3ea5be173e76be85,0x3eaa3dfc3eb5bc55
.quad 0x80003eb580003eb5,0x80003eb580003eb5,0x3eb500003eb50000,0x3eb500003eb50000,0xbe403e9abd6f3eb3,0xbeb03da3be933e52,0x3e9a3e403eb33d6f,0x3da33eb03e523e93,0xbea33e1fbdec3eab,0xbe1fbea3beabbdec,0x3e1f3ea33eab3dec,0xbea33e1fbdec3eab,0xbeb4bd17be2d3e9f,0x3e8dbe64bdcebeae,0xbd173eb43e9f3e2d,0xbe64be8dbeae3dce
.quad 0xbe8fbe5fbe5f3e8f,0x3e8f3e5f3e5fbe8f,0xbe5f3e8f3e8f3e5f,0x3e5fbe8fbe8fbe5f,0xbdf8beaabe853e75,0xbe193ea43eb53c79,0xbeaa3df83e753e85,0x3ea43e193c79beb5,0x3d96beb1be983e45,0xbeb1bd963e453e98,0xbeb1bd963e453e98,0xbd963eb13e98be45,0x3e7bbe82bea63e11,0xbbd5beb5be043ea8,0xbe82be7b3e113ea6,0xbeb53bd53ea83e04
.quad 0x80003eb580003eb5,0x80003eb580003eb5,0x3eb500003eb50000,0x3eb500003eb50000,0xbe9abe40beb3bd6f,0xbda3beb0be52be93,0xbe403e9abd6f3eb3,0xbeb03da3be933e52,0x3ea3be1f3decbeab,0x3e1f3ea33eab3dec,0xbe1fbea3beabbdec,0x3ea3be1f3decbeab,0xbd173eb43e9f3e2d,0xbe64be8dbeae3dce,0x3eb43d173e2dbe9f,0xbe8d3e643dce3eae
.quad 0xbe8fbe5fbe5f3e8f,0x3e8f3e5f3e5fbe8f,0xbe5f3e8f3e8f3e5f,0x3e5fbe8fbe8fbe5f,0x3eaabdf8be75be85,0xbea4be19bc793eb5,0xbdf8beaabe853e75,0xbe193ea43eb53c79,0xbd963eb13e98be45,0x3eb13d96be45be98,0x3eb13d96be45be98,0x3d96beb1be983e45,0xbe82be7b3e113ea6,0xbeb53bd53ea83e04,0xbe7b3e823ea6be11,0x3bd53eb53e04bea8
.quad 0x3eb500003eb5,0x3eb500003eb5,0xbeb50000beb50000,0xbeb50000beb50000,0xbe40be9abd6fbeb3,0xbeb0bda3be93be52,0x3e9abe403eb3bd6f,0x3da3beb03e52be93,0x3ea33e1f3dec3eab,0x3e1fbea33eabbdec,0xbe1f3ea3beab3dec,0x3ea33e1f3dec3eab,0xbeb43d17be2dbe9f,0x3e8d3e64bdce3eae,0xbd17beb43e9fbe2d,0xbe643e8dbeaebdce
.quad 0x3e8fbe5f3e5f3e8f,0xbe8f3e5fbe5fbe8f,0x3e5f3e8fbe8f3e5f,0xbe5fbe8f3e8fbe5f,0xbdf83eaabe85be75,0xbe19bea43eb5bc79,0xbeaabdf83e75be85,0x3ea4be193c793eb5,0xbd96beb13e983e45,0x3eb1bd96be453e98,0x3eb1bd96be453e98,0x3d963eb1be98be45,0x3e7b3e82bea6be11,0xbbd53eb5be04bea8,0xbe823e7b3e11bea6,0xbeb5bbd53ea8be04
.quad 0x3eb500003eb5,0x3eb500003eb5,0xbeb50000beb50000,0xbeb50000beb50000,0xbe9a3e40beb33d6f,0xbda33eb0be523e93,0xbe40be9abd6fbeb3,0xbeb0bda3be93be52,0xbea3be1fbdecbeab,0xbe1f3ea3beab3dec,0x3e1fbea33eabbdec,0xbea3be1fbdecbeab,0xbd17beb43e9fbe2d,0xbe643e8dbeaebdce,0x3eb4bd173e2d3e9f,0xbe8dbe643dcebeae
.quad 0x3e8fbe5f3e5f3e8f,0xbe8f3e5fbe5fbe8f,0x3e5f3e8fbe8f3e5f,0xbe5fbe8f3e8fbe5f,0x3eaa3df8be753e85,0xbea43e19bc79beb5,0xbdf83eaabe85be75,0xbe19bea43eb5bc79,0x3d963eb1be98be45,0xbeb13d963e45be98,0xbeb13d963e45be98,0xbd96beb13e983e45,0xbe823e7b3e11bea6,0xbeb5bbd53ea8be04,0xbe7bbe823ea63e11,0x3bd5beb53e043ea8
.quad 0x3eb0bdb0beb03db0,0x3eb0bdb0beb03db0,0xbdb0beb03db03eb0,0xbdb0beb03db03eb0,0x3eac3ddfbeb43ce7,0x3e253ea1be8abe6b,0x3ddfbeac3ce73eb4,0x3ea1be25be6b3e8a,0x3e693e8bbeb4bcf8,0xbe8b3e693cf8beb4,0x3e8bbe69bcf83eb4,0x3e693e8bbeb4bcf8,0x3d4c3eb3beafbdb4,0xbe91be593e9cbe38,0x3eb3bd4cbdb43eaf,0xbe593e91be38be9c
.quad 0xbe133ea5bea5be13,0x3e13bea53ea53e13,0x3ea53e13be133ea5,0xbea5be133e13bea5,0xbe963e4bbe97be47,0x3eb23d893d923eb1,0x3e4b3e96be473e97,0x3d89beb23eb1bd92,0xbeb53c55be85be76,0x3c553eb5be763e85,0x3c553eb5be763e85,0x3eb5bc553e853e76,0xbe9dbe34be5dbe8f,0xbeaf3dbdbeb4bd3a,0xbe343e9dbe8f3e5d,0x3dbd3eafbd3a3eb4
.quad 0x3eb0bdb0beb03db0,0x3eb0bdb0beb03db0,0xbdb0beb03db03eb0,0xbdb0beb03db03eb0,0xbddf3eacbce7beb4,0xbea13e253e6bbe8a,0x3eac3ddfbeb43ce7,0x3e253ea1be8abe6b,0xbe69be8b3eb43cf8,0x3e8bbe69bcf83eb4,0xbe8b3e693cf8beb4,0xbe69be8b3eb43cf8,0x3eb3bd4cbdb43eaf,0xbe593e91be38be9c,0xbd4cbeb33eaf3db4,0x3e913e59be9c3e38
.quad 0xbe133ea5bea5be13,0x3e13bea53ea53e13,0x3ea53e13be133ea5,0xbea5be133e13bea5,0xbe4bbe963e47be97,0xbd893eb2beb13d92,0xbe963e4bbe97be47,0x3eb23d893d923eb1,0x3eb5bc553e853e76,0xbc55beb53e76be85,0xbc55beb53e76be85,0xbeb53c55be85be76,0xbe343e9dbe8f3e5d,0x3dbd3eafbd3a3eb4,0x3e9d3e343e5d3e8f,0x3eafbdbd3eb43d3a
.quad 0xbeb0bdb03eb03db0,0xbeb0bdb03eb03db0,0x3db0beb0bdb03eb0,0x3db0beb0bdb03eb0,0x3eacbddfbeb4bce7,0x3e25bea1be8a3e6b,0x3ddf3eac3ce7beb4,0x3ea13e25be6bbe8a,0xbe693e8b3eb4bcf8,0x3e8b3e69bcf8beb4,0xbe8bbe693cf83eb4,0xbe693e8b3eb4bcf8,0x3d4cbeb3beaf3db4,0xbe913e593e9c3e38,0x3eb33d4cbdb4beaf,0xbe59be91be383e9c
.quad 0x3e133ea53ea5be13,0xbe13bea5bea53e13,0xbea53e133e133ea5,0x3ea5be13be13bea5,0xbe96be4bbe973e47,0x3eb2bd893d92beb1,0x3e4bbe96be47be97,0x3d893eb23eb13d92,0x3eb53c553e85be76,0xbc553eb53e763e85,0xbc553eb53e763e85,0xbeb5bc55be853e76,0xbe9d3e34be5d3e8f,0xbeafbdbdbeb43d3a,0xbe34be9dbe8fbe5d,0x3dbdbeafbd3abeb4
.quad 0xbeb0bdb03eb03db0,0xbeb0bdb03eb03db0,0x3db0beb0bdb03eb0,0x3db0beb0bdb03eb0,0xbddfbeacbce73eb4,0xbea1be253e6b3e8a,0x3eacbddfbeb4bce7,0x3e25bea1be8a3e6b,0x3e69be8bbeb43cf8,0xbe8bbe693cf83eb4,0x3e8b3e69bcf8beb4,0x3e69be8bbeb43cf8,0x3eb33d4cbdb4beaf,0xbe59be91be383e9c,0xbd4c3eb33eafbdb4,0x3e91be59be9cbe38
.quad 0x3e133ea53ea5be13,0xbe13bea5bea53e13,0xbea53e133e133ea5,0x3ea5be13be13bea5,0xbe4b3e963e473e97,0xbd89beb2beb1bd92,0xbe96be4bbe973e47,0x3eb2bd893d92beb1,0xbeb5bc55be853e76,0x3c55beb5be76be85,0x3c55beb5be76be85,0x3eb53c553e85be76,0xbe34be9dbe8fbe5d,0x3dbdbeafbd3abeb4,0x3e9dbe343e5dbe8f,0x3eaf3dbd3eb4bd3a
.quad 0x80003eb580003eb5,0x80003eb580003eb5,0x3eb500003eb50000,0x3eb500003eb50000,0xbe423e99bd783eb2,0xbeb13d9fbe943e50,0x3e993e423eb23d78,0x3d9f3eb13e503e94,0xbea43e1bbdf43eaa,0xbe1bbea4beaabdf4,0x3e1b3ea43eaa3df4,0xbea43e1bbdf43eaa,0xbeb4bd31be323e9e,0x3e8fbe5fbdc1beae,0xbd313eb43e9e3e32,0xbe5fbe8fbeae3dc1
.quad 0xbe8cbe66be663e8c,0x3e8c3e663e66be8c,0xbe663e8c3e8c3e66,0x3e66be8cbe8cbe66,0xbde3beacbe893e6c,0xbe233ea23eb53cd5,0xbeac3de33e6c3e89,0x3ea23e233cd5beb5,0x3db0beb0be9b3e3a,0xbeb0bdb03e3a3e9b,0xbeb0bdb03e3a3e9b,0xbdb03eb03e9bbe3a,0x3e83be7abea93e02,0x3c0ebeb5be133ea5,0xbe7abe833e023ea9,0xbeb5bc0e3ea53e13
.quad 0x80003eb580003eb5,0x80003eb580003eb5,0x3eb500003eb50000,0x3eb500003eb50000,0xbe99be42beb2bd78,0xbd9fbeb1be50be94,0xbe423e99bd783eb2,0xbeb13d9fbe943e50,0x3ea4be1b3df4beaa,0x3e1b3ea43eaa3df4,0xbe1bbea4beaabdf4,0x3ea4be1b3df4beaa,0xbd313eb43e9e3e32,0xbe5fbe8fbeae3dc1,0x3eb43d313e32be9e,0xbe8f3e5f3dc13eae
.quad 0xbe8cbe66be663e8c,0x3e8c3e663e66be8c,0xbe663e8c3e8c3e66,0x3e66be8cbe8cbe66,0x3eacbde3be6cbe89,0xbea2be23bcd53eb5,0xbde3beacbe893e6c,0xbe233ea23eb53cd5,0xbdb03eb03e9bbe3a,0x3eb03db0be3abe9b,0x3eb03db0be3abe9b,0x3db0beb0be9b3e3a,0xbe7abe833e023ea9,0xbeb5bc0e3ea53e13,0xbe833e7a3ea9be02,0xbc0e3eb53e13bea5
.quad 0x3eb500003eb5,0x3eb500003eb5,0xbeb50000beb50000,0xbeb50000beb50000,0xbe42be99bd78beb2,0xbeb1bd9fbe94be50,0x3e99be423eb2bd78,0x3d9fbeb13e50be94,0x3ea43e1b3df43eaa,0x3e1bbea43eaabdf4,0xbe1b3ea4beaa3df4,0x3ea43e1b3df43eaa,0xbeb43d31be32be9e,0x3e8f3e5fbdc13eae,0xbd31beb43e9ebe32,0xbe5f3e8fbeaebdc1
.quad 0x3e8cbe663e663e8c,0xbe8c3e66be66be8c,0x3e663e8cbe8c3e66,0xbe66be8c3e8cbe66,0xbde33eacbe89be6c,0xbe23bea23eb5bcd5,0xbeacbde33e6cbe89,0x3ea2be233cd53eb5,0xbdb0beb03e9b3e3a,0x3eb0bdb0be3a3e9b,0x3eb0bdb0be3a3e9b,0x3db03eb0be9bbe3a,0x3e833e7abea9be02,0x3c0e3eb5be13bea5,0xbe7a3e833e02bea9,0xbeb53c0e3ea5be13
.quad 0x3eb500003eb5,0x3eb500003eb5,0xbeb50000beb50000,0xbeb50000beb50000,0xbe993e42beb23d78,0xbd9f3eb1be503e94,0xbe42be99bd78beb2,0xbeb1bd9fbe94be50,0xbea4be1bbdf4beaa,0xbe1b3ea4beaa3df4,0x3e1bbea43eaabdf4,0xbea4be1bbdf4beaa,0xbd31beb43e9ebe32,0xbe5f3e8fbeaebdc1,0x3eb4bd313e323e9e,0xbe8fbe5f3dc1beae
.quad 0x3e8cbe663e663e8c,0xbe8c3e66be66be8c,0x3e663e8cbe8c3e66,0xbe66be8c3e8cbe66,0x3eac3de3be6c3e89,0xbea23e23bcd5beb5,0xbde33eacbe89be6c,0xbe23bea23eb5bcd5,0x3db03eb0be9bbe3a,0xbeb03db03e3abe9b,0xbeb03db03e3abe9b,0xbdb0beb03e9b3e3a,0xbe7a3e833e02bea9,0xbeb53c0e3ea5be13,0xbe83be7a3ea93e02,0xbc0ebeb53e133ea5
.quad 0x3eb2bd8dbeb23d8d,0x3eb2bd8dbeb23d8d,0xbd8dbeb23d8d3eb2,0xbd8dbeb23d8d3eb2,0x3ea93e02beb53c0e,0x3e133ea5be83be7a,0x3e02bea93c0e3eb5,0x3ea5be13be7a3e83,0x3e583e91beb3bd54,0xbe913e583d54beb3,0x3e91be58bd543eb3,0x3e583e91beb3bd54,0x3cd53eb5beacbde3,0xbe89be6c3ea2be23,0x3eb5bcd5bde33eac,0xbe6c3e89be23bea2
.quad 0xbe2b3ea0bea0be2b,0x3e2bbea03ea03e2b,0x3ea03e2bbe2b3ea0,0xbea0be2b3e2bbea0,0xbe9e3e32be8fbe5f,0x3eae3dc13d313eb4,0x3e323e9ebe5f3e8f,0x3dc1beae3eb4bd31,0xbeb5bc8ebe73be86,0xbc8e3eb5be863e73,0xbc8e3eb5be863e73,0x3eb53c8e3e733e86,0xbe94be50be42be99,0xbeb23d78beb1bd9f,0xbe503e94be993e42,0x3d783eb2bd9f3eb1
.quad 0x3eb2bd8dbeb23d8d,0x3eb2bd8dbeb23d8d,0xbd8dbeb23d8d3eb2,0xbd8dbeb23d8d3eb2,0xbe023ea9bc0ebeb5,0xbea53e133e7abe83,0x3ea93e02beb53c0e,0x3e133ea5be83be7a,0xbe58be913eb33d54,0x3e91be58bd543eb3,0xbe913e583d54beb3,0xbe58be913eb33d54,0x3eb5bcd5bde33eac,0xbe6c3e89be23bea2,0xbcd5beb53eac3de3,0x3e893e6cbea23e23
.quad 0xbe2b3ea0bea0be2b,0x3e2bbea03ea03e2b,0x3ea03e2bbe2b3ea0,0xbea0be2b3e2bbea0,0xbe32be9e3e5fbe8f,0xbdc13eaebeb43d31,0xbe9e3e32be8fbe5f,0x3eae3dc13d313eb4,0x3eb53c8e3e733e86,0x3c8ebeb53e86be73,0x3c8ebeb53e86be73,0xbeb5bc8ebe73be86,0xbe503e94be993e42,0x3d783eb2bd9f3eb1,0x3e943e503e423e99,0x3eb2bd783eb13d9f
.quad 0xbeb2bd8d3eb23d8d,0xbeb2bd8d3eb23d8d,0x3d8dbeb2bd8d3eb2,0x3d8dbeb2bd8d3eb2,0x3ea9be02beb5bc0e,0x3e13bea5be833e7a,0x3e023ea93c0ebeb5,0x3ea53e13be7abe83,0xbe583e913eb3bd54,0x3e913e58bd54beb3,0xbe91be583d543eb3,0xbe583e913eb3bd54,0x3cd5beb5beac3de3,0xbe893e6c3ea23e23,0x3eb53cd5bde3beac,0xbe6cbe89be233ea2
.quad 0x3e2b3ea03ea0be2b,0xbe2bbea0bea03e2b,0xbea03e2b3e2b3ea0,0x3ea0be2bbe2bbea0,0xbe9ebe32be8f3e5f,0x3eaebdc13d31beb4,0x3e32be9ebe5fbe8f,0x3dc13eae3eb43d31,0x3eb5bc8e3e73be86,0x3c8e3eb53e863e73,0x3c8e3eb53e863e73,0xbeb53c8ebe733e86,0xbe943e50be423e99,0xbeb2bd78beb13d9f,0xbe50be94be99be42,0x3d78beb2bd9fbeb1
.quad 0xbeb2bd8d3eb23d8d,0xbeb2bd8d3eb23d8d,0x3d8dbeb2bd8d3eb2,0x3d8dbeb2bd8d3eb2,0xbe02bea9bc0e3eb5,0xbea5be133e7a3e83,0x3ea9be02beb5bc0e,0x3e13bea5be833e7a,0x3e58be91beb33d54,0xbe91be583d543eb3,0x3e913e58bd54beb3,0x3e58be91beb33d54,0x3eb53cd5bde3beac,0xbe6cbe89be233ea2,0xbcd53eb53eacbde3,0x3e89be6cbea2be23
.quad 0x3e2b3ea03ea0be2b,0xbe2bbea0bea03e2b,0xbea03e2b3e2b3ea0,0x3ea0be2bbe2bbea0,0xbe323e9e3e5f3e8f,0xbdc1beaebeb4bd31,0xbe9ebe32be8f3e5f,0x3eaebdc13d31beb4,0xbeb53c8ebe733e86,0xbc8ebeb5be86be73,0xbc8ebeb5be86be73,0x3eb5bc8e3e73be86,0xbe50be94be99be42,0x3d78beb2bd9fbeb1,0x3e94be503e42be99,0x3eb23d783eb1bd9f
.quad 0x80003eb580003eb5,0x80003eb580003eb5,0x3eb500003eb50000,0x3eb500003eb50000,0xbe443e98bd803eb2,0xbeb13d9abe953e4f,0x3e983e443eb23d80,0x3d9a3eb13e4f3e95,0xbea53e17bdfc3eaa,0xbe17bea5beaabdfc,0x3e173ea53eaa3dfc,0xbea53e17bdfc3eaa,0xbeb3bd4cbe383e9c,0x3e91be59bdb4beaf,0xbd4c3eb33e9c3e38,0xbe59be91beaf3db4
.quad 0xbe89be6cbe6c3e89,0x3e893e6c3e6cbe89,0xbe6c3e893e893e6c,0x3e6cbe89be89be6c,0xbdcebeaebe8d3e64,0xbe2d3e9f3eb43d17,0xbeae3dce3e643e8d,0x3e9f3e2d3d17beb4,0x3dcabeaebe9f3e2f,0xbeaebdca3e2f3e9f,0xbeaebdca3e2f3e9f,0xbdca3eae3e9fbe2f,0x3e88be6ebeac3de7,0x3cc3beb5be213ea2,0xbe6ebe883de73eac,0xbeb5bcc33ea23e21
.quad 0x80003eb580003eb5,0x80003eb580003eb5,0x3eb500003eb50000,0x3eb500003eb50000,0xbe98be44beb2bd80,0xbd9abeb1be4fbe95,0xbe443e98bd803eb2,0xbeb13d9abe953e4f,0x3ea5be173dfcbeaa,0x3e173ea53eaa3dfc,0xbe17bea5beaabdfc,0x3ea5be173dfcbeaa,0xbd4c3eb33e9c3e38,0xbe59be91beaf3db4,0x3eb33d4c3e38be9c,0xbe913e593db43eaf
.quad 0xbe89be6cbe6c3e89,0x3e893e6c3e6cbe89,0xbe6c3e893e893e6c,0x3e6cbe89be89be6c,0x3eaebdcebe64be8d,0xbe9fbe2dbd173eb4,0xbdcebeaebe8d3e64,0xbe2d3e9f3eb43d17,0xbdca3eae3e9fbe2f,0x3eae3dcabe2fbe9f,0x3eae3dcabe2fbe9f,0x3dcabeaebe9f3e2f,0xbe6ebe883de73eac,0xbeb5bcc33ea23e21,0xbe883e6e3eacbde7,0xbcc33eb53e21bea2
.quad 0x3eb500003eb5,0x3eb500003eb5,0xbeb50000beb50000,0xbeb50000beb50000,0xbe44be98bd80beb2,0xbeb1bd9abe95be4f,0x3e98be443eb2bd80,0x3d9abeb13e4fbe95,0x3ea53e173dfc3eaa,0x3e17bea53eaabdfc,0xbe173ea5beaa3dfc,0x3ea53e173dfc3eaa,0xbeb33d4cbe38be9c,0x3e913e59bdb43eaf,0xbd4cbeb33e9cbe38,0xbe593e91beafbdb4
.quad 0x3e89be6c3e6c3e89,0xbe893e6cbe6cbe89,0x3e6c3e89be893e6c,0xbe6cbe893e89be6c,0xbdce3eaebe8dbe64,0xbe2dbe9f3eb4bd17,0xbeaebdce3e64be8d,0x3e9fbe2d3d173eb4,0xbdcabeae3e9f3e2f,0x3eaebdcabe2f3e9f,0x3eaebdcabe2f3e9f,0x3dca3eaebe9fbe2f,0x3e883e6ebeacbde7,0x3cc33eb5be21bea2,0xbe6e3e883de7beac,0xbeb53cc33ea2be21
.quad 0x3eb500003eb5,0x3eb500003eb5,0xbeb50000beb50000,0xbeb50000beb50000,0xbe983e44beb23d80,0xbd9a3eb1be4f3e95,0xbe44be98bd80beb2,0xbeb1bd9abe95be4f,0xbea5be17bdfcbeaa,0xbe173ea5beaa3dfc,0x3e17bea53eaabdfc,0xbea5be17bdfcbeaa,0xbd4cbeb33e9cbe38,0xbe593e91beafbdb4,0x3eb3bd4c3e383e9c,0xbe91be593db4beaf
.quad 0x3e89be6c3e6c3e89,0xbe893e6cbe6cbe89,0x3e6c3e89be893e6c,0xbe6cbe893e89be6c,0x3eae3dcebe643e8d,0xbe9f3e2dbd17beb4,0xbdce3eaebe8dbe64,0xbe2dbe9f3eb4bd17,0x3dca3eaebe9fbe2f,0xbeae3dca3e2fbe9f,0xbeae3dca3e2fbe9f,0xbdcabeae3e9f3e2f,0xbe6e3e883de7beac,0xbeb53cc33ea2be21,0xbe88be6e3eac3de7,0xbcc3beb53e213ea2
.quad 0x3eb3bd54beb33d54,0x3eb3bd54beb33d54,0xbd54beb33d543eb3,0xbd54beb33d543eb3,0x3ea53e15beb5bc32,0x3e003ea9be78be84,0x3e15bea5bc323eb5,0x3ea9be00be843e78,0x3e453e98beb1bd96,0xbe983e453d96beb1,0x3e98be45bd963eb1,0x3e453e98beb1bd96,0x3b0e3eb5bea8be08,0xbe81be7e3ea7be0d,0x3eb5bb0ebe083ea8,0xbe7e3e81be0dbea7
.quad 0xbe423e99be99be42,0x3e42be993e993e42,0x3e993e42be423e99,0xbe99be423e42be99,0xbea43e19be85be75,0x3eaa3df83c793eb5,0x3e193ea4be753e85,0x3df8beaa3eb5bc79,0xbeb3bd43be5bbe90,0xbd433eb3be903e5b,0xbd433eb3be903e5b,0x3eb33d433e5b3e90,0xbe8abe6bbe25bea1,0xbeb43ce7beacbddf,0xbe6b3e8abea13e25,0x3ce73eb4bddf3eac
.quad 0x3eb3bd54beb33d54,0x3eb3bd54beb33d54,0xbd54beb33d543eb3,0xbd54beb33d543eb3,0xbe153ea53c32beb5,0xbea93e003e84be78,0x3ea53e15beb5bc32,0x3e003ea9be78be84,0xbe45be983eb13d96,0x3e98be45bd963eb1,0xbe983e453d96beb1,0xbe45be983eb13d96,0x3eb5bb0ebe083ea8,0xbe7e3e81be0dbea7,0xbb0ebeb53ea83e08,0x3e813e7ebea73e0d
.quad 0xbe423e99be99be42,0x3e42be993e993e42,0x3e993e42be423e99,0xbe99be423e42be99,0xbe19bea43e75be85,0xbdf83eaabeb53c79,0xbea43e19be85be75,0x3eaa3df83c793eb5,0x3eb33d433e5b3e90,0x3d43beb33e90be5b,0x3d43beb33e90be5b,0xbeb3bd43be5bbe90,0xbe6b3e8abea13e25,0x3ce73eb4bddf3eac,0x3e8a3e6b3e253ea1,0x3eb4bce73eac3ddf
.quad 0xbeb3bd543eb33d54,0xbeb3bd543eb33d54,0x3d54beb3bd543eb3,0x3d54beb3bd543eb3,0x3ea5be15beb53c32,0x3e00bea9be783e84,0x3e153ea5bc32beb5,0x3ea93e00be84be78,0xbe453e983eb1bd96,0x3e983e45bd96beb1,0xbe98be453d963eb1,0xbe453e983eb1bd96,0x3b0ebeb5bea83e08,0xbe813e7e3ea73e0d,0x3eb53b0ebe08bea8,0xbe7ebe81be0d3ea7
.quad 0x3e423e993e99be42,0xbe42be99be993e42,0xbe993e423e423e99,0x3e99be42be42be99,0xbea4be19be853e75,0x3eaabdf83c79beb5,0x3e19bea4be75be85,0x3df83eaa3eb53c79,0x3eb3bd433e5bbe90,0x3d433eb33e903e5b,0x3d433eb33e903e5b,0xbeb33d43be5b3e90,0xbe8a3e6bbe253ea1,0xbeb4bce7beac3ddf,0xbe6bbe8abea1be25,0x3ce7beb4bddfbeac
.quad 0xbeb3bd543eb33d54,0xbeb3bd543eb33d54,0x3d54beb3bd543eb3,0x3d54beb3bd543eb3,0xbe15bea53c323eb5,0xbea9be003e843e78,0x3ea5be15beb53c32,0x3e00bea9be783e84,0x3e45be98beb13d96,0xbe98be453d963eb1,0x3e983e45bd96beb1,0x3e45be98beb13d96,0x3eb53b0ebe08bea8,0xbe7ebe81be0d3ea7,0xbb0e3eb53ea8be08,0x3e81be7ebea7be0d
.quad 0x3e423e993e99be42,0xbe42be99be993e42,0xbe993e423e423e99,0x3e99be42be42be99,0xbe193ea43e753e85,0xbdf8beaabeb5bc79,0xbea4be19be853e75,0x3eaabdf83c79beb5,0xbeb33d43be5b3e90,0xbd43beb3be90be5b,0xbd43beb3be90be5b,0x3eb3bd433e5bbe90,0xbe6bbe8abea1be25,0x3ce7beb4bddfbeac,0x3e8abe6b3e25bea1,0x3eb43ce73eacbddf
.quad 0x80003eb580003eb5,0x80003eb580003eb5,0x3eb500003eb50000,0x3eb500003eb50000,0xbe453e98bd853eb2,0xbeb13d96be953e4d,0x3e983e453eb23d85,0x3d963eb13e4d3e95,0xbea53e13be023ea9,0xbe13bea5bea9be02,0x3e133ea53ea93e02,0xbea53e13be023ea9,0xbeb3bd66be3e3e9a,0x3e93be54bda7beb0,0xbd663eb33e9a3e3e,0xbe54be93beb03da7
.quad 0xbe86be73be733e86,0x3e863e733e73be86,0xbe733e863e863e73,0x3e73be86be86be73,0xbdb9beafbe903e5b,0xbe363e9c3eb33d43,0xbeaf3db93e5b3e90,0x3e9c3e363d43beb3,0x3de3beacbea23e23,0xbeacbde33e233ea2,0xbeacbde33e233ea2,0xbde33eac3ea2be23,0x3e8dbe62beae3dca,0x3d20beb4be2f3e9f,0xbe62be8d3dca3eae,0xbeb4bd203e9f3e2f
.quad 0x80003eb580003eb5,0x80003eb580003eb5,0x3eb500003eb50000,0x3eb500003eb50000,0xbe98be45beb2bd85,0xbd96beb1be4dbe95,0xbe453e98bd853eb2,0xbeb13d96be953e4d,0x3ea5be133e02bea9,0x3e133ea53ea93e02,0xbe13bea5bea9be02,0x3ea5be133e02bea9,0xbd663eb33e9a3e3e,0xbe54be93beb03da7,0x3eb33d663e3ebe9a,0xbe933e543da73eb0
.quad 0xbe86be73be733e86,0x3e863e733e73be86,0xbe733e863e863e73,0x3e73be86be86be73,0x3eafbdb9be5bbe90,0xbe9cbe36bd433eb3,0xbdb9beafbe903e5b,0xbe363e9c3eb33d43,0xbde33eac3ea2be23,0x3eac3de3be23bea2,0x3eac3de3be23bea2,0x3de3beacbea23e23,0xbe62be8d3dca3eae,0xbeb4bd203e9f3e2f,0xbe8d3e623eaebdca,0xbd203eb43e2fbe9f
.quad 0x3eb500003eb5,0x3eb500003eb5,0xbeb50000beb50000,0xbeb50000beb50000,0xbe45be98bd85beb2,0xbeb1bd96be95be4d,0x3e98be453eb2bd85,0x3d96beb13e4dbe95,0x3ea53e133e023ea9,0x3e13bea53ea9be02,0xbe133ea5bea93e02,0x3ea53e133e023ea9,0xbeb33d66be3ebe9a,0x3e933e54bda73eb0,0xbd66beb33e9abe3e,0xbe543e93beb0bda7
.quad 0x3e86be733e733e86,0xbe863e73be73be86,0x3e733e86be863e73,0xbe73be863e86be73,0xbdb93eafbe90be5b,0xbe36be9c3eb3bd43,0xbeafbdb93e5bbe90,0x3e9cbe363d433eb3,0xbde3beac3ea23e23,0x3eacbde3be233ea2,0x3eacbde3be233ea2,0x3de33eacbea2be23,0x3e8d3e62beaebdca,0x3d203eb4be2fbe9f,0xbe623e8d3dcabeae,0xbeb43d203e9fbe2f
.quad 0x3eb500003eb5,0x3eb500003eb5,0xbeb50000beb50000,0xbeb50000beb50000,0xbe983e45beb23d85,0xbd963eb1be4d3e95,0xbe45be98bd85beb2,0xbeb1bd96be95be4d,0xbea5be13be02bea9,0xbe133ea5bea93e02,0x3e13bea53ea9be02,0xbea5be13be02bea9,0xbd66beb33e9abe3e,0xbe543e93beb0bda7,0x3eb3bd663e3e3e9a,0xbe93be543da7beb0
.quad 0x3e86be733e733e86,0xbe863e73be73be86,0x3e733e86be863e73,0xbe73be863e86be73,0x3eaf3db9be5b3e90,0xbe9c3e36bd43beb3,0xbdb93eafbe90be5b,0xbe36be9c3eb3bd43,0x3de33eacbea2be23,0xbeac3de33e23bea2,0xbeac3de33e23bea2,0xbde3beac3ea23e23,0xbe623e8d3dcabeae,0xbeb43d203e9fbe2f,0xbe8dbe623eae3dca,0xbd20beb43e2f3e9f
.quad 0x3eb4bd0ebeb43d0e,0x3eb4bd0ebeb43d0e,0xbd0ebeb43d0e3eb4,0xbd0ebeb43d0e3eb4,0x3ea13e27beb4bcf8,0x3ddb3eadbe69be8b,0x3e27bea1bcf83eb4,0x3eadbddbbe8b3e69,0x3e323e9ebeaebdc1,0xbe9e3e323dc1beae,0x3e9ebe32bdc13eae,0x3e323e9ebeaebdc1,0xbcb23eb5bea3be1f,0xbe70be883eabbdec,0x3eb53cb2be1f3ea3,0xbe883e70bdecbeab
.quad 0xbe583e91be91be58,0x3e58be913e913e58,0x3e913e58be583e91,0xbe91be583e58be91,0xbeaa3dfcbe76be85,0x3ea53e17bc553eb5,0x3dfc3eaabe853e76,0x3e17bea53eb53c55,0xbeb1bd9fbe42be99,0xbd9f3eb1be993e42,0xbd9f3eb1be993e42,0x3eb13d9f3e423e99,0xbe7dbe82be06bea8,0xbeb5bb8ebea6be0f,0xbe823e7dbea83e06,0xbb8e3eb5be0f3ea6
.quad 0x3eb4bd0ebeb43d0e,0x3eb4bd0ebeb43d0e,0xbd0ebeb43d0e3eb4,0xbd0ebeb43d0e3eb4,0xbe273ea13cf8beb4,0xbead3ddb3e8bbe69,0x3ea13e27beb4bcf8,0x3ddb3eadbe69be8b,0xbe32be9e3eae3dc1,0x3e9ebe32bdc13eae,0xbe9e3e323dc1beae,0xbe32be9e3eae3dc1,0x3eb53cb2be1f3ea3,0xbe883e70bdecbeab,0x3cb2beb53ea33e1f,0x3e703e88beab3dec
.quad 0xbe583e91be91be58,0x3e58be913e913e58,0x3e913e58be583e91,0xbe91be583e58be91,0xbdfcbeaa3e85be76,0xbe173ea5beb5bc55,0xbeaa3dfcbe76be85,0x3ea53e17bc553eb5,0x3eb13d9f3e423e99,0x3d9fbeb13e99be42,0x3d9fbeb13e99be42,0xbeb1bd9fbe42be99,0xbe823e7dbea83e06,0xbb8e3eb5be0f3ea6,0x3e7d3e823e063ea8,0x3eb53b8e3ea63e0f
.quad 0xbeb4bd0e3eb43d0e,0xbeb4bd0e3eb43d0e,0x3d0ebeb4bd0e3eb4,0x3d0ebeb4bd0e3eb4,0x3ea1be27beb43cf8,0x3ddbbeadbe693e8b,0x3e273ea1bcf8beb4,0x3ead3ddbbe8bbe69,0xbe323e9e3eaebdc1,0x3e9e3e32bdc1beae,0xbe9ebe323dc13eae,0xbe323e9e3eaebdc1,0xbcb2beb5bea33e1f,0xbe703e883eab3dec,0x3eb5bcb2be1fbea3,0xbe88be70bdec3eab
.quad 0x3e583e913e91be58,0xbe58be91be913e58,0xbe913e583e583e91,0x3e91be58be58be91,0xbeaabdfcbe763e85,0x3ea5be17bc55beb5,0x3dfcbeaabe85be76,0x3e173ea53eb5bc55,0x3eb1bd9f3e42be99,0x3d9f3eb13e993e42,0x3d9f3eb13e993e42,0xbeb13d9fbe423e99,0xbe7d3e82be063ea8,0xbeb53b8ebea63e0f,0xbe82be7dbea8be06,0xbb8ebeb5be0fbea6
.quad 0xbeb4bd0e3eb43d0e,0xbeb4bd0e3eb43d0e,0x3d0ebeb4bd0e3eb4,0x3d0ebeb4bd0e3eb4,0xbe27bea13cf83eb4,0xbeadbddb3e8b3e69,0x3ea1be27beb43cf8,0x3ddbbeadbe693e8b,0x3e32be9ebeae3dc1,0xbe9ebe323dc13eae,0x3e9e3e32bdc1beae,0x3e32be9ebeae3dc1,0x3eb5bcb2be1fbea3,0xbe88be70bdec3eab,0x3cb23eb53ea3be1f,0x3e70be88beabbdec
.quad 0x3e583e913e91be58,0xbe58be91be913e58,0xbe913e583e583e91,0x3e91be58be58be91,0xbdfc3eaa3e853e76,0xbe17bea5beb53c55,0xbeaabdfcbe763e85,0x3ea5be17bc55beb5,0xbeb13d9fbe423e99,0xbd9fbeb1be99be42,0xbd9fbeb1be99be42,0x3eb1bd9f3e42be99,0xbe82be7dbea8be06,0xbb8ebeb5be0fbea6,0x3e7dbe823e06bea8,0x3eb5bb8e3ea6be0f
.quad 0x80003eb580003eb5,0x80003eb580003eb5,0x3eb500003eb50000,0x3eb500003eb50000,0xbe473e97bd893eb2,0xbeb13d92be963e4b,0x3e973e473eb23d89,0x3d923eb13e4b3e96,0xbea63e0fbe063ea8,0xbe0fbea6bea8be06,0x3e0f3ea63ea83e06,0xbea63e0fbe063ea8,0xbeb2bd80be443e98,0x3e95be4fbd9abeb1,0xbd803eb23e983e44,0xbe4fbe95beb13d9a
.quad 0xbe83be7abe7a3e83,0x3e833e7a3e7abe83,0xbe7a3e833e833e7a,0x3e7abe83be83be7a,0xbda3beb0be933e52,0xbe403e9a3eb33d6f,0xbeb03da33e523e93,0x3e9a3e403d6fbeb3,0x3dfcbeaabea53e17,0xbeaabdfc3e173ea5,0xbeaabdfc3e173ea5,0xbdfc3eaa3ea5be17,0x3e92be56beb03dac,0x3d5dbeb3be3c3e9b,0xbe56be923dac3eb0,0xbeb3bd5d3e9b3e3c
.quad 0x80003eb580003eb5,0x80003eb580003eb5,0x3eb500003eb50000,0x3eb500003eb50000,0xbe97be47beb2bd89,0xbd92beb1be4bbe96,0xbe473e97bd893eb2,0xbeb13d92be963e4b,0x3ea6be0f3e06bea8,0x3e0f3ea63ea83e06,0xbe0fbea6bea8be06,0x3ea6be0f3e06bea8,0xbd803eb23e983e44,0xbe4fbe95beb13d9a,0x3eb23d803e44be98,0xbe953e4f3d9a3eb1
.quad 0xbe83be7abe7a3e83,0x3e833e7a3e7abe83,0xbe7a3e833e833e7a,0x3e7abe83be83be7a,0x3eb0bda3be52be93,0xbe9abe40bd6f3eb3,0xbda3beb0be933e52,0xbe403e9a3eb33d6f,0xbdfc3eaa3ea5be17,0x3eaa3dfcbe17bea5,0x3eaa3dfcbe17bea5,0x3dfcbeaabea53e17,0xbe56be923dac3eb0,0xbeb3bd5d3e9b3e3c,0xbe923e563eb0bdac,0xbd5d3eb33e3cbe9b
.quad 0x3eb500003eb5,0x3eb500003eb5,0xbeb50000beb50000,0xbeb50000beb50000,0xbe47be97bd89beb2,0xbeb1bd92be96be4b,0x3e97be473eb2bd89,0x3d92beb13e4bbe96,0x3ea63e0f3e063ea8,0x3e0fbea63ea8be06,0xbe0f3ea6bea83e06,0x3ea63e0f3e063ea8,0xbeb23d80be44be98,0x3e953e4fbd9a3eb1,0xbd80beb23e98be44,0xbe4f3e95beb1bd9a
.quad 0x3e83be7a3e7a3e83,0xbe833e7abe7abe83,0x3e7a3e83be833e7a,0xbe7abe833e83be7a,0xbda33eb0be93be52,0xbe40be9a3eb3bd6f,0xbeb0bda33e52be93,0x3e9abe403d6f3eb3,0xbdfcbeaa3ea53e17,0x3eaabdfcbe173ea5,0x3eaabdfcbe173ea5,0x3dfc3eaabea5be17,0x3e923e56beb0bdac,0x3d5d3eb3be3cbe9b,0xbe563e923dacbeb0,0xbeb33d5d3e9bbe3c
.quad 0x3eb500003eb5,0x3eb500003eb5,0xbeb50000beb50000,0xbeb50000beb50000,0xbe973e47beb23d89,0xbd923eb1be4b3e96,0xbe47be97bd89beb2,0xbeb1bd92be96be4b,0xbea6be0fbe06bea8,0xbe0f3ea6bea83e06,0x3e0fbea63ea8be06,0xbea6be0fbe06bea8,0xbd80beb23e98be44,0xbe4f3e95beb1bd9a,0x3eb2bd803e443e98,0xbe95be4f3d9abeb1
.quad 0x3e83be7a3e7a3e83,0xbe833e7abe7abe83,0x3e7a3e83be833e7a,0xbe7abe833e83be7a,0x3eb03da3be523e93,0xbe9a3e40bd6fbeb3,0xbda33eb0be93be52,0xbe40be9a3eb3bd6f,0x3dfc3eaabea5be17,0xbeaa3dfc3e17bea5,0xbeaa3dfc3e17bea5,0xbdfcbeaa3ea53e17,0xbe563e923dacbeb0,0xbeb33d5d3e9bbe3c,0xbe92be563eb03dac,0xbd5dbeb33e3c3e9b
.quad 0x3eb5bc8ebeb53c8e,0x3eb5bc8ebeb53c8e,0xbc8ebeb53c8e3eb5,0xbc8ebeb53c8e3eb5,0x3e9c3e38beb3bd4c,0x3db43eafbe59be91,0x3e38be9cbd4c3eb3,0x3eafbdb4be913e59,0x3e1f3ea3beabbdec,0xbea33e1f3decbeab,0x3ea3be1fbdec3eab,0x3e1f3ea3beabbdec,0xbd3a3eb4be9dbe34,0xbe5dbe8f3eafbdbd,0x3eb43d3abe343e9d,0xbe8f3e5dbdbdbeaf
.quad 0xbe6c3e89be89be6c,0x3e6cbe893e893e6c,0x3e893e6cbe6c3e89,0xbe89be6c3e6cbe89,0xbeae3dc5be60be8e,0x3e9e3e31bd283eb4,0x3dc53eaebe8e3e60,0x3e31be9e3eb43d28,0xbeadbddbbe27bea1,0xbddb3eadbea13e27,0xbddb3eadbea13e27,0x3ead3ddb3e273ea1,0xbe64be8dbdcebeae,0xbeb4bd17be9fbe2d,0xbe8d3e64beae3dce,0xbd173eb4be2d3e9f
.quad 0x3eb5bc8ebeb53c8e,0x3eb5bc8ebeb53c8e,0xbc8ebeb53c8e3eb5,0xbc8ebeb53c8e3eb5,0xbe383e9c3d4cbeb3,0xbeaf3db43e91be59,0x3e9c3e38beb3bd4c,0x3db43eafbe59be91,0xbe1fbea33eab3dec,0x3ea3be1fbdec3eab,0xbea33e1f3decbeab,0xbe1fbea33eab3dec,0x3eb43d3abe343e9d,0xbe8f3e5dbdbdbeaf,0x3d3abeb43e9d3e34,0x3e5d3e8fbeaf3dbd
.quad 0xbe6c3e89be89be6c,0x3e6cbe893e893e6c,0x3e893e6cbe6c3e89,0xbe89be6c3e6cbe89,0xbdc5beae3e8ebe60,0xbe313e9ebeb4bd28,0xbeae3dc5be60be8e,0x3e9e3e31bd283eb4,0x3ead3ddb3e273ea1,0x3ddbbead3ea1be27,0x3ddbbead3ea1be27,0xbeadbddbbe27bea1,0xbe8d3e64beae3dce,0xbd173eb4be2d3e9f,0x3e643e8d3dce3eae,0x3eb43d173e9f3e2d
.quad 0xbeb5bc8e3eb53c8e,0xbeb5bc8e3eb53c8e,0x3c8ebeb5bc8e3eb5,0x3c8ebeb5bc8e3eb5,0x3e9cbe38beb33d4c,0x3db4beafbe593e91,0x3e383e9cbd4cbeb3,0x3eaf3db4be91be59,0xbe1f3ea33eabbdec,0x3ea33e1fbdecbeab,0xbea3be1f3dec3eab,0xbe1f3ea33eabbdec,0xbd3abeb4be9d3e34,0xbe5d3e8f3eaf3dbd,0x3eb4bd3abe34be9d,0xbe8fbe5dbdbd3eaf
.quad 0x3e6c3e893e89be6c,0xbe6cbe89be893e6c,0xbe893e6c3e6c3e89,0x3e89be6cbe6cbe89,0xbeaebdc5be603e8e,0x3e9ebe31bd28beb4,0x3dc5beaebe8ebe60,0x3e313e9e3eb4bd28,0x3eadbddb3e27bea1,0x3ddb3ead3ea13e27,0x3ddb3ead3ea13e27,0xbead3ddbbe273ea1,0xbe643e8dbdce3eae,0xbeb43d17be9f3e2d,0xbe8dbe64beaebdce,0xbd17beb4be2dbe9f
.quad 0xbeb5bc8e3eb53c8e,0xbeb5bc8e3eb53c8e,0x3c8ebeb5bc8e3eb5,0x3c8ebeb5bc8e3eb5,0xbe38be9c3d4c3eb3,0xbeafbdb43e913e59,0x3e9cbe38beb33d4c,0x3db4beafbe593e91,0x3e1fbea3beab3dec,0xbea3be1f3dec3eab,0x3ea33e1fbdecbeab,0x3e1fbea3beab3dec,0x3eb4bd3abe34be9d,0xbe8fbe5dbdbd3eaf,0x3d3a3eb43e9dbe34,0x3e5dbe8fbeafbdbd
.quad 0x3e6c3e893e89be6c,0xbe6cbe89be893e6c,0xbe893e6c3e6c3e89,0x3e89be6cbe6cbe89,0xbdc53eae3e8e3e60,0xbe31be9ebeb43d28,0xbeaebdc5be603e8e,0x3e9ebe31bd28beb4,0xbead3ddbbe273ea1,0xbddbbeadbea1be27,0xbddbbeadbea1be27,0x3eadbddb3e27bea1,0xbe8dbe64beaebdce,0xbd17beb4be2dbe9f,0x3e64be8d3dcebeae,0x3eb4bd173e9fbe2d
.quad 0x87180000871000,0x87080000870000,0x96580000965000,0x96480000964000,0xa4380000a43000,0xa4280000a42000,0xb2180000b21000,0xb2080000b20000,0xbff80000bff000,0xbfe80000bfe000,0xcdd80000cdd000,0xcdc80000cdc000,0xdbb80000dbb000,0xdba80000dba000,0xe9980000e99000,0xe9880000e98000
.quad 0x87380000873000,0x87280000872000,0x97380000973000,0x97280000972000,0xa5180000a51000,0xa5080000a50000,0xb2f80000b2f000,0xb2e80000b2e000,0xc0d80000c0d000,0xc0c80000c0c000,0xceb80000ceb000,0xcea80000cea000,0xdc980000dc9000,0xdc880000dc8000,0xea780000ea7000,0xea680000ea6000
.quad 0x87580000875000,0x87480000874000,0x98180000981000,0x98080000980000,0xa5f80000a5f000,0xa5e80000a5e000,0xb3d80000b3d000,0xb3c80000b3c000,0xc1b80000c1b000,0xc1a80000c1a000,0xcf980000cf9000,0xcf880000cf8000,0xdd780000dd7000,0xdd680000dd6000,0xeb580000eb5000,0xeb480000eb4000
.quad 0x87780000877000,0x87680000876000,0x98f8000098f000,0x98e8000098e000,0xa6d80000a6d000,0xa6c80000a6c000,0xb4b80000b4b000,0xb4a80000b4a000,0xc2980000c29000,0xc2880000c28000,0xd0780000d07000,0xd0680000d06000,0xde580000de5000,0xde480000de4000,0xec380000ec3000,0xec280000ec2000
.quad 0x8d4000008c8000,0x8b8000008b0000,0x9b7800009ab800,0x99b80000993800,0xa9700000a8b000,0xa7b00000a73000,0xb7680000b6a800,0xb5a80000b52800,0xc5600000c4a000,0xc3a00000c32000,0xd3580000d29800,0xd1980000d11800,0xe1500000e09000,0xdf900000df1000,0xef480000ee8800,0xed880000ed0800
.quad 0x8d8000008cc000,0x8bc000008b4000,0x9bb800009af800,0x99f80000997800,0xa9b00000a8f000,0xa7f00000a77000,0xb7a80000b6e800,0xb5e80000b56800,0xc5a00000c4e000,0xc3e00000c36000,0xd3980000d2d800,0xd1d80000d15800,0xe1900000e0d000,0xdfd00000df5000,0xef880000eec800,0xedc80000ed4800
.quad 0x8dc000008d0000,0x8c4000008c0000,0x9bf800009b3800,0x9a7800009a3800,0xa9f00000a93000,0xa8700000a83000,0xb7e80000b72800,0xb6680000b62800,0xc5e00000c52000,0xc4600000c42000,0xd3d80000d31800,0xd2580000d21800,0xe1d00000e11000,0xe0500000e01000,0xefc80000ef0800,0xee480000ee0800
.quad 0x87980000879000,0x87880000878000,0x95180000951000,0x95080000950000,0xa4580000a45000,0xa4480000a44000,0xb2380000b23000,0xb2280000b22000,0xc0180000c01000,0xc0080000c00000,0xcdf80000cdf000,0xcde80000cde000,0xdbd80000dbd000,0xdbc80000dbc000,0xe9b80000e9b000,0xe9a80000e9a000
.quad 0x88780000887000,0x88680000886000,0x95380000953000,0x95280000952000,0xa5380000a53000,0xa5280000a52000,0xb3180000b31000,0xb3080000b30000,0xc0f80000c0f000,0xc0e80000c0e000,0xced80000ced000,0xcec80000cec000,0xdcb80000dcb000,0xdca80000dca000,0xea980000ea9000,0xea880000ea8000
.quad 0x89580000895000,0x89480000894000,0x95580000955000,0x95480000954000,0xa6180000a61000,0xa6080000a60000,0xb3f80000b3f000,0xb3e80000b3e000,0xc1d80000c1d000,0xc1c80000c1c000,0xcfb80000cfb000,0xcfa80000cfa000,0xdd980000dd9000,0xdd880000dd8000,0xeb780000eb7000,0xeb680000eb6000
.quad 0x8a3800008a3000,0x8a2800008a2000,0x95780000957000,0x95680000956000,0xa6f80000a6f000,0xa6e80000a6e000,0xb4d80000b4d000,0xb4c80000b4c000,0xc2b80000c2b000,0xc2a80000c2a000,0xd0980000d09000,0xd0880000d08000,0xde780000de7000,0xde680000de6000,0xec580000ec5000,0xec480000ec4000
.quad 0x8d4800008c8800,0x8b8800008b0800,0x9b4000009a8000,0x99800000990000,0xa9780000a8b800,0xa7b80000a73800,0xb7700000b6b000,0xb5b00000b53000,0xc5680000c4a800,0xc3a80000c32800,0xd3600000d2a000,0xd1a00000d12000,0xe1580000e09800,0xdf980000df1800,0xef500000ee9000,0xed900000ed1000
.quad 0x8d8800008cc800,0x8bc800008b4800,0x9b8000009ac000,0x99c00000994000,0xa9b80000a8f800,0xa7f80000a77800,0xb7b00000b6f000,0xb5f00000b57000,0xc5a80000c4e800,0xc3e80000c36800,0xd3a00000d2e000,0xd1e00000d16000,0xe1980000e0d800,0xdfd80000df5800,0xef900000eed000,0xedd00000ed5000
.quad 0x8dc800008d0800,0x8c4800008c0800,0x9bc000009b0000,0x9a4000009a0000,0xa9f80000a93800,0xa8780000a83800,0xb7f00000b73000,0xb6700000b63000,0xc5e80000c52800,0xc4680000c42800,0xd3e00000d32000,0xd2600000d22000,0xe1d80000e11800,0xe0580000e01800,0xefd00000ef1000,0xee500000ee1000
.quad 0x87b8000087b000,0x87a8000087a000,0x95980000959000,0x95880000958000,0xa3180000a31000,0xa3080000a30000,0xb2580000b25000,0xb2480000b24000,0xc0380000c03000,0xc0280000c02000,0xce180000ce1000,0xce080000ce0000,0xdbf80000dbf000,0xdbe80000dbe000,0xe9d80000e9d000,0xe9c80000e9c000
.quad 0x88980000889000,0x88880000888000,0x96780000967000,0x96680000966000,0xa3380000a33000,0xa3280000a32000,0xb3380000b33000,0xb3280000b32000,0xc1180000c11000,0xc1080000c10000,0xcef80000cef000,0xcee80000cee000,0xdcd80000dcd000,0xdcc80000dcc000,0xeab80000eab000,0xeaa80000eaa000
.quad 0x89780000897000,0x89680000896000,0x97580000975000,0x97480000974000,0xa3580000a35000,0xa3480000a34000,0xb4180000b41000,0xb4080000b40000,0xc1f80000c1f000,0xc1e80000c1e000,0xcfd80000cfd000,0xcfc80000cfc000,0xddb80000ddb000,0xdda80000dda000,0xeb980000eb9000,0xeb880000eb8000
.quad 0x8a5800008a5000,0x8a4800008a4000,0x98380000983000,0x98280000982000,0xa3780000a37000,0xa3680000a36000,0xb4f80000b4f000,0xb4e80000b4e000,0xc2d80000c2d000,0xc2c80000c2c000,0xd0b80000d0b000,0xd0a80000d0a000,0xde980000de9000,0xde880000de8000,0xec780000ec7000,0xec680000ec6000
.quad 0x8d5000008c9000,0x8b9000008b1000,0x9b4800009a8800,0x99880000990800,0xa9400000a88000,0xa7800000a70000,0xb7780000b6b800,0xb5b80000b53800,0xc5700000c4b000,0xc3b00000c33000,0xd3680000d2a800,0xd1a80000d12800,0xe1600000e0a000,0xdfa00000df2000,0xef580000ee9800,0xed980000ed1800
.quad 0x8d9000008cd000,0x8bd000008b5000,0x9b8800009ac800,0x99c80000994800,0xa9800000a8c000,0xa7c00000a74000,0xb7b80000b6f800,0xb5f80000b57800,0xc5b00000c4f000,0xc3f00000c37000,0xd3a80000d2e800,0xd1e80000d16800,0xe1a00000e0e000,0xdfe00000df6000,0xef980000eed800,0xedd80000ed5800
.quad 0x8dd000008d1000,0x8c5000008c1000,0x9bc800009b0800,0x9a4800009a0800,0xa9c00000a90000,0xa8400000a80000,0xb7f80000b73800,0xb6780000b63800,0xc5f00000c53000,0xc4700000c43000,0xd3e80000d32800,0xd2680000d22800,0xe1e00000e12000,0xe0600000e02000,0xefd80000ef1800,0xee580000ee1800
.quad 0x87d8000087d000,0x87c8000087c000,0x95b8000095b000,0x95a8000095a000,0xa3980000a39000,0xa3880000a38000,0xb1180000b11000,0xb1080000b10000,0xc0580000c05000,0xc0480000c04000,0xce380000ce3000,0xce280000ce2000,0xdc180000dc1000,0xdc080000dc0000,0xe9f80000e9f000,0xe9e80000e9e000
.quad 0x88b8000088b000,0x88a8000088a000,0x96980000969000,0x96880000968000,0xa4780000a47000,0xa4680000a46000,0xb1380000b13000,0xb1280000b12000,0xc1380000c13000,0xc1280000c12000,0xcf180000cf1000,0xcf080000cf0000,0xdcf80000dcf000,0xdce80000dce000,0xead80000ead000,0xeac80000eac000
.quad 0x89980000899000,0x89880000898000,0x97780000977000,0x97680000976000,0xa5580000a55000,0xa5480000a54000,0xb1580000b15000,0xb1480000b14000,0xc2180000c21000,0xc2080000c20000,0xcff80000cff000,0xcfe80000cfe000,0xddd80000ddd000,0xddc80000ddc000,0xebb80000ebb000,0xeba80000eba000
.quad 0x8a7800008a7000,0x8a6800008a6000,0x98580000985000,0x98480000984000,0xa6380000a63000,0xa6280000a62000,0xb1780000b17000,0xb1680000b16000,0xc2f80000c2f000,0xc2e80000c2e000,0xd0d80000d0d000,0xd0c80000d0c000,0xdeb80000deb000,0xdea80000dea000,0xec980000ec9000,0xec880000ec8000
.quad 0x8d5800008c9800,0x8b9800008b1800,0x9b5000009a9000,0x99900000991000,0xa9480000a88800,0xa7880000a70800,0xb7400000b68000,0xb5800000b50000,0xc5780000c4b800,0xc3b80000c33800,0xd3700000d2b000,0xd1b00000d13000,0xe1680000e0a800,0xdfa80000df2800,0xef600000eea000,0xeda00000ed2000
.quad 0x8d9800008cd800,0x8bd800008b5800,0x9b9000009ad000,0x99d00000995000,0xa9880000a8c800,0xa7c80000a74800,0xb7800000b6c000,0xb5c00000b54000,0xc5b80000c4f800,0xc3f80000c37800,0xd3b00000d2f000,0xd1f00000d17000,0xe1a80000e0e800,0xdfe80000df6800,0xefa00000eee000,0xede00000ed6000
.quad 0x8dd800008d1800,0x8c5800008c1800,0x9bd000009b1000,0x9a5000009a1000,0xa9c80000a90800,0xa8480000a80800,0xb7c00000b70000,0xb6400000b60000,0xc5f80000c53800,0xc4780000c43800,0xd3f00000d33000,0xd2700000d23000,0xe1e80000e12800,0xe0680000e02800,0xefe00000ef2000,0xee600000ee2000
.quad 0x87f8000087f000,0x87e8000087e000,0x95d8000095d000,0x95c8000095c000,0xa3b80000a3b000,0xa3a80000a3a000,0xb1980000b19000,0xb1880000b18000,0xbf180000bf1000,0xbf080000bf0000,0xce580000ce5000,0xce480000ce4000,0xdc380000dc3000,0xdc280000dc2000,0xea180000ea1000,0xea080000ea0000
.quad 0x88d8000088d000,0x88c8000088c000,0x96b8000096b000,0x96a8000096a000,0xa4980000a49000,0xa4880000a48000,0xb2780000b27000,0xb2680000b26000,0xbf380000bf3000,0xbf280000bf2000,0xcf380000cf3000,0xcf280000cf2000,0xdd180000dd1000,0xdd080000dd0000,0xeaf80000eaf000,0xeae80000eae000
.quad 0x89b8000089b000,0x89a8000089a000,0x97980000979000,0x97880000978000,0xa5780000a57000,0xa5680000a56000,0xb3580000b35000,0xb3480000b34000,0xbf580000bf5000,0xbf480000bf4000,0xd0180000d01000,0xd0080000d00000,0xddf80000ddf000,0xdde80000dde000,0xebd80000ebd000,0xebc80000ebc000
.quad 0x8a9800008a9000,0x8a8800008a8000,0x98780000987000,0x98680000986000,0xa6580000a65000,0xa6480000a64000,0xb4380000b43000,0xb4280000b42000,0xbf780000bf7000,0xbf680000bf6000,0xd0f80000d0f000,0xd0e80000d0e000,0xded80000ded000,0xdec80000dec000,0xecb80000ecb000,0xeca80000eca000
.quad 0x8d6000008ca000,0x8ba000008b2000,0x9b5800009a9800,0x99980000991800,0xa9500000a89000,0xa7900000a71000,0xb7480000b68800,0xb5880000b50800,0xc5400000c48000,0xc3800000c30000,0xd3780000d2b800,0xd1b80000d13800,0xe1700000e0b000,0xdfb00000df3000,0xef680000eea800,0xeda80000ed2800
.quad 0x8da000008ce000,0x8be000008b6000,0x9b9800009ad800,0x99d80000995800,0xa9900000a8d000,0xa7d00000a75000,0xb7880000b6c800,0xb5c80000b54800,0xc5800000c4c000,0xc3c00000c34000,0xd3b80000d2f800,0xd1f80000d17800,0xe1b00000e0f000,0xdff00000df7000,0xefa80000eee800,0xede80000ed6800
.quad 0x8de000008d2000,0x8c6000008c2000,0x9bd800009b1800,0x9a5800009a1800,0xa9d00000a91000,0xa8500000a81000,0xb7c80000b70800,0xb6480000b60800,0xc5c00000c50000,0xc4400000c40000,0xd3f80000d33800,0xd2780000d23800,0xe1f00000e13000,0xe0700000e03000,0xefe80000ef2800,0xee680000ee2800
.quad 0x88180000881000,0x88080000880000,0x95f8000095f000,0x95e8000095e000,0xa3d80000a3d000,0xa3c80000a3c000,0xb1b80000b1b000,0xb1a80000b1a000,0xbf980000bf9000,0xbf880000bf8000,0xcd180000cd1000,0xcd080000cd0000,0xdc580000dc5000,0xdc480000dc4000,0xea380000ea3000,0xea280000ea2000
.quad 0x88f8000088f000,0x88e8000088e000,0x96d8000096d000,0x96c8000096c000,0xa4b80000a4b000,0xa4a80000a4a000,0xb2980000b29000,0xb2880000b28000,0xc0780000c07000,0xc0680000c06000,0xcd380000cd3000,0xcd280000cd2000,0xdd380000dd3000,0xdd280000dd2000,0xeb180000eb1000,0xeb080000eb0000
.quad 0x89d8000089d000,0x89c8000089c000,0x97b8000097b000,0x97a8000097a000,0xa5980000a59000,0xa5880000a58000,0xb3780000b37000,0xb3680000b36000,0xc1580000c15000,0xc1480000c14000,0xcd580000cd5000,0xcd480000cd4000,0xde180000de1000,0xde080000de0000,0xebf80000ebf000,0xebe80000ebe000
.quad 0x8ab800008ab000,0x8aa800008aa000,0x98980000989000,0x98880000988000,0xa6780000a67000,0xa6680000a66000,0xb4580000b45000,0xb4480000b44000,0xc2380000c23000,0xc2280000c22000,0xcd780000cd7000,0xcd680000cd6000,0xdef80000def000,0xdee80000dee000,0xecd80000ecd000,0xecc80000ecc000
.quad 0x8d6800008ca800,0x8ba800008b2800,0x9b6000009aa000,0x99a00000992000,0xa9580000a89800,0xa7980000a71800,0xb7500000b69000,0xb5900000b51000,0xc5480000c48800,0xc3880000c30800,0xd3400000d28000,0xd1800000d10000,0xe1780000e0b800,0xdfb80000df3800,0xef700000eeb000,0xedb00000ed3000
.quad 0x8da800008ce800,0x8be800008b6800,0x9ba000009ae000,0x99e00000996000,0xa9980000a8d800,0xa7d80000a75800,0xb7900000b6d000,0xb5d00000b55000,0xc5880000c4c800,0xc3c80000c34800,0xd3800000d2c000,0xd1c00000d14000,0xe1b80000e0f800,0xdff80000df7800,0xefb00000eef000,0xedf00000ed7000
.quad 0x8de800008d2800,0x8c6800008c2800,0x9be000009b2000,0x9a6000009a2000,0xa9d80000a91800,0xa8580000a81800,0xb7d00000b71000,0xb6500000b61000,0xc5c80000c50800,0xc4480000c40800,0xd3c00000d30000,0xd2400000d20000,0xe1f80000e13800,0xe0780000e03800,0xeff00000ef3000,0xee700000ee3000
.quad 0x88380000883000,0x88280000882000,0x96180000961000,0x96080000960000,0xa3f80000a3f000,0xa3e80000a3e000,0xb1d80000b1d000,0xb1c80000b1c000,0xbfb80000bfb000,0xbfa80000bfa000,0xcd980000cd9000,0xcd880000cd8000,0xdb180000db1000,0xdb080000db0000,0xea580000ea5000,0xea480000ea4000
.quad 0x89180000891000,0x89080000890000,0x96f8000096f000,0x96e8000096e000,0xa4d80000a4d000,0xa4c80000a4c000,0xb2b80000b2b000,0xb2a80000b2a000,0xc0980000c09000,0xc0880000c08000,0xce780000ce7000,0xce680000ce6000,0xdb380000db3000,0xdb280000db2000,0xeb380000eb3000,0xeb280000eb2000
.quad 0x89f8000089f000,0x89e8000089e000,0x97d8000097d000,0x97c8000097c000,0xa5b80000a5b000,0xa5a80000a5a000,0xb3980000b39000,0xb3880000b38000,0xc1780000c17000,0xc1680000c16000,0xcf580000cf5000,0xcf480000cf4000,0xdb580000db5000,0xdb480000db4000,0xec180000ec1000,0xec080000ec0000
.quad 0x8ad800008ad000,0x8ac800008ac000,0x98b8000098b000,0x98a8000098a000,0xa6980000a69000,0xa6880000a68000,0xb4780000b47000,0xb4680000b46000,0xc2580000c25000,0xc2480000c24000,0xd0380000d03000,0xd0280000d02000,0xdb780000db7000,0xdb680000db6000,0xecf80000ecf000,0xece80000ece000
.quad 0x8d7000008cb000,0x8bb000008b3000,0x9b6800009aa800,0x99a80000992800,0xa9600000a8a000,0xa7a00000a72000,0xb7580000b69800,0xb5980000b51800,0xc5500000c49000,0xc3900000c31000,0xd3480000d28800,0xd1880000d10800,0xe1400000e08000,0xdf800000df0000,0xef780000eeb800,0xedb80000ed3800
.quad 0x8db000008cf000,0x8bf000008b7000,0x9ba800009ae800,0x99e80000996800,0xa9a00000a8e000,0xa7e00000a76000,0xb7980000b6d800,0xb5d80000b55800,0xc5900000c4d000,0xc3d00000c35000,0xd3880000d2c800,0xd1c80000d14800,0xe1800000e0c000,0xdfc00000df4000,0xefb80000eef800,0xedf80000ed7800
.quad 0x8df000008d3000,0x8c7000008c3000,0x9be800009b2800,0x9a6800009a2800,0xa9e00000a92000,0xa8600000a82000,0xb7d80000b71800,0xb6580000b61800,0xc5d00000c51000,0xc4500000c41000,0xd3c80000d30800,0xd2480000d20800,0xe1c00000e10000,0xe0400000e00000,0xeff80000ef3800,0xee780000ee3800
.quad 0x88580000885000,0x88480000884000,0x96380000963000,0x96280000962000,0xa4180000a41000,0xa4080000a40000,0xb1f80000b1f000,0xb1e80000b1e000,0xbfd80000bfd000,0xbfc80000bfc000,0xcdb80000cdb000,0xcda80000cda000,0xdb980000db9000,0xdb880000db8000,0xe9180000e91000,0xe9080000e90000
.quad 0x89380000893000,0x89280000892000,0x97180000971000,0x97080000970000,0xa4f80000a4f000,0xa4e80000a4e000,0xb2d80000b2d000,0xb2c80000b2c000,0xc0b80000c0b000,0xc0a80000c0a000,0xce980000ce9000,0xce880000ce8000,0xdc780000dc7000,0xdc680000dc6000,0xe9380000e93000,0xe9280000e92000
.quad 0x8a1800008a1000,0x8a0800008a0000,0x97f8000097f000,0x97e8000097e000,0xa5d80000a5d000,0xa5c80000a5c000,0xb3b80000b3b000,0xb3a80000b3a000,0xc1980000c19000,0xc1880000c18000,0xcf780000cf7000,0xcf680000cf6000,0xdd580000dd5000,0xdd480000dd4000,0xe9580000e95000,0xe9480000e94000
.quad 0x8af800008af000,0x8ae800008ae000,0x98d8000098d000,0x98c8000098c000,0xa6b80000a6b000,0xa6a80000a6a000,0xb4980000b49000,0xb4880000b48000,0xc2780000c27000,0xc2680000c26000,0xd0580000d05000,0xd0480000d04000,0xde380000de3000,0xde280000de2000,0xe9780000e97000,0xe9680000e96000
.quad 0x8d7800008cb800,0x8bb800008b3800,0x9b7000009ab000,0x99b00000993000,0xa9680000a8a800,0xa7a80000a72800,0xb7600000b6a000,0xb5a00000b52000,0xc5580000c49800,0xc3980000c31800,0xd3500000d29000,0xd1900000d11000,0xe1480000e08800,0xdf880000df0800,0xef400000ee8000,0xed800000ed0000
.quad 0x8db800008cf800,0x8bf800008b7800,0x9bb000009af000,0x99f00000997000,0xa9a80000a8e800,0xa7e80000a76800,0xb7a00000b6e000,0xb5e00000b56000,0xc5980000c4d800,0xc3d80000c35800,0xd3900000d2d000,0xd1d00000d15000,0xe1880000e0c800,0xdfc80000df4800,0xef800000eec000,0xedc00000ed4000
.quad 0x8df800008d3800,0x8c7800008c3800,0x9bf000009b3000,0x9a7000009a3000,0xa9e80000a92800,0xa8680000a82800,0xb7e00000b72000,0xb6600000b62000,0xc5d80000c51800,0xc4580000c41800,0xd3d00000d31000,0xd2500000d21000,0xe1c80000e10800,0xe0480000e00800,0xefc00000ef0000,0xee400000ee0000
.quad 0xf7080000f70000,0xf7180000f71000,0x106480001064000,0x106580001065000,0x114280001142000,0x114380001143000,0x122080001220000,0x122180001221000,0x12fe800012fe000,0x12ff800012ff000,0x13dc800013dc000,0x13dd800013dd000,0x14ba800014ba000,0x14bb800014bb000,0x159880001598000,0x159980001599000
.quad 0xf7280000f72000,0xf7380000f73000,0x107280001072000,0x107380001073000,0x115080001150000,0x115180001151000,0x122e8000122e000,0x122f8000122f000,0x130c8000130c000,0x130d8000130d000,0x13ea800013ea000,0x13eb800013eb000,0x14c8800014c8000,0x14c9800014c9000,0x15a6800015a6000,0x15a7800015a7000
.quad 0xf7480000f74000,0xf7580000f75000,0x108080001080000,0x108180001081000,0x115e8000115e000,0x115f8000115f000,0x123c8000123c000,0x123d8000123d000,0x131a8000131a000,0x131b8000131b000,0x13f8800013f8000,0x13f9800013f9000,0x14d6800014d6000,0x14d7800014d7000,0x15b4800015b4000,0x15b5800015b5000
.quad 0xf7680000f76000,0xf7780000f77000,0x108e8000108e000,0x108f8000108f000,0x116c8000116c000,0x116d8000116d000,0x124a8000124a000,0x124b8000124b000,0x132880001328000,0x132980001329000,0x140680001406000,0x140780001407000,0x14e4800014e4000,0x14e5800014e5000,0x15c2800015c2000,0x15c3800015c3000
.quad 0xfb800000fb0000,0xfd400000fc8000,0x109b80001093800,0x10b7800010ab800,0x117b00001173000,0x11970000118b000,0x125a80001252800,0x12768000126a800,0x133a00001332000,0x13560000134a000,0x141980001411800,0x143580001429800,0x14f9000014f1000,0x151500001509000,0x15d8800015d0800,0x15f4800015e8800
.quad 0xfbc00000fb4000,0xfd800000fcc000,0x109f80001097800,0x10bb800010af800,0x117f00001177000,0x119b0000118f000,0x125e80001256800,0x127a8000126e800,0x133e00001336000,0x135a0000134e000,0x141d80001415800,0x14398000142d800,0x14fd000014f5000,0x15190000150d000,0x15dc800015d4800,0x15f8800015ec800
.quad 0xfc400000fc0000,0xfdc00000fd0000,0x10a7800010a3800,0x10bf800010b3800,0x118700001183000,0x119f00001193000,0x126680001262800,0x127e80001272800,0x134600001342000,0x135e00001352000,0x142580001421800,0x143d80001431800,0x150500001501000,0x151d00001511000,0x15e4800015e0800,0x15fc800015f0800
.quad 0xf7880000f78000,0xf7980000f79000,0x105080001050000,0x105180001051000,0x114480001144000,0x114580001145000,0x122280001222000,0x122380001223000,0x130080001300000,0x130180001301000,0x13de800013de000,0x13df800013df000,0x14bc800014bc000,0x14bd800014bd000,0x159a8000159a000,0x159b8000159b000
.quad 0xf8680000f86000,0xf8780000f87000,0x105280001052000,0x105380001053000,0x115280001152000,0x115380001153000,0x123080001230000,0x123180001231000,0x130e8000130e000,0x130f8000130f000,0x13ec800013ec000,0x13ed800013ed000,0x14ca800014ca000,0x14cb800014cb000,0x15a8800015a8000,0x15a9800015a9000
.quad 0xf9480000f94000,0xf9580000f95000,0x105480001054000,0x105580001055000,0x116080001160000,0x116180001161000,0x123e8000123e000,0x123f8000123f000,0x131c8000131c000,0x131d8000131d000,0x13fa800013fa000,0x13fb800013fb000,0x14d8800014d8000,0x14d9800014d9000,0x15b6800015b6000,0x15b7800015b7000
.quad 0xfa280000fa2000,0xfa380000fa3000,0x105680001056000,0x105780001057000,0x116e8000116e000,0x116f8000116f000,0x124c8000124c000,0x124d8000124d000,0x132a8000132a000,0x132b8000132b000,0x140880001408000,0x140980001409000,0x14e6800014e6000,0x14e7800014e7000,0x15c4800015c4000,0x15c5800015c5000
.quad 0xfb880000fb0800,0xfd480000fc8800,0x109800001090000,0x10b4000010a8000,0x117b80001173800,0x11978000118b800,0x125b00001253000,0x12770000126b000,0x133a80001332800,0x13568000134a800,0x141a00001412000,0x14360000142a000,0x14f9800014f1800,0x151580001509800,0x15d9000015d1000,0x15f5000015e9000
.quad 0xfbc80000fb4800,0xfd880000fcc800,0x109c00001094000,0x10b8000010ac000,0x117f80001177800,0x119b8000118f800,0x125f00001257000,0x127b0000126f000,0x133e80001336800,0x135a8000134e800,0x141e00001416000,0x143a0000142e000,0x14fd800014f5800,0x15198000150d800,0x15dd000015d5000,0x15f9000015ed000
.quad 0xfc480000fc0800,0xfdc80000fd0800,0x10a4000010a0000,0x10bc000010b0000,0x118780001183800,0x119f80001193800,0x126700001263000,0x127f00001273000,0x134680001342800,0x135e80001352800,0x142600001422000,0x143e00001432000,0x150580001501800,0x151d80001511800,0x15e5000015e1000,0x15fd000015f1000
.quad 0xf7a80000f7a000,0xf7b80000f7b000,0x105880001058000,0x105980001059000,0x113080001130000,0x113180001131000,0x122480001224000,0x122580001225000,0x130280001302000,0x130380001303000,0x13e0800013e0000,0x13e1800013e1000,0x14be800014be000,0x14bf800014bf000,0x159c8000159c000,0x159d8000159d000
.quad 0xf8880000f88000,0xf8980000f89000,0x106680001066000,0x106780001067000,0x113280001132000,0x113380001133000,0x123280001232000,0x123380001233000,0x131080001310000,0x131180001311000,0x13ee800013ee000,0x13ef800013ef000,0x14cc800014cc000,0x14cd800014cd000,0x15aa800015aa000,0x15ab800015ab000
.quad 0xf9680000f96000,0xf9780000f97000,0x107480001074000,0x107580001075000,0x113480001134000,0x113580001135000,0x124080001240000,0x124180001241000,0x131e8000131e000,0x131f8000131f000,0x13fc800013fc000,0x13fd800013fd000,0x14da800014da000,0x14db800014db000,0x15b8800015b8000,0x15b9800015b9000
.quad 0xfa480000fa4000,0xfa580000fa5000,0x108280001082000,0x108380001083000,0x113680001136000,0x113780001137000,0x124e8000124e000,0x124f8000124f000,0x132c8000132c000,0x132d8000132d000,0x140a8000140a000,0x140b8000140b000,0x14e8800014e8000,0x14e9800014e9000,0x15c6800015c6000,0x15c7800015c7000
.quad 0xfb900000fb1000,0xfd500000fc9000,0x109880001090800,0x10b4800010a8800,0x117800001170000,0x119400001188000,0x125b80001253800,0x12778000126b800,0x133b00001333000,0x13570000134b000,0x141a80001412800,0x14368000142a800,0x14fa000014f2000,0x15160000150a000,0x15d9800015d1800,0x15f5800015e9800
.quad 0xfbd00000fb5000,0xfd900000fcd000,0x109c80001094800,0x10b8800010ac800,0x117c00001174000,0x11980000118c000,0x125f80001257800,0x127b8000126f800,0x133f00001337000,0x135b0000134f000,0x141e80001416800,0x143a8000142e800,0x14fe000014f6000,0x151a0000150e000,0x15dd800015d5800,0x15f9800015ed800
.quad 0xfc500000fc1000,0xfdd00000fd1000,0x10a4800010a0800,0x10bc800010b0800,0x118400001180000,0x119c00001190000,0x126780001263800,0x127f80001273800,0x134700001343000,0x135f00001353000,0x142680001422800,0x143e80001432800,0x150600001502000,0x151e00001512000,0x15e5800015e1800,0x15fd800015f1800
.quad 0xf7c80000f7c000,0xf7d80000f7d000,0x105a8000105a000,0x105b8000105b000,0x113880001138000,0x113980001139000,0x121080001210000,0x121180001211000,0x130480001304000,0x130580001305000,0x13e2800013e2000,0x13e3800013e3000,0x14c0800014c0000,0x14c1800014c1000,0x159e8000159e000,0x159f8000159f000
.quad 0xf8a80000f8a000,0xf8b80000f8b000,0x106880001068000,0x106980001069000,0x114680001146000,0x114780001147000,0x121280001212000,0x121380001213000,0x131280001312000,0x131380001313000,0x13f0800013f0000,0x13f1800013f1000,0x14ce800014ce000,0x14cf800014cf000,0x15ac800015ac000,0x15ad800015ad000
.quad 0xf9880000f98000,0xf9980000f99000,0x107680001076000,0x107780001077000,0x115480001154000,0x115580001155000,0x121480001214000,0x121580001215000,0x132080001320000,0x132180001321000,0x13fe800013fe000,0x13ff800013ff000,0x14dc800014dc000,0x14dd800014dd000,0x15ba800015ba000,0x15bb800015bb000
.quad 0xfa680000fa6000,0xfa780000fa7000,0x108480001084000,0x108580001085000,0x116280001162000,0x116380001163000,0x121680001216000,0x121780001217000,0x132e8000132e000,0x132f8000132f000,0x140c8000140c000,0x140d8000140d000,0x14ea800014ea000,0x14eb800014eb000,0x15c8800015c8000,0x15c9800015c9000
.quad 0xfb980000fb1800,0xfd580000fc9800,0x109900001091000,0x10b5000010a9000,0x117880001170800,0x119480001188800,0x125800001250000,0x127400001268000,0x133b80001333800,0x13578000134b800,0x141b00001413000,0x14370000142b000,0x14fa800014f2800,0x15168000150a800,0x15da000015d2000,0x15f6000015ea000
.quad 0xfbd80000fb5800,0xfd980000fcd800,0x109d00001095000,0x10b9000010ad000,0x117c80001174800,0x11988000118c800,0x125c00001254000,0x12780000126c000,0x133f80001337800,0x135b8000134f800,0x141f00001417000,0x143b0000142f000,0x14fe800014f6800,0x151a8000150e800,0x15de000015d6000,0x15fa000015ee000
.quad 0xfc580000fc1800,0xfdd80000fd1800,0x10a5000010a1000,0x10bd000010b1000,0x118480001180800,0x119c80001190800,0x126400001260000,0x127c00001270000,0x134780001343800,0x135f80001353800,0x142700001423000,0x143f00001433000,0x150680001502800,0x151e80001512800,0x15e6000015e2000,0x15fe000015f2000
.quad 0xf7e80000f7e000,0xf7f80000f7f000,0x105c8000105c000,0x105d8000105d000,0x113a8000113a000,0x113b8000113b000,0x121880001218000,0x121980001219000,0x12f0800012f0000,0x12f1800012f1000,0x13e4800013e4000,0x13e5800013e5000,0x14c2800014c2000,0x14c3800014c3000,0x15a0800015a0000,0x15a1800015a1000
.quad 0xf8c80000f8c000,0xf8d80000f8d000,0x106a8000106a000,0x106b8000106b000,0x114880001148000,0x114980001149000,0x122680001226000,0x122780001227000,0x12f2800012f2000,0x12f3800012f3000,0x13f2800013f2000,0x13f3800013f3000,0x14d0800014d0000,0x14d1800014d1000,0x15ae800015ae000,0x15af800015af000
.quad 0xf9a80000f9a000,0xf9b80000f9b000,0x107880001078000,0x107980001079000,0x115680001156000,0x115780001157000,0x123480001234000,0x123580001235000,0x12f4800012f4000,0x12f5800012f5000,0x140080001400000,0x140180001401000,0x14de800014de000,0x14df800014df000,0x15bc800015bc000,0x15bd800015bd000
.quad 0xfa880000fa8000,0xfa980000fa9000,0x108680001086000,0x108780001087000,0x116480001164000,0x116580001165000,0x124280001242000,0x124380001243000,0x12f6800012f6000,0x12f7800012f7000,0x140e8000140e000,0x140f8000140f000,0x14ec800014ec000,0x14ed800014ed000,0x15ca800015ca000,0x15cb800015cb000
.quad 0xfba00000fb2000,0xfd600000fca000,0x109980001091800,0x10b5800010a9800,0x117900001171000,0x119500001189000,0x125880001250800,0x127480001268800,0x133800001330000,0x135400001348000,0x141b80001413800,0x14378000142b800,0x14fb000014f3000,0x15170000150b000,0x15da800015d2800,0x15f6800015ea800
.quad 0xfbe00000fb6000,0xfda00000fce000,0x109d80001095800,0x10b9800010ad800,0x117d00001175000,0x11990000118d000,0x125c80001254800,0x12788000126c800,0x133c00001334000,0x13580000134c000,0x141f80001417800,0x143b8000142f800,0x14ff000014f7000,0x151b0000150f000,0x15de800015d6800,0x15fa800015ee800
.quad 0xfc600000fc2000,0xfde00000fd2000,0x10a5800010a1800,0x10bd800010b1800,0x118500001181000,0x119d00001191000,0x126480001260800,0x127c80001270800,0x134400001340000,0x135c00001350000,0x142780001423800,0x143f80001433800,0x150700001503000,0x151f00001513000,0x15e6800015e2800,0x15fe800015f2800
.quad 0xf8080000f80000,0xf8180000f81000,0x105e8000105e000,0x105f8000105f000,0x113c8000113c000,0x113d8000113d000,0x121a8000121a000,0x121b8000121b000,0x12f8800012f8000,0x12f9800012f9000,0x13d0800013d0000,0x13d1800013d1000,0x14c4800014c4000,0x14c5800014c5000,0x15a2800015a2000,0x15a3800015a3000
.quad 0xf8e80000f8e000,0xf8f80000f8f000,0x106c8000106c000,0x106d8000106d000,0x114a8000114a000,0x114b8000114b000,0x122880001228000,0x122980001229000,0x130680001306000,0x130780001307000,0x13d2800013d2000,0x13d3800013d3000,0x14d2800014d2000,0x14d3800014d3000,0x15b0800015b0000,0x15b1800015b1000
.quad 0xf9c80000f9c000,0xf9d80000f9d000,0x107a8000107a000,0x107b8000107b000,0x115880001158000,0x115980001159000,0x123680001236000,0x123780001237000,0x131480001314000,0x131580001315000,0x13d4800013d4000,0x13d5800013d5000,0x14e0800014e0000,0x14e1800014e1000,0x15be800015be000,0x15bf800015bf000
.quad 0xfaa80000faa000,0xfab80000fab000,0x108880001088000,0x108980001089000,0x116680001166000,0x116780001167000,0x124480001244000,0x124580001245000,0x132280001322000,0x132380001323000,0x13d6800013d6000,0x13d7800013d7000,0x14ee800014ee000,0x14ef800014ef000,0x15cc800015cc000,0x15cd800015cd000
.quad 0xfba80000fb2800,0xfd680000fca800,0x109a00001092000,0x10b6000010aa000,0x117980001171800,0x119580001189800,0x125900001251000,0x127500001269000,0x133880001330800,0x135480001348800,0x141800001410000,0x143400001428000,0x14fb800014f3800,0x15178000150b800,0x15db000015d3000,0x15f7000015eb000
.quad 0xfbe80000fb6800,0xfda80000fce800,0x109e00001096000,0x10ba000010ae000,0x117d80001175800,0x11998000118d800,0x125d00001255000,0x12790000126d000,0x133c80001334800,0x13588000134c800,0x141c00001414000,0x14380000142c000,0x14ff800014f7800,0x151b8000150f800,0x15df000015d7000,0x15fb000015ef000
.quad 0xfc680000fc2800,0xfde80000fd2800,0x10a6000010a2000,0x10be000010b2000,0x118580001181800,0x119d80001191800,0x126500001261000,0x127d00001271000,0x134480001340800,0x135c80001350800,0x142400001420000,0x143c00001430000,0x150780001503800,0x151f80001513800,0x15e7000015e3000,0x15ff000015f3000
.quad 0xf8280000f82000,0xf8380000f83000,0x106080001060000,0x106180001061000,0x113e8000113e000,0x113f8000113f000,0x121c8000121c000,0x121d8000121d000,0x12fa800012fa000,0x12fb800012fb000,0x13d8800013d8000,0x13d9800013d9000,0x14b0800014b0000,0x14b1800014b1000,0x15a4800015a4000,0x15a5800015a5000
.quad 0xf9080000f90000,0xf9180000f91000,0x106e8000106e000,0x106f8000106f000,0x114c8000114c000,0x114d8000114d000,0x122a8000122a000,0x122b8000122b000,0x130880001308000,0x130980001309000,0x13e6800013e6000,0x13e7800013e7000,0x14b2800014b2000,0x14b3800014b3000,0x15b2800015b2000,0x15b3800015b3000
.quad 0xf9e80000f9e000,0xf9f80000f9f000,0x107c8000107c000,0x107d8000107d000,0x115a8000115a000,0x115b8000115b000,0x123880001238000,0x123980001239000,0x131680001316000,0x131780001317000,0x13f4800013f4000,0x13f5800013f5000,0x14b4800014b4000,0x14b5800014b5000,0x15c0800015c0000,0x15c1800015c1000
.quad 0xfac80000fac000,0xfad80000fad000,0x108a8000108a000,0x108b8000108b000,0x116880001168000,0x116980001169000,0x124680001246000,0x124780001247000,0x132480001324000,0x132580001325000,0x140280001402000,0x140380001403000,0x14b6800014b6000,0x14b7800014b7000,0x15ce800015ce000,0x15cf800015cf000
.quad 0xfbb00000fb3000,0xfd700000fcb000,0x109a80001092800,0x10b6800010aa800,0x117a00001172000,0x11960000118a000,0x125980001251800,0x127580001269800,0x133900001331000,0x135500001349000,0x141880001410800,0x143480001428800,0x14f8000014f0000,0x151400001508000,0x15db800015d3800,0x15f7800015eb800
.quad 0xfbf00000fb7000,0xfdb00000fcf000,0x109e80001096800,0x10ba800010ae800,0x117e00001176000,0x119a0000118e000,0x125d80001255800,0x12798000126d800,0x133d00001335000,0x13590000134d000,0x141c80001414800,0x14388000142c800,0x14fc000014f4000,0x15180000150c000,0x15df800015d7800,0x15fb800015ef800
.quad 0xfc700000fc3000,0xfdf00000fd3000,0x10a6800010a2800,0x10be800010b2800,0x118600001182000,0x119e00001192000,0x126580001261800,0x127d80001271800,0x134500001341000,0x135d00001351000,0x142480001420800,0x143c80001430800,0x150400001500000,0x151c00001510000,0x15e7800015e3800,0x15ff800015f3800
.quad 0xf8480000f84000,0xf8580000f85000,0x106280001062000,0x106380001063000,0x114080001140000,0x114180001141000,0x121e8000121e000,0x121f8000121f000,0x12fc800012fc000,0x12fd800012fd000,0x13da800013da000,0x13db800013db000,0x14b8800014b8000,0x14b9800014b9000,0x159080001590000,0x159180001591000
.quad 0xf9280000f92000,0xf9380000f93000,0x107080001070000,0x107180001071000,0x114e8000114e000,0x114f8000114f000,0x122c8000122c000,0x122d8000122d000,0x130a8000130a000,0x130b8000130b000,0x13e8800013e8000,0x13e9800013e9000,0x14c6800014c6000,0x14c7800014c7000,0x159280001592000,0x159380001593000
.quad 0xfa080000fa0000,0xfa180000fa1000,0x107e8000107e000,0x107f8000107f000,0x115c8000115c000,0x115d8000115d000,0x123a8000123a000,0x123b8000123b000,0x131880001318000,0x131980001319000,0x13f6800013f6000,0x13f7800013f7000,0x14d4800014d4000,0x14d5800014d5000,0x159480001594000,0x159580001595000
.quad 0xfae80000fae000,0xfaf80000faf000,0x108c8000108c000,0x108d8000108d000,0x116a8000116a000,0x116b8000116b000,0x124880001248000,0x124980001249000,0x132680001326000,0x132780001327000,0x140480001404000,0x140580001405000,0x14e2800014e2000,0x14e3800014e3000,0x159680001596000,0x159780001597000
.quad 0xfbb80000fb3800,0xfd780000fcb800,0x109b00001093000,0x10b7000010ab000,0x117a80001172800,0x11968000118a800,0x125a00001252000,0x12760000126a000,0x133980001331800,0x135580001349800,0x141900001411000,0x143500001429000,0x14f8800014f0800,0x151480001508800,0x15d8000015d0000,0x15f4000015e8000
.quad 0xfbf80000fb7800,0xfdb80000fcf800,0x109f00001097000,0x10bb000010af000,0x117e80001176800,0x119a8000118e800,0x125e00001256000,0x127a0000126e000,0x133d80001335800,0x13598000134d800,0x141d00001415000,0x14390000142d000,0x14fc800014f4800,0x15188000150c800,0x15dc000015d4000,0x15f8000015ec000
.quad 0xfc780000fc3800,0xfdf80000fd3800,0x10a7000010a3000,0x10bf000010b3000,0x118680001182800,0x119e80001192800,0x126600001262000,0x127e00001272000,0x134580001341800,0x135d80001351800,0x142500001421000,0x143d00001431000,0x150480001500800,0x151c80001510800,0x15e4000015e0000,0x15fc000015f0000
.size tab_i, 88064
```
